```python
import torch

def _softmax(x, axis=-1):
    return torch.softmax(x, dim=axis)

def _gelu(x):
    return torch.nn.functional.gelu(x, approximate='tanh')

def _silu(x):
    return torch.nn.functional.silu(x)

def _sigmoid(x):
    return torch.sigmoid(x)

def _layernorm(x, axis=-1, eps=1e-05):
    m = x.mean(dim=axis, keepdim=True)
    v = x.var(dim=axis, keepdim=True, unbiased=False)
    return (x - m) / torch.sqrt(v + eps)

def _scatter_add(tgt, idx, src, axis=0):
    return tgt.clone().index_add_(axis, idx, src)

def _segment_sum(src, seg, n):
    out = torch.zeros((n,) + src.shape[1:], dtype=src.dtype)
    return out.index_add_(0, seg, src)

def _pad(x, pw):
    flat = tuple((v for pair in reversed(pw) for v in pair))
    return torch.nn.functional.pad(x, flat)
kernel_name = 'adaLN_cond__ssm_conv_h3__mixer_s_mlp__prompt'

def setup_inputs():

    _w = lambda a: (lambda t: t.to(torch.bfloat16) if t.is_floating_point() else t)(torch.as_tensor(a))

    def _A_setup():
        B, S, D = (1, 2048, 640)
        ks = 4
        return {'q': _w((lambda *s: torch.randn(*s, dtype=torch.bfloat16) * 0.05)(B, S, D)), 'k': _w((lambda *s: torch.randn(*s, dtype=torch.bfloat16) * 0.8)(B, S, D)), 'v': _w((lambda *s: torch.randn(*s, dtype=torch.bfloat16) * 0.8)(B, S, D)), 'shift_k': _w((lambda *s: torch.randn(*s, dtype=torch.bfloat16) * 0.8)(D, ks) * 0.5), 'ssm_k': _w((lambda *s: torch.randn(*s, dtype=torch.bfloat16) * 0.8)(D, S) * (1.0 / S ** 0.5)), 'ssm_D': _w((lambda *s: torch.randn(*s, dtype=torch.bfloat16) * 0.8)(D))}
    _A_in = _A_setup()

    def _B_setup():
        B, S, D, F = (1, 2048, 640, 1728)
        return {'x': _w((lambda *s: torch.randn(*s, dtype=torch.bfloat16) * 0.05)(B, S, D)), 'w1': _w((lambda *s: torch.randn(*s, dtype=torch.bfloat16) * 3.2)(D, D) * D ** (-0.5)), 'w2': _w((lambda *s: torch.randn(*s, dtype=torch.bfloat16) * 3.2)(D, D) * D ** (-0.5)), 'w3': _w((lambda *s: torch.randn(*s, dtype=torch.bfloat16) * 3.2)(D, F) * D ** (-0.5)), 'w4': _w((lambda *s: torch.randn(*s, dtype=torch.bfloat16) * 3.2)(F, D) * F ** (-0.5))}
    _B_in = _B_setup()
    return {'A_q': _A_in['q'], 'A_k': _A_in['k'], 'A_v': _A_in['v'], 'A_shift_k': _A_in['shift_k'], 'A_ssm_k': _A_in['ssm_k'], 'A_ssm_D': _A_in['ssm_D'], 'B_x': _B_in['x'], 'B_w1': _B_in['w1'], 'B_w2': _B_in['w2'], 'B_w3': _B_in['w3'], 'B_w4': _B_in['w4'], 'c': _w((lambda *s: torch.randn(*s, dtype=torch.bfloat16) * 0.1)(1, 640) * 8.0), 'w_mod': _w((lambda *s: torch.randn(*s, dtype=torch.bfloat16) * 0.1)(640, 6 * 640) * 640 ** (-0.5) * 8.0)}

def reference(A_q, A_k, A_v, A_shift_k, A_ssm_k, A_ssm_D, B_x, B_w1, B_w2, B_w3, B_w4, c, w_mod):

    def _A_ref(q, k, v, shift_k, ssm_k, ssm_D):
        B, S, D = q.shape
        ks = shift_k.shape[-1]
        k_pad = _pad(k, ((0, 0), (ks - 1, 0), (0, 0)))
        k_shift = torch.zeros_like(k)
        for t in range(ks):
            k_shift = k_shift + k_pad[:, t:t + S, :] * shift_k[:, ks - 1 - t][None, None, :]
        kv = k_shift * v
        L = 2 * S
        kv_pad = _pad(kv, ((0, 0), (0, S), (0, 0)))
        kf_pad = _pad(ssm_k, ((0, 0), (0, S)))
        kv_f = (lambda x, axes=(-2, -1): torch.fft.rfft2(x.float(), dim=axes))(kv_pad[:, None, :, :], axes=(1, 2))
        kf_f = (lambda x, axes=(-2, -1): torch.fft.rfft2(x.float(), dim=axes))(kf_pad[:, None, :], axes=(1, 2))
        kf_f = (lambda x, *d: x.permute(*d))(kf_f, 1, 2, 0)
        y_f = kv_f * kf_f[None, :, :, :]
        y = (lambda x, s, axes=(-2, -1): torch.fft.irfft2(x, s=s, dim=axes).to(torch.bfloat16))(y_f, (1, L), axes=(1, 2))[:, 0, :S, :]
        y = y + kv * ssm_D[None, None, :]
        return q * y

    def _B_ref(x, w1, w2, w3, w4):
        B, S, D = x.shape
        h = _gelu(_layernorm(x, axis=-1) @ w1)
        c = D // 4
        g0 = _pad(h[:, :, 0 * c:1 * c], ((0, 0), (1, 0), (0, 0)))[:, :S, :]
        g1 = _pad(h[:, :, 1 * c:2 * c], ((0, 0), (0, 1), (0, 0)))[:, 1:, :]
        g2 = _pad(h[:, :, 2 * c:3 * c], ((0, 0), (2, 0), (0, 0)))[:, :S, :]
        g3 = _pad(h[:, :, 3 * c:], ((0, 0), (0, 2), (0, 0)))[:, 2:, :]
        hs = torch.concatenate([g0, g1, g2, g3], axis=-1) @ w2
        x1 = x + hs
        h2 = _gelu(_layernorm(x1, axis=-1) @ w3) @ w4
        return x1 + h2
    x = A_q
    mod = (_silu(c) @ w_mod).reshape(c.shape[0], 6, 1, -1)
    sa, ca, ga, sb, cb, gb = (mod[:, 0].clone(), mod[:, 1].clone(), mod[:, 2].clone(), mod[:, 3].clone(), mod[:, 4].clone(), mod[:, 5].clone())
    h = _layernorm(x, axis=-1) * (1 + ca) + sa
    x = x + ga * _A_ref(h, A_k, A_v, A_shift_k, A_ssm_k, A_ssm_D)
    h = _layernorm(x, axis=-1) * (1 + cb) + sb
    x = x + gb * _B_ref(h, B_w1, B_w2, B_w3, B_w4)
    return x
```

```asm
; @launch kernel=k0_kernel grid=(456,1,1) block=(256,1,1) lds=24576
; @launch kernel=k1_kernel grid=(408,1,1) block=(256,1,1) lds=70656
; @launch kernel=chain_kernel grid=(256,1,1) block=(256,1,1) lds=163840
.amdgcn_target "amdgcn-amd-amdhsa--gfx950"
.text
.globl k0_kernel
.p2align 8
.type k0_kernel,@function
k0_kernel:
    s_cmp_ge_u32 s2, 456
    s_cbranch_scc1 k0_end
    s_cmp_ge_u32 s2, 416
    s_cbranch_scc1 k0_pf
    s_cmp_ge_u32 s2, 352
    s_cbranch_scc1 k0_st
    s_cmp_ge_u32 s2, 320
    s_cbranch_scc1 k0_mod
    s_load_dwordx2 s[12:13], s[0:1], 0
    s_load_dwordx4 s[4:7], s[0:1], 8
    s_load_dwordx2 s[8:9], s[0:1], 24
    s_load_dwordx2 s[10:11], s[0:1], 120
    s_waitcnt lgkmcnt(0)
    s_mov_b32 s28, s10
    s_mov_b32 s29, s11
    s_mov_b32 s30, 268435456
    s_mov_b32 s31, 0x00020000
    s_mov_b32 s16, s4
    s_mov_b32 s17, s5
    s_mov_b32 s18, 2621440
    s_mov_b32 s19, 0x00020000
    s_mov_b32 s20, s6
    s_mov_b32 s21, s7
    s_mov_b32 s22, 2621440
    s_mov_b32 s23, 0x00020000
    s_mov_b32 s24, s8
    s_mov_b32 s25, s9
    s_mov_b32 s26, 5120
    s_mov_b32 s27, 0x00020000
    s_mov_b32 s44, s12
    s_mov_b32 s45, s13
    s_mov_b32 s46, 2621440
    s_mov_b32 s47, 0x00020000
    s_mul_i32 s32, s2, 52429
    s_lshr_b32 s32, s32, 19
    s_mul_i32 s33, s32, 10
    s_sub_u32 s33, s2, s33
    v_and_b32 v1, 15, v0
    v_lshrrev_b32 v2, 4, v0
    s_lshl_b32 s34, s32, 6
    v_lshl_add_u32 v3, v2, 2, s34
    v_mul_u32_u24 v4, 1280, v3
    s_lshl_b32 s35, s33, 7
    v_lshl_add_u32 v5, v1, 3, s35
    v_add_u32 v4, v4, v5
    v_subrev_u32 v6, 3840, v4
    v_subrev_u32 v7, 2560, v4
    v_subrev_u32 v8, 1280, v4
    buffer_load_dwordx2 v[10:11], v6, s[16:19], 0 offen
    buffer_load_dwordx2 v[12:13], v7, s[16:19], 0 offen
    buffer_load_dwordx2 v[14:15], v8, s[16:19], 0 offen
    buffer_load_dwordx2 v[16:17], v4, s[16:19], 0 offen offset:0
    buffer_load_dwordx2 v[18:19], v4, s[16:19], 0 offen offset:1280
    buffer_load_dwordx2 v[20:21], v4, s[16:19], 0 offen offset:2560
    buffer_load_dwordx2 v[22:23], v4, s[16:19], 0 offen offset:3840
    v_lshlrev_b32 v100, 2, v5
    buffer_load_dwordx4 v[32:35], v100, s[24:27], 0 offen
    buffer_load_dwordx4 v[36:39], v100, s[24:27], 0 offen offset:16
    buffer_load_dwordx2 v[24:25], v4, s[20:23], 0 offen offset:0
    buffer_load_dwordx2 v[26:27], v4, s[20:23], 0 offen offset:1280
    buffer_load_dwordx2 v[28:29], v4, s[20:23], 0 offen offset:2560
    buffer_load_dwordx2 v[30:31], v4, s[20:23], 0 offen offset:3840
    buffer_load_dwordx2 v[112:113], v4, s[44:47], 0 offen offset:0
    buffer_load_dwordx2 v[114:115], v4, s[44:47], 0 offen offset:1280
    buffer_load_dwordx2 v[116:117], v4, s[44:47], 0 offen offset:2560
    buffer_load_dwordx2 v[118:119], v4, s[44:47], 0 offen offset:3840
    v_lshlrev_b32 v100, 9, v1
    v_sub_u32 v101, 15, v2
    v_lshl_add_u32 v100, v101, 3, v100
    v_lshrrev_b32 v101, 2, v2
    v_lshlrev_b32 v101, 11, v101
    v_lshl_add_u32 v101, v1, 7, v101
    v_add_u32 v101, 8192, v101
    v_bfe_u32 v102, v1, 1, 3
    v_and_b32 v103, 3, v2
    v_lshlrev_b32 v103, 1, v103
    v_xor_b32 v102, v102, v103
    v_xor_b32 v103, 1, v102
    v_lshl_add_u32 v102, v102, 4, v101
    v_lshl_add_u32 v103, v103, 4, v101
    s_waitcnt vmcnt(8)
    v_lshlrev_b32 v40, 16, v32
    v_and_b32 v44, 0xffff0000, v32
    v_lshlrev_b32 v48, 16, v33
    v_and_b32 v52, 0xffff0000, v33
    v_lshlrev_b32 v41, 16, v34
    v_and_b32 v45, 0xffff0000, v34
    v_lshlrev_b32 v49, 16, v35
    v_and_b32 v53, 0xffff0000, v35
    v_lshlrev_b32 v42, 16, v36
    v_and_b32 v46, 0xffff0000, v36
    v_lshlrev_b32 v50, 16, v37
    v_and_b32 v54, 0xffff0000, v37
    v_lshlrev_b32 v43, 16, v38
    v_and_b32 v47, 0xffff0000, v38
    v_lshlrev_b32 v51, 16, v39
    v_and_b32 v55, 0xffff0000, v39
    v_lshlrev_b32 v56, 16, v10
    v_and_b32 v57, 0xffff0000, v10
    v_lshlrev_b32 v58, 16, v11
    v_and_b32 v59, 0xffff0000, v11
    v_lshlrev_b32 v60, 16, v12
    v_and_b32 v61, 0xffff0000, v12
    v_lshlrev_b32 v62, 16, v13
    v_and_b32 v63, 0xffff0000, v13
    v_lshlrev_b32 v64, 16, v14
    v_and_b32 v65, 0xffff0000, v14
    v_lshlrev_b32 v66, 16, v15
    v_and_b32 v67, 0xffff0000, v15
    v_lshlrev_b32 v68, 16, v16
    v_and_b32 v69, 0xffff0000, v16
    v_lshlrev_b32 v70, 16, v17
    v_and_b32 v71, 0xffff0000, v17
    v_lshlrev_b32 v72, 16, v18
    v_and_b32 v73, 0xffff0000, v18
    v_lshlrev_b32 v74, 16, v19
    v_and_b32 v75, 0xffff0000, v19
    v_lshlrev_b32 v76, 16, v20
    v_and_b32 v77, 0xffff0000, v20
    v_lshlrev_b32 v78, 16, v21
    v_and_b32 v79, 0xffff0000, v21
    v_lshlrev_b32 v80, 16, v22
    v_and_b32 v81, 0xffff0000, v22
    v_lshlrev_b32 v82, 16, v23
    v_and_b32 v83, 0xffff0000, v23
    v_pk_mul_f32 v[84:85], v[56:57], v[52:53]
    v_pk_fma_f32 v[84:85], v[60:61], v[48:49], v[84:85]
    v_pk_fma_f32 v[84:85], v[64:65], v[44:45], v[84:85]
    v_pk_fma_f32 v[84:85], v[68:69], v[40:41], v[84:85]
    v_cvt_pk_bf16_f32 v104, v84, v85
    v_lshlrev_b32 v84, 16, v104
    v_and_b32 v85, 0xffff0000, v104
    v_pk_mul_f32 v[86:87], v[58:59], v[54:55]
    v_pk_fma_f32 v[86:87], v[62:63], v[50:51], v[86:87]
    v_pk_fma_f32 v[86:87], v[66:67], v[46:47], v[86:87]
    v_pk_fma_f32 v[86:87], v[70:71], v[42:43], v[86:87]
    v_cvt_pk_bf16_f32 v104, v86, v87
    v_lshlrev_b32 v86, 16, v104
    v_and_b32 v87, 0xffff0000, v104
    v_pk_mul_f32 v[88:89], v[60:61], v[52:53]
    v_pk_fma_f32 v[88:89], v[64:65], v[48:49], v[88:89]
    v_pk_fma_f32 v[88:89], v[68:69], v[44:45], v[88:89]
    v_pk_fma_f32 v[88:89], v[72:73], v[40:41], v[88:89]
    v_cvt_pk_bf16_f32 v104, v88, v89
    v_lshlrev_b32 v88, 16, v104
    v_and_b32 v89, 0xffff0000, v104
    v_pk_mul_f32 v[90:91], v[62:63], v[54:55]
    v_pk_fma_f32 v[90:91], v[66:67], v[50:51], v[90:91]
    v_pk_fma_f32 v[90:91], v[70:71], v[46:47], v[90:91]
    v_pk_fma_f32 v[90:91], v[74:75], v[42:43], v[90:91]
    v_cvt_pk_bf16_f32 v104, v90, v91
    v_lshlrev_b32 v90, 16, v104
    v_and_b32 v91, 0xffff0000, v104
    v_pk_mul_f32 v[92:93], v[64:65], v[52:53]
    v_pk_fma_f32 v[92:93], v[68:69], v[48:49], v[92:93]
    v_pk_fma_f32 v[92:93], v[72:73], v[44:45], v[92:93]
    v_pk_fma_f32 v[92:93], v[76:77], v[40:41], v[92:93]
    v_cvt_pk_bf16_f32 v104, v92, v93
    v_lshlrev_b32 v92, 16, v104
    v_and_b32 v93, 0xffff0000, v104
    v_pk_mul_f32 v[94:95], v[66:67], v[54:55]
    v_pk_fma_f32 v[94:95], v[70:71], v[50:51], v[94:95]
    v_pk_fma_f32 v[94:95], v[74:75], v[46:47], v[94:95]
    v_pk_fma_f32 v[94:95], v[78:79], v[42:43], v[94:95]
    v_cvt_pk_bf16_f32 v104, v94, v95
    v_lshlrev_b32 v94, 16, v104
    v_and_b32 v95, 0xffff0000, v104
    v_pk_mul_f32 v[96:97], v[68:69], v[52:53]
    v_pk_fma_f32 v[96:97], v[72:73], v[48:49], v[96:97]
    v_pk_fma_f32 v[96:97], v[76:77], v[44:45], v[96:97]
    v_pk_fma_f32 v[96:97], v[80:81], v[40:41], v[96:97]
    v_cvt_pk_bf16_f32 v104, v96, v97
    v_lshlrev_b32 v96, 16, v104
    v_and_b32 v97, 0xffff0000, v104
    v_pk_mul_f32 v[98:99], v[70:71], v[54:55]
    v_pk_fma_f32 v[98:99], v[74:75], v[50:51], v[98:99]
    v_pk_fma_f32 v[98:99], v[78:79], v[46:47], v[98:99]
    v_pk_fma_f32 v[98:99], v[82:83], v[42:43], v[98:99]
    v_cvt_pk_bf16_f32 v104, v98, v99
    v_lshlrev_b32 v98, 16, v104
    v_and_b32 v99, 0xffff0000, v104
    s_waitcnt vmcnt(4)
    v_lshlrev_b32 v104, 16, v24
    v_and_b32 v105, 0xffff0000, v24
    v_pk_mul_f32 v[84:85], v[84:85], v[104:105]
    v_lshlrev_b32 v104, 16, v25
    v_and_b32 v105, 0xffff0000, v25
    v_pk_mul_f32 v[86:87], v[86:87], v[104:105]
    v_lshlrev_b32 v104, 16, v26
    v_and_b32 v105, 0xffff0000, v26
    v_pk_mul_f32 v[88:89], v[88:89], v[104:105]
    v_lshlrev_b32 v104, 16, v27
    v_and_b32 v105, 0xffff0000, v27
    v_pk_mul_f32 v[90:91], v[90:91], v[104:105]
    v_lshlrev_b32 v104, 16, v28
    v_and_b32 v105, 0xffff0000, v28
    v_pk_mul_f32 v[92:93], v[92:93], v[104:105]
    v_lshlrev_b32 v104, 16, v29
    v_and_b32 v105, 0xffff0000, v29
    v_pk_mul_f32 v[94:95], v[94:95], v[104:105]
    v_lshlrev_b32 v104, 16, v30
    v_and_b32 v105, 0xffff0000, v30
    v_pk_mul_f32 v[96:97], v[96:97], v[104:105]
    v_lshlrev_b32 v104, 16, v31
    v_and_b32 v105, 0xffff0000, v31
    v_pk_mul_f32 v[98:99], v[98:99], v[104:105]
    v_cvt_pk_bf16_f32 v56, v84, v85
    v_cvt_pk_bf16_f32 v57, v86, v87
    v_cvt_pk_bf16_f32 v58, v88, v89
    v_cvt_pk_bf16_f32 v59, v90, v91
    v_cvt_pk_bf16_f32 v60, v92, v93
    v_cvt_pk_bf16_f32 v61, v94, v95
    v_cvt_pk_bf16_f32 v62, v96, v97
    v_cvt_pk_bf16_f32 v63, v98, v99
    v_cvt_pk_bf16_f32 v64, v96, v92
    v_cvt_pk_bf16_f32 v65, v88, v84
    v_cvt_pk_bf16_f32 v66, v97, v93
    v_cvt_pk_bf16_f32 v67, v89, v85
    v_cvt_pk_bf16_f32 v68, v98, v94
    v_cvt_pk_bf16_f32 v69, v90, v86
    v_cvt_pk_bf16_f32 v70, v99, v95
    v_cvt_pk_bf16_f32 v71, v91, v87
    ds_write_b64 v100, v[64:65] offset:0
    ds_write_b64 v100, v[66:67] offset:128
    ds_write_b64 v100, v[68:69] offset:256
    ds_write_b64 v100, v[70:71] offset:384
    ds_write_b128 v102, v[56:59]
    ds_write_b128 v103, v[60:63]
    s_waitcnt vmcnt(0)
    ds_write_b128 v102, v[112:115] offset:8192
    ds_write_b128 v103, v[116:119] offset:8192
    v_lshlrev_b32 v100, 4, v0
    v_lshrrev_b32 v101, 3, v0
    v_mul_u32_u24 v101, 4352, v101
    v_and_b32 v102, 7, v0
    v_lshl_add_u32 v103, v102, 4, v101
    v_lshrrev_b32 v104, 7, v0
    v_mul_u32_u24 v104, 20480, v104
    v_and_b32 v105, 127, v0
    v_lshl_add_u32 v104, v105, 4, v104
    s_mul_i32 s36, s33, 278528
    s_lshr_b32 s37, s32, 1
    s_mul_i32 s37, s37, 272
    s_add_u32 s36, s36, s37
    s_add_u32 s36, s36, 0
    s_and_b32 s37, s32, 1
    s_lshl_b32 s38, s37, 7
    s_sub_u32 s38, 128, s38
    s_add_u32 s38, s38, s36
    s_mul_i32 s39, s32, 81920
    s_lshl_b32 s40, s33, 11
    s_add_u32 s39, s39, s40
    s_add_u32 s39, s39, 2793472
    s_waitcnt lgkmcnt(0)
    s_barrier
    ds_read_b128 v[10:13], v100 offset:0
    ds_read_b128 v[14:17], v100 offset:4096
    ds_read_b128 v[18:21], v100 offset:8192
    ds_read_b128 v[22:25], v100 offset:12288
    ds_read_b128 v[112:115], v100 offset:16384
    ds_read_b128 v[116:119], v100 offset:20480
    s_add_u32 s41, s39, 2621440
    s_waitcnt lgkmcnt(5)
    buffer_store_dwordx4 v[10:13], v103, s[28:31], s38 offen sc1
    s_add_u32 s38, s38, 139264
    s_waitcnt lgkmcnt(4)
    buffer_store_dwordx4 v[14:17], v103, s[28:31], s38 offen sc1
    s_add_u32 s38, s38, 139264
    s_waitcnt lgkmcnt(3)
    buffer_store_dwordx4 v[18:21], v104, s[28:31], s39 offen sc1
    s_add_u32 s39, s39, 40960
    s_waitcnt lgkmcnt(2)
    buffer_store_dwordx4 v[22:25], v104, s[28:31], s39 offen sc1
    s_add_u32 s39, s39, 40960
    s_waitcnt lgkmcnt(1)
    buffer_store_dwordx4 v[112:115], v104, s[28:31], s41 offen sc1
    s_add_u32 s41, s41, 40960
    s_waitcnt lgkmcnt(0)
    buffer_store_dwordx4 v[116:119], v104, s[28:31], s41 offen sc1
    s_add_u32 s41, s41, 40960
    v_cmp_eq_u32 vcc, 0, v102
    s_and_saveexec_b64 s[42:43], vcc
    s_cmp_eq_u32 s37, 0
    s_cbranch_scc1 k0_kernel_L1
    s_cmp_eq_u32 s32, 31
    s_cbranch_scc1 k0_kernel_L2
    buffer_store_dwordx4 v[10:13], v101, s[28:31], s36 offen offset:528 sc1
    s_add_u32 s36, s36, 139264
    buffer_store_dwordx4 v[14:17], v101, s[28:31], s36 offen offset:528 sc1
    s_add_u32 s36, s36, 139264
    s_branch k0_kernel_L2
k0_kernel_L1:
    s_cmp_lg_u32 s32, 0
    s_cbranch_scc1 k0_kernel_L2
    v_mov_b32 v108, 0
    v_mov_b32 v109, 0
    v_mov_b32 v110, 0
    v_mov_b32 v111, 0
    buffer_store_dwordx4 v[108:111], v101, s[28:31], s36 offen offset:256 sc1
    s_add_u32 s36, s36, 139264
    buffer_store_dwordx4 v[108:111], v101, s[28:31], s36 offen offset:256 sc1
    s_add_u32 s36, s36, 139264
k0_kernel_L2:
    s_endpgm
k0_end:
    s_endpgm
k0_mod:
    s_cmp_ge_u32 s2, 350
    s_cbranch_scc1 k0_end
    s_load_dwordx4 s[12:15], s[0:1], 88
    s_load_dwordx2 s[10:11], s[0:1], 120
    s_sub_u32 s32, s2, 320
    v_and_b32 v3, 7, v0
    v_lshrrev_b32 v4, 3, v0
    v_lshlrev_b32 v5, 1, v4
    v_mul_u32_u24 v6, 7680, v4
    s_lshl_b32 s36, s32, 7
    v_lshl_add_u32 v7, v3, 4, s36
    v_add_u32 v6, v6, v7
    s_waitcnt lgkmcnt(0)
    s_mov_b32 s16, s12
    s_mov_b32 s17, s13
    s_mov_b32 s18, 1280
    s_mov_b32 s19, 0x00020000
    s_mov_b32 s20, s14
    s_mov_b32 s21, s15
    s_mov_b32 s22, 4915200
    s_mov_b32 s23, 0x00020000
    s_mov_b32 s28, s10
    s_mov_b32 s29, s11
    s_mov_b32 s30, 268435456
    s_mov_b32 s31, 0x00020000
    buffer_load_ushort v10, v5, s[16:19], 0 offen offset:0
    buffer_load_ushort v11, v5, s[16:19], 0 offen offset:64
    buffer_load_ushort v12, v5, s[16:19], 0 offen offset:128
    buffer_load_ushort v13, v5, s[16:19], 0 offen offset:192
    buffer_load_ushort v14, v5, s[16:19], 0 offen offset:256
    buffer_load_ushort v15, v5, s[16:19], 0 offen offset:320
    buffer_load_ushort v16, v5, s[16:19], 0 offen offset:384
    buffer_load_ushort v17, v5, s[16:19], 0 offen offset:448
    buffer_load_ushort v18, v5, s[16:19], 0 offen offset:512
    buffer_load_ushort v19, v5, s[16:19], 0 offen offset:576
    buffer_load_ushort v20, v5, s[16:19], 0 offen offset:640
    buffer_load_ushort v21, v5, s[16:19], 0 offen offset:704
    buffer_load_ushort v22, v5, s[16:19], 0 offen offset:768
    buffer_load_ushort v23, v5, s[16:19], 0 offen offset:832
    buffer_load_ushort v24, v5, s[16:19], 0 offen offset:896
    buffer_load_ushort v25, v5, s[16:19], 0 offen offset:960
    buffer_load_ushort v26, v5, s[16:19], 0 offen offset:1024
    buffer_load_ushort v27, v5, s[16:19], 0 offen offset:1088
    buffer_load_ushort v28, v5, s[16:19], 0 offen offset:1152
    buffer_load_ushort v29, v5, s[16:19], 0 offen offset:1216
    s_mov_b32 s37, 0
    buffer_load_dwordx4 v[32:35], v6, s[20:23], s37 offen
    s_mov_b32 s37, 245760
    buffer_load_dwordx4 v[36:39], v6, s[20:23], s37 offen
    s_mov_b32 s37, 491520
    buffer_load_dwordx4 v[40:43], v6, s[20:23], s37 offen
    s_mov_b32 s37, 737280
    buffer_load_dwordx4 v[44:47], v6, s[20:23], s37 offen
    s_mov_b32 s37, 983040
    buffer_load_dwordx4 v[48:51], v6, s[20:23], s37 offen
    s_mov_b32 s37, 1228800
    buffer_load_dwordx4 v[52:55], v6, s[20:23], s37 offen
    s_mov_b32 s37, 1474560
    buffer_load_dwordx4 v[56:59], v6, s[20:23], s37 offen
    s_mov_b32 s37, 1720320
    buffer_load_dwordx4 v[60:63], v6, s[20:23], s37 offen
    s_mov_b32 s37, 1966080
    buffer_load_dwordx4 v[64:67], v6, s[20:23], s37 offen
    s_mov_b32 s37, 2211840
    buffer_load_dwordx4 v[68:71], v6, s[20:23], s37 offen
    s_mov_b32 s37, 2457600
    buffer_load_dwordx4 v[72:75], v6, s[20:23], s37 offen
    s_mov_b32 s37, 2703360
    buffer_load_dwordx4 v[76:79], v6, s[20:23], s37 offen
    s_mov_b32 s37, 2949120
    buffer_load_dwordx4 v[80:83], v6, s[20:23], s37 offen
    s_mov_b32 s37, 3194880
    buffer_load_dwordx4 v[84:87], v6, s[20:23], s37 offen
    s_mov_b32 s37, 3440640
    buffer_load_dwordx4 v[88:91], v6, s[20:23], s37 offen
    s_mov_b32 s37, 3686400
    buffer_load_dwordx4 v[92:95], v6, s[20:23], s37 offen
    s_mov_b32 s37, 3932160
    buffer_load_dwordx4 v[96:99], v6, s[20:23], s37 offen
    s_mov_b32 s37, 4177920
    buffer_load_dwordx4 v[100:103], v6, s[20:23], s37 offen
    s_mov_b32 s37, 4423680
    buffer_load_dwordx4 v[104:107], v6, s[20:23], s37 offen
    s_mov_b32 s37, 4669440
    buffer_load_dwordx4 v[108:111], v6, s[20:23], s37 offen
    s_waitcnt vmcnt(20)
    v_lshlrev_b32 v10, 16, v10
    v_mul_f32 v120, 0xbfb8aa3b, v10
    v_exp_f32 v120, v120
    v_lshlrev_b32 v11, 16, v11
    v_mul_f32 v121, 0xbfb8aa3b, v11
    v_exp_f32 v121, v121
    v_lshlrev_b32 v12, 16, v12
    v_mul_f32 v122, 0xbfb8aa3b, v12
    v_exp_f32 v122, v122
    v_lshlrev_b32 v13, 16, v13
    v_mul_f32 v123, 0xbfb8aa3b, v13
    v_exp_f32 v123, v123
    v_lshlrev_b32 v14, 16, v14
    v_mul_f32 v124, 0xbfb8aa3b, v14
    v_exp_f32 v124, v124
    v_lshlrev_b32 v15, 16, v15
    v_mul_f32 v125, 0xbfb8aa3b, v15
    v_exp_f32 v125, v125
    v_lshlrev_b32 v16, 16, v16
    v_mul_f32 v126, 0xbfb8aa3b, v16
    v_exp_f32 v126, v126
    v_lshlrev_b32 v17, 16, v17
    v_mul_f32 v127, 0xbfb8aa3b, v17
    v_exp_f32 v127, v127
    v_lshlrev_b32 v18, 16, v18
    v_mul_f32 v128, 0xbfb8aa3b, v18
    v_exp_f32 v128, v128
    v_lshlrev_b32 v19, 16, v19
    v_mul_f32 v129, 0xbfb8aa3b, v19
    v_exp_f32 v129, v129
    v_lshlrev_b32 v20, 16, v20
    v_mul_f32 v130, 0xbfb8aa3b, v20
    v_exp_f32 v130, v130
    v_lshlrev_b32 v21, 16, v21
    v_mul_f32 v131, 0xbfb8aa3b, v21
    v_exp_f32 v131, v131
    v_lshlrev_b32 v22, 16, v22
    v_mul_f32 v132, 0xbfb8aa3b, v22
    v_exp_f32 v132, v132
    v_lshlrev_b32 v23, 16, v23
    v_mul_f32 v133, 0xbfb8aa3b, v23
    v_exp_f32 v133, v133
    v_lshlrev_b32 v24, 16, v24
    v_mul_f32 v134, 0xbfb8aa3b, v24
    v_exp_f32 v134, v134
    v_lshlrev_b32 v25, 16, v25
    v_mul_f32 v135, 0xbfb8aa3b, v25
    v_exp_f32 v135, v135
    v_lshlrev_b32 v26, 16, v26
    v_mul_f32 v136, 0xbfb8aa3b, v26
    v_exp_f32 v136, v136
    v_lshlrev_b32 v27, 16, v27
    v_mul_f32 v137, 0xbfb8aa3b, v27
    v_exp_f32 v137, v137
    v_lshlrev_b32 v28, 16, v28
    v_mul_f32 v138, 0xbfb8aa3b, v28
    v_exp_f32 v138, v138
    v_lshlrev_b32 v29, 16, v29
    v_mul_f32 v139, 0xbfb8aa3b, v29
    v_exp_f32 v139, v139
    v_add_f32 v120, 1.0, v120
    v_rcp_f32 v120, v120
    v_add_f32 v121, 1.0, v121
    v_rcp_f32 v121, v121
    v_add_f32 v122, 1.0, v122
    v_rcp_f32 v122, v122
    v_add_f32 v123, 1.0, v123
    v_rcp_f32 v123, v123
    v_add_f32 v124, 1.0, v124
    v_rcp_f32 v124, v124
    v_add_f32 v125, 1.0, v125
    v_rcp_f32 v125, v125
    v_add_f32 v126, 1.0, v126
    v_rcp_f32 v126, v126
    v_add_f32 v127, 1.0, v127
    v_rcp_f32 v127, v127
    v_add_f32 v128, 1.0, v128
    v_rcp_f32 v128, v128
    v_add_f32 v129, 1.0, v129
    v_rcp_f32 v129, v129
    v_add_f32 v130, 1.0, v130
    v_rcp_f32 v130, v130
    v_add_f32 v131, 1.0, v131
    v_rcp_f32 v131, v131
    v_add_f32 v132, 1.0, v132
    v_rcp_f32 v132, v132
    v_add_f32 v133, 1.0, v133
    v_rcp_f32 v133, v133
    v_add_f32 v134, 1.0, v134
    v_rcp_f32 v134, v134
    v_add_f32 v135, 1.0, v135
    v_rcp_f32 v135, v135
    v_add_f32 v136, 1.0, v136
    v_rcp_f32 v136, v136
    v_add_f32 v137, 1.0, v137
    v_rcp_f32 v137, v137
    v_add_f32 v138, 1.0, v138
    v_rcp_f32 v138, v138
    v_add_f32 v139, 1.0, v139
    v_rcp_f32 v139, v139
    s_nop 0
    v_mul_f32 v10, v10, v120
    v_mul_f32 v11, v11, v121
    v_mul_f32 v12, v12, v122
    v_mul_f32 v13, v13, v123
    v_mul_f32 v14, v14, v124
    v_mul_f32 v15, v15, v125
    v_mul_f32 v16, v16, v126
    v_mul_f32 v17, v17, v127
    v_mul_f32 v18, v18, v128
    v_mul_f32 v19, v19, v129
    v_mul_f32 v20, v20, v130
    v_mul_f32 v21, v21, v131
    v_mul_f32 v22, v22, v132
    v_mul_f32 v23, v23, v133
    v_mul_f32 v24, v24, v134
    v_mul_f32 v25, v25, v135
    v_mul_f32 v26, v26, v136
    v_mul_f32 v27, v27, v137
    v_mul_f32 v28, v28, v138
    v_mul_f32 v29, v29, v139
    v_cvt_pk_bf16_f32 v120, v10, v11
    v_lshlrev_b32 v10, 16, v120
    v_and_b32 v11, 0xffff0000, v120
    v_cvt_pk_bf16_f32 v120, v12, v13
    v_lshlrev_b32 v12, 16, v120
    v_and_b32 v13, 0xffff0000, v120
    v_cvt_pk_bf16_f32 v120, v14, v15
    v_lshlrev_b32 v14, 16, v120
    v_and_b32 v15, 0xffff0000, v120
    v_cvt_pk_bf16_f32 v120, v16, v17
    v_lshlrev_b32 v16, 16, v120
    v_and_b32 v17, 0xffff0000, v120
    v_cvt_pk_bf16_f32 v120, v18, v19
    v_lshlrev_b32 v18, 16, v120
    v_and_b32 v19, 0xffff0000, v120
    v_cvt_pk_bf16_f32 v120, v20, v21
    v_lshlrev_b32 v20, 16, v120
    v_and_b32 v21, 0xffff0000, v120
    v_cvt_pk_bf16_f32 v120, v22, v23
    v_lshlrev_b32 v22, 16, v120
    v_and_b32 v23, 0xffff0000, v120
    v_cvt_pk_bf16_f32 v120, v24, v25
    v_lshlrev_b32 v24, 16, v120
    v_and_b32 v25, 0xffff0000, v120
    v_cvt_pk_bf16_f32 v120, v26, v27
    v_lshlrev_b32 v26, 16, v120
    v_and_b32 v27, 0xffff0000, v120
    v_cvt_pk_bf16_f32 v120, v28, v29
    v_lshlrev_b32 v28, 16, v120
    v_and_b32 v29, 0xffff0000, v120
    v_mov_b32 v112, 0
    v_mov_b32 v113, 0
    v_mov_b32 v114, 0
    v_mov_b32 v115, 0
    v_mov_b32 v116, 0
    v_mov_b32 v117, 0
    v_mov_b32 v118, 0
    v_mov_b32 v119, 0
    s_waitcnt vmcnt(19)
    v_lshlrev_b32 v120, 16, v32
    v_and_b32 v121, 0xffff0000, v32
    v_fmac_f32 v112, v10, v120
    v_fmac_f32 v113, v10, v121
    v_lshlrev_b32 v120, 16, v33
    v_and_b32 v121, 0xffff0000, v33
    v_fmac_f32 v114, v10, v120
    v_fmac_f32 v115, v10, v121
    v_lshlrev_b32 v120, 16, v34
    v_and_b32 v121, 0xffff0000, v34
    v_fmac_f32 v116, v10, v120
    v_fmac_f32 v117, v10, v121
    v_lshlrev_b32 v120, 16, v35
    v_and_b32 v121, 0xffff0000, v35
    v_fmac_f32 v118, v10, v120
    v_fmac_f32 v119, v10, v121
    s_waitcnt vmcnt(18)
    v_lshlrev_b32 v120, 16, v36
    v_and_b32 v121, 0xffff0000, v36
    v_fmac_f32 v112, v11, v120
    v_fmac_f32 v113, v11, v121
    v_lshlrev_b32 v120, 16, v37
    v_and_b32 v121, 0xffff0000, v37
    v_fmac_f32 v114, v11, v120
    v_fmac_f32 v115, v11, v121
    v_lshlrev_b32 v120, 16, v38
    v_and_b32 v121, 0xffff0000, v38
    v_fmac_f32 v116, v11, v120
    v_fmac_f32 v117, v11, v121
    v_lshlrev_b32 v120, 16, v39
    v_and_b32 v121, 0xffff0000, v39
    v_fmac_f32 v118, v11, v120
    v_fmac_f32 v119, v11, v121
    s_waitcnt vmcnt(17)
    v_lshlrev_b32 v120, 16, v40
    v_and_b32 v121, 0xffff0000, v40
    v_fmac_f32 v112, v12, v120
    v_fmac_f32 v113, v12, v121
    v_lshlrev_b32 v120, 16, v41
    v_and_b32 v121, 0xffff0000, v41
    v_fmac_f32 v114, v12, v120
    v_fmac_f32 v115, v12, v121
    v_lshlrev_b32 v120, 16, v42
    v_and_b32 v121, 0xffff0000, v42
    v_fmac_f32 v116, v12, v120
    v_fmac_f32 v117, v12, v121
    v_lshlrev_b32 v120, 16, v43
    v_and_b32 v121, 0xffff0000, v43
    v_fmac_f32 v118, v12, v120
    v_fmac_f32 v119, v12, v121
    s_waitcnt vmcnt(16)
    v_lshlrev_b32 v120, 16, v44
    v_and_b32 v121, 0xffff0000, v44
    v_fmac_f32 v112, v13, v120
    v_fmac_f32 v113, v13, v121
    v_lshlrev_b32 v120, 16, v45
    v_and_b32 v121, 0xffff0000, v45
    v_fmac_f32 v114, v13, v120
    v_fmac_f32 v115, v13, v121
    v_lshlrev_b32 v120, 16, v46
    v_and_b32 v121, 0xffff0000, v46
    v_fmac_f32 v116, v13, v120
    v_fmac_f32 v117, v13, v121
    v_lshlrev_b32 v120, 16, v47
    v_and_b32 v121, 0xffff0000, v47
    v_fmac_f32 v118, v13, v120
    v_fmac_f32 v119, v13, v121
    s_waitcnt vmcnt(15)
    v_lshlrev_b32 v120, 16, v48
    v_and_b32 v121, 0xffff0000, v48
    v_fmac_f32 v112, v14, v120
    v_fmac_f32 v113, v14, v121
    v_lshlrev_b32 v120, 16, v49
    v_and_b32 v121, 0xffff0000, v49
    v_fmac_f32 v114, v14, v120
    v_fmac_f32 v115, v14, v121
    v_lshlrev_b32 v120, 16, v50
    v_and_b32 v121, 0xffff0000, v50
    v_fmac_f32 v116, v14, v120
    v_fmac_f32 v117, v14, v121
    v_lshlrev_b32 v120, 16, v51
    v_and_b32 v121, 0xffff0000, v51
    v_fmac_f32 v118, v14, v120
    v_fmac_f32 v119, v14, v121
    s_waitcnt vmcnt(14)
    v_lshlrev_b32 v120, 16, v52
    v_and_b32 v121, 0xffff0000, v52
    v_fmac_f32 v112, v15, v120
    v_fmac_f32 v113, v15, v121
    v_lshlrev_b32 v120, 16, v53
    v_and_b32 v121, 0xffff0000, v53
    v_fmac_f32 v114, v15, v120
    v_fmac_f32 v115, v15, v121
    v_lshlrev_b32 v120, 16, v54
    v_and_b32 v121, 0xffff0000, v54
    v_fmac_f32 v116, v15, v120
    v_fmac_f32 v117, v15, v121
    v_lshlrev_b32 v120, 16, v55
    v_and_b32 v121, 0xffff0000, v55
    v_fmac_f32 v118, v15, v120
    v_fmac_f32 v119, v15, v121
    s_waitcnt vmcnt(13)
    v_lshlrev_b32 v120, 16, v56
    v_and_b32 v121, 0xffff0000, v56
    v_fmac_f32 v112, v16, v120
    v_fmac_f32 v113, v16, v121
    v_lshlrev_b32 v120, 16, v57
    v_and_b32 v121, 0xffff0000, v57
    v_fmac_f32 v114, v16, v120
    v_fmac_f32 v115, v16, v121
    v_lshlrev_b32 v120, 16, v58
    v_and_b32 v121, 0xffff0000, v58
    v_fmac_f32 v116, v16, v120
    v_fmac_f32 v117, v16, v121
    v_lshlrev_b32 v120, 16, v59
    v_and_b32 v121, 0xffff0000, v59
    v_fmac_f32 v118, v16, v120
    v_fmac_f32 v119, v16, v121
    s_waitcnt vmcnt(12)
    v_lshlrev_b32 v120, 16, v60
    v_and_b32 v121, 0xffff0000, v60
    v_fmac_f32 v112, v17, v120
    v_fmac_f32 v113, v17, v121
    v_lshlrev_b32 v120, 16, v61
    v_and_b32 v121, 0xffff0000, v61
    v_fmac_f32 v114, v17, v120
    v_fmac_f32 v115, v17, v121
    v_lshlrev_b32 v120, 16, v62
    v_and_b32 v121, 0xffff0000, v62
    v_fmac_f32 v116, v17, v120
    v_fmac_f32 v117, v17, v121
    v_lshlrev_b32 v120, 16, v63
    v_and_b32 v121, 0xffff0000, v63
    v_fmac_f32 v118, v17, v120
    v_fmac_f32 v119, v17, v121
    s_waitcnt vmcnt(11)
    v_lshlrev_b32 v120, 16, v64
    v_and_b32 v121, 0xffff0000, v64
    v_fmac_f32 v112, v18, v120
    v_fmac_f32 v113, v18, v121
    v_lshlrev_b32 v120, 16, v65
    v_and_b32 v121, 0xffff0000, v65
    v_fmac_f32 v114, v18, v120
    v_fmac_f32 v115, v18, v121
    v_lshlrev_b32 v120, 16, v66
    v_and_b32 v121, 0xffff0000, v66
    v_fmac_f32 v116, v18, v120
    v_fmac_f32 v117, v18, v121
    v_lshlrev_b32 v120, 16, v67
    v_and_b32 v121, 0xffff0000, v67
    v_fmac_f32 v118, v18, v120
    v_fmac_f32 v119, v18, v121
    s_waitcnt vmcnt(10)
    v_lshlrev_b32 v120, 16, v68
    v_and_b32 v121, 0xffff0000, v68
    v_fmac_f32 v112, v19, v120
    v_fmac_f32 v113, v19, v121
    v_lshlrev_b32 v120, 16, v69
    v_and_b32 v121, 0xffff0000, v69
    v_fmac_f32 v114, v19, v120
    v_fmac_f32 v115, v19, v121
    v_lshlrev_b32 v120, 16, v70
    v_and_b32 v121, 0xffff0000, v70
    v_fmac_f32 v116, v19, v120
    v_fmac_f32 v117, v19, v121
    v_lshlrev_b32 v120, 16, v71
    v_and_b32 v121, 0xffff0000, v71
    v_fmac_f32 v118, v19, v120
    v_fmac_f32 v119, v19, v121
    s_waitcnt vmcnt(9)
    v_lshlrev_b32 v120, 16, v72
    v_and_b32 v121, 0xffff0000, v72
    v_fmac_f32 v112, v20, v120
    v_fmac_f32 v113, v20, v121
    v_lshlrev_b32 v120, 16, v73
    v_and_b32 v121, 0xffff0000, v73
    v_fmac_f32 v114, v20, v120
    v_fmac_f32 v115, v20, v121
    v_lshlrev_b32 v120, 16, v74
    v_and_b32 v121, 0xffff0000, v74
    v_fmac_f32 v116, v20, v120
    v_fmac_f32 v117, v20, v121
    v_lshlrev_b32 v120, 16, v75
    v_and_b32 v121, 0xffff0000, v75
    v_fmac_f32 v118, v20, v120
    v_fmac_f32 v119, v20, v121
    s_waitcnt vmcnt(8)
    v_lshlrev_b32 v120, 16, v76
    v_and_b32 v121, 0xffff0000, v76
    v_fmac_f32 v112, v21, v120
    v_fmac_f32 v113, v21, v121
    v_lshlrev_b32 v120, 16, v77
    v_and_b32 v121, 0xffff0000, v77
    v_fmac_f32 v114, v21, v120
    v_fmac_f32 v115, v21, v121
    v_lshlrev_b32 v120, 16, v78
    v_and_b32 v121, 0xffff0000, v78
    v_fmac_f32 v116, v21, v120
    v_fmac_f32 v117, v21, v121
    v_lshlrev_b32 v120, 16, v79
    v_and_b32 v121, 0xffff0000, v79
    v_fmac_f32 v118, v21, v120
    v_fmac_f32 v119, v21, v121
    s_waitcnt vmcnt(7)
    v_lshlrev_b32 v120, 16, v80
    v_and_b32 v121, 0xffff0000, v80
    v_fmac_f32 v112, v22, v120
    v_fmac_f32 v113, v22, v121
    v_lshlrev_b32 v120, 16, v81
    v_and_b32 v121, 0xffff0000, v81
    v_fmac_f32 v114, v22, v120
    v_fmac_f32 v115, v22, v121
    v_lshlrev_b32 v120, 16, v82
    v_and_b32 v121, 0xffff0000, v82
    v_fmac_f32 v116, v22, v120
    v_fmac_f32 v117, v22, v121
    v_lshlrev_b32 v120, 16, v83
    v_and_b32 v121, 0xffff0000, v83
    v_fmac_f32 v118, v22, v120
    v_fmac_f32 v119, v22, v121
    s_waitcnt vmcnt(6)
    v_lshlrev_b32 v120, 16, v84
    v_and_b32 v121, 0xffff0000, v84
    v_fmac_f32 v112, v23, v120
    v_fmac_f32 v113, v23, v121
    v_lshlrev_b32 v120, 16, v85
    v_and_b32 v121, 0xffff0000, v85
    v_fmac_f32 v114, v23, v120
    v_fmac_f32 v115, v23, v121
    v_lshlrev_b32 v120, 16, v86
    v_and_b32 v121, 0xffff0000, v86
    v_fmac_f32 v116, v23, v120
    v_fmac_f32 v117, v23, v121
    v_lshlrev_b32 v120, 16, v87
    v_and_b32 v121, 0xffff0000, v87
    v_fmac_f32 v118, v23, v120
    v_fmac_f32 v119, v23, v121
    s_waitcnt vmcnt(5)
    v_lshlrev_b32 v120, 16, v88
    v_and_b32 v121, 0xffff0000, v88
    v_fmac_f32 v112, v24, v120
    v_fmac_f32 v113, v24, v121
    v_lshlrev_b32 v120, 16, v89
    v_and_b32 v121, 0xffff0000, v89
    v_fmac_f32 v114, v24, v120
    v_fmac_f32 v115, v24, v121
    v_lshlrev_b32 v120, 16, v90
    v_and_b32 v121, 0xffff0000, v90
    v_fmac_f32 v116, v24, v120
    v_fmac_f32 v117, v24, v121
    v_lshlrev_b32 v120, 16, v91
    v_and_b32 v121, 0xffff0000, v91
    v_fmac_f32 v118, v24, v120
    v_fmac_f32 v119, v24, v121
    s_waitcnt vmcnt(4)
    v_lshlrev_b32 v120, 16, v92
    v_and_b32 v121, 0xffff0000, v92
    v_fmac_f32 v112, v25, v120
    v_fmac_f32 v113, v25, v121
    v_lshlrev_b32 v120, 16, v93
    v_and_b32 v121, 0xffff0000, v93
    v_fmac_f32 v114, v25, v120
    v_fmac_f32 v115, v25, v121
    v_lshlrev_b32 v120, 16, v94
    v_and_b32 v121, 0xffff0000, v94
    v_fmac_f32 v116, v25, v120
    v_fmac_f32 v117, v25, v121
    v_lshlrev_b32 v120, 16, v95
    v_and_b32 v121, 0xffff0000, v95
    v_fmac_f32 v118, v25, v120
    v_fmac_f32 v119, v25, v121
    s_waitcnt vmcnt(3)
    v_lshlrev_b32 v120, 16, v96
    v_and_b32 v121, 0xffff0000, v96
    v_fmac_f32 v112, v26, v120
    v_fmac_f32 v113, v26, v121
    v_lshlrev_b32 v120, 16, v97
    v_and_b32 v121, 0xffff0000, v97
    v_fmac_f32 v114, v26, v120
    v_fmac_f32 v115, v26, v121
    v_lshlrev_b32 v120, 16, v98
    v_and_b32 v121, 0xffff0000, v98
    v_fmac_f32 v116, v26, v120
    v_fmac_f32 v117, v26, v121
    v_lshlrev_b32 v120, 16, v99
    v_and_b32 v121, 0xffff0000, v99
    v_fmac_f32 v118, v26, v120
    v_fmac_f32 v119, v26, v121
    s_waitcnt vmcnt(2)
    v_lshlrev_b32 v120, 16, v100
    v_and_b32 v121, 0xffff0000, v100
    v_fmac_f32 v112, v27, v120
    v_fmac_f32 v113, v27, v121
    v_lshlrev_b32 v120, 16, v101
    v_and_b32 v121, 0xffff0000, v101
    v_fmac_f32 v114, v27, v120
    v_fmac_f32 v115, v27, v121
    v_lshlrev_b32 v120, 16, v102
    v_and_b32 v121, 0xffff0000, v102
    v_fmac_f32 v116, v27, v120
    v_fmac_f32 v117, v27, v121
    v_lshlrev_b32 v120, 16, v103
    v_and_b32 v121, 0xffff0000, v103
    v_fmac_f32 v118, v27, v120
    v_fmac_f32 v119, v27, v121
    s_waitcnt vmcnt(1)
    v_lshlrev_b32 v120, 16, v104
    v_and_b32 v121, 0xffff0000, v104
    v_fmac_f32 v112, v28, v120
    v_fmac_f32 v113, v28, v121
    v_lshlrev_b32 v120, 16, v105
    v_and_b32 v121, 0xffff0000, v105
    v_fmac_f32 v114, v28, v120
    v_fmac_f32 v115, v28, v121
    v_lshlrev_b32 v120, 16, v106
    v_and_b32 v121, 0xffff0000, v106
    v_fmac_f32 v116, v28, v120
    v_fmac_f32 v117, v28, v121
    v_lshlrev_b32 v120, 16, v107
    v_and_b32 v121, 0xffff0000, v107
    v_fmac_f32 v118, v28, v120
    v_fmac_f32 v119, v28, v121
    s_waitcnt vmcnt(0)
    v_lshlrev_b32 v120, 16, v108
    v_and_b32 v121, 0xffff0000, v108
    v_fmac_f32 v112, v29, v120
    v_fmac_f32 v113, v29, v121
    v_lshlrev_b32 v120, 16, v109
    v_and_b32 v121, 0xffff0000, v109
    v_fmac_f32 v114, v29, v120
    v_fmac_f32 v115, v29, v121
    v_lshlrev_b32 v120, 16, v110
    v_and_b32 v121, 0xffff0000, v110
    v_fmac_f32 v116, v29, v120
    v_fmac_f32 v117, v29, v121
    v_lshlrev_b32 v120, 16, v111
    v_and_b32 v121, 0xffff0000, v111
    v_fmac_f32 v118, v29, v120
    v_fmac_f32 v119, v29, v121
    v_lshlrev_b32 v7, 5, v0
    ds_write_b128 v7, v[112:115]
    ds_write_b128 v7, v[116:119] offset:16
    s_waitcnt lgkmcnt(0)
    s_barrier
    v_cmp_gt_u32 vcc, 64, v0
    s_and_saveexec_b64 s[42:43], vcc
    s_cbranch_execz k0_end
    v_lshlrev_b32 v7, 2, v0
    ds_read_b32 v32, v7 offset:0
    ds_read_b32 v33, v7 offset:256
    ds_read_b32 v34, v7 offset:512
    ds_read_b32 v35, v7 offset:768
    ds_read_b32 v36, v7 offset:1024
    ds_read_b32 v37, v7 offset:1280
    ds_read_b32 v38, v7 offset:1536
    ds_read_b32 v39, v7 offset:1792
    ds_read_b32 v40, v7 offset:2048
    ds_read_b32 v41, v7 offset:2304
    ds_read_b32 v42, v7 offset:2560
    ds_read_b32 v43, v7 offset:2816
    ds_read_b32 v44, v7 offset:3072
    ds_read_b32 v45, v7 offset:3328
    ds_read_b32 v46, v7 offset:3584
    ds_read_b32 v47, v7 offset:3840
    ds_read_b32 v48, v7 offset:4096
    ds_read_b32 v49, v7 offset:4352
    ds_read_b32 v50, v7 offset:4608
    ds_read_b32 v51, v7 offset:4864
    ds_read_b32 v52, v7 offset:5120
    ds_read_b32 v53, v7 offset:5376
    ds_read_b32 v54, v7 offset:5632
    ds_read_b32 v55, v7 offset:5888
    ds_read_b32 v56, v7 offset:6144
    ds_read_b32 v57, v7 offset:6400
    ds_read_b32 v58, v7 offset:6656
    ds_read_b32 v59, v7 offset:6912
    ds_read_b32 v60, v7 offset:7168
    ds_read_b32 v61, v7 offset:7424
    ds_read_b32 v62, v7 offset:7680
    ds_read_b32 v63, v7 offset:7936
    s_waitcnt lgkmcnt(0)
    v_add_f32 v32, v32, v48
    v_add_f32 v33, v33, v49
    v_add_f32 v34, v34, v50
    v_add_f32 v35, v35, v51
    v_add_f32 v36, v36, v52
    v_add_f32 v37, v37, v53
    v_add_f32 v38, v38, v54
    v_add_f32 v39, v39, v55
    v_add_f32 v40, v40, v56
    v_add_f32 v41, v41, v57
    v_add_f32 v42, v42, v58
    v_add_f32 v43, v43, v59
    v_add_f32 v44, v44, v60
    v_add_f32 v45, v45, v61
    v_add_f32 v46, v46, v62
    v_add_f32 v47, v47, v63
    v_add_f32 v32, v32, v40
    v_add_f32 v33, v33, v41
    v_add_f32 v34, v34, v42
    v_add_f32 v35, v35, v43
    v_add_f32 v36, v36, v44
    v_add_f32 v37, v37, v45
    v_add_f32 v38, v38, v46
    v_add_f32 v39, v39, v47
    v_add_f32 v32, v32, v36
    v_add_f32 v33, v33, v37
    v_add_f32 v34, v34, v38
    v_add_f32 v35, v35, v39
    v_add_f32 v32, v32, v34
    v_add_f32 v33, v33, v35
    v_add_f32 v32, v32, v33
    s_movk_i32 s22, 640
    v_cvt_pk_bf16_f32 v32, v32, v32
    v_lshlrev_b32 v32, 16, v32
    v_add_f32 v33, 1.0, v32
    v_cvt_pk_bf16_f32 v33, v33, v33
    v_lshlrev_b32 v33, 16, v33
    s_lshl_b32 s33, s32, 6
    v_add_u32 v34, s33, v0
    v_subrev_u32 v35, 640, v34
    v_cmp_gt_u32 vcc, 640, v35
    v_subrev_u32 v35, 2560, v34
    v_cmp_gt_u32 s[40:41], s22, v35
    s_or_b64 vcc, vcc, s[40:41]
    v_cndmask_b32 v32, v32, v33, vcc
    s_lshl_b32 s21, s32, 8
    s_add_u32 s21, s21, 10674176
    buffer_store_dword v32, v7, s[28:31], s21 offen sc1
    s_endpgm
k0_st:
    s_load_dwordx2 s[4:5], s[0:1], 0
    s_load_dwordx2 s[10:11], s[0:1], 120
    v_and_b32 v1, 63, v0
    v_lshrrev_b32 v2, 6, v0
    v_lshrrev_b32 v5, 3, v1
    v_and_b32 v6, 7, v1
    s_sub_u32 s21, s2, 352
    s_lshl_b32 s21, s21, 5
    v_lshl_add_u32 v7, v2, 3, v5
    v_add_u32 v7, s21, v7
    v_mul_u32_u24 v9, 1280, v7
    v_lshl_add_u32 v9, v6, 4, v9
    v_mov_b32 v20, 0x3f803f80
    s_waitcnt lgkmcnt(0)
    s_mov_b32 s16, s4
    s_mov_b32 s17, s5
    s_mov_b32 s18, 2621440
    s_mov_b32 s19, 0x00020000
    s_mov_b32 s28, s10
    s_mov_b32 s29, s11
    s_mov_b32 s30, 268435456
    s_mov_b32 s31, 0x00020000
    buffer_load_dwordx4 v[32:35], v9, s[16:19], 0 offen offset:0
    buffer_load_dwordx4 v[36:39], v9, s[16:19], 0 offen offset:128
    buffer_load_dwordx4 v[40:43], v9, s[16:19], 0 offen offset:256
    buffer_load_dwordx4 v[44:47], v9, s[16:19], 0 offen offset:384
    buffer_load_dwordx4 v[48:51], v9, s[16:19], 0 offen offset:512
    buffer_load_dwordx4 v[52:55], v9, s[16:19], 0 offen offset:640
    buffer_load_dwordx4 v[56:59], v9, s[16:19], 0 offen offset:768
    buffer_load_dwordx4 v[60:63], v9, s[16:19], 0 offen offset:896
    buffer_load_dwordx4 v[64:67], v9, s[16:19], 0 offen offset:1024
    buffer_load_dwordx4 v[68:71], v9, s[16:19], 0 offen offset:1152
    v_mov_b32 v12, 0
    v_mov_b32 v13, 0
    v_mov_b32 v14, 0
    v_mov_b32 v15, 0
    v_mov_b32 v16, 0
    v_mov_b32 v17, 0
    v_mov_b32 v18, 0
    v_mov_b32 v19, 0
    s_waitcnt vmcnt(9)
    v_dot2_f32_bf16 v12, v32, v20, v12
    v_dot2_f32_bf16 v13, v32, v32, v13
    v_dot2_f32_bf16 v14, v33, v20, v14
    v_dot2_f32_bf16 v15, v33, v33, v15
    v_dot2_f32_bf16 v12, v34, v20, v12
    v_dot2_f32_bf16 v13, v34, v34, v13
    v_dot2_f32_bf16 v14, v35, v20, v14
    v_dot2_f32_bf16 v15, v35, v35, v15
    s_waitcnt vmcnt(8)
    v_dot2_f32_bf16 v12, v36, v20, v12
    v_dot2_f32_bf16 v13, v36, v36, v13
    v_dot2_f32_bf16 v14, v37, v20, v14
    v_dot2_f32_bf16 v15, v37, v37, v15
    v_dot2_f32_bf16 v12, v38, v20, v12
    v_dot2_f32_bf16 v13, v38, v38, v13
    v_dot2_f32_bf16 v14, v39, v20, v14
    v_dot2_f32_bf16 v15, v39, v39, v15
    s_waitcnt vmcnt(7)
    v_dot2_f32_bf16 v12, v40, v20, v12
    v_dot2_f32_bf16 v13, v40, v40, v13
    v_dot2_f32_bf16 v14, v41, v20, v14
    v_dot2_f32_bf16 v15, v41, v41, v15
    v_dot2_f32_bf16 v12, v42, v20, v12
    v_dot2_f32_bf16 v13, v42, v42, v13
    v_dot2_f32_bf16 v14, v43, v20, v14
    v_dot2_f32_bf16 v15, v43, v43, v15
    s_waitcnt vmcnt(6)
    v_dot2_f32_bf16 v12, v44, v20, v12
    v_dot2_f32_bf16 v13, v44, v44, v13
    v_dot2_f32_bf16 v14, v45, v20, v14
    v_dot2_f32_bf16 v15, v45, v45, v15
    v_dot2_f32_bf16 v12, v46, v20, v12
    v_dot2_f32_bf16 v13, v46, v46, v13
    v_dot2_f32_bf16 v14, v47, v20, v14
    v_dot2_f32_bf16 v15, v47, v47, v15
    s_waitcnt vmcnt(5)
    v_dot2_f32_bf16 v12, v48, v20, v12
    v_dot2_f32_bf16 v13, v48, v48, v13
    v_dot2_f32_bf16 v14, v49, v20, v14
    v_dot2_f32_bf16 v15, v49, v49, v15
    v_dot2_f32_bf16 v12, v50, v20, v12
    v_dot2_f32_bf16 v13, v50, v50, v13
    v_dot2_f32_bf16 v14, v51, v20, v14
    v_dot2_f32_bf16 v15, v51, v51, v15
    s_waitcnt vmcnt(4)
    v_dot2_f32_bf16 v12, v52, v20, v12
    v_dot2_f32_bf16 v13, v52, v52, v13
    v_dot2_f32_bf16 v14, v53, v20, v14
    v_dot2_f32_bf16 v15, v53, v53, v15
    v_dot2_f32_bf16 v12, v54, v20, v12
    v_dot2_f32_bf16 v13, v54, v54, v13
    v_dot2_f32_bf16 v14, v55, v20, v14
    v_dot2_f32_bf16 v15, v55, v55, v15
    s_waitcnt vmcnt(3)
    v_dot2_f32_bf16 v12, v56, v20, v12
    v_dot2_f32_bf16 v13, v56, v56, v13
    v_dot2_f32_bf16 v14, v57, v20, v14
    v_dot2_f32_bf16 v15, v57, v57, v15
    v_dot2_f32_bf16 v12, v58, v20, v12
    v_dot2_f32_bf16 v13, v58, v58, v13
    v_dot2_f32_bf16 v14, v59, v20, v14
    v_dot2_f32_bf16 v15, v59, v59, v15
    s_waitcnt vmcnt(2)
    v_dot2_f32_bf16 v12, v60, v20, v12
    v_dot2_f32_bf16 v13, v60, v60, v13
    v_dot2_f32_bf16 v14, v61, v20, v14
    v_dot2_f32_bf16 v15, v61, v61, v15
    v_dot2_f32_bf16 v12, v62, v20, v12
    v_dot2_f32_bf16 v13, v62, v62, v13
    v_dot2_f32_bf16 v14, v63, v20, v14
    v_dot2_f32_bf16 v15, v63, v63, v15
    s_waitcnt vmcnt(1)
    v_dot2_f32_bf16 v12, v64, v20, v12
    v_dot2_f32_bf16 v13, v64, v64, v13
    v_dot2_f32_bf16 v14, v65, v20, v14
    v_dot2_f32_bf16 v15, v65, v65, v15
    v_dot2_f32_bf16 v12, v66, v20, v12
    v_dot2_f32_bf16 v13, v66, v66, v13
    v_dot2_f32_bf16 v14, v67, v20, v14
    v_dot2_f32_bf16 v15, v67, v67, v15
    s_waitcnt vmcnt(0)
    v_dot2_f32_bf16 v12, v68, v20, v12
    v_dot2_f32_bf16 v13, v68, v68, v13
    v_dot2_f32_bf16 v14, v69, v20, v14
    v_dot2_f32_bf16 v15, v69, v69, v15
    v_dot2_f32_bf16 v12, v70, v20, v12
    v_dot2_f32_bf16 v13, v70, v70, v13
    v_dot2_f32_bf16 v14, v71, v20, v14
    v_dot2_f32_bf16 v15, v71, v71, v15
    s_nop 2
    v_add_f32 v12, v12, v14
    v_add_f32 v13, v13, v15
    s_nop 1
    v_add_f32_dpp v12, v12, v12 quad_perm:[1,0,3,2] row_mask:0xf bank_mask:0xf
    v_add_f32_dpp v13, v13, v13 quad_perm:[1,0,3,2] row_mask:0xf bank_mask:0xf
    s_nop 1
    v_add_f32_dpp v12, v12, v12 quad_perm:[2,3,0,1] row_mask:0xf bank_mask:0xf
    v_add_f32_dpp v13, v13, v13 quad_perm:[2,3,0,1] row_mask:0xf bank_mask:0xf
    s_nop 1
    v_add_f32_dpp v12, v12, v12 row_half_mirror row_mask:0xf bank_mask:0xf
    v_add_f32_dpp v13, v13, v13 row_half_mirror row_mask:0xf bank_mask:0xf
    v_mul_f32 v12, 0x3acccccd, v12
    s_nop 0
    v_mul_f32 v13, 0x3acccccd, v13
    s_nop 0
    v_fma_f32 v13, -v12, v12, v13
    s_nop 0
    v_max_f32 v13, 0, v13
    s_nop 0
    v_cvt_pk_bf16_f32 v16, v12, v13
    s_nop 0
    v_lshlrev_b32 v12, 16, v16
    s_nop 0
    v_and_b32 v13, 0xffff0000, v16
    s_nop 0
    v_add_f32 v13, 0x3727c5ac, v13
    s_nop 0
    v_cvt_pk_bf16_f32 v16, v13, v13
    s_nop 0
    v_lshlrev_b32 v13, 16, v16
    s_nop 0
    v_sqrt_f32 v13, v13
    s_nop 0
    s_nop 0
    s_nop 0
    v_cvt_pk_bf16_f32 v16, v13, v13
    s_nop 0
    v_lshlrev_b32 v13, 16, v16
    s_nop 0
    v_rcp_f32 v13, v13
    s_nop 0
    s_nop 0
    s_nop 0
    v_mul_f32 v12, v12, v13
    s_nop 0
    v_sub_f32 v12, 0, v12
    s_nop 0
    v_lshlrev_b32 v7, 3, v7
    v_cmp_eq_u32 vcc, 0, v6
    s_and_saveexec_b64 s[42:43], vcc
    s_mov_b32 s21, 8036352
    buffer_store_dwordx2 v[12:13], v7, s[28:31], s21 offen sc1
    s_endpgm
k0_pf:
    s_load_dwordx2 s[4:5], s[0:1], 32
    v_lshrrev_b32 v2, 6, v0
    v_and_b32 v1, 63, v0
    v_readfirstlane_b32 s20, v2
    v_lshlrev_b32 v1, 4, v1
    s_sub_u32 s21, s2, 416
    s_lshr_b32 s21, s21, 3
    s_lshl_b32 s21, s21, 2
    s_add_u32 s21, s21, s20
    s_mul_i32 s23, s21, 3072
    s_lshl_b32 s21, s21, 3
    s_and_b32 s22, s2, 7
    s_add_u32 s21, s21, s22
    s_lshl_b32 s21, s21, 14
    s_waitcnt lgkmcnt(0)
    s_mov_b32 s16, s4
    s_mov_b32 s17, s5
    s_mov_b32 s18, 2621440
    s_mov_b32 s19, 0x00020000
    s_getpc_b64 s[24:25]
k0_pcref:
    s_sub_u32 s24, s24, k0_pcref-k0_kernel
    s_subb_u32 s25, s25, 0
    s_add_u32 s26, s23, 0
    s_min_u32 s26, s26, (chain_end-k0_kernel-1020)&0xfffffff0
    v_add_u32 v2, s26, v1
    v_mov_b32 v5, s25
    v_add_co_u32 v4, vcc, s24, v2
    v_addc_co_u32 v5, vcc, 0, v5, vcc
    global_load_dwordx4 v[72:75], v[4:5], off
    s_add_u32 s26, s23, 1024
    s_min_u32 s26, s26, (chain_end-k0_kernel-1020)&0xfffffff0
    v_add_u32 v2, s26, v1
    v_mov_b32 v5, s25
    v_add_co_u32 v4, vcc, s24, v2
    v_addc_co_u32 v5, vcc, 0, v5, vcc
    global_load_dwordx4 v[76:79], v[4:5], off
    s_add_u32 s26, s23, 2048
    s_min_u32 s26, s26, (chain_end-k0_kernel-1020)&0xfffffff0
    v_add_u32 v2, s26, v1
    v_mov_b32 v5, s25
    v_add_co_u32 v4, vcc, s24, v2
    v_addc_co_u32 v5, vcc, 0, v5, vcc
    global_load_dwordx4 v[80:83], v[4:5], off
    buffer_load_dwordx4 v[8:11], v1, s[16:19], s21 offen offset:0
    buffer_load_dwordx4 v[12:15], v1, s[16:19], s21 offen offset:1024
    buffer_load_dwordx4 v[16:19], v1, s[16:19], s21 offen offset:2048
    buffer_load_dwordx4 v[20:23], v1, s[16:19], s21 offen offset:3072
    s_add_u32 s21, s21, 4096
    buffer_load_dwordx4 v[24:27], v1, s[16:19], s21 offen offset:0
    buffer_load_dwordx4 v[28:31], v1, s[16:19], s21 offen offset:1024
    buffer_load_dwordx4 v[32:35], v1, s[16:19], s21 offen offset:2048
    buffer_load_dwordx4 v[36:39], v1, s[16:19], s21 offen offset:3072
    s_add_u32 s21, s21, 4096
    buffer_load_dwordx4 v[40:43], v1, s[16:19], s21 offen offset:0
    buffer_load_dwordx4 v[44:47], v1, s[16:19], s21 offen offset:1024
    buffer_load_dwordx4 v[48:51], v1, s[16:19], s21 offen offset:2048
    buffer_load_dwordx4 v[52:55], v1, s[16:19], s21 offen offset:3072
    s_add_u32 s21, s21, 4096
    buffer_load_dwordx4 v[56:59], v1, s[16:19], s21 offen offset:0
    buffer_load_dwordx4 v[60:63], v1, s[16:19], s21 offen offset:1024
    buffer_load_dwordx4 v[64:67], v1, s[16:19], s21 offen offset:2048
    buffer_load_dwordx4 v[68:71], v1, s[16:19], s21 offen offset:3072
    s_add_u32 s21, s21, 4096
    s_waitcnt vmcnt(0)
    s_endpgm
.globl k1_kernel
.p2align 8
.type k1_kernel,@function
k1_kernel:
    s_cmp_ge_u32 s2, 408
    s_cbranch_scc1 k1_end
    s_cmp_ge_u32 s2, 344
    s_cbranch_scc1 k1_pf
    s_load_dwordx4 s[4:7], s[0:1], 32
    s_load_dwordx2 s[10:11], s[0:1], 120
    s_load_dwordx8 s[12:19], s[0:1], 56
    s_load_dwordx2 s[46:47], s[0:1], 112
    v_lshrrev_b32 v2, 6, v0
    v_and_b32 v1, 63, v0
    v_readfirstlane_b32 s20, v2
    s_waitcnt lgkmcnt(0)
    s_mov_b32 s28, s10
    s_mov_b32 s29, s11
    s_mov_b32 s30, 268435456
    s_mov_b32 s31, 0x00020000
    s_mov_b32 s48, s46
    s_mov_b32 s49, s47
    s_mov_b32 s50, 256
    s_mov_b32 s51, 0x00020000
    s_cmp_ge_u32 s2, 190
    s_cbranch_scc1 k1_pack
    s_cmp_ge_u32 s2, 160
    s_cbranch_scc1 k1_modf
    s_setprio 3
    s_mov_b32 s24, s4
    s_mov_b32 s25, s5
    s_mov_b32 s26, 2621440
    s_mov_b32 s27, 0x00020000
    s_lshl_b32 s21, s2, 3
    s_add_u32 s22, s6, s21
    s_addc_u32 s23, s7, 0
    s_load_dwordx2 s[32:33], s[22:23], 0
    s_lshl_b32 s22, s2, 4
    s_add_u32 s22, s22, 10674176
    s_add_u32 s22, s10, s22
    s_addc_u32 s23, s11, 0
    s_load_dwordx4 s[56:59], s[22:23], 0
    s_load_dwordx4 s[60:63], s[22:23], 2560
    s_load_dwordx4 s[64:67], s[22:23], 5120
    s_lshl_b32 s21, s2, 2
    s_add_u32 s21, s21, s20
    s_mul_i32 s34, s20, 9472
    v_lshlrev_b32 v3, 4, v1
    s_lshl_b32 s35, s21, 12
    s_add_u32 s36, s34, 256
    s_mov_b32 m0, s36
    s_mul_i32 s37, s21, 4352
    s_add_u32 s37, s37, 0
    buffer_load_dwordx4 v3, s[24:27], s35 offen offset:0 lds
    buffer_load_dwordx4 v3, s[24:27], s35 offen offset:1024 lds
    buffer_load_dwordx4 v3, s[24:27], s35 offen offset:2048 lds
    buffer_load_dwordx4 v3, s[24:27], s35 offen offset:3072 lds
    v_lshrrev_b32 v4, 3, v0
    v_mul_u32_u24 v4, 20480, v4
    s_lshr_b32 s38, s2, 1
    s_and_b32 s38, s38, 7
    v_and_b32 v5, 7, v0
    v_xor_b32 v5, s38, v5
    v_lshl_add_u32 v4, v5, 4, v4
    s_lshl_b32 s38, s2, 7
    s_add_u32 s39, s38, 2793472
    s_add_u32 s36, s34, 4352
    s_mov_b32 m0, s36
    s_nop 0
    buffer_load_dwordx4 v3, s[28:31], s37 offen offset:0 lds
    buffer_load_dwordx4 v3, s[28:31], s37 offen offset:1024 lds
    buffer_load_dwordx4 v3, s[28:31], s37 offen offset:2048 lds
    buffer_load_dwordx4 v3, s[28:31], s37 offen offset:3072 lds
    s_add_u32 s36, s34, 8448
    s_mov_b32 m0, s36
    s_add_u32 s37, s37, 4096
    buffer_load_dwordx4 v3, s[28:31], s37 offen lds
    s_lshl_b32 s36, s20, 10
    s_add_u32 s53, s36, 37888
    s_add_u32 s54, s36, 8036352
    v_lshlrev_b32 v6, 4, v1
    buffer_load_dwordx4 v[240:243], v4, s[28:31], s39 offen
    s_add_u32 s55, s39, 2621440
    s_add_u32 m0, s53, 0
    s_add_u32 s39, s39, 655360
    buffer_load_dwordx4 v4, s[28:31], s55 offen lds
    s_add_u32 m0, s53, 16384
    s_add_u32 s55, s54, 0
    buffer_load_dwordx4 v6, s[28:31], s55 offen lds
    buffer_load_dwordx4 v[244:247], v4, s[28:31], s39 offen
    s_add_u32 s55, s39, 2621440
    s_add_u32 m0, s53, 4096
    s_add_u32 s39, s39, 655360
    buffer_load_dwordx4 v4, s[28:31], s55 offen lds
    s_add_u32 m0, s53, 20480
    s_add_u32 s55, s54, 4096
    buffer_load_dwordx4 v6, s[28:31], s55 offen lds
    buffer_load_dwordx4 v[248:251], v4, s[28:31], s39 offen
    s_add_u32 s55, s39, 2621440
    s_add_u32 m0, s53, 8192
    s_add_u32 s39, s39, 655360
    buffer_load_dwordx4 v4, s[28:31], s55 offen lds
    s_add_u32 m0, s53, 24576
    s_add_u32 s55, s54, 8192
    buffer_load_dwordx4 v6, s[28:31], s55 offen lds
    buffer_load_dwordx4 v[252:255], v4, s[28:31], s39 offen
    s_add_u32 s55, s39, 2621440
    s_add_u32 m0, s53, 12288
    s_add_u32 s39, s39, 655360
    buffer_load_dwordx4 v4, s[28:31], s55 offen lds
    s_add_u32 m0, s53, 28672
    s_add_u32 s55, s54, 12288
    buffer_load_dwordx4 v6, s[28:31], s55 offen lds
    v_lshl_add_u32 v5, v1, 2, s34
    v_mov_b32 v6, 0
    ds_write_b32 v5, v6
    v_and_b32 v7, 15, v1
    v_bfe_u32 v8, v1, 4, 1
    v_lshrrev_b32 v9, 5, v1
    v_mul_u32_u24 v10, 272, v7
    v_lshl_add_u32 v10, v9, 4, v10
    v_add_u32 v10, s34, v10
    v_add_u32 v10, 4356, v10
    v_lshlrev_b32 v11, 2, v8
    v_sub_u32 v10, v10, v11
    v_and_b32 v12, 7, v1
    v_mul_u32_u24 v13, 272, v12
    v_lshl_add_u32 v13, v9, 4, v13
    v_add_u32 v13, s34, v13
    v_add_u32 v13, 4356, v13
    v_sub_u32 v13, v13, v11
    v_bfe_u32 v11, v1, 3, 1
    v_lshlrev_b32 v11, 4, v11
    v_sub_u32 v11, 16, v11
    v_and_b32 v14, 31, v1
    v_lshlrev_b32 v14, 3, v14
    v_lshl_add_u32 v14, v9, 4, v14
    v_add_u32 v14, s34, v14
    v_add_u32 v14, 8, v14
    v_cmp_ne_u32 vcc, 0, v12
    v_mov_b32 v16, 0
    s_nop 1
    v_cndmask_b32 v15, v16, -1, vcc
    s_waitcnt vmcnt(12) lgkmcnt(0)
    ds_read_b64 v[176:177], v14 offset:1792
    ds_read_b64 v[178:179], v14 offset:1800
    ds_read_b64 v[180:181], v14 offset:1824
    ds_read_b64 v[182:183], v14 offset:1832
    ds_read_b64 v[184:185], v14 offset:1856
    ds_read_b64 v[186:187], v14 offset:1864
    ds_read_b64 v[188:189], v14 offset:1888
    ds_read_b64 v[190:191], v14 offset:1896
    ds_read_b64 v[192:193], v14 offset:1920
    ds_read_b64 v[194:195], v14 offset:1928
    ds_read_b64 v[196:197], v14 offset:1952
    ds_read_b64 v[198:199], v14 offset:1960
    ds_read_b64 v[200:201], v14 offset:1984
    ds_read_b64 v[202:203], v14 offset:1992
    ds_read_b64 v[204:205], v14 offset:2016
    ds_read_b64 v[206:207], v14 offset:2024
    ds_read2_b32 v[64:65], v10 offset0:0 offset1:1
    ds_read2_b32 v[66:67], v10 offset0:2 offset1:3
    ds_read2_b32 v[68:69], v10 offset0:8 offset1:9
    ds_read2_b32 v[70:71], v10 offset0:10 offset1:11
    ds_read2_b32 v[72:73], v10 offset0:16 offset1:17
    ds_read2_b32 v[74:75], v10 offset0:18 offset1:19
    ds_read2_b32 v[76:77], v10 offset0:24 offset1:25
    ds_read2_b32 v[78:79], v10 offset0:26 offset1:27
    ds_read2_b32 v[80:81], v10 offset0:32 offset1:33
    ds_read2_b32 v[82:83], v10 offset0:34 offset1:35
    ds_read2_b32 v[84:85], v10 offset0:40 offset1:41
    ds_read2_b32 v[86:87], v10 offset0:42 offset1:43
    ds_read2_b32 v[88:89], v10 offset0:48 offset1:49
    ds_read2_b32 v[90:91], v10 offset0:50 offset1:51
    ds_read2_b32 v[92:93], v10 offset0:56 offset1:57
    ds_read2_b32 v[94:95], v10 offset0:58 offset1:59
    s_waitcnt lgkmcnt(0)
    v_mfma_f32_32x32x16_bf16 v[144:159], v[176:179], v[64:67], 0
    ds_read_b32 v16, v10 offset:16
    ds_read_b32 v17, v10 offset:48
    ds_read_b32 v18, v10 offset:80
    ds_read_b32 v19, v10 offset:112
    ds_read_b32 v20, v10 offset:144
    ds_read_b32 v21, v10 offset:176
    ds_read_b32 v22, v10 offset:208
    ds_read_b32 v23, v10 offset:240
    ds_read2_b32 v[96:97], v13 offset0:0 offset1:1
    ds_read2_b32 v[98:99], v13 offset0:2 offset1:3
    ds_read_b32 v24, v13 offset:16
    ds_read2_b32 v[100:101], v13 offset0:8 offset1:9
    ds_read2_b32 v[102:103], v13 offset0:10 offset1:11
    ds_read_b32 v25, v13 offset:48
    ds_read2_b32 v[104:105], v13 offset0:16 offset1:17
    ds_read2_b32 v[106:107], v13 offset0:18 offset1:19
    v_mfma_f32_32x32x16_bf16 v[144:159], v[180:183], v[68:71], v[144:159]
    ds_read_b32 v26, v13 offset:80
    ds_read2_b32 v[108:109], v13 offset0:24 offset1:25
    ds_read2_b32 v[110:111], v13 offset0:26 offset1:27
    ds_read_b32 v27, v13 offset:112
    ds_read2_b32 v[112:113], v13 offset0:32 offset1:33
    ds_read2_b32 v[114:115], v13 offset0:34 offset1:35
    ds_read_b32 v28, v13 offset:144
    ds_read2_b32 v[116:117], v13 offset0:40 offset1:41
    ds_read2_b32 v[118:119], v13 offset0:42 offset1:43
    ds_read_b32 v29, v13 offset:176
    ds_read2_b32 v[120:121], v13 offset0:48 offset1:49
    ds_read2_b32 v[122:123], v13 offset0:50 offset1:51
    ds_read_b32 v30, v13 offset:208
    ds_read2_b32 v[124:125], v13 offset0:56 offset1:57
    ds_read2_b32 v[126:127], v13 offset0:58 offset1:59
    ds_read_b32 v31, v13 offset:240
    v_mfma_f32_32x32x16_bf16 v[144:159], v[184:187], v[72:75], v[144:159]
    s_waitcnt lgkmcnt(15)
    s_waitcnt lgkmcnt(0)
    v_alignbit_b32 v32, v65, v64, 16
    v_alignbit_b32 v33, v66, v65, 16
    v_alignbit_b32 v34, v67, v66, 16
    v_alignbit_b32 v35, v16, v67, 16
    v_mfma_f32_32x32x16_bf16 v[144:159], v[188:191], v[76:79], v[144:159]
    v_alignbit_b32 v36, v69, v68, 16
    v_alignbit_b32 v37, v70, v69, 16
    v_alignbit_b32 v38, v71, v70, 16
    v_alignbit_b32 v39, v17, v71, 16
    v_alignbit_b32 v40, v73, v72, 16
    v_alignbit_b32 v41, v74, v73, 16
    v_mfma_f32_32x32x16_bf16 v[144:159], v[192:195], v[80:83], v[144:159]
    v_alignbit_b32 v42, v75, v74, 16
    v_alignbit_b32 v43, v18, v75, 16
    v_alignbit_b32 v44, v77, v76, 16
    v_alignbit_b32 v45, v78, v77, 16
    v_alignbit_b32 v46, v79, v78, 16
    v_alignbit_b32 v47, v19, v79, 16
    v_mfma_f32_32x32x16_bf16 v[144:159], v[196:199], v[84:87], v[144:159]
    v_alignbit_b32 v48, v81, v80, 16
    v_alignbit_b32 v49, v82, v81, 16
    v_alignbit_b32 v50, v83, v82, 16
    v_alignbit_b32 v51, v20, v83, 16
    v_alignbit_b32 v52, v85, v84, 16
    v_alignbit_b32 v53, v86, v85, 16
    v_mfma_f32_32x32x16_bf16 v[144:159], v[200:203], v[88:91], v[144:159]
    v_alignbit_b32 v54, v87, v86, 16
    v_alignbit_b32 v55, v21, v87, 16
    v_alignbit_b32 v56, v89, v88, 16
    v_alignbit_b32 v57, v90, v89, 16
    v_alignbit_b32 v58, v91, v90, 16
    v_alignbit_b32 v59, v22, v91, 16
    v_mfma_f32_32x32x16_bf16 v[144:159], v[204:207], v[92:95], v[144:159]
    v_alignbit_b32 v60, v93, v92, 16
    v_alignbit_b32 v61, v94, v93, 16
    v_alignbit_b32 v62, v95, v94, 16
    v_alignbit_b32 v63, v23, v95, 16
    s_nop 0
    v_mfma_f32_32x32x16_bf16 v[128:143], v[176:179], v[32:35], 0
    ds_read_b64 v[208:209], v14 offset:3840
    ds_read_b64 v[210:211], v14 offset:3848
    s_nop 2
    v_mfma_f32_32x32x16_bf16 v[128:143], v[180:183], v[36:39], v[128:143]
    ds_read_b64 v[212:213], v14 offset:3872
    ds_read_b64 v[214:215], v14 offset:3880
    s_nop 2
    v_mfma_f32_32x32x16_bf16 v[128:143], v[184:187], v[40:43], v[128:143]
    ds_read_b64 v[216:217], v14 offset:3904
    ds_read_b64 v[218:219], v14 offset:3912
    v_alignbit_b32 v96, v97, v96, v11
    v_alignbit_b32 v97, v98, v97, v11
    v_alignbit_b32 v98, v99, v98, v11
    v_alignbit_b32 v99, v24, v99, v11
    v_alignbit_b32 v100, v101, v100, v11
    v_alignbit_b32 v101, v102, v101, v11
    v_alignbit_b32 v102, v103, v102, v11
    v_alignbit_b32 v103, v25, v103, v11
    v_alignbit_b32 v104, v105, v104, v11
    v_mfma_f32_32x32x16_bf16 v[128:143], v[188:191], v[44:47], v[128:143]
    ds_read_b64 v[220:221], v14 offset:3936
    ds_read_b64 v[222:223], v14 offset:3944
    v_alignbit_b32 v105, v106, v105, v11
    v_alignbit_b32 v106, v107, v106, v11
    v_alignbit_b32 v107, v26, v107, v11
    v_alignbit_b32 v108, v109, v108, v11
    v_alignbit_b32 v109, v110, v109, v11
    v_alignbit_b32 v110, v111, v110, v11
    v_alignbit_b32 v111, v27, v111, v11
    v_mov_b32_dpp v144, v144 row_shr:1 row_mask:0xf bank_mask:0xf bound_ctrl:0
    v_mfma_f32_32x32x16_bf16 v[128:143], v[192:195], v[48:51], v[128:143]
    ds_read_b64 v[224:225], v14 offset:3968
    ds_read_b64 v[226:227], v14 offset:3976
    v_mov_b32_dpp v145, v145 row_shr:1 row_mask:0xf bank_mask:0xf bound_ctrl:0
    v_mov_b32_dpp v146, v146 row_shr:1 row_mask:0xf bank_mask:0xf bound_ctrl:0
    v_mov_b32_dpp v147, v147 row_shr:1 row_mask:0xf bank_mask:0xf bound_ctrl:0
    v_mov_b32_dpp v148, v148 row_shr:1 row_mask:0xf bank_mask:0xf bound_ctrl:0
    v_mov_b32_dpp v149, v149 row_shr:1 row_mask:0xf bank_mask:0xf bound_ctrl:0
    v_mov_b32_dpp v150, v150 row_shr:1 row_mask:0xf bank_mask:0xf bound_ctrl:0
    v_mov_b32_dpp v151, v151 row_shr:1 row_mask:0xf bank_mask:0xf bound_ctrl:0
    v_mov_b32_dpp v152, v152 row_shr:1 row_mask:0xf bank_mask:0xf bound_ctrl:0
    v_mfma_f32_32x32x16_bf16 v[128:143], v[196:199], v[52:55], v[128:143]
    ds_read_b64 v[228:229], v14 offset:4000
    ds_read_b64 v[230:231], v14 offset:4008
    v_mov_b32_dpp v153, v153 row_shr:1 row_mask:0xf bank_mask:0xf bound_ctrl:0
    v_mov_b32_dpp v154, v154 row_shr:1 row_mask:0xf bank_mask:0xf bound_ctrl:0
    v_mov_b32_dpp v155, v155 row_shr:1 row_mask:0xf bank_mask:0xf bound_ctrl:0
    v_mov_b32_dpp v156, v156 row_shr:1 row_mask:0xf bank_mask:0xf bound_ctrl:0
    v_mov_b32_dpp v157, v157 row_shr:1 row_mask:0xf bank_mask:0xf bound_ctrl:0
    v_mov_b32_dpp v158, v158 row_shr:1 row_mask:0xf bank_mask:0xf bound_ctrl:0
    v_mov_b32_dpp v159, v159 row_shr:1 row_mask:0xf bank_mask:0xf bound_ctrl:0
    v_alignbit_b32 v112, v113, v112, v11
    v_mfma_f32_32x32x16_bf16 v[128:143], v[200:203], v[56:59], v[128:143]
    ds_read_b64 v[232:233], v14 offset:4032
    ds_read_b64 v[234:235], v14 offset:4040
    v_alignbit_b32 v113, v114, v113, v11
    v_alignbit_b32 v114, v115, v114, v11
    v_alignbit_b32 v115, v28, v115, v11
    v_alignbit_b32 v116, v117, v116, v11
    v_alignbit_b32 v117, v118, v117, v11
    v_alignbit_b32 v118, v119, v118, v11
    v_alignbit_b32 v119, v29, v119, v11
    v_alignbit_b32 v120, v121, v120, v11
    v_mfma_f32_32x32x16_bf16 v[128:143], v[204:207], v[60:63], v[128:143]
    ds_read_b64 v[236:237], v14 offset:4064
    ds_read_b64 v[238:239], v14 offset:4072
    v_alignbit_b32 v121, v122, v121, v11
    v_alignbit_b32 v122, v123, v122, v11
    v_alignbit_b32 v123, v30, v123, v11
    v_alignbit_b32 v124, v125, v124, v11
    v_alignbit_b32 v125, v126, v125, v11
    v_alignbit_b32 v126, v127, v126, v11
    v_alignbit_b32 v127, v31, v127, v11
    s_nop 0
    s_waitcnt lgkmcnt(0)
    v_mfma_f32_32x32x16_bf16 v[160:175], v[208:211], v[96:99], 0
    ds_read_b64 v[176:177], v14 offset:1536
    ds_read_b64 v[178:179], v14 offset:1544
    ds_read_b64 v[180:181], v14 offset:1568
    ds_read_b64 v[182:183], v14 offset:1576
    s_nop 0
    v_mfma_f32_32x32x16_bf16 v[160:175], v[212:215], v[100:103], v[160:175]
    ds_read_b64 v[184:185], v14 offset:1600
    ds_read_b64 v[186:187], v14 offset:1608
    ds_read_b64 v[188:189], v14 offset:1632
    s_nop 1
    v_mfma_f32_32x32x16_bf16 v[160:175], v[216:219], v[104:107], v[160:175]
    ds_read_b64 v[190:191], v14 offset:1640
    ds_read_b64 v[192:193], v14 offset:1664
    ds_read_b64 v[194:195], v14 offset:1672
    v_mov_b32_dpp v128, v128 row_shr:1 row_mask:0xf bank_mask:0xf bound_ctrl:0
    v_mov_b32_dpp v129, v129 row_shr:1 row_mask:0xf bank_mask:0xf bound_ctrl:0
    v_mov_b32_dpp v130, v130 row_shr:1 row_mask:0xf bank_mask:0xf bound_ctrl:0
    v_mfma_f32_32x32x16_bf16 v[160:175], v[220:223], v[108:111], v[160:175]
    ds_read_b64 v[196:197], v14 offset:1696
    ds_read_b64 v[198:199], v14 offset:1704
    ds_read_b64 v[200:201], v14 offset:1728
    v_mov_b32_dpp v131, v131 row_shr:1 row_mask:0xf bank_mask:0xf bound_ctrl:0
    v_mov_b32_dpp v132, v132 row_shr:1 row_mask:0xf bank_mask:0xf bound_ctrl:0
    v_mov_b32_dpp v133, v133 row_shr:1 row_mask:0xf bank_mask:0xf bound_ctrl:0
    v_mfma_f32_32x32x16_bf16 v[160:175], v[224:227], v[112:115], v[160:175]
    ds_read_b64 v[202:203], v14 offset:1736
    ds_read_b64 v[204:205], v14 offset:1760
    ds_read_b64 v[206:207], v14 offset:1768
    v_mov_b32_dpp v134, v134 row_shr:1 row_mask:0xf bank_mask:0xf bound_ctrl:0
    v_mov_b32_dpp v135, v135 row_shr:1 row_mask:0xf bank_mask:0xf bound_ctrl:0
    v_mov_b32_dpp v136, v136 row_shr:1 row_mask:0xf bank_mask:0xf bound_ctrl:0
    v_mfma_f32_32x32x16_bf16 v[160:175], v[228:231], v[116:119], v[160:175]
    v_mov_b32_dpp v137, v137 row_shr:1 row_mask:0xf bank_mask:0xf bound_ctrl:0
    v_mov_b32_dpp v138, v138 row_shr:1 row_mask:0xf bank_mask:0xf bound_ctrl:0
    v_mov_b32_dpp v139, v139 row_shr:1 row_mask:0xf bank_mask:0xf bound_ctrl:0
    v_mfma_f32_32x32x16_bf16 v[160:175], v[232:235], v[120:123], v[160:175]
    v_mov_b32_dpp v140, v140 row_shr:1 row_mask:0xf bank_mask:0xf bound_ctrl:0
    v_mov_b32_dpp v141, v141 row_shr:1 row_mask:0xf bank_mask:0xf bound_ctrl:0
    v_mfma_f32_32x32x16_bf16 v[160:175], v[236:239], v[124:127], v[160:175]
    v_mov_b32_dpp v142, v142 row_shr:1 row_mask:0xf bank_mask:0xf bound_ctrl:0
    v_mov_b32_dpp v143, v143 row_shr:1 row_mask:0xf bank_mask:0xf bound_ctrl:0
    s_waitcnt lgkmcnt(0)
    v_mfma_f32_32x32x16_bf16 v[144:159], v[176:179], v[64:67], v[144:159]
    ds_read_b64 v[208:209], v14 offset:3584
    ds_read_b64 v[210:211], v14 offset:3592
    s_nop 2
    v_mfma_f32_32x32x16_bf16 v[144:159], v[180:183], v[68:71], v[144:159]
    ds_read_b64 v[212:213], v14 offset:3616
    ds_read_b64 v[214:215], v14 offset:3624
    s_nop 2
    v_mfma_f32_32x32x16_bf16 v[144:159], v[184:187], v[72:75], v[144:159]
    ds_read_b64 v[216:217], v14 offset:3648
    ds_read_b64 v[218:219], v14 offset:3656
    v_and_b32_dpp v160, v160, v15 row_shr:1 row_mask:0xf bank_mask:0xf bound_ctrl:0
    v_and_b32_dpp v161, v161, v15 row_shr:1 row_mask:0xf bank_mask:0xf bound_ctrl:0
    v_and_b32_dpp v162, v162, v15 row_shr:1 row_mask:0xf bank_mask:0xf bound_ctrl:0
    v_mfma_f32_32x32x16_bf16 v[144:159], v[188:191], v[76:79], v[144:159]
    ds_read_b64 v[220:221], v14 offset:3680
    ds_read_b64 v[222:223], v14 offset:3688
    v_and_b32_dpp v163, v163, v15 row_shr:1 row_mask:0xf bank_mask:0xf bound_ctrl:0
    v_and_b32_dpp v164, v164, v15 row_shr:1 row_mask:0xf bank_mask:0xf bound_ctrl:0
    v_and_b32_dpp v165, v165, v15 row_shr:1 row_mask:0xf bank_mask:0xf bound_ctrl:0
    v_mfma_f32_32x32x16_bf16 v[144:159], v[192:195], v[80:83], v[144:159]
    ds_read_b64 v[224:225], v14 offset:3712
    ds_read_b64 v[226:227], v14 offset:3720
    v_and_b32_dpp v166, v166, v15 row_shr:1 row_mask:0xf bank_mask:0xf bound_ctrl:0
    v_and_b32_dpp v167, v167, v15 row_shr:1 row_mask:0xf bank_mask:0xf bound_ctrl:0
    v_and_b32_dpp v168, v168, v15 row_shr:1 row_mask:0xf bank_mask:0xf bound_ctrl:0
    v_mfma_f32_32x32x16_bf16 v[144:159], v[196:199], v[84:87], v[144:159]
    ds_read_b64 v[228:229], v14 offset:3744
    ds_read_b64 v[230:231], v14 offset:3752
    v_and_b32_dpp v169, v169, v15 row_shr:1 row_mask:0xf bank_mask:0xf bound_ctrl:0
    v_and_b32_dpp v170, v170, v15 row_shr:1 row_mask:0xf bank_mask:0xf bound_ctrl:0
    v_and_b32_dpp v171, v171, v15 row_shr:1 row_mask:0xf bank_mask:0xf bound_ctrl:0
    v_mfma_f32_32x32x16_bf16 v[144:159], v[200:203], v[88:91], v[144:159]
    ds_read_b64 v[232:233], v14 offset:3776
    ds_read_b64 v[234:235], v14 offset:3784
    v_and_b32_dpp v172, v172, v15 row_shr:1 row_mask:0xf bank_mask:0xf bound_ctrl:0
    v_and_b32_dpp v173, v173, v15 row_shr:1 row_mask:0xf bank_mask:0xf bound_ctrl:0
    v_mfma_f32_32x32x16_bf16 v[144:159], v[204:207], v[92:95], v[144:159]
    ds_read_b64 v[236:237], v14 offset:3808
    ds_read_b64 v[238:239], v14 offset:3816
    v_and_b32_dpp v174, v174, v15 row_shr:1 row_mask:0xf bank_mask:0xf bound_ctrl:0
    v_and_b32_dpp v175, v175, v15 row_shr:1 row_mask:0xf bank_mask:0xf bound_ctrl:0
    v_mfma_f32_32x32x16_bf16 v[128:143], v[176:179], v[32:35], v[128:143]
    s_nop 4
    v_mfma_f32_32x32x16_bf16 v[128:143], v[180:183], v[36:39], v[128:143]
    s_nop 4
    v_mfma_f32_32x32x16_bf16 v[128:143], v[184:187], v[40:43], v[128:143]
    v_mov_b32_dpp v144, v144 row_shr:1 row_mask:0xf bank_mask:0xf bound_ctrl:0
    v_mov_b32_dpp v145, v145 row_shr:1 row_mask:0xf bank_mask:0xf bound_ctrl:0
    v_mov_b32_dpp v146, v146 row_shr:1 row_mask:0xf bank_mask:0xf bound_ctrl:0
    v_mfma_f32_32x32x16_bf16 v[128:143], v[188:191], v[44:47], v[128:143]
    v_mov_b32_dpp v147, v147 row_shr:1 row_mask:0xf bank_mask:0xf bound_ctrl:0
    v_mov_b32_dpp v148, v148 row_shr:1 row_mask:0xf bank_mask:0xf bound_ctrl:0
    v_mov_b32_dpp v149, v149 row_shr:1 row_mask:0xf bank_mask:0xf bound_ctrl:0
    v_mfma_f32_32x32x16_bf16 v[128:143], v[192:195], v[48:51], v[128:143]
    v_mov_b32_dpp v150, v150 row_shr:1 row_mask:0xf bank_mask:0xf bound_ctrl:0
    v_mov_b32_dpp v151, v151 row_shr:1 row_mask:0xf bank_mask:0xf bound_ctrl:0
    v_mov_b32_dpp v152, v152 row_shr:1 row_mask:0xf bank_mask:0xf bound_ctrl:0
    v_mfma_f32_32x32x16_bf16 v[128:143], v[196:199], v[52:55], v[128:143]
    v_mov_b32_dpp v153, v153 row_shr:1 row_mask:0xf bank_mask:0xf bound_ctrl:0
    v_mov_b32_dpp v154, v154 row_shr:1 row_mask:0xf bank_mask:0xf bound_ctrl:0
    v_mov_b32_dpp v155, v155 row_shr:1 row_mask:0xf bank_mask:0xf bound_ctrl:0
    v_mfma_f32_32x32x16_bf16 v[128:143], v[200:203], v[56:59], v[128:143]
    v_mov_b32_dpp v156, v156 row_shr:1 row_mask:0xf bank_mask:0xf bound_ctrl:0
    v_mov_b32_dpp v157, v157 row_shr:1 row_mask:0xf bank_mask:0xf bound_ctrl:0
    v_mfma_f32_32x32x16_bf16 v[128:143], v[204:207], v[60:63], v[128:143]
    v_mov_b32_dpp v158, v158 row_shr:1 row_mask:0xf bank_mask:0xf bound_ctrl:0
    v_mov_b32_dpp v159, v159 row_shr:1 row_mask:0xf bank_mask:0xf bound_ctrl:0
    s_waitcnt lgkmcnt(0)
    v_mfma_f32_32x32x16_bf16 v[160:175], v[208:211], v[96:99], v[160:175]
    ds_read_b64 v[176:177], v14 offset:1280
    ds_read_b64 v[178:179], v14 offset:1288
    ds_read_b64 v[180:181], v14 offset:1312
    ds_read_b64 v[182:183], v14 offset:1320
    s_nop 0
    v_mfma_f32_32x32x16_bf16 v[160:175], v[212:215], v[100:103], v[160:175]
    ds_read_b64 v[184:185], v14 offset:1344
    ds_read_b64 v[186:187], v14 offset:1352
    ds_read_b64 v[188:189], v14 offset:1376
    s_nop 1
    v_mfma_f32_32x32x16_bf16 v[160:175], v[216:219], v[104:107], v[160:175]
    ds_read_b64 v[190:191], v14 offset:1384
    ds_read_b64 v[192:193], v14 offset:1408
    ds_read_b64 v[194:195], v14 offset:1416
    v_mov_b32_dpp v128, v128 row_shr:1 row_mask:0xf bank_mask:0xf bound_ctrl:0
    v_mov_b32_dpp v129, v129 row_shr:1 row_mask:0xf bank_mask:0xf bound_ctrl:0
    v_mov_b32_dpp v130, v130 row_shr:1 row_mask:0xf bank_mask:0xf bound_ctrl:0
    v_mfma_f32_32x32x16_bf16 v[160:175], v[220:223], v[108:111], v[160:175]
    ds_read_b64 v[196:197], v14 offset:1440
    ds_read_b64 v[198:199], v14 offset:1448
    ds_read_b64 v[200:201], v14 offset:1472
    v_mov_b32_dpp v131, v131 row_shr:1 row_mask:0xf bank_mask:0xf bound_ctrl:0
    v_mov_b32_dpp v132, v132 row_shr:1 row_mask:0xf bank_mask:0xf bound_ctrl:0
    v_mov_b32_dpp v133, v133 row_shr:1 row_mask:0xf bank_mask:0xf bound_ctrl:0
    v_mfma_f32_32x32x16_bf16 v[160:175], v[224:227], v[112:115], v[160:175]
    ds_read_b64 v[202:203], v14 offset:1480
    ds_read_b64 v[204:205], v14 offset:1504
    ds_read_b64 v[206:207], v14 offset:1512
    v_mov_b32_dpp v134, v134 row_shr:1 row_mask:0xf bank_mask:0xf bound_ctrl:0
    v_mov_b32_dpp v135, v135 row_shr:1 row_mask:0xf bank_mask:0xf bound_ctrl:0
    v_mov_b32_dpp v136, v136 row_shr:1 row_mask:0xf bank_mask:0xf bound_ctrl:0
    v_mfma_f32_32x32x16_bf16 v[160:175], v[228:231], v[116:119], v[160:175]
    v_mov_b32_dpp v137, v137 row_shr:1 row_mask:0xf bank_mask:0xf bound_ctrl:0
    v_mov_b32_dpp v138, v138 row_shr:1 row_mask:0xf bank_mask:0xf bound_ctrl:0
    v_mov_b32_dpp v139, v139 row_shr:1 row_mask:0xf bank_mask:0xf bound_ctrl:0
    v_mfma_f32_32x32x16_bf16 v[160:175], v[232:235], v[120:123], v[160:175]
    v_mov_b32_dpp v140, v140 row_shr:1 row_mask:0xf bank_mask:0xf bound_ctrl:0
    v_mov_b32_dpp v141, v141 row_shr:1 row_mask:0xf bank_mask:0xf bound_ctrl:0
    v_mfma_f32_32x32x16_bf16 v[160:175], v[236:239], v[124:127], v[160:175]
    v_mov_b32_dpp v142, v142 row_shr:1 row_mask:0xf bank_mask:0xf bound_ctrl:0
    v_mov_b32_dpp v143, v143 row_shr:1 row_mask:0xf bank_mask:0xf bound_ctrl:0
    s_waitcnt lgkmcnt(0)
    v_mfma_f32_32x32x16_bf16 v[144:159], v[176:179], v[64:67], v[144:159]
    ds_read_b64 v[208:209], v14 offset:3328
    ds_read_b64 v[210:211], v14 offset:3336
    s_nop 2
    v_mfma_f32_32x32x16_bf16 v[144:159], v[180:183], v[68:71], v[144:159]
    ds_read_b64 v[212:213], v14 offset:3360
    ds_read_b64 v[214:215], v14 offset:3368
    s_nop 2
    v_mfma_f32_32x32x16_bf16 v[144:159], v[184:187], v[72:75], v[144:159]
    ds_read_b64 v[216:217], v14 offset:3392
    ds_read_b64 v[218:219], v14 offset:3400
    v_and_b32_dpp v160, v160, v15 row_shr:1 row_mask:0xf bank_mask:0xf bound_ctrl:0
    v_and_b32_dpp v161, v161, v15 row_shr:1 row_mask:0xf bank_mask:0xf bound_ctrl:0
    v_and_b32_dpp v162, v162, v15 row_shr:1 row_mask:0xf bank_mask:0xf bound_ctrl:0
    v_mfma_f32_32x32x16_bf16 v[144:159], v[188:191], v[76:79], v[144:159]
    ds_read_b64 v[220:221], v14 offset:3424
    ds_read_b64 v[222:223], v14 offset:3432
    v_and_b32_dpp v163, v163, v15 row_shr:1 row_mask:0xf bank_mask:0xf bound_ctrl:0
    v_and_b32_dpp v164, v164, v15 row_shr:1 row_mask:0xf bank_mask:0xf bound_ctrl:0
    v_and_b32_dpp v165, v165, v15 row_shr:1 row_mask:0xf bank_mask:0xf bound_ctrl:0
    v_mfma_f32_32x32x16_bf16 v[144:159], v[192:195], v[80:83], v[144:159]
    ds_read_b64 v[224:225], v14 offset:3456
    ds_read_b64 v[226:227], v14 offset:3464
    v_and_b32_dpp v166, v166, v15 row_shr:1 row_mask:0xf bank_mask:0xf bound_ctrl:0
    v_and_b32_dpp v167, v167, v15 row_shr:1 row_mask:0xf bank_mask:0xf bound_ctrl:0
    v_and_b32_dpp v168, v168, v15 row_shr:1 row_mask:0xf bank_mask:0xf bound_ctrl:0
    v_mfma_f32_32x32x16_bf16 v[144:159], v[196:199], v[84:87], v[144:159]
    ds_read_b64 v[228:229], v14 offset:3488
    ds_read_b64 v[230:231], v14 offset:3496
    v_and_b32_dpp v169, v169, v15 row_shr:1 row_mask:0xf bank_mask:0xf bound_ctrl:0
    v_and_b32_dpp v170, v170, v15 row_shr:1 row_mask:0xf bank_mask:0xf bound_ctrl:0
    v_and_b32_dpp v171, v171, v15 row_shr:1 row_mask:0xf bank_mask:0xf bound_ctrl:0
    v_mfma_f32_32x32x16_bf16 v[144:159], v[200:203], v[88:91], v[144:159]
    ds_read_b64 v[232:233], v14 offset:3520
    ds_read_b64 v[234:235], v14 offset:3528
    v_and_b32_dpp v172, v172, v15 row_shr:1 row_mask:0xf bank_mask:0xf bound_ctrl:0
    v_and_b32_dpp v173, v173, v15 row_shr:1 row_mask:0xf bank_mask:0xf bound_ctrl:0
    v_mfma_f32_32x32x16_bf16 v[144:159], v[204:207], v[92:95], v[144:159]
    ds_read_b64 v[236:237], v14 offset:3552
    ds_read_b64 v[238:239], v14 offset:3560
    v_and_b32_dpp v174, v174, v15 row_shr:1 row_mask:0xf bank_mask:0xf bound_ctrl:0
    v_and_b32_dpp v175, v175, v15 row_shr:1 row_mask:0xf bank_mask:0xf bound_ctrl:0
    v_mfma_f32_32x32x16_bf16 v[128:143], v[176:179], v[32:35], v[128:143]
    s_nop 4
    v_mfma_f32_32x32x16_bf16 v[128:143], v[180:183], v[36:39], v[128:143]
    s_nop 4
    v_mfma_f32_32x32x16_bf16 v[128:143], v[184:187], v[40:43], v[128:143]
    v_mov_b32_dpp v144, v144 row_shr:1 row_mask:0xf bank_mask:0xf bound_ctrl:0
    v_mov_b32_dpp v145, v145 row_shr:1 row_mask:0xf bank_mask:0xf bound_ctrl:0
    v_mov_b32_dpp v146, v146 row_shr:1 row_mask:0xf bank_mask:0xf bound_ctrl:0
    v_mfma_f32_32x32x16_bf16 v[128:143], v[188:191], v[44:47], v[128:143]
    v_mov_b32_dpp v147, v147 row_shr:1 row_mask:0xf bank_mask:0xf bound_ctrl:0
    v_mov_b32_dpp v148, v148 row_shr:1 row_mask:0xf bank_mask:0xf bound_ctrl:0
    v_mov_b32_dpp v149, v149 row_shr:1 row_mask:0xf bank_mask:0xf bound_ctrl:0
    v_mfma_f32_32x32x16_bf16 v[128:143], v[192:195], v[48:51], v[128:143]
    v_mov_b32_dpp v150, v150 row_shr:1 row_mask:0xf bank_mask:0xf bound_ctrl:0
    v_mov_b32_dpp v151, v151 row_shr:1 row_mask:0xf bank_mask:0xf bound_ctrl:0
    v_mov_b32_dpp v152, v152 row_shr:1 row_mask:0xf bank_mask:0xf bound_ctrl:0
    v_mfma_f32_32x32x16_bf16 v[128:143], v[196:199], v[52:55], v[128:143]
    v_mov_b32_dpp v153, v153 row_shr:1 row_mask:0xf bank_mask:0xf bound_ctrl:0
    v_mov_b32_dpp v154, v154 row_shr:1 row_mask:0xf bank_mask:0xf bound_ctrl:0
    v_mov_b32_dpp v155, v155 row_shr:1 row_mask:0xf bank_mask:0xf bound_ctrl:0
    v_mfma_f32_32x32x16_bf16 v[128:143], v[200:203], v[56:59], v[128:143]
    v_mov_b32_dpp v156, v156 row_shr:1 row_mask:0xf bank_mask:0xf bound_ctrl:0
    v_mov_b32_dpp v157, v157 row_shr:1 row_mask:0xf bank_mask:0xf bound_ctrl:0
    v_mfma_f32_32x32x16_bf16 v[128:143], v[204:207], v[60:63], v[128:143]
    v_mov_b32_dpp v158, v158 row_shr:1 row_mask:0xf bank_mask:0xf bound_ctrl:0
    v_mov_b32_dpp v159, v159 row_shr:1 row_mask:0xf bank_mask:0xf bound_ctrl:0
    s_waitcnt lgkmcnt(0)
    v_mfma_f32_32x32x16_bf16 v[160:175], v[208:211], v[96:99], v[160:175]
    ds_read_b64 v[176:177], v14 offset:1024
    ds_read_b64 v[178:179], v14 offset:1032
    ds_read_b64 v[180:181], v14 offset:1056
    ds_read_b64 v[182:183], v14 offset:1064
    s_nop 0
    v_mfma_f32_32x32x16_bf16 v[160:175], v[212:215], v[100:103], v[160:175]
    ds_read_b64 v[184:185], v14 offset:1088
    ds_read_b64 v[186:187], v14 offset:1096
    ds_read_b64 v[188:189], v14 offset:1120
    s_nop 1
    v_mfma_f32_32x32x16_bf16 v[160:175], v[216:219], v[104:107], v[160:175]
    ds_read_b64 v[190:191], v14 offset:1128
    ds_read_b64 v[192:193], v14 offset:1152
    ds_read_b64 v[194:195], v14 offset:1160
    v_mov_b32_dpp v128, v128 row_shr:1 row_mask:0xf bank_mask:0xf bound_ctrl:0
    v_mov_b32_dpp v129, v129 row_shr:1 row_mask:0xf bank_mask:0xf bound_ctrl:0
    v_mov_b32_dpp v130, v130 row_shr:1 row_mask:0xf bank_mask:0xf bound_ctrl:0
    v_mfma_f32_32x32x16_bf16 v[160:175], v[220:223], v[108:111], v[160:175]
    ds_read_b64 v[196:197], v14 offset:1184
    ds_read_b64 v[198:199], v14 offset:1192
    ds_read_b64 v[200:201], v14 offset:1216
    v_mov_b32_dpp v131, v131 row_shr:1 row_mask:0xf bank_mask:0xf bound_ctrl:0
    v_mov_b32_dpp v132, v132 row_shr:1 row_mask:0xf bank_mask:0xf bound_ctrl:0
    v_mov_b32_dpp v133, v133 row_shr:1 row_mask:0xf bank_mask:0xf bound_ctrl:0
    v_mfma_f32_32x32x16_bf16 v[160:175], v[224:227], v[112:115], v[160:175]
    ds_read_b64 v[202:203], v14 offset:1224
    ds_read_b64 v[204:205], v14 offset:1248
    ds_read_b64 v[206:207], v14 offset:1256
    v_mov_b32_dpp v134, v134 row_shr:1 row_mask:0xf bank_mask:0xf bound_ctrl:0
    v_mov_b32_dpp v135, v135 row_shr:1 row_mask:0xf bank_mask:0xf bound_ctrl:0
    v_mov_b32_dpp v136, v136 row_shr:1 row_mask:0xf bank_mask:0xf bound_ctrl:0
    v_mfma_f32_32x32x16_bf16 v[160:175], v[228:231], v[116:119], v[160:175]
    v_mov_b32_dpp v137, v137 row_shr:1 row_mask:0xf bank_mask:0xf bound_ctrl:0
    v_mov_b32_dpp v138, v138 row_shr:1 row_mask:0xf bank_mask:0xf bound_ctrl:0
    v_mov_b32_dpp v139, v139 row_shr:1 row_mask:0xf bank_mask:0xf bound_ctrl:0
    v_mfma_f32_32x32x16_bf16 v[160:175], v[232:235], v[120:123], v[160:175]
    v_mov_b32_dpp v140, v140 row_shr:1 row_mask:0xf bank_mask:0xf bound_ctrl:0
    v_mov_b32_dpp v141, v141 row_shr:1 row_mask:0xf bank_mask:0xf bound_ctrl:0
    v_mfma_f32_32x32x16_bf16 v[160:175], v[236:239], v[124:127], v[160:175]
    v_mov_b32_dpp v142, v142 row_shr:1 row_mask:0xf bank_mask:0xf bound_ctrl:0
    v_mov_b32_dpp v143, v143 row_shr:1 row_mask:0xf bank_mask:0xf bound_ctrl:0
    s_waitcnt lgkmcnt(0)
    v_mfma_f32_32x32x16_bf16 v[144:159], v[176:179], v[64:67], v[144:159]
    ds_read_b64 v[208:209], v14 offset:3072
    ds_read_b64 v[210:211], v14 offset:3080
    s_nop 2
    v_mfma_f32_32x32x16_bf16 v[144:159], v[180:183], v[68:71], v[144:159]
    ds_read_b64 v[212:213], v14 offset:3104
    ds_read_b64 v[214:215], v14 offset:3112
    s_nop 2
    v_mfma_f32_32x32x16_bf16 v[144:159], v[184:187], v[72:75], v[144:159]
    ds_read_b64 v[216:217], v14 offset:3136
    ds_read_b64 v[218:219], v14 offset:3144
    v_and_b32_dpp v160, v160, v15 row_shr:1 row_mask:0xf bank_mask:0xf bound_ctrl:0
    v_and_b32_dpp v161, v161, v15 row_shr:1 row_mask:0xf bank_mask:0xf bound_ctrl:0
    v_and_b32_dpp v162, v162, v15 row_shr:1 row_mask:0xf bank_mask:0xf bound_ctrl:0
    v_mfma_f32_32x32x16_bf16 v[144:159], v[188:191], v[76:79], v[144:159]
    ds_read_b64 v[220:221], v14 offset:3168
    ds_read_b64 v[222:223], v14 offset:3176
    v_and_b32_dpp v163, v163, v15 row_shr:1 row_mask:0xf bank_mask:0xf bound_ctrl:0
    v_and_b32_dpp v164, v164, v15 row_shr:1 row_mask:0xf bank_mask:0xf bound_ctrl:0
    v_and_b32_dpp v165, v165, v15 row_shr:1 row_mask:0xf bank_mask:0xf bound_ctrl:0
    v_mfma_f32_32x32x16_bf16 v[144:159], v[192:195], v[80:83], v[144:159]
    ds_read_b64 v[224:225], v14 offset:3200
    ds_read_b64 v[226:227], v14 offset:3208
    v_and_b32_dpp v166, v166, v15 row_shr:1 row_mask:0xf bank_mask:0xf bound_ctrl:0
    v_and_b32_dpp v167, v167, v15 row_shr:1 row_mask:0xf bank_mask:0xf bound_ctrl:0
    v_and_b32_dpp v168, v168, v15 row_shr:1 row_mask:0xf bank_mask:0xf bound_ctrl:0
    v_mfma_f32_32x32x16_bf16 v[144:159], v[196:199], v[84:87], v[144:159]
    ds_read_b64 v[228:229], v14 offset:3232
    ds_read_b64 v[230:231], v14 offset:3240
    v_and_b32_dpp v169, v169, v15 row_shr:1 row_mask:0xf bank_mask:0xf bound_ctrl:0
    v_and_b32_dpp v170, v170, v15 row_shr:1 row_mask:0xf bank_mask:0xf bound_ctrl:0
    v_and_b32_dpp v171, v171, v15 row_shr:1 row_mask:0xf bank_mask:0xf bound_ctrl:0
    v_mfma_f32_32x32x16_bf16 v[144:159], v[200:203], v[88:91], v[144:159]
    ds_read_b64 v[232:233], v14 offset:3264
    ds_read_b64 v[234:235], v14 offset:3272
    v_and_b32_dpp v172, v172, v15 row_shr:1 row_mask:0xf bank_mask:0xf bound_ctrl:0
    v_and_b32_dpp v173, v173, v15 row_shr:1 row_mask:0xf bank_mask:0xf bound_ctrl:0
    v_mfma_f32_32x32x16_bf16 v[144:159], v[204:207], v[92:95], v[144:159]
    ds_read_b64 v[236:237], v14 offset:3296
    ds_read_b64 v[238:239], v14 offset:3304
    v_and_b32_dpp v174, v174, v15 row_shr:1 row_mask:0xf bank_mask:0xf bound_ctrl:0
    v_and_b32_dpp v175, v175, v15 row_shr:1 row_mask:0xf bank_mask:0xf bound_ctrl:0
    v_mfma_f32_32x32x16_bf16 v[128:143], v[176:179], v[32:35], v[128:143]
    s_nop 4
    v_mfma_f32_32x32x16_bf16 v[128:143], v[180:183], v[36:39], v[128:143]
    s_nop 4
    v_mfma_f32_32x32x16_bf16 v[128:143], v[184:187], v[40:43], v[128:143]
    v_mov_b32_dpp v144, v144 row_shr:1 row_mask:0xf bank_mask:0xf bound_ctrl:0
    v_mov_b32_dpp v145, v145 row_shr:1 row_mask:0xf bank_mask:0xf bound_ctrl:0
    v_mov_b32_dpp v146, v146 row_shr:1 row_mask:0xf bank_mask:0xf bound_ctrl:0
    v_mfma_f32_32x32x16_bf16 v[128:143], v[188:191], v[44:47], v[128:143]
    v_mov_b32_dpp v147, v147 row_shr:1 row_mask:0xf bank_mask:0xf bound_ctrl:0
    v_mov_b32_dpp v148, v148 row_shr:1 row_mask:0xf bank_mask:0xf bound_ctrl:0
    v_mov_b32_dpp v149, v149 row_shr:1 row_mask:0xf bank_mask:0xf bound_ctrl:0
    v_mfma_f32_32x32x16_bf16 v[128:143], v[192:195], v[48:51], v[128:143]
    v_mov_b32_dpp v150, v150 row_shr:1 row_mask:0xf bank_mask:0xf bound_ctrl:0
    v_mov_b32_dpp v151, v151 row_shr:1 row_mask:0xf bank_mask:0xf bound_ctrl:0
    v_mov_b32_dpp v152, v152 row_shr:1 row_mask:0xf bank_mask:0xf bound_ctrl:0
    v_mfma_f32_32x32x16_bf16 v[128:143], v[196:199], v[52:55], v[128:143]
    v_mov_b32_dpp v153, v153 row_shr:1 row_mask:0xf bank_mask:0xf bound_ctrl:0
    v_mov_b32_dpp v154, v154 row_shr:1 row_mask:0xf bank_mask:0xf bound_ctrl:0
    v_mov_b32_dpp v155, v155 row_shr:1 row_mask:0xf bank_mask:0xf bound_ctrl:0
    v_mfma_f32_32x32x16_bf16 v[128:143], v[200:203], v[56:59], v[128:143]
    v_mov_b32_dpp v156, v156 row_shr:1 row_mask:0xf bank_mask:0xf bound_ctrl:0
    v_mov_b32_dpp v157, v157 row_shr:1 row_mask:0xf bank_mask:0xf bound_ctrl:0
    v_mfma_f32_32x32x16_bf16 v[128:143], v[204:207], v[60:63], v[128:143]
    v_mov_b32_dpp v158, v158 row_shr:1 row_mask:0xf bank_mask:0xf bound_ctrl:0
    v_mov_b32_dpp v159, v159 row_shr:1 row_mask:0xf bank_mask:0xf bound_ctrl:0
    s_waitcnt lgkmcnt(0)
    v_mfma_f32_32x32x16_bf16 v[160:175], v[208:211], v[96:99], v[160:175]
    ds_read_b64 v[176:177], v14 offset:768
    ds_read_b64 v[178:179], v14 offset:776
    ds_read_b64 v[180:181], v14 offset:800
    ds_read_b64 v[182:183], v14 offset:808
    s_nop 0
    v_mfma_f32_32x32x16_bf16 v[160:175], v[212:215], v[100:103], v[160:175]
    ds_read_b64 v[184:185], v14 offset:832
    ds_read_b64 v[186:187], v14 offset:840
    ds_read_b64 v[188:189], v14 offset:864
    s_nop 1
    v_mfma_f32_32x32x16_bf16 v[160:175], v[216:219], v[104:107], v[160:175]
    ds_read_b64 v[190:191], v14 offset:872
    ds_read_b64 v[192:193], v14 offset:896
    ds_read_b64 v[194:195], v14 offset:904
    v_mov_b32_dpp v128, v128 row_shr:1 row_mask:0xf bank_mask:0xf bound_ctrl:0
    v_mov_b32_dpp v129, v129 row_shr:1 row_mask:0xf bank_mask:0xf bound_ctrl:0
    v_mov_b32_dpp v130, v130 row_shr:1 row_mask:0xf bank_mask:0xf bound_ctrl:0
    v_mfma_f32_32x32x16_bf16 v[160:175], v[220:223], v[108:111], v[160:175]
    ds_read_b64 v[196:197], v14 offset:928
    ds_read_b64 v[198:199], v14 offset:936
    ds_read_b64 v[200:201], v14 offset:960
    v_mov_b32_dpp v131, v131 row_shr:1 row_mask:0xf bank_mask:0xf bound_ctrl:0
    v_mov_b32_dpp v132, v132 row_shr:1 row_mask:0xf bank_mask:0xf bound_ctrl:0
    v_mov_b32_dpp v133, v133 row_shr:1 row_mask:0xf bank_mask:0xf bound_ctrl:0
    v_mfma_f32_32x32x16_bf16 v[160:175], v[224:227], v[112:115], v[160:175]
    ds_read_b64 v[202:203], v14 offset:968
    ds_read_b64 v[204:205], v14 offset:992
    ds_read_b64 v[206:207], v14 offset:1000
    v_mov_b32_dpp v134, v134 row_shr:1 row_mask:0xf bank_mask:0xf bound_ctrl:0
    v_mov_b32_dpp v135, v135 row_shr:1 row_mask:0xf bank_mask:0xf bound_ctrl:0
    v_mov_b32_dpp v136, v136 row_shr:1 row_mask:0xf bank_mask:0xf bound_ctrl:0
    v_mfma_f32_32x32x16_bf16 v[160:175], v[228:231], v[116:119], v[160:175]
    v_mov_b32_dpp v137, v137 row_shr:1 row_mask:0xf bank_mask:0xf bound_ctrl:0
    v_mov_b32_dpp v138, v138 row_shr:1 row_mask:0xf bank_mask:0xf bound_ctrl:0
    v_mov_b32_dpp v139, v139 row_shr:1 row_mask:0xf bank_mask:0xf bound_ctrl:0
    v_mfma_f32_32x32x16_bf16 v[160:175], v[232:235], v[120:123], v[160:175]
    v_mov_b32_dpp v140, v140 row_shr:1 row_mask:0xf bank_mask:0xf bound_ctrl:0
    v_mov_b32_dpp v141, v141 row_shr:1 row_mask:0xf bank_mask:0xf bound_ctrl:0
    v_mfma_f32_32x32x16_bf16 v[160:175], v[236:239], v[124:127], v[160:175]
    v_mov_b32_dpp v142, v142 row_shr:1 row_mask:0xf bank_mask:0xf bound_ctrl:0
    v_mov_b32_dpp v143, v143 row_shr:1 row_mask:0xf bank_mask:0xf bound_ctrl:0
    s_waitcnt lgkmcnt(0)
    v_mfma_f32_32x32x16_bf16 v[144:159], v[176:179], v[64:67], v[144:159]
    ds_read_b64 v[208:209], v14 offset:2816
    ds_read_b64 v[210:211], v14 offset:2824
    s_nop 2
    v_mfma_f32_32x32x16_bf16 v[144:159], v[180:183], v[68:71], v[144:159]
    ds_read_b64 v[212:213], v14 offset:2848
    ds_read_b64 v[214:215], v14 offset:2856
    s_nop 2
    v_mfma_f32_32x32x16_bf16 v[144:159], v[184:187], v[72:75], v[144:159]
    ds_read_b64 v[216:217], v14 offset:2880
    ds_read_b64 v[218:219], v14 offset:2888
    v_and_b32_dpp v160, v160, v15 row_shr:1 row_mask:0xf bank_mask:0xf bound_ctrl:0
    v_and_b32_dpp v161, v161, v15 row_shr:1 row_mask:0xf bank_mask:0xf bound_ctrl:0
    v_and_b32_dpp v162, v162, v15 row_shr:1 row_mask:0xf bank_mask:0xf bound_ctrl:0
    v_mfma_f32_32x32x16_bf16 v[144:159], v[188:191], v[76:79], v[144:159]
    ds_read_b64 v[220:221], v14 offset:2912
    ds_read_b64 v[222:223], v14 offset:2920
    v_and_b32_dpp v163, v163, v15 row_shr:1 row_mask:0xf bank_mask:0xf bound_ctrl:0
    v_and_b32_dpp v164, v164, v15 row_shr:1 row_mask:0xf bank_mask:0xf bound_ctrl:0
    v_and_b32_dpp v165, v165, v15 row_shr:1 row_mask:0xf bank_mask:0xf bound_ctrl:0
    v_mfma_f32_32x32x16_bf16 v[144:159], v[192:195], v[80:83], v[144:159]
    ds_read_b64 v[224:225], v14 offset:2944
    ds_read_b64 v[226:227], v14 offset:2952
    v_and_b32_dpp v166, v166, v15 row_shr:1 row_mask:0xf bank_mask:0xf bound_ctrl:0
    v_and_b32_dpp v167, v167, v15 row_shr:1 row_mask:0xf bank_mask:0xf bound_ctrl:0
    v_and_b32_dpp v168, v168, v15 row_shr:1 row_mask:0xf bank_mask:0xf bound_ctrl:0
    v_mfma_f32_32x32x16_bf16 v[144:159], v[196:199], v[84:87], v[144:159]
    ds_read_b64 v[228:229], v14 offset:2976
    ds_read_b64 v[230:231], v14 offset:2984
    v_and_b32_dpp v169, v169, v15 row_shr:1 row_mask:0xf bank_mask:0xf bound_ctrl:0
    v_and_b32_dpp v170, v170, v15 row_shr:1 row_mask:0xf bank_mask:0xf bound_ctrl:0
    v_and_b32_dpp v171, v171, v15 row_shr:1 row_mask:0xf bank_mask:0xf bound_ctrl:0
    v_mfma_f32_32x32x16_bf16 v[144:159], v[200:203], v[88:91], v[144:159]
    ds_read_b64 v[232:233], v14 offset:3008
    ds_read_b64 v[234:235], v14 offset:3016
    v_and_b32_dpp v172, v172, v15 row_shr:1 row_mask:0xf bank_mask:0xf bound_ctrl:0
    v_and_b32_dpp v173, v173, v15 row_shr:1 row_mask:0xf bank_mask:0xf bound_ctrl:0
    v_mfma_f32_32x32x16_bf16 v[144:159], v[204:207], v[92:95], v[144:159]
    ds_read_b64 v[236:237], v14 offset:3040
    ds_read_b64 v[238:239], v14 offset:3048
    v_and_b32_dpp v174, v174, v15 row_shr:1 row_mask:0xf bank_mask:0xf bound_ctrl:0
    v_and_b32_dpp v175, v175, v15 row_shr:1 row_mask:0xf bank_mask:0xf bound_ctrl:0
    v_mfma_f32_32x32x16_bf16 v[128:143], v[176:179], v[32:35], v[128:143]
    s_nop 4
    v_mfma_f32_32x32x16_bf16 v[128:143], v[180:183], v[36:39], v[128:143]
    s_nop 4
    v_mfma_f32_32x32x16_bf16 v[128:143], v[184:187], v[40:43], v[128:143]
    v_mov_b32_dpp v144, v144 row_shr:1 row_mask:0xf bank_mask:0xf bound_ctrl:0
    v_mov_b32_dpp v145, v145 row_shr:1 row_mask:0xf bank_mask:0xf bound_ctrl:0
    v_mov_b32_dpp v146, v146 row_shr:1 row_mask:0xf bank_mask:0xf bound_ctrl:0
    v_mfma_f32_32x32x16_bf16 v[128:143], v[188:191], v[44:47], v[128:143]
    v_mov_b32_dpp v147, v147 row_shr:1 row_mask:0xf bank_mask:0xf bound_ctrl:0
    v_mov_b32_dpp v148, v148 row_shr:1 row_mask:0xf bank_mask:0xf bound_ctrl:0
    v_mov_b32_dpp v149, v149 row_shr:1 row_mask:0xf bank_mask:0xf bound_ctrl:0
    v_mfma_f32_32x32x16_bf16 v[128:143], v[192:195], v[48:51], v[128:143]
    v_mov_b32_dpp v150, v150 row_shr:1 row_mask:0xf bank_mask:0xf bound_ctrl:0
    v_mov_b32_dpp v151, v151 row_shr:1 row_mask:0xf bank_mask:0xf bound_ctrl:0
    v_mov_b32_dpp v152, v152 row_shr:1 row_mask:0xf bank_mask:0xf bound_ctrl:0
    v_mfma_f32_32x32x16_bf16 v[128:143], v[196:199], v[52:55], v[128:143]
    v_mov_b32_dpp v153, v153 row_shr:1 row_mask:0xf bank_mask:0xf bound_ctrl:0
    v_mov_b32_dpp v154, v154 row_shr:1 row_mask:0xf bank_mask:0xf bound_ctrl:0
    v_mov_b32_dpp v155, v155 row_shr:1 row_mask:0xf bank_mask:0xf bound_ctrl:0
    v_mfma_f32_32x32x16_bf16 v[128:143], v[200:203], v[56:59], v[128:143]
    v_mov_b32_dpp v156, v156 row_shr:1 row_mask:0xf bank_mask:0xf bound_ctrl:0
    v_mov_b32_dpp v157, v157 row_shr:1 row_mask:0xf bank_mask:0xf bound_ctrl:0
    v_mfma_f32_32x32x16_bf16 v[128:143], v[204:207], v[60:63], v[128:143]
    v_mov_b32_dpp v158, v158 row_shr:1 row_mask:0xf bank_mask:0xf bound_ctrl:0
    v_mov_b32_dpp v159, v159 row_shr:1 row_mask:0xf bank_mask:0xf bound_ctrl:0
    s_waitcnt lgkmcnt(0)
    v_mfma_f32_32x32x16_bf16 v[160:175], v[208:211], v[96:99], v[160:175]
    ds_read_b64 v[176:177], v14 offset:512
    ds_read_b64 v[178:179], v14 offset:520
    ds_read_b64 v[180:181], v14 offset:544
    ds_read_b64 v[182:183], v14 offset:552
    s_nop 0
    v_mfma_f32_32x32x16_bf16 v[160:175], v[212:215], v[100:103], v[160:175]
    ds_read_b64 v[184:185], v14 offset:576
    ds_read_b64 v[186:187], v14 offset:584
    ds_read_b64 v[188:189], v14 offset:608
    s_nop 1
    v_mfma_f32_32x32x16_bf16 v[160:175], v[216:219], v[104:107], v[160:175]
    ds_read_b64 v[190:191], v14 offset:616
    ds_read_b64 v[192:193], v14 offset:640
    ds_read_b64 v[194:195], v14 offset:648
    v_mov_b32_dpp v128, v128 row_shr:1 row_mask:0xf bank_mask:0xf bound_ctrl:0
    v_mov_b32_dpp v129, v129 row_shr:1 row_mask:0xf bank_mask:0xf bound_ctrl:0
    v_mov_b32_dpp v130, v130 row_shr:1 row_mask:0xf bank_mask:0xf bound_ctrl:0
    v_mfma_f32_32x32x16_bf16 v[160:175], v[220:223], v[108:111], v[160:175]
    ds_read_b64 v[196:197], v14 offset:672
    ds_read_b64 v[198:199], v14 offset:680
    ds_read_b64 v[200:201], v14 offset:704
    v_mov_b32_dpp v131, v131 row_shr:1 row_mask:0xf bank_mask:0xf bound_ctrl:0
    v_mov_b32_dpp v132, v132 row_shr:1 row_mask:0xf bank_mask:0xf bound_ctrl:0
    v_mov_b32_dpp v133, v133 row_shr:1 row_mask:0xf bank_mask:0xf bound_ctrl:0
    v_mfma_f32_32x32x16_bf16 v[160:175], v[224:227], v[112:115], v[160:175]
    ds_read_b64 v[202:203], v14 offset:712
    ds_read_b64 v[204:205], v14 offset:736
    ds_read_b64 v[206:207], v14 offset:744
    v_mov_b32_dpp v134, v134 row_shr:1 row_mask:0xf bank_mask:0xf bound_ctrl:0
    v_mov_b32_dpp v135, v135 row_shr:1 row_mask:0xf bank_mask:0xf bound_ctrl:0
    v_mov_b32_dpp v136, v136 row_shr:1 row_mask:0xf bank_mask:0xf bound_ctrl:0
    v_mfma_f32_32x32x16_bf16 v[160:175], v[228:231], v[116:119], v[160:175]
    v_mov_b32_dpp v137, v137 row_shr:1 row_mask:0xf bank_mask:0xf bound_ctrl:0
    v_mov_b32_dpp v138, v138 row_shr:1 row_mask:0xf bank_mask:0xf bound_ctrl:0
    v_mov_b32_dpp v139, v139 row_shr:1 row_mask:0xf bank_mask:0xf bound_ctrl:0
    v_mfma_f32_32x32x16_bf16 v[160:175], v[232:235], v[120:123], v[160:175]
    v_mov_b32_dpp v140, v140 row_shr:1 row_mask:0xf bank_mask:0xf bound_ctrl:0
    v_mov_b32_dpp v141, v141 row_shr:1 row_mask:0xf bank_mask:0xf bound_ctrl:0
    v_mfma_f32_32x32x16_bf16 v[160:175], v[236:239], v[124:127], v[160:175]
    v_mov_b32_dpp v142, v142 row_shr:1 row_mask:0xf bank_mask:0xf bound_ctrl:0
    v_mov_b32_dpp v143, v143 row_shr:1 row_mask:0xf bank_mask:0xf bound_ctrl:0
    s_waitcnt lgkmcnt(0)
    v_mfma_f32_32x32x16_bf16 v[144:159], v[176:179], v[64:67], v[144:159]
    ds_read_b64 v[208:209], v14 offset:2560
    ds_read_b64 v[210:211], v14 offset:2568
    s_nop 2
    v_mfma_f32_32x32x16_bf16 v[144:159], v[180:183], v[68:71], v[144:159]
    ds_read_b64 v[212:213], v14 offset:2592
    ds_read_b64 v[214:215], v14 offset:2600
    s_nop 2
    v_mfma_f32_32x32x16_bf16 v[144:159], v[184:187], v[72:75], v[144:159]
    ds_read_b64 v[216:217], v14 offset:2624
    ds_read_b64 v[218:219], v14 offset:2632
    v_and_b32_dpp v160, v160, v15 row_shr:1 row_mask:0xf bank_mask:0xf bound_ctrl:0
    v_and_b32_dpp v161, v161, v15 row_shr:1 row_mask:0xf bank_mask:0xf bound_ctrl:0
    v_and_b32_dpp v162, v162, v15 row_shr:1 row_mask:0xf bank_mask:0xf bound_ctrl:0
    v_mfma_f32_32x32x16_bf16 v[144:159], v[188:191], v[76:79], v[144:159]
    ds_read_b64 v[220:221], v14 offset:2656
    ds_read_b64 v[222:223], v14 offset:2664
    v_and_b32_dpp v163, v163, v15 row_shr:1 row_mask:0xf bank_mask:0xf bound_ctrl:0
    v_and_b32_dpp v164, v164, v15 row_shr:1 row_mask:0xf bank_mask:0xf bound_ctrl:0
    v_and_b32_dpp v165, v165, v15 row_shr:1 row_mask:0xf bank_mask:0xf bound_ctrl:0
    v_mfma_f32_32x32x16_bf16 v[144:159], v[192:195], v[80:83], v[144:159]
    ds_read_b64 v[224:225], v14 offset:2688
    ds_read_b64 v[226:227], v14 offset:2696
    v_and_b32_dpp v166, v166, v15 row_shr:1 row_mask:0xf bank_mask:0xf bound_ctrl:0
    v_and_b32_dpp v167, v167, v15 row_shr:1 row_mask:0xf bank_mask:0xf bound_ctrl:0
    v_and_b32_dpp v168, v168, v15 row_shr:1 row_mask:0xf bank_mask:0xf bound_ctrl:0
    v_mfma_f32_32x32x16_bf16 v[144:159], v[196:199], v[84:87], v[144:159]
    ds_read_b64 v[228:229], v14 offset:2720
    ds_read_b64 v[230:231], v14 offset:2728
    v_and_b32_dpp v169, v169, v15 row_shr:1 row_mask:0xf bank_mask:0xf bound_ctrl:0
    v_and_b32_dpp v170, v170, v15 row_shr:1 row_mask:0xf bank_mask:0xf bound_ctrl:0
    v_and_b32_dpp v171, v171, v15 row_shr:1 row_mask:0xf bank_mask:0xf bound_ctrl:0
    v_mfma_f32_32x32x16_bf16 v[144:159], v[200:203], v[88:91], v[144:159]
    ds_read_b64 v[232:233], v14 offset:2752
    ds_read_b64 v[234:235], v14 offset:2760
    v_and_b32_dpp v172, v172, v15 row_shr:1 row_mask:0xf bank_mask:0xf bound_ctrl:0
    v_and_b32_dpp v173, v173, v15 row_shr:1 row_mask:0xf bank_mask:0xf bound_ctrl:0
    v_mfma_f32_32x32x16_bf16 v[144:159], v[204:207], v[92:95], v[144:159]
    ds_read_b64 v[236:237], v14 offset:2784
    ds_read_b64 v[238:239], v14 offset:2792
    v_and_b32_dpp v174, v174, v15 row_shr:1 row_mask:0xf bank_mask:0xf bound_ctrl:0
    v_and_b32_dpp v175, v175, v15 row_shr:1 row_mask:0xf bank_mask:0xf bound_ctrl:0
    v_mfma_f32_32x32x16_bf16 v[128:143], v[176:179], v[32:35], v[128:143]
    s_nop 4
    v_mfma_f32_32x32x16_bf16 v[128:143], v[180:183], v[36:39], v[128:143]
    s_nop 4
    v_mfma_f32_32x32x16_bf16 v[128:143], v[184:187], v[40:43], v[128:143]
    v_mov_b32_dpp v144, v144 row_shr:1 row_mask:0xf bank_mask:0xf bound_ctrl:0
    v_mov_b32_dpp v145, v145 row_shr:1 row_mask:0xf bank_mask:0xf bound_ctrl:0
    v_mov_b32_dpp v146, v146 row_shr:1 row_mask:0xf bank_mask:0xf bound_ctrl:0
    v_mfma_f32_32x32x16_bf16 v[128:143], v[188:191], v[44:47], v[128:143]
    v_mov_b32_dpp v147, v147 row_shr:1 row_mask:0xf bank_mask:0xf bound_ctrl:0
    v_mov_b32_dpp v148, v148 row_shr:1 row_mask:0xf bank_mask:0xf bound_ctrl:0
    v_mov_b32_dpp v149, v149 row_shr:1 row_mask:0xf bank_mask:0xf bound_ctrl:0
    v_mfma_f32_32x32x16_bf16 v[128:143], v[192:195], v[48:51], v[128:143]
    v_mov_b32_dpp v150, v150 row_shr:1 row_mask:0xf bank_mask:0xf bound_ctrl:0
    v_mov_b32_dpp v151, v151 row_shr:1 row_mask:0xf bank_mask:0xf bound_ctrl:0
    v_mov_b32_dpp v152, v152 row_shr:1 row_mask:0xf bank_mask:0xf bound_ctrl:0
    v_mfma_f32_32x32x16_bf16 v[128:143], v[196:199], v[52:55], v[128:143]
    v_mov_b32_dpp v153, v153 row_shr:1 row_mask:0xf bank_mask:0xf bound_ctrl:0
    v_mov_b32_dpp v154, v154 row_shr:1 row_mask:0xf bank_mask:0xf bound_ctrl:0
    v_mov_b32_dpp v155, v155 row_shr:1 row_mask:0xf bank_mask:0xf bound_ctrl:0
    v_mfma_f32_32x32x16_bf16 v[128:143], v[200:203], v[56:59], v[128:143]
    v_mov_b32_dpp v156, v156 row_shr:1 row_mask:0xf bank_mask:0xf bound_ctrl:0
    v_mov_b32_dpp v157, v157 row_shr:1 row_mask:0xf bank_mask:0xf bound_ctrl:0
    v_mfma_f32_32x32x16_bf16 v[128:143], v[204:207], v[60:63], v[128:143]
    v_mov_b32_dpp v158, v158 row_shr:1 row_mask:0xf bank_mask:0xf bound_ctrl:0
    v_mov_b32_dpp v159, v159 row_shr:1 row_mask:0xf bank_mask:0xf bound_ctrl:0
    s_waitcnt lgkmcnt(0)
    v_mfma_f32_32x32x16_bf16 v[160:175], v[208:211], v[96:99], v[160:175]
    ds_read_b64 v[176:177], v14 offset:256
    ds_read_b64 v[178:179], v14 offset:264
    ds_read_b64 v[180:181], v14 offset:288
    ds_read_b64 v[182:183], v14 offset:296
    s_nop 0
    v_mfma_f32_32x32x16_bf16 v[160:175], v[212:215], v[100:103], v[160:175]
    ds_read_b64 v[184:185], v14 offset:320
    ds_read_b64 v[186:187], v14 offset:328
    ds_read_b64 v[188:189], v14 offset:352
    s_nop 1
    v_mfma_f32_32x32x16_bf16 v[160:175], v[216:219], v[104:107], v[160:175]
    ds_read_b64 v[190:191], v14 offset:360
    ds_read_b64 v[192:193], v14 offset:384
    ds_read_b64 v[194:195], v14 offset:392
    v_mov_b32_dpp v128, v128 row_shr:1 row_mask:0xf bank_mask:0xf bound_ctrl:0
    v_mov_b32_dpp v129, v129 row_shr:1 row_mask:0xf bank_mask:0xf bound_ctrl:0
    v_mov_b32_dpp v130, v130 row_shr:1 row_mask:0xf bank_mask:0xf bound_ctrl:0
    v_mfma_f32_32x32x16_bf16 v[160:175], v[220:223], v[108:111], v[160:175]
    ds_read_b64 v[196:197], v14 offset:416
    ds_read_b64 v[198:199], v14 offset:424
    ds_read_b64 v[200:201], v14 offset:448
    v_mov_b32_dpp v131, v131 row_shr:1 row_mask:0xf bank_mask:0xf bound_ctrl:0
    v_mov_b32_dpp v132, v132 row_shr:1 row_mask:0xf bank_mask:0xf bound_ctrl:0
    v_mov_b32_dpp v133, v133 row_shr:1 row_mask:0xf bank_mask:0xf bound_ctrl:0
    v_mfma_f32_32x32x16_bf16 v[160:175], v[224:227], v[112:115], v[160:175]
    ds_read_b64 v[202:203], v14 offset:456
    ds_read_b64 v[204:205], v14 offset:480
    ds_read_b64 v[206:207], v14 offset:488
    v_mov_b32_dpp v134, v134 row_shr:1 row_mask:0xf bank_mask:0xf bound_ctrl:0
    v_mov_b32_dpp v135, v135 row_shr:1 row_mask:0xf bank_mask:0xf bound_ctrl:0
    v_mov_b32_dpp v136, v136 row_shr:1 row_mask:0xf bank_mask:0xf bound_ctrl:0
    v_mfma_f32_32x32x16_bf16 v[160:175], v[228:231], v[116:119], v[160:175]
    v_mov_b32_dpp v137, v137 row_shr:1 row_mask:0xf bank_mask:0xf bound_ctrl:0
    v_mov_b32_dpp v138, v138 row_shr:1 row_mask:0xf bank_mask:0xf bound_ctrl:0
    v_mov_b32_dpp v139, v139 row_shr:1 row_mask:0xf bank_mask:0xf bound_ctrl:0
    v_mfma_f32_32x32x16_bf16 v[160:175], v[232:235], v[120:123], v[160:175]
    v_mov_b32_dpp v140, v140 row_shr:1 row_mask:0xf bank_mask:0xf bound_ctrl:0
    v_mov_b32_dpp v141, v141 row_shr:1 row_mask:0xf bank_mask:0xf bound_ctrl:0
    v_mfma_f32_32x32x16_bf16 v[160:175], v[236:239], v[124:127], v[160:175]
    v_mov_b32_dpp v142, v142 row_shr:1 row_mask:0xf bank_mask:0xf bound_ctrl:0
    v_mov_b32_dpp v143, v143 row_shr:1 row_mask:0xf bank_mask:0xf bound_ctrl:0
    s_waitcnt lgkmcnt(0)
    v_mfma_f32_32x32x16_bf16 v[144:159], v[176:179], v[64:67], v[144:159]
    ds_read_b64 v[208:209], v14 offset:2304
    ds_read_b64 v[210:211], v14 offset:2312
    s_nop 2
    v_mfma_f32_32x32x16_bf16 v[144:159], v[180:183], v[68:71], v[144:159]
    ds_read_b64 v[212:213], v14 offset:2336
    ds_read_b64 v[214:215], v14 offset:2344
    s_nop 2
    v_mfma_f32_32x32x16_bf16 v[144:159], v[184:187], v[72:75], v[144:159]
    ds_read_b64 v[216:217], v14 offset:2368
    ds_read_b64 v[218:219], v14 offset:2376
    v_and_b32_dpp v160, v160, v15 row_shr:1 row_mask:0xf bank_mask:0xf bound_ctrl:0
    v_and_b32_dpp v161, v161, v15 row_shr:1 row_mask:0xf bank_mask:0xf bound_ctrl:0
    v_and_b32_dpp v162, v162, v15 row_shr:1 row_mask:0xf bank_mask:0xf bound_ctrl:0
    v_mfma_f32_32x32x16_bf16 v[144:159], v[188:191], v[76:79], v[144:159]
    ds_read_b64 v[220:221], v14 offset:2400
    ds_read_b64 v[222:223], v14 offset:2408
    v_and_b32_dpp v163, v163, v15 row_shr:1 row_mask:0xf bank_mask:0xf bound_ctrl:0
    v_and_b32_dpp v164, v164, v15 row_shr:1 row_mask:0xf bank_mask:0xf bound_ctrl:0
    v_and_b32_dpp v165, v165, v15 row_shr:1 row_mask:0xf bank_mask:0xf bound_ctrl:0
    v_mfma_f32_32x32x16_bf16 v[144:159], v[192:195], v[80:83], v[144:159]
    ds_read_b64 v[224:225], v14 offset:2432
    ds_read_b64 v[226:227], v14 offset:2440
    v_and_b32_dpp v166, v166, v15 row_shr:1 row_mask:0xf bank_mask:0xf bound_ctrl:0
    v_and_b32_dpp v167, v167, v15 row_shr:1 row_mask:0xf bank_mask:0xf bound_ctrl:0
    v_and_b32_dpp v168, v168, v15 row_shr:1 row_mask:0xf bank_mask:0xf bound_ctrl:0
    v_mfma_f32_32x32x16_bf16 v[144:159], v[196:199], v[84:87], v[144:159]
    ds_read_b64 v[228:229], v14 offset:2464
    ds_read_b64 v[230:231], v14 offset:2472
    v_and_b32_dpp v169, v169, v15 row_shr:1 row_mask:0xf bank_mask:0xf bound_ctrl:0
    v_and_b32_dpp v170, v170, v15 row_shr:1 row_mask:0xf bank_mask:0xf bound_ctrl:0
    v_and_b32_dpp v171, v171, v15 row_shr:1 row_mask:0xf bank_mask:0xf bound_ctrl:0
    v_mfma_f32_32x32x16_bf16 v[144:159], v[200:203], v[88:91], v[144:159]
    ds_read_b64 v[232:233], v14 offset:2496
    ds_read_b64 v[234:235], v14 offset:2504
    v_and_b32_dpp v172, v172, v15 row_shr:1 row_mask:0xf bank_mask:0xf bound_ctrl:0
    v_and_b32_dpp v173, v173, v15 row_shr:1 row_mask:0xf bank_mask:0xf bound_ctrl:0
    v_mfma_f32_32x32x16_bf16 v[144:159], v[204:207], v[92:95], v[144:159]
    ds_read_b64 v[236:237], v14 offset:2528
    ds_read_b64 v[238:239], v14 offset:2536
    v_and_b32_dpp v174, v174, v15 row_shr:1 row_mask:0xf bank_mask:0xf bound_ctrl:0
    v_and_b32_dpp v175, v175, v15 row_shr:1 row_mask:0xf bank_mask:0xf bound_ctrl:0
    v_mfma_f32_32x32x16_bf16 v[128:143], v[176:179], v[32:35], v[128:143]
    s_nop 4
    v_mfma_f32_32x32x16_bf16 v[128:143], v[180:183], v[36:39], v[128:143]
    s_nop 4
    v_mfma_f32_32x32x16_bf16 v[128:143], v[184:187], v[40:43], v[128:143]
    v_mov_b32_dpp v144, v144 row_shr:1 row_mask:0xf bank_mask:0xf bound_ctrl:0
    v_mov_b32_dpp v145, v145 row_shr:1 row_mask:0xf bank_mask:0xf bound_ctrl:0
    v_mov_b32_dpp v146, v146 row_shr:1 row_mask:0xf bank_mask:0xf bound_ctrl:0
    v_mfma_f32_32x32x16_bf16 v[128:143], v[188:191], v[44:47], v[128:143]
    v_mov_b32_dpp v147, v147 row_shr:1 row_mask:0xf bank_mask:0xf bound_ctrl:0
    v_mov_b32_dpp v148, v148 row_shr:1 row_mask:0xf bank_mask:0xf bound_ctrl:0
    v_mov_b32_dpp v149, v149 row_shr:1 row_mask:0xf bank_mask:0xf bound_ctrl:0
    v_mfma_f32_32x32x16_bf16 v[128:143], v[192:195], v[48:51], v[128:143]
    v_mov_b32_dpp v150, v150 row_shr:1 row_mask:0xf bank_mask:0xf bound_ctrl:0
    v_mov_b32_dpp v151, v151 row_shr:1 row_mask:0xf bank_mask:0xf bound_ctrl:0
    v_mov_b32_dpp v152, v152 row_shr:1 row_mask:0xf bank_mask:0xf bound_ctrl:0
    v_mfma_f32_32x32x16_bf16 v[128:143], v[196:199], v[52:55], v[128:143]
    v_mov_b32_dpp v153, v153 row_shr:1 row_mask:0xf bank_mask:0xf bound_ctrl:0
    v_mov_b32_dpp v154, v154 row_shr:1 row_mask:0xf bank_mask:0xf bound_ctrl:0
    v_mov_b32_dpp v155, v155 row_shr:1 row_mask:0xf bank_mask:0xf bound_ctrl:0
    v_mfma_f32_32x32x16_bf16 v[128:143], v[200:203], v[56:59], v[128:143]
    v_mov_b32_dpp v156, v156 row_shr:1 row_mask:0xf bank_mask:0xf bound_ctrl:0
    v_mov_b32_dpp v157, v157 row_shr:1 row_mask:0xf bank_mask:0xf bound_ctrl:0
    v_mfma_f32_32x32x16_bf16 v[128:143], v[204:207], v[60:63], v[128:143]
    v_mov_b32_dpp v158, v158 row_shr:1 row_mask:0xf bank_mask:0xf bound_ctrl:0
    v_mov_b32_dpp v159, v159 row_shr:1 row_mask:0xf bank_mask:0xf bound_ctrl:0
    s_waitcnt lgkmcnt(0)
    v_mfma_f32_32x32x16_bf16 v[160:175], v[208:211], v[96:99], v[160:175]
    ds_read_b64 v[176:177], v14 offset:0
    ds_read_b64 v[178:179], v14 offset:8
    ds_read_b64 v[180:181], v14 offset:32
    ds_read_b64 v[182:183], v14 offset:40
    s_nop 0
    v_mfma_f32_32x32x16_bf16 v[160:175], v[212:215], v[100:103], v[160:175]
    ds_read_b64 v[184:185], v14 offset:64
    ds_read_b64 v[186:187], v14 offset:72
    ds_read_b64 v[188:189], v14 offset:96
    s_nop 1
    v_mfma_f32_32x32x16_bf16 v[160:175], v[216:219], v[104:107], v[160:175]
    ds_read_b64 v[190:191], v14 offset:104
    ds_read_b64 v[192:193], v14 offset:128
    ds_read_b64 v[194:195], v14 offset:136
    v_mov_b32_dpp v128, v128 row_shr:1 row_mask:0xf bank_mask:0xf bound_ctrl:0
    v_mov_b32_dpp v129, v129 row_shr:1 row_mask:0xf bank_mask:0xf bound_ctrl:0
    v_mov_b32_dpp v130, v130 row_shr:1 row_mask:0xf bank_mask:0xf bound_ctrl:0
    v_mfma_f32_32x32x16_bf16 v[160:175], v[220:223], v[108:111], v[160:175]
    ds_read_b64 v[196:197], v14 offset:160
    ds_read_b64 v[198:199], v14 offset:168
    ds_read_b64 v[200:201], v14 offset:192
    v_mov_b32_dpp v131, v131 row_shr:1 row_mask:0xf bank_mask:0xf bound_ctrl:0
    v_mov_b32_dpp v132, v132 row_shr:1 row_mask:0xf bank_mask:0xf bound_ctrl:0
    v_mov_b32_dpp v133, v133 row_shr:1 row_mask:0xf bank_mask:0xf bound_ctrl:0
    v_mfma_f32_32x32x16_bf16 v[160:175], v[224:227], v[112:115], v[160:175]
    ds_read_b64 v[202:203], v14 offset:200
    ds_read_b64 v[204:205], v14 offset:224
    ds_read_b64 v[206:207], v14 offset:232
    v_mov_b32_dpp v134, v134 row_shr:1 row_mask:0xf bank_mask:0xf bound_ctrl:0
    v_mov_b32_dpp v135, v135 row_shr:1 row_mask:0xf bank_mask:0xf bound_ctrl:0
    v_mov_b32_dpp v136, v136 row_shr:1 row_mask:0xf bank_mask:0xf bound_ctrl:0
    v_mfma_f32_32x32x16_bf16 v[160:175], v[228:231], v[116:119], v[160:175]
    v_mov_b32_dpp v137, v137 row_shr:1 row_mask:0xf bank_mask:0xf bound_ctrl:0
    v_mov_b32_dpp v138, v138 row_shr:1 row_mask:0xf bank_mask:0xf bound_ctrl:0
    v_mov_b32_dpp v139, v139 row_shr:1 row_mask:0xf bank_mask:0xf bound_ctrl:0
    v_mfma_f32_32x32x16_bf16 v[160:175], v[232:235], v[120:123], v[160:175]
    v_mov_b32_dpp v140, v140 row_shr:1 row_mask:0xf bank_mask:0xf bound_ctrl:0
    v_mov_b32_dpp v141, v141 row_shr:1 row_mask:0xf bank_mask:0xf bound_ctrl:0
    v_mfma_f32_32x32x16_bf16 v[160:175], v[236:239], v[124:127], v[160:175]
    v_mov_b32_dpp v142, v142 row_shr:1 row_mask:0xf bank_mask:0xf bound_ctrl:0
    v_mov_b32_dpp v143, v143 row_shr:1 row_mask:0xf bank_mask:0xf bound_ctrl:0
    s_waitcnt lgkmcnt(0)
    v_mfma_f32_32x32x16_bf16 v[144:159], v[176:179], v[64:67], v[144:159]
    ds_read_b64 v[208:209], v14 offset:2048
    ds_read_b64 v[210:211], v14 offset:2056
    s_nop 2
    v_mfma_f32_32x32x16_bf16 v[144:159], v[180:183], v[68:71], v[144:159]
    ds_read_b64 v[212:213], v14 offset:2080
    ds_read_b64 v[214:215], v14 offset:2088
    s_nop 2
    v_mfma_f32_32x32x16_bf16 v[144:159], v[184:187], v[72:75], v[144:159]
    ds_read_b64 v[216:217], v14 offset:2112
    ds_read_b64 v[218:219], v14 offset:2120
    v_and_b32_dpp v160, v160, v15 row_shr:1 row_mask:0xf bank_mask:0xf bound_ctrl:0
    v_and_b32_dpp v161, v161, v15 row_shr:1 row_mask:0xf bank_mask:0xf bound_ctrl:0
    v_and_b32_dpp v162, v162, v15 row_shr:1 row_mask:0xf bank_mask:0xf bound_ctrl:0
    v_mfma_f32_32x32x16_bf16 v[144:159], v[188:191], v[76:79], v[144:159]
    ds_read_b64 v[220:221], v14 offset:2144
    ds_read_b64 v[222:223], v14 offset:2152
    v_and_b32_dpp v163, v163, v15 row_shr:1 row_mask:0xf bank_mask:0xf bound_ctrl:0
    v_and_b32_dpp v164, v164, v15 row_shr:1 row_mask:0xf bank_mask:0xf bound_ctrl:0
    v_and_b32_dpp v165, v165, v15 row_shr:1 row_mask:0xf bank_mask:0xf bound_ctrl:0
    v_mfma_f32_32x32x16_bf16 v[144:159], v[192:195], v[80:83], v[144:159]
    ds_read_b64 v[224:225], v14 offset:2176
    ds_read_b64 v[226:227], v14 offset:2184
    v_and_b32_dpp v166, v166, v15 row_shr:1 row_mask:0xf bank_mask:0xf bound_ctrl:0
    v_and_b32_dpp v167, v167, v15 row_shr:1 row_mask:0xf bank_mask:0xf bound_ctrl:0
    v_and_b32_dpp v168, v168, v15 row_shr:1 row_mask:0xf bank_mask:0xf bound_ctrl:0
    v_mfma_f32_32x32x16_bf16 v[144:159], v[196:199], v[84:87], v[144:159]
    ds_read_b64 v[228:229], v14 offset:2208
    ds_read_b64 v[230:231], v14 offset:2216
    v_and_b32_dpp v169, v169, v15 row_shr:1 row_mask:0xf bank_mask:0xf bound_ctrl:0
    v_and_b32_dpp v170, v170, v15 row_shr:1 row_mask:0xf bank_mask:0xf bound_ctrl:0
    v_and_b32_dpp v171, v171, v15 row_shr:1 row_mask:0xf bank_mask:0xf bound_ctrl:0
    v_mfma_f32_32x32x16_bf16 v[144:159], v[200:203], v[88:91], v[144:159]
    ds_read_b64 v[232:233], v14 offset:2240
    ds_read_b64 v[234:235], v14 offset:2248
    v_and_b32_dpp v172, v172, v15 row_shr:1 row_mask:0xf bank_mask:0xf bound_ctrl:0
    v_and_b32_dpp v173, v173, v15 row_shr:1 row_mask:0xf bank_mask:0xf bound_ctrl:0
    v_mfma_f32_32x32x16_bf16 v[144:159], v[204:207], v[92:95], v[144:159]
    ds_read_b64 v[236:237], v14 offset:2272
    ds_read_b64 v[238:239], v14 offset:2280
    v_and_b32_dpp v174, v174, v15 row_shr:1 row_mask:0xf bank_mask:0xf bound_ctrl:0
    v_and_b32_dpp v175, v175, v15 row_shr:1 row_mask:0xf bank_mask:0xf bound_ctrl:0
    v_mfma_f32_32x32x16_bf16 v[128:143], v[176:179], v[32:35], v[128:143]
    v_mfma_f32_32x32x16_bf16 v[128:143], v[180:183], v[36:39], v[128:143]
    v_mfma_f32_32x32x16_bf16 v[128:143], v[184:187], v[40:43], v[128:143]
    v_mfma_f32_32x32x16_bf16 v[128:143], v[188:191], v[44:47], v[128:143]
    v_mfma_f32_32x32x16_bf16 v[128:143], v[192:195], v[48:51], v[128:143]
    v_mfma_f32_32x32x16_bf16 v[128:143], v[196:199], v[52:55], v[128:143]
    v_mfma_f32_32x32x16_bf16 v[128:143], v[200:203], v[56:59], v[128:143]
    v_mfma_f32_32x32x16_bf16 v[128:143], v[204:207], v[60:63], v[128:143]
    s_waitcnt lgkmcnt(0)
    v_mfma_f32_32x32x16_bf16 v[160:175], v[208:211], v[96:99], v[160:175]
    v_mfma_f32_32x32x16_bf16 v[160:175], v[212:215], v[100:103], v[160:175]
    v_mfma_f32_32x32x16_bf16 v[160:175], v[216:219], v[104:107], v[160:175]
    v_mfma_f32_32x32x16_bf16 v[160:175], v[220:223], v[108:111], v[160:175]
    v_mfma_f32_32x32x16_bf16 v[160:175], v[224:227], v[112:115], v[160:175]
    v_mfma_f32_32x32x16_bf16 v[160:175], v[228:231], v[116:119], v[160:175]
    v_mfma_f32_32x32x16_bf16 v[160:175], v[232:235], v[120:123], v[160:175]
    v_mfma_f32_32x32x16_bf16 v[160:175], v[236:239], v[124:127], v[160:175]
    s_nop 11
    v_add_f32_dpp v128, v160, v128 row_shr:8 row_mask:0xf bank_mask:0xf bound_ctrl:0
    v_add_f32_dpp v129, v161, v129 row_shr:8 row_mask:0xf bank_mask:0xf bound_ctrl:0
    v_add_f32_dpp v130, v162, v130 row_shr:8 row_mask:0xf bank_mask:0xf bound_ctrl:0
    v_add_f32_dpp v131, v163, v131 row_shr:8 row_mask:0xf bank_mask:0xf bound_ctrl:0
    v_add_f32_dpp v132, v164, v132 row_shr:8 row_mask:0xf bank_mask:0xf bound_ctrl:0
    v_add_f32_dpp v133, v165, v133 row_shr:8 row_mask:0xf bank_mask:0xf bound_ctrl:0
    v_add_f32_dpp v134, v166, v134 row_shr:8 row_mask:0xf bank_mask:0xf bound_ctrl:0
    v_add_f32_dpp v135, v167, v135 row_shr:8 row_mask:0xf bank_mask:0xf bound_ctrl:0
    v_add_f32_dpp v136, v168, v136 row_shr:8 row_mask:0xf bank_mask:0xf bound_ctrl:0
    v_add_f32_dpp v137, v169, v137 row_shr:8 row_mask:0xf bank_mask:0xf bound_ctrl:0
    v_add_f32_dpp v138, v170, v138 row_shr:8 row_mask:0xf bank_mask:0xf bound_ctrl:0
    v_add_f32_dpp v139, v171, v139 row_shr:8 row_mask:0xf bank_mask:0xf bound_ctrl:0
    v_add_f32_dpp v140, v172, v140 row_shr:8 row_mask:0xf bank_mask:0xf bound_ctrl:0
    v_add_f32_dpp v141, v173, v141 row_shr:8 row_mask:0xf bank_mask:0xf bound_ctrl:0
    v_add_f32_dpp v142, v174, v142 row_shr:8 row_mask:0xf bank_mask:0xf bound_ctrl:0
    v_add_f32_dpp v143, v175, v143 row_shr:8 row_mask:0xf bank_mask:0xf bound_ctrl:0
    s_mov_b32 s42, 0xff00ff00
    s_mov_b32 s43, 0xff00ff00
    s_mov_b64 exec, s[42:43]
    v_add_f32 v144, v160, v144
    v_add_f32 v145, v161, v145
    v_add_f32 v146, v162, v146
    v_add_f32 v147, v163, v147
    v_add_f32 v148, v164, v148
    v_add_f32 v149, v165, v149
    v_add_f32 v150, v166, v150
    v_add_f32 v151, v167, v151
    v_add_f32 v152, v168, v152
    v_add_f32 v153, v169, v153
    v_add_f32 v154, v170, v154
    v_add_f32 v155, v171, v155
    v_add_f32 v156, v172, v156
    v_add_f32 v157, v173, v157
    v_add_f32 v158, v174, v158
    v_add_f32 v159, v175, v159
    s_mov_b64 exec, -1
    v_mul_u32_u24 v16, 264, v7
    v_lshl_add_u32 v16, v9, 5, v16
    v_lshl_add_u32 v16, v8, 2, v16
    v_add_u32 v16, s34, v16
    v_cvt_pk_bf16_f32 v32, v128, v144
    v_cvt_pk_bf16_f32 v33, v129, v145
    v_cvt_pk_bf16_f32 v34, v130, v146
    v_cvt_pk_bf16_f32 v35, v131, v147
    v_cvt_pk_bf16_f32 v36, v132, v148
    v_cvt_pk_bf16_f32 v37, v133, v149
    v_cvt_pk_bf16_f32 v38, v134, v150
    v_cvt_pk_bf16_f32 v39, v135, v151
    v_cvt_pk_bf16_f32 v40, v136, v152
    v_cvt_pk_bf16_f32 v41, v137, v153
    v_cvt_pk_bf16_f32 v42, v138, v154
    v_cvt_pk_bf16_f32 v43, v139, v155
    v_cvt_pk_bf16_f32 v44, v140, v156
    v_cvt_pk_bf16_f32 v45, v141, v157
    v_cvt_pk_bf16_f32 v46, v142, v158
    v_cvt_pk_bf16_f32 v47, v143, v159
    ds_write_b32 v16, v32 offset:0
    ds_write_b32 v16, v33 offset:8
    ds_write_b32 v16, v34 offset:16
    ds_write_b32 v16, v35 offset:24
    ds_write_b32 v16, v36 offset:64
    ds_write_b32 v16, v37 offset:72
    ds_write_b32 v16, v38 offset:80
    ds_write_b32 v16, v39 offset:88
    ds_write_b32 v16, v40 offset:128
    ds_write_b32 v16, v41 offset:136
    ds_write_b32 v16, v42 offset:144
    ds_write_b32 v16, v43 offset:152
    ds_write_b32 v16, v44 offset:192
    ds_write_b32 v16, v45 offset:200
    ds_write_b32 v16, v46 offset:208
    ds_write_b32 v16, v47 offset:216
    s_lshl_b32 s44, s32, 16
    s_and_b32 s45, s32, 0xffff0000
    s_lshl_b32 s46, s33, 16
    s_and_b32 s47, s33, 0xffff0000
    v_mul_u32_u24 v17, 264, v2
    v_lshl_add_u32 v17, v1, 2, v17
    s_waitcnt lgkmcnt(0)
    s_barrier
    ds_read_b32 v48, v17 offset:0
    ds_read_b32 v49, v17 offset:9472
    ds_read_b32 v50, v17 offset:18944
    ds_read_b32 v51, v17 offset:28416
    ds_read_b32 v52, v17 offset:1056
    ds_read_b32 v53, v17 offset:10528
    ds_read_b32 v54, v17 offset:20000
    ds_read_b32 v55, v17 offset:29472
    ds_read_b32 v56, v17 offset:2112
    ds_read_b32 v57, v17 offset:11584
    ds_read_b32 v58, v17 offset:21056
    ds_read_b32 v59, v17 offset:30528
    ds_read_b32 v60, v17 offset:3168
    ds_read_b32 v61, v17 offset:12640
    ds_read_b32 v62, v17 offset:22112
    ds_read_b32 v63, v17 offset:31584
    s_waitcnt vmcnt(0) lgkmcnt(0)
    v_mov_b32 v28, s44
    v_mov_b32 v29, s45
    v_mov_b32 v30, s46
    v_mov_b32 v31, s47
    v_lshlrev_b32 v18, 4, v0
    v_add_u32 v18, 37888, v18
    ds_read_b128 v[176:179], v18 offset:0
    ds_read_b128 v[144:147], v18 offset:16384
    ds_read_b128 v[180:183], v18 offset:4096
    ds_read_b128 v[148:151], v18 offset:20480
    ds_read_b128 v[184:187], v18 offset:8192
    ds_read_b128 v[152:155], v18 offset:24576
    ds_read_b128 v[188:191], v18 offset:12288
    ds_read_b128 v[156:159], v18 offset:28672
    v_mov_b32 v160, s64
    v_mov_b32 v164, s64
    v_mov_b32 v161, s65
    v_mov_b32 v165, s65
    v_mov_b32 v162, s66
    v_mov_b32 v166, s66
    v_mov_b32 v163, s67
    v_mov_b32 v167, s67
    v_mul_f32 v160, s60, v160
    v_mul_f32 v164, s56, v164
    v_mul_f32 v161, s61, v161
    v_mul_f32 v165, s57, v165
    v_mul_f32 v162, s62, v162
    v_mul_f32 v166, s58, v166
    v_mul_f32 v163, s63, v163
    v_mul_f32 v167, s59, v167
    s_waitcnt lgkmcnt(0)
    v_lshlrev_b32 v64, 16, v240
    v_and_b32 v65, 0xffff0000, v240
    v_pk_mul_f32 v[64:65], v[64:65], v[28:29]
    v_cvt_pk_bf16_f32 v72, v64, v65
    v_lshlrev_b32 v64, 16, v72
    v_and_b32 v65, 0xffff0000, v72
    v_lshlrev_b32 v66, 16, v241
    v_and_b32 v67, 0xffff0000, v241
    v_pk_mul_f32 v[66:67], v[66:67], v[30:31]
    v_cvt_pk_bf16_f32 v72, v66, v67
    v_lshlrev_b32 v66, 16, v72
    v_and_b32 v67, 0xffff0000, v72
    v_lshlrev_b32 v68, 16, v242
    v_and_b32 v69, 0xffff0000, v242
    v_pk_mul_f32 v[68:69], v[68:69], v[28:29]
    v_cvt_pk_bf16_f32 v72, v68, v69
    v_lshlrev_b32 v68, 16, v72
    v_and_b32 v69, 0xffff0000, v72
    v_lshlrev_b32 v70, 16, v243
    v_and_b32 v71, 0xffff0000, v243
    v_pk_mul_f32 v[70:71], v[70:71], v[30:31]
    v_cvt_pk_bf16_f32 v72, v70, v71
    v_lshlrev_b32 v70, 16, v72
    v_and_b32 v71, 0xffff0000, v72
    v_lshlrev_b32 v74, 16, v48
    v_and_b32 v78, 0xffff0000, v48
    v_lshlrev_b32 v75, 16, v49
    v_and_b32 v79, 0xffff0000, v49
    v_lshlrev_b32 v76, 16, v50
    v_and_b32 v80, 0xffff0000, v50
    v_lshlrev_b32 v77, 16, v51
    v_and_b32 v81, 0xffff0000, v51
    v_lshlrev_b32 v112, 16, v176
    v_and_b32 v113, 0xffff0000, v176
    v_lshlrev_b32 v114, 16, v177
    v_and_b32 v115, 0xffff0000, v177
    v_lshlrev_b32 v116, 16, v178
    v_and_b32 v117, 0xffff0000, v178
    v_lshlrev_b32 v118, 16, v179
    v_and_b32 v119, 0xffff0000, v179
    v_pk_add_f32 v[64:65], v[64:65], v[74:75]
    v_pk_add_f32 v[66:67], v[66:67], v[76:77]
    v_pk_add_f32 v[68:69], v[68:69], v[78:79]
    v_pk_add_f32 v[70:71], v[70:71], v[80:81]
    v_pk_fma_f32 v[120:121], v[112:113], v[144:145], v[144:145] op_sel:[0,1,0] op_sel_hi:[1,1,0]
    v_pk_fma_f32 v[122:123], v[114:115], v[144:145], v[144:145] op_sel:[0,1,0] op_sel_hi:[1,1,0]
    v_pk_fma_f32 v[124:125], v[116:117], v[146:147], v[146:147] op_sel:[0,1,0] op_sel_hi:[1,1,0]
    v_pk_fma_f32 v[126:127], v[118:119], v[146:147], v[146:147] op_sel:[0,1,0] op_sel_hi:[1,1,0]
    v_pk_fma_f32 v[120:121], v[120:121], v[160:161], v[164:165]
    v_pk_fma_f32 v[122:123], v[122:123], v[162:163], v[166:167]
    v_pk_fma_f32 v[124:125], v[124:125], v[160:161], v[164:165]
    v_pk_fma_f32 v[126:127], v[126:127], v[162:163], v[166:167]
    v_pk_fma_f32 v[64:65], v[64:65], v[120:121], v[112:113]
    v_pk_fma_f32 v[66:67], v[66:67], v[122:123], v[114:115]
    v_pk_fma_f32 v[68:69], v[68:69], v[124:125], v[116:117]
    v_pk_fma_f32 v[70:71], v[70:71], v[126:127], v[118:119]
    v_cvt_pk_bf16_f32 v96, v64, v65
    v_cvt_pk_bf16_f32 v97, v66, v67
    v_cvt_pk_bf16_f32 v98, v68, v69
    v_cvt_pk_bf16_f32 v99, v70, v71
    v_lshlrev_b32 v64, 16, v244
    v_and_b32 v65, 0xffff0000, v244
    v_pk_mul_f32 v[64:65], v[64:65], v[28:29]
    v_cvt_pk_bf16_f32 v72, v64, v65
    v_lshlrev_b32 v64, 16, v72
    v_and_b32 v65, 0xffff0000, v72
    v_lshlrev_b32 v66, 16, v245
    v_and_b32 v67, 0xffff0000, v245
    v_pk_mul_f32 v[66:67], v[66:67], v[30:31]
    v_cvt_pk_bf16_f32 v72, v66, v67
    v_lshlrev_b32 v66, 16, v72
    v_and_b32 v67, 0xffff0000, v72
    v_lshlrev_b32 v68, 16, v246
    v_and_b32 v69, 0xffff0000, v246
    v_pk_mul_f32 v[68:69], v[68:69], v[28:29]
    v_cvt_pk_bf16_f32 v72, v68, v69
    v_lshlrev_b32 v68, 16, v72
    v_and_b32 v69, 0xffff0000, v72
    v_lshlrev_b32 v70, 16, v247
    v_and_b32 v71, 0xffff0000, v247
    v_pk_mul_f32 v[70:71], v[70:71], v[30:31]
    v_cvt_pk_bf16_f32 v72, v70, v71
    v_lshlrev_b32 v70, 16, v72
    v_and_b32 v71, 0xffff0000, v72
    v_lshlrev_b32 v74, 16, v52
    v_and_b32 v78, 0xffff0000, v52
    v_lshlrev_b32 v75, 16, v53
    v_and_b32 v79, 0xffff0000, v53
    v_lshlrev_b32 v76, 16, v54
    v_and_b32 v80, 0xffff0000, v54
    v_lshlrev_b32 v77, 16, v55
    v_and_b32 v81, 0xffff0000, v55
    v_lshlrev_b32 v112, 16, v180
    v_and_b32 v113, 0xffff0000, v180
    v_lshlrev_b32 v114, 16, v181
    v_and_b32 v115, 0xffff0000, v181
    v_lshlrev_b32 v116, 16, v182
    v_and_b32 v117, 0xffff0000, v182
    v_lshlrev_b32 v118, 16, v183
    v_and_b32 v119, 0xffff0000, v183
    v_pk_add_f32 v[64:65], v[64:65], v[74:75]
    v_pk_add_f32 v[66:67], v[66:67], v[76:77]
    v_pk_add_f32 v[68:69], v[68:69], v[78:79]
    v_pk_add_f32 v[70:71], v[70:71], v[80:81]
    v_pk_fma_f32 v[120:121], v[112:113], v[148:149], v[148:149] op_sel:[0,1,0] op_sel_hi:[1,1,0]
    v_pk_fma_f32 v[122:123], v[114:115], v[148:149], v[148:149] op_sel:[0,1,0] op_sel_hi:[1,1,0]
    v_pk_fma_f32 v[124:125], v[116:117], v[150:151], v[150:151] op_sel:[0,1,0] op_sel_hi:[1,1,0]
    v_pk_fma_f32 v[126:127], v[118:119], v[150:151], v[150:151] op_sel:[0,1,0] op_sel_hi:[1,1,0]
    v_pk_fma_f32 v[120:121], v[120:121], v[160:161], v[164:165]
    v_pk_fma_f32 v[122:123], v[122:123], v[162:163], v[166:167]
    v_pk_fma_f32 v[124:125], v[124:125], v[160:161], v[164:165]
    v_pk_fma_f32 v[126:127], v[126:127], v[162:163], v[166:167]
    v_pk_fma_f32 v[64:65], v[64:65], v[120:121], v[112:113]
    v_pk_fma_f32 v[66:67], v[66:67], v[122:123], v[114:115]
    v_pk_fma_f32 v[68:69], v[68:69], v[124:125], v[116:117]
    v_pk_fma_f32 v[70:71], v[70:71], v[126:127], v[118:119]
    v_cvt_pk_bf16_f32 v100, v64, v65
    v_cvt_pk_bf16_f32 v101, v66, v67
    v_cvt_pk_bf16_f32 v102, v68, v69
    v_cvt_pk_bf16_f32 v103, v70, v71
    v_lshlrev_b32 v64, 16, v248
    v_and_b32 v65, 0xffff0000, v248
    v_pk_mul_f32 v[64:65], v[64:65], v[28:29]
    v_cvt_pk_bf16_f32 v72, v64, v65
    v_lshlrev_b32 v64, 16, v72
    v_and_b32 v65, 0xffff0000, v72
    v_lshlrev_b32 v66, 16, v249
    v_and_b32 v67, 0xffff0000, v249
    v_pk_mul_f32 v[66:67], v[66:67], v[30:31]
    v_cvt_pk_bf16_f32 v72, v66, v67
    v_lshlrev_b32 v66, 16, v72
    v_and_b32 v67, 0xffff0000, v72
    v_lshlrev_b32 v68, 16, v250
    v_and_b32 v69, 0xffff0000, v250
    v_pk_mul_f32 v[68:69], v[68:69], v[28:29]
    v_cvt_pk_bf16_f32 v72, v68, v69
    v_lshlrev_b32 v68, 16, v72
    v_and_b32 v69, 0xffff0000, v72
    v_lshlrev_b32 v70, 16, v251
    v_and_b32 v71, 0xffff0000, v251
    v_pk_mul_f32 v[70:71], v[70:71], v[30:31]
    v_cvt_pk_bf16_f32 v72, v70, v71
    v_lshlrev_b32 v70, 16, v72
    v_and_b32 v71, 0xffff0000, v72
    v_lshlrev_b32 v74, 16, v56
    v_and_b32 v78, 0xffff0000, v56
    v_lshlrev_b32 v75, 16, v57
    v_and_b32 v79, 0xffff0000, v57
    v_lshlrev_b32 v76, 16, v58
    v_and_b32 v80, 0xffff0000, v58
    v_lshlrev_b32 v77, 16, v59
    v_and_b32 v81, 0xffff0000, v59
    v_lshlrev_b32 v112, 16, v184
    v_and_b32 v113, 0xffff0000, v184
    v_lshlrev_b32 v114, 16, v185
    v_and_b32 v115, 0xffff0000, v185
    v_lshlrev_b32 v116, 16, v186
    v_and_b32 v117, 0xffff0000, v186
    v_lshlrev_b32 v118, 16, v187
    v_and_b32 v119, 0xffff0000, v187
    v_pk_add_f32 v[64:65], v[64:65], v[74:75]
    v_pk_add_f32 v[66:67], v[66:67], v[76:77]
    v_pk_add_f32 v[68:69], v[68:69], v[78:79]
    v_pk_add_f32 v[70:71], v[70:71], v[80:81]
    v_pk_fma_f32 v[120:121], v[112:113], v[152:153], v[152:153] op_sel:[0,1,0] op_sel_hi:[1,1,0]
    v_pk_fma_f32 v[122:123], v[114:115], v[152:153], v[152:153] op_sel:[0,1,0] op_sel_hi:[1,1,0]
    v_pk_fma_f32 v[124:125], v[116:117], v[154:155], v[154:155] op_sel:[0,1,0] op_sel_hi:[1,1,0]
    v_pk_fma_f32 v[126:127], v[118:119], v[154:155], v[154:155] op_sel:[0,1,0] op_sel_hi:[1,1,0]
    v_pk_fma_f32 v[120:121], v[120:121], v[160:161], v[164:165]
    v_pk_fma_f32 v[122:123], v[122:123], v[162:163], v[166:167]
    v_pk_fma_f32 v[124:125], v[124:125], v[160:161], v[164:165]
    v_pk_fma_f32 v[126:127], v[126:127], v[162:163], v[166:167]
    v_pk_fma_f32 v[64:65], v[64:65], v[120:121], v[112:113]
    v_pk_fma_f32 v[66:67], v[66:67], v[122:123], v[114:115]
    v_pk_fma_f32 v[68:69], v[68:69], v[124:125], v[116:117]
    v_pk_fma_f32 v[70:71], v[70:71], v[126:127], v[118:119]
    v_cvt_pk_bf16_f32 v104, v64, v65
    v_cvt_pk_bf16_f32 v105, v66, v67
    v_cvt_pk_bf16_f32 v106, v68, v69
    v_cvt_pk_bf16_f32 v107, v70, v71
    v_lshlrev_b32 v64, 16, v252
    v_and_b32 v65, 0xffff0000, v252
    v_pk_mul_f32 v[64:65], v[64:65], v[28:29]
    v_cvt_pk_bf16_f32 v72, v64, v65
    v_lshlrev_b32 v64, 16, v72
    v_and_b32 v65, 0xffff0000, v72
    v_lshlrev_b32 v66, 16, v253
    v_and_b32 v67, 0xffff0000, v253
    v_pk_mul_f32 v[66:67], v[66:67], v[30:31]
    v_cvt_pk_bf16_f32 v72, v66, v67
    v_lshlrev_b32 v66, 16, v72
    v_and_b32 v67, 0xffff0000, v72
    v_lshlrev_b32 v68, 16, v254
    v_and_b32 v69, 0xffff0000, v254
    v_pk_mul_f32 v[68:69], v[68:69], v[28:29]
    v_cvt_pk_bf16_f32 v72, v68, v69
    v_lshlrev_b32 v68, 16, v72
    v_and_b32 v69, 0xffff0000, v72
    v_lshlrev_b32 v70, 16, v255
    v_and_b32 v71, 0xffff0000, v255
    v_pk_mul_f32 v[70:71], v[70:71], v[30:31]
    v_cvt_pk_bf16_f32 v72, v70, v71
    v_lshlrev_b32 v70, 16, v72
    v_and_b32 v71, 0xffff0000, v72
    v_lshlrev_b32 v74, 16, v60
    v_and_b32 v78, 0xffff0000, v60
    v_lshlrev_b32 v75, 16, v61
    v_and_b32 v79, 0xffff0000, v61
    v_lshlrev_b32 v76, 16, v62
    v_and_b32 v80, 0xffff0000, v62
    v_lshlrev_b32 v77, 16, v63
    v_and_b32 v81, 0xffff0000, v63
    v_lshlrev_b32 v112, 16, v188
    v_and_b32 v113, 0xffff0000, v188
    v_lshlrev_b32 v114, 16, v189
    v_and_b32 v115, 0xffff0000, v189
    v_lshlrev_b32 v116, 16, v190
    v_and_b32 v117, 0xffff0000, v190
    v_lshlrev_b32 v118, 16, v191
    v_and_b32 v119, 0xffff0000, v191
    v_pk_add_f32 v[64:65], v[64:65], v[74:75]
    v_pk_add_f32 v[66:67], v[66:67], v[76:77]
    v_pk_add_f32 v[68:69], v[68:69], v[78:79]
    v_pk_add_f32 v[70:71], v[70:71], v[80:81]
    v_pk_fma_f32 v[120:121], v[112:113], v[156:157], v[156:157] op_sel:[0,1,0] op_sel_hi:[1,1,0]
    v_pk_fma_f32 v[122:123], v[114:115], v[156:157], v[156:157] op_sel:[0,1,0] op_sel_hi:[1,1,0]
    v_pk_fma_f32 v[124:125], v[116:117], v[158:159], v[158:159] op_sel:[0,1,0] op_sel_hi:[1,1,0]
    v_pk_fma_f32 v[126:127], v[118:119], v[158:159], v[158:159] op_sel:[0,1,0] op_sel_hi:[1,1,0]
    v_pk_fma_f32 v[120:121], v[120:121], v[160:161], v[164:165]
    v_pk_fma_f32 v[122:123], v[122:123], v[162:163], v[166:167]
    v_pk_fma_f32 v[124:125], v[124:125], v[160:161], v[164:165]
    v_pk_fma_f32 v[126:127], v[126:127], v[162:163], v[166:167]
    v_pk_fma_f32 v[64:65], v[64:65], v[120:121], v[112:113]
    v_pk_fma_f32 v[66:67], v[66:67], v[122:123], v[114:115]
    v_pk_fma_f32 v[68:69], v[68:69], v[124:125], v[116:117]
    v_pk_fma_f32 v[70:71], v[70:71], v[126:127], v[118:119]
    v_cvt_pk_bf16_f32 v108, v64, v65
    v_cvt_pk_bf16_f32 v109, v66, v67
    v_cvt_pk_bf16_f32 v110, v68, v69
    v_cvt_pk_bf16_f32 v111, v70, v71
    s_add_u32 s39, s38, 8052736
    buffer_store_dwordx4 v[96:99], v4, s[28:31], s39 offen sc1
    s_add_u32 s39, s39, 655360
    buffer_store_dwordx4 v[100:103], v4, s[28:31], s39 offen sc1
    s_add_u32 s39, s39, 655360
    buffer_store_dwordx4 v[104:107], v4, s[28:31], s39 offen sc1
    s_add_u32 s39, s39, 655360
    buffer_store_dwordx4 v[108:111], v4, s[28:31], s39 offen sc1
    s_add_u32 s39, s39, 655360
    s_waitcnt vmcnt(0)
    s_endpgm
k1_pack:
    s_sub_u32 s21, s2, 190
    v_lshrrev_b32 v3, 3, v0
    v_and_b32 v4, 7, v0
    v_mul_u32_u24 v5, 144, v3
    v_lshl_add_u32 v5, v4, 4, v5
    v_and_b32 v6, 15, v1
    v_lshrrev_b32 v7, 4, v1
    v_lshrrev_b32 v8, 2, v6
    v_lshl_add_u32 v8, v7, 3, v8
    v_mul_u32_u24 v8, 144, v8
    v_and_b32 v9, 3, v6
    v_lshl_add_u32 v8, v9, 3, v8
    s_lshl_b32 s22, s20, 5
    v_add_u32 v8, s22, v8
    v_lshlrev_b32 v9, 4, v1
    s_cmp_lt_u32 s21, 20
    s_cbranch_scc1 k1_kernel_pk1
    s_cmp_lt_u32 s21, 40
    s_cbranch_scc1 k1_kernel_pk2
    s_cmp_lt_u32 s21, 94
    s_cbranch_scc1 k1_kernel_pk3
    s_branch k1_kernel_pk4
k1_kernel_pk1:
    s_mov_b32 s24, s12
    s_mov_b32 s25, s13
    s_mov_b32 s26, 819200
    s_mov_b32 s27, 0x00020000
    s_sub_u32 s32, s21, 0
    s_mul_i32 s33, s32, 52429
    s_lshr_b32 s33, s33, 19
    s_mul_i32 s34, s33, 10
    s_sub_u32 s34, s32, s34
    v_mul_u32_u24 v10, 1280, v3
    v_lshl_add_u32 v10, v4, 4, v10
    s_mul_i32 s35, s33, 409600
    s_lshl_b32 s36, s34, 7
    s_add_u32 s35, s35, s36
    buffer_load_dwordx4 v[32:35], v10, s[24:27], s35 offen
    s_add_u32 s35, s35, 40960
    buffer_load_dwordx4 v[36:39], v10, s[24:27], s35 offen
    s_add_u32 s35, s35, 40960
    buffer_load_dwordx4 v[40:43], v10, s[24:27], s35 offen
    s_add_u32 s35, s35, 40960
    buffer_load_dwordx4 v[44:47], v10, s[24:27], s35 offen
    s_add_u32 s35, s35, 40960
    buffer_load_dwordx4 v[48:51], v10, s[24:27], s35 offen
    s_add_u32 s35, s35, 40960
    buffer_load_dwordx4 v[52:55], v10, s[24:27], s35 offen
    s_add_u32 s35, s35, 40960
    buffer_load_dwordx4 v[56:59], v10, s[24:27], s35 offen
    s_add_u32 s35, s35, 40960
    buffer_load_dwordx4 v[60:63], v10, s[24:27], s35 offen
    s_add_u32 s35, s35, 40960
    buffer_load_dwordx4 v[64:67], v10, s[24:27], s35 offen
    s_add_u32 s35, s35, 40960
    buffer_load_dwordx4 v[68:71], v10, s[24:27], s35 offen
    s_lshl_b32 s36, s34, 2
    s_add_u32 s36, s36, s20
    s_mul_i32 s38, s36, 6554
    s_lshr_b32 s38, s38, 16
    s_mul_i32 s39, s38, 10
    s_sub_u32 s39, s36, s39
    s_cmp_ge_u32 s39, 5
    s_cselect_b32 s40, 1, 0
    s_sub_u32 s41, s39, 6
    s_cmp_eq_u32 s39, 5
    s_cselect_b32 s41, 4, s41
    s_cmp_eq_u32 s40, 1
    s_cselect_b32 s39, s41, s39
    s_mul_i32 s37, s38, 200
    s_mul_i32 s40, s40, 100
    s_add_u32 s37, s37, s40
    s_mul_i32 s40, s33, 50
    s_add_u32 s37, s37, s40
    s_add_u32 s37, s37, s39
    s_lshl_b32 s37, s37, 10
    s_add_u32 s37, s37, 25796608
    s_movk_i32 s41, 5120
    s_waitcnt vmcnt(9)
    ds_write_b128 v5, v[32:35] offset:0
    s_waitcnt vmcnt(8)
    ds_write_b128 v5, v[36:39] offset:4608
    s_waitcnt vmcnt(7)
    ds_write_b128 v5, v[40:43] offset:9216
    s_waitcnt vmcnt(6)
    ds_write_b128 v5, v[44:47] offset:13824
    s_waitcnt vmcnt(5)
    ds_write_b128 v5, v[48:51] offset:18432
    s_waitcnt vmcnt(4)
    ds_write_b128 v5, v[52:55] offset:23040
    s_waitcnt vmcnt(3)
    ds_write_b128 v5, v[56:59] offset:27648
    s_waitcnt vmcnt(2)
    ds_write_b128 v5, v[60:63] offset:32256
    s_waitcnt vmcnt(1)
    ds_write_b128 v5, v[64:67] offset:36864
    s_waitcnt vmcnt(0)
    ds_write_b128 v5, v[68:71] offset:41472
    s_waitcnt lgkmcnt(0)
    s_barrier
    ds_read_b64_tr_b16 v[32:33], v8 offset:0
    ds_read_b64_tr_b16 v[34:35], v8 offset:576
    ds_read_b64_tr_b16 v[36:37], v8 offset:4608
    ds_read_b64_tr_b16 v[38:39], v8 offset:5184
    ds_read_b64_tr_b16 v[40:41], v8 offset:9216
    ds_read_b64_tr_b16 v[42:43], v8 offset:9792
    ds_read_b64_tr_b16 v[44:45], v8 offset:13824
    ds_read_b64_tr_b16 v[46:47], v8 offset:14400
    ds_read_b64_tr_b16 v[48:49], v8 offset:18432
    ds_read_b64_tr_b16 v[50:51], v8 offset:19008
    ds_read_b64_tr_b16 v[52:53], v8 offset:23040
    ds_read_b64_tr_b16 v[54:55], v8 offset:23616
    ds_read_b64_tr_b16 v[56:57], v8 offset:27648
    ds_read_b64_tr_b16 v[58:59], v8 offset:28224
    ds_read_b64_tr_b16 v[60:61], v8 offset:32256
    ds_read_b64_tr_b16 v[62:63], v8 offset:32832
    ds_read_b64_tr_b16 v[64:65], v8 offset:36864
    ds_read_b64_tr_b16 v[66:67], v8 offset:37440
    ds_read_b64_tr_b16 v[68:69], v8 offset:41472
    ds_read_b64_tr_b16 v[70:71], v8 offset:42048
    v_mov_b32 v12, 0
    v_mov_b32 v13, 0x3f803f80
    s_waitcnt lgkmcnt(15)
    buffer_store_dwordx4 v[32:35], v9, s[28:31], s37 offen sc1
    s_add_u32 s37, s37, s41
    v_dot2_f32_bf16 v12, v32, v13, v12
    v_dot2_f32_bf16 v12, v33, v13, v12
    v_dot2_f32_bf16 v12, v34, v13, v12
    v_dot2_f32_bf16 v12, v35, v13, v12
    s_waitcnt lgkmcnt(15)
    buffer_store_dwordx4 v[36:39], v9, s[28:31], s37 offen sc1
    s_add_u32 s37, s37, s41
    v_dot2_f32_bf16 v12, v36, v13, v12
    v_dot2_f32_bf16 v12, v37, v13, v12
    v_dot2_f32_bf16 v12, v38, v13, v12
    v_dot2_f32_bf16 v12, v39, v13, v12
    s_waitcnt lgkmcnt(14)
    buffer_store_dwordx4 v[40:43], v9, s[28:31], s37 offen sc1
    s_add_u32 s37, s37, s41
    v_dot2_f32_bf16 v12, v40, v13, v12
    v_dot2_f32_bf16 v12, v41, v13, v12
    v_dot2_f32_bf16 v12, v42, v13, v12
    v_dot2_f32_bf16 v12, v43, v13, v12
    s_waitcnt lgkmcnt(12)
    buffer_store_dwordx4 v[44:47], v9, s[28:31], s37 offen sc1
    s_add_u32 s37, s37, s41
    v_dot2_f32_bf16 v12, v44, v13, v12
    v_dot2_f32_bf16 v12, v45, v13, v12
    v_dot2_f32_bf16 v12, v46, v13, v12
    v_dot2_f32_bf16 v12, v47, v13, v12
    s_waitcnt lgkmcnt(10)
    buffer_store_dwordx4 v[48:51], v9, s[28:31], s37 offen sc1
    s_add_u32 s37, s37, s41
    v_dot2_f32_bf16 v12, v48, v13, v12
    v_dot2_f32_bf16 v12, v49, v13, v12
    v_dot2_f32_bf16 v12, v50, v13, v12
    v_dot2_f32_bf16 v12, v51, v13, v12
    s_waitcnt lgkmcnt(8)
    buffer_store_dwordx4 v[52:55], v9, s[28:31], s37 offen sc1
    s_add_u32 s37, s37, s41
    v_dot2_f32_bf16 v12, v52, v13, v12
    v_dot2_f32_bf16 v12, v53, v13, v12
    v_dot2_f32_bf16 v12, v54, v13, v12
    v_dot2_f32_bf16 v12, v55, v13, v12
    s_waitcnt lgkmcnt(6)
    buffer_store_dwordx4 v[56:59], v9, s[28:31], s37 offen sc1
    s_add_u32 s37, s37, s41
    v_dot2_f32_bf16 v12, v56, v13, v12
    v_dot2_f32_bf16 v12, v57, v13, v12
    v_dot2_f32_bf16 v12, v58, v13, v12
    v_dot2_f32_bf16 v12, v59, v13, v12
    s_waitcnt lgkmcnt(4)
    buffer_store_dwordx4 v[60:63], v9, s[28:31], s37 offen sc1
    s_add_u32 s37, s37, s41
    v_dot2_f32_bf16 v12, v60, v13, v12
    v_dot2_f32_bf16 v12, v61, v13, v12
    v_dot2_f32_bf16 v12, v62, v13, v12
    v_dot2_f32_bf16 v12, v63, v13, v12
    s_waitcnt lgkmcnt(2)
    buffer_store_dwordx4 v[64:67], v9, s[28:31], s37 offen sc1
    s_add_u32 s37, s37, s41
    v_dot2_f32_bf16 v12, v64, v13, v12
    v_dot2_f32_bf16 v12, v65, v13, v12
    v_dot2_f32_bf16 v12, v66, v13, v12
    v_dot2_f32_bf16 v12, v67, v13, v12
    s_waitcnt lgkmcnt(0)
    buffer_store_dwordx4 v[68:71], v9, s[28:31], s37 offen sc1
    s_add_u32 s37, s37, s41
    v_dot2_f32_bf16 v12, v68, v13, v12
    v_dot2_f32_bf16 v12, v69, v13, v12
    v_dot2_f32_bf16 v12, v70, v13, v12
    v_dot2_f32_bf16 v12, v71, v13, v12
    s_nop 2
    v_mov_b32 v13, v12
    s_nop 1
    v_permlane32_swap_b32 v13, v12
    v_add_f32 v12, v12, v13
    v_mov_b32 v13, v12
    s_nop 1
    v_permlane16_swap_b32 v13, v12
    v_add_f32 v12, v12, v13
    s_mul_i32 s38, s33, 7168
    s_lshl_b32 s39, s36, 6
    s_add_u32 s38, s38, s39
    s_add_u32 s38, s38, 10706944
    v_lshlrev_b32 v14, 2, v1
    v_cmp_gt_u32 vcc, 16, v1
    s_and_saveexec_b64 s[40:41], vcc
    buffer_store_dword v12, v14, s[28:31], s38 offen sc1
    s_endpgm
k1_kernel_pk2:
    s_mov_b32 s24, s14
    s_mov_b32 s25, s15
    s_mov_b32 s26, 819200
    s_mov_b32 s27, 0x00020000
    s_sub_u32 s32, s21, 20
    s_mul_i32 s33, s32, 52429
    s_lshr_b32 s33, s33, 19
    s_mul_i32 s34, s33, 10
    s_sub_u32 s34, s32, s34
    v_mul_u32_u24 v10, 1280, v3
    v_lshl_add_u32 v10, v4, 4, v10
    s_mul_i32 s35, s33, 409600
    s_lshl_b32 s36, s34, 7
    s_add_u32 s35, s35, s36
    buffer_load_dwordx4 v[32:35], v10, s[24:27], s35 offen
    s_add_u32 s35, s35, 40960
    buffer_load_dwordx4 v[36:39], v10, s[24:27], s35 offen
    s_add_u32 s35, s35, 40960
    buffer_load_dwordx4 v[40:43], v10, s[24:27], s35 offen
    s_add_u32 s35, s35, 40960
    buffer_load_dwordx4 v[44:47], v10, s[24:27], s35 offen
    s_add_u32 s35, s35, 40960
    buffer_load_dwordx4 v[48:51], v10, s[24:27], s35 offen
    s_add_u32 s35, s35, 40960
    buffer_load_dwordx4 v[52:55], v10, s[24:27], s35 offen
    s_add_u32 s35, s35, 40960
    buffer_load_dwordx4 v[56:59], v10, s[24:27], s35 offen
    s_add_u32 s35, s35, 40960
    buffer_load_dwordx4 v[60:63], v10, s[24:27], s35 offen
    s_add_u32 s35, s35, 40960
    buffer_load_dwordx4 v[64:67], v10, s[24:27], s35 offen
    s_add_u32 s35, s35, 40960
    buffer_load_dwordx4 v[68:71], v10, s[24:27], s35 offen
    s_lshl_b32 s36, s34, 2
    s_add_u32 s36, s36, s20
    s_mul_i32 s38, s36, 6554
    s_lshr_b32 s38, s38, 16
    s_mul_i32 s39, s38, 10
    s_sub_u32 s39, s36, s39
    s_cmp_ge_u32 s39, 5
    s_cselect_b32 s40, 1, 0
    s_sub_u32 s41, s39, 6
    s_cmp_eq_u32 s39, 5
    s_cselect_b32 s41, 4, s41
    s_cmp_eq_u32 s40, 1
    s_cselect_b32 s39, s41, s39
    s_mul_i32 s37, s38, 200
    s_mul_i32 s40, s40, 100
    s_add_u32 s37, s37, s40
    s_mul_i32 s40, s33, 50
    s_add_u32 s37, s37, s40
    s_add_u32 s37, s37, s39
    s_lshl_b32 s37, s37, 10
    s_add_u32 s37, s37, 26615808
    s_movk_i32 s41, 5120
    s_waitcnt vmcnt(9)
    ds_write_b128 v5, v[32:35] offset:0
    s_waitcnt vmcnt(8)
    ds_write_b128 v5, v[36:39] offset:4608
    s_waitcnt vmcnt(7)
    ds_write_b128 v5, v[40:43] offset:9216
    s_waitcnt vmcnt(6)
    ds_write_b128 v5, v[44:47] offset:13824
    s_waitcnt vmcnt(5)
    ds_write_b128 v5, v[48:51] offset:18432
    s_waitcnt vmcnt(4)
    ds_write_b128 v5, v[52:55] offset:23040
    s_waitcnt vmcnt(3)
    ds_write_b128 v5, v[56:59] offset:27648
    s_waitcnt vmcnt(2)
    ds_write_b128 v5, v[60:63] offset:32256
    s_waitcnt vmcnt(1)
    ds_write_b128 v5, v[64:67] offset:36864
    s_waitcnt vmcnt(0)
    ds_write_b128 v5, v[68:71] offset:41472
    s_waitcnt lgkmcnt(0)
    s_barrier
    ds_read_b64_tr_b16 v[32:33], v8 offset:0
    ds_read_b64_tr_b16 v[34:35], v8 offset:576
    ds_read_b64_tr_b16 v[36:37], v8 offset:4608
    ds_read_b64_tr_b16 v[38:39], v8 offset:5184
    ds_read_b64_tr_b16 v[40:41], v8 offset:9216
    ds_read_b64_tr_b16 v[42:43], v8 offset:9792
    ds_read_b64_tr_b16 v[44:45], v8 offset:13824
    ds_read_b64_tr_b16 v[46:47], v8 offset:14400
    ds_read_b64_tr_b16 v[48:49], v8 offset:18432
    ds_read_b64_tr_b16 v[50:51], v8 offset:19008
    ds_read_b64_tr_b16 v[52:53], v8 offset:23040
    ds_read_b64_tr_b16 v[54:55], v8 offset:23616
    ds_read_b64_tr_b16 v[56:57], v8 offset:27648
    ds_read_b64_tr_b16 v[58:59], v8 offset:28224
    ds_read_b64_tr_b16 v[60:61], v8 offset:32256
    ds_read_b64_tr_b16 v[62:63], v8 offset:32832
    ds_read_b64_tr_b16 v[64:65], v8 offset:36864
    ds_read_b64_tr_b16 v[66:67], v8 offset:37440
    ds_read_b64_tr_b16 v[68:69], v8 offset:41472
    ds_read_b64_tr_b16 v[70:71], v8 offset:42048
    s_waitcnt lgkmcnt(15)
    buffer_store_dwordx4 v[32:35], v9, s[28:31], s37 offen sc1
    s_add_u32 s37, s37, s41
    s_waitcnt lgkmcnt(15)
    buffer_store_dwordx4 v[36:39], v9, s[28:31], s37 offen sc1
    s_add_u32 s37, s37, s41
    s_waitcnt lgkmcnt(14)
    buffer_store_dwordx4 v[40:43], v9, s[28:31], s37 offen sc1
    s_add_u32 s37, s37, s41
    s_waitcnt lgkmcnt(12)
    buffer_store_dwordx4 v[44:47], v9, s[28:31], s37 offen sc1
    s_add_u32 s37, s37, s41
    s_waitcnt lgkmcnt(10)
    buffer_store_dwordx4 v[48:51], v9, s[28:31], s37 offen sc1
    s_add_u32 s37, s37, s41
    s_waitcnt lgkmcnt(8)
    buffer_store_dwordx4 v[52:55], v9, s[28:31], s37 offen sc1
    s_add_u32 s37, s37, s41
    s_waitcnt lgkmcnt(6)
    buffer_store_dwordx4 v[56:59], v9, s[28:31], s37 offen sc1
    s_add_u32 s37, s37, s41
    s_waitcnt lgkmcnt(4)
    buffer_store_dwordx4 v[60:63], v9, s[28:31], s37 offen sc1
    s_add_u32 s37, s37, s41
    s_waitcnt lgkmcnt(2)
    buffer_store_dwordx4 v[64:67], v9, s[28:31], s37 offen sc1
    s_add_u32 s37, s37, s41
    s_waitcnt lgkmcnt(0)
    buffer_store_dwordx4 v[68:71], v9, s[28:31], s37 offen sc1
    s_add_u32 s37, s37, s41
    s_endpgm
k1_kernel_pk3:
    s_mov_b32 s24, s16
    s_mov_b32 s25, s17
    s_mov_b32 s26, 2211840
    s_mov_b32 s27, 0x00020000
    s_sub_u32 s32, s21, 40
    s_mul_i32 s33, s32, 2428
    s_lshr_b32 s33, s33, 16
    s_mul_i32 s34, s33, 27
    s_sub_u32 s34, s32, s34
    v_mul_u32_u24 v10, 3456, v3
    v_lshl_add_u32 v10, v4, 4, v10
    s_mul_i32 s35, s33, 1105920
    s_lshl_b32 s36, s34, 7
    s_add_u32 s35, s35, s36
    buffer_load_dwordx4 v[32:35], v10, s[24:27], s35 offen
    s_add_u32 s35, s35, 110592
    buffer_load_dwordx4 v[36:39], v10, s[24:27], s35 offen
    s_add_u32 s35, s35, 110592
    buffer_load_dwordx4 v[40:43], v10, s[24:27], s35 offen
    s_add_u32 s35, s35, 110592
    buffer_load_dwordx4 v[44:47], v10, s[24:27], s35 offen
    s_add_u32 s35, s35, 110592
    buffer_load_dwordx4 v[48:51], v10, s[24:27], s35 offen
    s_add_u32 s35, s35, 110592
    buffer_load_dwordx4 v[52:55], v10, s[24:27], s35 offen
    s_add_u32 s35, s35, 110592
    buffer_load_dwordx4 v[56:59], v10, s[24:27], s35 offen
    s_add_u32 s35, s35, 110592
    buffer_load_dwordx4 v[60:63], v10, s[24:27], s35 offen
    s_add_u32 s35, s35, 110592
    buffer_load_dwordx4 v[64:67], v10, s[24:27], s35 offen
    s_add_u32 s35, s35, 110592
    buffer_load_dwordx4 v[68:71], v10, s[24:27], s35 offen
    s_lshl_b32 s36, s34, 2
    s_add_u32 s36, s36, s20
    s_mul_i32 s38, s36, 9363
    s_lshr_b32 s38, s38, 16
    s_mul_i32 s39, s38, 7
    s_sub_u32 s39, s36, s39
    s_add_u32 s40, s39, 6
    s_sub_u32 s41, s39, 1
    s_cmp_eq_u32 s39, 0
    s_cselect_b32 s41, 6, s41
    s_and_b32 s40, s38, 1
    s_cmp_eq_u32 s40, 1
    s_cselect_b32 s39, s41, s39
    s_mov_b32 s41, 4
    s_mov_b32 s40, s39
    s_cmp_ge_u32 s39, 4
    s_cselect_b32 s41, 2, s41
    s_add_u32 s42, s39, 76
    s_cmp_ge_u32 s39, 4
    s_cselect_b32 s40, s42, s40
    s_cmp_eq_u32 s39, 6
    s_cselect_b32 s41, 1, s41
    s_cselect_b32 s40, 120, s40
    s_mul_i32 s42, s33, 10
    s_mul_i32 s42, s42, s41
    s_add_u32 s40, s40, s42
    s_mul_i32 s37, s38, 140
    s_add_u32 s37, s37, s40
    s_lshl_b32 s37, s37, 10
    s_add_u32 s37, s37, 27435008
    s_lshl_b32 s41, s41, 10
    s_waitcnt vmcnt(9)
    ds_write_b128 v5, v[32:35] offset:0
    s_waitcnt vmcnt(8)
    ds_write_b128 v5, v[36:39] offset:4608
    s_waitcnt vmcnt(7)
    ds_write_b128 v5, v[40:43] offset:9216
    s_waitcnt vmcnt(6)
    ds_write_b128 v5, v[44:47] offset:13824
    s_waitcnt vmcnt(5)
    ds_write_b128 v5, v[48:51] offset:18432
    s_waitcnt vmcnt(4)
    ds_write_b128 v5, v[52:55] offset:23040
    s_waitcnt vmcnt(3)
    ds_write_b128 v5, v[56:59] offset:27648
    s_waitcnt vmcnt(2)
    ds_write_b128 v5, v[60:63] offset:32256
    s_waitcnt vmcnt(1)
    ds_write_b128 v5, v[64:67] offset:36864
    s_waitcnt vmcnt(0)
    ds_write_b128 v5, v[68:71] offset:41472
    s_waitcnt lgkmcnt(0)
    s_barrier
    ds_read_b64_tr_b16 v[32:33], v8 offset:0
    ds_read_b64_tr_b16 v[34:35], v8 offset:576
    ds_read_b64_tr_b16 v[36:37], v8 offset:4608
    ds_read_b64_tr_b16 v[38:39], v8 offset:5184
    ds_read_b64_tr_b16 v[40:41], v8 offset:9216
    ds_read_b64_tr_b16 v[42:43], v8 offset:9792
    ds_read_b64_tr_b16 v[44:45], v8 offset:13824
    ds_read_b64_tr_b16 v[46:47], v8 offset:14400
    ds_read_b64_tr_b16 v[48:49], v8 offset:18432
    ds_read_b64_tr_b16 v[50:51], v8 offset:19008
    ds_read_b64_tr_b16 v[52:53], v8 offset:23040
    ds_read_b64_tr_b16 v[54:55], v8 offset:23616
    ds_read_b64_tr_b16 v[56:57], v8 offset:27648
    ds_read_b64_tr_b16 v[58:59], v8 offset:28224
    ds_read_b64_tr_b16 v[60:61], v8 offset:32256
    ds_read_b64_tr_b16 v[62:63], v8 offset:32832
    ds_read_b64_tr_b16 v[64:65], v8 offset:36864
    ds_read_b64_tr_b16 v[66:67], v8 offset:37440
    ds_read_b64_tr_b16 v[68:69], v8 offset:41472
    ds_read_b64_tr_b16 v[70:71], v8 offset:42048
    v_mov_b32 v12, 0
    v_mov_b32 v13, 0x3f803f80
    s_waitcnt lgkmcnt(15)
    buffer_store_dwordx4 v[32:35], v9, s[28:31], s37 offen sc1
    s_add_u32 s37, s37, s41
    v_dot2_f32_bf16 v12, v32, v13, v12
    v_dot2_f32_bf16 v12, v33, v13, v12
    v_dot2_f32_bf16 v12, v34, v13, v12
    v_dot2_f32_bf16 v12, v35, v13, v12
    s_waitcnt lgkmcnt(15)
    buffer_store_dwordx4 v[36:39], v9, s[28:31], s37 offen sc1
    s_add_u32 s37, s37, s41
    v_dot2_f32_bf16 v12, v36, v13, v12
    v_dot2_f32_bf16 v12, v37, v13, v12
    v_dot2_f32_bf16 v12, v38, v13, v12
    v_dot2_f32_bf16 v12, v39, v13, v12
    s_waitcnt lgkmcnt(14)
    buffer_store_dwordx4 v[40:43], v9, s[28:31], s37 offen sc1
    s_add_u32 s37, s37, s41
    v_dot2_f32_bf16 v12, v40, v13, v12
    v_dot2_f32_bf16 v12, v41, v13, v12
    v_dot2_f32_bf16 v12, v42, v13, v12
    v_dot2_f32_bf16 v12, v43, v13, v12
    s_waitcnt lgkmcnt(12)
    buffer_store_dwordx4 v[44:47], v9, s[28:31], s37 offen sc1
    s_add_u32 s37, s37, s41
    v_dot2_f32_bf16 v12, v44, v13, v12
    v_dot2_f32_bf16 v12, v45, v13, v12
    v_dot2_f32_bf16 v12, v46, v13, v12
    v_dot2_f32_bf16 v12, v47, v13, v12
    s_waitcnt lgkmcnt(10)
    buffer_store_dwordx4 v[48:51], v9, s[28:31], s37 offen sc1
    s_add_u32 s37, s37, s41
    v_dot2_f32_bf16 v12, v48, v13, v12
    v_dot2_f32_bf16 v12, v49, v13, v12
    v_dot2_f32_bf16 v12, v50, v13, v12
    v_dot2_f32_bf16 v12, v51, v13, v12
    s_waitcnt lgkmcnt(8)
    buffer_store_dwordx4 v[52:55], v9, s[28:31], s37 offen sc1
    s_add_u32 s37, s37, s41
    v_dot2_f32_bf16 v12, v52, v13, v12
    v_dot2_f32_bf16 v12, v53, v13, v12
    v_dot2_f32_bf16 v12, v54, v13, v12
    v_dot2_f32_bf16 v12, v55, v13, v12
    s_waitcnt lgkmcnt(6)
    buffer_store_dwordx4 v[56:59], v9, s[28:31], s37 offen sc1
    s_add_u32 s37, s37, s41
    v_dot2_f32_bf16 v12, v56, v13, v12
    v_dot2_f32_bf16 v12, v57, v13, v12
    v_dot2_f32_bf16 v12, v58, v13, v12
    v_dot2_f32_bf16 v12, v59, v13, v12
    s_waitcnt lgkmcnt(4)
    buffer_store_dwordx4 v[60:63], v9, s[28:31], s37 offen sc1
    s_add_u32 s37, s37, s41
    v_dot2_f32_bf16 v12, v60, v13, v12
    v_dot2_f32_bf16 v12, v61, v13, v12
    v_dot2_f32_bf16 v12, v62, v13, v12
    v_dot2_f32_bf16 v12, v63, v13, v12
    s_waitcnt lgkmcnt(2)
    buffer_store_dwordx4 v[64:67], v9, s[28:31], s37 offen sc1
    s_add_u32 s37, s37, s41
    v_dot2_f32_bf16 v12, v64, v13, v12
    v_dot2_f32_bf16 v12, v65, v13, v12
    v_dot2_f32_bf16 v12, v66, v13, v12
    v_dot2_f32_bf16 v12, v67, v13, v12
    s_waitcnt lgkmcnt(0)
    buffer_store_dwordx4 v[68:71], v9, s[28:31], s37 offen sc1
    s_add_u32 s37, s37, s41
    v_dot2_f32_bf16 v12, v68, v13, v12
    v_dot2_f32_bf16 v12, v69, v13, v12
    v_dot2_f32_bf16 v12, v70, v13, v12
    v_dot2_f32_bf16 v12, v71, v13, v12
    s_nop 2
    v_mov_b32 v13, v12
    s_nop 1
    v_permlane32_swap_b32 v13, v12
    v_add_f32 v12, v12, v13
    v_mov_b32 v13, v12
    s_nop 1
    v_permlane16_swap_b32 v13, v12
    v_add_f32 v12, v12, v13
    s_mul_i32 s38, s33, 7168
    s_lshl_b32 s39, s36, 6
    s_add_u32 s38, s38, s39
    s_add_u32 s38, s38, 10690560
    v_lshlrev_b32 v14, 2, v1
    v_cmp_gt_u32 vcc, 16, v1
    s_and_saveexec_b64 s[40:41], vcc
    buffer_store_dword v12, v14, s[28:31], s38 offen sc1
    s_endpgm
k1_kernel_pk4:
    s_mov_b32 s24, s18
    s_mov_b32 s25, s19
    s_mov_b32 s26, 2211840
    s_mov_b32 s27, 0x00020000
    s_sub_u32 s32, s21, 94
    s_mul_i32 s33, s32, 52429
    s_lshr_b32 s33, s33, 19
    s_mul_i32 s34, s33, 10
    s_sub_u32 s34, s32, s34
    v_mul_u32_u24 v10, 1280, v3
    v_lshl_add_u32 v10, v4, 4, v10
    s_mul_i32 s35, s33, 368640
    s_lshl_b32 s36, s34, 7
    s_add_u32 s35, s35, s36
    buffer_load_dwordx4 v[32:35], v10, s[24:27], s35 offen
    s_add_u32 s35, s35, 40960
    buffer_load_dwordx4 v[36:39], v10, s[24:27], s35 offen
    s_add_u32 s35, s35, 40960
    buffer_load_dwordx4 v[40:43], v10, s[24:27], s35 offen
    s_add_u32 s35, s35, 40960
    buffer_load_dwordx4 v[44:47], v10, s[24:27], s35 offen
    s_add_u32 s35, s35, 40960
    buffer_load_dwordx4 v[48:51], v10, s[24:27], s35 offen
    s_add_u32 s35, s35, 40960
    buffer_load_dwordx4 v[52:55], v10, s[24:27], s35 offen
    s_add_u32 s35, s35, 40960
    buffer_load_dwordx4 v[56:59], v10, s[24:27], s35 offen
    s_add_u32 s35, s35, 40960
    buffer_load_dwordx4 v[60:63], v10, s[24:27], s35 offen
    s_add_u32 s35, s35, 40960
    buffer_load_dwordx4 v[64:67], v10, s[24:27], s35 offen
    s_lshl_b32 s36, s34, 2
    s_add_u32 s36, s36, s20
    s_mul_i32 s38, s36, 13108
    s_lshr_b32 s38, s38, 16
    s_mul_i32 s39, s38, 5
    s_sub_u32 s39, s36, s39
    s_sub_u32 s41, s39, 1
    s_cmp_eq_u32 s39, 0
    s_cselect_b32 s41, 4, s41
    s_and_b32 s40, s38, 1
    s_cmp_eq_u32 s40, 1
    s_cselect_b32 s39, s41, s39
    s_mul_i32 s40, s33, 21846
    s_lshr_b32 s40, s40, 16
    s_mul_i32 s41, s40, 3
    s_sub_u32 s41, s33, s41
    s_mul_i32 s37, s38, 270
    s_mul_i32 s41, s41, 90
    s_add_u32 s37, s37, s41
    s_mul_i32 s40, s40, 5
    s_add_u32 s37, s37, s40
    s_add_u32 s37, s37, s39
    s_lshl_b32 s37, s37, 10
    s_add_u32 s37, s37, 29728768
    s_movk_i32 s41, 10240
    s_waitcnt vmcnt(8)
    ds_write_b128 v5, v[32:35] offset:0
    s_waitcnt vmcnt(7)
    ds_write_b128 v5, v[36:39] offset:4608
    s_waitcnt vmcnt(6)
    ds_write_b128 v5, v[40:43] offset:9216
    s_waitcnt vmcnt(5)
    ds_write_b128 v5, v[44:47] offset:13824
    s_waitcnt vmcnt(4)
    ds_write_b128 v5, v[48:51] offset:18432
    s_waitcnt vmcnt(3)
    ds_write_b128 v5, v[52:55] offset:23040
    s_waitcnt vmcnt(2)
    ds_write_b128 v5, v[56:59] offset:27648
    s_waitcnt vmcnt(1)
    ds_write_b128 v5, v[60:63] offset:32256
    s_waitcnt vmcnt(0)
    ds_write_b128 v5, v[64:67] offset:36864
    s_waitcnt lgkmcnt(0)
    s_barrier
    ds_read_b64_tr_b16 v[32:33], v8 offset:0
    ds_read_b64_tr_b16 v[34:35], v8 offset:576
    ds_read_b64_tr_b16 v[36:37], v8 offset:4608
    ds_read_b64_tr_b16 v[38:39], v8 offset:5184
    ds_read_b64_tr_b16 v[40:41], v8 offset:9216
    ds_read_b64_tr_b16 v[42:43], v8 offset:9792
    ds_read_b64_tr_b16 v[44:45], v8 offset:13824
    ds_read_b64_tr_b16 v[46:47], v8 offset:14400
    ds_read_b64_tr_b16 v[48:49], v8 offset:18432
    ds_read_b64_tr_b16 v[50:51], v8 offset:19008
    ds_read_b64_tr_b16 v[52:53], v8 offset:23040
    ds_read_b64_tr_b16 v[54:55], v8 offset:23616
    ds_read_b64_tr_b16 v[56:57], v8 offset:27648
    ds_read_b64_tr_b16 v[58:59], v8 offset:28224
    ds_read_b64_tr_b16 v[60:61], v8 offset:32256
    ds_read_b64_tr_b16 v[62:63], v8 offset:32832
    ds_read_b64_tr_b16 v[64:65], v8 offset:36864
    ds_read_b64_tr_b16 v[66:67], v8 offset:37440
    s_waitcnt lgkmcnt(15)
    buffer_store_dwordx4 v[32:35], v9, s[28:31], s37 offen sc1
    s_add_u32 s37, s37, s41
    s_waitcnt lgkmcnt(14)
    buffer_store_dwordx4 v[36:39], v9, s[28:31], s37 offen sc1
    s_add_u32 s37, s37, s41
    s_waitcnt lgkmcnt(12)
    buffer_store_dwordx4 v[40:43], v9, s[28:31], s37 offen sc1
    s_add_u32 s37, s37, s41
    s_waitcnt lgkmcnt(10)
    buffer_store_dwordx4 v[44:47], v9, s[28:31], s37 offen sc1
    s_add_u32 s37, s37, s41
    s_waitcnt lgkmcnt(8)
    buffer_store_dwordx4 v[48:51], v9, s[28:31], s37 offen sc1
    s_add_u32 s37, s37, s41
    s_waitcnt lgkmcnt(6)
    buffer_store_dwordx4 v[52:55], v9, s[28:31], s37 offen sc1
    s_add_u32 s37, s37, s41
    s_waitcnt lgkmcnt(4)
    buffer_store_dwordx4 v[56:59], v9, s[28:31], s37 offen sc1
    s_add_u32 s37, s37, s41
    s_waitcnt lgkmcnt(2)
    buffer_store_dwordx4 v[60:63], v9, s[28:31], s37 offen sc1
    s_add_u32 s37, s37, s41
    s_waitcnt lgkmcnt(0)
    buffer_store_dwordx4 v[64:67], v9, s[28:31], s37 offen sc1
    s_add_u32 s37, s37, s41
    s_endpgm
k1_modf:
    s_load_dwordx4 s[12:15], s[0:1], 88
    s_load_dwordx2 s[10:11], s[0:1], 120
    s_sub_u32 s32, s2, 130
    v_and_b32 v3, 7, v0
    v_lshrrev_b32 v4, 3, v0
    v_lshlrev_b32 v5, 1, v4
    v_mul_u32_u24 v6, 7680, v4
    s_lshl_b32 s36, s32, 7
    v_lshl_add_u32 v7, v3, 4, s36
    v_add_u32 v6, v6, v7
    s_waitcnt lgkmcnt(0)
    s_mov_b32 s16, s12
    s_mov_b32 s17, s13
    s_mov_b32 s18, 1280
    s_mov_b32 s19, 0x00020000
    s_mov_b32 s20, s14
    s_mov_b32 s21, s15
    s_mov_b32 s22, 4915200
    s_mov_b32 s23, 0x00020000
    s_mov_b32 s28, s10
    s_mov_b32 s29, s11
    s_mov_b32 s30, 268435456
    s_mov_b32 s31, 0x00020000
    buffer_load_ushort v10, v5, s[16:19], 0 offen offset:0
    buffer_load_ushort v11, v5, s[16:19], 0 offen offset:64
    buffer_load_ushort v12, v5, s[16:19], 0 offen offset:128
    buffer_load_ushort v13, v5, s[16:19], 0 offen offset:192
    buffer_load_ushort v14, v5, s[16:19], 0 offen offset:256
    buffer_load_ushort v15, v5, s[16:19], 0 offen offset:320
    buffer_load_ushort v16, v5, s[16:19], 0 offen offset:384
    buffer_load_ushort v17, v5, s[16:19], 0 offen offset:448
    buffer_load_ushort v18, v5, s[16:19], 0 offen offset:512
    buffer_load_ushort v19, v5, s[16:19], 0 offen offset:576
    buffer_load_ushort v20, v5, s[16:19], 0 offen offset:640
    buffer_load_ushort v21, v5, s[16:19], 0 offen offset:704
    buffer_load_ushort v22, v5, s[16:19], 0 offen offset:768
    buffer_load_ushort v23, v5, s[16:19], 0 offen offset:832
    buffer_load_ushort v24, v5, s[16:19], 0 offen offset:896
    buffer_load_ushort v25, v5, s[16:19], 0 offen offset:960
    buffer_load_ushort v26, v5, s[16:19], 0 offen offset:1024
    buffer_load_ushort v27, v5, s[16:19], 0 offen offset:1088
    buffer_load_ushort v28, v5, s[16:19], 0 offen offset:1152
    buffer_load_ushort v29, v5, s[16:19], 0 offen offset:1216
    s_mov_b32 s37, 0
    buffer_load_dwordx4 v[32:35], v6, s[20:23], s37 offen
    s_mov_b32 s37, 245760
    buffer_load_dwordx4 v[36:39], v6, s[20:23], s37 offen
    s_mov_b32 s37, 491520
    buffer_load_dwordx4 v[40:43], v6, s[20:23], s37 offen
    s_mov_b32 s37, 737280
    buffer_load_dwordx4 v[44:47], v6, s[20:23], s37 offen
    s_mov_b32 s37, 983040
    buffer_load_dwordx4 v[48:51], v6, s[20:23], s37 offen
    s_mov_b32 s37, 1228800
    buffer_load_dwordx4 v[52:55], v6, s[20:23], s37 offen
    s_mov_b32 s37, 1474560
    buffer_load_dwordx4 v[56:59], v6, s[20:23], s37 offen
    s_mov_b32 s37, 1720320
    buffer_load_dwordx4 v[60:63], v6, s[20:23], s37 offen
    s_mov_b32 s37, 1966080
    buffer_load_dwordx4 v[64:67], v6, s[20:23], s37 offen
    s_mov_b32 s37, 2211840
    buffer_load_dwordx4 v[68:71], v6, s[20:23], s37 offen
    s_mov_b32 s37, 2457600
    buffer_load_dwordx4 v[72:75], v6, s[20:23], s37 offen
    s_mov_b32 s37, 2703360
    buffer_load_dwordx4 v[76:79], v6, s[20:23], s37 offen
    s_mov_b32 s37, 2949120
    buffer_load_dwordx4 v[80:83], v6, s[20:23], s37 offen
    s_mov_b32 s37, 3194880
    buffer_load_dwordx4 v[84:87], v6, s[20:23], s37 offen
    s_mov_b32 s37, 3440640
    buffer_load_dwordx4 v[88:91], v6, s[20:23], s37 offen
    s_mov_b32 s37, 3686400
    buffer_load_dwordx4 v[92:95], v6, s[20:23], s37 offen
    s_mov_b32 s37, 3932160
    buffer_load_dwordx4 v[96:99], v6, s[20:23], s37 offen
    s_mov_b32 s37, 4177920
    buffer_load_dwordx4 v[100:103], v6, s[20:23], s37 offen
    s_mov_b32 s37, 4423680
    buffer_load_dwordx4 v[104:107], v6, s[20:23], s37 offen
    s_mov_b32 s37, 4669440
    buffer_load_dwordx4 v[108:111], v6, s[20:23], s37 offen
    s_waitcnt vmcnt(20)
    v_lshlrev_b32 v10, 16, v10
    v_mul_f32 v120, 0xbfb8aa3b, v10
    v_exp_f32 v120, v120
    v_lshlrev_b32 v11, 16, v11
    v_mul_f32 v121, 0xbfb8aa3b, v11
    v_exp_f32 v121, v121
    v_lshlrev_b32 v12, 16, v12
    v_mul_f32 v122, 0xbfb8aa3b, v12
    v_exp_f32 v122, v122
    v_lshlrev_b32 v13, 16, v13
    v_mul_f32 v123, 0xbfb8aa3b, v13
    v_exp_f32 v123, v123
    v_lshlrev_b32 v14, 16, v14
    v_mul_f32 v124, 0xbfb8aa3b, v14
    v_exp_f32 v124, v124
    v_lshlrev_b32 v15, 16, v15
    v_mul_f32 v125, 0xbfb8aa3b, v15
    v_exp_f32 v125, v125
    v_lshlrev_b32 v16, 16, v16
    v_mul_f32 v126, 0xbfb8aa3b, v16
    v_exp_f32 v126, v126
    v_lshlrev_b32 v17, 16, v17
    v_mul_f32 v127, 0xbfb8aa3b, v17
    v_exp_f32 v127, v127
    v_lshlrev_b32 v18, 16, v18
    v_mul_f32 v128, 0xbfb8aa3b, v18
    v_exp_f32 v128, v128
    v_lshlrev_b32 v19, 16, v19
    v_mul_f32 v129, 0xbfb8aa3b, v19
    v_exp_f32 v129, v129
    v_lshlrev_b32 v20, 16, v20
    v_mul_f32 v130, 0xbfb8aa3b, v20
    v_exp_f32 v130, v130
    v_lshlrev_b32 v21, 16, v21
    v_mul_f32 v131, 0xbfb8aa3b, v21
    v_exp_f32 v131, v131
    v_lshlrev_b32 v22, 16, v22
    v_mul_f32 v132, 0xbfb8aa3b, v22
    v_exp_f32 v132, v132
    v_lshlrev_b32 v23, 16, v23
    v_mul_f32 v133, 0xbfb8aa3b, v23
    v_exp_f32 v133, v133
    v_lshlrev_b32 v24, 16, v24
    v_mul_f32 v134, 0xbfb8aa3b, v24
    v_exp_f32 v134, v134
    v_lshlrev_b32 v25, 16, v25
    v_mul_f32 v135, 0xbfb8aa3b, v25
    v_exp_f32 v135, v135
    v_lshlrev_b32 v26, 16, v26
    v_mul_f32 v136, 0xbfb8aa3b, v26
    v_exp_f32 v136, v136
    v_lshlrev_b32 v27, 16, v27
    v_mul_f32 v137, 0xbfb8aa3b, v27
    v_exp_f32 v137, v137
    v_lshlrev_b32 v28, 16, v28
    v_mul_f32 v138, 0xbfb8aa3b, v28
    v_exp_f32 v138, v138
    v_lshlrev_b32 v29, 16, v29
    v_mul_f32 v139, 0xbfb8aa3b, v29
    v_exp_f32 v139, v139
    v_add_f32 v120, 1.0, v120
    v_rcp_f32 v120, v120
    v_add_f32 v121, 1.0, v121
    v_rcp_f32 v121, v121
    v_add_f32 v122, 1.0, v122
    v_rcp_f32 v122, v122
    v_add_f32 v123, 1.0, v123
    v_rcp_f32 v123, v123
    v_add_f32 v124, 1.0, v124
    v_rcp_f32 v124, v124
    v_add_f32 v125, 1.0, v125
    v_rcp_f32 v125, v125
    v_add_f32 v126, 1.0, v126
    v_rcp_f32 v126, v126
    v_add_f32 v127, 1.0, v127
    v_rcp_f32 v127, v127
    v_add_f32 v128, 1.0, v128
    v_rcp_f32 v128, v128
    v_add_f32 v129, 1.0, v129
    v_rcp_f32 v129, v129
    v_add_f32 v130, 1.0, v130
    v_rcp_f32 v130, v130
    v_add_f32 v131, 1.0, v131
    v_rcp_f32 v131, v131
    v_add_f32 v132, 1.0, v132
    v_rcp_f32 v132, v132
    v_add_f32 v133, 1.0, v133
    v_rcp_f32 v133, v133
    v_add_f32 v134, 1.0, v134
    v_rcp_f32 v134, v134
    v_add_f32 v135, 1.0, v135
    v_rcp_f32 v135, v135
    v_add_f32 v136, 1.0, v136
    v_rcp_f32 v136, v136
    v_add_f32 v137, 1.0, v137
    v_rcp_f32 v137, v137
    v_add_f32 v138, 1.0, v138
    v_rcp_f32 v138, v138
    v_add_f32 v139, 1.0, v139
    v_rcp_f32 v139, v139
    s_nop 0
    v_mul_f32 v10, v10, v120
    v_mul_f32 v11, v11, v121
    v_mul_f32 v12, v12, v122
    v_mul_f32 v13, v13, v123
    v_mul_f32 v14, v14, v124
    v_mul_f32 v15, v15, v125
    v_mul_f32 v16, v16, v126
    v_mul_f32 v17, v17, v127
    v_mul_f32 v18, v18, v128
    v_mul_f32 v19, v19, v129
    v_mul_f32 v20, v20, v130
    v_mul_f32 v21, v21, v131
    v_mul_f32 v22, v22, v132
    v_mul_f32 v23, v23, v133
    v_mul_f32 v24, v24, v134
    v_mul_f32 v25, v25, v135
    v_mul_f32 v26, v26, v136
    v_mul_f32 v27, v27, v137
    v_mul_f32 v28, v28, v138
    v_mul_f32 v29, v29, v139
    v_cvt_pk_bf16_f32 v120, v10, v11
    v_lshlrev_b32 v10, 16, v120
    v_and_b32 v11, 0xffff0000, v120
    v_cvt_pk_bf16_f32 v120, v12, v13
    v_lshlrev_b32 v12, 16, v120
    v_and_b32 v13, 0xffff0000, v120
    v_cvt_pk_bf16_f32 v120, v14, v15
    v_lshlrev_b32 v14, 16, v120
    v_and_b32 v15, 0xffff0000, v120
    v_cvt_pk_bf16_f32 v120, v16, v17
    v_lshlrev_b32 v16, 16, v120
    v_and_b32 v17, 0xffff0000, v120
    v_cvt_pk_bf16_f32 v120, v18, v19
    v_lshlrev_b32 v18, 16, v120
    v_and_b32 v19, 0xffff0000, v120
    v_cvt_pk_bf16_f32 v120, v20, v21
    v_lshlrev_b32 v20, 16, v120
    v_and_b32 v21, 0xffff0000, v120
    v_cvt_pk_bf16_f32 v120, v22, v23
    v_lshlrev_b32 v22, 16, v120
    v_and_b32 v23, 0xffff0000, v120
    v_cvt_pk_bf16_f32 v120, v24, v25
    v_lshlrev_b32 v24, 16, v120
    v_and_b32 v25, 0xffff0000, v120
    v_cvt_pk_bf16_f32 v120, v26, v27
    v_lshlrev_b32 v26, 16, v120
    v_and_b32 v27, 0xffff0000, v120
    v_cvt_pk_bf16_f32 v120, v28, v29
    v_lshlrev_b32 v28, 16, v120
    v_and_b32 v29, 0xffff0000, v120
    v_mov_b32 v112, 0
    v_mov_b32 v113, 0
    v_mov_b32 v114, 0
    v_mov_b32 v115, 0
    v_mov_b32 v116, 0
    v_mov_b32 v117, 0
    v_mov_b32 v118, 0
    v_mov_b32 v119, 0
    s_waitcnt vmcnt(19)
    v_lshlrev_b32 v120, 16, v32
    v_and_b32 v121, 0xffff0000, v32
    v_fmac_f32 v112, v10, v120
    v_fmac_f32 v113, v10, v121
    v_lshlrev_b32 v120, 16, v33
    v_and_b32 v121, 0xffff0000, v33
    v_fmac_f32 v114, v10, v120
    v_fmac_f32 v115, v10, v121
    v_lshlrev_b32 v120, 16, v34
    v_and_b32 v121, 0xffff0000, v34
    v_fmac_f32 v116, v10, v120
    v_fmac_f32 v117, v10, v121
    v_lshlrev_b32 v120, 16, v35
    v_and_b32 v121, 0xffff0000, v35
    v_fmac_f32 v118, v10, v120
    v_fmac_f32 v119, v10, v121
    s_waitcnt vmcnt(18)
    v_lshlrev_b32 v120, 16, v36
    v_and_b32 v121, 0xffff0000, v36
    v_fmac_f32 v112, v11, v120
    v_fmac_f32 v113, v11, v121
    v_lshlrev_b32 v120, 16, v37
    v_and_b32 v121, 0xffff0000, v37
    v_fmac_f32 v114, v11, v120
    v_fmac_f32 v115, v11, v121
    v_lshlrev_b32 v120, 16, v38
    v_and_b32 v121, 0xffff0000, v38
    v_fmac_f32 v116, v11, v120
    v_fmac_f32 v117, v11, v121
    v_lshlrev_b32 v120, 16, v39
    v_and_b32 v121, 0xffff0000, v39
    v_fmac_f32 v118, v11, v120
    v_fmac_f32 v119, v11, v121
    s_waitcnt vmcnt(17)
    v_lshlrev_b32 v120, 16, v40
    v_and_b32 v121, 0xffff0000, v40
    v_fmac_f32 v112, v12, v120
    v_fmac_f32 v113, v12, v121
    v_lshlrev_b32 v120, 16, v41
    v_and_b32 v121, 0xffff0000, v41
    v_fmac_f32 v114, v12, v120
    v_fmac_f32 v115, v12, v121
    v_lshlrev_b32 v120, 16, v42
    v_and_b32 v121, 0xffff0000, v42
    v_fmac_f32 v116, v12, v120
    v_fmac_f32 v117, v12, v121
    v_lshlrev_b32 v120, 16, v43
    v_and_b32 v121, 0xffff0000, v43
    v_fmac_f32 v118, v12, v120
    v_fmac_f32 v119, v12, v121
    s_waitcnt vmcnt(16)
    v_lshlrev_b32 v120, 16, v44
    v_and_b32 v121, 0xffff0000, v44
    v_fmac_f32 v112, v13, v120
    v_fmac_f32 v113, v13, v121
    v_lshlrev_b32 v120, 16, v45
    v_and_b32 v121, 0xffff0000, v45
    v_fmac_f32 v114, v13, v120
    v_fmac_f32 v115, v13, v121
    v_lshlrev_b32 v120, 16, v46
    v_and_b32 v121, 0xffff0000, v46
    v_fmac_f32 v116, v13, v120
    v_fmac_f32 v117, v13, v121
    v_lshlrev_b32 v120, 16, v47
    v_and_b32 v121, 0xffff0000, v47
    v_fmac_f32 v118, v13, v120
    v_fmac_f32 v119, v13, v121
    s_waitcnt vmcnt(15)
    v_lshlrev_b32 v120, 16, v48
    v_and_b32 v121, 0xffff0000, v48
    v_fmac_f32 v112, v14, v120
    v_fmac_f32 v113, v14, v121
    v_lshlrev_b32 v120, 16, v49
    v_and_b32 v121, 0xffff0000, v49
    v_fmac_f32 v114, v14, v120
    v_fmac_f32 v115, v14, v121
    v_lshlrev_b32 v120, 16, v50
    v_and_b32 v121, 0xffff0000, v50
    v_fmac_f32 v116, v14, v120
    v_fmac_f32 v117, v14, v121
    v_lshlrev_b32 v120, 16, v51
    v_and_b32 v121, 0xffff0000, v51
    v_fmac_f32 v118, v14, v120
    v_fmac_f32 v119, v14, v121
    s_waitcnt vmcnt(14)
    v_lshlrev_b32 v120, 16, v52
    v_and_b32 v121, 0xffff0000, v52
    v_fmac_f32 v112, v15, v120
    v_fmac_f32 v113, v15, v121
    v_lshlrev_b32 v120, 16, v53
    v_and_b32 v121, 0xffff0000, v53
    v_fmac_f32 v114, v15, v120
    v_fmac_f32 v115, v15, v121
    v_lshlrev_b32 v120, 16, v54
    v_and_b32 v121, 0xffff0000, v54
    v_fmac_f32 v116, v15, v120
    v_fmac_f32 v117, v15, v121
    v_lshlrev_b32 v120, 16, v55
    v_and_b32 v121, 0xffff0000, v55
    v_fmac_f32 v118, v15, v120
    v_fmac_f32 v119, v15, v121
    s_waitcnt vmcnt(13)
    v_lshlrev_b32 v120, 16, v56
    v_and_b32 v121, 0xffff0000, v56
    v_fmac_f32 v112, v16, v120
    v_fmac_f32 v113, v16, v121
    v_lshlrev_b32 v120, 16, v57
    v_and_b32 v121, 0xffff0000, v57
    v_fmac_f32 v114, v16, v120
    v_fmac_f32 v115, v16, v121
    v_lshlrev_b32 v120, 16, v58
    v_and_b32 v121, 0xffff0000, v58
    v_fmac_f32 v116, v16, v120
    v_fmac_f32 v117, v16, v121
    v_lshlrev_b32 v120, 16, v59
    v_and_b32 v121, 0xffff0000, v59
    v_fmac_f32 v118, v16, v120
    v_fmac_f32 v119, v16, v121
    s_waitcnt vmcnt(12)
    v_lshlrev_b32 v120, 16, v60
    v_and_b32 v121, 0xffff0000, v60
    v_fmac_f32 v112, v17, v120
    v_fmac_f32 v113, v17, v121
    v_lshlrev_b32 v120, 16, v61
    v_and_b32 v121, 0xffff0000, v61
    v_fmac_f32 v114, v17, v120
    v_fmac_f32 v115, v17, v121
    v_lshlrev_b32 v120, 16, v62
    v_and_b32 v121, 0xffff0000, v62
    v_fmac_f32 v116, v17, v120
    v_fmac_f32 v117, v17, v121
    v_lshlrev_b32 v120, 16, v63
    v_and_b32 v121, 0xffff0000, v63
    v_fmac_f32 v118, v17, v120
    v_fmac_f32 v119, v17, v121
    s_waitcnt vmcnt(11)
    v_lshlrev_b32 v120, 16, v64
    v_and_b32 v121, 0xffff0000, v64
    v_fmac_f32 v112, v18, v120
    v_fmac_f32 v113, v18, v121
    v_lshlrev_b32 v120, 16, v65
    v_and_b32 v121, 0xffff0000, v65
    v_fmac_f32 v114, v18, v120
    v_fmac_f32 v115, v18, v121
    v_lshlrev_b32 v120, 16, v66
    v_and_b32 v121, 0xffff0000, v66
    v_fmac_f32 v116, v18, v120
    v_fmac_f32 v117, v18, v121
    v_lshlrev_b32 v120, 16, v67
    v_and_b32 v121, 0xffff0000, v67
    v_fmac_f32 v118, v18, v120
    v_fmac_f32 v119, v18, v121
    s_waitcnt vmcnt(10)
    v_lshlrev_b32 v120, 16, v68
    v_and_b32 v121, 0xffff0000, v68
    v_fmac_f32 v112, v19, v120
    v_fmac_f32 v113, v19, v121
    v_lshlrev_b32 v120, 16, v69
    v_and_b32 v121, 0xffff0000, v69
    v_fmac_f32 v114, v19, v120
    v_fmac_f32 v115, v19, v121
    v_lshlrev_b32 v120, 16, v70
    v_and_b32 v121, 0xffff0000, v70
    v_fmac_f32 v116, v19, v120
    v_fmac_f32 v117, v19, v121
    v_lshlrev_b32 v120, 16, v71
    v_and_b32 v121, 0xffff0000, v71
    v_fmac_f32 v118, v19, v120
    v_fmac_f32 v119, v19, v121
    s_waitcnt vmcnt(9)
    v_lshlrev_b32 v120, 16, v72
    v_and_b32 v121, 0xffff0000, v72
    v_fmac_f32 v112, v20, v120
    v_fmac_f32 v113, v20, v121
    v_lshlrev_b32 v120, 16, v73
    v_and_b32 v121, 0xffff0000, v73
    v_fmac_f32 v114, v20, v120
    v_fmac_f32 v115, v20, v121
    v_lshlrev_b32 v120, 16, v74
    v_and_b32 v121, 0xffff0000, v74
    v_fmac_f32 v116, v20, v120
    v_fmac_f32 v117, v20, v121
    v_lshlrev_b32 v120, 16, v75
    v_and_b32 v121, 0xffff0000, v75
    v_fmac_f32 v118, v20, v120
    v_fmac_f32 v119, v20, v121
    s_waitcnt vmcnt(8)
    v_lshlrev_b32 v120, 16, v76
    v_and_b32 v121, 0xffff0000, v76
    v_fmac_f32 v112, v21, v120
    v_fmac_f32 v113, v21, v121
    v_lshlrev_b32 v120, 16, v77
    v_and_b32 v121, 0xffff0000, v77
    v_fmac_f32 v114, v21, v120
    v_fmac_f32 v115, v21, v121
    v_lshlrev_b32 v120, 16, v78
    v_and_b32 v121, 0xffff0000, v78
    v_fmac_f32 v116, v21, v120
    v_fmac_f32 v117, v21, v121
    v_lshlrev_b32 v120, 16, v79
    v_and_b32 v121, 0xffff0000, v79
    v_fmac_f32 v118, v21, v120
    v_fmac_f32 v119, v21, v121
    s_waitcnt vmcnt(7)
    v_lshlrev_b32 v120, 16, v80
    v_and_b32 v121, 0xffff0000, v80
    v_fmac_f32 v112, v22, v120
    v_fmac_f32 v113, v22, v121
    v_lshlrev_b32 v120, 16, v81
    v_and_b32 v121, 0xffff0000, v81
    v_fmac_f32 v114, v22, v120
    v_fmac_f32 v115, v22, v121
    v_lshlrev_b32 v120, 16, v82
    v_and_b32 v121, 0xffff0000, v82
    v_fmac_f32 v116, v22, v120
    v_fmac_f32 v117, v22, v121
    v_lshlrev_b32 v120, 16, v83
    v_and_b32 v121, 0xffff0000, v83
    v_fmac_f32 v118, v22, v120
    v_fmac_f32 v119, v22, v121
    s_waitcnt vmcnt(6)
    v_lshlrev_b32 v120, 16, v84
    v_and_b32 v121, 0xffff0000, v84
    v_fmac_f32 v112, v23, v120
    v_fmac_f32 v113, v23, v121
    v_lshlrev_b32 v120, 16, v85
    v_and_b32 v121, 0xffff0000, v85
    v_fmac_f32 v114, v23, v120
    v_fmac_f32 v115, v23, v121
    v_lshlrev_b32 v120, 16, v86
    v_and_b32 v121, 0xffff0000, v86
    v_fmac_f32 v116, v23, v120
    v_fmac_f32 v117, v23, v121
    v_lshlrev_b32 v120, 16, v87
    v_and_b32 v121, 0xffff0000, v87
    v_fmac_f32 v118, v23, v120
    v_fmac_f32 v119, v23, v121
    s_waitcnt vmcnt(5)
    v_lshlrev_b32 v120, 16, v88
    v_and_b32 v121, 0xffff0000, v88
    v_fmac_f32 v112, v24, v120
    v_fmac_f32 v113, v24, v121
    v_lshlrev_b32 v120, 16, v89
    v_and_b32 v121, 0xffff0000, v89
    v_fmac_f32 v114, v24, v120
    v_fmac_f32 v115, v24, v121
    v_lshlrev_b32 v120, 16, v90
    v_and_b32 v121, 0xffff0000, v90
    v_fmac_f32 v116, v24, v120
    v_fmac_f32 v117, v24, v121
    v_lshlrev_b32 v120, 16, v91
    v_and_b32 v121, 0xffff0000, v91
    v_fmac_f32 v118, v24, v120
    v_fmac_f32 v119, v24, v121
    s_waitcnt vmcnt(4)
    v_lshlrev_b32 v120, 16, v92
    v_and_b32 v121, 0xffff0000, v92
    v_fmac_f32 v112, v25, v120
    v_fmac_f32 v113, v25, v121
    v_lshlrev_b32 v120, 16, v93
    v_and_b32 v121, 0xffff0000, v93
    v_fmac_f32 v114, v25, v120
    v_fmac_f32 v115, v25, v121
    v_lshlrev_b32 v120, 16, v94
    v_and_b32 v121, 0xffff0000, v94
    v_fmac_f32 v116, v25, v120
    v_fmac_f32 v117, v25, v121
    v_lshlrev_b32 v120, 16, v95
    v_and_b32 v121, 0xffff0000, v95
    v_fmac_f32 v118, v25, v120
    v_fmac_f32 v119, v25, v121
    s_waitcnt vmcnt(3)
    v_lshlrev_b32 v120, 16, v96
    v_and_b32 v121, 0xffff0000, v96
    v_fmac_f32 v112, v26, v120
    v_fmac_f32 v113, v26, v121
    v_lshlrev_b32 v120, 16, v97
    v_and_b32 v121, 0xffff0000, v97
    v_fmac_f32 v114, v26, v120
    v_fmac_f32 v115, v26, v121
    v_lshlrev_b32 v120, 16, v98
    v_and_b32 v121, 0xffff0000, v98
    v_fmac_f32 v116, v26, v120
    v_fmac_f32 v117, v26, v121
    v_lshlrev_b32 v120, 16, v99
    v_and_b32 v121, 0xffff0000, v99
    v_fmac_f32 v118, v26, v120
    v_fmac_f32 v119, v26, v121
    s_waitcnt vmcnt(2)
    v_lshlrev_b32 v120, 16, v100
    v_and_b32 v121, 0xffff0000, v100
    v_fmac_f32 v112, v27, v120
    v_fmac_f32 v113, v27, v121
    v_lshlrev_b32 v120, 16, v101
    v_and_b32 v121, 0xffff0000, v101
    v_fmac_f32 v114, v27, v120
    v_fmac_f32 v115, v27, v121
    v_lshlrev_b32 v120, 16, v102
    v_and_b32 v121, 0xffff0000, v102
    v_fmac_f32 v116, v27, v120
    v_fmac_f32 v117, v27, v121
    v_lshlrev_b32 v120, 16, v103
    v_and_b32 v121, 0xffff0000, v103
    v_fmac_f32 v118, v27, v120
    v_fmac_f32 v119, v27, v121
    s_waitcnt vmcnt(1)
    v_lshlrev_b32 v120, 16, v104
    v_and_b32 v121, 0xffff0000, v104
    v_fmac_f32 v112, v28, v120
    v_fmac_f32 v113, v28, v121
    v_lshlrev_b32 v120, 16, v105
    v_and_b32 v121, 0xffff0000, v105
    v_fmac_f32 v114, v28, v120
    v_fmac_f32 v115, v28, v121
    v_lshlrev_b32 v120, 16, v106
    v_and_b32 v121, 0xffff0000, v106
    v_fmac_f32 v116, v28, v120
    v_fmac_f32 v117, v28, v121
    v_lshlrev_b32 v120, 16, v107
    v_and_b32 v121, 0xffff0000, v107
    v_fmac_f32 v118, v28, v120
    v_fmac_f32 v119, v28, v121
    s_waitcnt vmcnt(0)
    v_lshlrev_b32 v120, 16, v108
    v_and_b32 v121, 0xffff0000, v108
    v_fmac_f32 v112, v29, v120
    v_fmac_f32 v113, v29, v121
    v_lshlrev_b32 v120, 16, v109
    v_and_b32 v121, 0xffff0000, v109
    v_fmac_f32 v114, v29, v120
    v_fmac_f32 v115, v29, v121
    v_lshlrev_b32 v120, 16, v110
    v_and_b32 v121, 0xffff0000, v110
    v_fmac_f32 v116, v29, v120
    v_fmac_f32 v117, v29, v121
    v_lshlrev_b32 v120, 16, v111
    v_and_b32 v121, 0xffff0000, v111
    v_fmac_f32 v118, v29, v120
    v_fmac_f32 v119, v29, v121
    v_lshlrev_b32 v7, 5, v0
    ds_write_b128 v7, v[112:115]
    ds_write_b128 v7, v[116:119] offset:16
    s_waitcnt lgkmcnt(0)
    s_barrier
    v_cmp_gt_u32 vcc, 64, v0
    s_and_saveexec_b64 s[42:43], vcc
    s_cbranch_execz k1_end
    v_lshlrev_b32 v7, 2, v0
    ds_read_b32 v32, v7 offset:0
    ds_read_b32 v33, v7 offset:256
    ds_read_b32 v34, v7 offset:512
    ds_read_b32 v35, v7 offset:768
    ds_read_b32 v36, v7 offset:1024
    ds_read_b32 v37, v7 offset:1280
    ds_read_b32 v38, v7 offset:1536
    ds_read_b32 v39, v7 offset:1792
    ds_read_b32 v40, v7 offset:2048
    ds_read_b32 v41, v7 offset:2304
    ds_read_b32 v42, v7 offset:2560
    ds_read_b32 v43, v7 offset:2816
    ds_read_b32 v44, v7 offset:3072
    ds_read_b32 v45, v7 offset:3328
    ds_read_b32 v46, v7 offset:3584
    ds_read_b32 v47, v7 offset:3840
    ds_read_b32 v48, v7 offset:4096
    ds_read_b32 v49, v7 offset:4352
    ds_read_b32 v50, v7 offset:4608
    ds_read_b32 v51, v7 offset:4864
    ds_read_b32 v52, v7 offset:5120
    ds_read_b32 v53, v7 offset:5376
    ds_read_b32 v54, v7 offset:5632
    ds_read_b32 v55, v7 offset:5888
    ds_read_b32 v56, v7 offset:6144
    ds_read_b32 v57, v7 offset:6400
    ds_read_b32 v58, v7 offset:6656
    ds_read_b32 v59, v7 offset:6912
    ds_read_b32 v60, v7 offset:7168
    ds_read_b32 v61, v7 offset:7424
    ds_read_b32 v62, v7 offset:7680
    ds_read_b32 v63, v7 offset:7936
    s_waitcnt lgkmcnt(0)
    v_add_f32 v32, v32, v48
    v_add_f32 v33, v33, v49
    v_add_f32 v34, v34, v50
    v_add_f32 v35, v35, v51
    v_add_f32 v36, v36, v52
    v_add_f32 v37, v37, v53
    v_add_f32 v38, v38, v54
    v_add_f32 v39, v39, v55
    v_add_f32 v40, v40, v56
    v_add_f32 v41, v41, v57
    v_add_f32 v42, v42, v58
    v_add_f32 v43, v43, v59
    v_add_f32 v44, v44, v60
    v_add_f32 v45, v45, v61
    v_add_f32 v46, v46, v62
    v_add_f32 v47, v47, v63
    v_add_f32 v32, v32, v40
    v_add_f32 v33, v33, v41
    v_add_f32 v34, v34, v42
    v_add_f32 v35, v35, v43
    v_add_f32 v36, v36, v44
    v_add_f32 v37, v37, v45
    v_add_f32 v38, v38, v46
    v_add_f32 v39, v39, v47
    v_add_f32 v32, v32, v36
    v_add_f32 v33, v33, v37
    v_add_f32 v34, v34, v38
    v_add_f32 v35, v35, v39
    v_add_f32 v32, v32, v34
    v_add_f32 v33, v33, v35
    v_add_f32 v32, v32, v33
    s_movk_i32 s22, 640
    v_cvt_pk_bf16_f32 v32, v32, v32
    v_lshlrev_b32 v32, 16, v32
    v_add_f32 v33, 1.0, v32
    v_cvt_pk_bf16_f32 v33, v33, v33
    v_lshlrev_b32 v33, 16, v33
    s_lshl_b32 s33, s32, 6
    v_add_u32 v34, s33, v0
    v_subrev_u32 v35, 640, v34
    v_cmp_gt_u32 vcc, 640, v35
    v_subrev_u32 v35, 2560, v34
    v_cmp_gt_u32 s[40:41], s22, v35
    s_or_b64 vcc, vcc, s[40:41]
    v_cndmask_b32 v32, v32, v33, vcc
    s_lshl_b32 s21, s32, 8
    s_add_u32 s21, s21, 10674176
    buffer_store_dword v32, v7, s[28:31], s21 offen sc1
    s_endpgm
k1_end:
    s_endpgm
k1_pf:
    s_load_dwordx2 s[4:5], s[0:1], 0
    v_lshrrev_b32 v2, 6, v0
    v_and_b32 v1, 63, v0
    v_readfirstlane_b32 s20, v2
    v_lshlrev_b32 v1, 4, v1
    s_sub_u32 s21, s2, 344
    s_lshr_b32 s21, s21, 3
    s_lshl_b32 s21, s21, 2
    s_add_u32 s21, s21, s20
    s_mul_i32 s21, s21, 10240
    s_and_b32 s22, s2, 7
    s_mul_i32 s22, s22, 327680
    s_add_u32 s21, s21, s22
    s_waitcnt lgkmcnt(0)
    s_mov_b32 s16, s4
    s_mov_b32 s17, s5
    s_mov_b32 s18, 2621440
    s_mov_b32 s19, 0x00020000
    s_load_dwordx2 s[10:11], s[0:1], 120
    s_sub_u32 s23, s2, 344
    s_lshl_b32 s23, s23, 2
    s_add_u32 s23, s23, s20
    v_mov_b32 v60, 0
    v_mov_b32 v61, 0
    v_mov_b32 v62, 0
    v_mov_b32 v63, 0
    s_lshl_b32 s24, s23, 10
    s_add_u32 s25, s24, 31940608
    s_sub_u32 s26, s24, 196608
    s_add_u32 s27, s26, 13344768
    s_cmp_ge_u32 s23, 192
    s_cselect_b32 s25, s27, s25
    s_add_u32 s27, s26, 15925248
    s_cmp_ge_u32 s23, 212
    s_cselect_b32 s25, s27, s25
    s_waitcnt lgkmcnt(0)
    s_mov_b32 s28, s10
    s_mov_b32 s29, s11
    s_mov_b32 s30, 268435456
    s_mov_b32 s31, 0x00020000
    s_cmp_ge_u32 s23, 232
    s_cbranch_scc1 k1_kernel_nz5
    buffer_store_dwordx4 v[60:63], v1, s[28:31], s25 offen sc1
k1_kernel_nz5:
    s_endpgm
.globl chain_kernel
.p2align 8
.type chain_kernel,@function
chain_kernel:
    s_cmp_ge_u32 s2, 256
    s_cbranch_scc1 chain_end
    s_load_dwordx2 s[4:5], s[0:1], 0
    s_load_dwordx2 s[6:7], s[0:1], 104
    s_load_dwordx2 s[10:11], s[0:1], 120
    v_lshrrev_b32 v2, 6, v0
    v_and_b32 v1, 63, v0
    v_readfirstlane_b32 s20, v2
    s_and_b32 s25, s2, 7
    s_lshr_b32 s26, s2, 3
    s_lshl_b32 s23, s25, 3
    s_lshr_b32 s27, s26, 2
    s_add_u32 s23, s23, s27
    s_and_b32 s24, s26, 3
    s_and_b32 s21, s20, 1
    s_lshr_b32 s22, s20, 1
    v_lshrrev_b32 v3, 4, v1
    v_and_b32 v4, 15, v1
    v_lshlrev_b32 v8, 4, v1
    s_waitcnt lgkmcnt(0)
    s_mov_b32 s28, s10
    s_mov_b32 s29, s11
    s_mov_b32 s30, 268435456
    s_mov_b32 s31, 0x00020000
    s_mul_i32 s25, s20, 10240
    s_add_u32 s10, s25, 0
    s_mul_i32 s11, s23, 40960
    s_add_u32 s11, s11, s25
    s_add_u32 s11, s11, 8052736
    s_lshl_b32 s12, s20, 10
    s_add_u32 s13, s12, 10681856
    s_add_u32 s12, s12, 130560
    s_lshl_b32 s14, s21, 10
    s_add_u32 s14, s14, 139264
    s_mul_i32 s15, s21, 7168
    s_mul_i32 s25, s24, 640
    s_add_u32 s15, s15, s25
    s_add_u32 s15, s15, 10706944
    s_mov_b32 m0, s10
    s_add_u32 s10, s10, 4096
    buffer_load_dwordx4 v8, s[28:31], s11 offen offset:0 lds
    buffer_load_dwordx4 v8, s[28:31], s11 offen offset:1024 lds
    buffer_load_dwordx4 v8, s[28:31], s11 offen offset:2048 lds
    buffer_load_dwordx4 v8, s[28:31], s11 offen offset:3072 lds
    s_add_u32 s11, s11, 4096
    s_mov_b32 m0, s10
    s_add_u32 s10, s10, 4096
    buffer_load_dwordx4 v8, s[28:31], s11 offen offset:0 lds
    buffer_load_dwordx4 v8, s[28:31], s11 offen offset:1024 lds
    buffer_load_dwordx4 v8, s[28:31], s11 offen offset:2048 lds
    buffer_load_dwordx4 v8, s[28:31], s11 offen offset:3072 lds
    s_add_u32 s11, s11, 4096
    s_mov_b32 m0, s10
    s_add_u32 s10, s10, 4096
    buffer_load_dwordx4 v8, s[28:31], s11 offen offset:0 lds
    buffer_load_dwordx4 v8, s[28:31], s11 offen offset:1024 lds
    s_mov_b32 m0, s12
    s_nop 0
    buffer_load_dwordx4 v8, s[28:31], s13 offen lds
    s_mov_b32 m0, 134656
    s_mov_b32 s13, 10685952
    buffer_load_dwordx4 v8, s[28:31], s13 offen lds
    s_mov_b32 m0, s14
    s_nop 0
    buffer_load_dwordx4 v8, s[28:31], s15 offen lds
    s_mov_b32 s32, s6
    s_mov_b32 s33, s7
    s_mov_b32 s34, 2621440
    s_mov_b32 s35, 0x00020000
    s_mul_i32 s36, s24, 200
    s_mul_i32 s37, s21, 100
    s_add_u32 s36, s36, s37
    s_mul_i32 s37, s22, 50
    s_add_u32 s36, s36, s37
    s_lshl_b32 s36, s36, 10
    s_add_u32 s37, s36, 26615808
    s_add_u32 s36, s36, 25796608
    v_lshrrev_b32 v2, 1, v3
    s_lshl_b32 s26, s21, 2
    v_add_u32 v2, s26, v2
    v_and_b32 v7, 7, v4
    v_xor_b32 v2, v2, v7
    v_lshlrev_b32 v2, 4, v2
    buffer_load_dwordx4 a[0:3], v8, s[28:31], s36 offen offset:0
    v_lshl_add_u32 v226, v4, 8, v2
    v_and_b32 v2, 1, v3
    v_lshl_add_u32 v226, v2, 3, v226
    s_mul_i32 s26, s22, 20480
    s_add_u32 s27, s26, 0
    v_add_u32 v226, s27, v226
    v_lshlrev_b32 v227, 5, v4
    v_add_u32 v227, 122880, v227
    s_lshl_b32 s27, s21, 3
    v_add_u32 v2, s27, v3
    v_xor_b32 v2, v2, v7
    v_lshlrev_b32 v2, 4, v2
    v_and_b32 v7, 3, v4
    v_lshl_add_u32 v2, v7, 8, v2
    v_lshrrev_b32 v7, 2, v4
    v_lshl_add_u32 v2, v7, 10, v2
    s_add_u32 s27, s26, 40960
    v_add_u32 v228, s27, v2
    v_xor_b32 v2, v4, v3
    buffer_load_dwordx4 a[4:7], v8, s[28:31], s36 offen offset:1024
    v_lshlrev_b32 v2, 4, v2
    v_lshl_add_u32 v2, v3, 8, v2
    v_xor_b32 v7, 64, v2
    s_mul_i32 s26, s22, 30720
    s_add_u32 s26, s26, 40960
    s_mul_i32 s27, s22, 10240
    s_sub_u32 s27, 61440, s27
    v_add_u32 v229, s26, v2
    v_add_u32 v230, s26, v7
    v_add_u32 v231, s27, v2
    v_add_u32 v232, s27, v7
    v_lshlrev_b32 v2, 4, v3
    s_mul_i32 s26, s21, 384
    s_add_u32 s26, s26, 139264
    v_add_u32 v233, s26, v2
    s_mul_i32 s26, s21, 64
    s_add_u32 s26, s26, 139520
    v_add_u32 v234, s26, v2
    buffer_load_dwordx4 a[8:11], v8, s[28:31], s36 offen offset:2048
    s_lshl_b32 s26, s22, 7
    s_add_u32 s26, s26, 138240
    v_lshl_add_u32 v235, v4, 3, s26
    s_mul_i32 s39, s24, 5
    s_mul_i32 s40, s21, 3
    s_add_u32 s40, s40, s39
    s_add_u32 s41, s39, 2
    v_lshrrev_b32 v12, 1, v3
    v_and_b32 v13, 1, v3
    v_lshlrev_b32 v13, 3, v13
    s_add_u32 s26, s40, 0
    v_add_u32 v14, 0, v12
    s_and_b32 s27, s26, 1
    s_lshl_b32 s27, s27, 2
    v_add_u32 v15, s27, v14
    v_xor_b32 v15, v15, v4
    v_lshlrev_b32 v15, 4, v15
    v_lshl_add_u32 v15, v14, 8, v15
    buffer_load_dwordx4 a[12:15], v8, s[28:31], s36 offen offset:3072
    v_add_u32 v15, v15, v13
    s_mul_i32 s27, s22, 20
    s_add_u32 s27, s27, s26
    s_lshl_b32 s27, s27, 10
    s_add_u32 s27, s27, 40960
    v_add_u32 v236, s27, v15
    s_add_u32 s26, s40, 0
    v_add_u32 v14, 2, v12
    s_and_b32 s27, s26, 1
    s_lshl_b32 s27, s27, 2
    v_add_u32 v15, s27, v14
    v_xor_b32 v15, v15, v4
    v_lshlrev_b32 v15, 4, v15
    v_lshl_add_u32 v15, v14, 8, v15
    v_add_u32 v15, v15, v13
    s_mul_i32 s27, s22, 20
    s_add_u32 s27, s27, s26
    s_lshl_b32 s27, s27, 10
    s_add_u32 s36, s36, 4096
    buffer_load_dwordx4 a[16:19], v8, s[28:31], s36 offen offset:0
    s_add_u32 s27, s27, 40960
    v_add_u32 v237, s27, v15
    s_add_u32 s26, s40, 1
    v_add_u32 v14, 0, v12
    s_and_b32 s27, s26, 1
    s_lshl_b32 s27, s27, 2
    v_add_u32 v15, s27, v14
    v_xor_b32 v15, v15, v4
    v_lshlrev_b32 v15, 4, v15
    v_lshl_add_u32 v15, v14, 8, v15
    v_add_u32 v15, v15, v13
    s_mul_i32 s27, s22, 20
    s_add_u32 s27, s27, s26
    s_lshl_b32 s27, s27, 10
    s_add_u32 s27, s27, 40960
    v_add_u32 v238, s27, v15
    s_add_u32 s26, s40, 1
    v_add_u32 v14, 2, v12
    buffer_load_dwordx4 a[20:23], v8, s[28:31], s36 offen offset:1024
    s_and_b32 s27, s26, 1
    s_lshl_b32 s27, s27, 2
    v_add_u32 v15, s27, v14
    v_xor_b32 v15, v15, v4
    v_lshlrev_b32 v15, 4, v15
    v_lshl_add_u32 v15, v14, 8, v15
    v_add_u32 v15, v15, v13
    s_mul_i32 s27, s22, 20
    s_add_u32 s27, s27, s26
    s_lshl_b32 s27, s27, 10
    s_add_u32 s27, s27, 40960
    v_add_u32 v239, s27, v15
    s_mov_b32 s26, s41
    s_lshl_b32 s27, s21, 1
    v_add_u32 v14, s27, v12
    s_and_b32 s27, s26, 1
    s_lshl_b32 s27, s27, 2
    v_add_u32 v15, s27, v14
    buffer_load_dwordx4 a[24:27], v8, s[28:31], s36 offen offset:2048
    v_xor_b32 v15, v15, v4
    v_lshlrev_b32 v15, 4, v15
    v_lshl_add_u32 v15, v14, 8, v15
    v_add_u32 v15, v15, v13
    s_mul_i32 s27, s22, 20
    s_add_u32 s27, s27, s26
    s_lshl_b32 s27, s27, 10
    s_add_u32 s27, s27, 40960
    v_add_u32 v240, s27, v15
    s_lshr_b32 s26, s24, 1
    s_add_u32 s26, s26, 1
    s_sub_u32 s27, 0, s26
    s_and_b32 s42, s24, 1
    s_cmp_eq_u32 s42, 1
    s_cselect_b32 s42, s27, s26
    s_lshl_b32 s43, s23, 5
    s_lshl_b32 s26, s22, 4
    s_add_u32 s43, s43, s26
    buffer_load_dwordx4 a[28:31], v8, s[28:31], s36 offen offset:3072
    v_add_u32 v241, s43, v4
    v_add_u32 v241, s42, v241
    s_movk_i32 s27, 2048
    v_cmp_gt_u32 s[60:61], s27, v241
    v_lshrrev_b32 v242, 4, v241
    v_and_b32 v241, 15, v241
    s_mov_b32 s27, 20480
    v_mul_lo_u32 v242, v242, s27
    v_lshl_add_u32 v242, v241, 4, v242
    v_and_b32 v241, 1, v3
    v_lshlrev_b32 v241, 9, v241
    v_lshrrev_b32 v2, 1, v3
    v_lshl_add_u32 v241, v2, 8, v241
    v_add_u32 v241, v241, v242
    s_lshl_b32 s27, s21, 9
    v_lshl_add_u32 v242, v2, 8, v242
    v_add_u32 v242, s27, v242
    v_and_b32 v2, 1, v3
    v_lshl_add_u32 v242, v2, 3, v242
    s_add_u32 s36, s36, 4096
    buffer_load_dwordx4 a[32:35], v8, s[28:31], s36 offen offset:0
    v_add_u32 v243, s43, v4
    v_lshrrev_b32 v244, 4, v243
    v_and_b32 v243, 15, v243
    s_mov_b32 s27, 20480
    v_mul_lo_u32 v244, v244, s27
    v_lshl_add_u32 v244, v243, 4, v244
    v_and_b32 v243, 1, v3
    v_lshlrev_b32 v243, 9, v243
    v_lshrrev_b32 v2, 1, v3
    v_lshl_add_u32 v243, v2, 8, v243
    v_add_u32 v243, v243, v244
    s_lshl_b32 s27, s21, 9
    v_lshl_add_u32 v244, v2, 8, v244
    v_add_u32 v244, s27, v244
    v_and_b32 v2, 1, v3
    v_lshl_add_u32 v244, v2, 3, v244
    s_lshl_b32 s44, s40, 10
    s_add_u32 s38, s44, 15966208
    s_add_u32 s44, s44, 13344768
    buffer_load_dwordx4 a[36:39], v8, s[28:31], s36 offen offset:1024
    s_lshl_b32 s45, s41, 10
    s_add_u32 s39, s45, 15966208
    s_add_u32 s45, s45, 13344768
    s_lshl_b32 s46, s23, 2
    s_add_u32 s46, s46, s24
    s_lshl_b32 s46, s46, 7
    s_add_u32 s49, s46, 31973376
    s_add_u32 s46, s46, 31940608
    v_add_u32 v7, 1, v1
    v_lshrrev_b32 v7, 1, v7
    v_add_u32 v7, s23, v7
    v_subrev_u32 v7, 1, v7
    v_max_i32 v7, 0, v7
    v_min_i32 v7, 63, v7
    v_lshrrev_b32 v2, 1, v1
    s_lshl_b32 s26, s22, 1
    v_add_u32 v2, s26, v2
    v_lshl_add_u32 v7, v7, 2, v2
    buffer_load_dwordx4 a[40:43], v8, s[28:31], s36 offen offset:2048
    v_lshlrev_b32 v245, 7, v7
    s_lshl_b32 s26, s23, 1
    s_add_u32 s27, s26, s22
    s_mul_i32 s27, s27, 20
    s_mul_i32 s3, s22, 10
    s_add_u32 s27, s27, s3
    s_lshl_b32 s27, s27, 10
    s_add_u32 s50, s27, 13344768
    s_add_u32 s27, s26, 1
    s_sub_u32 s27, s27, s22
    s_mul_i32 s27, s27, 20
    s_add_u32 s27, s27, s3
    s_lshl_b32 s27, s27, 10
    s_add_u32 s51, s27, 13344768
    s_mul_i32 s26, s20, 5120
    s_add_u32 s26, s26, 143360
    v_add_u32 v246, s26, v8
    s_xor_b32 s27, s20, 2
    buffer_load_dwordx4 a[44:47], v8, s[28:31], s36 offen offset:3072
    s_mul_i32 s27, s27, 5120
    s_add_u32 s27, s27, 143360
    v_add_u32 v247, s27, v8
    s_lshr_b32 s26, s2, 3
    s_and_b32 s3, s2, 7
    s_and_b32 s4, s3, 1
    s_lshr_b32 s3, s3, 1
    s_and_b32 s52, s26, 7
    s_lshl_b32 s27, s4, 3
    s_add_u32 s52, s52, s27
    s_lshr_b32 s27, s26, 3
    s_lshl_b32 s53, s3, 2
    s_add_u32 s53, s53, s27
    s_and_b32 s57, s26, 3
    s_lshl_b32 s27, s4, 2
    s_add_u32 s57, s57, s27
    s_lshr_b32 s27, s26, 2
    s_lshl_b32 s58, s3, 3
    s_add_u32 s36, s36, 4096
    buffer_load_dwordx4 a[48:51], v8, s[28:31], s36 offen offset:0
    s_add_u32 s58, s58, s27
    s_and_b32 s57, s26, 7
    s_lshr_b32 s27, s26, 3
    s_and_b32 s58, s2, 7
    s_lshl_b32 s58, s58, 2
    s_add_u32 s58, s58, s27
    s_mul_i32 s54, s52, 143360
    s_add_u32 s54, s54, 27435008
    s_mul_i32 s59, s57, 276480
    s_add_u32 s59, s59, 29728768
    v_mov_b32 v224, 0x3f803f80
    v_mov_b32 v216, 0
    v_mov_b32 v217, 0
    v_mov_b32 v220, 0
    v_mov_b32 v221, 0
    v_mov_b32 v218, 0
    v_mov_b32 v219, 0
    v_mov_b32 v222, 0
    buffer_load_dwordx4 a[52:55], v8, s[28:31], s36 offen offset:1024
    v_mov_b32 v223, 0
    s_waitcnt vmcnt(14)
    s_barrier
    v_xor_b32 v12, 32, v226
    ds_read_b64 v[32:33], v226 offset:0
    ds_read_b64 v[34:35], v226 offset:128
    ds_read_b64 v[36:37], v12 offset:0
    ds_read_b64 v[38:39], v12 offset:128
    ds_read_b64 v[40:41], v226 offset:4096
    buffer_load_dwordx4 a[56:59], v8, s[28:31], s36 offen offset:2048
    ds_read_b64 v[42:43], v226 offset:4224
    s_waitcnt lgkmcnt(4)
    v_dot2_f32_bf16 v220, v32, v224, v220
    v_lshlrev_b32 v72, 16, v32
    v_dot2_f32_bf16 v221, v32, v32, v221
    v_and_b32 v73, 0xffff0000, v32
    v_dot2_f32_bf16 v220, v33, v224, v220
    ds_read_b64 v[44:45], v12 offset:4096
    v_lshlrev_b32 v74, 16, v33
    v_dot2_f32_bf16 v221, v33, v33, v221
    v_and_b32 v75, 0xffff0000, v33
    v_dot2_f32_bf16 v220, v34, v224, v220
    ds_read_b64 v[46:47], v12 offset:4224
    buffer_load_dwordx4 a[60:63], v8, s[28:31], s36 offen offset:3072
    v_lshlrev_b32 v76, 16, v34
    v_dot2_f32_bf16 v221, v34, v34, v221
    v_and_b32 v77, 0xffff0000, v34
    v_dot2_f32_bf16 v220, v35, v224, v220
    v_lshlrev_b32 v78, 16, v35
    v_dot2_f32_bf16 v221, v35, v35, v221
    v_and_b32 v79, 0xffff0000, v35
    s_waitcnt lgkmcnt(4)
    v_dot2_f32_bf16 v222, v36, v224, v222
    v_lshlrev_b32 v80, 16, v36
    v_dot2_f32_bf16 v223, v36, v36, v223
    v_and_b32 v81, 0xffff0000, v36
    v_dot2_f32_bf16 v222, v37, v224, v222
    ds_read_b64 v[48:49], v226 offset:8192
    v_lshlrev_b32 v82, 16, v37
    v_dot2_f32_bf16 v223, v37, v37, v223
    v_and_b32 v83, 0xffff0000, v37
    s_add_u32 s36, s36, 4096
    buffer_load_dwordx4 a[64:67], v8, s[28:31], s36 offen offset:0
    v_dot2_f32_bf16 v222, v38, v224, v222
    ds_read_b64 v[50:51], v226 offset:8320
    v_lshlrev_b32 v84, 16, v38
    v_dot2_f32_bf16 v223, v38, v38, v223
    v_and_b32 v85, 0xffff0000, v38
    v_dot2_f32_bf16 v222, v39, v224, v222
    v_lshlrev_b32 v86, 16, v39
    v_dot2_f32_bf16 v223, v39, v39, v223
    v_and_b32 v87, 0xffff0000, v39
    s_waitcnt lgkmcnt(4)
    v_dot2_f32_bf16 v220, v40, v224, v220
    v_lshlrev_b32 v88, 16, v40
    v_dot2_f32_bf16 v221, v40, v40, v221
    v_and_b32 v89, 0xffff0000, v40
    v_dot2_f32_bf16 v220, v41, v224, v220
    ds_read_b64 v[52:53], v12 offset:8192
    buffer_load_dwordx4 a[68:71], v8, s[28:31], s36 offen offset:1024
    v_lshlrev_b32 v90, 16, v41
    v_dot2_f32_bf16 v221, v41, v41, v221
    v_and_b32 v91, 0xffff0000, v41
    v_dot2_f32_bf16 v220, v42, v224, v220
    ds_read_b64 v[54:55], v12 offset:8320
    v_lshlrev_b32 v92, 16, v42
    v_dot2_f32_bf16 v221, v42, v42, v221
    v_and_b32 v93, 0xffff0000, v42
    v_dot2_f32_bf16 v220, v43, v224, v220
    v_lshlrev_b32 v94, 16, v43
    v_dot2_f32_bf16 v221, v43, v43, v221
    v_and_b32 v95, 0xffff0000, v43
    s_waitcnt lgkmcnt(4)
    v_dot2_f32_bf16 v222, v44, v224, v222
    v_lshlrev_b32 v96, 16, v44
    v_dot2_f32_bf16 v223, v44, v44, v223
    v_and_b32 v97, 0xffff0000, v44
    buffer_load_dwordx4 a[72:75], v8, s[28:31], s36 offen offset:2048
    v_dot2_f32_bf16 v222, v45, v224, v222
    ds_read_b64 v[56:57], v226 offset:12288
    v_lshlrev_b32 v98, 16, v45
    v_dot2_f32_bf16 v223, v45, v45, v223
    v_and_b32 v99, 0xffff0000, v45
    v_dot2_f32_bf16 v222, v46, v224, v222
    ds_read_b64 v[58:59], v226 offset:12416
    v_lshlrev_b32 v100, 16, v46
    v_dot2_f32_bf16 v223, v46, v46, v223
    v_and_b32 v101, 0xffff0000, v46
    v_dot2_f32_bf16 v222, v47, v224, v222
    v_lshlrev_b32 v102, 16, v47
    v_dot2_f32_bf16 v223, v47, v47, v223
    v_and_b32 v103, 0xffff0000, v47
    s_waitcnt lgkmcnt(4)
    buffer_load_dwordx4 a[76:79], v8, s[28:31], s36 offen offset:3072
    v_dot2_f32_bf16 v220, v48, v224, v220
    v_lshlrev_b32 v104, 16, v48
    v_dot2_f32_bf16 v221, v48, v48, v221
    v_and_b32 v105, 0xffff0000, v48
    v_dot2_f32_bf16 v220, v49, v224, v220
    ds_read_b64 v[60:61], v12 offset:12288
    v_lshlrev_b32 v106, 16, v49
    v_dot2_f32_bf16 v221, v49, v49, v221
    v_and_b32 v107, 0xffff0000, v49
    v_dot2_f32_bf16 v220, v50, v224, v220
    ds_read_b64 v[62:63], v12 offset:12416
    v_lshlrev_b32 v108, 16, v50
    v_dot2_f32_bf16 v221, v50, v50, v221
    v_and_b32 v109, 0xffff0000, v50
    v_dot2_f32_bf16 v220, v51, v224, v220
    s_add_u32 s36, s36, 4096
    buffer_load_dwordx4 a[80:83], v8, s[28:31], s36 offen offset:0
    v_lshlrev_b32 v110, 16, v51
    v_dot2_f32_bf16 v221, v51, v51, v221
    v_and_b32 v111, 0xffff0000, v51
    s_waitcnt lgkmcnt(4)
    v_dot2_f32_bf16 v222, v52, v224, v222
    v_lshlrev_b32 v112, 16, v52
    v_dot2_f32_bf16 v223, v52, v52, v223
    v_and_b32 v113, 0xffff0000, v52
    v_dot2_f32_bf16 v222, v53, v224, v222
    ds_read_b64 v[64:65], v226 offset:16384
    v_lshlrev_b32 v114, 16, v53
    v_dot2_f32_bf16 v223, v53, v53, v223
    v_and_b32 v115, 0xffff0000, v53
    v_dot2_f32_bf16 v222, v54, v224, v222
    ds_read_b64 v[66:67], v226 offset:16512
    buffer_load_dwordx4 a[84:87], v8, s[28:31], s36 offen offset:1024
    v_lshlrev_b32 v116, 16, v54
    v_dot2_f32_bf16 v223, v54, v54, v223
    v_and_b32 v117, 0xffff0000, v54
    v_dot2_f32_bf16 v222, v55, v224, v222
    v_lshlrev_b32 v118, 16, v55
    v_dot2_f32_bf16 v223, v55, v55, v223
    v_and_b32 v119, 0xffff0000, v55
    s_waitcnt lgkmcnt(4)
    v_dot2_f32_bf16 v220, v56, v224, v220
    v_lshlrev_b32 v120, 16, v56
    v_dot2_f32_bf16 v221, v56, v56, v221
    v_and_b32 v121, 0xffff0000, v56
    v_dot2_f32_bf16 v220, v57, v224, v220
    ds_read_b64 v[68:69], v12 offset:16384
    v_lshlrev_b32 v122, 16, v57
    v_dot2_f32_bf16 v221, v57, v57, v221
    v_and_b32 v123, 0xffff0000, v57
    buffer_load_dwordx4 a[88:91], v8, s[28:31], s36 offen offset:2048
    v_dot2_f32_bf16 v220, v58, v224, v220
    ds_read_b64 v[70:71], v12 offset:16512
    v_lshlrev_b32 v124, 16, v58
    v_dot2_f32_bf16 v221, v58, v58, v221
    v_and_b32 v125, 0xffff0000, v58
    v_dot2_f32_bf16 v220, v59, v224, v220
    v_lshlrev_b32 v126, 16, v59
    v_dot2_f32_bf16 v221, v59, v59, v221
    v_and_b32 v127, 0xffff0000, v59
    s_waitcnt lgkmcnt(4)
    v_dot2_f32_bf16 v222, v60, v224, v222
    v_lshlrev_b32 v128, 16, v60
    v_dot2_f32_bf16 v223, v60, v60, v223
    v_and_b32 v129, 0xffff0000, v60
    v_dot2_f32_bf16 v222, v61, v224, v222
    v_lshlrev_b32 v130, 16, v61
    v_dot2_f32_bf16 v223, v61, v61, v223
    buffer_load_dwordx4 a[92:95], v8, s[28:31], s36 offen offset:3072
    v_and_b32 v131, 0xffff0000, v61
    v_dot2_f32_bf16 v222, v62, v224, v222
    v_lshlrev_b32 v132, 16, v62
    v_dot2_f32_bf16 v223, v62, v62, v223
    v_and_b32 v133, 0xffff0000, v62
    v_dot2_f32_bf16 v222, v63, v224, v222
    v_lshlrev_b32 v134, 16, v63
    v_dot2_f32_bf16 v223, v63, v63, v223
    v_and_b32 v135, 0xffff0000, v63
    s_waitcnt lgkmcnt(2)
    v_dot2_f32_bf16 v220, v64, v224, v220
    v_lshlrev_b32 v136, 16, v64
    v_dot2_f32_bf16 v221, v64, v64, v221
    v_and_b32 v137, 0xffff0000, v64
    v_dot2_f32_bf16 v220, v65, v224, v220
    v_lshlrev_b32 v138, 16, v65
    v_dot2_f32_bf16 v221, v65, v65, v221
    v_and_b32 v139, 0xffff0000, v65
    v_dot2_f32_bf16 v220, v66, v224, v220
    s_add_u32 s36, s36, 4096
    buffer_load_dwordx4 a[96:99], v8, s[28:31], s36 offen offset:0
    v_lshlrev_b32 v140, 16, v66
    v_dot2_f32_bf16 v221, v66, v66, v221
    v_and_b32 v141, 0xffff0000, v66
    v_dot2_f32_bf16 v220, v67, v224, v220
    v_lshlrev_b32 v142, 16, v67
    v_dot2_f32_bf16 v221, v67, v67, v221
    v_and_b32 v143, 0xffff0000, v67
    s_waitcnt lgkmcnt(0)
    v_dot2_f32_bf16 v222, v68, v224, v222
    v_lshlrev_b32 v144, 16, v68
    v_dot2_f32_bf16 v223, v68, v68, v223
    v_and_b32 v145, 0xffff0000, v68
    v_dot2_f32_bf16 v222, v69, v224, v222
    v_lshlrev_b32 v146, 16, v69
    v_dot2_f32_bf16 v223, v69, v69, v223
    v_and_b32 v147, 0xffff0000, v69
    v_dot2_f32_bf16 v222, v70, v224, v222
    v_lshlrev_b32 v148, 16, v70
    v_dot2_f32_bf16 v223, v70, v70, v223
    buffer_load_dwordx4 a[100:103], v8, s[28:31], s36 offen offset:1024
    v_and_b32 v149, 0xffff0000, v70
    v_dot2_f32_bf16 v222, v71, v224, v222
    v_lshlrev_b32 v150, 16, v71
    v_dot2_f32_bf16 v223, v71, v71, v223
    v_and_b32 v151, 0xffff0000, v71
    s_nop 2
    s_nop 1
    v_add_f32_dpp v220, v220, v220 quad_perm:[1,0,3,2] row_mask:0xf bank_mask:0xf
    v_add_f32_dpp v221, v221, v221 quad_perm:[1,0,3,2] row_mask:0xf bank_mask:0xf
    v_add_f32_dpp v222, v222, v222 quad_perm:[1,0,3,2] row_mask:0xf bank_mask:0xf
    v_add_f32_dpp v223, v223, v223 quad_perm:[1,0,3,2] row_mask:0xf bank_mask:0xf
    v_add_f32_dpp v220, v220, v220 quad_perm:[2,3,0,1] row_mask:0xf bank_mask:0xf
    v_add_f32_dpp v221, v221, v221 quad_perm:[2,3,0,1] row_mask:0xf bank_mask:0xf
    v_add_f32_dpp v222, v222, v222 quad_perm:[2,3,0,1] row_mask:0xf bank_mask:0xf
    v_add_f32_dpp v223, v223, v223 quad_perm:[2,3,0,1] row_mask:0xf bank_mask:0xf
    v_add_f32_dpp v220, v220, v220 row_half_mirror row_mask:0xf bank_mask:0xf
    v_add_f32_dpp v221, v221, v221 row_half_mirror row_mask:0xf bank_mask:0xf
    v_add_f32_dpp v222, v222, v222 row_half_mirror row_mask:0xf bank_mask:0xf
    v_add_f32_dpp v223, v223, v223 row_half_mirror row_mask:0xf bank_mask:0xf
    buffer_load_dwordx4 a[104:107], v8, s[28:31], s36 offen offset:2048
    v_add_f32_dpp v220, v220, v220 row_mirror row_mask:0xf bank_mask:0xf
    v_add_f32_dpp v221, v221, v221 row_mirror row_mask:0xf bank_mask:0xf
    v_add_f32_dpp v222, v222, v222 row_mirror row_mask:0xf bank_mask:0xf
    v_add_f32_dpp v223, v223, v223 row_mirror row_mask:0xf bank_mask:0xf
    v_mul_f32 v220, 0x3acccccd, v220
    v_mul_f32 v222, 0x3acccccd, v222
    v_mul_f32 v221, 0x3acccccd, v221
    v_mul_f32 v223, 0x3acccccd, v223
    v_fma_f32 v221, -v220, v220, v221
    v_fma_f32 v223, -v222, v222, v223
    v_max_f32 v221, 0, v221
    v_max_f32 v223, 0, v223
    v_cvt_pk_bf16_f32 v192, v220, v221
    v_cvt_pk_bf16_f32 v193, v222, v223
    v_lshlrev_b32 v220, 16, v192
    v_lshlrev_b32 v222, 16, v193
    v_and_b32 v221, 0xffff0000, v192
    v_and_b32 v223, 0xffff0000, v193
    v_add_f32 v221, 0x3727c5ac, v221
    buffer_load_dwordx4 a[108:111], v8, s[28:31], s36 offen offset:3072
    v_add_f32 v223, 0x3727c5ac, v223
    v_cvt_pk_bf16_f32 v192, v221, v221
    v_cvt_pk_bf16_f32 v193, v223, v223
    v_lshlrev_b32 v221, 16, v192
    v_lshlrev_b32 v223, 16, v193
    v_sqrt_f32 v221, v221
    v_sqrt_f32 v223, v223
    s_nop 0
    s_nop 0
    v_cvt_pk_bf16_f32 v192, v221, v221
    v_cvt_pk_bf16_f32 v193, v223, v223
    v_lshlrev_b32 v221, 16, v192
    v_lshlrev_b32 v223, 16, v193
    v_rcp_f32 v221, v221
    v_rcp_f32 v223, v223
    s_add_u32 s36, s36, 4096
    buffer_load_dwordx4 a[112:115], v8, s[28:31], s36 offen offset:0
    s_nop 0
    s_nop 0
    v_mul_f32 v220, v220, v221
    v_mul_f32 v222, v222, v223
    v_sub_f32 v220, 0, v220
    v_sub_f32 v222, 0, v222
    v_mov_b32 v216, 0
    v_mov_b32 v217, 0
    v_mov_b32 v218, 0
    v_mov_b32 v219, 0
    v_xor_b32 v12, 64, v228
    ds_read_b128 v[152:155], v227 offset:10240
    ds_read_b128 v[156:159], v227 offset:10256
    ds_read_b128 v[160:163], v227 offset:7680
    buffer_load_dwordx4 a[116:119], v8, s[28:31], s36 offen offset:1024
    ds_read_b128 v[164:167], v227 offset:7696
    s_waitcnt lgkmcnt(0)
    v_pk_fma_f32 v[72:73], v[72:73], v[220:221], v[220:221] op_sel:[0,1,0] op_sel_hi:[1,1,0]
    v_pk_fma_f32 v[74:75], v[74:75], v[220:221], v[220:221] op_sel:[0,1,0] op_sel_hi:[1,1,0]
    v_pk_fma_f32 v[76:77], v[76:77], v[220:221], v[220:221] op_sel:[0,1,0] op_sel_hi:[1,1,0]
    ds_read_b128 v[168:171], v227 offset:10752
    v_pk_fma_f32 v[78:79], v[78:79], v[220:221], v[220:221] op_sel:[0,1,0] op_sel_hi:[1,1,0]
    v_pk_fma_f32 v[72:73], v[72:73], v[152:153], v[160:161]
    v_pk_fma_f32 v[74:75], v[74:75], v[154:155], v[162:163]
    ds_read_b128 v[172:175], v227 offset:10768
    v_pk_fma_f32 v[76:77], v[76:77], v[156:157], v[164:165]
    v_pk_fma_f32 v[78:79], v[78:79], v[158:159], v[166:167]
    v_cvt_pk_bf16_f32 v32, v72, v73
    buffer_load_dwordx4 a[120:123], v8, s[28:31], s36 offen offset:2048
    ds_read_b128 v[176:179], v227 offset:8192
    v_cvt_pk_bf16_f32 v33, v74, v75
    v_cvt_pk_bf16_f32 v34, v76, v77
    v_cvt_pk_bf16_f32 v35, v78, v79
    ds_read_b128 v[180:183], v227 offset:8208
    v_dot2_f32_bf16 v216, v32, v224, v216
    v_dot2_f32_bf16 v217, v32, v32, v217
    v_dot2_f32_bf16 v216, v33, v224, v216
    v_dot2_f32_bf16 v217, v33, v33, v217
    v_dot2_f32_bf16 v216, v34, v224, v216
    v_dot2_f32_bf16 v217, v34, v34, v217
    v_dot2_f32_bf16 v216, v35, v224, v216
    v_dot2_f32_bf16 v217, v35, v35, v217
    ds_write_b128 v228, v[32:35] offset:0
    buffer_load_dwordx4 a[124:127], v8, s[28:31], s36 offen offset:3072
    v_pk_fma_f32 v[80:81], v[80:81], v[222:223], v[222:223] op_sel:[0,1,0] op_sel_hi:[1,1,0]
    v_pk_fma_f32 v[82:83], v[82:83], v[222:223], v[222:223] op_sel:[0,1,0] op_sel_hi:[1,1,0]
    v_pk_fma_f32 v[84:85], v[84:85], v[222:223], v[222:223] op_sel:[0,1,0] op_sel_hi:[1,1,0]
    v_pk_fma_f32 v[86:87], v[86:87], v[222:223], v[222:223] op_sel:[0,1,0] op_sel_hi:[1,1,0]
    v_pk_fma_f32 v[80:81], v[80:81], v[152:153], v[160:161]
    v_pk_fma_f32 v[82:83], v[82:83], v[154:155], v[162:163]
    v_pk_fma_f32 v[84:85], v[84:85], v[156:157], v[164:165]
    v_pk_fma_f32 v[86:87], v[86:87], v[158:159], v[166:167]
    v_cvt_pk_bf16_f32 v36, v80, v81
    v_cvt_pk_bf16_f32 v37, v82, v83
    v_cvt_pk_bf16_f32 v38, v84, v85
    v_cvt_pk_bf16_f32 v39, v86, v87
    v_dot2_f32_bf16 v218, v36, v224, v218
    v_dot2_f32_bf16 v219, v36, v36, v219
    v_dot2_f32_bf16 v218, v37, v224, v218
    v_dot2_f32_bf16 v219, v37, v37, v219
    v_dot2_f32_bf16 v218, v38, v224, v218
    v_dot2_f32_bf16 v219, v38, v38, v219
    v_dot2_f32_bf16 v218, v39, v224, v218
    s_add_u32 s36, s36, 4096
    buffer_load_dwordx4 a[128:131], v8, s[28:31], s36 offen offset:0
    v_dot2_f32_bf16 v219, v39, v39, v219
    ds_write_b128 v12, v[36:39] offset:0
    s_waitcnt lgkmcnt(1)
    v_pk_fma_f32 v[88:89], v[88:89], v[220:221], v[220:221] op_sel:[0,1,0] op_sel_hi:[1,1,0]
    v_pk_fma_f32 v[90:91], v[90:91], v[220:221], v[220:221] op_sel:[0,1,0] op_sel_hi:[1,1,0]
    v_pk_fma_f32 v[92:93], v[92:93], v[220:221], v[220:221] op_sel:[0,1,0] op_sel_hi:[1,1,0]
    ds_read_b128 v[152:155], v227 offset:11264
    v_pk_fma_f32 v[94:95], v[94:95], v[220:221], v[220:221] op_sel:[0,1,0] op_sel_hi:[1,1,0]
    v_pk_fma_f32 v[88:89], v[88:89], v[168:169], v[176:177]
    v_pk_fma_f32 v[90:91], v[90:91], v[170:171], v[178:179]
    buffer_load_dwordx4 a[132:135], v8, s[28:31], s36 offen offset:1024
    ds_read_b128 v[156:159], v227 offset:11280
    v_pk_fma_f32 v[92:93], v[92:93], v[172:173], v[180:181]
    v_pk_fma_f32 v[94:95], v[94:95], v[174:175], v[182:183]
    v_cvt_pk_bf16_f32 v40, v88, v89
    ds_read_b128 v[160:163], v227 offset:8704
    v_cvt_pk_bf16_f32 v41, v90, v91
    v_cvt_pk_bf16_f32 v42, v92, v93
    v_cvt_pk_bf16_f32 v43, v94, v95
    ds_read_b128 v[164:167], v227 offset:8720
    v_dot2_f32_bf16 v216, v40, v224, v216
    v_dot2_f32_bf16 v217, v40, v40, v217
    v_dot2_f32_bf16 v216, v41, v224, v216
    v_dot2_f32_bf16 v217, v41, v41, v217
    buffer_load_dwordx4 a[136:139], v8, s[28:31], s36 offen offset:2048
    v_dot2_f32_bf16 v216, v42, v224, v216
    v_dot2_f32_bf16 v217, v42, v42, v217
    v_dot2_f32_bf16 v216, v43, v224, v216
    v_dot2_f32_bf16 v217, v43, v43, v217
    ds_write_b128 v228, v[40:43] offset:4096
    v_pk_fma_f32 v[96:97], v[96:97], v[222:223], v[222:223] op_sel:[0,1,0] op_sel_hi:[1,1,0]
    v_pk_fma_f32 v[98:99], v[98:99], v[222:223], v[222:223] op_sel:[0,1,0] op_sel_hi:[1,1,0]
    v_pk_fma_f32 v[100:101], v[100:101], v[222:223], v[222:223] op_sel:[0,1,0] op_sel_hi:[1,1,0]
    v_pk_fma_f32 v[102:103], v[102:103], v[222:223], v[222:223] op_sel:[0,1,0] op_sel_hi:[1,1,0]
    v_pk_fma_f32 v[96:97], v[96:97], v[168:169], v[176:177]
    v_pk_fma_f32 v[98:99], v[98:99], v[170:171], v[178:179]
    v_pk_fma_f32 v[100:101], v[100:101], v[172:173], v[180:181]
    buffer_load_dwordx4 a[140:143], v8, s[28:31], s36 offen offset:3072
    v_pk_fma_f32 v[102:103], v[102:103], v[174:175], v[182:183]
    v_cvt_pk_bf16_f32 v44, v96, v97
    v_cvt_pk_bf16_f32 v45, v98, v99
    v_cvt_pk_bf16_f32 v46, v100, v101
    v_cvt_pk_bf16_f32 v47, v102, v103
    v_dot2_f32_bf16 v218, v44, v224, v218
    v_dot2_f32_bf16 v219, v44, v44, v219
    v_dot2_f32_bf16 v218, v45, v224, v218
    v_dot2_f32_bf16 v219, v45, v45, v219
    v_dot2_f32_bf16 v218, v46, v224, v218
    v_dot2_f32_bf16 v219, v46, v46, v219
    v_dot2_f32_bf16 v218, v47, v224, v218
    v_dot2_f32_bf16 v219, v47, v47, v219
    ds_write_b128 v12, v[44:47] offset:4096
    s_add_u32 s36, s36, 4096
    buffer_load_dwordx4 a[144:147], v8, s[28:31], s36 offen offset:0
    s_waitcnt lgkmcnt(1)
    v_pk_fma_f32 v[104:105], v[104:105], v[220:221], v[220:221] op_sel:[0,1,0] op_sel_hi:[1,1,0]
    v_pk_fma_f32 v[106:107], v[106:107], v[220:221], v[220:221] op_sel:[0,1,0] op_sel_hi:[1,1,0]
    v_pk_fma_f32 v[108:109], v[108:109], v[220:221], v[220:221] op_sel:[0,1,0] op_sel_hi:[1,1,0]
    ds_read_b128 v[168:171], v227 offset:11776
    v_pk_fma_f32 v[110:111], v[110:111], v[220:221], v[220:221] op_sel:[0,1,0] op_sel_hi:[1,1,0]
    v_pk_fma_f32 v[104:105], v[104:105], v[152:153], v[160:161]
    v_pk_fma_f32 v[106:107], v[106:107], v[154:155], v[162:163]
    ds_read_b128 v[172:175], v227 offset:11792
    v_pk_fma_f32 v[108:109], v[108:109], v[156:157], v[164:165]
    v_pk_fma_f32 v[110:111], v[110:111], v[158:159], v[166:167]
    v_cvt_pk_bf16_f32 v48, v104, v105
    ds_read_b128 v[176:179], v227 offset:9216
    buffer_load_dwordx4 a[148:151], v8, s[28:31], s36 offen offset:1024
    v_cvt_pk_bf16_f32 v49, v106, v107
    v_cvt_pk_bf16_f32 v50, v108, v109
    v_cvt_pk_bf16_f32 v51, v110, v111
    ds_read_b128 v[180:183], v227 offset:9232
    v_dot2_f32_bf16 v216, v48, v224, v216
    v_dot2_f32_bf16 v217, v48, v48, v217
    v_dot2_f32_bf16 v216, v49, v224, v216
    v_dot2_f32_bf16 v217, v49, v49, v217
    v_dot2_f32_bf16 v216, v50, v224, v216
    v_dot2_f32_bf16 v217, v50, v50, v217
    v_dot2_f32_bf16 v216, v51, v224, v216
    v_dot2_f32_bf16 v217, v51, v51, v217
    ds_write_b128 v228, v[48:51] offset:8192
    buffer_load_dwordx4 a[152:155], v8, s[28:31], s36 offen offset:2048
    v_pk_fma_f32 v[112:113], v[112:113], v[222:223], v[222:223] op_sel:[0,1,0] op_sel_hi:[1,1,0]
    v_pk_fma_f32 v[114:115], v[114:115], v[222:223], v[222:223] op_sel:[0,1,0] op_sel_hi:[1,1,0]
    v_pk_fma_f32 v[116:117], v[116:117], v[222:223], v[222:223] op_sel:[0,1,0] op_sel_hi:[1,1,0]
    v_pk_fma_f32 v[118:119], v[118:119], v[222:223], v[222:223] op_sel:[0,1,0] op_sel_hi:[1,1,0]
    v_pk_fma_f32 v[112:113], v[112:113], v[152:153], v[160:161]
    v_pk_fma_f32 v[114:115], v[114:115], v[154:155], v[162:163]
    v_pk_fma_f32 v[116:117], v[116:117], v[156:157], v[164:165]
    v_pk_fma_f32 v[118:119], v[118:119], v[158:159], v[166:167]
    v_cvt_pk_bf16_f32 v52, v112, v113
    v_cvt_pk_bf16_f32 v53, v114, v115
    v_cvt_pk_bf16_f32 v54, v116, v117
    v_cvt_pk_bf16_f32 v55, v118, v119
    v_dot2_f32_bf16 v218, v52, v224, v218
    v_dot2_f32_bf16 v219, v52, v52, v219
    v_dot2_f32_bf16 v218, v53, v224, v218
    v_dot2_f32_bf16 v219, v53, v53, v219
    v_dot2_f32_bf16 v218, v54, v224, v218
    v_dot2_f32_bf16 v219, v54, v54, v219
    v_dot2_f32_bf16 v218, v55, v224, v218
    buffer_load_dwordx4 a[156:159], v8, s[28:31], s36 offen offset:3072
    v_dot2_f32_bf16 v219, v55, v55, v219
    ds_write_b128 v12, v[52:55] offset:8192
    s_waitcnt lgkmcnt(1)
    v_pk_fma_f32 v[120:121], v[120:121], v[220:221], v[220:221] op_sel:[0,1,0] op_sel_hi:[1,1,0]
    v_pk_fma_f32 v[122:123], v[122:123], v[220:221], v[220:221] op_sel:[0,1,0] op_sel_hi:[1,1,0]
    v_pk_fma_f32 v[124:125], v[124:125], v[220:221], v[220:221] op_sel:[0,1,0] op_sel_hi:[1,1,0]
    ds_read_b128 v[152:155], v227 offset:12288
    v_pk_fma_f32 v[126:127], v[126:127], v[220:221], v[220:221] op_sel:[0,1,0] op_sel_hi:[1,1,0]
    v_pk_fma_f32 v[120:121], v[120:121], v[168:169], v[176:177]
    v_pk_fma_f32 v[122:123], v[122:123], v[170:171], v[178:179]
    s_add_u32 s36, s36, 4096
    buffer_load_dwordx4 a[160:163], v8, s[28:31], s36 offen offset:0
    ds_read_b128 v[156:159], v227 offset:12304
    v_pk_fma_f32 v[124:125], v[124:125], v[172:173], v[180:181]
    v_pk_fma_f32 v[126:127], v[126:127], v[174:175], v[182:183]
    v_cvt_pk_bf16_f32 v56, v120, v121
    ds_read_b128 v[160:163], v227 offset:9728
    v_cvt_pk_bf16_f32 v57, v122, v123
    v_cvt_pk_bf16_f32 v58, v124, v125
    v_cvt_pk_bf16_f32 v59, v126, v127
    ds_read_b128 v[164:167], v227 offset:9744
    v_dot2_f32_bf16 v216, v56, v224, v216
    v_dot2_f32_bf16 v217, v56, v56, v217
    v_dot2_f32_bf16 v216, v57, v224, v216
    v_dot2_f32_bf16 v217, v57, v57, v217
    buffer_load_dwordx4 a[164:167], v8, s[28:31], s36 offen offset:1024
    v_dot2_f32_bf16 v216, v58, v224, v216
    v_dot2_f32_bf16 v217, v58, v58, v217
    v_dot2_f32_bf16 v216, v59, v224, v216
    v_dot2_f32_bf16 v217, v59, v59, v217
    ds_write_b128 v228, v[56:59] offset:12288
    v_pk_fma_f32 v[128:129], v[128:129], v[222:223], v[222:223] op_sel:[0,1,0] op_sel_hi:[1,1,0]
    v_pk_fma_f32 v[130:131], v[130:131], v[222:223], v[222:223] op_sel:[0,1,0] op_sel_hi:[1,1,0]
    v_pk_fma_f32 v[132:133], v[132:133], v[222:223], v[222:223] op_sel:[0,1,0] op_sel_hi:[1,1,0]
    v_pk_fma_f32 v[134:135], v[134:135], v[222:223], v[222:223] op_sel:[0,1,0] op_sel_hi:[1,1,0]
    v_pk_fma_f32 v[128:129], v[128:129], v[168:169], v[176:177]
    v_pk_fma_f32 v[130:131], v[130:131], v[170:171], v[178:179]
    v_pk_fma_f32 v[132:133], v[132:133], v[172:173], v[180:181]
    buffer_load_dwordx4 a[168:171], v8, s[28:31], s36 offen offset:2048
    v_pk_fma_f32 v[134:135], v[134:135], v[174:175], v[182:183]
    v_cvt_pk_bf16_f32 v60, v128, v129
    v_cvt_pk_bf16_f32 v61, v130, v131
    v_cvt_pk_bf16_f32 v62, v132, v133
    v_cvt_pk_bf16_f32 v63, v134, v135
    v_dot2_f32_bf16 v218, v60, v224, v218
    v_dot2_f32_bf16 v219, v60, v60, v219
    v_dot2_f32_bf16 v218, v61, v224, v218
    v_dot2_f32_bf16 v219, v61, v61, v219
    v_dot2_f32_bf16 v218, v62, v224, v218
    v_dot2_f32_bf16 v219, v62, v62, v219
    v_dot2_f32_bf16 v218, v63, v224, v218
    v_dot2_f32_bf16 v219, v63, v63, v219
    ds_write_b128 v12, v[60:63] offset:12288
    buffer_load_dwordx4 a[172:175], v8, s[28:31], s36 offen offset:3072
    s_waitcnt lgkmcnt(1)
    v_pk_fma_f32 v[136:137], v[136:137], v[220:221], v[220:221] op_sel:[0,1,0] op_sel_hi:[1,1,0]
    v_pk_fma_f32 v[138:139], v[138:139], v[220:221], v[220:221] op_sel:[0,1,0] op_sel_hi:[1,1,0]
    v_pk_fma_f32 v[140:141], v[140:141], v[220:221], v[220:221] op_sel:[0,1,0] op_sel_hi:[1,1,0]
    v_pk_fma_f32 v[142:143], v[142:143], v[220:221], v[220:221] op_sel:[0,1,0] op_sel_hi:[1,1,0]
    v_pk_fma_f32 v[136:137], v[136:137], v[152:153], v[160:161]
    v_pk_fma_f32 v[138:139], v[138:139], v[154:155], v[162:163]
    v_pk_fma_f32 v[140:141], v[140:141], v[156:157], v[164:165]
    v_pk_fma_f32 v[142:143], v[142:143], v[158:159], v[166:167]
    v_cvt_pk_bf16_f32 v64, v136, v137
    v_cvt_pk_bf16_f32 v65, v138, v139
    v_cvt_pk_bf16_f32 v66, v140, v141
    v_cvt_pk_bf16_f32 v67, v142, v143
    v_dot2_f32_bf16 v216, v64, v224, v216
    v_dot2_f32_bf16 v217, v64, v64, v217
    v_dot2_f32_bf16 v216, v65, v224, v216
    v_dot2_f32_bf16 v217, v65, v65, v217
    v_dot2_f32_bf16 v216, v66, v224, v216
    v_dot2_f32_bf16 v217, v66, v66, v217
    s_add_u32 s36, s36, 4096
    buffer_load_dwordx4 a[176:179], v8, s[28:31], s36 offen offset:0
    v_dot2_f32_bf16 v216, v67, v224, v216
    v_dot2_f32_bf16 v217, v67, v67, v217
    ds_write_b128 v228, v[64:67] offset:16384
    v_pk_fma_f32 v[144:145], v[144:145], v[222:223], v[222:223] op_sel:[0,1,0] op_sel_hi:[1,1,0]
    v_pk_fma_f32 v[146:147], v[146:147], v[222:223], v[222:223] op_sel:[0,1,0] op_sel_hi:[1,1,0]
    v_pk_fma_f32 v[148:149], v[148:149], v[222:223], v[222:223] op_sel:[0,1,0] op_sel_hi:[1,1,0]
    v_pk_fma_f32 v[150:151], v[150:151], v[222:223], v[222:223] op_sel:[0,1,0] op_sel_hi:[1,1,0]
    v_pk_fma_f32 v[144:145], v[144:145], v[152:153], v[160:161]
    v_pk_fma_f32 v[146:147], v[146:147], v[154:155], v[162:163]
    v_pk_fma_f32 v[148:149], v[148:149], v[156:157], v[164:165]
    v_pk_fma_f32 v[150:151], v[150:151], v[158:159], v[166:167]
    v_cvt_pk_bf16_f32 v68, v144, v145
    buffer_load_dwordx4 a[180:183], v8, s[28:31], s36 offen offset:1024
    v_cvt_pk_bf16_f32 v69, v146, v147
    v_cvt_pk_bf16_f32 v70, v148, v149
    v_cvt_pk_bf16_f32 v71, v150, v151
    v_dot2_f32_bf16 v218, v68, v224, v218
    v_dot2_f32_bf16 v219, v68, v68, v219
    v_dot2_f32_bf16 v218, v69, v224, v218
    v_dot2_f32_bf16 v219, v69, v69, v219
    v_dot2_f32_bf16 v218, v70, v224, v218
    v_dot2_f32_bf16 v219, v70, v70, v219
    v_dot2_f32_bf16 v218, v71, v224, v218
    v_dot2_f32_bf16 v219, v71, v71, v219
    ds_write_b128 v12, v[68:71] offset:16384
    buffer_load_dwordx4 a[184:187], v8, s[28:31], s36 offen offset:2048
    buffer_load_dwordx4 a[188:191], v8, s[28:31], s36 offen offset:3072
    s_add_u32 s36, s36, 4096
    buffer_load_dwordx4 a[192:195], v8, s[28:31], s36 offen offset:0
    buffer_load_dwordx4 a[196:199], v8, s[28:31], s36 offen offset:1024
    s_nop 1
    s_nop 1
    v_add_f32_dpp v216, v216, v216 quad_perm:[1,0,3,2] row_mask:0xf bank_mask:0xf
    v_add_f32_dpp v217, v217, v217 quad_perm:[1,0,3,2] row_mask:0xf bank_mask:0xf
    v_add_f32_dpp v218, v218, v218 quad_perm:[1,0,3,2] row_mask:0xf bank_mask:0xf
    v_add_f32_dpp v219, v219, v219 quad_perm:[1,0,3,2] row_mask:0xf bank_mask:0xf
    v_add_f32_dpp v216, v216, v216 quad_perm:[2,3,0,1] row_mask:0xf bank_mask:0xf
    v_add_f32_dpp v217, v217, v217 quad_perm:[2,3,0,1] row_mask:0xf bank_mask:0xf
    buffer_load_dwordx4 a[200:203], v8, s[28:31], s37 offen offset:0
    v_add_f32_dpp v218, v218, v218 quad_perm:[2,3,0,1] row_mask:0xf bank_mask:0xf
    v_add_f32_dpp v219, v219, v219 quad_perm:[2,3,0,1] row_mask:0xf bank_mask:0xf
    v_add_f32_dpp v216, v216, v216 row_half_mirror row_mask:0xf bank_mask:0xf
    v_add_f32_dpp v217, v217, v217 row_half_mirror row_mask:0xf bank_mask:0xf
    v_add_f32_dpp v218, v218, v218 row_half_mirror row_mask:0xf bank_mask:0xf
    v_add_f32_dpp v219, v219, v219 row_half_mirror row_mask:0xf bank_mask:0xf
    v_add_f32_dpp v216, v216, v216 row_mirror row_mask:0xf bank_mask:0xf
    v_add_f32_dpp v217, v217, v217 row_mirror row_mask:0xf bank_mask:0xf
    v_add_f32_dpp v218, v218, v218 row_mirror row_mask:0xf bank_mask:0xf
    v_add_f32_dpp v219, v219, v219 row_mirror row_mask:0xf bank_mask:0xf
    v_mul_f32 v216, 0x3acccccd, v216
    v_mul_f32 v218, 0x3acccccd, v218
    v_mul_f32 v217, 0x3acccccd, v217
    v_mul_f32 v219, 0x3acccccd, v219
    v_fma_f32 v217, -v216, v216, v217
    v_fma_f32 v219, -v218, v218, v219
    v_max_f32 v217, 0, v217
    v_max_f32 v219, 0, v219
    v_cvt_pk_bf16_f32 v192, v216, v217
    buffer_load_dwordx4 a[204:207], v8, s[28:31], s37 offen offset:1024
    v_cvt_pk_bf16_f32 v193, v218, v219
    v_lshlrev_b32 v216, 16, v192
    v_lshlrev_b32 v218, 16, v193
    v_and_b32 v217, 0xffff0000, v192
    v_and_b32 v219, 0xffff0000, v193
    v_add_f32 v217, 0x3727c5ac, v217
    v_add_f32 v219, 0x3727c5ac, v219
    v_cvt_pk_bf16_f32 v192, v217, v217
    v_cvt_pk_bf16_f32 v193, v219, v219
    v_lshlrev_b32 v217, 16, v192
    v_lshlrev_b32 v219, 16, v193
    v_sqrt_f32 v217, v217
    v_sqrt_f32 v219, v219
    s_nop 0
    s_nop 0
    v_cvt_pk_bf16_f32 v192, v217, v217
    v_cvt_pk_bf16_f32 v193, v219, v219
    buffer_load_dwordx4 a[208:211], v8, s[28:31], s37 offen offset:2048
    v_lshlrev_b32 v217, 16, v192
    v_lshlrev_b32 v219, 16, v193
    v_rcp_f32 v217, v217
    v_rcp_f32 v219, v219
    s_nop 0
    s_nop 0
    v_mul_f32 v216, v216, v217
    v_mul_f32 v218, v218, v219
    v_sub_f32 v216, 0, v216
    v_sub_f32 v218, 0, v218
    s_lshl_b32 s26, s20, 6
    v_lshl_add_u32 v2, v3, 3, s26
    v_add_u32 v2, 138240, v2
    ds_write_b64 v2, v[216:217]
    buffer_load_dwordx4 a[212:215], v8, s[28:31], s37 offen offset:3072
    ds_write_b64 v2, v[218:219] offset:32
    s_waitcnt lgkmcnt(0)
    s_barrier
    ds_read_b128 v[72:75], v229 offset:0
    ds_read_b128 v[76:79], v231 offset:0
    s_waitcnt vmcnt(49) lgkmcnt(0)
    v_mfma_f32_16x16x32_bf16 v[32:35], a[0:3], v[72:75], 0
    s_add_u32 s37, s37, 4096
    buffer_load_dwordx4 a[216:219], v8, s[28:31], s37 offen offset:0
    v_mfma_f32_16x16x32_bf16 v[52:55], a[0:3], v[76:79], 0
    ds_read_b128 v[80:83], v230 offset:1024
    v_mfma_f32_16x16x32_bf16 v[36:39], a[4:7], v[72:75], 0
    v_mfma_f32_16x16x32_bf16 v[56:59], a[4:7], v[76:79], 0
    ds_read_b128 v[84:87], v232 offset:1024
    v_mfma_f32_16x16x32_bf16 v[40:43], a[8:11], v[72:75], 0
    buffer_load_dwordx4 a[220:223], v8, s[28:31], s37 offen offset:1024
    v_mfma_f32_16x16x32_bf16 v[60:63], a[8:11], v[76:79], 0
    ds_read_b128 v[112:115], v233 offset:0
    v_mfma_f32_16x16x32_bf16 v[44:47], a[12:15], v[72:75], 0
    v_mfma_f32_16x16x32_bf16 v[64:67], a[12:15], v[76:79], 0
    ds_read_b128 v[132:135], v233 offset:1024
    v_mfma_f32_16x16x32_bf16 v[48:51], a[16:19], v[72:75], 0
    buffer_load_dwordx4 a[224:227], v8, s[28:31], s37 offen offset:2048
    v_mfma_f32_16x16x32_bf16 v[68:71], a[16:19], v[76:79], 0
    s_waitcnt vmcnt(47) lgkmcnt(0)
    v_mfma_f32_16x16x32_bf16 v[32:35], a[20:23], v[80:83], v[32:35]
    v_mfma_f32_16x16x32_bf16 v[52:55], a[20:23], v[84:87], v[52:55]
    ds_read_b128 v[72:75], v229 offset:2048
    v_mfma_f32_16x16x32_bf16 v[36:39], a[24:27], v[80:83], v[36:39]
    buffer_load_dwordx4 a[228:231], v8, s[28:31], s37 offen offset:3072
    v_mfma_f32_16x16x32_bf16 v[56:59], a[24:27], v[84:87], v[56:59]
    ds_read_b128 v[76:79], v231 offset:2048
    v_mfma_f32_16x16x32_bf16 v[40:43], a[28:31], v[80:83], v[40:43]
    v_mfma_f32_16x16x32_bf16 v[60:63], a[28:31], v[84:87], v[60:63]
    ds_read_b128 v[116:119], v233 offset:64
    v_mfma_f32_16x16x32_bf16 v[44:47], a[32:35], v[80:83], v[44:47]
    s_add_u32 s37, s37, 4096
    buffer_load_dwordx4 a[232:235], v8, s[28:31], s37 offen offset:0
    v_mfma_f32_16x16x32_bf16 v[64:67], a[32:35], v[84:87], v[64:67]
    ds_read_b128 v[136:139], v233 offset:1088
    v_mfma_f32_16x16x32_bf16 v[48:51], a[36:39], v[80:83], v[48:51]
    v_mfma_f32_16x16x32_bf16 v[68:71], a[36:39], v[84:87], v[68:71]
    s_waitcnt vmcnt(44) lgkmcnt(0)
    v_mfma_f32_16x16x32_bf16 v[32:35], a[40:43], v[72:75], v[32:35]
    buffer_load_dwordx4 a[236:239], v8, s[28:31], s37 offen offset:1024
    v_mfma_f32_16x16x32_bf16 v[52:55], a[40:43], v[76:79], v[52:55]
    ds_read_b128 v[80:83], v230 offset:3072
    v_mfma_f32_16x16x32_bf16 v[36:39], a[44:47], v[72:75], v[36:39]
    v_mfma_f32_16x16x32_bf16 v[56:59], a[44:47], v[76:79], v[56:59]
    ds_read_b128 v[84:87], v232 offset:3072
    v_mfma_f32_16x16x32_bf16 v[40:43], a[48:51], v[72:75], v[40:43]
    buffer_load_dwordx4 a[240:243], v8, s[28:31], s37 offen offset:2048
    v_mfma_f32_16x16x32_bf16 v[60:63], a[48:51], v[76:79], v[60:63]
    ds_read_b128 v[120:123], v233 offset:128
    v_mfma_f32_16x16x32_bf16 v[44:47], a[52:55], v[72:75], v[44:47]
    v_mfma_f32_16x16x32_bf16 v[64:67], a[52:55], v[76:79], v[64:67]
    ds_read_b128 v[140:143], v233 offset:1152
    v_mfma_f32_16x16x32_bf16 v[48:51], a[56:59], v[72:75], v[48:51]
    buffer_load_dwordx4 a[244:247], v8, s[28:31], s37 offen offset:3072
    v_mfma_f32_16x16x32_bf16 v[68:71], a[56:59], v[76:79], v[68:71]
    s_waitcnt vmcnt(42) lgkmcnt(0)
    v_mfma_f32_16x16x32_bf16 v[32:35], a[60:63], v[80:83], v[32:35]
    v_mfma_f32_16x16x32_bf16 v[52:55], a[60:63], v[84:87], v[52:55]
    ds_read_b128 v[72:75], v229 offset:4096
    v_mfma_f32_16x16x32_bf16 v[36:39], a[64:67], v[80:83], v[36:39]
    s_add_u32 s37, s37, 4096
    buffer_load_dwordx4 a[248:251], v8, s[28:31], s37 offen offset:0
    v_mfma_f32_16x16x32_bf16 v[56:59], a[64:67], v[84:87], v[56:59]
    ds_read_b128 v[76:79], v231 offset:4096
    v_mfma_f32_16x16x32_bf16 v[40:43], a[68:71], v[80:83], v[40:43]
    v_mfma_f32_16x16x32_bf16 v[60:63], a[68:71], v[84:87], v[60:63]
    ds_read_b128 v[124:127], v233 offset:192
    v_mfma_f32_16x16x32_bf16 v[44:47], a[72:75], v[80:83], v[44:47]
    buffer_load_dwordx4 a[252:255], v8, s[28:31], s37 offen offset:1024
    v_mfma_f32_16x16x32_bf16 v[64:67], a[72:75], v[84:87], v[64:67]
    ds_read_b128 v[144:147], v233 offset:1216
    v_mfma_f32_16x16x32_bf16 v[48:51], a[76:79], v[80:83], v[48:51]
    v_mfma_f32_16x16x32_bf16 v[68:71], a[76:79], v[84:87], v[68:71]
    s_waitcnt vmcnt(39) lgkmcnt(0)
    v_mfma_f32_16x16x32_bf16 v[32:35], a[80:83], v[72:75], v[32:35]
    buffer_load_dwordx4 a[0:3], v8, s[28:31], s37 offen offset:2048
    v_mfma_f32_16x16x32_bf16 v[52:55], a[80:83], v[76:79], v[52:55]
    ds_read_b128 v[80:83], v230 offset:5120
    v_mfma_f32_16x16x32_bf16 v[36:39], a[84:87], v[72:75], v[36:39]
    v_mfma_f32_16x16x32_bf16 v[56:59], a[84:87], v[76:79], v[56:59]
    ds_read_b128 v[84:87], v232 offset:5120
    v_mfma_f32_16x16x32_bf16 v[40:43], a[88:91], v[72:75], v[40:43]
    buffer_load_dwordx4 a[4:7], v8, s[28:31], s37 offen offset:3072
    v_mfma_f32_16x16x32_bf16 v[60:63], a[88:91], v[76:79], v[60:63]
    ds_read_b128 v[128:131], v234
    v_mfma_f32_16x16x32_bf16 v[44:47], a[92:95], v[72:75], v[44:47]
    v_mfma_f32_16x16x32_bf16 v[64:67], a[92:95], v[76:79], v[64:67]
    ds_read_b128 v[148:151], v234 offset:1024
    v_mfma_f32_16x16x32_bf16 v[48:51], a[96:99], v[72:75], v[48:51]
    s_add_u32 s37, s37, 4096
    buffer_load_dwordx4 a[8:11], v8, s[28:31], s37 offen offset:0
    v_mfma_f32_16x16x32_bf16 v[68:71], a[96:99], v[76:79], v[68:71]
    s_waitcnt vmcnt(37) lgkmcnt(0)
    v_mfma_f32_16x16x32_bf16 v[32:35], a[100:103], v[80:83], v[32:35]
    v_mfma_f32_16x16x32_bf16 v[52:55], a[100:103], v[84:87], v[52:55]
    ds_read_b128 v[72:75], v229 offset:6144
    v_mfma_f32_16x16x32_bf16 v[36:39], a[104:107], v[80:83], v[36:39]
    buffer_load_dwordx4 a[12:15], v8, s[28:31], s37 offen offset:1024
    v_mfma_f32_16x16x32_bf16 v[56:59], a[104:107], v[84:87], v[56:59]
    ds_read_b128 v[76:79], v231 offset:6144
    v_mfma_f32_16x16x32_bf16 v[40:43], a[108:111], v[80:83], v[40:43]
    v_mfma_f32_16x16x32_bf16 v[60:63], a[108:111], v[84:87], v[60:63]
    ds_read_b64 v[152:153], v235
    v_mfma_f32_16x16x32_bf16 v[44:47], a[112:115], v[80:83], v[44:47]
    buffer_load_dwordx4 a[16:19], v8, s[28:31], s37 offen offset:2048
    v_mfma_f32_16x16x32_bf16 v[64:67], a[112:115], v[84:87], v[64:67]
    ds_read_b64 v[16:17], v236
    v_mfma_f32_16x16x32_bf16 v[48:51], a[116:119], v[80:83], v[48:51]
    v_mfma_f32_16x16x32_bf16 v[68:71], a[116:119], v[84:87], v[68:71]
    s_waitcnt vmcnt(34) lgkmcnt(0)
    v_mfma_f32_16x16x32_bf16 v[32:35], a[120:123], v[72:75], v[32:35]
    buffer_load_dwordx4 a[20:23], v8, s[28:31], s37 offen offset:3072
    v_mfma_f32_16x16x32_bf16 v[52:55], a[120:123], v[76:79], v[52:55]
    ds_read_b128 v[80:83], v230 offset:7168
    v_mfma_f32_16x16x32_bf16 v[36:39], a[124:127], v[72:75], v[36:39]
    v_mfma_f32_16x16x32_bf16 v[56:59], a[124:127], v[76:79], v[56:59]
    ds_read_b128 v[84:87], v232 offset:7168
    v_mfma_f32_16x16x32_bf16 v[40:43], a[128:131], v[72:75], v[40:43]
    s_add_u32 s37, s37, 4096
    buffer_load_dwordx4 a[24:27], v8, s[28:31], s37 offen offset:0
    v_mfma_f32_16x16x32_bf16 v[60:63], a[128:131], v[76:79], v[60:63]
    ds_read_b64 v[18:19], v237
    v_mfma_f32_16x16x32_bf16 v[44:47], a[132:135], v[72:75], v[44:47]
    v_mfma_f32_16x16x32_bf16 v[64:67], a[132:135], v[76:79], v[64:67]
    ds_read_b64 v[20:21], v238
    v_mfma_f32_16x16x32_bf16 v[48:51], a[136:139], v[72:75], v[48:51]
    buffer_load_dwordx4 a[28:31], v8, s[28:31], s37 offen offset:1024
    v_mfma_f32_16x16x32_bf16 v[68:71], a[136:139], v[76:79], v[68:71]
    s_waitcnt vmcnt(32) lgkmcnt(0)
    v_mfma_f32_16x16x32_bf16 v[32:35], a[140:143], v[80:83], v[32:35]
    v_mfma_f32_16x16x32_bf16 v[52:55], a[140:143], v[84:87], v[52:55]
    ds_read_b128 v[72:75], v229 offset:8192
    v_mfma_f32_16x16x32_bf16 v[36:39], a[144:147], v[80:83], v[36:39]
    buffer_load_dwordx4 a[32:35], v8, s[28:31], s37 offen offset:2048
    v_mfma_f32_16x16x32_bf16 v[56:59], a[144:147], v[84:87], v[56:59]
    ds_read_b128 v[76:79], v231 offset:8192
    v_mfma_f32_16x16x32_bf16 v[40:43], a[148:151], v[80:83], v[40:43]
    v_mfma_f32_16x16x32_bf16 v[60:63], a[148:151], v[84:87], v[60:63]
    ds_read_b64 v[22:23], v239
    v_mfma_f32_16x16x32_bf16 v[44:47], a[152:155], v[80:83], v[44:47]
    buffer_load_dwordx4 a[36:39], v8, s[28:31], s37 offen offset:3072
    v_mfma_f32_16x16x32_bf16 v[64:67], a[152:155], v[84:87], v[64:67]
    ds_read_b64 v[24:25], v240
    v_mfma_f32_16x16x32_bf16 v[48:51], a[156:159], v[80:83], v[48:51]
    v_mfma_f32_16x16x32_bf16 v[68:71], a[156:159], v[84:87], v[68:71]
    s_waitcnt vmcnt(29) lgkmcnt(0)
    v_mfma_f32_16x16x32_bf16 v[32:35], a[160:163], v[72:75], v[32:35]
    s_add_u32 s37, s37, 4096
    buffer_load_dwordx4 a[40:43], v8, s[28:31], s37 offen offset:0
    v_mfma_f32_16x16x32_bf16 v[52:55], a[160:163], v[76:79], v[52:55]
    ds_read_b128 v[80:83], v230 offset:9216
    v_mfma_f32_16x16x32_bf16 v[36:39], a[164:167], v[72:75], v[36:39]
    v_mfma_f32_16x16x32_bf16 v[56:59], a[164:167], v[76:79], v[56:59]
    ds_read_b128 v[84:87], v232 offset:9216
    v_mfma_f32_16x16x32_bf16 v[40:43], a[168:171], v[72:75], v[40:43]
    buffer_load_dwordx4 a[44:47], v8, s[28:31], s37 offen offset:1024
    v_mfma_f32_16x16x32_bf16 v[60:63], a[168:171], v[76:79], v[60:63]
    v_mfma_f32_16x16x32_bf16 v[44:47], a[172:175], v[72:75], v[44:47]
    v_mfma_f32_16x16x32_bf16 v[64:67], a[172:175], v[76:79], v[64:67]
    v_mfma_f32_16x16x32_bf16 v[48:51], a[176:179], v[72:75], v[48:51]
    v_mfma_f32_16x16x32_bf16 v[68:71], a[176:179], v[76:79], v[68:71]
    buffer_load_dwordx4 a[48:51], v8, s[28:31], s37 offen offset:2048
    s_waitcnt vmcnt(27) lgkmcnt(0)
    v_mfma_f32_16x16x32_bf16 v[32:35], a[180:183], v[80:83], v[32:35]
    v_mfma_f32_16x16x32_bf16 v[52:55], a[180:183], v[84:87], v[52:55]
    v_mfma_f32_16x16x32_bf16 v[36:39], a[184:187], v[80:83], v[36:39]
    v_mfma_f32_16x16x32_bf16 v[56:59], a[184:187], v[84:87], v[56:59]
    v_mfma_f32_16x16x32_bf16 v[40:43], a[188:191], v[80:83], v[40:43]
    buffer_load_dwordx4 a[52:55], v8, s[28:31], s37 offen offset:3072
    v_mfma_f32_16x16x32_bf16 v[60:63], a[188:191], v[84:87], v[60:63]
    v_mfma_f32_16x16x32_bf16 v[44:47], a[192:195], v[80:83], v[44:47]
    v_mfma_f32_16x16x32_bf16 v[64:67], a[192:195], v[84:87], v[64:67]
    v_mfma_f32_16x16x32_bf16 v[48:51], a[196:199], v[80:83], v[48:51]
    v_mfma_f32_16x16x32_bf16 v[68:71], a[196:199], v[84:87], v[68:71]
    s_add_u32 s37, s37, 4096
    buffer_load_dwordx4 a[56:59], v8, s[28:31], s37 offen offset:0
    s_waitcnt lgkmcnt(0)
    s_nop 4
    ds_write_b128 v246, v[52:55] offset:0
    ds_write_b128 v246, v[56:59] offset:1024
    buffer_load_dwordx4 a[60:63], v8, s[28:31], s37 offen offset:1024
    ds_write_b128 v246, v[60:63] offset:2048
    ds_write_b128 v246, v[64:67] offset:3072
    ds_write_b128 v246, v[68:71] offset:4096
    buffer_load_dwordx4 a[64:67], v8, s[28:31], s37 offen offset:2048
    v_pk_add_f32 v[112:113], v[112:113], v[132:133]
    v_pk_add_f32 v[114:115], v[114:115], v[134:135]
    v_pk_add_f32 v[116:117], v[116:117], v[136:137]
    v_pk_add_f32 v[118:119], v[118:119], v[138:139]
    v_pk_add_f32 v[120:121], v[120:121], v[140:141]
    v_pk_add_f32 v[122:123], v[122:123], v[142:143]
    v_pk_add_f32 v[124:125], v[124:125], v[144:145]
    v_pk_add_f32 v[126:127], v[126:127], v[146:147]
    v_pk_add_f32 v[128:129], v[128:129], v[148:149]
    v_pk_add_f32 v[130:131], v[130:131], v[150:151]
    v_pk_mul_f32 v[112:113], v[112:113], v[152:153] op_sel_hi:[1,0]
    v_pk_mul_f32 v[114:115], v[114:115], v[152:153] op_sel_hi:[1,0]
    v_pk_mul_f32 v[116:117], v[116:117], v[152:153] op_sel_hi:[1,0]
    v_pk_mul_f32 v[118:119], v[118:119], v[152:153] op_sel_hi:[1,0]
    v_pk_mul_f32 v[120:121], v[120:121], v[152:153] op_sel_hi:[1,0]
    v_pk_mul_f32 v[122:123], v[122:123], v[152:153] op_sel_hi:[1,0]
    v_pk_mul_f32 v[124:125], v[124:125], v[152:153] op_sel_hi:[1,0]
    v_pk_mul_f32 v[126:127], v[126:127], v[152:153] op_sel_hi:[1,0]
    v_pk_mul_f32 v[128:129], v[128:129], v[152:153] op_sel_hi:[1,0]
    buffer_load_dwordx4 a[68:71], v8, s[28:31], s37 offen offset:3072
    v_pk_mul_f32 v[130:131], v[130:131], v[152:153] op_sel_hi:[1,0]
    v_mov_b32 v30, 0xbdd2d3e8
    v_mov_b32 v31, 0xc0135761
    s_waitcnt lgkmcnt(0)
    s_barrier
    ds_read_b128 v[88:91], v247 offset:0
    ds_read_b128 v[92:95], v247 offset:1024
    ds_read_b128 v[96:99], v247 offset:2048
    ds_read_b128 v[100:103], v247 offset:3072
    ds_read_b128 v[104:107], v247 offset:4096
    s_add_u32 s37, s37, 4096
    buffer_load_dwordx4 a[72:75], v8, s[28:31], s37 offen offset:0
    s_waitcnt lgkmcnt(4)
    v_pk_add_f32 v[32:33], v[32:33], v[88:89]
    v_pk_add_f32 v[34:35], v[34:35], v[90:91]
    s_waitcnt lgkmcnt(3)
    v_pk_add_f32 v[36:37], v[36:37], v[92:93]
    v_pk_add_f32 v[38:39], v[38:39], v[94:95]
    s_waitcnt lgkmcnt(2)
    v_pk_add_f32 v[40:41], v[40:41], v[96:97]
    v_pk_add_f32 v[42:43], v[42:43], v[98:99]
    s_waitcnt lgkmcnt(1)
    v_pk_add_f32 v[44:45], v[44:45], v[100:101]
    v_pk_add_f32 v[46:47], v[46:47], v[102:103]
    s_waitcnt lgkmcnt(0)
    v_pk_add_f32 v[48:49], v[48:49], v[104:105]
    v_pk_add_f32 v[50:51], v[50:51], v[106:107]
    v_pk_fma_f32 v[32:33], v[32:33], v[152:153], v[112:113] op_sel:[0,1,0] op_sel_hi:[1,1,1]
    v_pk_fma_f32 v[34:35], v[34:35], v[152:153], v[114:115] op_sel:[0,1,0] op_sel_hi:[1,1,1]
    v_pk_fma_f32 v[36:37], v[36:37], v[152:153], v[116:117] op_sel:[0,1,0] op_sel_hi:[1,1,1]
    v_pk_fma_f32 v[38:39], v[38:39], v[152:153], v[118:119] op_sel:[0,1,0] op_sel_hi:[1,1,1]
    buffer_load_dwordx4 a[76:79], v8, s[28:31], s37 offen offset:1024
    v_pk_fma_f32 v[40:41], v[40:41], v[152:153], v[120:121] op_sel:[0,1,0] op_sel_hi:[1,1,1]
    v_pk_fma_f32 v[42:43], v[42:43], v[152:153], v[122:123] op_sel:[0,1,0] op_sel_hi:[1,1,1]
    v_pk_fma_f32 v[44:45], v[44:45], v[152:153], v[124:125] op_sel:[0,1,0] op_sel_hi:[1,1,1]
    v_pk_fma_f32 v[46:47], v[46:47], v[152:153], v[126:127] op_sel:[0,1,0] op_sel_hi:[1,1,1]
    v_pk_fma_f32 v[48:49], v[48:49], v[152:153], v[128:129] op_sel:[0,1,0] op_sel_hi:[1,1,1]
    v_pk_fma_f32 v[50:51], v[50:51], v[152:153], v[130:131] op_sel:[0,1,0] op_sel_hi:[1,1,1]
    v_pk_mul_f32 v[192:193], v[32:33], v[32:33]
    v_pk_mul_f32 v[194:195], v[34:35], v[34:35]
    v_pk_mul_f32 v[196:197], v[36:37], v[36:37]
    v_pk_mul_f32 v[198:199], v[38:39], v[38:39]
    v_pk_mul_f32 v[200:201], v[40:41], v[40:41]
    v_pk_mul_f32 v[202:203], v[42:43], v[42:43]
    v_pk_mul_f32 v[204:205], v[44:45], v[44:45]
    v_pk_mul_f32 v[206:207], v[46:47], v[46:47]
    v_pk_mul_f32 v[208:209], v[48:49], v[48:49]
    v_pk_mul_f32 v[210:211], v[50:51], v[50:51]
    v_pk_fma_f32 v[192:193], v[192:193], v[30:31], v[30:31] op_sel:[0,0,1] op_sel_hi:[1,0,1]
    v_pk_fma_f32 v[194:195], v[194:195], v[30:31], v[30:31] op_sel:[0,0,1] op_sel_hi:[1,0,1]
    v_pk_fma_f32 v[196:197], v[196:197], v[30:31], v[30:31] op_sel:[0,0,1] op_sel_hi:[1,0,1]
    buffer_load_dwordx4 a[80:83], v8, s[28:31], s37 offen offset:2048
    v_pk_fma_f32 v[198:199], v[198:199], v[30:31], v[30:31] op_sel:[0,0,1] op_sel_hi:[1,0,1]
    v_pk_fma_f32 v[200:201], v[200:201], v[30:31], v[30:31] op_sel:[0,0,1] op_sel_hi:[1,0,1]
    v_pk_fma_f32 v[202:203], v[202:203], v[30:31], v[30:31] op_sel:[0,0,1] op_sel_hi:[1,0,1]
    v_pk_fma_f32 v[204:205], v[204:205], v[30:31], v[30:31] op_sel:[0,0,1] op_sel_hi:[1,0,1]
    v_pk_fma_f32 v[206:207], v[206:207], v[30:31], v[30:31] op_sel:[0,0,1] op_sel_hi:[1,0,1]
    v_pk_fma_f32 v[208:209], v[208:209], v[30:31], v[30:31] op_sel:[0,0,1] op_sel_hi:[1,0,1]
    v_pk_fma_f32 v[210:211], v[210:211], v[30:31], v[30:31] op_sel:[0,0,1] op_sel_hi:[1,0,1]
    v_pk_mul_f32 v[192:193], v[192:193], v[32:33]
    v_pk_mul_f32 v[194:195], v[194:195], v[34:35]
    v_pk_mul_f32 v[196:197], v[196:197], v[36:37]
    v_pk_mul_f32 v[198:199], v[198:199], v[38:39]
    v_pk_mul_f32 v[200:201], v[200:201], v[40:41]
    v_pk_mul_f32 v[202:203], v[202:203], v[42:43]
    v_pk_mul_f32 v[204:205], v[204:205], v[44:45]
    v_pk_mul_f32 v[206:207], v[206:207], v[46:47]
    v_pk_mul_f32 v[208:209], v[208:209], v[48:49]
    v_pk_mul_f32 v[210:211], v[210:211], v[50:51]
    v_exp_f32 v192, v192
    buffer_load_dwordx4 a[84:87], v8, s[28:31], s37 offen offset:3072
    v_exp_f32 v193, v193
    v_exp_f32 v194, v194
    v_exp_f32 v195, v195
    v_exp_f32 v196, v196
    v_exp_f32 v197, v197
    v_exp_f32 v198, v198
    v_exp_f32 v199, v199
    v_exp_f32 v200, v200
    v_exp_f32 v201, v201
    v_exp_f32 v202, v202
    s_add_u32 s37, s37, 4096
    buffer_load_dwordx4 a[88:91], v8, s[28:31], s37 offen offset:0
    v_exp_f32 v203, v203
    v_exp_f32 v204, v204
    v_exp_f32 v205, v205
    v_exp_f32 v206, v206
    v_exp_f32 v207, v207
    v_exp_f32 v208, v208
    v_exp_f32 v209, v209
    v_exp_f32 v210, v210
    v_exp_f32 v211, v211
    v_pk_add_f32 v[192:193], v[192:193], 1.0 op_sel_hi:[1,0]
    buffer_load_dwordx4 a[92:95], v8, s[28:31], s37 offen offset:1024
    v_pk_add_f32 v[194:195], v[194:195], 1.0 op_sel_hi:[1,0]
    v_pk_add_f32 v[196:197], v[196:197], 1.0 op_sel_hi:[1,0]
    v_pk_add_f32 v[198:199], v[198:199], 1.0 op_sel_hi:[1,0]
    v_pk_add_f32 v[200:201], v[200:201], 1.0 op_sel_hi:[1,0]
    v_pk_add_f32 v[202:203], v[202:203], 1.0 op_sel_hi:[1,0]
    v_pk_add_f32 v[204:205], v[204:205], 1.0 op_sel_hi:[1,0]
    v_pk_add_f32 v[206:207], v[206:207], 1.0 op_sel_hi:[1,0]
    v_pk_add_f32 v[208:209], v[208:209], 1.0 op_sel_hi:[1,0]
    v_pk_add_f32 v[210:211], v[210:211], 1.0 op_sel_hi:[1,0]
    v_rcp_f32 v192, v192
    v_rcp_f32 v193, v193
    v_rcp_f32 v194, v194
    v_rcp_f32 v195, v195
    v_rcp_f32 v196, v196
    buffer_load_dwordx4 a[96:99], v8, s[28:31], s37 offen offset:2048
    v_rcp_f32 v197, v197
    v_rcp_f32 v198, v198
    v_rcp_f32 v199, v199
    v_rcp_f32 v200, v200
    v_rcp_f32 v201, v201
    v_rcp_f32 v202, v202
    v_rcp_f32 v203, v203
    v_rcp_f32 v204, v204
    v_rcp_f32 v205, v205
    v_rcp_f32 v206, v206
    buffer_load_dwordx4 a[100:103], v8, s[28:31], s37 offen offset:3072
    v_rcp_f32 v207, v207
    v_rcp_f32 v208, v208
    v_rcp_f32 v209, v209
    v_rcp_f32 v210, v210
    v_rcp_f32 v211, v211
    v_pk_mul_f32 v[32:33], v[32:33], v[192:193]
    v_pk_mul_f32 v[34:35], v[34:35], v[194:195]
    v_pk_mul_f32 v[36:37], v[36:37], v[196:197]
    v_pk_mul_f32 v[38:39], v[38:39], v[198:199]
    v_pk_mul_f32 v[40:41], v[40:41], v[200:201]
    v_pk_mul_f32 v[42:43], v[42:43], v[202:203]
    v_pk_mul_f32 v[44:45], v[44:45], v[204:205]
    v_pk_mul_f32 v[46:47], v[46:47], v[206:207]
    v_pk_mul_f32 v[48:49], v[48:49], v[208:209]
    s_add_u32 s37, s37, 4096
    buffer_load_dwordx4 a[104:107], v8, s[28:31], s37 offen offset:0
    v_pk_mul_f32 v[50:51], v[50:51], v[210:211]
    v_cvt_pk_bf16_f32 v180, v32, v33
    v_cvt_pk_bf16_f32 v181, v34, v35
    v_cvt_pk_bf16_f32 v182, v36, v37
    v_cvt_pk_bf16_f32 v183, v38, v39
    v_cvt_pk_bf16_f32 v184, v40, v41
    v_cvt_pk_bf16_f32 v185, v42, v43
    v_cvt_pk_bf16_f32 v186, v44, v45
    v_cvt_pk_bf16_f32 v187, v46, v47
    v_cvt_pk_bf16_f32 v188, v48, v49
    v_cvt_pk_bf16_f32 v189, v50, v51
    s_nop 1
    v_permlane16_swap_b32 v180, v182
    v_permlane16_swap_b32 v181, v183
    v_permlane16_swap_b32 v184, v186
    v_permlane16_swap_b32 v185, v187
    s_mov_b64 exec, s[60:61]
    buffer_store_dwordx4 v[180:183], v241, s[28:31], s44 offen sc1
    buffer_store_dwordx4 v[184:187], v241, s[28:31], s44 offen offset:1024 sc1
    buffer_store_dwordx2 v[188:189], v242, s[28:31], s45 offen sc1
    s_mov_b64 exec, -1
    s_waitcnt vmcnt(0)
    s_barrier
    s_cmp_lg_u32 s20, 0
    s_cbranch_scc1 chain_kernel_sig1
    v_mov_b32 v2, 1
    v_mov_b32 v7, 0
    s_mov_b64 exec, 1
    buffer_store_dword v2, v7, s[28:31], s46 offen sc1
    s_mov_b64 exec, -1
chain_kernel_sig1:
    buffer_load_dwordx4 a[108:111], v8, s[28:31], s37 offen offset:1024
    buffer_load_dwordx4 a[112:115], v8, s[28:31], s37 offen offset:2048
    buffer_load_dwordx4 a[116:119], v8, s[28:31], s37 offen offset:3072
    s_add_u32 s37, s37, 4096
    buffer_load_dwordx4 a[120:123], v8, s[28:31], s37 offen offset:0
    buffer_load_dwordx4 a[124:127], v8, s[28:31], s37 offen offset:1024
    buffer_load_dwordx4 a[128:131], v8, s[28:31], s37 offen offset:2048
    buffer_load_dwordx4 a[132:135], v8, s[28:31], s37 offen offset:3072
    s_add_u32 s37, s37, 4096
    buffer_load_dwordx4 a[136:139], v8, s[28:31], s37 offen offset:0
    buffer_load_dwordx4 a[140:143], v8, s[28:31], s37 offen offset:1024
    s_mul_i32 s25, s20, 10
    s_lshl_b32 s25, s25, 10
    s_add_u32 s62, s25, 0
    s_add_u32 s63, s25, s54
    s_add_u32 s63, s63, 0
    s_mov_b32 m0, s62
    buffer_load_dwordx4 v8, s[28:31], s63 offen offset:0 lds
    buffer_load_dwordx4 v8, s[28:31], s63 offen offset:1024 lds
    buffer_load_dwordx4 v8, s[28:31], s63 offen offset:2048 lds
    buffer_load_dwordx4 v8, s[28:31], s63 offen offset:3072 lds
    s_add_u32 s62, s62, 4096
    s_add_u32 s63, s63, 4096
    s_mov_b32 m0, s62
    buffer_load_dwordx4 v8, s[28:31], s63 offen offset:0 lds
    buffer_load_dwordx4 v8, s[28:31], s63 offen offset:1024 lds
    buffer_load_dwordx4 v8, s[28:31], s63 offen offset:2048 lds
    buffer_load_dwordx4 v8, s[28:31], s63 offen offset:3072 lds
    s_add_u32 s62, s62, 4096
    s_add_u32 s63, s63, 4096
    s_mov_b32 m0, s62
    buffer_load_dwordx4 v8, s[28:31], s63 offen offset:0 lds
    buffer_load_dwordx4 v8, s[28:31], s63 offen offset:1024 lds
    s_mov_b32 s48, 31940608
    s_mov_b32 s47, 0
    s_mov_b64 exec, 15
chain_kernel_poll2:
    buffer_load_dword v2, v245, s[28:31], s48 offen sc1
    s_add_u32 s47, s47, 1
    s_waitcnt vmcnt(0)
    v_cmp_ne_u32 vcc, 1, v2
    s_cmp_ge_u32 s47, 20000
    s_cbranch_scc1 chain_kernel_polld3
    s_cbranch_vccnz chain_kernel_poll2
chain_kernel_polld3:
    s_mov_b64 exec, -1
    buffer_load_dwordx4 v[72:75], v8, s[28:31], s50 offen offset:0 sc1
    buffer_load_dwordx4 v[76:79], v8, s[28:31], s51 offen offset:0 sc1
    buffer_load_dwordx4 v[80:83], v8, s[28:31], s50 offen offset:1024 sc1
    buffer_load_dwordx4 v[84:87], v8, s[28:31], s51 offen offset:1024 sc1
    buffer_load_dwordx4 v[88:91], v8, s[28:31], s50 offen offset:2048 sc1
    buffer_load_dwordx4 v[92:95], v8, s[28:31], s51 offen offset:2048 sc1
    buffer_load_dwordx4 v[96:99], v8, s[28:31], s50 offen offset:3072 sc1
    buffer_load_dwordx4 v[100:103], v8, s[28:31], s51 offen offset:3072 sc1
    s_add_u32 s50, s50, 4096
    s_add_u32 s51, s51, 4096
    buffer_load_dwordx4 v[104:107], v8, s[28:31], s50 offen offset:0 sc1
    buffer_load_dwordx4 v[108:111], v8, s[28:31], s51 offen offset:0 sc1
    s_lshl_b32 s26, s53, 3
    s_lshl_b32 s27, s20, 1
    s_add_u32 s56, s26, s27
    s_mul_i32 s6, s56, 20480
    s_add_u32 s6, s6, 15966208
    s_add_u32 s7, s6, 20480
    s_lshl_b32 s26, s53, 2
    s_add_u32 s26, s26, s20
    s_lshl_b32 s26, s26, 9
    s_add_u32 s8, s26, 31973376
    v_lshlrev_b32 v228, 3, v4
    v_lshl_add_u32 v228, v3, 8, v228
    s_lshl_b32 s9, s56, 10
    s_add_u32 s9, s9, 25665536
    s_and_b32 s42, s52, 1
    s_mul_i32 s12, s52, 7
    s_add_u32 s13, s12, 1
    s_lshr_b32 s13, s13, 1
    s_add_u32 s26, s13, 3
    s_sub_u32 s27, s13, 1
    s_cmp_eq_u32 s42, 1
    s_cselect_b32 s12, s27, s26
    s_lshl_b32 s13, s13, 10
    s_add_u32 s13, s13, 18587648
    s_lshl_b32 s12, s12, 10
    s_add_u32 s12, s12, 18587648
    s_lshl_b32 s14, s56, 4
    s_lshl_b32 s15, s53, 4
    s_add_u32 s15, s15, s52
    s_lshl_b32 s15, s15, 2
    s_add_u32 s15, s15, s20
    s_lshl_b32 s15, s15, 7
    s_add_u32 s15, s15, 32006144
    s_lshr_b32 s26, s43, 4
    s_lshl_b32 s26, s26, 3
    s_lshl_b32 s27, s24, 1
    s_add_u32 s26, s26, s27
    s_add_u32 s26, s26, s21
    s_lshl_b32 s26, s26, 7
    s_add_u32 s19, s26, 25665536
    v_add_u32 v226, s14, v4
    v_lshrrev_b32 v227, 4, v226
    v_and_b32 v226, 15, v226
    s_mov_b32 s27, 55296
    v_mul_lo_u32 v227, v227, s27
    v_lshl_add_u32 v227, v226, 4, v227
    v_and_b32 v226, 1, v3
    v_lshlrev_b32 v226, 9, v226
    v_lshrrev_b32 v2, 1, v3
    v_lshl_add_u32 v226, v2, 8, v226
    v_add_u32 v226, v226, v227
    s_lshl_b32 s27, s42, 9
    v_lshl_add_u32 v227, v2, 8, v227
    v_add_u32 v227, s27, v227
    v_and_b32 v2, 1, v3
    v_lshl_add_u32 v227, v2, 3, v227
    s_waitcnt vmcnt(8)
    v_mfma_f32_16x16x32_bf16 v[32:35], a[200:203], v[72:75], 0
    v_mfma_f32_16x16x32_bf16 v[52:55], a[200:203], v[76:79], 0
    buffer_load_dwordx4 v[112:115], v8, s[28:31], s50 offen offset:1024 sc1
    v_mfma_f32_16x16x32_bf16 v[36:39], a[204:207], v[72:75], 0
    v_mfma_f32_16x16x32_bf16 v[56:59], a[204:207], v[76:79], 0
    v_mfma_f32_16x16x32_bf16 v[40:43], a[208:211], v[72:75], 0
    v_mfma_f32_16x16x32_bf16 v[60:63], a[208:211], v[76:79], 0
    buffer_load_dwordx4 v[116:119], v8, s[28:31], s51 offen offset:1024 sc1
    v_mfma_f32_16x16x32_bf16 v[44:47], a[212:215], v[72:75], 0
    v_mfma_f32_16x16x32_bf16 v[64:67], a[212:215], v[76:79], 0
    v_mfma_f32_16x16x32_bf16 v[48:51], a[216:219], v[72:75], 0
    v_mfma_f32_16x16x32_bf16 v[68:71], a[216:219], v[76:79], 0
    s_waitcnt vmcnt(8)
    v_mfma_f32_16x16x32_bf16 v[32:35], a[220:223], v[80:83], v[32:35]
    v_mfma_f32_16x16x32_bf16 v[52:55], a[220:223], v[84:87], v[52:55]
    buffer_load_dwordx4 v[120:123], v8, s[28:31], s50 offen offset:2048 sc1
    v_mfma_f32_16x16x32_bf16 v[36:39], a[224:227], v[80:83], v[36:39]
    v_mfma_f32_16x16x32_bf16 v[56:59], a[224:227], v[84:87], v[56:59]
    v_mfma_f32_16x16x32_bf16 v[40:43], a[228:231], v[80:83], v[40:43]
    v_mfma_f32_16x16x32_bf16 v[60:63], a[228:231], v[84:87], v[60:63]
    buffer_load_dwordx4 v[124:127], v8, s[28:31], s51 offen offset:2048 sc1
    v_mfma_f32_16x16x32_bf16 v[44:47], a[232:235], v[80:83], v[44:47]
    v_mfma_f32_16x16x32_bf16 v[64:67], a[232:235], v[84:87], v[64:67]
    v_mfma_f32_16x16x32_bf16 v[48:51], a[236:239], v[80:83], v[48:51]
    v_mfma_f32_16x16x32_bf16 v[68:71], a[236:239], v[84:87], v[68:71]
    s_waitcnt vmcnt(8)
    v_mfma_f32_16x16x32_bf16 v[32:35], a[240:243], v[88:91], v[32:35]
    v_mfma_f32_16x16x32_bf16 v[52:55], a[240:243], v[92:95], v[52:55]
    buffer_load_dwordx4 v[128:131], v8, s[28:31], s50 offen offset:3072 sc1
    v_mfma_f32_16x16x32_bf16 v[36:39], a[244:247], v[88:91], v[36:39]
    v_mfma_f32_16x16x32_bf16 v[56:59], a[244:247], v[92:95], v[56:59]
    v_mfma_f32_16x16x32_bf16 v[40:43], a[248:251], v[88:91], v[40:43]
    v_mfma_f32_16x16x32_bf16 v[60:63], a[248:251], v[92:95], v[60:63]
    buffer_load_dwordx4 v[132:135], v8, s[28:31], s51 offen offset:3072 sc1
    v_mfma_f32_16x16x32_bf16 v[44:47], a[252:255], v[88:91], v[44:47]
    v_mfma_f32_16x16x32_bf16 v[64:67], a[252:255], v[92:95], v[64:67]
    v_mfma_f32_16x16x32_bf16 v[48:51], a[0:3], v[88:91], v[48:51]
    v_mfma_f32_16x16x32_bf16 v[68:71], a[0:3], v[92:95], v[68:71]
    s_waitcnt vmcnt(8)
    v_mfma_f32_16x16x32_bf16 v[32:35], a[4:7], v[96:99], v[32:35]
    v_mfma_f32_16x16x32_bf16 v[52:55], a[4:7], v[100:103], v[52:55]
    s_add_u32 s50, s50, 4096
    s_add_u32 s51, s51, 4096
    buffer_load_dwordx4 v[136:139], v8, s[28:31], s50 offen offset:0 sc1
    v_mfma_f32_16x16x32_bf16 v[36:39], a[8:11], v[96:99], v[36:39]
    v_mfma_f32_16x16x32_bf16 v[56:59], a[8:11], v[100:103], v[56:59]
    v_mfma_f32_16x16x32_bf16 v[40:43], a[12:15], v[96:99], v[40:43]
    v_mfma_f32_16x16x32_bf16 v[60:63], a[12:15], v[100:103], v[60:63]
    buffer_load_dwordx4 v[140:143], v8, s[28:31], s51 offen offset:0 sc1
    v_mfma_f32_16x16x32_bf16 v[44:47], a[16:19], v[96:99], v[44:47]
    v_mfma_f32_16x16x32_bf16 v[64:67], a[16:19], v[100:103], v[64:67]
    v_mfma_f32_16x16x32_bf16 v[48:51], a[20:23], v[96:99], v[48:51]
    v_mfma_f32_16x16x32_bf16 v[68:71], a[20:23], v[100:103], v[68:71]
    s_waitcnt vmcnt(8)
    v_mfma_f32_16x16x32_bf16 v[32:35], a[24:27], v[104:107], v[32:35]
    v_mfma_f32_16x16x32_bf16 v[52:55], a[24:27], v[108:111], v[52:55]
    buffer_load_dwordx4 v[144:147], v8, s[28:31], s50 offen offset:1024 sc1
    v_mfma_f32_16x16x32_bf16 v[36:39], a[28:31], v[104:107], v[36:39]
    v_mfma_f32_16x16x32_bf16 v[56:59], a[28:31], v[108:111], v[56:59]
    v_mfma_f32_16x16x32_bf16 v[40:43], a[32:35], v[104:107], v[40:43]
    v_mfma_f32_16x16x32_bf16 v[60:63], a[32:35], v[108:111], v[60:63]
    buffer_load_dwordx4 v[148:151], v8, s[28:31], s51 offen offset:1024 sc1
    v_mfma_f32_16x16x32_bf16 v[44:47], a[36:39], v[104:107], v[44:47]
    v_mfma_f32_16x16x32_bf16 v[64:67], a[36:39], v[108:111], v[64:67]
    s_mul_i32 s25, s20, 20
    s_lshl_b32 s25, s25, 10
    s_add_u32 s62, s25, 40960
    s_add_u32 s63, s25, s54
    s_add_u32 s63, s63, 40960
    s_mov_b32 m0, s62
    buffer_load_dwordx4 v8, s[28:31], s63 offen offset:0 lds
    v_mfma_f32_16x16x32_bf16 v[48:51], a[40:43], v[104:107], v[48:51]
    v_mfma_f32_16x16x32_bf16 v[68:71], a[40:43], v[108:111], v[68:71]
    s_waitcnt vmcnt(9)
    v_mfma_f32_16x16x32_bf16 v[32:35], a[44:47], v[112:115], v[32:35]
    v_mfma_f32_16x16x32_bf16 v[52:55], a[44:47], v[116:119], v[52:55]
    buffer_load_dwordx4 v8, s[28:31], s63 offen offset:1024 lds
    v_mfma_f32_16x16x32_bf16 v[36:39], a[48:51], v[112:115], v[36:39]
    v_mfma_f32_16x16x32_bf16 v[56:59], a[48:51], v[116:119], v[56:59]
    buffer_load_dwordx4 v8, s[28:31], s63 offen offset:2048 lds
    v_mfma_f32_16x16x32_bf16 v[40:43], a[52:55], v[112:115], v[40:43]
    v_mfma_f32_16x16x32_bf16 v[60:63], a[52:55], v[116:119], v[60:63]
    v_mfma_f32_16x16x32_bf16 v[44:47], a[56:59], v[112:115], v[44:47]
    v_mfma_f32_16x16x32_bf16 v[64:67], a[56:59], v[116:119], v[64:67]
    buffer_load_dwordx4 v8, s[28:31], s63 offen offset:3072 lds
    v_mfma_f32_16x16x32_bf16 v[48:51], a[60:63], v[112:115], v[48:51]
    v_mfma_f32_16x16x32_bf16 v[68:71], a[60:63], v[116:119], v[68:71]
    s_waitcnt vmcnt(10)
    v_mfma_f32_16x16x32_bf16 v[32:35], a[64:67], v[120:123], v[32:35]
    v_mfma_f32_16x16x32_bf16 v[52:55], a[64:67], v[124:127], v[52:55]
    s_add_u32 s62, s62, 4096
    s_add_u32 s63, s63, 4096
    s_mov_b32 m0, s62
    buffer_load_dwordx4 v8, s[28:31], s63 offen offset:0 lds
    v_mfma_f32_16x16x32_bf16 v[36:39], a[68:71], v[120:123], v[36:39]
    v_mfma_f32_16x16x32_bf16 v[56:59], a[68:71], v[124:127], v[56:59]
    buffer_load_dwordx4 v8, s[28:31], s63 offen offset:1024 lds
    v_mfma_f32_16x16x32_bf16 v[40:43], a[72:75], v[120:123], v[40:43]
    v_mfma_f32_16x16x32_bf16 v[60:63], a[72:75], v[124:127], v[60:63]
    v_mfma_f32_16x16x32_bf16 v[44:47], a[76:79], v[120:123], v[44:47]
    v_mfma_f32_16x16x32_bf16 v[64:67], a[76:79], v[124:127], v[64:67]
    buffer_load_dwordx4 v8, s[28:31], s63 offen offset:2048 lds
    v_mfma_f32_16x16x32_bf16 v[48:51], a[80:83], v[120:123], v[48:51]
    v_mfma_f32_16x16x32_bf16 v[68:71], a[80:83], v[124:127], v[68:71]
    s_waitcnt vmcnt(11)
    v_mfma_f32_16x16x32_bf16 v[32:35], a[84:87], v[128:131], v[32:35]
    v_mfma_f32_16x16x32_bf16 v[52:55], a[84:87], v[132:135], v[52:55]
    buffer_load_dwordx4 v8, s[28:31], s63 offen offset:3072 lds
    v_mfma_f32_16x16x32_bf16 v[36:39], a[88:91], v[128:131], v[36:39]
    v_mfma_f32_16x16x32_bf16 v[56:59], a[88:91], v[132:135], v[56:59]
    s_add_u32 s62, s62, 4096
    s_add_u32 s63, s63, 4096
    s_mov_b32 m0, s62
    buffer_load_dwordx4 v8, s[28:31], s63 offen offset:0 lds
    v_mfma_f32_16x16x32_bf16 v[40:43], a[92:95], v[128:131], v[40:43]
    v_mfma_f32_16x16x32_bf16 v[60:63], a[92:95], v[132:135], v[60:63]
    v_mfma_f32_16x16x32_bf16 v[44:47], a[96:99], v[128:131], v[44:47]
    v_mfma_f32_16x16x32_bf16 v[64:67], a[96:99], v[132:135], v[64:67]
    buffer_load_dwordx4 v8, s[28:31], s63 offen offset:1024 lds
    v_mfma_f32_16x16x32_bf16 v[48:51], a[100:103], v[128:131], v[48:51]
    v_mfma_f32_16x16x32_bf16 v[68:71], a[100:103], v[132:135], v[68:71]
    s_waitcnt vmcnt(12)
    v_mfma_f32_16x16x32_bf16 v[32:35], a[104:107], v[136:139], v[32:35]
    v_mfma_f32_16x16x32_bf16 v[52:55], a[104:107], v[140:143], v[52:55]
    buffer_load_dwordx4 v8, s[28:31], s63 offen offset:2048 lds
    v_mfma_f32_16x16x32_bf16 v[36:39], a[108:111], v[136:139], v[36:39]
    v_mfma_f32_16x16x32_bf16 v[56:59], a[108:111], v[140:143], v[56:59]
    buffer_load_dwordx4 v8, s[28:31], s63 offen offset:3072 lds
    v_mfma_f32_16x16x32_bf16 v[40:43], a[112:115], v[136:139], v[40:43]
    v_mfma_f32_16x16x32_bf16 v[60:63], a[112:115], v[140:143], v[60:63]
    v_mfma_f32_16x16x32_bf16 v[44:47], a[116:119], v[136:139], v[44:47]
    v_mfma_f32_16x16x32_bf16 v[64:67], a[116:119], v[140:143], v[64:67]
    s_add_u32 s62, s62, 4096
    s_add_u32 s63, s63, 4096
    s_mov_b32 m0, s62
    buffer_load_dwordx4 v8, s[28:31], s63 offen offset:0 lds
    v_mfma_f32_16x16x32_bf16 v[48:51], a[120:123], v[136:139], v[48:51]
    v_mfma_f32_16x16x32_bf16 v[68:71], a[120:123], v[140:143], v[68:71]
    s_waitcnt vmcnt(13)
    v_mfma_f32_16x16x32_bf16 v[32:35], a[124:127], v[144:147], v[32:35]
    v_mfma_f32_16x16x32_bf16 v[52:55], a[124:127], v[148:151], v[52:55]
    buffer_load_dwordx4 v8, s[28:31], s63 offen offset:1024 lds
    v_mfma_f32_16x16x32_bf16 v[36:39], a[128:131], v[144:147], v[36:39]
    v_mfma_f32_16x16x32_bf16 v[56:59], a[128:131], v[148:151], v[56:59]
    buffer_load_dwordx4 v8, s[28:31], s63 offen offset:2048 lds
    v_mfma_f32_16x16x32_bf16 v[40:43], a[132:135], v[144:147], v[40:43]
    v_mfma_f32_16x16x32_bf16 v[60:63], a[132:135], v[148:151], v[60:63]
    v_mfma_f32_16x16x32_bf16 v[44:47], a[136:139], v[144:147], v[44:47]
    v_mfma_f32_16x16x32_bf16 v[64:67], a[136:139], v[148:151], v[64:67]
    buffer_load_dwordx4 v8, s[28:31], s63 offen offset:3072 lds
    v_mfma_f32_16x16x32_bf16 v[48:51], a[140:143], v[144:147], v[48:51]
    v_mfma_f32_16x16x32_bf16 v[68:71], a[140:143], v[148:151], v[68:71]
    s_nop 4
    ds_write_b128 v246, v[52:55] offset:0
    ds_write_b128 v246, v[56:59] offset:1024
    ds_write_b128 v246, v[60:63] offset:2048
    ds_write_b128 v246, v[64:67] offset:3072
    ds_write_b128 v246, v[68:71] offset:4096
    v_lshlrev_b32 v112, 16, v16
    v_and_b32 v113, 0xffff0000, v16
    v_lshlrev_b32 v114, 16, v17
    v_and_b32 v115, 0xffff0000, v17
    v_lshlrev_b32 v116, 16, v18
    v_and_b32 v117, 0xffff0000, v18
    v_lshlrev_b32 v118, 16, v19
    v_and_b32 v119, 0xffff0000, v19
    v_lshlrev_b32 v120, 16, v20
    v_and_b32 v121, 0xffff0000, v20
    v_lshlrev_b32 v122, 16, v21
    v_and_b32 v123, 0xffff0000, v21
    v_lshlrev_b32 v124, 16, v22
    v_and_b32 v125, 0xffff0000, v22
    v_lshlrev_b32 v126, 16, v23
    v_and_b32 v127, 0xffff0000, v23
    v_lshlrev_b32 v128, 16, v24
    v_and_b32 v129, 0xffff0000, v24
    v_lshlrev_b32 v130, 16, v25
    v_and_b32 v131, 0xffff0000, v25
    v_pk_add_f32 v[32:33], v[32:33], v[112:113]
    v_pk_add_f32 v[34:35], v[34:35], v[114:115]
    v_pk_add_f32 v[36:37], v[36:37], v[116:117]
    v_pk_add_f32 v[38:39], v[38:39], v[118:119]
    v_pk_add_f32 v[40:41], v[40:41], v[120:121]
    v_pk_add_f32 v[42:43], v[42:43], v[122:123]
    v_pk_add_f32 v[44:45], v[44:45], v[124:125]
    v_pk_add_f32 v[46:47], v[46:47], v[126:127]
    v_pk_add_f32 v[48:49], v[48:49], v[128:129]
    v_pk_add_f32 v[50:51], v[50:51], v[130:131]
    v_mov_b32 v28, 0
    v_mov_b32 v29, 0
    s_add_u32 s62, s62, 4096
    s_add_u32 s63, s63, 4096
    s_mov_b32 m0, s62
    buffer_load_dwordx4 v8, s[28:31], s63 offen offset:0 lds
    buffer_load_dwordx4 v8, s[28:31], s63 offen offset:1024 lds
    buffer_load_dwordx4 v8, s[28:31], s63 offen offset:2048 lds
    buffer_load_dwordx4 v8, s[28:31], s63 offen offset:3072 lds
    s_mul_i32 s25, s20, 5
    s_lshl_b32 s25, s25, 10
    s_add_u32 s62, s25, 122880
    s_add_u32 s63, s25, s54
    s_add_u32 s63, s63, 122880
    s_mov_b32 m0, s62
    buffer_load_dwordx4 v8, s[28:31], s63 offen offset:0 lds
    buffer_load_dwordx4 v8, s[28:31], s63 offen offset:1024 lds
    buffer_load_dwordx4 v8, s[28:31], s63 offen offset:2048 lds
    buffer_load_dwordx4 v8, s[28:31], s63 offen offset:3072 lds
    s_add_u32 s62, s62, 4096
    s_add_u32 s63, s63, 4096
    s_mov_b32 m0, s62
    buffer_load_dwordx4 v8, s[28:31], s63 offen offset:0 lds
    s_waitcnt lgkmcnt(0)
    s_barrier
    ds_read_b128 v[88:91], v247 offset:0
    ds_read_b128 v[92:95], v247 offset:1024
    ds_read_b128 v[96:99], v247 offset:2048
    ds_read_b128 v[100:103], v247 offset:3072
    ds_read_b128 v[104:107], v247 offset:4096
    s_waitcnt lgkmcnt(4)
    v_pk_add_f32 v[32:33], v[32:33], v[88:89]
    v_pk_add_f32 v[34:35], v[34:35], v[90:91]
    v_cvt_pk_bf16_f32 v180, v32, v33
    v_cvt_pk_bf16_f32 v181, v34, v35
    s_waitcnt lgkmcnt(3)
    v_pk_add_f32 v[36:37], v[36:37], v[92:93]
    v_pk_add_f32 v[38:39], v[38:39], v[94:95]
    v_cvt_pk_bf16_f32 v182, v36, v37
    v_cvt_pk_bf16_f32 v183, v38, v39
    s_waitcnt lgkmcnt(2)
    v_pk_add_f32 v[40:41], v[40:41], v[96:97]
    v_pk_add_f32 v[42:43], v[42:43], v[98:99]
    v_cvt_pk_bf16_f32 v184, v40, v41
    v_cvt_pk_bf16_f32 v185, v42, v43
    s_waitcnt lgkmcnt(1)
    v_pk_add_f32 v[44:45], v[44:45], v[100:101]
    v_pk_add_f32 v[46:47], v[46:47], v[102:103]
    v_cvt_pk_bf16_f32 v186, v44, v45
    v_cvt_pk_bf16_f32 v187, v46, v47
    s_waitcnt lgkmcnt(0)
    v_pk_add_f32 v[48:49], v[48:49], v[104:105]
    v_pk_add_f32 v[50:51], v[50:51], v[106:107]
    v_cvt_pk_bf16_f32 v188, v48, v49
    v_cvt_pk_bf16_f32 v189, v50, v51
    v_dot2_f32_bf16 v28, v180, v224, v28
    v_dot2_f32_bf16 v29, v180, v180, v29
    v_dot2_f32_bf16 v28, v181, v224, v28
    v_dot2_f32_bf16 v29, v181, v181, v29
    v_dot2_f32_bf16 v28, v182, v224, v28
    v_dot2_f32_bf16 v29, v182, v182, v29
    v_dot2_f32_bf16 v28, v183, v224, v28
    v_dot2_f32_bf16 v29, v183, v183, v29
    v_dot2_f32_bf16 v28, v184, v224, v28
    v_dot2_f32_bf16 v29, v184, v184, v29
    v_dot2_f32_bf16 v28, v185, v224, v28
    v_dot2_f32_bf16 v29, v185, v185, v29
    v_dot2_f32_bf16 v28, v186, v224, v28
    v_dot2_f32_bf16 v29, v186, v186, v29
    v_dot2_f32_bf16 v28, v187, v224, v28
    v_dot2_f32_bf16 v29, v187, v187, v29
    v_dot2_f32_bf16 v28, v188, v224, v28
    v_dot2_f32_bf16 v29, v188, v188, v29
    v_dot2_f32_bf16 v28, v189, v224, v28
    v_dot2_f32_bf16 v29, v189, v189, v29
    s_nop 1
    v_permlane16_swap_b32 v180, v182
    v_permlane16_swap_b32 v181, v183
    v_permlane16_swap_b32 v184, v186
    v_permlane16_swap_b32 v185, v187
    buffer_store_dwordx4 v[180:183], v243, s[28:31], s38 offen sc1
    buffer_store_dwordx4 v[184:187], v243, s[28:31], s38 offen offset:1024 sc1
    buffer_store_dwordx2 v[188:189], v244, s[28:31], s39 offen sc1
    v_mov_b32 v160, v28
    v_mov_b32 v161, v29
    s_nop 1
    v_permlane32_swap_b32 v160, v28
    v_permlane32_swap_b32 v161, v29
    s_nop 1
    v_add_f32 v28, v28, v160
    v_add_f32 v29, v29, v161
    v_mov_b32 v160, v28
    v_mov_b32 v161, v29
    s_nop 1
    v_permlane16_swap_b32 v160, v28
    v_permlane16_swap_b32 v161, v29
    s_nop 1
    v_add_f32 v28, v28, v160
    v_add_f32 v29, v29, v161
    v_lshlrev_b32 v2, 3, v4
    s_mov_b64 exec, 0xffff
    buffer_store_dwordx2 v[28:29], v2, s[28:31], s19 offen sc1
    s_mov_b64 exec, -1
    s_waitcnt vmcnt(0)
    s_barrier
    s_cmp_lg_u32 s20, 0
    s_cbranch_scc1 chain_kernel_sig4
    v_mov_b32 v2, 1
    v_mov_b32 v7, 0
    s_mov_b64 exec, 1
    buffer_store_dword v2, v7, s[28:31], s49 offen sc1
    s_mov_b64 exec, -1
chain_kernel_sig4:
    v_and_b32 v2, 31, v1
    v_lshlrev_b32 v2, 4, v2
    v_lshrrev_b32 v7, 5, v1
    v_mul_u32_u24 v7, 7168, v7
    v_add_u32 v2, v2, v7
    s_mul_i32 s26, s52, 448
    s_add_u32 s26, s26, 10690560
    s_mov_b32 m0, 162816
    v_lshlrev_b32 v7, 7, v1
    buffer_load_dwordx4 v2, s[28:31], s26 offen lds
    s_mov_b32 s47, 0
    s_mov_b64 exec, 15
chain_kernel_poll5:
    buffer_load_dword v2, v7, s[28:31], s8 offen sc1
    s_add_u32 s47, s47, 1
    s_waitcnt vmcnt(0)
    v_cmp_ne_u32 vcc, 1, v2
    s_cmp_ge_u32 s47, 20000
    s_cbranch_scc1 chain_kernel_polld6
    s_cbranch_vccnz chain_kernel_poll5
chain_kernel_polld6:
    s_mov_b64 exec, -1
    buffer_load_dwordx4 a[0:3], v8, s[28:31], s6 offen offset:0 sc1
    buffer_load_dwordx4 a[4:7], v8, s[28:31], s7 offen offset:0 sc1
    buffer_load_dwordx4 a[8:11], v8, s[28:31], s6 offen offset:1024 sc1
    buffer_load_dwordx4 a[12:15], v8, s[28:31], s7 offen offset:1024 sc1
    buffer_load_dwordx4 a[16:19], v8, s[28:31], s6 offen offset:2048 sc1
    buffer_load_dwordx4 a[20:23], v8, s[28:31], s7 offen offset:2048 sc1
    buffer_load_dwordx4 a[24:27], v8, s[28:31], s6 offen offset:3072 sc1
    buffer_load_dwordx4 a[28:31], v8, s[28:31], s7 offen offset:3072 sc1
    s_add_u32 s6, s6, 4096
    s_add_u32 s7, s7, 4096
    buffer_load_dwordx4 a[32:35], v8, s[28:31], s6 offen offset:0 sc1
    buffer_load_dwordx4 a[36:39], v8, s[28:31], s7 offen offset:0 sc1
    s_barrier
    s_lshl_b32 s26, s42, 6
    v_lshlrev_b32 v2, 4, v3
    v_add_u32 v7, 162816, v2
    v_add_u32 v2, s26, v7
    s_mul_i32 s26, s42, 384
    s_sub_u32 s26, 384, s26
    v_add_u32 v7, s26, v7
    ds_read_b128 v[88:91], v2 offset:0
    ds_read_b128 v[116:119], v2 offset:512
    ds_read_b128 v[92:95], v2 offset:64
    ds_read_b128 v[120:123], v2 offset:576
    ds_read_b128 v[96:99], v2 offset:128
    ds_read_b128 v[124:127], v2 offset:640
    ds_read_b128 v[100:103], v2 offset:192
    ds_read_b128 v[128:131], v2 offset:704
    ds_read_b128 v[104:107], v2 offset:256
    ds_read_b128 v[132:135], v2 offset:768
    ds_read_b128 v[108:111], v2 offset:320
    ds_read_b128 v[136:139], v2 offset:832
    ds_read_b128 v[112:115], v7
    ds_read_b128 v[140:143], v7 offset:512
    s_and_b32 s36, s57, 1
    s_lshl_b32 s43, s58, 6
    s_lshl_b32 s26, s21, 5
    s_add_u32 s43, s43, s26
    s_lshl_b32 s26, s22, 4
    s_add_u32 s43, s43, s26
    s_mul_i32 s40, s57, 5
    s_add_u32 s41, s40, 1
    s_lshr_b32 s41, s41, 1
    s_add_u32 s26, s41, 2
    s_sub_u32 s27, s41, 1
    s_cmp_eq_u32 s36, 1
    s_cselect_b32 s40, s27, s26
    s_lshl_b32 s44, s41, 10
    s_lshl_b32 s45, s40, 10
    s_lshl_b32 s26, s36, 9
    s_add_u32 s45, s45, s26
    s_lshr_b32 s26, s58, 1
    s_lshl_b32 s26, s26, 4
    s_mul_i32 s27, s22, 7
    s_add_u32 s26, s26, s27
    s_lshl_b32 s26, s26, 2
    s_and_b32 s27, s58, 1
    s_lshl_b32 s27, s27, 1
    s_add_u32 s26, s26, s27
    s_add_u32 s26, s26, s21
    s_lshl_b32 s26, s26, 7
    s_add_u32 s48, s26, 32006144
    v_lshlrev_b32 v234, 9, v1
    s_lshl_b32 s26, s58, 2
    s_lshl_b32 s27, s21, 1
    s_add_u32 s26, s26, s27
    s_add_u32 s27, s26, s22
    s_mul_i32 s27, s27, 54
    s_mul_i32 s39, s22, 27
    s_add_u32 s27, s27, s39
    s_lshl_b32 s27, s27, 10
    s_add_u32 s50, s27, 18587648
    s_add_u32 s27, s26, 1
    s_sub_u32 s27, s27, s22
    s_mul_i32 s27, s27, 54
    s_add_u32 s27, s27, s39
    s_lshl_b32 s27, s27, 10
    s_add_u32 s51, s27, 18587648
    v_add_u32 v9, s43, v4
    v_lshrrev_b32 v11, 4, v9
    v_and_b32 v10, 15, v9
    v_mul_u32_u24 v11, 20480, v11
    v_lshl_add_u32 v11, v10, 4, v11
    v_lshrrev_b32 v2, 1, v3
    v_lshl_add_u32 v11, v2, 8, v11
    v_and_b32 v7, 1, v3
    v_lshl_add_u32 v230, v7, 3, v11
    v_mul_u32_u24 v9, 1280, v9
    v_lshlrev_b32 v7, 5, v7
    v_lshl_add_u32 v7, v2, 4, v7
    v_add_u32 v231, v9, v7
    v_lshl_add_u32 v232, v3, 3, v9
    v_lshlrev_b32 v233, 4, v3
    v_add_u32 v9, s43, v4
    v_lshrrev_b32 v10, 4, v9
    v_mul_u32_u24 v10, 20480, v10
    v_and_b32 v11, 1, v9
    v_lshl_add_u32 v10, v11, 3, v10
    v_lshl_add_u32 v10, v3, 7, v10
    v_bfe_u32 v11, v9, 1, 3
    s_mul_i32 s26, s57, 20
    s_lshl_b32 s27, s36, 2
    s_add_u32 s27, s27, s26
    s_mul_i32 s3, s36, 16
    s_sub_u32 s3, 16, s3
    s_add_u32 s3, s3, s26
    s_add_u32 s4, s27, 0
    v_add_u32 v2, s4, v3
    v_bfe_u32 v2, v2, 1, 3
    v_xor_b32 v2, v2, v11
    v_lshl_add_u32 v2, v2, 4, v10
    s_lshl_b32 s4, s4, 7
    v_add_u32 v235, s4, v2
    s_add_u32 s4, s27, 4
    v_add_u32 v2, s4, v3
    v_bfe_u32 v2, v2, 1, 3
    v_xor_b32 v2, v2, v11
    v_lshl_add_u32 v2, v2, 4, v10
    s_lshl_b32 s4, s4, 7
    v_add_u32 v236, s4, v2
    s_add_u32 s4, s27, 8
    v_add_u32 v2, s4, v3
    v_bfe_u32 v2, v2, 1, 3
    v_xor_b32 v2, v2, v11
    v_lshl_add_u32 v2, v2, 4, v10
    s_lshl_b32 s4, s4, 7
    v_add_u32 v237, s4, v2
    s_add_u32 s4, s27, 12
    v_add_u32 v2, s4, v3
    v_bfe_u32 v2, v2, 1, 3
    v_xor_b32 v2, v2, v11
    v_lshl_add_u32 v2, v2, 4, v10
    s_lshl_b32 s4, s4, 7
    v_add_u32 v238, s4, v2
    s_mov_b32 s4, s3
    v_add_u32 v2, s4, v3
    v_bfe_u32 v2, v2, 1, 3
    v_xor_b32 v2, v2, v11
    v_lshl_add_u32 v2, v2, 4, v10
    s_lshl_b32 s4, s4, 7
    v_add_u32 v239, s4, v2
    s_mul_i32 s37, s57, 320
    s_add_u32 s37, s37, 10686976
    s_mul_i32 s26, s36, 256
    s_sub_u32 s26, 256, s26
    s_add_u32 s38, s37, s26
    s_lshl_b32 s26, s36, 6
    s_add_u32 s37, s37, s26
    s_mul_i32 s26, s57, 160
    s_lshl_b32 s27, s36, 5
    s_add_u32 s46, s26, s27
    s_mul_i32 s27, s36, 128
    s_sub_u32 s27, 128, s27
    s_add_u32 s49, s26, s27
    s_waitcnt lgkmcnt(0)
    v_pk_add_f32 v[88:89], v[88:89], v[116:117]
    v_pk_add_f32 v[90:91], v[90:91], v[118:119]
    v_pk_add_f32 v[92:93], v[92:93], v[120:121]
    v_pk_add_f32 v[94:95], v[94:95], v[122:123]
    v_pk_add_f32 v[96:97], v[96:97], v[124:125]
    v_pk_add_f32 v[98:99], v[98:99], v[126:127]
    v_pk_add_f32 v[100:101], v[100:101], v[128:129]
    v_pk_add_f32 v[102:103], v[102:103], v[130:131]
    v_pk_add_f32 v[104:105], v[104:105], v[132:133]
    v_pk_add_f32 v[106:107], v[106:107], v[134:135]
    v_pk_add_f32 v[108:109], v[108:109], v[136:137]
    v_pk_add_f32 v[110:111], v[110:111], v[138:139]
    v_pk_add_f32 v[112:113], v[112:113], v[140:141]
    v_pk_add_f32 v[114:115], v[114:115], v[142:143]
    v_mov_b32 v12, v8
    v_add_u32 v13, 0x10000, v8
    v_add_u32 v14, 0x20000, v8
    ds_read_b128 a[160:163], v12 offset:0
    ds_read_b128 a[164:167], v12 offset:1024
    ds_read_b128 a[168:171], v12 offset:2048
    ds_read_b128 a[172:175], v12 offset:3072
    ds_read_b128 a[176:179], v12 offset:4096
    ds_read_b128 a[180:183], v12 offset:5120
    ds_read_b128 a[184:187], v12 offset:6144
    s_waitcnt vmcnt(8) lgkmcnt(6)
    v_mfma_f32_16x16x32_bf16 v[32:35], a[160:163], a[0:3], 0
    v_mfma_f32_16x16x32_bf16 v[60:63], a[160:163], a[4:7], 0
    ds_read_b128 a[188:191], v12 offset:7168
    buffer_load_dwordx4 a[40:43], v8, s[28:31], s6 offen offset:1024 sc1
    s_waitcnt lgkmcnt(6)
    v_mfma_f32_16x16x32_bf16 v[36:39], a[164:167], a[0:3], 0
    v_mfma_f32_16x16x32_bf16 v[64:67], a[164:167], a[4:7], 0
    ds_read_b128 a[160:163], v12 offset:8192
    s_waitcnt lgkmcnt(6)
    v_mfma_f32_16x16x32_bf16 v[40:43], a[168:171], a[0:3], 0
    v_mfma_f32_16x16x32_bf16 v[68:71], a[168:171], a[4:7], 0
    ds_read_b128 a[164:167], v12 offset:9216
    buffer_load_dwordx4 a[44:47], v8, s[28:31], s7 offen offset:1024 sc1
    s_waitcnt lgkmcnt(6)
    v_mfma_f32_16x16x32_bf16 v[44:47], a[172:175], a[0:3], 0
    v_mfma_f32_16x16x32_bf16 v[72:75], a[172:175], a[4:7], 0
    ds_read_b128 a[168:171], v12 offset:10240
    s_waitcnt vmcnt(8) lgkmcnt(6)
    v_mfma_f32_16x16x32_bf16 v[32:35], a[176:179], a[8:11], v[32:35]
    v_mfma_f32_16x16x32_bf16 v[60:63], a[176:179], a[12:15], v[60:63]
    ds_read_b128 a[172:175], v12 offset:11264
    buffer_load_dwordx4 a[48:51], v8, s[28:31], s6 offen offset:2048 sc1
    s_waitcnt lgkmcnt(6)
    v_mfma_f32_16x16x32_bf16 v[36:39], a[180:183], a[8:11], v[36:39]
    v_mfma_f32_16x16x32_bf16 v[64:67], a[180:183], a[12:15], v[64:67]
    ds_read_b128 a[176:179], v12 offset:12288
    s_waitcnt lgkmcnt(6)
    v_mfma_f32_16x16x32_bf16 v[40:43], a[184:187], a[8:11], v[40:43]
    v_mfma_f32_16x16x32_bf16 v[68:71], a[184:187], a[12:15], v[68:71]
    ds_read_b128 a[180:183], v12 offset:13312
    buffer_load_dwordx4 a[52:55], v8, s[28:31], s7 offen offset:2048 sc1
    s_waitcnt lgkmcnt(6)
    v_mfma_f32_16x16x32_bf16 v[44:47], a[188:191], a[8:11], v[44:47]
    v_mfma_f32_16x16x32_bf16 v[72:75], a[188:191], a[12:15], v[72:75]
    ds_read_b128 a[184:187], v12 offset:14336
    s_waitcnt vmcnt(8) lgkmcnt(6)
    v_mfma_f32_16x16x32_bf16 v[32:35], a[160:163], a[16:19], v[32:35]
    v_mfma_f32_16x16x32_bf16 v[60:63], a[160:163], a[20:23], v[60:63]
    ds_read_b128 a[188:191], v12 offset:15360
    buffer_load_dwordx4 a[56:59], v8, s[28:31], s6 offen offset:3072 sc1
    s_waitcnt lgkmcnt(6)
    v_mfma_f32_16x16x32_bf16 v[36:39], a[164:167], a[16:19], v[36:39]
    v_mfma_f32_16x16x32_bf16 v[64:67], a[164:167], a[20:23], v[64:67]
    ds_read_b128 a[160:163], v12 offset:16384
    s_waitcnt lgkmcnt(6)
    v_mfma_f32_16x16x32_bf16 v[40:43], a[168:171], a[16:19], v[40:43]
    v_mfma_f32_16x16x32_bf16 v[68:71], a[168:171], a[20:23], v[68:71]
    ds_read_b128 a[164:167], v12 offset:17408
    buffer_load_dwordx4 a[60:63], v8, s[28:31], s7 offen offset:3072 sc1
    s_waitcnt lgkmcnt(6)
    v_mfma_f32_16x16x32_bf16 v[44:47], a[172:175], a[16:19], v[44:47]
    v_mfma_f32_16x16x32_bf16 v[72:75], a[172:175], a[20:23], v[72:75]
    ds_read_b128 a[168:171], v12 offset:18432
    s_waitcnt vmcnt(8) lgkmcnt(6)
    v_mfma_f32_16x16x32_bf16 v[32:35], a[176:179], a[24:27], v[32:35]
    v_mfma_f32_16x16x32_bf16 v[60:63], a[176:179], a[28:31], v[60:63]
    ds_read_b128 a[172:175], v12 offset:19456
    s_add_u32 s6, s6, 4096
    s_add_u32 s7, s7, 4096
    buffer_load_dwordx4 a[64:67], v8, s[28:31], s6 offen offset:0 sc1
    s_waitcnt lgkmcnt(6)
    v_mfma_f32_16x16x32_bf16 v[36:39], a[180:183], a[24:27], v[36:39]
    v_mfma_f32_16x16x32_bf16 v[64:67], a[180:183], a[28:31], v[64:67]
    ds_read_b128 a[176:179], v12 offset:20480
    s_waitcnt lgkmcnt(6)
    v_mfma_f32_16x16x32_bf16 v[40:43], a[184:187], a[24:27], v[40:43]
    v_mfma_f32_16x16x32_bf16 v[68:71], a[184:187], a[28:31], v[68:71]
    ds_read_b128 a[180:183], v12 offset:21504
    buffer_load_dwordx4 a[68:71], v8, s[28:31], s7 offen offset:0 sc1
    s_waitcnt lgkmcnt(6)
    v_mfma_f32_16x16x32_bf16 v[44:47], a[188:191], a[24:27], v[44:47]
    v_mfma_f32_16x16x32_bf16 v[72:75], a[188:191], a[28:31], v[72:75]
    ds_read_b128 a[184:187], v12 offset:22528
    s_waitcnt vmcnt(8) lgkmcnt(6)
    v_mfma_f32_16x16x32_bf16 v[32:35], a[160:163], a[32:35], v[32:35]
    v_mfma_f32_16x16x32_bf16 v[60:63], a[160:163], a[36:39], v[60:63]
    ds_read_b128 a[188:191], v12 offset:23552
    buffer_load_dwordx4 a[72:75], v8, s[28:31], s6 offen offset:1024 sc1
    s_waitcnt lgkmcnt(6)
    v_mfma_f32_16x16x32_bf16 v[36:39], a[164:167], a[32:35], v[36:39]
    v_mfma_f32_16x16x32_bf16 v[64:67], a[164:167], a[36:39], v[64:67]
    ds_read_b128 a[160:163], v12 offset:24576
    s_waitcnt lgkmcnt(6)
    v_mfma_f32_16x16x32_bf16 v[40:43], a[168:171], a[32:35], v[40:43]
    v_mfma_f32_16x16x32_bf16 v[68:71], a[168:171], a[36:39], v[68:71]
    ds_read_b128 a[164:167], v12 offset:25600
    buffer_load_dwordx4 a[76:79], v8, s[28:31], s7 offen offset:1024 sc1
    s_waitcnt lgkmcnt(6)
    v_mfma_f32_16x16x32_bf16 v[44:47], a[172:175], a[32:35], v[44:47]
    v_mfma_f32_16x16x32_bf16 v[72:75], a[172:175], a[36:39], v[72:75]
    ds_read_b128 a[168:171], v12 offset:26624
    s_waitcnt vmcnt(8) lgkmcnt(6)
    v_mfma_f32_16x16x32_bf16 v[32:35], a[176:179], a[40:43], v[32:35]
    v_mfma_f32_16x16x32_bf16 v[60:63], a[176:179], a[44:47], v[60:63]
    ds_read_b128 a[172:175], v12 offset:27648
    buffer_load_dwordx4 a[80:83], v8, s[28:31], s6 offen offset:2048 sc1
    s_waitcnt lgkmcnt(6)
    v_mfma_f32_16x16x32_bf16 v[36:39], a[180:183], a[40:43], v[36:39]
    v_mfma_f32_16x16x32_bf16 v[64:67], a[180:183], a[44:47], v[64:67]
    ds_read_b128 a[176:179], v12 offset:28672
    s_waitcnt lgkmcnt(6)
    v_mfma_f32_16x16x32_bf16 v[40:43], a[184:187], a[40:43], v[40:43]
    v_mfma_f32_16x16x32_bf16 v[68:71], a[184:187], a[44:47], v[68:71]
    ds_read_b128 a[180:183], v12 offset:29696
    buffer_load_dwordx4 a[84:87], v8, s[28:31], s7 offen offset:2048 sc1
    s_waitcnt lgkmcnt(6)
    v_mfma_f32_16x16x32_bf16 v[44:47], a[188:191], a[40:43], v[44:47]
    v_mfma_f32_16x16x32_bf16 v[72:75], a[188:191], a[44:47], v[72:75]
    ds_read_b128 a[184:187], v12 offset:30720
    s_waitcnt vmcnt(8) lgkmcnt(6)
    v_mfma_f32_16x16x32_bf16 v[32:35], a[160:163], a[48:51], v[32:35]
    v_mfma_f32_16x16x32_bf16 v[60:63], a[160:163], a[52:55], v[60:63]
    ds_read_b128 a[188:191], v12 offset:31744
    buffer_load_dwordx4 a[88:91], v8, s[28:31], s6 offen offset:3072 sc1
    s_waitcnt lgkmcnt(6)
    v_mfma_f32_16x16x32_bf16 v[36:39], a[164:167], a[48:51], v[36:39]
    v_mfma_f32_16x16x32_bf16 v[64:67], a[164:167], a[52:55], v[64:67]
    ds_read_b128 a[160:163], v12 offset:32768
    s_waitcnt lgkmcnt(6)
    v_mfma_f32_16x16x32_bf16 v[40:43], a[168:171], a[48:51], v[40:43]
    v_mfma_f32_16x16x32_bf16 v[68:71], a[168:171], a[52:55], v[68:71]
    ds_read_b128 a[164:167], v12 offset:33792
    buffer_load_dwordx4 a[92:95], v8, s[28:31], s7 offen offset:3072 sc1
    s_waitcnt lgkmcnt(6)
    v_mfma_f32_16x16x32_bf16 v[44:47], a[172:175], a[48:51], v[44:47]
    v_mfma_f32_16x16x32_bf16 v[72:75], a[172:175], a[52:55], v[72:75]
    ds_read_b128 a[168:171], v12 offset:34816
    s_waitcnt vmcnt(8) lgkmcnt(6)
    v_mfma_f32_16x16x32_bf16 v[32:35], a[176:179], a[56:59], v[32:35]
    v_mfma_f32_16x16x32_bf16 v[60:63], a[176:179], a[60:63], v[60:63]
    ds_read_b128 a[172:175], v12 offset:35840
    s_add_u32 s6, s6, 4096
    s_add_u32 s7, s7, 4096
    buffer_load_dwordx4 a[96:99], v8, s[28:31], s6 offen offset:0 sc1
    s_waitcnt lgkmcnt(6)
    v_mfma_f32_16x16x32_bf16 v[36:39], a[180:183], a[56:59], v[36:39]
    v_mfma_f32_16x16x32_bf16 v[64:67], a[180:183], a[60:63], v[64:67]
    ds_read_b128 a[176:179], v12 offset:36864
    s_waitcnt lgkmcnt(6)
    v_mfma_f32_16x16x32_bf16 v[40:43], a[184:187], a[56:59], v[40:43]
    v_mfma_f32_16x16x32_bf16 v[68:71], a[184:187], a[60:63], v[68:71]
    ds_read_b128 a[180:183], v12 offset:37888
    buffer_load_dwordx4 a[100:103], v8, s[28:31], s7 offen offset:0 sc1
    s_waitcnt lgkmcnt(6)
    v_mfma_f32_16x16x32_bf16 v[44:47], a[188:191], a[56:59], v[44:47]
    v_mfma_f32_16x16x32_bf16 v[72:75], a[188:191], a[60:63], v[72:75]
    ds_read_b128 a[184:187], v12 offset:38912
    s_waitcnt vmcnt(8) lgkmcnt(6)
    v_mfma_f32_16x16x32_bf16 v[32:35], a[160:163], a[64:67], v[32:35]
    v_mfma_f32_16x16x32_bf16 v[60:63], a[160:163], a[68:71], v[60:63]
    ds_read_b128 a[188:191], v12 offset:39936
    buffer_load_dwordx4 a[104:107], v8, s[28:31], s6 offen offset:1024 sc1
    s_waitcnt lgkmcnt(6)
    v_mfma_f32_16x16x32_bf16 v[36:39], a[164:167], a[64:67], v[36:39]
    v_mfma_f32_16x16x32_bf16 v[64:67], a[164:167], a[68:71], v[64:67]
    ds_read_b128 a[160:163], v12 offset:40960
    s_waitcnt lgkmcnt(6)
    v_mfma_f32_16x16x32_bf16 v[40:43], a[168:171], a[64:67], v[40:43]
    v_mfma_f32_16x16x32_bf16 v[68:71], a[168:171], a[68:71], v[68:71]
    ds_read_b128 a[164:167], v12 offset:41984
    buffer_load_dwordx4 a[108:111], v8, s[28:31], s7 offen offset:1024 sc1
    s_waitcnt lgkmcnt(6)
    v_mfma_f32_16x16x32_bf16 v[44:47], a[172:175], a[64:67], v[44:47]
    v_mfma_f32_16x16x32_bf16 v[72:75], a[172:175], a[68:71], v[72:75]
    ds_read_b128 a[168:171], v12 offset:43008
    s_waitcnt vmcnt(8) lgkmcnt(6)
    v_mfma_f32_16x16x32_bf16 v[32:35], a[176:179], a[72:75], v[32:35]
    v_mfma_f32_16x16x32_bf16 v[60:63], a[176:179], a[76:79], v[60:63]
    ds_read_b128 a[172:175], v12 offset:44032
    buffer_load_dwordx4 a[112:115], v8, s[28:31], s6 offen offset:2048 sc1
    s_waitcnt lgkmcnt(6)
    v_mfma_f32_16x16x32_bf16 v[36:39], a[180:183], a[72:75], v[36:39]
    v_mfma_f32_16x16x32_bf16 v[64:67], a[180:183], a[76:79], v[64:67]
    ds_read_b128 a[176:179], v12 offset:45056
    s_waitcnt lgkmcnt(6)
    v_mfma_f32_16x16x32_bf16 v[40:43], a[184:187], a[72:75], v[40:43]
    v_mfma_f32_16x16x32_bf16 v[68:71], a[184:187], a[76:79], v[68:71]
    ds_read_b128 a[180:183], v12 offset:46080
    buffer_load_dwordx4 a[116:119], v8, s[28:31], s7 offen offset:2048 sc1
    s_waitcnt lgkmcnt(6)
    v_mfma_f32_16x16x32_bf16 v[44:47], a[188:191], a[72:75], v[44:47]
    v_mfma_f32_16x16x32_bf16 v[72:75], a[188:191], a[76:79], v[72:75]
    ds_read_b128 a[184:187], v12 offset:47104
    s_waitcnt vmcnt(8) lgkmcnt(6)
    v_mfma_f32_16x16x32_bf16 v[32:35], a[160:163], a[80:83], v[32:35]
    v_mfma_f32_16x16x32_bf16 v[60:63], a[160:163], a[84:87], v[60:63]
    ds_read_b128 a[188:191], v12 offset:48128
    buffer_load_dwordx4 a[120:123], v8, s[28:31], s6 offen offset:3072 sc1
    s_waitcnt lgkmcnt(6)
    v_mfma_f32_16x16x32_bf16 v[36:39], a[164:167], a[80:83], v[36:39]
    v_mfma_f32_16x16x32_bf16 v[64:67], a[164:167], a[84:87], v[64:67]
    ds_read_b128 a[160:163], v12 offset:49152
    s_waitcnt lgkmcnt(6)
    v_mfma_f32_16x16x32_bf16 v[40:43], a[168:171], a[80:83], v[40:43]
    v_mfma_f32_16x16x32_bf16 v[68:71], a[168:171], a[84:87], v[68:71]
    ds_read_b128 a[164:167], v12 offset:50176
    buffer_load_dwordx4 a[124:127], v8, s[28:31], s7 offen offset:3072 sc1
    s_waitcnt lgkmcnt(6)
    v_mfma_f32_16x16x32_bf16 v[44:47], a[172:175], a[80:83], v[44:47]
    v_mfma_f32_16x16x32_bf16 v[72:75], a[172:175], a[84:87], v[72:75]
    ds_read_b128 a[168:171], v12 offset:51200
    s_waitcnt vmcnt(8) lgkmcnt(6)
    v_mfma_f32_16x16x32_bf16 v[32:35], a[176:179], a[88:91], v[32:35]
    v_mfma_f32_16x16x32_bf16 v[60:63], a[176:179], a[92:95], v[60:63]
    ds_read_b128 a[172:175], v12 offset:52224
    s_add_u32 s6, s6, 4096
    s_add_u32 s7, s7, 4096
    buffer_load_dwordx4 a[128:131], v8, s[28:31], s6 offen offset:0 sc1
    s_waitcnt lgkmcnt(6)
    v_mfma_f32_16x16x32_bf16 v[36:39], a[180:183], a[88:91], v[36:39]
    v_mfma_f32_16x16x32_bf16 v[64:67], a[180:183], a[92:95], v[64:67]
    ds_read_b128 a[176:179], v12 offset:53248
    s_waitcnt lgkmcnt(6)
    v_mfma_f32_16x16x32_bf16 v[40:43], a[184:187], a[88:91], v[40:43]
    v_mfma_f32_16x16x32_bf16 v[68:71], a[184:187], a[92:95], v[68:71]
    ds_read_b128 a[180:183], v12 offset:54272
    buffer_load_dwordx4 a[132:135], v8, s[28:31], s7 offen offset:0 sc1
    s_waitcnt lgkmcnt(6)
    v_mfma_f32_16x16x32_bf16 v[44:47], a[188:191], a[88:91], v[44:47]
    v_mfma_f32_16x16x32_bf16 v[72:75], a[188:191], a[92:95], v[72:75]
    ds_read_b128 a[184:187], v12 offset:55296
    s_waitcnt vmcnt(8) lgkmcnt(6)
    v_mfma_f32_16x16x32_bf16 v[32:35], a[160:163], a[96:99], v[32:35]
    v_mfma_f32_16x16x32_bf16 v[60:63], a[160:163], a[100:103], v[60:63]
    ds_read_b128 a[188:191], v12 offset:56320
    buffer_load_dwordx4 a[136:139], v8, s[28:31], s6 offen offset:1024 sc1
    s_waitcnt lgkmcnt(6)
    v_mfma_f32_16x16x32_bf16 v[36:39], a[164:167], a[96:99], v[36:39]
    v_mfma_f32_16x16x32_bf16 v[64:67], a[164:167], a[100:103], v[64:67]
    ds_read_b128 a[160:163], v12 offset:57344
    s_waitcnt lgkmcnt(6)
    v_mfma_f32_16x16x32_bf16 v[40:43], a[168:171], a[96:99], v[40:43]
    v_mfma_f32_16x16x32_bf16 v[68:71], a[168:171], a[100:103], v[68:71]
    ds_read_b128 a[164:167], v12 offset:58368
    buffer_load_dwordx4 a[140:143], v8, s[28:31], s7 offen offset:1024 sc1
    s_waitcnt lgkmcnt(6)
    v_mfma_f32_16x16x32_bf16 v[44:47], a[172:175], a[96:99], v[44:47]
    v_mfma_f32_16x16x32_bf16 v[72:75], a[172:175], a[100:103], v[72:75]
    ds_read_b128 a[168:171], v12 offset:59392
    s_waitcnt vmcnt(8) lgkmcnt(6)
    v_mfma_f32_16x16x32_bf16 v[32:35], a[176:179], a[104:107], v[32:35]
    v_mfma_f32_16x16x32_bf16 v[60:63], a[176:179], a[108:111], v[60:63]
    ds_read_b128 a[172:175], v12 offset:60416
    buffer_load_dwordx4 a[144:147], v8, s[28:31], s6 offen offset:2048 sc1
    s_waitcnt lgkmcnt(6)
    v_mfma_f32_16x16x32_bf16 v[36:39], a[180:183], a[104:107], v[36:39]
    v_mfma_f32_16x16x32_bf16 v[64:67], a[180:183], a[108:111], v[64:67]
    ds_read_b128 a[176:179], v12 offset:61440
    s_waitcnt lgkmcnt(6)
    v_mfma_f32_16x16x32_bf16 v[40:43], a[184:187], a[104:107], v[40:43]
    v_mfma_f32_16x16x32_bf16 v[68:71], a[184:187], a[108:111], v[68:71]
    ds_read_b128 a[180:183], v12 offset:62464
    buffer_load_dwordx4 a[148:151], v8, s[28:31], s7 offen offset:2048 sc1
    s_waitcnt lgkmcnt(6)
    v_mfma_f32_16x16x32_bf16 v[44:47], a[188:191], a[104:107], v[44:47]
    v_mfma_f32_16x16x32_bf16 v[72:75], a[188:191], a[108:111], v[72:75]
    ds_read_b128 a[184:187], v12 offset:63488
    s_waitcnt vmcnt(8) lgkmcnt(6)
    v_mfma_f32_16x16x32_bf16 v[32:35], a[160:163], a[112:115], v[32:35]
    v_mfma_f32_16x16x32_bf16 v[60:63], a[160:163], a[116:119], v[60:63]
    ds_read_b128 a[188:191], v12 offset:64512
    buffer_load_dwordx4 a[152:155], v8, s[28:31], s6 offen offset:3072 sc1
    s_waitcnt lgkmcnt(6)
    v_mfma_f32_16x16x32_bf16 v[36:39], a[164:167], a[112:115], v[36:39]
    v_mfma_f32_16x16x32_bf16 v[64:67], a[164:167], a[116:119], v[64:67]
    ds_read_b128 a[160:163], v13 offset:0
    s_waitcnt lgkmcnt(6)
    v_mfma_f32_16x16x32_bf16 v[40:43], a[168:171], a[112:115], v[40:43]
    v_mfma_f32_16x16x32_bf16 v[68:71], a[168:171], a[116:119], v[68:71]
    ds_read_b128 a[164:167], v13 offset:1024
    buffer_load_dwordx4 a[156:159], v8, s[28:31], s7 offen offset:3072 sc1
    s_waitcnt lgkmcnt(6)
    v_mfma_f32_16x16x32_bf16 v[44:47], a[172:175], a[112:115], v[44:47]
    v_mfma_f32_16x16x32_bf16 v[72:75], a[172:175], a[116:119], v[72:75]
    ds_read_b128 a[168:171], v13 offset:2048
    s_waitcnt vmcnt(8) lgkmcnt(6)
    v_mfma_f32_16x16x32_bf16 v[32:35], a[176:179], a[120:123], v[32:35]
    v_mfma_f32_16x16x32_bf16 v[60:63], a[176:179], a[124:127], v[60:63]
    ds_read_b128 a[172:175], v13 offset:3072
    buffer_load_dwordx2 v[16:17], v228, s[28:31], s9 offen offset:0 sc1
    s_waitcnt lgkmcnt(6)
    v_mfma_f32_16x16x32_bf16 v[36:39], a[180:183], a[120:123], v[36:39]
    v_mfma_f32_16x16x32_bf16 v[64:67], a[180:183], a[124:127], v[64:67]
    ds_read_b128 a[176:179], v13 offset:4096
    s_waitcnt lgkmcnt(6)
    v_mfma_f32_16x16x32_bf16 v[40:43], a[184:187], a[120:123], v[40:43]
    v_mfma_f32_16x16x32_bf16 v[68:71], a[184:187], a[124:127], v[68:71]
    ds_read_b128 a[180:183], v13 offset:5120
    buffer_load_dwordx2 v[18:19], v228, s[28:31], s9 offen offset:128 sc1
    s_waitcnt lgkmcnt(6)
    v_mfma_f32_16x16x32_bf16 v[44:47], a[188:191], a[120:123], v[44:47]
    v_mfma_f32_16x16x32_bf16 v[72:75], a[188:191], a[124:127], v[72:75]
    ds_read_b128 a[184:187], v13 offset:6144
    s_waitcnt vmcnt(8) lgkmcnt(6)
    v_mfma_f32_16x16x32_bf16 v[32:35], a[160:163], a[128:131], v[32:35]
    v_mfma_f32_16x16x32_bf16 v[60:63], a[160:163], a[132:135], v[60:63]
    ds_read_b128 a[188:191], v13 offset:7168
    buffer_load_dwordx2 v[20:21], v228, s[28:31], s9 offen offset:1024 sc1
    s_waitcnt lgkmcnt(6)
    v_mfma_f32_16x16x32_bf16 v[36:39], a[164:167], a[128:131], v[36:39]
    v_mfma_f32_16x16x32_bf16 v[64:67], a[164:167], a[132:135], v[64:67]
    ds_read_b128 a[160:163], v13 offset:8192
    s_waitcnt lgkmcnt(6)
    v_mfma_f32_16x16x32_bf16 v[40:43], a[168:171], a[128:131], v[40:43]
    v_mfma_f32_16x16x32_bf16 v[68:71], a[168:171], a[132:135], v[68:71]
    ds_read_b128 a[164:167], v13 offset:9216
    buffer_load_dwordx2 v[22:23], v228, s[28:31], s9 offen offset:1152 sc1
    s_waitcnt lgkmcnt(6)
    v_mfma_f32_16x16x32_bf16 v[44:47], a[172:175], a[128:131], v[44:47]
    v_mfma_f32_16x16x32_bf16 v[72:75], a[172:175], a[132:135], v[72:75]
    ds_read_b128 a[168:171], v13 offset:10240
    s_waitcnt vmcnt(8) lgkmcnt(6)
    v_mfma_f32_16x16x32_bf16 v[32:35], a[176:179], a[136:139], v[32:35]
    v_mfma_f32_16x16x32_bf16 v[60:63], a[176:179], a[140:143], v[60:63]
    ds_read_b128 a[172:175], v13 offset:11264
    s_waitcnt lgkmcnt(6)
    v_mfma_f32_16x16x32_bf16 v[36:39], a[180:183], a[136:139], v[36:39]
    v_mfma_f32_16x16x32_bf16 v[64:67], a[180:183], a[140:143], v[64:67]
    ds_read_b128 a[176:179], v13 offset:12288
    s_mul_i32 s25, s20, 3
    s_min_u32 s25, s25, 7
    s_lshl_b32 s25, s25, 10
    s_add_u32 s62, s25, 143360
    s_add_u32 s63, s25, s59
    s_add_u32 s63, s63, 0
    s_mov_b32 m0, s62
    buffer_load_dwordx4 v8, s[28:31], s63 offen offset:0 lds
    s_waitcnt lgkmcnt(6)
    v_mfma_f32_16x16x32_bf16 v[40:43], a[184:187], a[136:139], v[40:43]
    v_mfma_f32_16x16x32_bf16 v[68:71], a[184:187], a[140:143], v[68:71]
    ds_read_b128 a[180:183], v13 offset:13312
    s_waitcnt lgkmcnt(6)
    v_mfma_f32_16x16x32_bf16 v[44:47], a[188:191], a[136:139], v[44:47]
    v_mfma_f32_16x16x32_bf16 v[72:75], a[188:191], a[140:143], v[72:75]
    ds_read_b128 a[184:187], v13 offset:14336
    buffer_load_dwordx4 v8, s[28:31], s63 offen offset:1024 lds
    s_waitcnt vmcnt(8) lgkmcnt(6)
    v_mfma_f32_16x16x32_bf16 v[32:35], a[160:163], a[144:147], v[32:35]
    v_mfma_f32_16x16x32_bf16 v[60:63], a[160:163], a[148:151], v[60:63]
    ds_read_b128 a[188:191], v13 offset:15360
    s_waitcnt lgkmcnt(6)
    v_mfma_f32_16x16x32_bf16 v[36:39], a[164:167], a[144:147], v[36:39]
    v_mfma_f32_16x16x32_bf16 v[64:67], a[164:167], a[148:151], v[64:67]
    ds_read_b128 a[160:163], v13 offset:16384
    buffer_load_dwordx4 v8, s[28:31], s63 offen offset:2048 lds
    s_waitcnt lgkmcnt(6)
    v_mfma_f32_16x16x32_bf16 v[40:43], a[168:171], a[144:147], v[40:43]
    v_mfma_f32_16x16x32_bf16 v[68:71], a[168:171], a[148:151], v[68:71]
    ds_read_b128 a[164:167], v13 offset:17408
    s_waitcnt lgkmcnt(6)
    v_mfma_f32_16x16x32_bf16 v[44:47], a[172:175], a[144:147], v[44:47]
    v_mfma_f32_16x16x32_bf16 v[72:75], a[172:175], a[148:151], v[72:75]
    ds_read_b128 a[168:171], v13 offset:18432
    s_waitcnt vmcnt(7) lgkmcnt(6)
    v_mfma_f32_16x16x32_bf16 v[32:35], a[176:179], a[152:155], v[32:35]
    v_mfma_f32_16x16x32_bf16 v[60:63], a[176:179], a[156:159], v[60:63]
    ds_read_b128 a[172:175], v13 offset:19456
    s_waitcnt lgkmcnt(6)
    v_mfma_f32_16x16x32_bf16 v[36:39], a[180:183], a[152:155], v[36:39]
    v_mfma_f32_16x16x32_bf16 v[64:67], a[180:183], a[156:159], v[64:67]
    ds_read_b128 a[176:179], v13 offset:20480
    s_waitcnt lgkmcnt(6)
    v_mfma_f32_16x16x32_bf16 v[40:43], a[184:187], a[152:155], v[40:43]
    v_mfma_f32_16x16x32_bf16 v[68:71], a[184:187], a[156:159], v[68:71]
    ds_read_b128 a[180:183], v13 offset:21504
    s_waitcnt lgkmcnt(6)
    v_mfma_f32_16x16x32_bf16 v[44:47], a[188:191], a[152:155], v[44:47]
    v_mfma_f32_16x16x32_bf16 v[72:75], a[188:191], a[156:159], v[72:75]
    ds_read_b128 a[184:187], v13 offset:22528
    s_waitcnt lgkmcnt(6)
    v_mfma_f32_16x16x32_bf16 v[48:51], a[160:163], a[0:3], 0
    v_mfma_f32_16x16x32_bf16 v[76:79], a[160:163], a[4:7], 0
    ds_read_b128 a[188:191], v13 offset:23552
    s_waitcnt lgkmcnt(6)
    v_mfma_f32_16x16x32_bf16 v[52:55], a[164:167], a[0:3], 0
    v_mfma_f32_16x16x32_bf16 v[80:83], a[164:167], a[4:7], 0
    ds_read_b128 a[160:163], v13 offset:24576
    s_barrier
    s_waitcnt lgkmcnt(6)
    v_mfma_f32_16x16x32_bf16 v[48:51], a[168:171], a[8:11], v[48:51]
    v_mfma_f32_16x16x32_bf16 v[76:79], a[168:171], a[12:15], v[76:79]
    ds_read_b128 a[164:167], v13 offset:25600
    s_mul_i32 s25, s20, 20
    s_lshl_b32 s25, s25, 10
    s_add_u32 s62, s25, 0
    s_add_u32 s63, s25, s59
    s_add_u32 s63, s63, 10240
    s_mov_b32 m0, s62
    buffer_load_dwordx4 v8, s[28:31], s63 offen offset:0 lds
    s_waitcnt lgkmcnt(6)
    v_mfma_f32_16x16x32_bf16 v[52:55], a[172:175], a[8:11], v[52:55]
    v_mfma_f32_16x16x32_bf16 v[80:83], a[172:175], a[12:15], v[80:83]
    ds_read_b128 a[168:171], v13 offset:26624
    s_waitcnt lgkmcnt(6)
    v_mfma_f32_16x16x32_bf16 v[48:51], a[176:179], a[16:19], v[48:51]
    v_mfma_f32_16x16x32_bf16 v[76:79], a[176:179], a[20:23], v[76:79]
    ds_read_b128 a[172:175], v13 offset:27648
    buffer_load_dwordx4 v8, s[28:31], s63 offen offset:1024 lds
    s_waitcnt lgkmcnt(6)
    v_mfma_f32_16x16x32_bf16 v[52:55], a[180:183], a[16:19], v[52:55]
    v_mfma_f32_16x16x32_bf16 v[80:83], a[180:183], a[20:23], v[80:83]
    ds_read_b128 a[176:179], v13 offset:28672
    s_waitcnt lgkmcnt(6)
    v_mfma_f32_16x16x32_bf16 v[48:51], a[184:187], a[24:27], v[48:51]
    v_mfma_f32_16x16x32_bf16 v[76:79], a[184:187], a[28:31], v[76:79]
    ds_read_b128 a[180:183], v13 offset:29696
    buffer_load_dwordx4 v8, s[28:31], s63 offen offset:2048 lds
    s_waitcnt lgkmcnt(6)
    v_mfma_f32_16x16x32_bf16 v[52:55], a[188:191], a[24:27], v[52:55]
    v_mfma_f32_16x16x32_bf16 v[80:83], a[188:191], a[28:31], v[80:83]
    ds_read_b128 a[184:187], v13 offset:30720
    s_waitcnt lgkmcnt(6)
    v_mfma_f32_16x16x32_bf16 v[48:51], a[160:163], a[32:35], v[48:51]
    v_mfma_f32_16x16x32_bf16 v[76:79], a[160:163], a[36:39], v[76:79]
    ds_read_b128 a[188:191], v13 offset:31744
    buffer_load_dwordx4 v8, s[28:31], s63 offen offset:3072 lds
    s_waitcnt lgkmcnt(6)
    v_mfma_f32_16x16x32_bf16 v[52:55], a[164:167], a[32:35], v[52:55]
    v_mfma_f32_16x16x32_bf16 v[80:83], a[164:167], a[36:39], v[80:83]
    ds_read_b128 a[160:163], v13 offset:32768
    s_waitcnt lgkmcnt(6)
    v_mfma_f32_16x16x32_bf16 v[48:51], a[168:171], a[40:43], v[48:51]
    v_mfma_f32_16x16x32_bf16 v[76:79], a[168:171], a[44:47], v[76:79]
    ds_read_b128 a[164:167], v13 offset:33792
    s_add_u32 s62, s62, 4096
    s_add_u32 s63, s63, 4096
    s_mov_b32 m0, s62
    buffer_load_dwordx4 v8, s[28:31], s63 offen offset:0 lds
    s_waitcnt lgkmcnt(6)
    v_mfma_f32_16x16x32_bf16 v[52:55], a[172:175], a[40:43], v[52:55]
    v_mfma_f32_16x16x32_bf16 v[80:83], a[172:175], a[44:47], v[80:83]
    ds_read_b128 a[168:171], v13 offset:34816
    s_waitcnt lgkmcnt(6)
    v_mfma_f32_16x16x32_bf16 v[48:51], a[176:179], a[48:51], v[48:51]
    v_mfma_f32_16x16x32_bf16 v[76:79], a[176:179], a[52:55], v[76:79]
    ds_read_b128 a[172:175], v13 offset:35840
    buffer_load_dwordx4 v8, s[28:31], s63 offen offset:1024 lds
    s_waitcnt lgkmcnt(6)
    v_mfma_f32_16x16x32_bf16 v[52:55], a[180:183], a[48:51], v[52:55]
    v_mfma_f32_16x16x32_bf16 v[80:83], a[180:183], a[52:55], v[80:83]
    ds_read_b128 a[176:179], v13 offset:36864
    s_waitcnt lgkmcnt(6)
    v_mfma_f32_16x16x32_bf16 v[48:51], a[184:187], a[56:59], v[48:51]
    v_mfma_f32_16x16x32_bf16 v[76:79], a[184:187], a[60:63], v[76:79]
    ds_read_b128 a[180:183], v13 offset:37888
    buffer_load_dwordx4 v8, s[28:31], s63 offen offset:2048 lds
    s_waitcnt lgkmcnt(6)
    v_mfma_f32_16x16x32_bf16 v[52:55], a[188:191], a[56:59], v[52:55]
    v_mfma_f32_16x16x32_bf16 v[80:83], a[188:191], a[60:63], v[80:83]
    ds_read_b128 a[184:187], v13 offset:38912
    s_waitcnt lgkmcnt(6)
    v_mfma_f32_16x16x32_bf16 v[48:51], a[160:163], a[64:67], v[48:51]
    v_mfma_f32_16x16x32_bf16 v[76:79], a[160:163], a[68:71], v[76:79]
    ds_read_b128 a[188:191], v13 offset:39936
    buffer_load_dwordx4 v8, s[28:31], s63 offen offset:3072 lds
    s_waitcnt lgkmcnt(6)
    v_mfma_f32_16x16x32_bf16 v[52:55], a[164:167], a[64:67], v[52:55]
    v_mfma_f32_16x16x32_bf16 v[80:83], a[164:167], a[68:71], v[80:83]
    ds_read_b128 a[160:163], v13 offset:40960
    s_waitcnt lgkmcnt(6)
    v_mfma_f32_16x16x32_bf16 v[48:51], a[168:171], a[72:75], v[48:51]
    v_mfma_f32_16x16x32_bf16 v[76:79], a[168:171], a[76:79], v[76:79]
    ds_read_b128 a[164:167], v13 offset:41984
    s_add_u32 s62, s62, 4096
    s_add_u32 s63, s63, 4096
    s_mov_b32 m0, s62
    buffer_load_dwordx4 v8, s[28:31], s63 offen offset:0 lds
    s_waitcnt lgkmcnt(6)
    v_mfma_f32_16x16x32_bf16 v[52:55], a[172:175], a[72:75], v[52:55]
    v_mfma_f32_16x16x32_bf16 v[80:83], a[172:175], a[76:79], v[80:83]
    ds_read_b128 a[168:171], v13 offset:43008
    s_waitcnt lgkmcnt(6)
    v_mfma_f32_16x16x32_bf16 v[48:51], a[176:179], a[80:83], v[48:51]
    v_mfma_f32_16x16x32_bf16 v[76:79], a[176:179], a[84:87], v[76:79]
    ds_read_b128 a[172:175], v13 offset:44032
    buffer_load_dwordx4 v8, s[28:31], s63 offen offset:1024 lds
    s_waitcnt lgkmcnt(6)
    v_mfma_f32_16x16x32_bf16 v[52:55], a[180:183], a[80:83], v[52:55]
    v_mfma_f32_16x16x32_bf16 v[80:83], a[180:183], a[84:87], v[80:83]
    ds_read_b128 a[176:179], v13 offset:45056
    s_waitcnt lgkmcnt(6)
    v_mfma_f32_16x16x32_bf16 v[48:51], a[184:187], a[88:91], v[48:51]
    v_mfma_f32_16x16x32_bf16 v[76:79], a[184:187], a[92:95], v[76:79]
    ds_read_b128 a[180:183], v13 offset:46080
    buffer_load_dwordx4 v8, s[28:31], s63 offen offset:2048 lds
    s_waitcnt lgkmcnt(6)
    v_mfma_f32_16x16x32_bf16 v[52:55], a[188:191], a[88:91], v[52:55]
    v_mfma_f32_16x16x32_bf16 v[80:83], a[188:191], a[92:95], v[80:83]
    ds_read_b128 a[184:187], v13 offset:47104
    s_waitcnt lgkmcnt(6)
    v_mfma_f32_16x16x32_bf16 v[48:51], a[160:163], a[96:99], v[48:51]
    v_mfma_f32_16x16x32_bf16 v[76:79], a[160:163], a[100:103], v[76:79]
    ds_read_b128 a[188:191], v13 offset:48128
    buffer_load_dwordx4 v8, s[28:31], s63 offen offset:3072 lds
    s_waitcnt lgkmcnt(6)
    v_mfma_f32_16x16x32_bf16 v[52:55], a[164:167], a[96:99], v[52:55]
    v_mfma_f32_16x16x32_bf16 v[80:83], a[164:167], a[100:103], v[80:83]
    ds_read_b128 a[160:163], v13 offset:49152
    s_waitcnt lgkmcnt(6)
    v_mfma_f32_16x16x32_bf16 v[48:51], a[168:171], a[104:107], v[48:51]
    v_mfma_f32_16x16x32_bf16 v[76:79], a[168:171], a[108:111], v[76:79]
    ds_read_b128 a[164:167], v13 offset:50176
    s_add_u32 s62, s62, 4096
    s_add_u32 s63, s63, 4096
    s_mov_b32 m0, s62
    buffer_load_dwordx4 v8, s[28:31], s63 offen offset:0 lds
    s_waitcnt lgkmcnt(6)
    v_mfma_f32_16x16x32_bf16 v[52:55], a[172:175], a[104:107], v[52:55]
    v_mfma_f32_16x16x32_bf16 v[80:83], a[172:175], a[108:111], v[80:83]
    ds_read_b128 a[168:171], v13 offset:51200
    s_waitcnt lgkmcnt(6)
    v_mfma_f32_16x16x32_bf16 v[48:51], a[176:179], a[112:115], v[48:51]
    v_mfma_f32_16x16x32_bf16 v[76:79], a[176:179], a[116:119], v[76:79]
    ds_read_b128 a[172:175], v13 offset:52224
    buffer_load_dwordx4 v8, s[28:31], s63 offen offset:1024 lds
    s_waitcnt lgkmcnt(6)
    v_mfma_f32_16x16x32_bf16 v[52:55], a[180:183], a[112:115], v[52:55]
    v_mfma_f32_16x16x32_bf16 v[80:83], a[180:183], a[116:119], v[80:83]
    ds_read_b128 a[176:179], v13 offset:53248
    s_waitcnt lgkmcnt(6)
    v_mfma_f32_16x16x32_bf16 v[48:51], a[184:187], a[120:123], v[48:51]
    v_mfma_f32_16x16x32_bf16 v[76:79], a[184:187], a[124:127], v[76:79]
    ds_read_b128 a[180:183], v13 offset:54272
    buffer_load_dwordx4 v8, s[28:31], s63 offen offset:2048 lds
    s_waitcnt lgkmcnt(6)
    v_mfma_f32_16x16x32_bf16 v[52:55], a[188:191], a[120:123], v[52:55]
    v_mfma_f32_16x16x32_bf16 v[80:83], a[188:191], a[124:127], v[80:83]
    ds_read_b128 a[184:187], v13 offset:55296
    s_waitcnt lgkmcnt(6)
    v_mfma_f32_16x16x32_bf16 v[48:51], a[160:163], a[128:131], v[48:51]
    v_mfma_f32_16x16x32_bf16 v[76:79], a[160:163], a[132:135], v[76:79]
    ds_read_b128 a[188:191], v13 offset:56320
    buffer_load_dwordx4 v8, s[28:31], s63 offen offset:3072 lds
    s_waitcnt lgkmcnt(6)
    v_mfma_f32_16x16x32_bf16 v[52:55], a[164:167], a[128:131], v[52:55]
    v_mfma_f32_16x16x32_bf16 v[80:83], a[164:167], a[132:135], v[80:83]
    ds_read_b128 a[160:163], v13 offset:57344
    s_waitcnt lgkmcnt(6)
    v_mfma_f32_16x16x32_bf16 v[48:51], a[168:171], a[136:139], v[48:51]
    v_mfma_f32_16x16x32_bf16 v[76:79], a[168:171], a[140:143], v[76:79]
    ds_read_b128 a[164:167], v13 offset:58368
    s_add_u32 s62, s62, 4096
    s_add_u32 s63, s63, 4096
    s_mov_b32 m0, s62
    buffer_load_dwordx4 v8, s[28:31], s63 offen offset:0 lds
    s_waitcnt lgkmcnt(6)
    v_mfma_f32_16x16x32_bf16 v[52:55], a[172:175], a[136:139], v[52:55]
    v_mfma_f32_16x16x32_bf16 v[80:83], a[172:175], a[140:143], v[80:83]
    ds_read_b128 a[168:171], v13 offset:59392
    s_waitcnt lgkmcnt(6)
    v_mfma_f32_16x16x32_bf16 v[48:51], a[176:179], a[144:147], v[48:51]
    v_mfma_f32_16x16x32_bf16 v[76:79], a[176:179], a[148:151], v[76:79]
    ds_read_b128 a[172:175], v13 offset:60416
    buffer_load_dwordx4 v8, s[28:31], s63 offen offset:1024 lds
    s_waitcnt lgkmcnt(6)
    v_mfma_f32_16x16x32_bf16 v[52:55], a[180:183], a[144:147], v[52:55]
    v_mfma_f32_16x16x32_bf16 v[80:83], a[180:183], a[148:151], v[80:83]
    ds_read_b128 a[176:179], v13 offset:61440
    s_waitcnt lgkmcnt(6)
    v_mfma_f32_16x16x32_bf16 v[48:51], a[184:187], a[152:155], v[48:51]
    v_mfma_f32_16x16x32_bf16 v[76:79], a[184:187], a[156:159], v[76:79]
    ds_read_b128 a[180:183], v13 offset:62464
    buffer_load_dwordx4 v8, s[28:31], s63 offen offset:2048 lds
    s_waitcnt lgkmcnt(6)
    v_mfma_f32_16x16x32_bf16 v[52:55], a[188:191], a[152:155], v[52:55]
    v_mfma_f32_16x16x32_bf16 v[80:83], a[188:191], a[156:159], v[80:83]
    ds_read_b128 a[184:187], v13 offset:63488
    s_waitcnt lgkmcnt(6)
    v_mfma_f32_16x16x32_bf16 v[56:59], a[160:163], a[0:3], 0
    v_mfma_f32_16x16x32_bf16 v[84:87], a[160:163], a[4:7], 0
    ds_read_b128 a[188:191], v13 offset:64512
    s_waitcnt lgkmcnt(6)
    v_mfma_f32_16x16x32_bf16 v[56:59], a[164:167], a[8:11], v[56:59]
    v_mfma_f32_16x16x32_bf16 v[84:87], a[164:167], a[12:15], v[84:87]
    ds_read_b128 a[160:163], v14 offset:0
    buffer_load_dwordx4 v8, s[28:31], s63 offen offset:3072 lds
    s_waitcnt lgkmcnt(6)
    v_mfma_f32_16x16x32_bf16 v[56:59], a[168:171], a[16:19], v[56:59]
    v_mfma_f32_16x16x32_bf16 v[84:87], a[168:171], a[20:23], v[84:87]
    ds_read_b128 a[164:167], v14 offset:1024
    s_mul_i32 s25, s20, 3
    s_min_u32 s25, s25, 7
    s_lshl_b32 s25, s25, 10
    s_add_u32 s62, s25, 153600
    s_add_u32 s63, s25, s59
    s_add_u32 s63, s63, 92160
    s_mov_b32 m0, s62
    buffer_load_dwordx4 v8, s[28:31], s63 offen offset:0 lds
    s_waitcnt lgkmcnt(6)
    v_mfma_f32_16x16x32_bf16 v[56:59], a[172:175], a[24:27], v[56:59]
    v_mfma_f32_16x16x32_bf16 v[84:87], a[172:175], a[28:31], v[84:87]
    ds_read_b128 a[168:171], v14 offset:2048
    buffer_load_dwordx4 v8, s[28:31], s63 offen offset:1024 lds
    s_waitcnt lgkmcnt(6)
    v_mfma_f32_16x16x32_bf16 v[56:59], a[176:179], a[32:35], v[56:59]
    v_mfma_f32_16x16x32_bf16 v[84:87], a[176:179], a[36:39], v[84:87]
    ds_read_b128 a[172:175], v14 offset:3072
    buffer_load_dwordx4 v8, s[28:31], s63 offen offset:2048 lds
    s_waitcnt lgkmcnt(6)
    v_mfma_f32_16x16x32_bf16 v[56:59], a[180:183], a[40:43], v[56:59]
    v_mfma_f32_16x16x32_bf16 v[84:87], a[180:183], a[44:47], v[84:87]
    ds_read_b128 a[176:179], v14 offset:4096
    s_waitcnt lgkmcnt(6)
    v_mfma_f32_16x16x32_bf16 v[56:59], a[184:187], a[48:51], v[56:59]
    v_mfma_f32_16x16x32_bf16 v[84:87], a[184:187], a[52:55], v[84:87]
    ds_read_b128 a[180:183], v14 offset:5120
    s_waitcnt lgkmcnt(6)
    v_mfma_f32_16x16x32_bf16 v[56:59], a[188:191], a[56:59], v[56:59]
    v_mfma_f32_16x16x32_bf16 v[84:87], a[188:191], a[60:63], v[84:87]
    ds_read_b128 a[184:187], v14 offset:6144
    s_waitcnt lgkmcnt(6)
    v_mfma_f32_16x16x32_bf16 v[56:59], a[160:163], a[64:67], v[56:59]
    v_mfma_f32_16x16x32_bf16 v[84:87], a[160:163], a[68:71], v[84:87]
    ds_read_b128 a[188:191], v14 offset:7168
    s_waitcnt lgkmcnt(6)
    v_mfma_f32_16x16x32_bf16 v[56:59], a[164:167], a[72:75], v[56:59]
    v_mfma_f32_16x16x32_bf16 v[84:87], a[164:167], a[76:79], v[84:87]
    ds_read_b128 a[160:163], v14 offset:8192
    s_waitcnt lgkmcnt(6)
    v_mfma_f32_16x16x32_bf16 v[56:59], a[168:171], a[80:83], v[56:59]
    v_mfma_f32_16x16x32_bf16 v[84:87], a[168:171], a[84:87], v[84:87]
    ds_read_b128 a[164:167], v14 offset:9216
    s_waitcnt lgkmcnt(6)
    v_mfma_f32_16x16x32_bf16 v[56:59], a[172:175], a[88:91], v[56:59]
    v_mfma_f32_16x16x32_bf16 v[84:87], a[172:175], a[92:95], v[84:87]
    ds_read_b128 a[168:171], v14 offset:10240
    s_waitcnt lgkmcnt(6)
    v_mfma_f32_16x16x32_bf16 v[56:59], a[176:179], a[96:99], v[56:59]
    v_mfma_f32_16x16x32_bf16 v[84:87], a[176:179], a[100:103], v[84:87]
    ds_read_b128 a[172:175], v14 offset:11264
    s_waitcnt lgkmcnt(6)
    v_mfma_f32_16x16x32_bf16 v[56:59], a[180:183], a[104:107], v[56:59]
    v_mfma_f32_16x16x32_bf16 v[84:87], a[180:183], a[108:111], v[84:87]
    s_waitcnt lgkmcnt(5)
    v_mfma_f32_16x16x32_bf16 v[56:59], a[184:187], a[112:115], v[56:59]
    v_mfma_f32_16x16x32_bf16 v[84:87], a[184:187], a[116:119], v[84:87]
    s_waitcnt lgkmcnt(4)
    v_mfma_f32_16x16x32_bf16 v[56:59], a[188:191], a[120:123], v[56:59]
    v_mfma_f32_16x16x32_bf16 v[84:87], a[188:191], a[124:127], v[84:87]
    s_waitcnt lgkmcnt(3)
    v_mfma_f32_16x16x32_bf16 v[56:59], a[160:163], a[128:131], v[56:59]
    v_mfma_f32_16x16x32_bf16 v[84:87], a[160:163], a[132:135], v[84:87]
    s_waitcnt lgkmcnt(2)
    v_mfma_f32_16x16x32_bf16 v[56:59], a[164:167], a[136:139], v[56:59]
    v_mfma_f32_16x16x32_bf16 v[84:87], a[164:167], a[140:143], v[84:87]
    s_waitcnt lgkmcnt(1)
    v_mfma_f32_16x16x32_bf16 v[56:59], a[168:171], a[144:147], v[56:59]
    v_mfma_f32_16x16x32_bf16 v[84:87], a[168:171], a[148:151], v[84:87]
    s_waitcnt lgkmcnt(0)
    v_mfma_f32_16x16x32_bf16 v[56:59], a[172:175], a[152:155], v[56:59]
    v_mfma_f32_16x16x32_bf16 v[84:87], a[172:175], a[156:159], v[84:87]
    s_barrier
    s_waitcnt vmcnt(26)
    v_add_f32 v16, v16, v18
    v_add_f32 v17, v17, v19
    v_add_f32 v20, v20, v22
    v_add_f32 v21, v21, v23
    s_nop 0
    v_mov_b32 v24, v16
    v_mov_b32 v25, v17
    v_mov_b32 v26, v20
    v_mov_b32 v27, v21
    s_nop 1
    v_permlane32_swap_b32 v24, v16
    v_permlane32_swap_b32 v25, v17
    v_permlane32_swap_b32 v26, v20
    v_permlane32_swap_b32 v27, v21
    s_nop 1
    v_add_f32 v16, v16, v24
    v_add_f32 v17, v17, v25
    v_add_f32 v20, v20, v26
    v_add_f32 v21, v21, v27
    v_mov_b32 v24, v16
    v_mov_b32 v25, v17
    v_mov_b32 v26, v20
    v_mov_b32 v27, v21
    s_nop 1
    v_permlane16_swap_b32 v24, v16
    v_permlane16_swap_b32 v25, v17
    v_permlane16_swap_b32 v26, v20
    v_permlane16_swap_b32 v27, v21
    s_nop 1
    v_add_f32 v16, v16, v24
    v_add_f32 v17, v17, v25
    v_add_f32 v20, v20, v26
    v_add_f32 v21, v21, v27
    v_mul_f32 v16, 0x3acccccd, v16
    v_mul_f32 v20, 0x3acccccd, v20
    v_mul_f32 v17, 0x3acccccd, v17
    v_mul_f32 v21, 0x3acccccd, v21
    v_fma_f32 v17, -v16, v16, v17
    v_fma_f32 v21, -v20, v20, v21
    v_max_f32 v17, 0, v17
    v_max_f32 v21, 0, v21
    v_cvt_pk_bf16_f32 v18, v16, v17
    v_cvt_pk_bf16_f32 v22, v20, v21
    v_lshlrev_b32 v16, 16, v18
    v_lshlrev_b32 v20, 16, v22
    v_and_b32 v17, 0xffff0000, v18
    v_and_b32 v21, 0xffff0000, v22
    v_add_f32 v17, 0x3727c5ac, v17
    v_add_f32 v21, 0x3727c5ac, v21
    v_cvt_pk_bf16_f32 v18, v17, v17
    v_cvt_pk_bf16_f32 v22, v21, v21
    v_lshlrev_b32 v17, 16, v18
    v_lshlrev_b32 v21, 16, v22
    v_sqrt_f32 v17, v17
    v_sqrt_f32 v21, v21
    s_nop 0
    s_nop 0
    v_cvt_pk_bf16_f32 v18, v17, v17
    v_cvt_pk_bf16_f32 v22, v21, v21
    v_lshlrev_b32 v17, 16, v18
    v_lshlrev_b32 v21, 16, v22
    v_rcp_f32 v17, v17
    v_rcp_f32 v21, v21
    s_nop 0
    s_nop 0
    v_mul_f32 v16, v16, v17
    v_mul_f32 v20, v20, v21
    v_sub_f32 v16, 0, v16
    v_sub_f32 v20, 0, v20
    v_mov_b32 v30, 0xbdd2d3e8
    v_mov_b32 v31, 0xc0135761
    v_pk_mul_f32 v[176:177], v[88:89], v[16:17] op_sel_hi:[1,0]
    v_pk_mul_f32 v[178:179], v[90:91], v[16:17] op_sel_hi:[1,0]
    v_pk_mul_f32 v[180:181], v[92:93], v[16:17] op_sel_hi:[1,0]
    v_pk_mul_f32 v[182:183], v[94:95], v[16:17] op_sel_hi:[1,0]
    v_pk_mul_f32 v[184:185], v[96:97], v[16:17] op_sel_hi:[1,0]
    v_pk_mul_f32 v[186:187], v[98:99], v[16:17] op_sel_hi:[1,0]
    v_pk_mul_f32 v[188:189], v[100:101], v[16:17] op_sel_hi:[1,0]
    v_pk_mul_f32 v[190:191], v[102:103], v[16:17] op_sel_hi:[1,0]
    v_pk_mul_f32 v[192:193], v[104:105], v[16:17] op_sel_hi:[1,0]
    v_pk_mul_f32 v[194:195], v[106:107], v[16:17] op_sel_hi:[1,0]
    v_pk_mul_f32 v[196:197], v[108:109], v[16:17] op_sel_hi:[1,0]
    v_pk_mul_f32 v[198:199], v[110:111], v[16:17] op_sel_hi:[1,0]
    v_pk_mul_f32 v[200:201], v[112:113], v[16:17] op_sel_hi:[1,0]
    v_pk_mul_f32 v[202:203], v[114:115], v[16:17] op_sel_hi:[1,0]
    v_pk_fma_f32 v[32:33], v[32:33], v[16:17], v[176:177] op_sel:[0,1,0] op_sel_hi:[1,1,1]
    v_pk_fma_f32 v[34:35], v[34:35], v[16:17], v[178:179] op_sel:[0,1,0] op_sel_hi:[1,1,1]
    v_pk_fma_f32 v[36:37], v[36:37], v[16:17], v[180:181] op_sel:[0,1,0] op_sel_hi:[1,1,1]
    v_pk_fma_f32 v[38:39], v[38:39], v[16:17], v[182:183] op_sel:[0,1,0] op_sel_hi:[1,1,1]
    v_pk_fma_f32 v[40:41], v[40:41], v[16:17], v[184:185] op_sel:[0,1,0] op_sel_hi:[1,1,1]
    v_pk_fma_f32 v[42:43], v[42:43], v[16:17], v[186:187] op_sel:[0,1,0] op_sel_hi:[1,1,1]
    v_pk_fma_f32 v[44:45], v[44:45], v[16:17], v[188:189] op_sel:[0,1,0] op_sel_hi:[1,1,1]
    v_pk_fma_f32 v[46:47], v[46:47], v[16:17], v[190:191] op_sel:[0,1,0] op_sel_hi:[1,1,1]
    v_pk_fma_f32 v[48:49], v[48:49], v[16:17], v[192:193] op_sel:[0,1,0] op_sel_hi:[1,1,1]
    v_pk_fma_f32 v[50:51], v[50:51], v[16:17], v[194:195] op_sel:[0,1,0] op_sel_hi:[1,1,1]
    v_pk_fma_f32 v[52:53], v[52:53], v[16:17], v[196:197] op_sel:[0,1,0] op_sel_hi:[1,1,1]
    v_pk_fma_f32 v[54:55], v[54:55], v[16:17], v[198:199] op_sel:[0,1,0] op_sel_hi:[1,1,1]
    v_pk_fma_f32 v[56:57], v[56:57], v[16:17], v[200:201] op_sel:[0,1,0] op_sel_hi:[1,1,1]
    v_pk_fma_f32 v[58:59], v[58:59], v[16:17], v[202:203] op_sel:[0,1,0] op_sel_hi:[1,1,1]
    v_pk_mul_f32 v[176:177], v[32:33], v[32:33]
    v_pk_mul_f32 v[178:179], v[34:35], v[34:35]
    v_pk_mul_f32 v[180:181], v[36:37], v[36:37]
    v_pk_mul_f32 v[182:183], v[38:39], v[38:39]
    v_pk_mul_f32 v[184:185], v[40:41], v[40:41]
    v_pk_mul_f32 v[186:187], v[42:43], v[42:43]
    s_mul_i32 s25, s20, 15
    s_lshl_b32 s25, s25, 10
    s_add_u32 s62, s25, 81920
    s_add_u32 s63, s25, s59
    s_add_u32 s63, s63, 102400
    s_mov_b32 m0, s62
    buffer_load_dwordx4 v8, s[28:31], s63 offen offset:0 lds
    v_pk_mul_f32 v[188:189], v[44:45], v[44:45]
    v_pk_mul_f32 v[190:191], v[46:47], v[46:47]
    v_pk_mul_f32 v[192:193], v[48:49], v[48:49]
    v_pk_mul_f32 v[194:195], v[50:51], v[50:51]
    v_pk_mul_f32 v[196:197], v[52:53], v[52:53]
    v_pk_mul_f32 v[198:199], v[54:55], v[54:55]
    v_pk_mul_f32 v[200:201], v[56:57], v[56:57]
    v_pk_mul_f32 v[202:203], v[58:59], v[58:59]
    v_pk_fma_f32 v[176:177], v[176:177], v[30:31], v[30:31] op_sel:[0,0,1] op_sel_hi:[1,0,1]
    v_pk_fma_f32 v[178:179], v[178:179], v[30:31], v[30:31] op_sel:[0,0,1] op_sel_hi:[1,0,1]
    v_pk_fma_f32 v[180:181], v[180:181], v[30:31], v[30:31] op_sel:[0,0,1] op_sel_hi:[1,0,1]
    v_pk_fma_f32 v[182:183], v[182:183], v[30:31], v[30:31] op_sel:[0,0,1] op_sel_hi:[1,0,1]
    buffer_load_dwordx4 v8, s[28:31], s63 offen offset:1024 lds
    v_pk_fma_f32 v[184:185], v[184:185], v[30:31], v[30:31] op_sel:[0,0,1] op_sel_hi:[1,0,1]
    v_pk_fma_f32 v[186:187], v[186:187], v[30:31], v[30:31] op_sel:[0,0,1] op_sel_hi:[1,0,1]
    v_pk_fma_f32 v[188:189], v[188:189], v[30:31], v[30:31] op_sel:[0,0,1] op_sel_hi:[1,0,1]
    v_pk_fma_f32 v[190:191], v[190:191], v[30:31], v[30:31] op_sel:[0,0,1] op_sel_hi:[1,0,1]
    v_pk_fma_f32 v[192:193], v[192:193], v[30:31], v[30:31] op_sel:[0,0,1] op_sel_hi:[1,0,1]
    v_pk_fma_f32 v[194:195], v[194:195], v[30:31], v[30:31] op_sel:[0,0,1] op_sel_hi:[1,0,1]
    v_pk_fma_f32 v[196:197], v[196:197], v[30:31], v[30:31] op_sel:[0,0,1] op_sel_hi:[1,0,1]
    v_pk_fma_f32 v[198:199], v[198:199], v[30:31], v[30:31] op_sel:[0,0,1] op_sel_hi:[1,0,1]
    v_pk_fma_f32 v[200:201], v[200:201], v[30:31], v[30:31] op_sel:[0,0,1] op_sel_hi:[1,0,1]
    v_pk_fma_f32 v[202:203], v[202:203], v[30:31], v[30:31] op_sel:[0,0,1] op_sel_hi:[1,0,1]
    v_pk_mul_f32 v[176:177], v[176:177], v[32:33]
    v_pk_mul_f32 v[178:179], v[178:179], v[34:35]
    buffer_load_dwordx4 v8, s[28:31], s63 offen offset:2048 lds
    v_pk_mul_f32 v[180:181], v[180:181], v[36:37]
    v_pk_mul_f32 v[182:183], v[182:183], v[38:39]
    v_pk_mul_f32 v[184:185], v[184:185], v[40:41]
    v_pk_mul_f32 v[186:187], v[186:187], v[42:43]
    v_pk_mul_f32 v[188:189], v[188:189], v[44:45]
    v_pk_mul_f32 v[190:191], v[190:191], v[46:47]
    v_pk_mul_f32 v[192:193], v[192:193], v[48:49]
    v_pk_mul_f32 v[194:195], v[194:195], v[50:51]
    v_pk_mul_f32 v[196:197], v[196:197], v[52:53]
    v_pk_mul_f32 v[198:199], v[198:199], v[54:55]
    v_pk_mul_f32 v[200:201], v[200:201], v[56:57]
    v_pk_mul_f32 v[202:203], v[202:203], v[58:59]
    buffer_load_dwordx4 v8, s[28:31], s63 offen offset:3072 lds
    v_exp_f32 v176, v176
    v_exp_f32 v177, v177
    v_exp_f32 v178, v178
    v_exp_f32 v179, v179
    v_exp_f32 v180, v180
    v_exp_f32 v181, v181
    v_exp_f32 v182, v182
    v_exp_f32 v183, v183
    v_exp_f32 v184, v184
    v_exp_f32 v185, v185
    v_exp_f32 v186, v186
    v_exp_f32 v187, v187
    s_add_u32 s62, s62, 4096
    s_add_u32 s63, s63, 4096
    s_mov_b32 m0, s62
    buffer_load_dwordx4 v8, s[28:31], s63 offen offset:0 lds
    v_exp_f32 v188, v188
    v_exp_f32 v189, v189
    v_exp_f32 v190, v190
    v_exp_f32 v191, v191
    v_exp_f32 v192, v192
    v_exp_f32 v193, v193
    v_exp_f32 v194, v194
    v_exp_f32 v195, v195
    v_exp_f32 v196, v196
    v_exp_f32 v197, v197
    v_exp_f32 v198, v198
    v_exp_f32 v199, v199
    buffer_load_dwordx4 v8, s[28:31], s63 offen offset:1024 lds
    v_exp_f32 v200, v200
    v_exp_f32 v201, v201
    v_exp_f32 v202, v202
    v_exp_f32 v203, v203
    v_pk_add_f32 v[176:177], v[176:177], 1.0 op_sel_hi:[1,0]
    v_pk_add_f32 v[178:179], v[178:179], 1.0 op_sel_hi:[1,0]
    v_pk_add_f32 v[180:181], v[180:181], 1.0 op_sel_hi:[1,0]
    v_pk_add_f32 v[182:183], v[182:183], 1.0 op_sel_hi:[1,0]
    v_pk_add_f32 v[184:185], v[184:185], 1.0 op_sel_hi:[1,0]
    v_pk_add_f32 v[186:187], v[186:187], 1.0 op_sel_hi:[1,0]
    v_pk_add_f32 v[188:189], v[188:189], 1.0 op_sel_hi:[1,0]
    v_pk_add_f32 v[190:191], v[190:191], 1.0 op_sel_hi:[1,0]
    buffer_load_dwordx4 v8, s[28:31], s63 offen offset:2048 lds
    v_pk_add_f32 v[192:193], v[192:193], 1.0 op_sel_hi:[1,0]
    v_pk_add_f32 v[194:195], v[194:195], 1.0 op_sel_hi:[1,0]
    v_pk_add_f32 v[196:197], v[196:197], 1.0 op_sel_hi:[1,0]
    v_pk_add_f32 v[198:199], v[198:199], 1.0 op_sel_hi:[1,0]
    v_pk_add_f32 v[200:201], v[200:201], 1.0 op_sel_hi:[1,0]
    v_pk_add_f32 v[202:203], v[202:203], 1.0 op_sel_hi:[1,0]
    v_rcp_f32 v176, v176
    v_rcp_f32 v177, v177
    v_rcp_f32 v178, v178
    v_rcp_f32 v179, v179
    v_rcp_f32 v180, v180
    v_rcp_f32 v181, v181
    buffer_load_dwordx4 v8, s[28:31], s63 offen offset:3072 lds
    v_rcp_f32 v182, v182
    v_rcp_f32 v183, v183
    v_rcp_f32 v184, v184
    v_rcp_f32 v185, v185
    v_rcp_f32 v186, v186
    v_rcp_f32 v187, v187
    v_rcp_f32 v188, v188
    v_rcp_f32 v189, v189
    v_rcp_f32 v190, v190
    v_rcp_f32 v191, v191
    v_rcp_f32 v192, v192
    v_rcp_f32 v193, v193
    s_add_u32 s62, s62, 4096
    s_add_u32 s63, s63, 4096
    s_mov_b32 m0, s62
    buffer_load_dwordx4 v8, s[28:31], s63 offen offset:0 lds
    v_rcp_f32 v194, v194
    v_rcp_f32 v195, v195
    v_rcp_f32 v196, v196
    v_rcp_f32 v197, v197
    v_rcp_f32 v198, v198
    v_rcp_f32 v199, v199
    v_rcp_f32 v200, v200
    v_rcp_f32 v201, v201
    v_rcp_f32 v202, v202
    v_rcp_f32 v203, v203
    v_pk_mul_f32 v[32:33], v[32:33], v[176:177]
    v_pk_mul_f32 v[34:35], v[34:35], v[178:179]
    buffer_load_dwordx4 v8, s[28:31], s63 offen offset:1024 lds
    v_pk_mul_f32 v[36:37], v[36:37], v[180:181]
    v_pk_mul_f32 v[38:39], v[38:39], v[182:183]
    v_pk_mul_f32 v[40:41], v[40:41], v[184:185]
    v_pk_mul_f32 v[42:43], v[42:43], v[186:187]
    v_pk_mul_f32 v[44:45], v[44:45], v[188:189]
    v_pk_mul_f32 v[46:47], v[46:47], v[190:191]
    v_pk_mul_f32 v[48:49], v[48:49], v[192:193]
    v_pk_mul_f32 v[50:51], v[50:51], v[194:195]
    v_pk_mul_f32 v[52:53], v[52:53], v[196:197]
    v_pk_mul_f32 v[54:55], v[54:55], v[198:199]
    v_pk_mul_f32 v[56:57], v[56:57], v[200:201]
    v_pk_mul_f32 v[58:59], v[58:59], v[202:203]
    buffer_load_dwordx4 v8, s[28:31], s63 offen offset:2048 lds
    v_cvt_pk_bf16_f32 v144, v32, v33
    v_cvt_pk_bf16_f32 v145, v34, v35
    v_cvt_pk_bf16_f32 v146, v36, v37
    v_cvt_pk_bf16_f32 v147, v38, v39
    v_cvt_pk_bf16_f32 v148, v40, v41
    v_cvt_pk_bf16_f32 v149, v42, v43
    v_cvt_pk_bf16_f32 v150, v44, v45
    v_cvt_pk_bf16_f32 v151, v46, v47
    v_cvt_pk_bf16_f32 v152, v48, v49
    v_cvt_pk_bf16_f32 v153, v50, v51
    v_cvt_pk_bf16_f32 v154, v52, v53
    v_cvt_pk_bf16_f32 v155, v54, v55
    v_cvt_pk_bf16_f32 v156, v56, v57
    v_cvt_pk_bf16_f32 v157, v58, v59
    s_nop 1
    v_permlane16_swap_b32 v144, v146
    v_permlane16_swap_b32 v145, v147
    v_permlane16_swap_b32 v148, v150
    v_permlane16_swap_b32 v149, v151
    v_permlane16_swap_b32 v152, v154
    v_permlane16_swap_b32 v153, v155
    s_add_u32 s26, s13, 0
    s_add_u32 s27, s12, 0
    buffer_store_dwordx4 v[144:147], v226, s[28:31], s26 offen sc1
    buffer_store_dwordx2 v[156:157], v227, s[28:31], s27 offen sc1
    s_cmp_eq_u32 s52, 15
    s_cbranch_scc1 chain_kernel_j157
    buffer_store_dwordx4 v[148:151], v226, s[28:31], s26 offen offset:1024 sc1
    buffer_store_dwordx4 v[152:155], v226, s[28:31], s26 offen offset:2048 sc1
chain_kernel_j157:
    v_pk_mul_f32 v[176:177], v[88:89], v[20:21] op_sel_hi:[1,0]
    v_pk_mul_f32 v[178:179], v[90:91], v[20:21] op_sel_hi:[1,0]
    v_pk_mul_f32 v[180:181], v[92:93], v[20:21] op_sel_hi:[1,0]
    v_pk_mul_f32 v[182:183], v[94:95], v[20:21] op_sel_hi:[1,0]
    v_pk_mul_f32 v[184:185], v[96:97], v[20:21] op_sel_hi:[1,0]
    v_pk_mul_f32 v[186:187], v[98:99], v[20:21] op_sel_hi:[1,0]
    v_pk_mul_f32 v[188:189], v[100:101], v[20:21] op_sel_hi:[1,0]
    v_pk_mul_f32 v[190:191], v[102:103], v[20:21] op_sel_hi:[1,0]
    v_pk_mul_f32 v[192:193], v[104:105], v[20:21] op_sel_hi:[1,0]
    v_pk_mul_f32 v[194:195], v[106:107], v[20:21] op_sel_hi:[1,0]
    v_pk_mul_f32 v[196:197], v[108:109], v[20:21] op_sel_hi:[1,0]
    v_pk_mul_f32 v[198:199], v[110:111], v[20:21] op_sel_hi:[1,0]
    v_pk_mul_f32 v[200:201], v[112:113], v[20:21] op_sel_hi:[1,0]
    v_pk_mul_f32 v[202:203], v[114:115], v[20:21] op_sel_hi:[1,0]
    v_pk_fma_f32 v[60:61], v[60:61], v[20:21], v[176:177] op_sel:[0,1,0] op_sel_hi:[1,1,1]
    v_pk_fma_f32 v[62:63], v[62:63], v[20:21], v[178:179] op_sel:[0,1,0] op_sel_hi:[1,1,1]
    v_pk_fma_f32 v[64:65], v[64:65], v[20:21], v[180:181] op_sel:[0,1,0] op_sel_hi:[1,1,1]
    v_pk_fma_f32 v[66:67], v[66:67], v[20:21], v[182:183] op_sel:[0,1,0] op_sel_hi:[1,1,1]
    v_pk_fma_f32 v[68:69], v[68:69], v[20:21], v[184:185] op_sel:[0,1,0] op_sel_hi:[1,1,1]
    v_pk_fma_f32 v[70:71], v[70:71], v[20:21], v[186:187] op_sel:[0,1,0] op_sel_hi:[1,1,1]
    v_pk_fma_f32 v[72:73], v[72:73], v[20:21], v[188:189] op_sel:[0,1,0] op_sel_hi:[1,1,1]
    v_pk_fma_f32 v[74:75], v[74:75], v[20:21], v[190:191] op_sel:[0,1,0] op_sel_hi:[1,1,1]
    v_pk_fma_f32 v[76:77], v[76:77], v[20:21], v[192:193] op_sel:[0,1,0] op_sel_hi:[1,1,1]
    v_pk_fma_f32 v[78:79], v[78:79], v[20:21], v[194:195] op_sel:[0,1,0] op_sel_hi:[1,1,1]
    v_pk_fma_f32 v[80:81], v[80:81], v[20:21], v[196:197] op_sel:[0,1,0] op_sel_hi:[1,1,1]
    v_pk_fma_f32 v[82:83], v[82:83], v[20:21], v[198:199] op_sel:[0,1,0] op_sel_hi:[1,1,1]
    v_pk_fma_f32 v[84:85], v[84:85], v[20:21], v[200:201] op_sel:[0,1,0] op_sel_hi:[1,1,1]
    v_pk_fma_f32 v[86:87], v[86:87], v[20:21], v[202:203] op_sel:[0,1,0] op_sel_hi:[1,1,1]
    v_pk_mul_f32 v[176:177], v[60:61], v[60:61]
    v_pk_mul_f32 v[178:179], v[62:63], v[62:63]
    v_pk_mul_f32 v[180:181], v[64:65], v[64:65]
    v_pk_mul_f32 v[182:183], v[66:67], v[66:67]
    v_pk_mul_f32 v[184:185], v[68:69], v[68:69]
    v_pk_mul_f32 v[186:187], v[70:71], v[70:71]
    buffer_load_dwordx4 v8, s[28:31], s63 offen offset:3072 lds
    v_pk_mul_f32 v[188:189], v[72:73], v[72:73]
    v_pk_mul_f32 v[190:191], v[74:75], v[74:75]
    v_pk_mul_f32 v[192:193], v[76:77], v[76:77]
    v_pk_mul_f32 v[194:195], v[78:79], v[78:79]
    v_pk_mul_f32 v[196:197], v[80:81], v[80:81]
    v_pk_mul_f32 v[198:199], v[82:83], v[82:83]
    v_pk_mul_f32 v[200:201], v[84:85], v[84:85]
    v_pk_mul_f32 v[202:203], v[86:87], v[86:87]
    v_pk_fma_f32 v[176:177], v[176:177], v[30:31], v[30:31] op_sel:[0,0,1] op_sel_hi:[1,0,1]
    v_pk_fma_f32 v[178:179], v[178:179], v[30:31], v[30:31] op_sel:[0,0,1] op_sel_hi:[1,0,1]
    v_pk_fma_f32 v[180:181], v[180:181], v[30:31], v[30:31] op_sel:[0,0,1] op_sel_hi:[1,0,1]
    v_pk_fma_f32 v[182:183], v[182:183], v[30:31], v[30:31] op_sel:[0,0,1] op_sel_hi:[1,0,1]
    s_add_u32 s62, s62, 4096
    s_add_u32 s63, s63, 4096
    s_mov_b32 m0, s62
    buffer_load_dwordx4 v8, s[28:31], s63 offen offset:0 lds
    v_pk_fma_f32 v[184:185], v[184:185], v[30:31], v[30:31] op_sel:[0,0,1] op_sel_hi:[1,0,1]
    v_pk_fma_f32 v[186:187], v[186:187], v[30:31], v[30:31] op_sel:[0,0,1] op_sel_hi:[1,0,1]
    v_pk_fma_f32 v[188:189], v[188:189], v[30:31], v[30:31] op_sel:[0,0,1] op_sel_hi:[1,0,1]
    v_pk_fma_f32 v[190:191], v[190:191], v[30:31], v[30:31] op_sel:[0,0,1] op_sel_hi:[1,0,1]
    v_pk_fma_f32 v[192:193], v[192:193], v[30:31], v[30:31] op_sel:[0,0,1] op_sel_hi:[1,0,1]
    v_pk_fma_f32 v[194:195], v[194:195], v[30:31], v[30:31] op_sel:[0,0,1] op_sel_hi:[1,0,1]
    v_pk_fma_f32 v[196:197], v[196:197], v[30:31], v[30:31] op_sel:[0,0,1] op_sel_hi:[1,0,1]
    v_pk_fma_f32 v[198:199], v[198:199], v[30:31], v[30:31] op_sel:[0,0,1] op_sel_hi:[1,0,1]
    v_pk_fma_f32 v[200:201], v[200:201], v[30:31], v[30:31] op_sel:[0,0,1] op_sel_hi:[1,0,1]
    v_pk_fma_f32 v[202:203], v[202:203], v[30:31], v[30:31] op_sel:[0,0,1] op_sel_hi:[1,0,1]
    v_pk_mul_f32 v[176:177], v[176:177], v[60:61]
    v_pk_mul_f32 v[178:179], v[178:179], v[62:63]
    buffer_load_dwordx4 v8, s[28:31], s63 offen offset:1024 lds
    v_pk_mul_f32 v[180:181], v[180:181], v[64:65]
    v_pk_mul_f32 v[182:183], v[182:183], v[66:67]
    v_pk_mul_f32 v[184:185], v[184:185], v[68:69]
    v_pk_mul_f32 v[186:187], v[186:187], v[70:71]
    v_pk_mul_f32 v[188:189], v[188:189], v[72:73]
    v_pk_mul_f32 v[190:191], v[190:191], v[74:75]
    v_pk_mul_f32 v[192:193], v[192:193], v[76:77]
    v_pk_mul_f32 v[194:195], v[194:195], v[78:79]
    v_pk_mul_f32 v[196:197], v[196:197], v[80:81]
    v_pk_mul_f32 v[198:199], v[198:199], v[82:83]
    v_pk_mul_f32 v[200:201], v[200:201], v[84:85]
    v_pk_mul_f32 v[202:203], v[202:203], v[86:87]
    buffer_load_dwordx4 v8, s[28:31], s63 offen offset:2048 lds
    v_exp_f32 v176, v176
    v_exp_f32 v177, v177
    v_exp_f32 v178, v178
    v_exp_f32 v179, v179
    v_exp_f32 v180, v180
    v_exp_f32 v181, v181
    v_exp_f32 v182, v182
    v_exp_f32 v183, v183
    v_exp_f32 v184, v184
    v_exp_f32 v185, v185
    v_exp_f32 v186, v186
    v_exp_f32 v187, v187
    v_exp_f32 v188, v188
    v_exp_f32 v189, v189
    v_exp_f32 v190, v190
    v_exp_f32 v191, v191
    v_exp_f32 v192, v192
    v_exp_f32 v193, v193
    v_exp_f32 v194, v194
    v_exp_f32 v195, v195
    v_exp_f32 v196, v196
    v_exp_f32 v197, v197
    v_exp_f32 v198, v198
    v_exp_f32 v199, v199
    v_exp_f32 v200, v200
    v_exp_f32 v201, v201
    v_exp_f32 v202, v202
    v_exp_f32 v203, v203
    v_pk_add_f32 v[176:177], v[176:177], 1.0 op_sel_hi:[1,0]
    v_pk_add_f32 v[178:179], v[178:179], 1.0 op_sel_hi:[1,0]
    v_pk_add_f32 v[180:181], v[180:181], 1.0 op_sel_hi:[1,0]
    v_pk_add_f32 v[182:183], v[182:183], 1.0 op_sel_hi:[1,0]
    v_pk_add_f32 v[184:185], v[184:185], 1.0 op_sel_hi:[1,0]
    v_pk_add_f32 v[186:187], v[186:187], 1.0 op_sel_hi:[1,0]
    v_pk_add_f32 v[188:189], v[188:189], 1.0 op_sel_hi:[1,0]
    v_pk_add_f32 v[190:191], v[190:191], 1.0 op_sel_hi:[1,0]
    v_pk_add_f32 v[192:193], v[192:193], 1.0 op_sel_hi:[1,0]
    v_pk_add_f32 v[194:195], v[194:195], 1.0 op_sel_hi:[1,0]
    v_pk_add_f32 v[196:197], v[196:197], 1.0 op_sel_hi:[1,0]
    v_pk_add_f32 v[198:199], v[198:199], 1.0 op_sel_hi:[1,0]
    v_pk_add_f32 v[200:201], v[200:201], 1.0 op_sel_hi:[1,0]
    v_pk_add_f32 v[202:203], v[202:203], 1.0 op_sel_hi:[1,0]
    v_rcp_f32 v176, v176
    v_rcp_f32 v177, v177
    v_rcp_f32 v178, v178
    v_rcp_f32 v179, v179
    v_rcp_f32 v180, v180
    v_rcp_f32 v181, v181
    v_rcp_f32 v182, v182
    v_rcp_f32 v183, v183
    v_rcp_f32 v184, v184
    v_rcp_f32 v185, v185
    v_rcp_f32 v186, v186
    v_rcp_f32 v187, v187
    v_rcp_f32 v188, v188
    v_rcp_f32 v189, v189
    v_rcp_f32 v190, v190
    v_rcp_f32 v191, v191
    v_rcp_f32 v192, v192
    v_rcp_f32 v193, v193
    v_rcp_f32 v194, v194
    v_rcp_f32 v195, v195
    v_rcp_f32 v196, v196
    v_rcp_f32 v197, v197
    v_rcp_f32 v198, v198
    v_rcp_f32 v199, v199
    v_rcp_f32 v200, v200
    v_rcp_f32 v201, v201
    v_rcp_f32 v202, v202
    v_rcp_f32 v203, v203
    v_pk_mul_f32 v[60:61], v[60:61], v[176:177]
    v_pk_mul_f32 v[62:63], v[62:63], v[178:179]
    v_pk_mul_f32 v[64:65], v[64:65], v[180:181]
    v_pk_mul_f32 v[66:67], v[66:67], v[182:183]
    v_pk_mul_f32 v[68:69], v[68:69], v[184:185]
    v_pk_mul_f32 v[70:71], v[70:71], v[186:187]
    v_pk_mul_f32 v[72:73], v[72:73], v[188:189]
    v_pk_mul_f32 v[74:75], v[74:75], v[190:191]
    v_pk_mul_f32 v[76:77], v[76:77], v[192:193]
    v_pk_mul_f32 v[78:79], v[78:79], v[194:195]
    v_pk_mul_f32 v[80:81], v[80:81], v[196:197]
    v_pk_mul_f32 v[82:83], v[82:83], v[198:199]
    v_pk_mul_f32 v[84:85], v[84:85], v[200:201]
    v_pk_mul_f32 v[86:87], v[86:87], v[202:203]
    v_cvt_pk_bf16_f32 v160, v60, v61
    v_cvt_pk_bf16_f32 v161, v62, v63
    v_cvt_pk_bf16_f32 v162, v64, v65
    v_cvt_pk_bf16_f32 v163, v66, v67
    v_cvt_pk_bf16_f32 v164, v68, v69
    v_cvt_pk_bf16_f32 v165, v70, v71
    v_cvt_pk_bf16_f32 v166, v72, v73
    v_cvt_pk_bf16_f32 v167, v74, v75
    v_cvt_pk_bf16_f32 v168, v76, v77
    v_cvt_pk_bf16_f32 v169, v78, v79
    v_cvt_pk_bf16_f32 v170, v80, v81
    v_cvt_pk_bf16_f32 v171, v82, v83
    v_cvt_pk_bf16_f32 v172, v84, v85
    v_cvt_pk_bf16_f32 v173, v86, v87
    s_nop 1
    v_permlane16_swap_b32 v160, v162
    v_permlane16_swap_b32 v161, v163
    v_permlane16_swap_b32 v164, v166
    v_permlane16_swap_b32 v165, v167
    v_permlane16_swap_b32 v168, v170
    v_permlane16_swap_b32 v169, v171
    s_add_u32 s26, s13, 55296
    s_add_u32 s27, s12, 55296
    buffer_store_dwordx4 v[160:163], v226, s[28:31], s26 offen sc1
    buffer_store_dwordx2 v[172:173], v227, s[28:31], s27 offen sc1
    s_cmp_eq_u32 s52, 15
    s_cbranch_scc1 chain_kernel_j158
    buffer_store_dwordx4 v[164:167], v226, s[28:31], s26 offen offset:1024 sc1
    buffer_store_dwordx4 v[168:171], v226, s[28:31], s26 offen offset:2048 sc1
chain_kernel_j158:
    s_waitcnt vmcnt(0)
    v_mov_b32 v2, 1
    v_mov_b32 v7, 0
    s_mov_b64 exec, 1
    buffer_store_dword v2, v7, s[28:31], s15 offen sc1
    s_mov_b64 exec, -1
    s_mov_b32 s47, 0
    s_mov_b64 exec, 511
chain_kernel_poll9:
    buffer_load_dword v2, v234, s[28:31], s48 offen sc1
    s_add_u32 s47, s47, 1
    s_waitcnt vmcnt(0)
    v_cmp_ne_u32 vcc, 1, v2
    s_cmp_ge_u32 s47, 20000
    s_cbranch_scc1 chain_kernel_polld10
    s_cbranch_vccnz chain_kernel_poll9
chain_kernel_polld10:
    s_mov_b64 exec, -1
    buffer_load_dwordx4 a[0:3], v8, s[28:31], s50 offen offset:0 sc1
    buffer_load_dwordx4 a[4:7], v8, s[28:31], s51 offen offset:0 sc1
    buffer_load_dwordx4 a[8:11], v8, s[28:31], s50 offen offset:1024 sc1
    buffer_load_dwordx4 a[12:15], v8, s[28:31], s51 offen offset:1024 sc1
    buffer_load_dwordx4 a[16:19], v8, s[28:31], s50 offen offset:2048 sc1
    buffer_load_dwordx4 a[20:23], v8, s[28:31], s51 offen offset:2048 sc1
    buffer_load_dwordx4 a[24:27], v8, s[28:31], s50 offen offset:3072 sc1
    buffer_load_dwordx4 a[28:31], v8, s[28:31], s51 offen offset:3072 sc1
    s_add_u32 s50, s50, 4096
    s_add_u32 s51, s51, 4096
    buffer_load_dwordx4 a[32:35], v8, s[28:31], s50 offen offset:0 sc1
    buffer_load_dwordx4 a[36:39], v8, s[28:31], s51 offen offset:0 sc1
    s_barrier
    s_mul_i32 s26, s22, 5120
    v_add_u32 v12, s26, v8
    v_add_u32 v13, 0x10000, v12
    v_add_u32 v14, 0x20000, v12
    ds_read_b128 a[216:219], v14 offset:12288
    ds_read_b128 a[220:223], v14 offset:13312
    ds_read_b128 a[224:227], v14 offset:14336
    ds_read_b128 a[228:231], v14 offset:15360
    ds_read_b128 a[232:235], v14 offset:16384
    ds_read_b128 a[236:239], v12 offset:0
    ds_read_b128 a[240:243], v12 offset:1024
    s_waitcnt vmcnt(8) lgkmcnt(6)
    v_mfma_f32_16x16x32_bf16 v[32:35], a[216:219], a[0:3], 0
    v_mfma_f32_16x16x32_bf16 v[52:55], a[216:219], a[4:7], 0
    ds_read_b128 a[244:247], v12 offset:2048
    buffer_load_dwordx4 a[40:43], v8, s[28:31], s50 offen offset:1024 sc1
    s_waitcnt lgkmcnt(6)
    v_mfma_f32_16x16x32_bf16 v[36:39], a[220:223], a[0:3], 0
    v_mfma_f32_16x16x32_bf16 v[56:59], a[220:223], a[4:7], 0
    ds_read_b128 a[216:219], v12 offset:3072
    buffer_load_dwordx4 a[44:47], v8, s[28:31], s51 offen offset:1024 sc1
    s_waitcnt lgkmcnt(6)
    v_mfma_f32_16x16x32_bf16 v[40:43], a[224:227], a[0:3], 0
    v_mfma_f32_16x16x32_bf16 v[60:63], a[224:227], a[4:7], 0
    ds_read_b128 a[220:223], v12 offset:4096
    buffer_load_dwordx4 a[48:51], v8, s[28:31], s50 offen offset:2048 sc1
    s_waitcnt lgkmcnt(6)
    v_mfma_f32_16x16x32_bf16 v[44:47], a[228:231], a[0:3], 0
    v_mfma_f32_16x16x32_bf16 v[64:67], a[228:231], a[4:7], 0
    ds_read_b128 a[224:227], v12 offset:10240
    buffer_load_dwordx4 a[52:55], v8, s[28:31], s51 offen offset:2048 sc1
    s_waitcnt lgkmcnt(6)
    v_mfma_f32_16x16x32_bf16 v[48:51], a[232:235], a[0:3], 0
    v_mfma_f32_16x16x32_bf16 v[68:71], a[232:235], a[4:7], 0
    ds_read_b128 a[228:231], v12 offset:11264
    buffer_load_dwordx4 a[56:59], v8, s[28:31], s50 offen offset:3072 sc1
    s_waitcnt vmcnt(11) lgkmcnt(6)
    v_mfma_f32_16x16x32_bf16 v[32:35], a[236:239], a[8:11], v[32:35]
    v_mfma_f32_16x16x32_bf16 v[52:55], a[236:239], a[12:15], v[52:55]
    ds_read_b128 a[232:235], v12 offset:12288
    buffer_load_dwordx4 a[60:63], v8, s[28:31], s51 offen offset:3072 sc1
    s_waitcnt lgkmcnt(6)
    v_mfma_f32_16x16x32_bf16 v[36:39], a[240:243], a[8:11], v[36:39]
    v_mfma_f32_16x16x32_bf16 v[56:59], a[240:243], a[12:15], v[56:59]
    ds_read_b128 a[236:239], v12 offset:13312
    s_add_u32 s50, s50, 4096
    s_add_u32 s51, s51, 4096
    buffer_load_dwordx4 a[64:67], v8, s[28:31], s50 offen offset:0 sc1
    s_waitcnt lgkmcnt(6)
    v_mfma_f32_16x16x32_bf16 v[40:43], a[244:247], a[8:11], v[40:43]
    v_mfma_f32_16x16x32_bf16 v[60:63], a[244:247], a[12:15], v[60:63]
    ds_read_b128 a[240:243], v12 offset:14336
    buffer_load_dwordx4 a[68:71], v8, s[28:31], s51 offen offset:0 sc1
    s_waitcnt lgkmcnt(6)
    v_mfma_f32_16x16x32_bf16 v[44:47], a[216:219], a[8:11], v[44:47]
    v_mfma_f32_16x16x32_bf16 v[64:67], a[216:219], a[12:15], v[64:67]
    ds_read_b128 a[244:247], v12 offset:20480
    buffer_load_dwordx4 a[72:75], v8, s[28:31], s50 offen offset:1024 sc1
    s_waitcnt lgkmcnt(6)
    v_mfma_f32_16x16x32_bf16 v[48:51], a[220:223], a[8:11], v[48:51]
    v_mfma_f32_16x16x32_bf16 v[68:71], a[220:223], a[12:15], v[68:71]
    ds_read_b128 a[216:219], v12 offset:21504
    buffer_load_dwordx4 a[76:79], v8, s[28:31], s51 offen offset:1024 sc1
    s_waitcnt vmcnt(14) lgkmcnt(6)
    v_mfma_f32_16x16x32_bf16 v[32:35], a[224:227], a[16:19], v[32:35]
    v_mfma_f32_16x16x32_bf16 v[52:55], a[224:227], a[20:23], v[52:55]
    ds_read_b128 a[220:223], v12 offset:22528
    buffer_load_dwordx4 a[80:83], v8, s[28:31], s50 offen offset:2048 sc1
    s_waitcnt lgkmcnt(6)
    v_mfma_f32_16x16x32_bf16 v[36:39], a[228:231], a[16:19], v[36:39]
    v_mfma_f32_16x16x32_bf16 v[56:59], a[228:231], a[20:23], v[56:59]
    ds_read_b128 a[224:227], v12 offset:23552
    buffer_load_dwordx4 a[84:87], v8, s[28:31], s51 offen offset:2048 sc1
    s_waitcnt lgkmcnt(6)
    v_mfma_f32_16x16x32_bf16 v[40:43], a[232:235], a[16:19], v[40:43]
    v_mfma_f32_16x16x32_bf16 v[60:63], a[232:235], a[20:23], v[60:63]
    ds_read_b128 a[228:231], v12 offset:24576
    buffer_load_dwordx4 a[88:91], v8, s[28:31], s50 offen offset:3072 sc1
    s_waitcnt lgkmcnt(6)
    v_mfma_f32_16x16x32_bf16 v[44:47], a[236:239], a[16:19], v[44:47]
    v_mfma_f32_16x16x32_bf16 v[64:67], a[236:239], a[20:23], v[64:67]
    s_waitcnt lgkmcnt(5)
    s_barrier
    ds_read_b128 a[232:235], v12 offset:30720
    buffer_load_dwordx4 a[92:95], v8, s[28:31], s51 offen offset:3072 sc1
    s_waitcnt lgkmcnt(6)
    v_mfma_f32_16x16x32_bf16 v[48:51], a[240:243], a[16:19], v[48:51]
    v_mfma_f32_16x16x32_bf16 v[68:71], a[240:243], a[20:23], v[68:71]
    ds_read_b128 a[236:239], v12 offset:31744
    s_add_u32 s50, s50, 4096
    s_add_u32 s51, s51, 4096
    buffer_load_dwordx4 a[96:99], v8, s[28:31], s50 offen offset:0 sc1
    s_waitcnt vmcnt(17) lgkmcnt(6)
    v_mfma_f32_16x16x32_bf16 v[32:35], a[244:247], a[24:27], v[32:35]
    v_mfma_f32_16x16x32_bf16 v[52:55], a[244:247], a[28:31], v[52:55]
    ds_read_b128 a[240:243], v12 offset:32768
    buffer_load_dwordx4 a[100:103], v8, s[28:31], s51 offen offset:0 sc1
    s_waitcnt lgkmcnt(6)
    v_mfma_f32_16x16x32_bf16 v[36:39], a[216:219], a[24:27], v[36:39]
    v_mfma_f32_16x16x32_bf16 v[56:59], a[216:219], a[28:31], v[56:59]
    ds_read_b128 a[244:247], v12 offset:33792
    buffer_load_dwordx4 a[104:107], v8, s[28:31], s50 offen offset:1024 sc1
    s_waitcnt lgkmcnt(6)
    v_mfma_f32_16x16x32_bf16 v[40:43], a[220:223], a[24:27], v[40:43]
    v_mfma_f32_16x16x32_bf16 v[60:63], a[220:223], a[28:31], v[60:63]
    ds_read_b128 a[216:219], v12 offset:34816
    buffer_load_dwordx4 a[108:111], v8, s[28:31], s51 offen offset:1024 sc1
    s_waitcnt lgkmcnt(6)
    v_mfma_f32_16x16x32_bf16 v[44:47], a[224:227], a[24:27], v[44:47]
    v_mfma_f32_16x16x32_bf16 v[64:67], a[224:227], a[28:31], v[64:67]
    ds_read_b128 a[220:223], v12 offset:40960
    buffer_load_dwordx4 a[112:115], v8, s[28:31], s50 offen offset:2048 sc1
    s_waitcnt lgkmcnt(6)
    v_mfma_f32_16x16x32_bf16 v[48:51], a[228:231], a[24:27], v[48:51]
    v_mfma_f32_16x16x32_bf16 v[68:71], a[228:231], a[28:31], v[68:71]
    ds_read_b128 a[224:227], v12 offset:41984
    buffer_load_dwordx4 a[116:119], v8, s[28:31], s51 offen offset:2048 sc1
    s_waitcnt vmcnt(20) lgkmcnt(6)
    v_mfma_f32_16x16x32_bf16 v[32:35], a[232:235], a[32:35], v[32:35]
    v_mfma_f32_16x16x32_bf16 v[52:55], a[232:235], a[36:39], v[52:55]
    ds_read_b128 a[228:231], v12 offset:43008
    buffer_load_dwordx4 a[120:123], v8, s[28:31], s50 offen offset:3072 sc1
    s_waitcnt lgkmcnt(6)
    v_mfma_f32_16x16x32_bf16 v[36:39], a[236:239], a[32:35], v[36:39]
    v_mfma_f32_16x16x32_bf16 v[56:59], a[236:239], a[36:39], v[56:59]
    ds_read_b128 a[232:235], v12 offset:44032
    buffer_load_dwordx4 a[124:127], v8, s[28:31], s51 offen offset:3072 sc1
    s_waitcnt lgkmcnt(6)
    v_mfma_f32_16x16x32_bf16 v[40:43], a[240:243], a[32:35], v[40:43]
    v_mfma_f32_16x16x32_bf16 v[60:63], a[240:243], a[36:39], v[60:63]
    ds_read_b128 a[236:239], v12 offset:45056
    s_mul_i32 s25, s20, 3
    s_min_u32 s25, s25, 7
    s_lshl_b32 s25, s25, 10
    s_add_u32 s62, s25, 143360
    s_add_u32 s63, s25, s59
    s_add_u32 s63, s63, 163840
    s_mov_b32 m0, s62
    buffer_load_dwordx4 v8, s[28:31], s63 offen offset:0 lds
    s_waitcnt lgkmcnt(6)
    v_mfma_f32_16x16x32_bf16 v[44:47], a[244:247], a[32:35], v[44:47]
    v_mfma_f32_16x16x32_bf16 v[64:67], a[244:247], a[36:39], v[64:67]
    ds_read_b128 a[240:243], v12 offset:51200
    buffer_load_dwordx4 v8, s[28:31], s63 offen offset:1024 lds
    s_waitcnt lgkmcnt(6)
    v_mfma_f32_16x16x32_bf16 v[48:51], a[216:219], a[32:35], v[48:51]
    v_mfma_f32_16x16x32_bf16 v[68:71], a[216:219], a[36:39], v[68:71]
    ds_read_b128 a[244:247], v12 offset:52224
    buffer_load_dwordx4 v8, s[28:31], s63 offen offset:2048 lds
    s_waitcnt vmcnt(23) lgkmcnt(6)
    v_mfma_f32_16x16x32_bf16 v[32:35], a[220:223], a[40:43], v[32:35]
    v_mfma_f32_16x16x32_bf16 v[52:55], a[220:223], a[44:47], v[52:55]
    ds_read_b128 a[216:219], v12 offset:53248
    s_mul_i32 s25, s20, 5
    s_lshl_b32 s25, s25, 10
    s_add_u32 s62, s25, 0
    s_add_u32 s63, s25, s59
    s_add_u32 s63, s63, 174080
    s_mov_b32 m0, s62
    buffer_load_dwordx4 v8, s[28:31], s63 offen offset:0 lds
    s_waitcnt lgkmcnt(6)
    v_mfma_f32_16x16x32_bf16 v[36:39], a[224:227], a[40:43], v[36:39]
    v_mfma_f32_16x16x32_bf16 v[56:59], a[224:227], a[44:47], v[56:59]
    ds_read_b128 a[220:223], v12 offset:54272
    buffer_load_dwordx4 v8, s[28:31], s63 offen offset:1024 lds
    s_waitcnt lgkmcnt(6)
    v_mfma_f32_16x16x32_bf16 v[40:43], a[228:231], a[40:43], v[40:43]
    v_mfma_f32_16x16x32_bf16 v[60:63], a[228:231], a[44:47], v[60:63]
    ds_read_b128 a[224:227], v12 offset:55296
    buffer_load_dwordx4 v8, s[28:31], s63 offen offset:2048 lds
    s_waitcnt lgkmcnt(6)
    v_mfma_f32_16x16x32_bf16 v[44:47], a[232:235], a[40:43], v[44:47]
    v_mfma_f32_16x16x32_bf16 v[64:67], a[232:235], a[44:47], v[64:67]
    s_waitcnt lgkmcnt(5)
    s_barrier
    ds_read_b128 a[228:231], v12 offset:61440
    buffer_load_dwordx4 v8, s[28:31], s63 offen offset:3072 lds
    s_waitcnt lgkmcnt(6)
    v_mfma_f32_16x16x32_bf16 v[48:51], a[236:239], a[40:43], v[48:51]
    v_mfma_f32_16x16x32_bf16 v[68:71], a[236:239], a[44:47], v[68:71]
    ds_read_b128 a[232:235], v12 offset:62464
    s_add_u32 s62, s62, 4096
    s_add_u32 s63, s63, 4096
    s_mov_b32 m0, s62
    buffer_load_dwordx4 v8, s[28:31], s63 offen offset:0 lds
    s_waitcnt vmcnt(26) lgkmcnt(6)
    v_mfma_f32_16x16x32_bf16 v[32:35], a[240:243], a[48:51], v[32:35]
    v_mfma_f32_16x16x32_bf16 v[52:55], a[240:243], a[52:55], v[52:55]
    ds_read_b128 a[236:239], v12 offset:63488
    s_add_u32 s50, s50, 4096
    s_add_u32 s51, s51, 4096
    buffer_load_dwordx4 a[128:131], v8, s[28:31], s50 offen offset:0 sc1
    s_waitcnt lgkmcnt(6)
    v_mfma_f32_16x16x32_bf16 v[36:39], a[244:247], a[48:51], v[36:39]
    v_mfma_f32_16x16x32_bf16 v[56:59], a[244:247], a[52:55], v[56:59]
    ds_read_b128 a[240:243], v12 offset:64512
    buffer_load_dwordx4 a[132:135], v8, s[28:31], s51 offen offset:0 sc1
    s_waitcnt lgkmcnt(6)
    v_mfma_f32_16x16x32_bf16 v[40:43], a[216:219], a[48:51], v[40:43]
    v_mfma_f32_16x16x32_bf16 v[60:63], a[216:219], a[52:55], v[60:63]
    ds_read_b128 a[244:247], v13 offset:0
    buffer_load_dwordx4 a[136:139], v8, s[28:31], s50 offen offset:1024 sc1
    s_waitcnt lgkmcnt(6)
    v_mfma_f32_16x16x32_bf16 v[44:47], a[220:223], a[48:51], v[44:47]
    v_mfma_f32_16x16x32_bf16 v[64:67], a[220:223], a[52:55], v[64:67]
    ds_read_b128 a[216:219], v13 offset:6144
    buffer_load_dwordx4 a[140:143], v8, s[28:31], s51 offen offset:1024 sc1
    s_waitcnt lgkmcnt(6)
    v_mfma_f32_16x16x32_bf16 v[48:51], a[224:227], a[48:51], v[48:51]
    v_mfma_f32_16x16x32_bf16 v[68:71], a[224:227], a[52:55], v[68:71]
    ds_read_b128 a[220:223], v13 offset:7168
    buffer_load_dwordx4 a[144:147], v8, s[28:31], s50 offen offset:2048 sc1
    s_waitcnt vmcnt(29) lgkmcnt(6)
    v_mfma_f32_16x16x32_bf16 v[32:35], a[228:231], a[56:59], v[32:35]
    v_mfma_f32_16x16x32_bf16 v[52:55], a[228:231], a[60:63], v[52:55]
    ds_read_b128 a[224:227], v13 offset:8192
    buffer_load_dwordx4 a[148:151], v8, s[28:31], s51 offen offset:2048 sc1
    s_waitcnt lgkmcnt(6)
    v_mfma_f32_16x16x32_bf16 v[36:39], a[232:235], a[56:59], v[36:39]
    v_mfma_f32_16x16x32_bf16 v[56:59], a[232:235], a[60:63], v[56:59]
    ds_read_b128 a[228:231], v13 offset:9216
    s_mul_i32 s25, s20, 8
    s_min_u32 s25, s25, 22
    s_lshl_b32 s25, s25, 10
    s_add_u32 s62, s25, 20480
    s_add_u32 s63, s25, s59
    s_add_u32 s63, s63, 194560
    s_mov_b32 m0, s62
    buffer_load_dwordx4 v8, s[28:31], s63 offen offset:0 lds
    s_waitcnt lgkmcnt(6)
    v_mfma_f32_16x16x32_bf16 v[40:43], a[236:239], a[56:59], v[40:43]
    v_mfma_f32_16x16x32_bf16 v[60:63], a[236:239], a[60:63], v[60:63]
    ds_read_b128 a[232:235], v13 offset:10240
    buffer_load_dwordx4 v8, s[28:31], s63 offen offset:1024 lds
    s_waitcnt lgkmcnt(6)
    v_mfma_f32_16x16x32_bf16 v[44:47], a[240:243], a[56:59], v[44:47]
    v_mfma_f32_16x16x32_bf16 v[64:67], a[240:243], a[60:63], v[64:67]
    ds_read_b128 a[236:239], v14 offset:22528
    buffer_load_dwordx4 v8, s[28:31], s63 offen offset:2048 lds
    s_waitcnt lgkmcnt(6)
    v_mfma_f32_16x16x32_bf16 v[48:51], a[244:247], a[56:59], v[48:51]
    v_mfma_f32_16x16x32_bf16 v[68:71], a[244:247], a[60:63], v[68:71]
    ds_read_b128 a[240:243], v14 offset:23552
    buffer_load_dwordx4 v8, s[28:31], s63 offen offset:3072 lds
    s_waitcnt vmcnt(32) lgkmcnt(6)
    v_mfma_f32_16x16x32_bf16 v[32:35], a[216:219], a[64:67], v[32:35]
    v_mfma_f32_16x16x32_bf16 v[52:55], a[216:219], a[68:71], v[52:55]
    ds_read_b128 a[244:247], v14 offset:24576
    s_add_u32 s62, s62, 4096
    s_add_u32 s63, s63, 4096
    s_mov_b32 m0, s62
    buffer_load_dwordx4 v8, s[28:31], s63 offen offset:0 lds
    s_waitcnt lgkmcnt(6)
    v_mfma_f32_16x16x32_bf16 v[36:39], a[220:223], a[64:67], v[36:39]
    v_mfma_f32_16x16x32_bf16 v[56:59], a[220:223], a[68:71], v[56:59]
    ds_read_b128 a[216:219], v14 offset:25600
    buffer_load_dwordx4 v8, s[28:31], s63 offen offset:1024 lds
    s_waitcnt lgkmcnt(6)
    v_mfma_f32_16x16x32_bf16 v[40:43], a[224:227], a[64:67], v[40:43]
    v_mfma_f32_16x16x32_bf16 v[60:63], a[224:227], a[68:71], v[60:63]
    ds_read_b128 a[220:223], v14 offset:26624
    buffer_load_dwordx4 v8, s[28:31], s63 offen offset:2048 lds
    s_waitcnt lgkmcnt(6)
    v_mfma_f32_16x16x32_bf16 v[44:47], a[228:231], a[64:67], v[44:47]
    v_mfma_f32_16x16x32_bf16 v[64:67], a[228:231], a[68:71], v[64:67]
    s_waitcnt lgkmcnt(5)
    s_barrier
    ds_read_b128 a[224:227], v13 offset:16384
    buffer_load_dwordx4 v8, s[28:31], s63 offen offset:3072 lds
    s_waitcnt lgkmcnt(6)
    v_mfma_f32_16x16x32_bf16 v[48:51], a[232:235], a[64:67], v[48:51]
    v_mfma_f32_16x16x32_bf16 v[68:71], a[232:235], a[68:71], v[68:71]
    ds_read_b128 a[228:231], v13 offset:17408
    buffer_load_dwordx4 a[152:155], v8, s[28:31], s50 offen offset:3072 sc1
    s_waitcnt vmcnt(35) lgkmcnt(6)
    v_mfma_f32_16x16x32_bf16 v[32:35], a[236:239], a[72:75], v[32:35]
    v_mfma_f32_16x16x32_bf16 v[52:55], a[236:239], a[76:79], v[52:55]
    ds_read_b128 a[232:235], v13 offset:18432
    buffer_load_dwordx4 a[156:159], v8, s[28:31], s51 offen offset:3072 sc1
    s_waitcnt lgkmcnt(6)
    v_mfma_f32_16x16x32_bf16 v[36:39], a[240:243], a[72:75], v[36:39]
    v_mfma_f32_16x16x32_bf16 v[56:59], a[240:243], a[76:79], v[56:59]
    ds_read_b128 a[236:239], v13 offset:19456
    s_add_u32 s50, s50, 4096
    s_add_u32 s51, s51, 4096
    buffer_load_dwordx4 a[160:163], v8, s[28:31], s50 offen offset:0 sc1
    s_waitcnt lgkmcnt(6)
    v_mfma_f32_16x16x32_bf16 v[40:43], a[244:247], a[72:75], v[40:43]
    v_mfma_f32_16x16x32_bf16 v[60:63], a[244:247], a[76:79], v[60:63]
    ds_read_b128 a[240:243], v13 offset:20480
    buffer_load_dwordx4 a[164:167], v8, s[28:31], s51 offen offset:0 sc1
    s_waitcnt lgkmcnt(6)
    v_mfma_f32_16x16x32_bf16 v[44:47], a[216:219], a[72:75], v[44:47]
    v_mfma_f32_16x16x32_bf16 v[64:67], a[216:219], a[76:79], v[64:67]
    ds_read_b128 a[244:247], v13 offset:26624
    buffer_load_dwordx4 a[168:171], v8, s[28:31], s50 offen offset:1024 sc1
    s_waitcnt lgkmcnt(6)
    v_mfma_f32_16x16x32_bf16 v[48:51], a[220:223], a[72:75], v[48:51]
    v_mfma_f32_16x16x32_bf16 v[68:71], a[220:223], a[76:79], v[68:71]
    ds_read_b128 a[216:219], v13 offset:27648
    buffer_load_dwordx4 a[172:175], v8, s[28:31], s51 offen offset:1024 sc1
    s_waitcnt vmcnt(38) lgkmcnt(6)
    v_mfma_f32_16x16x32_bf16 v[32:35], a[224:227], a[80:83], v[32:35]
    v_mfma_f32_16x16x32_bf16 v[52:55], a[224:227], a[84:87], v[52:55]
    ds_read_b128 a[220:223], v13 offset:28672
    s_mul_i32 s25, s20, 8
    s_min_u32 s25, s25, 22
    s_lshl_b32 s25, s25, 10
    s_add_u32 s62, s25, 51200
    s_add_u32 s63, s25, s59
    s_add_u32 s63, s63, 225280
    s_mov_b32 m0, s62
    buffer_load_dwordx4 v8, s[28:31], s63 offen offset:0 lds
    s_waitcnt lgkmcnt(6)
    v_mfma_f32_16x16x32_bf16 v[36:39], a[228:231], a[80:83], v[36:39]
    v_mfma_f32_16x16x32_bf16 v[56:59], a[228:231], a[84:87], v[56:59]
    ds_read_b128 a[224:227], v13 offset:29696
    buffer_load_dwordx4 v8, s[28:31], s63 offen offset:1024 lds
    s_waitcnt lgkmcnt(6)
    v_mfma_f32_16x16x32_bf16 v[40:43], a[232:235], a[80:83], v[40:43]
    v_mfma_f32_16x16x32_bf16 v[60:63], a[232:235], a[84:87], v[60:63]
    ds_read_b128 a[228:231], v13 offset:30720
    buffer_load_dwordx4 v8, s[28:31], s63 offen offset:2048 lds
    s_waitcnt lgkmcnt(6)
    v_mfma_f32_16x16x32_bf16 v[44:47], a[236:239], a[80:83], v[44:47]
    v_mfma_f32_16x16x32_bf16 v[64:67], a[236:239], a[84:87], v[64:67]
    ds_read_b128 a[232:235], v13 offset:36864
    buffer_load_dwordx4 v8, s[28:31], s63 offen offset:3072 lds
    s_waitcnt lgkmcnt(6)
    v_mfma_f32_16x16x32_bf16 v[48:51], a[240:243], a[80:83], v[48:51]
    v_mfma_f32_16x16x32_bf16 v[68:71], a[240:243], a[84:87], v[68:71]
    ds_read_b128 a[236:239], v13 offset:37888
    s_add_u32 s62, s62, 4096
    s_add_u32 s63, s63, 4096
    s_mov_b32 m0, s62
    buffer_load_dwordx4 v8, s[28:31], s63 offen offset:0 lds
    s_waitcnt vmcnt(41) lgkmcnt(6)
    v_mfma_f32_16x16x32_bf16 v[32:35], a[244:247], a[88:91], v[32:35]
    v_mfma_f32_16x16x32_bf16 v[52:55], a[244:247], a[92:95], v[52:55]
    ds_read_b128 a[240:243], v13 offset:38912
    buffer_load_dwordx4 v8, s[28:31], s63 offen offset:1024 lds
    s_waitcnt lgkmcnt(6)
    v_mfma_f32_16x16x32_bf16 v[36:39], a[216:219], a[88:91], v[36:39]
    v_mfma_f32_16x16x32_bf16 v[56:59], a[216:219], a[92:95], v[56:59]
    ds_read_b128 a[244:247], v13 offset:39936
    buffer_load_dwordx4 v8, s[28:31], s63 offen offset:2048 lds
    s_waitcnt lgkmcnt(6)
    v_mfma_f32_16x16x32_bf16 v[40:43], a[220:223], a[88:91], v[40:43]
    v_mfma_f32_16x16x32_bf16 v[60:63], a[220:223], a[92:95], v[60:63]
    ds_read_b128 a[216:219], v13 offset:40960
    buffer_load_dwordx4 v8, s[28:31], s63 offen offset:3072 lds
    s_waitcnt lgkmcnt(6)
    v_mfma_f32_16x16x32_bf16 v[44:47], a[224:227], a[88:91], v[44:47]
    v_mfma_f32_16x16x32_bf16 v[64:67], a[224:227], a[92:95], v[64:67]
    s_waitcnt lgkmcnt(5)
    s_barrier
    ds_read_b128 a[220:223], v13 offset:47104
    buffer_load_dwordx4 a[176:179], v8, s[28:31], s50 offen offset:2048 sc1
    s_waitcnt lgkmcnt(6)
    v_mfma_f32_16x16x32_bf16 v[48:51], a[228:231], a[88:91], v[48:51]
    v_mfma_f32_16x16x32_bf16 v[68:71], a[228:231], a[92:95], v[68:71]
    ds_read_b128 a[224:227], v13 offset:48128
    buffer_load_dwordx4 a[180:183], v8, s[28:31], s51 offen offset:2048 sc1
    s_waitcnt vmcnt(44) lgkmcnt(6)
    v_mfma_f32_16x16x32_bf16 v[32:35], a[232:235], a[96:99], v[32:35]
    v_mfma_f32_16x16x32_bf16 v[52:55], a[232:235], a[100:103], v[52:55]
    ds_read_b128 a[228:231], v13 offset:49152
    buffer_load_dwordx4 a[184:187], v8, s[28:31], s50 offen offset:3072 sc1
    s_waitcnt lgkmcnt(6)
    v_mfma_f32_16x16x32_bf16 v[36:39], a[236:239], a[96:99], v[36:39]
    v_mfma_f32_16x16x32_bf16 v[56:59], a[236:239], a[100:103], v[56:59]
    ds_read_b128 a[232:235], v13 offset:50176
    buffer_load_dwordx4 a[188:191], v8, s[28:31], s51 offen offset:3072 sc1
    s_waitcnt lgkmcnt(6)
    v_mfma_f32_16x16x32_bf16 v[40:43], a[240:243], a[96:99], v[40:43]
    v_mfma_f32_16x16x32_bf16 v[60:63], a[240:243], a[100:103], v[60:63]
    ds_read_b128 a[236:239], v13 offset:51200
    s_add_u32 s50, s50, 4096
    s_add_u32 s51, s51, 4096
    buffer_load_dwordx4 a[192:195], v8, s[28:31], s50 offen offset:0 sc1
    s_waitcnt lgkmcnt(6)
    v_mfma_f32_16x16x32_bf16 v[44:47], a[244:247], a[96:99], v[44:47]
    v_mfma_f32_16x16x32_bf16 v[64:67], a[244:247], a[100:103], v[64:67]
    ds_read_b128 a[240:243], v13 offset:57344
    buffer_load_dwordx4 a[196:199], v8, s[28:31], s51 offen offset:0 sc1
    s_waitcnt lgkmcnt(6)
    v_mfma_f32_16x16x32_bf16 v[48:51], a[216:219], a[96:99], v[48:51]
    v_mfma_f32_16x16x32_bf16 v[68:71], a[216:219], a[100:103], v[68:71]
    ds_read_b128 a[244:247], v13 offset:58368
    s_mul_i32 s25, s20, 3
    s_min_u32 s25, s25, 7
    s_lshl_b32 s25, s25, 10
    s_add_u32 s62, s25, 153600
    s_add_u32 s63, s25, s59
    s_add_u32 s63, s63, 256000
    s_mov_b32 m0, s62
    buffer_load_dwordx4 v8, s[28:31], s63 offen offset:0 lds
    s_waitcnt vmcnt(47) lgkmcnt(6)
    v_mfma_f32_16x16x32_bf16 v[32:35], a[220:223], a[104:107], v[32:35]
    v_mfma_f32_16x16x32_bf16 v[52:55], a[220:223], a[108:111], v[52:55]
    ds_read_b128 a[216:219], v13 offset:59392
    buffer_load_dwordx4 v8, s[28:31], s63 offen offset:1024 lds
    s_waitcnt lgkmcnt(6)
    v_mfma_f32_16x16x32_bf16 v[36:39], a[224:227], a[104:107], v[36:39]
    v_mfma_f32_16x16x32_bf16 v[56:59], a[224:227], a[108:111], v[56:59]
    ds_read_b128 a[220:223], v13 offset:60416
    buffer_load_dwordx4 v8, s[28:31], s63 offen offset:2048 lds
    s_waitcnt lgkmcnt(6)
    v_mfma_f32_16x16x32_bf16 v[40:43], a[228:231], a[104:107], v[40:43]
    v_mfma_f32_16x16x32_bf16 v[60:63], a[228:231], a[108:111], v[60:63]
    ds_read_b128 a[224:227], v13 offset:61440
    s_mul_i32 s25, s20, 3
    s_min_u32 s25, s25, 7
    s_lshl_b32 s25, s25, 10
    s_add_u32 s62, s25, 81920
    s_add_u32 s63, s25, s59
    s_add_u32 s63, s63, 266240
    s_mov_b32 m0, s62
    buffer_load_dwordx4 v8, s[28:31], s63 offen offset:0 lds
    s_waitcnt lgkmcnt(6)
    v_mfma_f32_16x16x32_bf16 v[44:47], a[232:235], a[104:107], v[44:47]
    v_mfma_f32_16x16x32_bf16 v[64:67], a[232:235], a[108:111], v[64:67]
    ds_read_b128 a[228:231], v14 offset:2048
    buffer_load_dwordx4 v8, s[28:31], s63 offen offset:1024 lds
    s_waitcnt lgkmcnt(6)
    v_mfma_f32_16x16x32_bf16 v[48:51], a[236:239], a[104:107], v[48:51]
    v_mfma_f32_16x16x32_bf16 v[68:71], a[236:239], a[108:111], v[68:71]
    ds_read_b128 a[232:235], v14 offset:3072
    buffer_load_dwordx4 v8, s[28:31], s63 offen offset:2048 lds
    s_waitcnt vmcnt(50) lgkmcnt(6)
    v_mfma_f32_16x16x32_bf16 v[32:35], a[240:243], a[112:115], v[32:35]
    v_mfma_f32_16x16x32_bf16 v[52:55], a[240:243], a[116:119], v[52:55]
    ds_read_b128 a[236:239], v14 offset:4096
    buffer_load_dwordx4 a[200:203], v8, s[28:31], s50 offen offset:1024 sc1
    s_waitcnt lgkmcnt(6)
    v_mfma_f32_16x16x32_bf16 v[36:39], a[244:247], a[112:115], v[36:39]
    v_mfma_f32_16x16x32_bf16 v[56:59], a[244:247], a[116:119], v[56:59]
    ds_read_b128 a[240:243], v14 offset:5120
    buffer_load_dwordx4 a[204:207], v8, s[28:31], s51 offen offset:1024 sc1
    s_waitcnt lgkmcnt(6)
    v_mfma_f32_16x16x32_bf16 v[40:43], a[216:219], a[112:115], v[40:43]
    v_mfma_f32_16x16x32_bf16 v[60:63], a[216:219], a[116:119], v[60:63]
    ds_read_b128 a[244:247], v14 offset:6144
    buffer_load_dwordx4 a[208:211], v8, s[28:31], s50 offen offset:2048 sc1
    s_waitcnt lgkmcnt(6)
    v_mfma_f32_16x16x32_bf16 v[44:47], a[220:223], a[112:115], v[44:47]
    v_mfma_f32_16x16x32_bf16 v[64:67], a[220:223], a[116:119], v[64:67]
    s_waitcnt vmcnt(43) lgkmcnt(5)
    s_barrier
    ds_read_b128 a[216:219], v14 offset:12288
    buffer_load_dwordx4 a[212:215], v8, s[28:31], s51 offen offset:2048 sc1
    s_waitcnt lgkmcnt(6)
    v_mfma_f32_16x16x32_bf16 v[48:51], a[224:227], a[112:115], v[48:51]
    v_mfma_f32_16x16x32_bf16 v[68:71], a[224:227], a[116:119], v[68:71]
    ds_read_b128 a[220:223], v14 offset:13312
    s_add_u32 s26, s44, 15966208
    buffer_load_dwordx2 v[96:97], v230, s[28:31], s26 offen sc1
    s_waitcnt lgkmcnt(6)
    v_mfma_f32_16x16x32_bf16 v[32:35], a[228:231], a[120:123], v[32:35]
    v_mfma_f32_16x16x32_bf16 v[52:55], a[228:231], a[124:127], v[52:55]
    ds_read_b128 a[224:227], v14 offset:14336
    s_mov_b32 s26, 8052736
    buffer_load_dwordx2 v[106:107], v235, s[28:31], s26 offen
    s_waitcnt lgkmcnt(6)
    v_mfma_f32_16x16x32_bf16 v[36:39], a[232:235], a[120:123], v[36:39]
    v_mfma_f32_16x16x32_bf16 v[56:59], a[232:235], a[124:127], v[56:59]
    ds_read_b128 a[228:231], v14 offset:15360
    s_add_u32 s26, s44, 15966720
    buffer_load_dwordx2 v[98:99], v230, s[28:31], s26 offen sc1
    s_waitcnt lgkmcnt(6)
    v_mfma_f32_16x16x32_bf16 v[40:43], a[236:239], a[120:123], v[40:43]
    v_mfma_f32_16x16x32_bf16 v[60:63], a[236:239], a[124:127], v[60:63]
    ds_read_b128 a[232:235], v14 offset:16384
    s_mov_b32 s26, 8052736
    buffer_load_dwordx2 v[108:109], v236, s[28:31], s26 offen
    s_waitcnt lgkmcnt(6)
    v_mfma_f32_16x16x32_bf16 v[44:47], a[240:243], a[120:123], v[44:47]
    v_mfma_f32_16x16x32_bf16 v[64:67], a[240:243], a[124:127], v[64:67]
    ds_read_b128 a[236:239], v12 offset:0
    s_add_u32 s26, s44, 15967232
    buffer_load_dwordx2 v[100:101], v230, s[28:31], s26 offen sc1
    s_waitcnt lgkmcnt(6)
    v_mfma_f32_16x16x32_bf16 v[48:51], a[244:247], a[120:123], v[48:51]
    v_mfma_f32_16x16x32_bf16 v[68:71], a[244:247], a[124:127], v[68:71]
    ds_read_b128 a[240:243], v12 offset:1024
    s_mov_b32 s26, 8052736
    buffer_load_dwordx2 v[110:111], v237, s[28:31], s26 offen
    s_waitcnt vmcnt(48) lgkmcnt(6)
    v_mfma_f32_16x16x32_bf16 v[32:35], a[216:219], a[128:131], v[32:35]
    v_mfma_f32_16x16x32_bf16 v[52:55], a[216:219], a[132:135], v[52:55]
    ds_read_b128 a[244:247], v12 offset:2048
    s_add_u32 s26, s44, 15967744
    buffer_load_dwordx2 v[102:103], v230, s[28:31], s26 offen sc1
    s_waitcnt lgkmcnt(6)
    v_mfma_f32_16x16x32_bf16 v[36:39], a[220:223], a[128:131], v[36:39]
    v_mfma_f32_16x16x32_bf16 v[56:59], a[220:223], a[132:135], v[56:59]
    ds_read_b128 a[216:219], v12 offset:3072
    s_mov_b32 s26, 8052736
    buffer_load_dwordx2 v[112:113], v238, s[28:31], s26 offen
    s_waitcnt lgkmcnt(6)
    v_mfma_f32_16x16x32_bf16 v[40:43], a[224:227], a[128:131], v[40:43]
    v_mfma_f32_16x16x32_bf16 v[60:63], a[224:227], a[132:135], v[60:63]
    ds_read_b128 a[220:223], v12 offset:4096
    s_add_u32 s26, s45, 15966208
    buffer_load_dwordx2 v[104:105], v230, s[28:31], s26 offen sc1
    s_waitcnt lgkmcnt(6)
    v_mfma_f32_16x16x32_bf16 v[44:47], a[228:231], a[128:131], v[44:47]
    v_mfma_f32_16x16x32_bf16 v[64:67], a[228:231], a[132:135], v[64:67]
    ds_read_b128 a[224:227], v12 offset:10240
    s_mov_b32 s26, 8052736
    buffer_load_dwordx2 v[114:115], v239, s[28:31], s26 offen
    s_waitcnt lgkmcnt(6)
    v_mfma_f32_16x16x32_bf16 v[48:51], a[232:235], a[128:131], v[48:51]
    v_mfma_f32_16x16x32_bf16 v[68:71], a[232:235], a[132:135], v[68:71]
    ds_read_b128 a[228:231], v12 offset:11264
    buffer_load_dwordx4 v[116:119], v233, s[28:31], s37 offen offset:0
    s_waitcnt vmcnt(51) lgkmcnt(6)
    v_mfma_f32_16x16x32_bf16 v[32:35], a[236:239], a[136:139], v[32:35]
    v_mfma_f32_16x16x32_bf16 v[52:55], a[236:239], a[140:143], v[52:55]
    ds_read_b128 a[232:235], v12 offset:12288
    buffer_load_dwordx4 v[120:123], v233, s[28:31], s37 offen offset:64
    s_waitcnt lgkmcnt(6)
    v_mfma_f32_16x16x32_bf16 v[36:39], a[240:243], a[136:139], v[36:39]
    v_mfma_f32_16x16x32_bf16 v[56:59], a[240:243], a[140:143], v[56:59]
    ds_read_b128 a[236:239], v12 offset:13312
    buffer_load_dwordx4 v[124:127], v233, s[28:31], s37 offen offset:128
    s_waitcnt lgkmcnt(6)
    v_mfma_f32_16x16x32_bf16 v[40:43], a[244:247], a[136:139], v[40:43]
    v_mfma_f32_16x16x32_bf16 v[60:63], a[244:247], a[140:143], v[60:63]
    ds_read_b128 a[240:243], v12 offset:14336
    buffer_load_dwordx4 v[128:131], v233, s[28:31], s37 offen offset:192
    s_waitcnt lgkmcnt(6)
    v_mfma_f32_16x16x32_bf16 v[44:47], a[216:219], a[136:139], v[44:47]
    v_mfma_f32_16x16x32_bf16 v[64:67], a[216:219], a[140:143], v[64:67]
    s_waitcnt vmcnt(44) lgkmcnt(5)
    s_barrier
    ds_read_b128 a[244:247], v12 offset:20480
    buffer_load_dwordx4 v[132:135], v233, s[28:31], s38 offen
    s_waitcnt lgkmcnt(6)
    v_mfma_f32_16x16x32_bf16 v[48:51], a[220:223], a[136:139], v[48:51]
    v_mfma_f32_16x16x32_bf16 v[68:71], a[220:223], a[140:143], v[68:71]
    ds_read_b128 a[216:219], v12 offset:21504
    s_waitcnt lgkmcnt(6)
    v_mfma_f32_16x16x32_bf16 v[32:35], a[224:227], a[144:147], v[32:35]
    v_mfma_f32_16x16x32_bf16 v[52:55], a[224:227], a[148:151], v[52:55]
    ds_read_b128 a[220:223], v12 offset:22528
    s_waitcnt lgkmcnt(6)
    v_mfma_f32_16x16x32_bf16 v[36:39], a[228:231], a[144:147], v[36:39]
    v_mfma_f32_16x16x32_bf16 v[56:59], a[228:231], a[148:151], v[56:59]
    ds_read_b128 a[224:227], v12 offset:23552
    s_waitcnt lgkmcnt(6)
    v_mfma_f32_16x16x32_bf16 v[40:43], a[232:235], a[144:147], v[40:43]
    v_mfma_f32_16x16x32_bf16 v[60:63], a[232:235], a[148:151], v[60:63]
    ds_read_b128 a[228:231], v12 offset:24576
    s_waitcnt lgkmcnt(6)
    v_mfma_f32_16x16x32_bf16 v[44:47], a[236:239], a[144:147], v[44:47]
    v_mfma_f32_16x16x32_bf16 v[64:67], a[236:239], a[148:151], v[64:67]
    ds_read_b128 a[232:235], v12 offset:30720
    s_waitcnt lgkmcnt(6)
    v_mfma_f32_16x16x32_bf16 v[48:51], a[240:243], a[144:147], v[48:51]
    v_mfma_f32_16x16x32_bf16 v[68:71], a[240:243], a[148:151], v[68:71]
    ds_read_b128 a[236:239], v12 offset:31744
    s_waitcnt vmcnt(43) lgkmcnt(6)
    v_mfma_f32_16x16x32_bf16 v[32:35], a[244:247], a[152:155], v[32:35]
    v_mfma_f32_16x16x32_bf16 v[52:55], a[244:247], a[156:159], v[52:55]
    ds_read_b128 a[240:243], v12 offset:32768
    s_waitcnt lgkmcnt(6)
    v_mfma_f32_16x16x32_bf16 v[36:39], a[216:219], a[152:155], v[36:39]
    v_mfma_f32_16x16x32_bf16 v[56:59], a[216:219], a[156:159], v[56:59]
    ds_read_b128 a[244:247], v12 offset:33792
    s_waitcnt lgkmcnt(6)
    v_mfma_f32_16x16x32_bf16 v[40:43], a[220:223], a[152:155], v[40:43]
    v_mfma_f32_16x16x32_bf16 v[60:63], a[220:223], a[156:159], v[60:63]
    ds_read_b128 a[216:219], v12 offset:34816
    s_waitcnt lgkmcnt(6)
    v_mfma_f32_16x16x32_bf16 v[44:47], a[224:227], a[152:155], v[44:47]
    v_mfma_f32_16x16x32_bf16 v[64:67], a[224:227], a[156:159], v[64:67]
    ds_read_b128 a[220:223], v12 offset:40960
    s_waitcnt lgkmcnt(6)
    v_mfma_f32_16x16x32_bf16 v[48:51], a[228:231], a[152:155], v[48:51]
    v_mfma_f32_16x16x32_bf16 v[68:71], a[228:231], a[156:159], v[68:71]
    ds_read_b128 a[224:227], v12 offset:41984
    s_waitcnt vmcnt(41) lgkmcnt(6)
    v_mfma_f32_16x16x32_bf16 v[32:35], a[232:235], a[160:163], v[32:35]
    v_mfma_f32_16x16x32_bf16 v[52:55], a[232:235], a[164:167], v[52:55]
    ds_read_b128 a[228:231], v12 offset:43008
    s_waitcnt lgkmcnt(6)
    v_mfma_f32_16x16x32_bf16 v[36:39], a[236:239], a[160:163], v[36:39]
    v_mfma_f32_16x16x32_bf16 v[56:59], a[236:239], a[164:167], v[56:59]
    ds_read_b128 a[232:235], v12 offset:44032
    s_waitcnt lgkmcnt(6)
    v_mfma_f32_16x16x32_bf16 v[40:43], a[240:243], a[160:163], v[40:43]
    v_mfma_f32_16x16x32_bf16 v[60:63], a[240:243], a[164:167], v[60:63]
    ds_read_b128 a[236:239], v12 offset:45056
    s_waitcnt lgkmcnt(6)
    v_mfma_f32_16x16x32_bf16 v[44:47], a[244:247], a[160:163], v[44:47]
    v_mfma_f32_16x16x32_bf16 v[64:67], a[244:247], a[164:167], v[64:67]
    s_waitcnt vmcnt(31) lgkmcnt(5)
    s_barrier
    ds_read_b128 a[240:243], v12 offset:51200
    s_waitcnt lgkmcnt(6)
    v_mfma_f32_16x16x32_bf16 v[48:51], a[216:219], a[160:163], v[48:51]
    v_mfma_f32_16x16x32_bf16 v[68:71], a[216:219], a[164:167], v[68:71]
    ds_read_b128 a[244:247], v12 offset:52224
    s_waitcnt lgkmcnt(6)
    v_mfma_f32_16x16x32_bf16 v[32:35], a[220:223], a[168:171], v[32:35]
    v_mfma_f32_16x16x32_bf16 v[52:55], a[220:223], a[172:175], v[52:55]
    ds_read_b128 a[216:219], v12 offset:53248
    s_waitcnt lgkmcnt(6)
    v_mfma_f32_16x16x32_bf16 v[36:39], a[224:227], a[168:171], v[36:39]
    v_mfma_f32_16x16x32_bf16 v[56:59], a[224:227], a[172:175], v[56:59]
    ds_read_b128 a[220:223], v12 offset:54272
    s_waitcnt lgkmcnt(6)
    v_mfma_f32_16x16x32_bf16 v[40:43], a[228:231], a[168:171], v[40:43]
    v_mfma_f32_16x16x32_bf16 v[60:63], a[228:231], a[172:175], v[60:63]
    ds_read_b128 a[224:227], v12 offset:55296
    s_waitcnt lgkmcnt(6)
    v_mfma_f32_16x16x32_bf16 v[44:47], a[232:235], a[168:171], v[44:47]
    v_mfma_f32_16x16x32_bf16 v[64:67], a[232:235], a[172:175], v[64:67]
    ds_read_b128 a[228:231], v12 offset:61440
    s_waitcnt lgkmcnt(6)
    v_mfma_f32_16x16x32_bf16 v[48:51], a[236:239], a[168:171], v[48:51]
    v_mfma_f32_16x16x32_bf16 v[68:71], a[236:239], a[172:175], v[68:71]
    ds_read_b128 a[232:235], v12 offset:62464
    s_waitcnt vmcnt(29) lgkmcnt(6)
    v_mfma_f32_16x16x32_bf16 v[32:35], a[240:243], a[176:179], v[32:35]
    v_mfma_f32_16x16x32_bf16 v[52:55], a[240:243], a[180:183], v[52:55]
    ds_read_b128 a[236:239], v12 offset:63488
    s_waitcnt lgkmcnt(6)
    v_mfma_f32_16x16x32_bf16 v[36:39], a[244:247], a[176:179], v[36:39]
    v_mfma_f32_16x16x32_bf16 v[56:59], a[244:247], a[180:183], v[56:59]
    ds_read_b128 a[240:243], v12 offset:64512
    s_waitcnt lgkmcnt(6)
    v_mfma_f32_16x16x32_bf16 v[40:43], a[216:219], a[176:179], v[40:43]
    v_mfma_f32_16x16x32_bf16 v[60:63], a[216:219], a[180:183], v[60:63]
    ds_read_b128 a[244:247], v13 offset:0
    s_waitcnt lgkmcnt(6)
    v_mfma_f32_16x16x32_bf16 v[44:47], a[220:223], a[176:179], v[44:47]
    v_mfma_f32_16x16x32_bf16 v[64:67], a[220:223], a[180:183], v[64:67]
    ds_read_b128 a[216:219], v13 offset:6144
    s_waitcnt lgkmcnt(6)
    v_mfma_f32_16x16x32_bf16 v[48:51], a[224:227], a[176:179], v[48:51]
    v_mfma_f32_16x16x32_bf16 v[68:71], a[224:227], a[180:183], v[68:71]
    ds_read_b128 a[220:223], v13 offset:7168
    s_waitcnt vmcnt(27) lgkmcnt(6)
    v_mfma_f32_16x16x32_bf16 v[32:35], a[228:231], a[184:187], v[32:35]
    v_mfma_f32_16x16x32_bf16 v[52:55], a[228:231], a[188:191], v[52:55]
    ds_read_b128 a[224:227], v13 offset:8192
    s_waitcnt lgkmcnt(6)
    v_mfma_f32_16x16x32_bf16 v[36:39], a[232:235], a[184:187], v[36:39]
    v_mfma_f32_16x16x32_bf16 v[56:59], a[232:235], a[188:191], v[56:59]
    ds_read_b128 a[228:231], v13 offset:9216
    s_waitcnt lgkmcnt(6)
    v_mfma_f32_16x16x32_bf16 v[40:43], a[236:239], a[184:187], v[40:43]
    v_mfma_f32_16x16x32_bf16 v[60:63], a[236:239], a[188:191], v[60:63]
    ds_read_b128 a[232:235], v13 offset:10240
    s_waitcnt lgkmcnt(6)
    v_mfma_f32_16x16x32_bf16 v[44:47], a[240:243], a[184:187], v[44:47]
    v_mfma_f32_16x16x32_bf16 v[64:67], a[240:243], a[188:191], v[64:67]
    s_waitcnt vmcnt(19) lgkmcnt(5)
    s_barrier
    ds_read_b128 a[236:239], v14 offset:22528
    s_waitcnt lgkmcnt(6)
    v_mfma_f32_16x16x32_bf16 v[48:51], a[244:247], a[184:187], v[48:51]
    v_mfma_f32_16x16x32_bf16 v[68:71], a[244:247], a[188:191], v[68:71]
    ds_read_b128 a[240:243], v14 offset:23552
    s_waitcnt lgkmcnt(6)
    v_mfma_f32_16x16x32_bf16 v[32:35], a[216:219], a[192:195], v[32:35]
    v_mfma_f32_16x16x32_bf16 v[52:55], a[216:219], a[196:199], v[52:55]
    ds_read_b128 a[244:247], v14 offset:24576
    s_waitcnt lgkmcnt(6)
    v_mfma_f32_16x16x32_bf16 v[36:39], a[220:223], a[192:195], v[36:39]
    v_mfma_f32_16x16x32_bf16 v[56:59], a[220:223], a[196:199], v[56:59]
    ds_read_b128 a[216:219], v14 offset:25600
    s_waitcnt lgkmcnt(6)
    v_mfma_f32_16x16x32_bf16 v[40:43], a[224:227], a[192:195], v[40:43]
    v_mfma_f32_16x16x32_bf16 v[60:63], a[224:227], a[196:199], v[60:63]
    ds_read_b128 a[220:223], v14 offset:26624
    s_waitcnt lgkmcnt(6)
    v_mfma_f32_16x16x32_bf16 v[44:47], a[228:231], a[192:195], v[44:47]
    v_mfma_f32_16x16x32_bf16 v[64:67], a[228:231], a[196:199], v[64:67]
    ds_read_b128 a[224:227], v13 offset:16384
    s_waitcnt lgkmcnt(6)
    v_mfma_f32_16x16x32_bf16 v[48:51], a[232:235], a[192:195], v[48:51]
    v_mfma_f32_16x16x32_bf16 v[68:71], a[232:235], a[196:199], v[68:71]
    ds_read_b128 a[228:231], v13 offset:17408
    s_waitcnt vmcnt(17) lgkmcnt(6)
    v_mfma_f32_16x16x32_bf16 v[32:35], a[236:239], a[200:203], v[32:35]
    v_mfma_f32_16x16x32_bf16 v[52:55], a[236:239], a[204:207], v[52:55]
    ds_read_b128 a[232:235], v13 offset:18432
    s_waitcnt lgkmcnt(6)
    v_mfma_f32_16x16x32_bf16 v[36:39], a[240:243], a[200:203], v[36:39]
    v_mfma_f32_16x16x32_bf16 v[56:59], a[240:243], a[204:207], v[56:59]
    ds_read_b128 a[236:239], v13 offset:19456
    s_waitcnt lgkmcnt(6)
    v_mfma_f32_16x16x32_bf16 v[40:43], a[244:247], a[200:203], v[40:43]
    v_mfma_f32_16x16x32_bf16 v[60:63], a[244:247], a[204:207], v[60:63]
    ds_read_b128 a[240:243], v13 offset:20480
    s_waitcnt lgkmcnt(6)
    v_mfma_f32_16x16x32_bf16 v[44:47], a[216:219], a[200:203], v[44:47]
    v_mfma_f32_16x16x32_bf16 v[64:67], a[216:219], a[204:207], v[64:67]
    s_waitcnt lgkmcnt(5)
    v_mfma_f32_16x16x32_bf16 v[48:51], a[220:223], a[200:203], v[48:51]
    v_mfma_f32_16x16x32_bf16 v[68:71], a[220:223], a[204:207], v[68:71]
    s_waitcnt vmcnt(15) lgkmcnt(4)
    v_mfma_f32_16x16x32_bf16 v[32:35], a[224:227], a[208:211], v[32:35]
    v_mfma_f32_16x16x32_bf16 v[52:55], a[224:227], a[212:215], v[52:55]
    s_waitcnt lgkmcnt(3)
    v_mfma_f32_16x16x32_bf16 v[36:39], a[228:231], a[208:211], v[36:39]
    v_mfma_f32_16x16x32_bf16 v[56:59], a[228:231], a[212:215], v[56:59]
    s_waitcnt lgkmcnt(2)
    v_mfma_f32_16x16x32_bf16 v[40:43], a[232:235], a[208:211], v[40:43]
    v_mfma_f32_16x16x32_bf16 v[60:63], a[232:235], a[212:215], v[60:63]
    s_waitcnt lgkmcnt(1)
    v_mfma_f32_16x16x32_bf16 v[44:47], a[236:239], a[208:211], v[44:47]
    v_mfma_f32_16x16x32_bf16 v[64:67], a[236:239], a[212:215], v[64:67]
    s_waitcnt lgkmcnt(0)
    v_mfma_f32_16x16x32_bf16 v[48:51], a[240:243], a[208:211], v[48:51]
    v_mfma_f32_16x16x32_bf16 v[68:71], a[240:243], a[212:215], v[68:71]
    s_barrier
    s_nop 4
    ds_write_b128 v246, v[52:55] offset:0
    ds_write_b128 v246, v[56:59] offset:1024
    ds_write_b128 v246, v[60:63] offset:2048
    ds_write_b128 v246, v[64:67] offset:3072
    ds_write_b128 v246, v[68:71] offset:4096
    s_waitcnt vmcnt(0)
    v_lshlrev_b32 v136, 16, v96
    v_and_b32 v137, 0xffff0000, v96
    v_lshlrev_b32 v138, 16, v97
    v_and_b32 v139, 0xffff0000, v97
    v_lshlrev_b32 v156, 16, v106
    v_and_b32 v157, 0xffff0000, v106
    v_lshlrev_b32 v158, 16, v107
    v_and_b32 v159, 0xffff0000, v107
    v_lshlrev_b32 v140, 16, v98
    v_and_b32 v141, 0xffff0000, v98
    v_lshlrev_b32 v142, 16, v99
    v_and_b32 v143, 0xffff0000, v99
    v_lshlrev_b32 v160, 16, v108
    v_and_b32 v161, 0xffff0000, v108
    v_lshlrev_b32 v162, 16, v109
    v_and_b32 v163, 0xffff0000, v109
    v_lshlrev_b32 v144, 16, v100
    v_and_b32 v145, 0xffff0000, v100
    v_lshlrev_b32 v146, 16, v101
    v_and_b32 v147, 0xffff0000, v101
    v_lshlrev_b32 v164, 16, v110
    v_and_b32 v165, 0xffff0000, v110
    v_lshlrev_b32 v166, 16, v111
    v_and_b32 v167, 0xffff0000, v111
    v_lshlrev_b32 v148, 16, v102
    v_and_b32 v149, 0xffff0000, v102
    v_lshlrev_b32 v150, 16, v103
    v_and_b32 v151, 0xffff0000, v103
    v_lshlrev_b32 v168, 16, v112
    v_and_b32 v169, 0xffff0000, v112
    v_lshlrev_b32 v170, 16, v113
    v_and_b32 v171, 0xffff0000, v113
    v_lshlrev_b32 v152, 16, v104
    v_and_b32 v153, 0xffff0000, v104
    v_lshlrev_b32 v154, 16, v105
    v_and_b32 v155, 0xffff0000, v105
    v_lshlrev_b32 v172, 16, v114
    v_and_b32 v173, 0xffff0000, v114
    v_lshlrev_b32 v174, 16, v115
    v_and_b32 v175, 0xffff0000, v115
    v_pk_add_f32 v[32:33], v[32:33], v[136:137]
    v_pk_add_f32 v[34:35], v[34:35], v[138:139]
    v_pk_add_f32 v[36:37], v[36:37], v[140:141]
    v_pk_add_f32 v[38:39], v[38:39], v[142:143]
    v_pk_add_f32 v[40:41], v[40:41], v[144:145]
    v_pk_add_f32 v[42:43], v[42:43], v[146:147]
    v_pk_add_f32 v[44:45], v[44:45], v[148:149]
    v_pk_add_f32 v[46:47], v[46:47], v[150:151]
    v_pk_add_f32 v[48:49], v[48:49], v[152:153]
    v_pk_add_f32 v[50:51], v[50:51], v[154:155]
    s_waitcnt lgkmcnt(0)
    s_barrier
    ds_read_b128 v[72:75], v247 offset:0
    ds_read_b128 v[76:79], v247 offset:1024
    ds_read_b128 v[80:83], v247 offset:2048
    ds_read_b128 v[84:87], v247 offset:3072
    ds_read_b128 v[88:91], v247 offset:4096
    s_waitcnt lgkmcnt(4)
    v_pk_add_f32 v[32:33], v[32:33], v[72:73]
    v_pk_add_f32 v[34:35], v[34:35], v[74:75]
    v_pk_fma_f32 v[32:33], v[32:33], v[116:117], v[156:157]
    v_pk_fma_f32 v[34:35], v[34:35], v[118:119], v[158:159]
    v_cvt_pk_bf16_f32 v180, v32, v33
    v_cvt_pk_bf16_f32 v181, v34, v35
    s_waitcnt lgkmcnt(3)
    v_pk_add_f32 v[36:37], v[36:37], v[76:77]
    v_pk_add_f32 v[38:39], v[38:39], v[78:79]
    v_pk_fma_f32 v[36:37], v[36:37], v[120:121], v[160:161]
    v_pk_fma_f32 v[38:39], v[38:39], v[122:123], v[162:163]
    v_cvt_pk_bf16_f32 v182, v36, v37
    v_cvt_pk_bf16_f32 v183, v38, v39
    s_waitcnt lgkmcnt(2)
    v_pk_add_f32 v[40:41], v[40:41], v[80:81]
    v_pk_add_f32 v[42:43], v[42:43], v[82:83]
    v_pk_fma_f32 v[40:41], v[40:41], v[124:125], v[164:165]
    v_pk_fma_f32 v[42:43], v[42:43], v[126:127], v[166:167]
    v_cvt_pk_bf16_f32 v184, v40, v41
    v_cvt_pk_bf16_f32 v185, v42, v43
    s_waitcnt lgkmcnt(1)
    v_pk_add_f32 v[44:45], v[44:45], v[84:85]
    v_pk_add_f32 v[46:47], v[46:47], v[86:87]
    v_pk_fma_f32 v[44:45], v[44:45], v[128:129], v[168:169]
    v_pk_fma_f32 v[46:47], v[46:47], v[130:131], v[170:171]
    v_cvt_pk_bf16_f32 v186, v44, v45
    v_cvt_pk_bf16_f32 v187, v46, v47
    s_waitcnt lgkmcnt(0)
    v_pk_add_f32 v[48:49], v[48:49], v[88:89]
    v_pk_add_f32 v[50:51], v[50:51], v[90:91]
    v_pk_fma_f32 v[48:49], v[48:49], v[132:133], v[172:173]
    v_pk_fma_f32 v[50:51], v[50:51], v[134:135], v[174:175]
    v_cvt_pk_bf16_f32 v188, v48, v49
    v_cvt_pk_bf16_f32 v189, v50, v51
    s_nop 1
    v_permlane16_swap_b32 v180, v182
    v_permlane16_swap_b32 v181, v183
    v_permlane16_swap_b32 v184, v186
    v_permlane16_swap_b32 v185, v187
    buffer_store_dwordx4 v[180:183], v231, s[32:35], s46 offen sc1
    buffer_store_dwordx4 v[184:187], v231, s[32:35], s46 offen offset:64 sc1
    buffer_store_dwordx2 v[188:189], v232, s[32:35], s49 offen sc1
    s_endpgm
chain_end:
    s_endpgm
.section .rodata,"a"
.p2align 6
.amdhsa_kernel k0_kernel
  .amdhsa_next_free_vgpr 144
  .amdhsa_next_free_sgpr 64
  .amdhsa_accum_offset 144
  .amdhsa_group_segment_fixed_size 0
  .amdhsa_kernarg_size 128
  .amdhsa_user_sgpr_count 2
  .amdhsa_user_sgpr_kernarg_segment_ptr 1
  .amdhsa_system_sgpr_workgroup_id_x 1
  .amdhsa_float_denorm_mode_32 3
.end_amdhsa_kernel
.p2align 6
.amdhsa_kernel k1_kernel
  .amdhsa_next_free_vgpr 256
  .amdhsa_next_free_sgpr 72
  .amdhsa_accum_offset 256
  .amdhsa_group_segment_fixed_size 0
  .amdhsa_kernarg_size 128
  .amdhsa_user_sgpr_count 2
  .amdhsa_user_sgpr_kernarg_segment_ptr 1
  .amdhsa_system_sgpr_workgroup_id_x 1
  .amdhsa_float_denorm_mode_32 3
.end_amdhsa_kernel
.p2align 6
.amdhsa_kernel chain_kernel
  .amdhsa_next_free_vgpr 512
  .amdhsa_next_free_sgpr 100
  .amdhsa_accum_offset 256
  .amdhsa_group_segment_fixed_size 0
  .amdhsa_kernarg_size 128
  .amdhsa_user_sgpr_count 2
  .amdhsa_user_sgpr_kernarg_segment_ptr 1
  .amdhsa_system_sgpr_workgroup_id_x 1
  .amdhsa_float_denorm_mode_32 3
.end_amdhsa_kernel
```

```asm
; @launch kernel=k0_kernel grid=(512,1,1) block=(256,1,1) lds=8192
; @launch kernel=k1_kernel grid=(256,1,1) block=(256,1,1) lds=37952
; @launch kernel=chain_kernel grid=(256,1,1) block=(256,1,1) lds=163840
.amdgcn_target "amdgcn-amd-amdhsa--gfx950"
.text
.globl k0_kernel
.p2align 8
.type k0_kernel,@function
k0_kernel:
    s_cmp_ge_u32 s2, 512
    s_cbranch_scc1 k0_end
    s_load_dwordx4 s[4:7], s[0:1], 8
    s_load_dwordx2 s[8:9], s[0:1], 24
    s_load_dwordx2 s[10:11], s[0:1], 120
    s_load_dwordx2 s[60:61], s[0:1], 0
    s_load_dwordx2 s[62:63], s[0:1], 96
    s_load_dwordx2 s[52:53], s[0:1], 88
    s_load_dwordx4 s[56:59], s[0:1], 32
    v_lshrrev_b32 v2, 6, v0
    v_and_b32 v1, 63, v0
    v_readfirstlane_b32 s20, v2
    s_waitcnt lgkmcnt(0)
    s_mov_b32 s28, s10
    s_mov_b32 s29, s11
    s_mov_b32 s30, 268435456
    s_mov_b32 s31, 0x00020000
    s_cmp_ge_u32 s2, 320
    s_cbranch_scc1 p_aux
    s_mov_b32 s45, s20
    s_mov_b32 s16, s4
    s_mov_b32 s17, s5
    s_mov_b32 s18, 2621440
    s_mov_b32 s19, 0x00020000
    s_mov_b32 s20, s6
    s_mov_b32 s21, s7
    s_mov_b32 s22, 2621440
    s_mov_b32 s23, 0x00020000
    s_mov_b32 s24, s8
    s_mov_b32 s25, s9
    s_mov_b32 s26, 5120
    s_mov_b32 s27, 0x00020000
    s_mul_i32 s32, s2, 52429
    s_lshr_b32 s32, s32, 19
    s_mul_i32 s33, s32, 10
    s_sub_u32 s33, s2, s33
    v_and_b32 v1, 15, v0
    v_lshrrev_b32 v2, 4, v0
    s_lshl_b32 s34, s32, 6
    v_lshl_add_u32 v3, v2, 2, s34
    v_mul_u32_u24 v4, 1280, v3
    s_lshl_b32 s35, s33, 7
    v_lshl_add_u32 v5, v1, 3, s35
    v_add_u32 v4, v4, v5
    v_subrev_u32 v6, 3840, v4
    v_subrev_u32 v7, 2560, v4
    v_subrev_u32 v8, 1280, v4
    buffer_load_dwordx2 v[10:11], v6, s[16:19], 0 offen nt
    buffer_load_dwordx2 v[12:13], v7, s[16:19], 0 offen nt
    buffer_load_dwordx2 v[14:15], v8, s[16:19], 0 offen nt
    buffer_load_dwordx2 v[16:17], v4, s[16:19], 0 offen offset:0 nt
    buffer_load_dwordx2 v[18:19], v4, s[16:19], 0 offen offset:1280 nt
    buffer_load_dwordx2 v[20:21], v4, s[16:19], 0 offen offset:2560 nt
    buffer_load_dwordx2 v[22:23], v4, s[16:19], 0 offen offset:3840 nt
    v_lshlrev_b32 v100, 2, v5
    buffer_load_dwordx4 v[32:35], v100, s[24:27], 0 offen
    buffer_load_dwordx4 v[36:39], v100, s[24:27], 0 offen offset:16
    buffer_load_dwordx2 v[24:25], v4, s[20:23], 0 offen offset:0 nt
    buffer_load_dwordx2 v[26:27], v4, s[20:23], 0 offen offset:1280 nt
    buffer_load_dwordx2 v[28:29], v4, s[20:23], 0 offen offset:2560 nt
    buffer_load_dwordx2 v[30:31], v4, s[20:23], 0 offen offset:3840 nt
    v_lshlrev_b32 v100, 9, v1
    v_sub_u32 v101, 15, v2
    v_lshl_add_u32 v100, v101, 3, v100
    v_lshrrev_b32 v101, 3, v0
    v_mul_u32_u24 v101, 4352, v101
    v_and_b32 v102, 7, v0
    v_lshl_add_u32 v103, v102, 4, v101
    v_lshlrev_b32 v104, 4, v0
    s_mul_i32 s36, s33, 278528
    s_lshr_b32 s37, s32, 1
    s_mul_i32 s37, s37, 272
    s_add_u32 s36, s36, s37
    s_add_u32 s36, s36, 0
    s_and_b32 s37, s32, 1
    s_lshl_b32 s38, s37, 7
    s_sub_u32 s38, 128, s38
    s_add_u32 s38, s38, s36
    s_waitcnt vmcnt(4)
    v_lshlrev_b32 v40, 16, v32
    v_and_b32 v44, 0xffff0000, v32
    v_lshlrev_b32 v48, 16, v33
    v_and_b32 v52, 0xffff0000, v33
    v_lshlrev_b32 v41, 16, v34
    v_and_b32 v45, 0xffff0000, v34
    v_lshlrev_b32 v49, 16, v35
    v_and_b32 v53, 0xffff0000, v35
    v_lshlrev_b32 v42, 16, v36
    v_and_b32 v46, 0xffff0000, v36
    v_lshlrev_b32 v50, 16, v37
    v_and_b32 v54, 0xffff0000, v37
    v_lshlrev_b32 v43, 16, v38
    v_and_b32 v47, 0xffff0000, v38
    v_lshlrev_b32 v51, 16, v39
    v_and_b32 v55, 0xffff0000, v39
    v_lshlrev_b32 v56, 16, v10
    v_and_b32 v57, 0xffff0000, v10
    v_lshlrev_b32 v58, 16, v11
    v_and_b32 v59, 0xffff0000, v11
    v_lshlrev_b32 v60, 16, v12
    v_and_b32 v61, 0xffff0000, v12
    v_lshlrev_b32 v62, 16, v13
    v_and_b32 v63, 0xffff0000, v13
    v_lshlrev_b32 v64, 16, v14
    v_and_b32 v65, 0xffff0000, v14
    v_lshlrev_b32 v66, 16, v15
    v_and_b32 v67, 0xffff0000, v15
    v_lshlrev_b32 v68, 16, v16
    v_and_b32 v69, 0xffff0000, v16
    v_lshlrev_b32 v70, 16, v17
    v_and_b32 v71, 0xffff0000, v17
    v_lshlrev_b32 v72, 16, v18
    v_and_b32 v73, 0xffff0000, v18
    v_lshlrev_b32 v74, 16, v19
    v_and_b32 v75, 0xffff0000, v19
    v_lshlrev_b32 v76, 16, v20
    v_and_b32 v77, 0xffff0000, v20
    v_lshlrev_b32 v78, 16, v21
    v_and_b32 v79, 0xffff0000, v21
    v_lshlrev_b32 v80, 16, v22
    v_and_b32 v81, 0xffff0000, v22
    v_lshlrev_b32 v82, 16, v23
    v_and_b32 v83, 0xffff0000, v23
    v_pk_mul_f32 v[84:85], v[56:57], v[52:53]
    v_pk_mul_f32 v[86:87], v[58:59], v[54:55]
    v_pk_mul_f32 v[88:89], v[60:61], v[52:53]
    v_pk_mul_f32 v[90:91], v[62:63], v[54:55]
    v_pk_mul_f32 v[92:93], v[64:65], v[52:53]
    v_pk_mul_f32 v[94:95], v[66:67], v[54:55]
    v_pk_mul_f32 v[96:97], v[68:69], v[52:53]
    v_pk_mul_f32 v[98:99], v[70:71], v[54:55]
    v_pk_fma_f32 v[84:85], v[60:61], v[48:49], v[84:85]
    v_pk_fma_f32 v[86:87], v[62:63], v[50:51], v[86:87]
    v_pk_fma_f32 v[88:89], v[64:65], v[48:49], v[88:89]
    v_pk_fma_f32 v[90:91], v[66:67], v[50:51], v[90:91]
    v_pk_fma_f32 v[92:93], v[68:69], v[48:49], v[92:93]
    v_pk_fma_f32 v[94:95], v[70:71], v[50:51], v[94:95]
    v_pk_fma_f32 v[96:97], v[72:73], v[48:49], v[96:97]
    v_pk_fma_f32 v[98:99], v[74:75], v[50:51], v[98:99]
    v_pk_fma_f32 v[84:85], v[64:65], v[44:45], v[84:85]
    v_pk_fma_f32 v[86:87], v[66:67], v[46:47], v[86:87]
    v_pk_fma_f32 v[88:89], v[68:69], v[44:45], v[88:89]
    v_pk_fma_f32 v[90:91], v[70:71], v[46:47], v[90:91]
    v_pk_fma_f32 v[92:93], v[72:73], v[44:45], v[92:93]
    v_pk_fma_f32 v[94:95], v[74:75], v[46:47], v[94:95]
    v_pk_fma_f32 v[96:97], v[76:77], v[44:45], v[96:97]
    v_pk_fma_f32 v[98:99], v[78:79], v[46:47], v[98:99]
    v_pk_fma_f32 v[84:85], v[68:69], v[40:41], v[84:85]
    v_pk_fma_f32 v[86:87], v[70:71], v[42:43], v[86:87]
    v_pk_fma_f32 v[88:89], v[72:73], v[40:41], v[88:89]
    v_pk_fma_f32 v[90:91], v[74:75], v[42:43], v[90:91]
    v_pk_fma_f32 v[92:93], v[76:77], v[40:41], v[92:93]
    v_pk_fma_f32 v[94:95], v[78:79], v[42:43], v[94:95]
    v_pk_fma_f32 v[96:97], v[80:81], v[40:41], v[96:97]
    v_pk_fma_f32 v[98:99], v[82:83], v[42:43], v[98:99]
    v_cvt_pk_bf16_f32 v56, v84, v85
    v_cvt_pk_bf16_f32 v57, v86, v87
    v_cvt_pk_bf16_f32 v58, v88, v89
    v_cvt_pk_bf16_f32 v59, v90, v91
    v_cvt_pk_bf16_f32 v60, v92, v93
    v_cvt_pk_bf16_f32 v61, v94, v95
    v_cvt_pk_bf16_f32 v62, v96, v97
    v_cvt_pk_bf16_f32 v63, v98, v99
    s_waitcnt vmcnt(0)
    v_lshlrev_b32 v84, 16, v56
    v_and_b32 v85, 0xffff0000, v56
    v_lshlrev_b32 v86, 16, v57
    v_and_b32 v87, 0xffff0000, v57
    v_lshlrev_b32 v88, 16, v58
    v_and_b32 v89, 0xffff0000, v58
    v_lshlrev_b32 v90, 16, v59
    v_and_b32 v91, 0xffff0000, v59
    v_lshlrev_b32 v92, 16, v60
    v_and_b32 v93, 0xffff0000, v60
    v_lshlrev_b32 v94, 16, v61
    v_and_b32 v95, 0xffff0000, v61
    v_lshlrev_b32 v96, 16, v62
    v_and_b32 v97, 0xffff0000, v62
    v_lshlrev_b32 v98, 16, v63
    v_and_b32 v99, 0xffff0000, v63
    v_lshlrev_b32 v64, 16, v24
    v_and_b32 v65, 0xffff0000, v24
    v_pk_mul_f32 v[84:85], v[84:85], v[64:65]
    v_lshlrev_b32 v66, 16, v25
    v_and_b32 v67, 0xffff0000, v25
    v_pk_mul_f32 v[86:87], v[86:87], v[66:67]
    v_lshlrev_b32 v68, 16, v26
    v_and_b32 v69, 0xffff0000, v26
    v_pk_mul_f32 v[88:89], v[88:89], v[68:69]
    v_lshlrev_b32 v70, 16, v27
    v_and_b32 v71, 0xffff0000, v27
    v_pk_mul_f32 v[90:91], v[90:91], v[70:71]
    v_lshlrev_b32 v64, 16, v28
    v_and_b32 v65, 0xffff0000, v28
    v_pk_mul_f32 v[92:93], v[92:93], v[64:65]
    v_lshlrev_b32 v66, 16, v29
    v_and_b32 v67, 0xffff0000, v29
    v_pk_mul_f32 v[94:95], v[94:95], v[66:67]
    v_lshlrev_b32 v68, 16, v30
    v_and_b32 v69, 0xffff0000, v30
    v_pk_mul_f32 v[96:97], v[96:97], v[68:69]
    v_lshlrev_b32 v70, 16, v31
    v_and_b32 v71, 0xffff0000, v31
    v_pk_mul_f32 v[98:99], v[98:99], v[70:71]
    v_cvt_pk_bf16_f32 v64, v96, v92
    v_cvt_pk_bf16_f32 v65, v88, v84
    v_cvt_pk_bf16_f32 v66, v97, v93
    v_cvt_pk_bf16_f32 v67, v89, v85
    v_cvt_pk_bf16_f32 v68, v98, v94
    v_cvt_pk_bf16_f32 v69, v90, v86
    v_cvt_pk_bf16_f32 v70, v99, v95
    v_cvt_pk_bf16_f32 v71, v91, v87
    ds_write_b64 v100, v[64:65] offset:0
    ds_write_b64 v100, v[66:67] offset:128
    ds_write_b64 v100, v[68:69] offset:256
    ds_write_b64 v100, v[70:71] offset:384
    s_waitcnt lgkmcnt(0)
    s_barrier
    ds_read_b128 v[10:13], v104 offset:0
    ds_read_b128 v[14:17], v104 offset:4096
    s_waitcnt lgkmcnt(1)
    buffer_store_dwordx4 v[10:13], v103, s[28:31], s38 offen sc1
    s_add_u32 s38, s38, 139264
    s_waitcnt lgkmcnt(0)
    buffer_store_dwordx4 v[14:17], v103, s[28:31], s38 offen sc1
    s_add_u32 s38, s38, 139264
    v_cmp_eq_u32 vcc, 0, v102
    s_and_saveexec_b64 s[66:67], vcc
    s_cmp_eq_u32 s37, 0
    s_cbranch_scc1 k0_kernel_L1
    s_cmp_eq_u32 s32, 31
    s_cbranch_scc1 k0_kernel_L2
    buffer_store_dwordx4 v[10:13], v101, s[28:31], s36 offen offset:528 sc1
    s_add_u32 s36, s36, 139264
    buffer_store_dwordx4 v[14:17], v101, s[28:31], s36 offen offset:528 sc1
    s_add_u32 s36, s36, 139264
    s_branch k0_kernel_L2
k0_kernel_L1:
    s_cmp_lg_u32 s32, 0
    s_cbranch_scc1 k0_kernel_L2
    v_mov_b32 v108, 0
    v_mov_b32 v109, 0
    v_mov_b32 v110, 0
    v_mov_b32 v111, 0
    buffer_store_dwordx4 v[108:111], v101, s[28:31], s36 offen offset:256 sc1
    s_add_u32 s36, s36, 139264
    buffer_store_dwordx4 v[108:111], v101, s[28:31], s36 offen offset:256 sc1
    s_add_u32 s36, s36, 139264
k0_kernel_L2:
    s_endpgm
k0_end:
    s_endpgm
p_aux:
    s_sub_u32 s21, s2, 320
    s_cmp_ge_u32 s20, 2
    s_cbranch_scc1 p_misc
    s_cmp_eq_u32 s20, 1
    s_cbranch_scc1 p_aux1
    s_cmp_lt_u32 s21, 128
    s_cbranch_scc1 p_st
    s_sub_u32 s21, s21, 128
    s_branch p_mod
p_aux1:
    s_cmp_ge_u32 s21, 56
    s_cbranch_scc1 k0_end
    s_add_u32 s21, s21, 64
p_mod:
    s_lshr_b32 s32, s21, 2
    s_and_b32 s33, s21, 3
    v_lshrrev_b32 v4, 3, v1
    v_and_b32 v3, 7, v1
    s_mul_i32 s34, s33, 160
    v_add_u32 v4, s34, v4
    v_lshlrev_b32 v5, 1, v4
    v_mul_u32_u24 v6, 7680, v4
    s_lshl_b32 s36, s32, 7
    v_lshl_add_u32 v7, v3, 4, s36
    v_add_u32 v6, v6, v7
    s_mov_b32 s16, s52
    s_mov_b32 s17, s53
    s_mov_b32 s18, 1280
    s_mov_b32 s19, 0x00020000
    s_mov_b32 s24, s62
    s_mov_b32 s25, s63
    s_mov_b32 s26, 4915200
    s_mov_b32 s27, 0x00020000
    buffer_load_ushort v8, v5, s[16:19], 0 offen offset:0
    buffer_load_ushort v9, v5, s[16:19], 0 offen offset:16
    buffer_load_ushort v10, v5, s[16:19], 0 offen offset:32
    buffer_load_ushort v11, v5, s[16:19], 0 offen offset:48
    buffer_load_ushort v12, v5, s[16:19], 0 offen offset:64
    buffer_load_ushort v13, v5, s[16:19], 0 offen offset:80
    buffer_load_ushort v14, v5, s[16:19], 0 offen offset:96
    buffer_load_ushort v15, v5, s[16:19], 0 offen offset:112
    buffer_load_ushort v16, v5, s[16:19], 0 offen offset:128
    buffer_load_ushort v17, v5, s[16:19], 0 offen offset:144
    buffer_load_ushort v18, v5, s[16:19], 0 offen offset:160
    buffer_load_ushort v19, v5, s[16:19], 0 offen offset:176
    buffer_load_ushort v20, v5, s[16:19], 0 offen offset:192
    buffer_load_ushort v21, v5, s[16:19], 0 offen offset:208
    buffer_load_ushort v22, v5, s[16:19], 0 offen offset:224
    buffer_load_ushort v23, v5, s[16:19], 0 offen offset:240
    buffer_load_ushort v24, v5, s[16:19], 0 offen offset:256
    buffer_load_ushort v25, v5, s[16:19], 0 offen offset:272
    buffer_load_ushort v26, v5, s[16:19], 0 offen offset:288
    buffer_load_ushort v27, v5, s[16:19], 0 offen offset:304
    s_mov_b32 s37, 0
    buffer_load_dwordx4 v[32:35], v6, s[24:27], s37 offen nt
    s_add_u32 s37, s37, 61440
    buffer_load_dwordx4 v[36:39], v6, s[24:27], s37 offen nt
    s_add_u32 s37, s37, 61440
    buffer_load_dwordx4 v[40:43], v6, s[24:27], s37 offen nt
    s_add_u32 s37, s37, 61440
    buffer_load_dwordx4 v[44:47], v6, s[24:27], s37 offen nt
    s_add_u32 s37, s37, 61440
    buffer_load_dwordx4 v[48:51], v6, s[24:27], s37 offen nt
    s_add_u32 s37, s37, 61440
    buffer_load_dwordx4 v[52:55], v6, s[24:27], s37 offen nt
    s_add_u32 s37, s37, 61440
    buffer_load_dwordx4 v[56:59], v6, s[24:27], s37 offen nt
    s_add_u32 s37, s37, 61440
    buffer_load_dwordx4 v[60:63], v6, s[24:27], s37 offen nt
    s_add_u32 s37, s37, 61440
    buffer_load_dwordx4 v[64:67], v6, s[24:27], s37 offen nt
    s_add_u32 s37, s37, 61440
    buffer_load_dwordx4 v[68:71], v6, s[24:27], s37 offen nt
    s_add_u32 s37, s37, 61440
    buffer_load_dwordx4 v[72:75], v6, s[24:27], s37 offen nt
    s_add_u32 s37, s37, 61440
    buffer_load_dwordx4 v[76:79], v6, s[24:27], s37 offen nt
    s_add_u32 s37, s37, 61440
    buffer_load_dwordx4 v[80:83], v6, s[24:27], s37 offen nt
    s_add_u32 s37, s37, 61440
    buffer_load_dwordx4 v[84:87], v6, s[24:27], s37 offen nt
    s_add_u32 s37, s37, 61440
    buffer_load_dwordx4 v[88:91], v6, s[24:27], s37 offen nt
    s_add_u32 s37, s37, 61440
    buffer_load_dwordx4 v[92:95], v6, s[24:27], s37 offen nt
    s_add_u32 s37, s37, 61440
    buffer_load_dwordx4 v[96:99], v6, s[24:27], s37 offen nt
    s_add_u32 s37, s37, 61440
    buffer_load_dwordx4 v[100:103], v6, s[24:27], s37 offen nt
    s_add_u32 s37, s37, 61440
    buffer_load_dwordx4 v[104:107], v6, s[24:27], s37 offen nt
    s_add_u32 s37, s37, 61440
    buffer_load_dwordx4 v[108:111], v6, s[24:27], s37 offen nt
    s_waitcnt vmcnt(20)
    v_lshlrev_b32 v8, 16, v8
    v_lshlrev_b32 v9, 16, v9
    v_lshlrev_b32 v10, 16, v10
    v_lshlrev_b32 v11, 16, v11
    v_mul_f32 v120, 0xbfb8aa3b, v8
    v_mul_f32 v121, 0xbfb8aa3b, v9
    v_mul_f32 v122, 0xbfb8aa3b, v10
    v_mul_f32 v123, 0xbfb8aa3b, v11
    v_exp_f32 v120, v120
    v_exp_f32 v121, v121
    v_exp_f32 v122, v122
    v_exp_f32 v123, v123
    v_add_f32 v120, 1.0, v120
    v_add_f32 v121, 1.0, v121
    v_add_f32 v122, 1.0, v122
    v_add_f32 v123, 1.0, v123
    v_rcp_f32 v120, v120
    v_rcp_f32 v121, v121
    v_rcp_f32 v122, v122
    v_rcp_f32 v123, v123
    s_nop 0
    v_mul_f32 v8, v8, v120
    v_mul_f32 v9, v9, v121
    v_mul_f32 v10, v10, v122
    v_mul_f32 v11, v11, v123
    v_cvt_pk_bf16_f32 v120, v8, v9
    v_lshlrev_b32 v8, 16, v120
    v_and_b32 v9, 0xffff0000, v120
    v_cvt_pk_bf16_f32 v120, v10, v11
    v_lshlrev_b32 v10, 16, v120
    v_and_b32 v11, 0xffff0000, v120
    v_lshlrev_b32 v12, 16, v12
    v_lshlrev_b32 v13, 16, v13
    v_lshlrev_b32 v14, 16, v14
    v_lshlrev_b32 v15, 16, v15
    v_mul_f32 v120, 0xbfb8aa3b, v12
    v_mul_f32 v121, 0xbfb8aa3b, v13
    v_mul_f32 v122, 0xbfb8aa3b, v14
    v_mul_f32 v123, 0xbfb8aa3b, v15
    v_exp_f32 v120, v120
    v_exp_f32 v121, v121
    v_exp_f32 v122, v122
    v_exp_f32 v123, v123
    v_add_f32 v120, 1.0, v120
    v_add_f32 v121, 1.0, v121
    v_add_f32 v122, 1.0, v122
    v_add_f32 v123, 1.0, v123
    v_rcp_f32 v120, v120
    v_rcp_f32 v121, v121
    v_rcp_f32 v122, v122
    v_rcp_f32 v123, v123
    s_nop 0
    v_mul_f32 v12, v12, v120
    v_mul_f32 v13, v13, v121
    v_mul_f32 v14, v14, v122
    v_mul_f32 v15, v15, v123
    v_cvt_pk_bf16_f32 v120, v12, v13
    v_lshlrev_b32 v12, 16, v120
    v_and_b32 v13, 0xffff0000, v120
    v_cvt_pk_bf16_f32 v120, v14, v15
    v_lshlrev_b32 v14, 16, v120
    v_and_b32 v15, 0xffff0000, v120
    v_lshlrev_b32 v16, 16, v16
    v_lshlrev_b32 v17, 16, v17
    v_lshlrev_b32 v18, 16, v18
    v_lshlrev_b32 v19, 16, v19
    v_mul_f32 v120, 0xbfb8aa3b, v16
    v_mul_f32 v121, 0xbfb8aa3b, v17
    v_mul_f32 v122, 0xbfb8aa3b, v18
    v_mul_f32 v123, 0xbfb8aa3b, v19
    v_exp_f32 v120, v120
    v_exp_f32 v121, v121
    v_exp_f32 v122, v122
    v_exp_f32 v123, v123
    v_add_f32 v120, 1.0, v120
    v_add_f32 v121, 1.0, v121
    v_add_f32 v122, 1.0, v122
    v_add_f32 v123, 1.0, v123
    v_rcp_f32 v120, v120
    v_rcp_f32 v121, v121
    v_rcp_f32 v122, v122
    v_rcp_f32 v123, v123
    s_nop 0
    v_mul_f32 v16, v16, v120
    v_mul_f32 v17, v17, v121
    v_mul_f32 v18, v18, v122
    v_mul_f32 v19, v19, v123
    v_cvt_pk_bf16_f32 v120, v16, v17
    v_lshlrev_b32 v16, 16, v120
    v_and_b32 v17, 0xffff0000, v120
    v_cvt_pk_bf16_f32 v120, v18, v19
    v_lshlrev_b32 v18, 16, v120
    v_and_b32 v19, 0xffff0000, v120
    v_lshlrev_b32 v20, 16, v20
    v_lshlrev_b32 v21, 16, v21
    v_lshlrev_b32 v22, 16, v22
    v_lshlrev_b32 v23, 16, v23
    v_mul_f32 v120, 0xbfb8aa3b, v20
    v_mul_f32 v121, 0xbfb8aa3b, v21
    v_mul_f32 v122, 0xbfb8aa3b, v22
    v_mul_f32 v123, 0xbfb8aa3b, v23
    v_exp_f32 v120, v120
    v_exp_f32 v121, v121
    v_exp_f32 v122, v122
    v_exp_f32 v123, v123
    v_add_f32 v120, 1.0, v120
    v_add_f32 v121, 1.0, v121
    v_add_f32 v122, 1.0, v122
    v_add_f32 v123, 1.0, v123
    v_rcp_f32 v120, v120
    v_rcp_f32 v121, v121
    v_rcp_f32 v122, v122
    v_rcp_f32 v123, v123
    s_nop 0
    v_mul_f32 v20, v20, v120
    v_mul_f32 v21, v21, v121
    v_mul_f32 v22, v22, v122
    v_mul_f32 v23, v23, v123
    v_cvt_pk_bf16_f32 v120, v20, v21
    v_lshlrev_b32 v20, 16, v120
    v_and_b32 v21, 0xffff0000, v120
    v_cvt_pk_bf16_f32 v120, v22, v23
    v_lshlrev_b32 v22, 16, v120
    v_and_b32 v23, 0xffff0000, v120
    v_lshlrev_b32 v24, 16, v24
    v_lshlrev_b32 v25, 16, v25
    v_lshlrev_b32 v26, 16, v26
    v_lshlrev_b32 v27, 16, v27
    v_mul_f32 v120, 0xbfb8aa3b, v24
    v_mul_f32 v121, 0xbfb8aa3b, v25
    v_mul_f32 v122, 0xbfb8aa3b, v26
    v_mul_f32 v123, 0xbfb8aa3b, v27
    v_exp_f32 v120, v120
    v_exp_f32 v121, v121
    v_exp_f32 v122, v122
    v_exp_f32 v123, v123
    v_add_f32 v120, 1.0, v120
    v_add_f32 v121, 1.0, v121
    v_add_f32 v122, 1.0, v122
    v_add_f32 v123, 1.0, v123
    v_rcp_f32 v120, v120
    v_rcp_f32 v121, v121
    v_rcp_f32 v122, v122
    v_rcp_f32 v123, v123
    s_nop 0
    v_mul_f32 v24, v24, v120
    v_mul_f32 v25, v25, v121
    v_mul_f32 v26, v26, v122
    v_mul_f32 v27, v27, v123
    v_cvt_pk_bf16_f32 v120, v24, v25
    v_lshlrev_b32 v24, 16, v120
    v_and_b32 v25, 0xffff0000, v120
    v_cvt_pk_bf16_f32 v120, v26, v27
    v_lshlrev_b32 v26, 16, v120
    v_and_b32 v27, 0xffff0000, v120
    v_mov_b32 v112, 0
    v_mov_b32 v113, 0
    v_mov_b32 v114, 0
    v_mov_b32 v115, 0
    v_mov_b32 v116, 0
    v_mov_b32 v117, 0
    v_mov_b32 v118, 0
    v_mov_b32 v119, 0
    s_waitcnt vmcnt(19)
    v_lshlrev_b32 v120, 16, v32
    v_and_b32 v121, 0xffff0000, v32
    v_lshlrev_b32 v122, 16, v33
    v_and_b32 v123, 0xffff0000, v33
    v_lshlrev_b32 v124, 16, v34
    v_and_b32 v125, 0xffff0000, v34
    v_lshlrev_b32 v126, 16, v35
    v_and_b32 v127, 0xffff0000, v35
    v_pk_fma_f32 v[112:113], v[120:121], v[8:9], v[112:113] op_sel:[0,0,0] op_sel_hi:[1,0,1]
    v_pk_fma_f32 v[114:115], v[122:123], v[8:9], v[114:115] op_sel:[0,0,0] op_sel_hi:[1,0,1]
    v_pk_fma_f32 v[116:117], v[124:125], v[8:9], v[116:117] op_sel:[0,0,0] op_sel_hi:[1,0,1]
    v_pk_fma_f32 v[118:119], v[126:127], v[8:9], v[118:119] op_sel:[0,0,0] op_sel_hi:[1,0,1]
    s_waitcnt vmcnt(18)
    v_lshlrev_b32 v120, 16, v36
    v_and_b32 v121, 0xffff0000, v36
    v_lshlrev_b32 v122, 16, v37
    v_and_b32 v123, 0xffff0000, v37
    v_lshlrev_b32 v124, 16, v38
    v_and_b32 v125, 0xffff0000, v38
    v_lshlrev_b32 v126, 16, v39
    v_and_b32 v127, 0xffff0000, v39
    v_pk_fma_f32 v[112:113], v[120:121], v[8:9], v[112:113] op_sel:[0,1,0] op_sel_hi:[1,1,1]
    v_pk_fma_f32 v[114:115], v[122:123], v[8:9], v[114:115] op_sel:[0,1,0] op_sel_hi:[1,1,1]
    v_pk_fma_f32 v[116:117], v[124:125], v[8:9], v[116:117] op_sel:[0,1,0] op_sel_hi:[1,1,1]
    v_pk_fma_f32 v[118:119], v[126:127], v[8:9], v[118:119] op_sel:[0,1,0] op_sel_hi:[1,1,1]
    s_waitcnt vmcnt(17)
    v_lshlrev_b32 v120, 16, v40
    v_and_b32 v121, 0xffff0000, v40
    v_lshlrev_b32 v122, 16, v41
    v_and_b32 v123, 0xffff0000, v41
    v_lshlrev_b32 v124, 16, v42
    v_and_b32 v125, 0xffff0000, v42
    v_lshlrev_b32 v126, 16, v43
    v_and_b32 v127, 0xffff0000, v43
    v_pk_fma_f32 v[112:113], v[120:121], v[10:11], v[112:113] op_sel:[0,0,0] op_sel_hi:[1,0,1]
    v_pk_fma_f32 v[114:115], v[122:123], v[10:11], v[114:115] op_sel:[0,0,0] op_sel_hi:[1,0,1]
    v_pk_fma_f32 v[116:117], v[124:125], v[10:11], v[116:117] op_sel:[0,0,0] op_sel_hi:[1,0,1]
    v_pk_fma_f32 v[118:119], v[126:127], v[10:11], v[118:119] op_sel:[0,0,0] op_sel_hi:[1,0,1]
    s_waitcnt vmcnt(16)
    v_lshlrev_b32 v120, 16, v44
    v_and_b32 v121, 0xffff0000, v44
    v_lshlrev_b32 v122, 16, v45
    v_and_b32 v123, 0xffff0000, v45
    v_lshlrev_b32 v124, 16, v46
    v_and_b32 v125, 0xffff0000, v46
    v_lshlrev_b32 v126, 16, v47
    v_and_b32 v127, 0xffff0000, v47
    v_pk_fma_f32 v[112:113], v[120:121], v[10:11], v[112:113] op_sel:[0,1,0] op_sel_hi:[1,1,1]
    v_pk_fma_f32 v[114:115], v[122:123], v[10:11], v[114:115] op_sel:[0,1,0] op_sel_hi:[1,1,1]
    v_pk_fma_f32 v[116:117], v[124:125], v[10:11], v[116:117] op_sel:[0,1,0] op_sel_hi:[1,1,1]
    v_pk_fma_f32 v[118:119], v[126:127], v[10:11], v[118:119] op_sel:[0,1,0] op_sel_hi:[1,1,1]
    s_waitcnt vmcnt(15)
    v_lshlrev_b32 v120, 16, v48
    v_and_b32 v121, 0xffff0000, v48
    v_lshlrev_b32 v122, 16, v49
    v_and_b32 v123, 0xffff0000, v49
    v_lshlrev_b32 v124, 16, v50
    v_and_b32 v125, 0xffff0000, v50
    v_lshlrev_b32 v126, 16, v51
    v_and_b32 v127, 0xffff0000, v51
    v_pk_fma_f32 v[112:113], v[120:121], v[12:13], v[112:113] op_sel:[0,0,0] op_sel_hi:[1,0,1]
    v_pk_fma_f32 v[114:115], v[122:123], v[12:13], v[114:115] op_sel:[0,0,0] op_sel_hi:[1,0,1]
    v_pk_fma_f32 v[116:117], v[124:125], v[12:13], v[116:117] op_sel:[0,0,0] op_sel_hi:[1,0,1]
    v_pk_fma_f32 v[118:119], v[126:127], v[12:13], v[118:119] op_sel:[0,0,0] op_sel_hi:[1,0,1]
    s_waitcnt vmcnt(14)
    v_lshlrev_b32 v120, 16, v52
    v_and_b32 v121, 0xffff0000, v52
    v_lshlrev_b32 v122, 16, v53
    v_and_b32 v123, 0xffff0000, v53
    v_lshlrev_b32 v124, 16, v54
    v_and_b32 v125, 0xffff0000, v54
    v_lshlrev_b32 v126, 16, v55
    v_and_b32 v127, 0xffff0000, v55
    v_pk_fma_f32 v[112:113], v[120:121], v[12:13], v[112:113] op_sel:[0,1,0] op_sel_hi:[1,1,1]
    v_pk_fma_f32 v[114:115], v[122:123], v[12:13], v[114:115] op_sel:[0,1,0] op_sel_hi:[1,1,1]
    v_pk_fma_f32 v[116:117], v[124:125], v[12:13], v[116:117] op_sel:[0,1,0] op_sel_hi:[1,1,1]
    v_pk_fma_f32 v[118:119], v[126:127], v[12:13], v[118:119] op_sel:[0,1,0] op_sel_hi:[1,1,1]
    s_waitcnt vmcnt(13)
    v_lshlrev_b32 v120, 16, v56
    v_and_b32 v121, 0xffff0000, v56
    v_lshlrev_b32 v122, 16, v57
    v_and_b32 v123, 0xffff0000, v57
    v_lshlrev_b32 v124, 16, v58
    v_and_b32 v125, 0xffff0000, v58
    v_lshlrev_b32 v126, 16, v59
    v_and_b32 v127, 0xffff0000, v59
    v_pk_fma_f32 v[112:113], v[120:121], v[14:15], v[112:113] op_sel:[0,0,0] op_sel_hi:[1,0,1]
    v_pk_fma_f32 v[114:115], v[122:123], v[14:15], v[114:115] op_sel:[0,0,0] op_sel_hi:[1,0,1]
    v_pk_fma_f32 v[116:117], v[124:125], v[14:15], v[116:117] op_sel:[0,0,0] op_sel_hi:[1,0,1]
    v_pk_fma_f32 v[118:119], v[126:127], v[14:15], v[118:119] op_sel:[0,0,0] op_sel_hi:[1,0,1]
    s_waitcnt vmcnt(12)
    v_lshlrev_b32 v120, 16, v60
    v_and_b32 v121, 0xffff0000, v60
    v_lshlrev_b32 v122, 16, v61
    v_and_b32 v123, 0xffff0000, v61
    v_lshlrev_b32 v124, 16, v62
    v_and_b32 v125, 0xffff0000, v62
    v_lshlrev_b32 v126, 16, v63
    v_and_b32 v127, 0xffff0000, v63
    v_pk_fma_f32 v[112:113], v[120:121], v[14:15], v[112:113] op_sel:[0,1,0] op_sel_hi:[1,1,1]
    v_pk_fma_f32 v[114:115], v[122:123], v[14:15], v[114:115] op_sel:[0,1,0] op_sel_hi:[1,1,1]
    v_pk_fma_f32 v[116:117], v[124:125], v[14:15], v[116:117] op_sel:[0,1,0] op_sel_hi:[1,1,1]
    v_pk_fma_f32 v[118:119], v[126:127], v[14:15], v[118:119] op_sel:[0,1,0] op_sel_hi:[1,1,1]
    s_waitcnt vmcnt(11)
    v_lshlrev_b32 v120, 16, v64
    v_and_b32 v121, 0xffff0000, v64
    v_lshlrev_b32 v122, 16, v65
    v_and_b32 v123, 0xffff0000, v65
    v_lshlrev_b32 v124, 16, v66
    v_and_b32 v125, 0xffff0000, v66
    v_lshlrev_b32 v126, 16, v67
    v_and_b32 v127, 0xffff0000, v67
    v_pk_fma_f32 v[112:113], v[120:121], v[16:17], v[112:113] op_sel:[0,0,0] op_sel_hi:[1,0,1]
    v_pk_fma_f32 v[114:115], v[122:123], v[16:17], v[114:115] op_sel:[0,0,0] op_sel_hi:[1,0,1]
    v_pk_fma_f32 v[116:117], v[124:125], v[16:17], v[116:117] op_sel:[0,0,0] op_sel_hi:[1,0,1]
    v_pk_fma_f32 v[118:119], v[126:127], v[16:17], v[118:119] op_sel:[0,0,0] op_sel_hi:[1,0,1]
    s_waitcnt vmcnt(10)
    v_lshlrev_b32 v120, 16, v68
    v_and_b32 v121, 0xffff0000, v68
    v_lshlrev_b32 v122, 16, v69
    v_and_b32 v123, 0xffff0000, v69
    v_lshlrev_b32 v124, 16, v70
    v_and_b32 v125, 0xffff0000, v70
    v_lshlrev_b32 v126, 16, v71
    v_and_b32 v127, 0xffff0000, v71
    v_pk_fma_f32 v[112:113], v[120:121], v[16:17], v[112:113] op_sel:[0,1,0] op_sel_hi:[1,1,1]
    v_pk_fma_f32 v[114:115], v[122:123], v[16:17], v[114:115] op_sel:[0,1,0] op_sel_hi:[1,1,1]
    v_pk_fma_f32 v[116:117], v[124:125], v[16:17], v[116:117] op_sel:[0,1,0] op_sel_hi:[1,1,1]
    v_pk_fma_f32 v[118:119], v[126:127], v[16:17], v[118:119] op_sel:[0,1,0] op_sel_hi:[1,1,1]
    s_waitcnt vmcnt(9)
    v_lshlrev_b32 v120, 16, v72
    v_and_b32 v121, 0xffff0000, v72
    v_lshlrev_b32 v122, 16, v73
    v_and_b32 v123, 0xffff0000, v73
    v_lshlrev_b32 v124, 16, v74
    v_and_b32 v125, 0xffff0000, v74
    v_lshlrev_b32 v126, 16, v75
    v_and_b32 v127, 0xffff0000, v75
    v_pk_fma_f32 v[112:113], v[120:121], v[18:19], v[112:113] op_sel:[0,0,0] op_sel_hi:[1,0,1]
    v_pk_fma_f32 v[114:115], v[122:123], v[18:19], v[114:115] op_sel:[0,0,0] op_sel_hi:[1,0,1]
    v_pk_fma_f32 v[116:117], v[124:125], v[18:19], v[116:117] op_sel:[0,0,0] op_sel_hi:[1,0,1]
    v_pk_fma_f32 v[118:119], v[126:127], v[18:19], v[118:119] op_sel:[0,0,0] op_sel_hi:[1,0,1]
    s_waitcnt vmcnt(8)
    v_lshlrev_b32 v120, 16, v76
    v_and_b32 v121, 0xffff0000, v76
    v_lshlrev_b32 v122, 16, v77
    v_and_b32 v123, 0xffff0000, v77
    v_lshlrev_b32 v124, 16, v78
    v_and_b32 v125, 0xffff0000, v78
    v_lshlrev_b32 v126, 16, v79
    v_and_b32 v127, 0xffff0000, v79
    v_pk_fma_f32 v[112:113], v[120:121], v[18:19], v[112:113] op_sel:[0,1,0] op_sel_hi:[1,1,1]
    v_pk_fma_f32 v[114:115], v[122:123], v[18:19], v[114:115] op_sel:[0,1,0] op_sel_hi:[1,1,1]
    v_pk_fma_f32 v[116:117], v[124:125], v[18:19], v[116:117] op_sel:[0,1,0] op_sel_hi:[1,1,1]
    v_pk_fma_f32 v[118:119], v[126:127], v[18:19], v[118:119] op_sel:[0,1,0] op_sel_hi:[1,1,1]
    s_waitcnt vmcnt(7)
    v_lshlrev_b32 v120, 16, v80
    v_and_b32 v121, 0xffff0000, v80
    v_lshlrev_b32 v122, 16, v81
    v_and_b32 v123, 0xffff0000, v81
    v_lshlrev_b32 v124, 16, v82
    v_and_b32 v125, 0xffff0000, v82
    v_lshlrev_b32 v126, 16, v83
    v_and_b32 v127, 0xffff0000, v83
    v_pk_fma_f32 v[112:113], v[120:121], v[20:21], v[112:113] op_sel:[0,0,0] op_sel_hi:[1,0,1]
    v_pk_fma_f32 v[114:115], v[122:123], v[20:21], v[114:115] op_sel:[0,0,0] op_sel_hi:[1,0,1]
    v_pk_fma_f32 v[116:117], v[124:125], v[20:21], v[116:117] op_sel:[0,0,0] op_sel_hi:[1,0,1]
    v_pk_fma_f32 v[118:119], v[126:127], v[20:21], v[118:119] op_sel:[0,0,0] op_sel_hi:[1,0,1]
    s_waitcnt vmcnt(6)
    v_lshlrev_b32 v120, 16, v84
    v_and_b32 v121, 0xffff0000, v84
    v_lshlrev_b32 v122, 16, v85
    v_and_b32 v123, 0xffff0000, v85
    v_lshlrev_b32 v124, 16, v86
    v_and_b32 v125, 0xffff0000, v86
    v_lshlrev_b32 v126, 16, v87
    v_and_b32 v127, 0xffff0000, v87
    v_pk_fma_f32 v[112:113], v[120:121], v[20:21], v[112:113] op_sel:[0,1,0] op_sel_hi:[1,1,1]
    v_pk_fma_f32 v[114:115], v[122:123], v[20:21], v[114:115] op_sel:[0,1,0] op_sel_hi:[1,1,1]
    v_pk_fma_f32 v[116:117], v[124:125], v[20:21], v[116:117] op_sel:[0,1,0] op_sel_hi:[1,1,1]
    v_pk_fma_f32 v[118:119], v[126:127], v[20:21], v[118:119] op_sel:[0,1,0] op_sel_hi:[1,1,1]
    s_waitcnt vmcnt(5)
    v_lshlrev_b32 v120, 16, v88
    v_and_b32 v121, 0xffff0000, v88
    v_lshlrev_b32 v122, 16, v89
    v_and_b32 v123, 0xffff0000, v89
    v_lshlrev_b32 v124, 16, v90
    v_and_b32 v125, 0xffff0000, v90
    v_lshlrev_b32 v126, 16, v91
    v_and_b32 v127, 0xffff0000, v91
    v_pk_fma_f32 v[112:113], v[120:121], v[22:23], v[112:113] op_sel:[0,0,0] op_sel_hi:[1,0,1]
    v_pk_fma_f32 v[114:115], v[122:123], v[22:23], v[114:115] op_sel:[0,0,0] op_sel_hi:[1,0,1]
    v_pk_fma_f32 v[116:117], v[124:125], v[22:23], v[116:117] op_sel:[0,0,0] op_sel_hi:[1,0,1]
    v_pk_fma_f32 v[118:119], v[126:127], v[22:23], v[118:119] op_sel:[0,0,0] op_sel_hi:[1,0,1]
    s_waitcnt vmcnt(4)
    v_lshlrev_b32 v120, 16, v92
    v_and_b32 v121, 0xffff0000, v92
    v_lshlrev_b32 v122, 16, v93
    v_and_b32 v123, 0xffff0000, v93
    v_lshlrev_b32 v124, 16, v94
    v_and_b32 v125, 0xffff0000, v94
    v_lshlrev_b32 v126, 16, v95
    v_and_b32 v127, 0xffff0000, v95
    v_pk_fma_f32 v[112:113], v[120:121], v[22:23], v[112:113] op_sel:[0,1,0] op_sel_hi:[1,1,1]
    v_pk_fma_f32 v[114:115], v[122:123], v[22:23], v[114:115] op_sel:[0,1,0] op_sel_hi:[1,1,1]
    v_pk_fma_f32 v[116:117], v[124:125], v[22:23], v[116:117] op_sel:[0,1,0] op_sel_hi:[1,1,1]
    v_pk_fma_f32 v[118:119], v[126:127], v[22:23], v[118:119] op_sel:[0,1,0] op_sel_hi:[1,1,1]
    s_waitcnt vmcnt(3)
    v_lshlrev_b32 v120, 16, v96
    v_and_b32 v121, 0xffff0000, v96
    v_lshlrev_b32 v122, 16, v97
    v_and_b32 v123, 0xffff0000, v97
    v_lshlrev_b32 v124, 16, v98
    v_and_b32 v125, 0xffff0000, v98
    v_lshlrev_b32 v126, 16, v99
    v_and_b32 v127, 0xffff0000, v99
    v_pk_fma_f32 v[112:113], v[120:121], v[24:25], v[112:113] op_sel:[0,0,0] op_sel_hi:[1,0,1]
    v_pk_fma_f32 v[114:115], v[122:123], v[24:25], v[114:115] op_sel:[0,0,0] op_sel_hi:[1,0,1]
    v_pk_fma_f32 v[116:117], v[124:125], v[24:25], v[116:117] op_sel:[0,0,0] op_sel_hi:[1,0,1]
    v_pk_fma_f32 v[118:119], v[126:127], v[24:25], v[118:119] op_sel:[0,0,0] op_sel_hi:[1,0,1]
    s_waitcnt vmcnt(2)
    v_lshlrev_b32 v120, 16, v100
    v_and_b32 v121, 0xffff0000, v100
    v_lshlrev_b32 v122, 16, v101
    v_and_b32 v123, 0xffff0000, v101
    v_lshlrev_b32 v124, 16, v102
    v_and_b32 v125, 0xffff0000, v102
    v_lshlrev_b32 v126, 16, v103
    v_and_b32 v127, 0xffff0000, v103
    v_pk_fma_f32 v[112:113], v[120:121], v[24:25], v[112:113] op_sel:[0,1,0] op_sel_hi:[1,1,1]
    v_pk_fma_f32 v[114:115], v[122:123], v[24:25], v[114:115] op_sel:[0,1,0] op_sel_hi:[1,1,1]
    v_pk_fma_f32 v[116:117], v[124:125], v[24:25], v[116:117] op_sel:[0,1,0] op_sel_hi:[1,1,1]
    v_pk_fma_f32 v[118:119], v[126:127], v[24:25], v[118:119] op_sel:[0,1,0] op_sel_hi:[1,1,1]
    s_waitcnt vmcnt(1)
    v_lshlrev_b32 v120, 16, v104
    v_and_b32 v121, 0xffff0000, v104
    v_lshlrev_b32 v122, 16, v105
    v_and_b32 v123, 0xffff0000, v105
    v_lshlrev_b32 v124, 16, v106
    v_and_b32 v125, 0xffff0000, v106
    v_lshlrev_b32 v126, 16, v107
    v_and_b32 v127, 0xffff0000, v107
    v_pk_fma_f32 v[112:113], v[120:121], v[26:27], v[112:113] op_sel:[0,0,0] op_sel_hi:[1,0,1]
    v_pk_fma_f32 v[114:115], v[122:123], v[26:27], v[114:115] op_sel:[0,0,0] op_sel_hi:[1,0,1]
    v_pk_fma_f32 v[116:117], v[124:125], v[26:27], v[116:117] op_sel:[0,0,0] op_sel_hi:[1,0,1]
    v_pk_fma_f32 v[118:119], v[126:127], v[26:27], v[118:119] op_sel:[0,0,0] op_sel_hi:[1,0,1]
    s_waitcnt vmcnt(0)
    v_lshlrev_b32 v120, 16, v108
    v_and_b32 v121, 0xffff0000, v108
    v_lshlrev_b32 v122, 16, v109
    v_and_b32 v123, 0xffff0000, v109
    v_lshlrev_b32 v124, 16, v110
    v_and_b32 v125, 0xffff0000, v110
    v_lshlrev_b32 v126, 16, v111
    v_and_b32 v127, 0xffff0000, v111
    v_pk_fma_f32 v[112:113], v[120:121], v[26:27], v[112:113] op_sel:[0,1,0] op_sel_hi:[1,1,1]
    v_pk_fma_f32 v[114:115], v[122:123], v[26:27], v[114:115] op_sel:[0,1,0] op_sel_hi:[1,1,1]
    v_pk_fma_f32 v[116:117], v[124:125], v[26:27], v[116:117] op_sel:[0,1,0] op_sel_hi:[1,1,1]
    v_pk_fma_f32 v[118:119], v[126:127], v[26:27], v[118:119] op_sel:[0,1,0] op_sel_hi:[1,1,1]
    s_nop 1
    v_add_f32_dpp v112, v112, v112 row_ror:8 row_mask:0xf bank_mask:0xf
    v_add_f32_dpp v113, v113, v113 row_ror:8 row_mask:0xf bank_mask:0xf
    v_add_f32_dpp v114, v114, v114 row_ror:8 row_mask:0xf bank_mask:0xf
    v_add_f32_dpp v115, v115, v115 row_ror:8 row_mask:0xf bank_mask:0xf
    v_add_f32_dpp v116, v116, v116 row_ror:8 row_mask:0xf bank_mask:0xf
    v_add_f32_dpp v117, v117, v117 row_ror:8 row_mask:0xf bank_mask:0xf
    v_add_f32_dpp v118, v118, v118 row_ror:8 row_mask:0xf bank_mask:0xf
    v_add_f32_dpp v119, v119, v119 row_ror:8 row_mask:0xf bank_mask:0xf
    v_mov_b32 v120, v112
    v_mov_b32 v121, v113
    v_mov_b32 v122, v114
    v_mov_b32 v123, v115
    v_mov_b32 v124, v116
    v_mov_b32 v125, v117
    v_mov_b32 v126, v118
    v_mov_b32 v127, v119
    s_nop 1
    v_permlane32_swap_b32 v120, v112
    v_permlane32_swap_b32 v121, v113
    v_permlane32_swap_b32 v122, v114
    v_permlane32_swap_b32 v123, v115
    v_permlane32_swap_b32 v124, v116
    v_permlane32_swap_b32 v125, v117
    v_permlane32_swap_b32 v126, v118
    v_permlane32_swap_b32 v127, v119
    s_nop 1
    v_add_f32 v112, v112, v120
    v_add_f32 v113, v113, v121
    v_add_f32 v114, v114, v122
    v_add_f32 v115, v115, v123
    v_add_f32 v116, v116, v124
    v_add_f32 v117, v117, v125
    v_add_f32 v118, v118, v126
    v_add_f32 v119, v119, v127
    v_mov_b32 v120, v112
    v_mov_b32 v121, v113
    v_mov_b32 v122, v114
    v_mov_b32 v123, v115
    v_mov_b32 v124, v116
    v_mov_b32 v125, v117
    v_mov_b32 v126, v118
    v_mov_b32 v127, v119
    s_nop 1
    v_permlane16_swap_b32 v120, v112
    v_permlane16_swap_b32 v121, v113
    v_permlane16_swap_b32 v122, v114
    v_permlane16_swap_b32 v123, v115
    v_permlane16_swap_b32 v124, v116
    v_permlane16_swap_b32 v125, v117
    v_permlane16_swap_b32 v126, v118
    v_permlane16_swap_b32 v127, v119
    s_nop 1
    v_add_f32 v112, v112, v120
    v_add_f32 v113, v113, v121
    v_add_f32 v114, v114, v122
    v_add_f32 v115, v115, v123
    v_add_f32 v116, v116, v124
    v_add_f32 v117, v117, v125
    v_add_f32 v118, v118, v126
    v_add_f32 v119, v119, v127
    v_lshlrev_b32 v7, 5, v3
    s_mul_i32 s36, s33, 15360
    s_lshl_b32 s37, s32, 8
    s_add_u32 s37, s37, s36
    s_add_u32 s37, s37, 2793472
    s_mov_b64 exec, 0xff
    buffer_store_dwordx4 v[112:115], v7, s[28:31], s37 offen sc1
    buffer_store_dwordx4 v[116:119], v7, s[28:31], s37 offen offset:16 sc1
    s_endpgm
p_st:
    s_mov_b32 s16, s60
    s_mov_b32 s17, s61
    s_mov_b32 s18, 2621440
    s_mov_b32 s19, 0x00020000
    v_lshrrev_b32 v5, 3, v1
    v_and_b32 v6, 7, v1
    s_lshl_b32 s23, s21, 4
    v_add_u32 v7, s23, v5
    v_mul_u32_u24 v9, 1280, v7
    v_lshl_add_u32 v9, v6, 4, v9
    v_mov_b32 v20, 0x3f803f80
    s_mov_b32 s24, 0
    buffer_load_dwordx4 v[32:35], v9, s[16:19], s24 offen offset:0 nt
    buffer_load_dwordx4 v[36:39], v9, s[16:19], s24 offen offset:128 nt
    buffer_load_dwordx4 v[40:43], v9, s[16:19], s24 offen offset:256 nt
    buffer_load_dwordx4 v[44:47], v9, s[16:19], s24 offen offset:384 nt
    buffer_load_dwordx4 v[48:51], v9, s[16:19], s24 offen offset:512 nt
    buffer_load_dwordx4 v[52:55], v9, s[16:19], s24 offen offset:640 nt
    buffer_load_dwordx4 v[56:59], v9, s[16:19], s24 offen offset:768 nt
    buffer_load_dwordx4 v[60:63], v9, s[16:19], s24 offen offset:896 nt
    buffer_load_dwordx4 v[64:67], v9, s[16:19], s24 offen offset:1024 nt
    buffer_load_dwordx4 v[68:71], v9, s[16:19], s24 offen offset:1152 nt
    s_add_u32 s24, s24, 10240
    buffer_load_dwordx4 v[72:75], v9, s[16:19], s24 offen offset:0 nt
    buffer_load_dwordx4 v[76:79], v9, s[16:19], s24 offen offset:128 nt
    buffer_load_dwordx4 v[80:83], v9, s[16:19], s24 offen offset:256 nt
    buffer_load_dwordx4 v[84:87], v9, s[16:19], s24 offen offset:384 nt
    buffer_load_dwordx4 v[88:91], v9, s[16:19], s24 offen offset:512 nt
    buffer_load_dwordx4 v[92:95], v9, s[16:19], s24 offen offset:640 nt
    buffer_load_dwordx4 v[96:99], v9, s[16:19], s24 offen offset:768 nt
    buffer_load_dwordx4 v[100:103], v9, s[16:19], s24 offen offset:896 nt
    buffer_load_dwordx4 v[104:107], v9, s[16:19], s24 offen offset:1024 nt
    buffer_load_dwordx4 v[108:111], v9, s[16:19], s24 offen offset:1152 nt
    v_and_b32 v21, 1, v5
    v_lshl_add_u32 v21, v6, 1, v21
    v_lshlrev_b32 v21, 7, v21
    v_lshrrev_b32 v22, 1, v5
    v_xor_b32 v22, v22, v6
    v_lshl_add_u32 v21, v22, 4, v21
    v_xor_b32 v23, 64, v21
    s_mul_i32 s25, s21, 20480
    s_add_u32 s25, s25, 2854912
    v_mov_b32 v10, 0
    v_mov_b32 v11, 0
    v_mov_b32 v12, 0
    v_mov_b32 v13, 0
    s_waitcnt vmcnt(19)
    v_dot2_f32_bf16 v10, v32, v20, v10
    v_dot2_f32_bf16 v11, v32, v32, v11
    v_dot2_f32_bf16 v10, v33, v20, v10
    v_dot2_f32_bf16 v11, v33, v33, v11
    v_dot2_f32_bf16 v10, v34, v20, v10
    v_dot2_f32_bf16 v11, v34, v34, v11
    v_dot2_f32_bf16 v10, v35, v20, v10
    v_dot2_f32_bf16 v11, v35, v35, v11
    v_mov_b32 v120, v32
    v_mov_b32 v121, v33
    v_mov_b32 v122, v34
    v_mov_b32 v123, v35
    v_mov_b32_dpp v120, v34 row_ror:8 row_mask:0xf bank_mask:0xc
    v_mov_b32_dpp v121, v35 row_ror:8 row_mask:0xf bank_mask:0xc
    v_mov_b32_dpp v122, v32 row_ror:8 row_mask:0xf bank_mask:0x3
    v_mov_b32_dpp v123, v33 row_ror:8 row_mask:0xf bank_mask:0x3
    s_add_u32 s26, s25, 0
    buffer_store_dwordx4 v[120:123], v21, s[28:31], s26 offen sc1
    s_waitcnt vmcnt(19)
    v_dot2_f32_bf16 v10, v36, v20, v10
    v_dot2_f32_bf16 v11, v36, v36, v11
    v_dot2_f32_bf16 v10, v37, v20, v10
    v_dot2_f32_bf16 v11, v37, v37, v11
    v_dot2_f32_bf16 v10, v38, v20, v10
    v_dot2_f32_bf16 v11, v38, v38, v11
    v_dot2_f32_bf16 v10, v39, v20, v10
    v_dot2_f32_bf16 v11, v39, v39, v11
    v_mov_b32 v124, v36
    v_mov_b32 v125, v37
    v_mov_b32 v126, v38
    v_mov_b32 v127, v39
    v_mov_b32_dpp v124, v38 row_ror:8 row_mask:0xf bank_mask:0xc
    v_mov_b32_dpp v125, v39 row_ror:8 row_mask:0xf bank_mask:0xc
    v_mov_b32_dpp v126, v36 row_ror:8 row_mask:0xf bank_mask:0x3
    v_mov_b32_dpp v127, v37 row_ror:8 row_mask:0xf bank_mask:0x3
    s_add_u32 s26, s25, 2048
    buffer_store_dwordx4 v[124:127], v21, s[28:31], s26 offen sc1
    s_waitcnt vmcnt(19)
    v_dot2_f32_bf16 v10, v40, v20, v10
    v_dot2_f32_bf16 v11, v40, v40, v11
    v_dot2_f32_bf16 v10, v41, v20, v10
    v_dot2_f32_bf16 v11, v41, v41, v11
    v_dot2_f32_bf16 v10, v42, v20, v10
    v_dot2_f32_bf16 v11, v42, v42, v11
    v_dot2_f32_bf16 v10, v43, v20, v10
    v_dot2_f32_bf16 v11, v43, v43, v11
    v_mov_b32 v120, v40
    v_mov_b32 v121, v41
    v_mov_b32 v122, v42
    v_mov_b32 v123, v43
    v_mov_b32_dpp v120, v42 row_ror:8 row_mask:0xf bank_mask:0xc
    v_mov_b32_dpp v121, v43 row_ror:8 row_mask:0xf bank_mask:0xc
    v_mov_b32_dpp v122, v40 row_ror:8 row_mask:0xf bank_mask:0x3
    v_mov_b32_dpp v123, v41 row_ror:8 row_mask:0xf bank_mask:0x3
    s_add_u32 s26, s25, 4096
    buffer_store_dwordx4 v[120:123], v21, s[28:31], s26 offen sc1
    s_waitcnt vmcnt(19)
    v_dot2_f32_bf16 v10, v44, v20, v10
    v_dot2_f32_bf16 v11, v44, v44, v11
    v_dot2_f32_bf16 v10, v45, v20, v10
    v_dot2_f32_bf16 v11, v45, v45, v11
    v_dot2_f32_bf16 v10, v46, v20, v10
    v_dot2_f32_bf16 v11, v46, v46, v11
    v_dot2_f32_bf16 v10, v47, v20, v10
    v_dot2_f32_bf16 v11, v47, v47, v11
    v_mov_b32 v124, v44
    v_mov_b32 v125, v45
    v_mov_b32 v126, v46
    v_mov_b32 v127, v47
    v_mov_b32_dpp v124, v46 row_ror:8 row_mask:0xf bank_mask:0xc
    v_mov_b32_dpp v125, v47 row_ror:8 row_mask:0xf bank_mask:0xc
    v_mov_b32_dpp v126, v44 row_ror:8 row_mask:0xf bank_mask:0x3
    v_mov_b32_dpp v127, v45 row_ror:8 row_mask:0xf bank_mask:0x3
    s_add_u32 s26, s25, 6144
    buffer_store_dwordx4 v[124:127], v21, s[28:31], s26 offen sc1
    s_waitcnt vmcnt(19)
    v_dot2_f32_bf16 v10, v48, v20, v10
    v_dot2_f32_bf16 v11, v48, v48, v11
    v_dot2_f32_bf16 v10, v49, v20, v10
    v_dot2_f32_bf16 v11, v49, v49, v11
    v_dot2_f32_bf16 v10, v50, v20, v10
    v_dot2_f32_bf16 v11, v50, v50, v11
    v_dot2_f32_bf16 v10, v51, v20, v10
    v_dot2_f32_bf16 v11, v51, v51, v11
    v_mov_b32 v120, v48
    v_mov_b32 v121, v49
    v_mov_b32 v122, v50
    v_mov_b32 v123, v51
    v_mov_b32_dpp v120, v50 row_ror:8 row_mask:0xf bank_mask:0xc
    v_mov_b32_dpp v121, v51 row_ror:8 row_mask:0xf bank_mask:0xc
    v_mov_b32_dpp v122, v48 row_ror:8 row_mask:0xf bank_mask:0x3
    v_mov_b32_dpp v123, v49 row_ror:8 row_mask:0xf bank_mask:0x3
    s_add_u32 s26, s25, 8192
    buffer_store_dwordx4 v[120:123], v21, s[28:31], s26 offen sc1
    s_waitcnt vmcnt(19)
    v_dot2_f32_bf16 v10, v52, v20, v10
    v_dot2_f32_bf16 v11, v52, v52, v11
    v_dot2_f32_bf16 v10, v53, v20, v10
    v_dot2_f32_bf16 v11, v53, v53, v11
    v_dot2_f32_bf16 v10, v54, v20, v10
    v_dot2_f32_bf16 v11, v54, v54, v11
    v_dot2_f32_bf16 v10, v55, v20, v10
    v_dot2_f32_bf16 v11, v55, v55, v11
    v_mov_b32 v124, v52
    v_mov_b32 v125, v53
    v_mov_b32 v126, v54
    v_mov_b32 v127, v55
    v_mov_b32_dpp v124, v54 row_ror:8 row_mask:0xf bank_mask:0xc
    v_mov_b32_dpp v125, v55 row_ror:8 row_mask:0xf bank_mask:0xc
    v_mov_b32_dpp v126, v52 row_ror:8 row_mask:0xf bank_mask:0x3
    v_mov_b32_dpp v127, v53 row_ror:8 row_mask:0xf bank_mask:0x3
    s_add_u32 s26, s25, 10240
    buffer_store_dwordx4 v[124:127], v21, s[28:31], s26 offen sc1
    s_waitcnt vmcnt(19)
    v_dot2_f32_bf16 v10, v56, v20, v10
    v_dot2_f32_bf16 v11, v56, v56, v11
    v_dot2_f32_bf16 v10, v57, v20, v10
    v_dot2_f32_bf16 v11, v57, v57, v11
    v_dot2_f32_bf16 v10, v58, v20, v10
    v_dot2_f32_bf16 v11, v58, v58, v11
    v_dot2_f32_bf16 v10, v59, v20, v10
    v_dot2_f32_bf16 v11, v59, v59, v11
    v_mov_b32 v120, v56
    v_mov_b32 v121, v57
    v_mov_b32 v122, v58
    v_mov_b32 v123, v59
    v_mov_b32_dpp v120, v58 row_ror:8 row_mask:0xf bank_mask:0xc
    v_mov_b32_dpp v121, v59 row_ror:8 row_mask:0xf bank_mask:0xc
    v_mov_b32_dpp v122, v56 row_ror:8 row_mask:0xf bank_mask:0x3
    v_mov_b32_dpp v123, v57 row_ror:8 row_mask:0xf bank_mask:0x3
    s_add_u32 s26, s25, 12288
    buffer_store_dwordx4 v[120:123], v21, s[28:31], s26 offen sc1
    s_waitcnt vmcnt(19)
    v_dot2_f32_bf16 v10, v60, v20, v10
    v_dot2_f32_bf16 v11, v60, v60, v11
    v_dot2_f32_bf16 v10, v61, v20, v10
    v_dot2_f32_bf16 v11, v61, v61, v11
    v_dot2_f32_bf16 v10, v62, v20, v10
    v_dot2_f32_bf16 v11, v62, v62, v11
    v_dot2_f32_bf16 v10, v63, v20, v10
    v_dot2_f32_bf16 v11, v63, v63, v11
    v_mov_b32 v124, v60
    v_mov_b32 v125, v61
    v_mov_b32 v126, v62
    v_mov_b32 v127, v63
    v_mov_b32_dpp v124, v62 row_ror:8 row_mask:0xf bank_mask:0xc
    v_mov_b32_dpp v125, v63 row_ror:8 row_mask:0xf bank_mask:0xc
    v_mov_b32_dpp v126, v60 row_ror:8 row_mask:0xf bank_mask:0x3
    v_mov_b32_dpp v127, v61 row_ror:8 row_mask:0xf bank_mask:0x3
    s_add_u32 s26, s25, 14336
    buffer_store_dwordx4 v[124:127], v21, s[28:31], s26 offen sc1
    s_waitcnt vmcnt(19)
    v_dot2_f32_bf16 v10, v64, v20, v10
    v_dot2_f32_bf16 v11, v64, v64, v11
    v_dot2_f32_bf16 v10, v65, v20, v10
    v_dot2_f32_bf16 v11, v65, v65, v11
    v_dot2_f32_bf16 v10, v66, v20, v10
    v_dot2_f32_bf16 v11, v66, v66, v11
    v_dot2_f32_bf16 v10, v67, v20, v10
    v_dot2_f32_bf16 v11, v67, v67, v11
    v_mov_b32 v120, v64
    v_mov_b32 v121, v65
    v_mov_b32 v122, v66
    v_mov_b32 v123, v67
    v_mov_b32_dpp v120, v66 row_ror:8 row_mask:0xf bank_mask:0xc
    v_mov_b32_dpp v121, v67 row_ror:8 row_mask:0xf bank_mask:0xc
    v_mov_b32_dpp v122, v64 row_ror:8 row_mask:0xf bank_mask:0x3
    v_mov_b32_dpp v123, v65 row_ror:8 row_mask:0xf bank_mask:0x3
    s_add_u32 s26, s25, 16384
    buffer_store_dwordx4 v[120:123], v21, s[28:31], s26 offen sc1
    s_waitcnt vmcnt(19)
    v_dot2_f32_bf16 v10, v68, v20, v10
    v_dot2_f32_bf16 v11, v68, v68, v11
    v_dot2_f32_bf16 v10, v69, v20, v10
    v_dot2_f32_bf16 v11, v69, v69, v11
    v_dot2_f32_bf16 v10, v70, v20, v10
    v_dot2_f32_bf16 v11, v70, v70, v11
    v_dot2_f32_bf16 v10, v71, v20, v10
    v_dot2_f32_bf16 v11, v71, v71, v11
    v_mov_b32 v124, v68
    v_mov_b32 v125, v69
    v_mov_b32 v126, v70
    v_mov_b32 v127, v71
    v_mov_b32_dpp v124, v70 row_ror:8 row_mask:0xf bank_mask:0xc
    v_mov_b32_dpp v125, v71 row_ror:8 row_mask:0xf bank_mask:0xc
    v_mov_b32_dpp v126, v68 row_ror:8 row_mask:0xf bank_mask:0x3
    v_mov_b32_dpp v127, v69 row_ror:8 row_mask:0xf bank_mask:0x3
    s_add_u32 s26, s25, 18432
    buffer_store_dwordx4 v[124:127], v21, s[28:31], s26 offen sc1
    s_waitcnt vmcnt(19)
    v_dot2_f32_bf16 v12, v72, v20, v12
    v_dot2_f32_bf16 v13, v72, v72, v13
    v_dot2_f32_bf16 v12, v73, v20, v12
    v_dot2_f32_bf16 v13, v73, v73, v13
    v_dot2_f32_bf16 v12, v74, v20, v12
    v_dot2_f32_bf16 v13, v74, v74, v13
    v_dot2_f32_bf16 v12, v75, v20, v12
    v_dot2_f32_bf16 v13, v75, v75, v13
    v_mov_b32 v120, v72
    v_mov_b32 v121, v73
    v_mov_b32 v122, v74
    v_mov_b32 v123, v75
    v_mov_b32_dpp v120, v74 row_ror:8 row_mask:0xf bank_mask:0xc
    v_mov_b32_dpp v121, v75 row_ror:8 row_mask:0xf bank_mask:0xc
    v_mov_b32_dpp v122, v72 row_ror:8 row_mask:0xf bank_mask:0x3
    v_mov_b32_dpp v123, v73 row_ror:8 row_mask:0xf bank_mask:0x3
    s_add_u32 s26, s25, 0
    buffer_store_dwordx4 v[120:123], v23, s[28:31], s26 offen sc1
    s_waitcnt vmcnt(19)
    v_dot2_f32_bf16 v12, v76, v20, v12
    v_dot2_f32_bf16 v13, v76, v76, v13
    v_dot2_f32_bf16 v12, v77, v20, v12
    v_dot2_f32_bf16 v13, v77, v77, v13
    v_dot2_f32_bf16 v12, v78, v20, v12
    v_dot2_f32_bf16 v13, v78, v78, v13
    v_dot2_f32_bf16 v12, v79, v20, v12
    v_dot2_f32_bf16 v13, v79, v79, v13
    v_mov_b32 v124, v76
    v_mov_b32 v125, v77
    v_mov_b32 v126, v78
    v_mov_b32 v127, v79
    v_mov_b32_dpp v124, v78 row_ror:8 row_mask:0xf bank_mask:0xc
    v_mov_b32_dpp v125, v79 row_ror:8 row_mask:0xf bank_mask:0xc
    v_mov_b32_dpp v126, v76 row_ror:8 row_mask:0xf bank_mask:0x3
    v_mov_b32_dpp v127, v77 row_ror:8 row_mask:0xf bank_mask:0x3
    s_add_u32 s26, s25, 2048
    buffer_store_dwordx4 v[124:127], v23, s[28:31], s26 offen sc1
    s_waitcnt vmcnt(19)
    v_dot2_f32_bf16 v12, v80, v20, v12
    v_dot2_f32_bf16 v13, v80, v80, v13
    v_dot2_f32_bf16 v12, v81, v20, v12
    v_dot2_f32_bf16 v13, v81, v81, v13
    v_dot2_f32_bf16 v12, v82, v20, v12
    v_dot2_f32_bf16 v13, v82, v82, v13
    v_dot2_f32_bf16 v12, v83, v20, v12
    v_dot2_f32_bf16 v13, v83, v83, v13
    v_mov_b32 v120, v80
    v_mov_b32 v121, v81
    v_mov_b32 v122, v82
    v_mov_b32 v123, v83
    v_mov_b32_dpp v120, v82 row_ror:8 row_mask:0xf bank_mask:0xc
    v_mov_b32_dpp v121, v83 row_ror:8 row_mask:0xf bank_mask:0xc
    v_mov_b32_dpp v122, v80 row_ror:8 row_mask:0xf bank_mask:0x3
    v_mov_b32_dpp v123, v81 row_ror:8 row_mask:0xf bank_mask:0x3
    s_add_u32 s26, s25, 4096
    buffer_store_dwordx4 v[120:123], v23, s[28:31], s26 offen sc1
    s_waitcnt vmcnt(19)
    v_dot2_f32_bf16 v12, v84, v20, v12
    v_dot2_f32_bf16 v13, v84, v84, v13
    v_dot2_f32_bf16 v12, v85, v20, v12
    v_dot2_f32_bf16 v13, v85, v85, v13
    v_dot2_f32_bf16 v12, v86, v20, v12
    v_dot2_f32_bf16 v13, v86, v86, v13
    v_dot2_f32_bf16 v12, v87, v20, v12
    v_dot2_f32_bf16 v13, v87, v87, v13
    v_mov_b32 v124, v84
    v_mov_b32 v125, v85
    v_mov_b32 v126, v86
    v_mov_b32 v127, v87
    v_mov_b32_dpp v124, v86 row_ror:8 row_mask:0xf bank_mask:0xc
    v_mov_b32_dpp v125, v87 row_ror:8 row_mask:0xf bank_mask:0xc
    v_mov_b32_dpp v126, v84 row_ror:8 row_mask:0xf bank_mask:0x3
    v_mov_b32_dpp v127, v85 row_ror:8 row_mask:0xf bank_mask:0x3
    s_add_u32 s26, s25, 6144
    buffer_store_dwordx4 v[124:127], v23, s[28:31], s26 offen sc1
    s_waitcnt vmcnt(19)
    v_dot2_f32_bf16 v12, v88, v20, v12
    v_dot2_f32_bf16 v13, v88, v88, v13
    v_dot2_f32_bf16 v12, v89, v20, v12
    v_dot2_f32_bf16 v13, v89, v89, v13
    v_dot2_f32_bf16 v12, v90, v20, v12
    v_dot2_f32_bf16 v13, v90, v90, v13
    v_dot2_f32_bf16 v12, v91, v20, v12
    v_dot2_f32_bf16 v13, v91, v91, v13
    v_mov_b32 v120, v88
    v_mov_b32 v121, v89
    v_mov_b32 v122, v90
    v_mov_b32 v123, v91
    v_mov_b32_dpp v120, v90 row_ror:8 row_mask:0xf bank_mask:0xc
    v_mov_b32_dpp v121, v91 row_ror:8 row_mask:0xf bank_mask:0xc
    v_mov_b32_dpp v122, v88 row_ror:8 row_mask:0xf bank_mask:0x3
    v_mov_b32_dpp v123, v89 row_ror:8 row_mask:0xf bank_mask:0x3
    s_add_u32 s26, s25, 8192
    buffer_store_dwordx4 v[120:123], v23, s[28:31], s26 offen sc1
    s_waitcnt vmcnt(19)
    v_dot2_f32_bf16 v12, v92, v20, v12
    v_dot2_f32_bf16 v13, v92, v92, v13
    v_dot2_f32_bf16 v12, v93, v20, v12
    v_dot2_f32_bf16 v13, v93, v93, v13
    v_dot2_f32_bf16 v12, v94, v20, v12
    v_dot2_f32_bf16 v13, v94, v94, v13
    v_dot2_f32_bf16 v12, v95, v20, v12
    v_dot2_f32_bf16 v13, v95, v95, v13
    v_mov_b32 v124, v92
    v_mov_b32 v125, v93
    v_mov_b32 v126, v94
    v_mov_b32 v127, v95
    v_mov_b32_dpp v124, v94 row_ror:8 row_mask:0xf bank_mask:0xc
    v_mov_b32_dpp v125, v95 row_ror:8 row_mask:0xf bank_mask:0xc
    v_mov_b32_dpp v126, v92 row_ror:8 row_mask:0xf bank_mask:0x3
    v_mov_b32_dpp v127, v93 row_ror:8 row_mask:0xf bank_mask:0x3
    s_add_u32 s26, s25, 10240
    buffer_store_dwordx4 v[124:127], v23, s[28:31], s26 offen sc1
    s_waitcnt vmcnt(19)
    v_dot2_f32_bf16 v12, v96, v20, v12
    v_dot2_f32_bf16 v13, v96, v96, v13
    v_dot2_f32_bf16 v12, v97, v20, v12
    v_dot2_f32_bf16 v13, v97, v97, v13
    v_dot2_f32_bf16 v12, v98, v20, v12
    v_dot2_f32_bf16 v13, v98, v98, v13
    v_dot2_f32_bf16 v12, v99, v20, v12
    v_dot2_f32_bf16 v13, v99, v99, v13
    v_mov_b32 v120, v96
    v_mov_b32 v121, v97
    v_mov_b32 v122, v98
    v_mov_b32 v123, v99
    v_mov_b32_dpp v120, v98 row_ror:8 row_mask:0xf bank_mask:0xc
    v_mov_b32_dpp v121, v99 row_ror:8 row_mask:0xf bank_mask:0xc
    v_mov_b32_dpp v122, v96 row_ror:8 row_mask:0xf bank_mask:0x3
    v_mov_b32_dpp v123, v97 row_ror:8 row_mask:0xf bank_mask:0x3
    s_add_u32 s26, s25, 12288
    buffer_store_dwordx4 v[120:123], v23, s[28:31], s26 offen sc1
    s_waitcnt vmcnt(19)
    v_dot2_f32_bf16 v12, v100, v20, v12
    v_dot2_f32_bf16 v13, v100, v100, v13
    v_dot2_f32_bf16 v12, v101, v20, v12
    v_dot2_f32_bf16 v13, v101, v101, v13
    v_dot2_f32_bf16 v12, v102, v20, v12
    v_dot2_f32_bf16 v13, v102, v102, v13
    v_dot2_f32_bf16 v12, v103, v20, v12
    v_dot2_f32_bf16 v13, v103, v103, v13
    v_mov_b32 v124, v100
    v_mov_b32 v125, v101
    v_mov_b32 v126, v102
    v_mov_b32 v127, v103
    v_mov_b32_dpp v124, v102 row_ror:8 row_mask:0xf bank_mask:0xc
    v_mov_b32_dpp v125, v103 row_ror:8 row_mask:0xf bank_mask:0xc
    v_mov_b32_dpp v126, v100 row_ror:8 row_mask:0xf bank_mask:0x3
    v_mov_b32_dpp v127, v101 row_ror:8 row_mask:0xf bank_mask:0x3
    s_add_u32 s26, s25, 14336
    buffer_store_dwordx4 v[124:127], v23, s[28:31], s26 offen sc1
    s_waitcnt vmcnt(19)
    v_dot2_f32_bf16 v12, v104, v20, v12
    v_dot2_f32_bf16 v13, v104, v104, v13
    v_dot2_f32_bf16 v12, v105, v20, v12
    v_dot2_f32_bf16 v13, v105, v105, v13
    v_dot2_f32_bf16 v12, v106, v20, v12
    v_dot2_f32_bf16 v13, v106, v106, v13
    v_dot2_f32_bf16 v12, v107, v20, v12
    v_dot2_f32_bf16 v13, v107, v107, v13
    v_mov_b32 v120, v104
    v_mov_b32 v121, v105
    v_mov_b32 v122, v106
    v_mov_b32 v123, v107
    v_mov_b32_dpp v120, v106 row_ror:8 row_mask:0xf bank_mask:0xc
    v_mov_b32_dpp v121, v107 row_ror:8 row_mask:0xf bank_mask:0xc
    v_mov_b32_dpp v122, v104 row_ror:8 row_mask:0xf bank_mask:0x3
    v_mov_b32_dpp v123, v105 row_ror:8 row_mask:0xf bank_mask:0x3
    s_add_u32 s26, s25, 16384
    buffer_store_dwordx4 v[120:123], v23, s[28:31], s26 offen sc1
    s_waitcnt vmcnt(19)
    v_dot2_f32_bf16 v12, v108, v20, v12
    v_dot2_f32_bf16 v13, v108, v108, v13
    v_dot2_f32_bf16 v12, v109, v20, v12
    v_dot2_f32_bf16 v13, v109, v109, v13
    v_dot2_f32_bf16 v12, v110, v20, v12
    v_dot2_f32_bf16 v13, v110, v110, v13
    v_dot2_f32_bf16 v12, v111, v20, v12
    v_dot2_f32_bf16 v13, v111, v111, v13
    v_mov_b32 v124, v108
    v_mov_b32 v125, v109
    v_mov_b32 v126, v110
    v_mov_b32 v127, v111
    v_mov_b32_dpp v124, v110 row_ror:8 row_mask:0xf bank_mask:0xc
    v_mov_b32_dpp v125, v111 row_ror:8 row_mask:0xf bank_mask:0xc
    v_mov_b32_dpp v126, v108 row_ror:8 row_mask:0xf bank_mask:0x3
    v_mov_b32_dpp v127, v109 row_ror:8 row_mask:0xf bank_mask:0x3
    s_add_u32 s26, s25, 18432
    buffer_store_dwordx4 v[124:127], v23, s[28:31], s26 offen sc1
    s_nop 2
    v_add_f32_dpp v10, v10, v10 quad_perm:[1,0,3,2] row_mask:0xf bank_mask:0xf
    v_add_f32_dpp v11, v11, v11 quad_perm:[1,0,3,2] row_mask:0xf bank_mask:0xf
    v_add_f32_dpp v12, v12, v12 quad_perm:[1,0,3,2] row_mask:0xf bank_mask:0xf
    v_add_f32_dpp v13, v13, v13 quad_perm:[1,0,3,2] row_mask:0xf bank_mask:0xf
    v_add_f32_dpp v10, v10, v10 quad_perm:[2,3,0,1] row_mask:0xf bank_mask:0xf
    v_add_f32_dpp v11, v11, v11 quad_perm:[2,3,0,1] row_mask:0xf bank_mask:0xf
    v_add_f32_dpp v12, v12, v12 quad_perm:[2,3,0,1] row_mask:0xf bank_mask:0xf
    v_add_f32_dpp v13, v13, v13 quad_perm:[2,3,0,1] row_mask:0xf bank_mask:0xf
    v_add_f32_dpp v10, v10, v10 row_half_mirror row_mask:0xf bank_mask:0xf
    v_add_f32_dpp v11, v11, v11 row_half_mirror row_mask:0xf bank_mask:0xf
    v_add_f32_dpp v12, v12, v12 row_half_mirror row_mask:0xf bank_mask:0xf
    v_add_f32_dpp v13, v13, v13 row_half_mirror row_mask:0xf bank_mask:0xf
    v_mul_f32 v10, 0x3acccccd, v10
    v_mul_f32 v12, 0x3acccccd, v12
    v_mul_f32 v11, 0x3acccccd, v11
    v_mul_f32 v13, 0x3acccccd, v13
    v_fma_f32 v11, -v10, v10, v11
    v_fma_f32 v13, -v12, v12, v13
    v_max_f32 v11, 0, v11
    v_max_f32 v13, 0, v13
    v_cvt_pk_bf16_f32 v24, v10, v11
    v_cvt_pk_bf16_f32 v25, v12, v13
    v_lshlrev_b32 v10, 16, v24
    v_lshlrev_b32 v12, 16, v25
    v_and_b32 v11, 0xffff0000, v24
    v_and_b32 v13, 0xffff0000, v25
    v_add_f32 v11, 0x3727c5ac, v11
    v_add_f32 v13, 0x3727c5ac, v13
    v_cvt_pk_bf16_f32 v24, v11, v11
    v_cvt_pk_bf16_f32 v25, v13, v13
    v_lshlrev_b32 v11, 16, v24
    v_lshlrev_b32 v13, 16, v25
    v_sqrt_f32 v11, v11
    v_sqrt_f32 v13, v13
    s_nop 0
    s_nop 0
    v_cvt_pk_bf16_f32 v24, v11, v11
    v_cvt_pk_bf16_f32 v25, v13, v13
    v_lshlrev_b32 v11, 16, v24
    v_lshlrev_b32 v13, 16, v25
    v_rcp_f32 v11, v11
    v_rcp_f32 v13, v13
    s_nop 0
    s_nop 0
    v_mul_f32 v10, v10, v11
    v_mul_f32 v12, v12, v13
    v_sub_f32 v10, 0, v10
    v_sub_f32 v12, 0, v12
    v_lshlrev_b32 v7, 3, v7
    v_cmp_eq_u32 vcc, 0, v6
    s_mov_b32 s23, 5476352
    s_and_saveexec_b64 s[66:67], vcc
    buffer_store_dwordx2 v[10:11], v7, s[28:31], s23 offen offset:0 sc1
    buffer_store_dwordx2 v[12:13], v7, s[28:31], s23 offen offset:64 sc1
    s_endpgm
p_misc:
    s_lshr_b32 s22, s21, 3
    s_mov_b32 s23, s21
    s_cmp_eq_u32 s20, 2
    s_cbranch_scc1 k0_kernel_m33
    s_cmp_ge_u32 s21, 64
    s_cbranch_scc1 k0_end
    s_add_u32 s22, s22, 24
    s_add_u32 s23, s23, 192
k0_kernel_m33:
    v_lshlrev_b32 v1, 4, v1
    v_mov_b32 v60, 0
    v_mov_b32 v61, 0
    v_mov_b32 v62, 0
    v_mov_b32 v63, 0
    s_lshl_b32 s24, s23, 10
    s_add_u32 s25, s24, 29380608
    s_add_u32 s26, s24, 10784768
    s_add_u32 s27, s24, 13365248
    s_cmp_ge_u32 s23, 20
    s_cselect_b32 s26, s27, s26
    s_cmp_ge_u32 s23, 256
    s_cbranch_scc1 k0_kernel_nz4
    buffer_store_dwordx4 v[60:63], v1, s[28:31], s25 offen sc1
k0_kernel_nz4:
    s_cmp_ge_u32 s23, 40
    s_cbranch_scc1 k0_kernel_nz5
    buffer_store_dwordx4 v[60:63], v1, s[28:31], s26 offen sc1
k0_kernel_nz5:
    s_mov_b32 s16, s56
    s_mov_b32 s17, s57
    s_mov_b32 s18, 2621440
    s_mov_b32 s19, 0x00020000
    s_and_b32 s24, s2, 7
    s_mul_i32 s24, s24, 327680
    s_mul_i32 s21, s22, 10240
    s_add_u32 s21, s21, s24
    buffer_load_dwordx4 v[8:11], v1, s[16:19], s21 offen offset:0 nt
    buffer_load_dwordx4 v[12:15], v1, s[16:19], s21 offen offset:1024 nt
    buffer_load_dwordx4 v[16:19], v1, s[16:19], s21 offen offset:2048 nt
    buffer_load_dwordx4 v[20:23], v1, s[16:19], s21 offen offset:3072 nt
    s_add_u32 s21, s21, 4096
    buffer_load_dwordx4 v[24:27], v1, s[16:19], s21 offen offset:0 nt
    buffer_load_dwordx4 v[28:31], v1, s[16:19], s21 offen offset:1024 nt
    buffer_load_dwordx4 v[32:35], v1, s[16:19], s21 offen offset:2048 nt
    buffer_load_dwordx4 v[36:39], v1, s[16:19], s21 offen offset:3072 nt
    s_add_u32 s21, s21, 4096
    buffer_load_dwordx4 v[40:43], v1, s[16:19], s21 offen offset:0 nt
    buffer_load_dwordx4 v[44:47], v1, s[16:19], s21 offen offset:1024 nt
    s_getpc_b64 s[24:25]
k0_pcref:
    s_sub_u32 s24, s24, k0_pcref-k0_kernel
    s_subb_u32 s25, s25, 0
    s_lshl_b32 s23, s22, 11
    s_add_u32 s26, s23, 0
    s_min_u32 s26, s26, (chain_end-k0_kernel-1020)&0xfffffff0
    v_add_u32 v64, s26, v1
    v_mov_b32 v5, s25
    v_add_co_u32 v4, vcc, s24, v64
    v_addc_co_u32 v5, vcc, 0, v5, vcc
    global_load_dwordx4 v[72:75], v[4:5], off
    s_add_u32 s26, s23, 1024
    s_min_u32 s26, s26, (chain_end-k0_kernel-1020)&0xfffffff0
    v_add_u32 v64, s26, v1
    v_mov_b32 v5, s25
    v_add_co_u32 v4, vcc, s24, v64
    v_addc_co_u32 v5, vcc, 0, v5, vcc
    global_load_dwordx4 v[76:79], v[4:5], off
    s_waitcnt vmcnt(0)
    s_endpgm
.globl k1_kernel
.p2align 8
.type k1_kernel,@function
k1_kernel:
    s_cmp_ge_u32 s2, 256
    s_cbranch_scc1 k1_end
    s_load_dwordx4 s[4:7], s[0:1], 32
    s_load_dwordx2 s[10:11], s[0:1], 120
    s_load_dwordx8 s[12:19], s[0:1], 56
    s_load_dwordx2 s[60:61], s[0:1], 0
    s_load_dwordx2 s[62:63], s[0:1], 96
    s_load_dwordx2 s[52:53], s[0:1], 88
    v_lshrrev_b32 v2, 6, v0
    v_and_b32 v1, 63, v0
    v_readfirstlane_b32 s20, v2
    s_and_b32 s58, s2, 7
    s_lshr_b32 s59, s2, 3
    s_waitcnt lgkmcnt(0)
    s_mov_b32 s28, s10
    s_mov_b32 s29, s11
    s_mov_b32 s30, 268435456
    s_mov_b32 s31, 0x00020000
    s_mov_b32 s46, 1
    s_cmp_ge_u32 s59, 20
    s_cbranch_scc1 k1_help
    s_mul_i32 s2, s58, 20
    s_add_u32 s2, s2, s59
    s_setprio 3
    s_mov_b32 s24, s4
    s_mov_b32 s25, s5
    s_mov_b32 s26, 2621440
    s_mov_b32 s27, 0x00020000
    s_lshl_b32 s21, s2, 3
    s_add_u32 s22, s6, s21
    s_addc_u32 s23, s7, 0
    s_load_dwordx2 s[32:33], s[22:23], 0
    s_lshl_b32 s21, s2, 2
    s_add_u32 s21, s21, s20
    s_mul_i32 s34, s20, 9472
    v_lshlrev_b32 v3, 4, v1
    s_lshl_b32 s35, s21, 12
    s_add_u32 s36, s34, 256
    s_mov_b32 m0, s36
    s_mul_i32 s37, s21, 4352
    s_add_u32 s37, s37, 0
    buffer_load_dwordx4 v3, s[24:27], s35 offen offset:0 lds
    buffer_load_dwordx4 v3, s[24:27], s35 offen offset:1024 lds
    buffer_load_dwordx4 v3, s[24:27], s35 offen offset:2048 lds
    buffer_load_dwordx4 v3, s[24:27], s35 offen offset:3072 lds
    v_lshrrev_b32 v4, 3, v0
    v_mul_u32_u24 v4, 20480, v4
    s_lshr_b32 s38, s2, 1
    s_and_b32 s38, s38, 7
    v_and_b32 v5, 7, v0
    v_xor_b32 v5, s38, v5
    v_lshl_add_u32 v4, v5, 4, v4
    s_lshl_b32 s38, s2, 7
    s_add_u32 s36, s34, 4352
    s_mov_b32 m0, s36
    s_nop 0
    buffer_load_dwordx4 v3, s[28:31], s37 offen offset:0 lds
    buffer_load_dwordx4 v3, s[28:31], s37 offen offset:1024 lds
    buffer_load_dwordx4 v3, s[28:31], s37 offen offset:2048 lds
    buffer_load_dwordx4 v3, s[28:31], s37 offen offset:3072 lds
    s_add_u32 s36, s34, 8448
    s_mov_b32 m0, s36
    s_add_u32 s37, s37, 4096
    buffer_load_dwordx4 v3, s[28:31], s37 offen lds
    s_lshl_b32 s22, s2, 4
    s_add_u32 s22, s22, 2793472
    s_add_u32 s22, s10, s22
    s_addc_u32 s23, s11, 0
    s_load_dwordx4 s[68:71], s[22:23], 0
    s_load_dwordx4 s[72:75], s[22:23], 2560
    s_load_dwordx4 s[76:79], s[22:23], 5120
    s_load_dwordx4 s[80:83], s[22:23], 15360
    s_load_dwordx4 s[84:87], s[22:23], 17920
    s_load_dwordx4 s[12:15], s[22:23], 20480
    s_load_dwordx4 s[16:19], s[22:23], 30720
    s_load_dwordx4 s[48:51], s[22:23], 33280
    s_load_dwordx4 s[52:55], s[22:23], 35840
    s_load_dwordx4 s[56:59], s[22:23], 46080
    s_load_dwordx4 s[60:63], s[22:23], 48640
    s_load_dwordx4 s[64:67], s[22:23], 51200
    v_lshl_add_u32 v5, v1, 2, s34
    v_mov_b32 v6, 0
    ds_write_b32 v5, v6
    v_and_b32 v7, 15, v1
    v_bfe_u32 v8, v1, 4, 1
    v_lshrrev_b32 v9, 5, v1
    v_mul_u32_u24 v10, 272, v7
    v_lshl_add_u32 v10, v9, 4, v10
    v_add_u32 v10, s34, v10
    v_add_u32 v10, 4356, v10
    v_lshlrev_b32 v11, 2, v8
    v_sub_u32 v10, v10, v11
    v_and_b32 v12, 7, v1
    v_mul_u32_u24 v13, 272, v12
    v_lshl_add_u32 v13, v9, 4, v13
    v_add_u32 v13, s34, v13
    v_add_u32 v13, 4356, v13
    v_sub_u32 v13, v13, v11
    v_bfe_u32 v11, v1, 3, 1
    v_lshlrev_b32 v11, 4, v11
    v_sub_u32 v11, 16, v11
    v_and_b32 v14, 31, v1
    v_lshlrev_b32 v14, 3, v14
    v_lshl_add_u32 v14, v9, 4, v14
    v_add_u32 v14, s34, v14
    v_add_u32 v14, 8, v14
    v_cmp_ne_u32 vcc, 0, v12
    v_mov_b32 v16, 0
    s_nop 1
    v_cndmask_b32 v15, v16, -1, vcc
    s_waitcnt vmcnt(0) lgkmcnt(0)
    ds_read_b64 v[176:177], v14 offset:1792
    ds_read_b64 v[178:179], v14 offset:1800
    ds_read_b64 v[180:181], v14 offset:1824
    ds_read_b64 v[182:183], v14 offset:1832
    ds_read_b64 v[184:185], v14 offset:1856
    ds_read_b64 v[186:187], v14 offset:1864
    ds_read_b64 v[188:189], v14 offset:1888
    ds_read_b64 v[190:191], v14 offset:1896
    ds_read_b64 v[192:193], v14 offset:1920
    ds_read_b64 v[194:195], v14 offset:1928
    ds_read_b64 v[196:197], v14 offset:1952
    ds_read_b64 v[198:199], v14 offset:1960
    ds_read_b64 v[200:201], v14 offset:1984
    ds_read_b64 v[202:203], v14 offset:1992
    ds_read_b64 v[204:205], v14 offset:2016
    ds_read_b64 v[206:207], v14 offset:2024
    ds_read2_b32 v[64:65], v10 offset0:0 offset1:1
    ds_read2_b32 v[66:67], v10 offset0:2 offset1:3
    ds_read2_b32 v[68:69], v10 offset0:8 offset1:9
    ds_read2_b32 v[70:71], v10 offset0:10 offset1:11
    ds_read2_b32 v[72:73], v10 offset0:16 offset1:17
    ds_read2_b32 v[74:75], v10 offset0:18 offset1:19
    ds_read2_b32 v[76:77], v10 offset0:24 offset1:25
    ds_read2_b32 v[78:79], v10 offset0:26 offset1:27
    ds_read2_b32 v[80:81], v10 offset0:32 offset1:33
    ds_read2_b32 v[82:83], v10 offset0:34 offset1:35
    ds_read2_b32 v[84:85], v10 offset0:40 offset1:41
    ds_read2_b32 v[86:87], v10 offset0:42 offset1:43
    ds_read2_b32 v[88:89], v10 offset0:48 offset1:49
    ds_read2_b32 v[90:91], v10 offset0:50 offset1:51
    ds_read2_b32 v[92:93], v10 offset0:56 offset1:57
    ds_read2_b32 v[94:95], v10 offset0:58 offset1:59
    s_waitcnt lgkmcnt(0)
    v_mfma_f32_32x32x16_bf16 v[144:159], v[176:179], v[64:67], 0
    ds_read_b32 v16, v10 offset:16
    ds_read_b32 v17, v10 offset:48
    ds_read_b32 v18, v10 offset:80
    ds_read_b32 v19, v10 offset:112
    ds_read_b32 v20, v10 offset:144
    ds_read_b32 v21, v10 offset:176
    ds_read_b32 v22, v10 offset:208
    ds_read_b32 v23, v10 offset:240
    ds_read2_b32 v[96:97], v13 offset0:0 offset1:1
    ds_read2_b32 v[98:99], v13 offset0:2 offset1:3
    ds_read_b32 v24, v13 offset:16
    ds_read2_b32 v[100:101], v13 offset0:8 offset1:9
    ds_read2_b32 v[102:103], v13 offset0:10 offset1:11
    ds_read_b32 v25, v13 offset:48
    ds_read2_b32 v[104:105], v13 offset0:16 offset1:17
    ds_read2_b32 v[106:107], v13 offset0:18 offset1:19
    v_mfma_f32_32x32x16_bf16 v[144:159], v[180:183], v[68:71], v[144:159]
    ds_read_b32 v26, v13 offset:80
    ds_read2_b32 v[108:109], v13 offset0:24 offset1:25
    ds_read2_b32 v[110:111], v13 offset0:26 offset1:27
    ds_read_b32 v27, v13 offset:112
    ds_read2_b32 v[112:113], v13 offset0:32 offset1:33
    ds_read2_b32 v[114:115], v13 offset0:34 offset1:35
    ds_read_b32 v28, v13 offset:144
    ds_read2_b32 v[116:117], v13 offset0:40 offset1:41
    ds_read2_b32 v[118:119], v13 offset0:42 offset1:43
    ds_read_b32 v29, v13 offset:176
    ds_read2_b32 v[120:121], v13 offset0:48 offset1:49
    ds_read2_b32 v[122:123], v13 offset0:50 offset1:51
    ds_read_b32 v30, v13 offset:208
    ds_read2_b32 v[124:125], v13 offset0:56 offset1:57
    ds_read2_b32 v[126:127], v13 offset0:58 offset1:59
    ds_read_b32 v31, v13 offset:240
    v_mfma_f32_32x32x16_bf16 v[144:159], v[184:187], v[72:75], v[144:159]
    s_waitcnt lgkmcnt(15)
    s_waitcnt lgkmcnt(0)
    v_alignbit_b32 v32, v65, v64, 16
    v_alignbit_b32 v33, v66, v65, 16
    v_alignbit_b32 v34, v67, v66, 16
    v_alignbit_b32 v35, v16, v67, 16
    v_mfma_f32_32x32x16_bf16 v[144:159], v[188:191], v[76:79], v[144:159]
    v_alignbit_b32 v36, v69, v68, 16
    v_alignbit_b32 v37, v70, v69, 16
    v_alignbit_b32 v38, v71, v70, 16
    v_alignbit_b32 v39, v17, v71, 16
    v_alignbit_b32 v40, v73, v72, 16
    v_alignbit_b32 v41, v74, v73, 16
    v_mfma_f32_32x32x16_bf16 v[144:159], v[192:195], v[80:83], v[144:159]
    v_alignbit_b32 v42, v75, v74, 16
    v_alignbit_b32 v43, v18, v75, 16
    v_alignbit_b32 v44, v77, v76, 16
    v_alignbit_b32 v45, v78, v77, 16
    v_alignbit_b32 v46, v79, v78, 16
    v_alignbit_b32 v47, v19, v79, 16
    v_mfma_f32_32x32x16_bf16 v[144:159], v[196:199], v[84:87], v[144:159]
    v_alignbit_b32 v48, v81, v80, 16
    v_alignbit_b32 v49, v82, v81, 16
    v_alignbit_b32 v50, v83, v82, 16
    v_alignbit_b32 v51, v20, v83, 16
    v_alignbit_b32 v52, v85, v84, 16
    v_alignbit_b32 v53, v86, v85, 16
    v_mfma_f32_32x32x16_bf16 v[144:159], v[200:203], v[88:91], v[144:159]
    v_alignbit_b32 v54, v87, v86, 16
    v_alignbit_b32 v55, v21, v87, 16
    v_alignbit_b32 v56, v89, v88, 16
    v_alignbit_b32 v57, v90, v89, 16
    v_alignbit_b32 v58, v91, v90, 16
    v_alignbit_b32 v59, v22, v91, 16
    v_mfma_f32_32x32x16_bf16 v[144:159], v[204:207], v[92:95], v[144:159]
    v_alignbit_b32 v60, v93, v92, 16
    v_alignbit_b32 v61, v94, v93, 16
    v_alignbit_b32 v62, v95, v94, 16
    v_alignbit_b32 v63, v23, v95, 16
    s_nop 0
    v_mfma_f32_32x32x16_bf16 v[128:143], v[176:179], v[32:35], 0
    ds_read_b64 v[208:209], v14 offset:3840
    ds_read_b64 v[210:211], v14 offset:3848
    s_nop 2
    v_mfma_f32_32x32x16_bf16 v[128:143], v[180:183], v[36:39], v[128:143]
    ds_read_b64 v[212:213], v14 offset:3872
    ds_read_b64 v[214:215], v14 offset:3880
    s_nop 2
    v_mfma_f32_32x32x16_bf16 v[128:143], v[184:187], v[40:43], v[128:143]
    ds_read_b64 v[216:217], v14 offset:3904
    ds_read_b64 v[218:219], v14 offset:3912
    v_alignbit_b32 v96, v97, v96, v11
    v_alignbit_b32 v97, v98, v97, v11
    v_alignbit_b32 v98, v99, v98, v11
    v_alignbit_b32 v99, v24, v99, v11
    v_alignbit_b32 v100, v101, v100, v11
    v_alignbit_b32 v101, v102, v101, v11
    v_alignbit_b32 v102, v103, v102, v11
    v_alignbit_b32 v103, v25, v103, v11
    v_alignbit_b32 v104, v105, v104, v11
    v_mfma_f32_32x32x16_bf16 v[128:143], v[188:191], v[44:47], v[128:143]
    ds_read_b64 v[220:221], v14 offset:3936
    ds_read_b64 v[222:223], v14 offset:3944
    v_alignbit_b32 v105, v106, v105, v11
    v_alignbit_b32 v106, v107, v106, v11
    v_alignbit_b32 v107, v26, v107, v11
    v_alignbit_b32 v108, v109, v108, v11
    v_alignbit_b32 v109, v110, v109, v11
    v_alignbit_b32 v110, v111, v110, v11
    v_alignbit_b32 v111, v27, v111, v11
    v_mov_b32_dpp v144, v144 row_shr:1 row_mask:0xf bank_mask:0xf bound_ctrl:0
    v_mfma_f32_32x32x16_bf16 v[128:143], v[192:195], v[48:51], v[128:143]
    ds_read_b64 v[224:225], v14 offset:3968
    ds_read_b64 v[226:227], v14 offset:3976
    v_mov_b32_dpp v145, v145 row_shr:1 row_mask:0xf bank_mask:0xf bound_ctrl:0
    v_mov_b32_dpp v146, v146 row_shr:1 row_mask:0xf bank_mask:0xf bound_ctrl:0
    v_mov_b32_dpp v147, v147 row_shr:1 row_mask:0xf bank_mask:0xf bound_ctrl:0
    v_mov_b32_dpp v148, v148 row_shr:1 row_mask:0xf bank_mask:0xf bound_ctrl:0
    v_mov_b32_dpp v149, v149 row_shr:1 row_mask:0xf bank_mask:0xf bound_ctrl:0
    v_mov_b32_dpp v150, v150 row_shr:1 row_mask:0xf bank_mask:0xf bound_ctrl:0
    v_mov_b32_dpp v151, v151 row_shr:1 row_mask:0xf bank_mask:0xf bound_ctrl:0
    v_mov_b32_dpp v152, v152 row_shr:1 row_mask:0xf bank_mask:0xf bound_ctrl:0
    v_mfma_f32_32x32x16_bf16 v[128:143], v[196:199], v[52:55], v[128:143]
    ds_read_b64 v[228:229], v14 offset:4000
    ds_read_b64 v[230:231], v14 offset:4008
    v_mov_b32_dpp v153, v153 row_shr:1 row_mask:0xf bank_mask:0xf bound_ctrl:0
    v_mov_b32_dpp v154, v154 row_shr:1 row_mask:0xf bank_mask:0xf bound_ctrl:0
    v_mov_b32_dpp v155, v155 row_shr:1 row_mask:0xf bank_mask:0xf bound_ctrl:0
    v_mov_b32_dpp v156, v156 row_shr:1 row_mask:0xf bank_mask:0xf bound_ctrl:0
    v_mov_b32_dpp v157, v157 row_shr:1 row_mask:0xf bank_mask:0xf bound_ctrl:0
    v_mov_b32_dpp v158, v158 row_shr:1 row_mask:0xf bank_mask:0xf bound_ctrl:0
    v_mov_b32_dpp v159, v159 row_shr:1 row_mask:0xf bank_mask:0xf bound_ctrl:0
    v_alignbit_b32 v112, v113, v112, v11
    v_mfma_f32_32x32x16_bf16 v[128:143], v[200:203], v[56:59], v[128:143]
    ds_read_b64 v[232:233], v14 offset:4032
    ds_read_b64 v[234:235], v14 offset:4040
    v_alignbit_b32 v113, v114, v113, v11
    v_alignbit_b32 v114, v115, v114, v11
    v_alignbit_b32 v115, v28, v115, v11
    v_alignbit_b32 v116, v117, v116, v11
    v_alignbit_b32 v117, v118, v117, v11
    v_alignbit_b32 v118, v119, v118, v11
    v_alignbit_b32 v119, v29, v119, v11
    v_alignbit_b32 v120, v121, v120, v11
    v_mfma_f32_32x32x16_bf16 v[128:143], v[204:207], v[60:63], v[128:143]
    ds_read_b64 v[236:237], v14 offset:4064
    ds_read_b64 v[238:239], v14 offset:4072
    v_alignbit_b32 v121, v122, v121, v11
    v_alignbit_b32 v122, v123, v122, v11
    v_alignbit_b32 v123, v30, v123, v11
    v_alignbit_b32 v124, v125, v124, v11
    v_alignbit_b32 v125, v126, v125, v11
    v_alignbit_b32 v126, v127, v126, v11
    v_alignbit_b32 v127, v31, v127, v11
    s_nop 0
    s_waitcnt lgkmcnt(0)
    v_mfma_f32_32x32x16_bf16 v[160:175], v[208:211], v[96:99], 0
    ds_read_b64 v[176:177], v14 offset:1536
    ds_read_b64 v[178:179], v14 offset:1544
    ds_read_b64 v[180:181], v14 offset:1568
    ds_read_b64 v[182:183], v14 offset:1576
    s_nop 0
    v_mfma_f32_32x32x16_bf16 v[160:175], v[212:215], v[100:103], v[160:175]
    ds_read_b64 v[184:185], v14 offset:1600
    ds_read_b64 v[186:187], v14 offset:1608
    ds_read_b64 v[188:189], v14 offset:1632
    s_nop 1
    v_mfma_f32_32x32x16_bf16 v[160:175], v[216:219], v[104:107], v[160:175]
    ds_read_b64 v[190:191], v14 offset:1640
    ds_read_b64 v[192:193], v14 offset:1664
    ds_read_b64 v[194:195], v14 offset:1672
    v_mov_b32_dpp v128, v128 row_shr:1 row_mask:0xf bank_mask:0xf bound_ctrl:0
    v_mov_b32_dpp v129, v129 row_shr:1 row_mask:0xf bank_mask:0xf bound_ctrl:0
    v_mov_b32_dpp v130, v130 row_shr:1 row_mask:0xf bank_mask:0xf bound_ctrl:0
    v_mfma_f32_32x32x16_bf16 v[160:175], v[220:223], v[108:111], v[160:175]
    ds_read_b64 v[196:197], v14 offset:1696
    ds_read_b64 v[198:199], v14 offset:1704
    ds_read_b64 v[200:201], v14 offset:1728
    v_mov_b32_dpp v131, v131 row_shr:1 row_mask:0xf bank_mask:0xf bound_ctrl:0
    v_mov_b32_dpp v132, v132 row_shr:1 row_mask:0xf bank_mask:0xf bound_ctrl:0
    v_mov_b32_dpp v133, v133 row_shr:1 row_mask:0xf bank_mask:0xf bound_ctrl:0
    v_mfma_f32_32x32x16_bf16 v[160:175], v[224:227], v[112:115], v[160:175]
    ds_read_b64 v[202:203], v14 offset:1736
    ds_read_b64 v[204:205], v14 offset:1760
    ds_read_b64 v[206:207], v14 offset:1768
    v_mov_b32_dpp v134, v134 row_shr:1 row_mask:0xf bank_mask:0xf bound_ctrl:0
    v_mov_b32_dpp v135, v135 row_shr:1 row_mask:0xf bank_mask:0xf bound_ctrl:0
    v_mov_b32_dpp v136, v136 row_shr:1 row_mask:0xf bank_mask:0xf bound_ctrl:0
    v_mfma_f32_32x32x16_bf16 v[160:175], v[228:231], v[116:119], v[160:175]
    v_mov_b32_dpp v137, v137 row_shr:1 row_mask:0xf bank_mask:0xf bound_ctrl:0
    v_mov_b32_dpp v138, v138 row_shr:1 row_mask:0xf bank_mask:0xf bound_ctrl:0
    v_mov_b32_dpp v139, v139 row_shr:1 row_mask:0xf bank_mask:0xf bound_ctrl:0
    v_mfma_f32_32x32x16_bf16 v[160:175], v[232:235], v[120:123], v[160:175]
    v_mov_b32_dpp v140, v140 row_shr:1 row_mask:0xf bank_mask:0xf bound_ctrl:0
    v_mov_b32_dpp v141, v141 row_shr:1 row_mask:0xf bank_mask:0xf bound_ctrl:0
    v_mfma_f32_32x32x16_bf16 v[160:175], v[236:239], v[124:127], v[160:175]
    v_mov_b32_dpp v142, v142 row_shr:1 row_mask:0xf bank_mask:0xf bound_ctrl:0
    v_mov_b32_dpp v143, v143 row_shr:1 row_mask:0xf bank_mask:0xf bound_ctrl:0
    s_add_u32 s39, s38, 2854912
    buffer_load_dwordx4 a[0:3], v4, s[28:31], s39 offen
    s_waitcnt lgkmcnt(0)
    v_mfma_f32_32x32x16_bf16 v[144:159], v[176:179], v[64:67], v[144:159]
    ds_read_b64 v[208:209], v14 offset:3584
    ds_read_b64 v[210:211], v14 offset:3592
    s_nop 2
    v_mfma_f32_32x32x16_bf16 v[144:159], v[180:183], v[68:71], v[144:159]
    ds_read_b64 v[212:213], v14 offset:3616
    ds_read_b64 v[214:215], v14 offset:3624
    s_nop 2
    v_mfma_f32_32x32x16_bf16 v[144:159], v[184:187], v[72:75], v[144:159]
    ds_read_b64 v[216:217], v14 offset:3648
    ds_read_b64 v[218:219], v14 offset:3656
    v_and_b32_dpp v160, v160, v15 row_shr:1 row_mask:0xf bank_mask:0xf bound_ctrl:0
    v_and_b32_dpp v161, v161, v15 row_shr:1 row_mask:0xf bank_mask:0xf bound_ctrl:0
    v_and_b32_dpp v162, v162, v15 row_shr:1 row_mask:0xf bank_mask:0xf bound_ctrl:0
    v_mfma_f32_32x32x16_bf16 v[144:159], v[188:191], v[76:79], v[144:159]
    ds_read_b64 v[220:221], v14 offset:3680
    ds_read_b64 v[222:223], v14 offset:3688
    v_and_b32_dpp v163, v163, v15 row_shr:1 row_mask:0xf bank_mask:0xf bound_ctrl:0
    v_and_b32_dpp v164, v164, v15 row_shr:1 row_mask:0xf bank_mask:0xf bound_ctrl:0
    v_and_b32_dpp v165, v165, v15 row_shr:1 row_mask:0xf bank_mask:0xf bound_ctrl:0
    v_mfma_f32_32x32x16_bf16 v[144:159], v[192:195], v[80:83], v[144:159]
    ds_read_b64 v[224:225], v14 offset:3712
    ds_read_b64 v[226:227], v14 offset:3720
    v_and_b32_dpp v166, v166, v15 row_shr:1 row_mask:0xf bank_mask:0xf bound_ctrl:0
    v_and_b32_dpp v167, v167, v15 row_shr:1 row_mask:0xf bank_mask:0xf bound_ctrl:0
    v_and_b32_dpp v168, v168, v15 row_shr:1 row_mask:0xf bank_mask:0xf bound_ctrl:0
    v_mfma_f32_32x32x16_bf16 v[144:159], v[196:199], v[84:87], v[144:159]
    ds_read_b64 v[228:229], v14 offset:3744
    ds_read_b64 v[230:231], v14 offset:3752
    v_and_b32_dpp v169, v169, v15 row_shr:1 row_mask:0xf bank_mask:0xf bound_ctrl:0
    v_and_b32_dpp v170, v170, v15 row_shr:1 row_mask:0xf bank_mask:0xf bound_ctrl:0
    v_and_b32_dpp v171, v171, v15 row_shr:1 row_mask:0xf bank_mask:0xf bound_ctrl:0
    v_mfma_f32_32x32x16_bf16 v[144:159], v[200:203], v[88:91], v[144:159]
    ds_read_b64 v[232:233], v14 offset:3776
    ds_read_b64 v[234:235], v14 offset:3784
    v_and_b32_dpp v172, v172, v15 row_shr:1 row_mask:0xf bank_mask:0xf bound_ctrl:0
    v_and_b32_dpp v173, v173, v15 row_shr:1 row_mask:0xf bank_mask:0xf bound_ctrl:0
    v_mfma_f32_32x32x16_bf16 v[144:159], v[204:207], v[92:95], v[144:159]
    ds_read_b64 v[236:237], v14 offset:3808
    ds_read_b64 v[238:239], v14 offset:3816
    v_and_b32_dpp v174, v174, v15 row_shr:1 row_mask:0xf bank_mask:0xf bound_ctrl:0
    v_and_b32_dpp v175, v175, v15 row_shr:1 row_mask:0xf bank_mask:0xf bound_ctrl:0
    v_lshlrev_b32 v16, 4, v0
    s_mov_b32 s39, 5476352
    buffer_load_dwordx4 a[16:19], v16, s[28:31], s39 offen
    v_mfma_f32_32x32x16_bf16 v[128:143], v[176:179], v[32:35], v[128:143]
    s_nop 4
    v_mfma_f32_32x32x16_bf16 v[128:143], v[180:183], v[36:39], v[128:143]
    s_nop 4
    v_mfma_f32_32x32x16_bf16 v[128:143], v[184:187], v[40:43], v[128:143]
    v_mov_b32_dpp v144, v144 row_shr:1 row_mask:0xf bank_mask:0xf bound_ctrl:0
    v_mov_b32_dpp v145, v145 row_shr:1 row_mask:0xf bank_mask:0xf bound_ctrl:0
    v_mov_b32_dpp v146, v146 row_shr:1 row_mask:0xf bank_mask:0xf bound_ctrl:0
    v_mfma_f32_32x32x16_bf16 v[128:143], v[188:191], v[44:47], v[128:143]
    v_mov_b32_dpp v147, v147 row_shr:1 row_mask:0xf bank_mask:0xf bound_ctrl:0
    v_mov_b32_dpp v148, v148 row_shr:1 row_mask:0xf bank_mask:0xf bound_ctrl:0
    v_mov_b32_dpp v149, v149 row_shr:1 row_mask:0xf bank_mask:0xf bound_ctrl:0
    v_mfma_f32_32x32x16_bf16 v[128:143], v[192:195], v[48:51], v[128:143]
    v_mov_b32_dpp v150, v150 row_shr:1 row_mask:0xf bank_mask:0xf bound_ctrl:0
    v_mov_b32_dpp v151, v151 row_shr:1 row_mask:0xf bank_mask:0xf bound_ctrl:0
    v_mov_b32_dpp v152, v152 row_shr:1 row_mask:0xf bank_mask:0xf bound_ctrl:0
    v_mfma_f32_32x32x16_bf16 v[128:143], v[196:199], v[52:55], v[128:143]
    v_mov_b32_dpp v153, v153 row_shr:1 row_mask:0xf bank_mask:0xf bound_ctrl:0
    v_mov_b32_dpp v154, v154 row_shr:1 row_mask:0xf bank_mask:0xf bound_ctrl:0
    v_mov_b32_dpp v155, v155 row_shr:1 row_mask:0xf bank_mask:0xf bound_ctrl:0
    v_mfma_f32_32x32x16_bf16 v[128:143], v[200:203], v[56:59], v[128:143]
    v_mov_b32_dpp v156, v156 row_shr:1 row_mask:0xf bank_mask:0xf bound_ctrl:0
    v_mov_b32_dpp v157, v157 row_shr:1 row_mask:0xf bank_mask:0xf bound_ctrl:0
    v_mfma_f32_32x32x16_bf16 v[128:143], v[204:207], v[60:63], v[128:143]
    v_mov_b32_dpp v158, v158 row_shr:1 row_mask:0xf bank_mask:0xf bound_ctrl:0
    v_mov_b32_dpp v159, v159 row_shr:1 row_mask:0xf bank_mask:0xf bound_ctrl:0
    s_waitcnt lgkmcnt(0)
    v_mfma_f32_32x32x16_bf16 v[160:175], v[208:211], v[96:99], v[160:175]
    ds_read_b64 v[176:177], v14 offset:1280
    ds_read_b64 v[178:179], v14 offset:1288
    ds_read_b64 v[180:181], v14 offset:1312
    ds_read_b64 v[182:183], v14 offset:1320
    s_nop 0
    v_mfma_f32_32x32x16_bf16 v[160:175], v[212:215], v[100:103], v[160:175]
    ds_read_b64 v[184:185], v14 offset:1344
    ds_read_b64 v[186:187], v14 offset:1352
    ds_read_b64 v[188:189], v14 offset:1376
    s_nop 1
    v_mfma_f32_32x32x16_bf16 v[160:175], v[216:219], v[104:107], v[160:175]
    ds_read_b64 v[190:191], v14 offset:1384
    ds_read_b64 v[192:193], v14 offset:1408
    ds_read_b64 v[194:195], v14 offset:1416
    v_mov_b32_dpp v128, v128 row_shr:1 row_mask:0xf bank_mask:0xf bound_ctrl:0
    v_mov_b32_dpp v129, v129 row_shr:1 row_mask:0xf bank_mask:0xf bound_ctrl:0
    v_mov_b32_dpp v130, v130 row_shr:1 row_mask:0xf bank_mask:0xf bound_ctrl:0
    v_mfma_f32_32x32x16_bf16 v[160:175], v[220:223], v[108:111], v[160:175]
    ds_read_b64 v[196:197], v14 offset:1440
    ds_read_b64 v[198:199], v14 offset:1448
    ds_read_b64 v[200:201], v14 offset:1472
    v_mov_b32_dpp v131, v131 row_shr:1 row_mask:0xf bank_mask:0xf bound_ctrl:0
    v_mov_b32_dpp v132, v132 row_shr:1 row_mask:0xf bank_mask:0xf bound_ctrl:0
    v_mov_b32_dpp v133, v133 row_shr:1 row_mask:0xf bank_mask:0xf bound_ctrl:0
    v_mfma_f32_32x32x16_bf16 v[160:175], v[224:227], v[112:115], v[160:175]
    ds_read_b64 v[202:203], v14 offset:1480
    ds_read_b64 v[204:205], v14 offset:1504
    ds_read_b64 v[206:207], v14 offset:1512
    v_mov_b32_dpp v134, v134 row_shr:1 row_mask:0xf bank_mask:0xf bound_ctrl:0
    v_mov_b32_dpp v135, v135 row_shr:1 row_mask:0xf bank_mask:0xf bound_ctrl:0
    v_mov_b32_dpp v136, v136 row_shr:1 row_mask:0xf bank_mask:0xf bound_ctrl:0
    v_mfma_f32_32x32x16_bf16 v[160:175], v[228:231], v[116:119], v[160:175]
    v_mov_b32_dpp v137, v137 row_shr:1 row_mask:0xf bank_mask:0xf bound_ctrl:0
    v_mov_b32_dpp v138, v138 row_shr:1 row_mask:0xf bank_mask:0xf bound_ctrl:0
    v_mov_b32_dpp v139, v139 row_shr:1 row_mask:0xf bank_mask:0xf bound_ctrl:0
    v_mfma_f32_32x32x16_bf16 v[160:175], v[232:235], v[120:123], v[160:175]
    v_mov_b32_dpp v140, v140 row_shr:1 row_mask:0xf bank_mask:0xf bound_ctrl:0
    v_mov_b32_dpp v141, v141 row_shr:1 row_mask:0xf bank_mask:0xf bound_ctrl:0
    v_mfma_f32_32x32x16_bf16 v[160:175], v[236:239], v[124:127], v[160:175]
    v_mov_b32_dpp v142, v142 row_shr:1 row_mask:0xf bank_mask:0xf bound_ctrl:0
    v_mov_b32_dpp v143, v143 row_shr:1 row_mask:0xf bank_mask:0xf bound_ctrl:0
    s_add_u32 s39, s38, 3510272
    buffer_load_dwordx4 a[4:7], v4, s[28:31], s39 offen
    s_waitcnt lgkmcnt(0)
    v_mfma_f32_32x32x16_bf16 v[144:159], v[176:179], v[64:67], v[144:159]
    ds_read_b64 v[208:209], v14 offset:3328
    ds_read_b64 v[210:211], v14 offset:3336
    s_nop 2
    v_mfma_f32_32x32x16_bf16 v[144:159], v[180:183], v[68:71], v[144:159]
    ds_read_b64 v[212:213], v14 offset:3360
    ds_read_b64 v[214:215], v14 offset:3368
    s_nop 2
    v_mfma_f32_32x32x16_bf16 v[144:159], v[184:187], v[72:75], v[144:159]
    ds_read_b64 v[216:217], v14 offset:3392
    ds_read_b64 v[218:219], v14 offset:3400
    v_and_b32_dpp v160, v160, v15 row_shr:1 row_mask:0xf bank_mask:0xf bound_ctrl:0
    v_and_b32_dpp v161, v161, v15 row_shr:1 row_mask:0xf bank_mask:0xf bound_ctrl:0
    v_and_b32_dpp v162, v162, v15 row_shr:1 row_mask:0xf bank_mask:0xf bound_ctrl:0
    v_mfma_f32_32x32x16_bf16 v[144:159], v[188:191], v[76:79], v[144:159]
    ds_read_b64 v[220:221], v14 offset:3424
    ds_read_b64 v[222:223], v14 offset:3432
    v_and_b32_dpp v163, v163, v15 row_shr:1 row_mask:0xf bank_mask:0xf bound_ctrl:0
    v_and_b32_dpp v164, v164, v15 row_shr:1 row_mask:0xf bank_mask:0xf bound_ctrl:0
    v_and_b32_dpp v165, v165, v15 row_shr:1 row_mask:0xf bank_mask:0xf bound_ctrl:0
    v_mfma_f32_32x32x16_bf16 v[144:159], v[192:195], v[80:83], v[144:159]
    ds_read_b64 v[224:225], v14 offset:3456
    ds_read_b64 v[226:227], v14 offset:3464
    v_and_b32_dpp v166, v166, v15 row_shr:1 row_mask:0xf bank_mask:0xf bound_ctrl:0
    v_and_b32_dpp v167, v167, v15 row_shr:1 row_mask:0xf bank_mask:0xf bound_ctrl:0
    v_and_b32_dpp v168, v168, v15 row_shr:1 row_mask:0xf bank_mask:0xf bound_ctrl:0
    v_mfma_f32_32x32x16_bf16 v[144:159], v[196:199], v[84:87], v[144:159]
    ds_read_b64 v[228:229], v14 offset:3488
    ds_read_b64 v[230:231], v14 offset:3496
    v_and_b32_dpp v169, v169, v15 row_shr:1 row_mask:0xf bank_mask:0xf bound_ctrl:0
    v_and_b32_dpp v170, v170, v15 row_shr:1 row_mask:0xf bank_mask:0xf bound_ctrl:0
    v_and_b32_dpp v171, v171, v15 row_shr:1 row_mask:0xf bank_mask:0xf bound_ctrl:0
    v_mfma_f32_32x32x16_bf16 v[144:159], v[200:203], v[88:91], v[144:159]
    ds_read_b64 v[232:233], v14 offset:3520
    ds_read_b64 v[234:235], v14 offset:3528
    v_and_b32_dpp v172, v172, v15 row_shr:1 row_mask:0xf bank_mask:0xf bound_ctrl:0
    v_and_b32_dpp v173, v173, v15 row_shr:1 row_mask:0xf bank_mask:0xf bound_ctrl:0
    v_mfma_f32_32x32x16_bf16 v[144:159], v[204:207], v[92:95], v[144:159]
    ds_read_b64 v[236:237], v14 offset:3552
    ds_read_b64 v[238:239], v14 offset:3560
    v_and_b32_dpp v174, v174, v15 row_shr:1 row_mask:0xf bank_mask:0xf bound_ctrl:0
    v_and_b32_dpp v175, v175, v15 row_shr:1 row_mask:0xf bank_mask:0xf bound_ctrl:0
    v_lshlrev_b32 v16, 4, v0
    s_mov_b32 s39, 5480448
    buffer_load_dwordx4 a[20:23], v16, s[28:31], s39 offen
    v_mfma_f32_32x32x16_bf16 v[128:143], v[176:179], v[32:35], v[128:143]
    s_nop 4
    v_mfma_f32_32x32x16_bf16 v[128:143], v[180:183], v[36:39], v[128:143]
    s_nop 4
    v_mfma_f32_32x32x16_bf16 v[128:143], v[184:187], v[40:43], v[128:143]
    v_mov_b32_dpp v144, v144 row_shr:1 row_mask:0xf bank_mask:0xf bound_ctrl:0
    v_mov_b32_dpp v145, v145 row_shr:1 row_mask:0xf bank_mask:0xf bound_ctrl:0
    v_mov_b32_dpp v146, v146 row_shr:1 row_mask:0xf bank_mask:0xf bound_ctrl:0
    v_mfma_f32_32x32x16_bf16 v[128:143], v[188:191], v[44:47], v[128:143]
    v_mov_b32_dpp v147, v147 row_shr:1 row_mask:0xf bank_mask:0xf bound_ctrl:0
    v_mov_b32_dpp v148, v148 row_shr:1 row_mask:0xf bank_mask:0xf bound_ctrl:0
    v_mov_b32_dpp v149, v149 row_shr:1 row_mask:0xf bank_mask:0xf bound_ctrl:0
    v_mfma_f32_32x32x16_bf16 v[128:143], v[192:195], v[48:51], v[128:143]
    v_mov_b32_dpp v150, v150 row_shr:1 row_mask:0xf bank_mask:0xf bound_ctrl:0
    v_mov_b32_dpp v151, v151 row_shr:1 row_mask:0xf bank_mask:0xf bound_ctrl:0
    v_mov_b32_dpp v152, v152 row_shr:1 row_mask:0xf bank_mask:0xf bound_ctrl:0
    v_mfma_f32_32x32x16_bf16 v[128:143], v[196:199], v[52:55], v[128:143]
    v_mov_b32_dpp v153, v153 row_shr:1 row_mask:0xf bank_mask:0xf bound_ctrl:0
    v_mov_b32_dpp v154, v154 row_shr:1 row_mask:0xf bank_mask:0xf bound_ctrl:0
    v_mov_b32_dpp v155, v155 row_shr:1 row_mask:0xf bank_mask:0xf bound_ctrl:0
    v_mfma_f32_32x32x16_bf16 v[128:143], v[200:203], v[56:59], v[128:143]
    v_mov_b32_dpp v156, v156 row_shr:1 row_mask:0xf bank_mask:0xf bound_ctrl:0
    v_mov_b32_dpp v157, v157 row_shr:1 row_mask:0xf bank_mask:0xf bound_ctrl:0
    v_mfma_f32_32x32x16_bf16 v[128:143], v[204:207], v[60:63], v[128:143]
    v_mov_b32_dpp v158, v158 row_shr:1 row_mask:0xf bank_mask:0xf bound_ctrl:0
    v_mov_b32_dpp v159, v159 row_shr:1 row_mask:0xf bank_mask:0xf bound_ctrl:0
    s_waitcnt lgkmcnt(0)
    v_mfma_f32_32x32x16_bf16 v[160:175], v[208:211], v[96:99], v[160:175]
    ds_read_b64 v[176:177], v14 offset:1024
    ds_read_b64 v[178:179], v14 offset:1032
    ds_read_b64 v[180:181], v14 offset:1056
    ds_read_b64 v[182:183], v14 offset:1064
    s_nop 0
    v_mfma_f32_32x32x16_bf16 v[160:175], v[212:215], v[100:103], v[160:175]
    ds_read_b64 v[184:185], v14 offset:1088
    ds_read_b64 v[186:187], v14 offset:1096
    ds_read_b64 v[188:189], v14 offset:1120
    s_nop 1
    v_mfma_f32_32x32x16_bf16 v[160:175], v[216:219], v[104:107], v[160:175]
    ds_read_b64 v[190:191], v14 offset:1128
    ds_read_b64 v[192:193], v14 offset:1152
    ds_read_b64 v[194:195], v14 offset:1160
    v_mov_b32_dpp v128, v128 row_shr:1 row_mask:0xf bank_mask:0xf bound_ctrl:0
    v_mov_b32_dpp v129, v129 row_shr:1 row_mask:0xf bank_mask:0xf bound_ctrl:0
    v_mov_b32_dpp v130, v130 row_shr:1 row_mask:0xf bank_mask:0xf bound_ctrl:0
    v_mfma_f32_32x32x16_bf16 v[160:175], v[220:223], v[108:111], v[160:175]
    ds_read_b64 v[196:197], v14 offset:1184
    ds_read_b64 v[198:199], v14 offset:1192
    ds_read_b64 v[200:201], v14 offset:1216
    v_mov_b32_dpp v131, v131 row_shr:1 row_mask:0xf bank_mask:0xf bound_ctrl:0
    v_mov_b32_dpp v132, v132 row_shr:1 row_mask:0xf bank_mask:0xf bound_ctrl:0
    v_mov_b32_dpp v133, v133 row_shr:1 row_mask:0xf bank_mask:0xf bound_ctrl:0
    v_mfma_f32_32x32x16_bf16 v[160:175], v[224:227], v[112:115], v[160:175]
    ds_read_b64 v[202:203], v14 offset:1224
    ds_read_b64 v[204:205], v14 offset:1248
    ds_read_b64 v[206:207], v14 offset:1256
    v_mov_b32_dpp v134, v134 row_shr:1 row_mask:0xf bank_mask:0xf bound_ctrl:0
    v_mov_b32_dpp v135, v135 row_shr:1 row_mask:0xf bank_mask:0xf bound_ctrl:0
    v_mov_b32_dpp v136, v136 row_shr:1 row_mask:0xf bank_mask:0xf bound_ctrl:0
    v_mfma_f32_32x32x16_bf16 v[160:175], v[228:231], v[116:119], v[160:175]
    v_mov_b32_dpp v137, v137 row_shr:1 row_mask:0xf bank_mask:0xf bound_ctrl:0
    v_mov_b32_dpp v138, v138 row_shr:1 row_mask:0xf bank_mask:0xf bound_ctrl:0
    v_mov_b32_dpp v139, v139 row_shr:1 row_mask:0xf bank_mask:0xf bound_ctrl:0
    v_mfma_f32_32x32x16_bf16 v[160:175], v[232:235], v[120:123], v[160:175]
    v_mov_b32_dpp v140, v140 row_shr:1 row_mask:0xf bank_mask:0xf bound_ctrl:0
    v_mov_b32_dpp v141, v141 row_shr:1 row_mask:0xf bank_mask:0xf bound_ctrl:0
    v_mfma_f32_32x32x16_bf16 v[160:175], v[236:239], v[124:127], v[160:175]
    v_mov_b32_dpp v142, v142 row_shr:1 row_mask:0xf bank_mask:0xf bound_ctrl:0
    v_mov_b32_dpp v143, v143 row_shr:1 row_mask:0xf bank_mask:0xf bound_ctrl:0
    s_add_u32 s39, s38, 4165632
    buffer_load_dwordx4 a[8:11], v4, s[28:31], s39 offen
    s_waitcnt lgkmcnt(0)
    v_mfma_f32_32x32x16_bf16 v[144:159], v[176:179], v[64:67], v[144:159]
    ds_read_b64 v[208:209], v14 offset:3072
    ds_read_b64 v[210:211], v14 offset:3080
    s_nop 2
    v_mfma_f32_32x32x16_bf16 v[144:159], v[180:183], v[68:71], v[144:159]
    ds_read_b64 v[212:213], v14 offset:3104
    ds_read_b64 v[214:215], v14 offset:3112
    s_nop 2
    v_mfma_f32_32x32x16_bf16 v[144:159], v[184:187], v[72:75], v[144:159]
    ds_read_b64 v[216:217], v14 offset:3136
    ds_read_b64 v[218:219], v14 offset:3144
    v_and_b32_dpp v160, v160, v15 row_shr:1 row_mask:0xf bank_mask:0xf bound_ctrl:0
    v_and_b32_dpp v161, v161, v15 row_shr:1 row_mask:0xf bank_mask:0xf bound_ctrl:0
    v_and_b32_dpp v162, v162, v15 row_shr:1 row_mask:0xf bank_mask:0xf bound_ctrl:0
    v_mfma_f32_32x32x16_bf16 v[144:159], v[188:191], v[76:79], v[144:159]
    ds_read_b64 v[220:221], v14 offset:3168
    ds_read_b64 v[222:223], v14 offset:3176
    v_and_b32_dpp v163, v163, v15 row_shr:1 row_mask:0xf bank_mask:0xf bound_ctrl:0
    v_and_b32_dpp v164, v164, v15 row_shr:1 row_mask:0xf bank_mask:0xf bound_ctrl:0
    v_and_b32_dpp v165, v165, v15 row_shr:1 row_mask:0xf bank_mask:0xf bound_ctrl:0
    v_mfma_f32_32x32x16_bf16 v[144:159], v[192:195], v[80:83], v[144:159]
    ds_read_b64 v[224:225], v14 offset:3200
    ds_read_b64 v[226:227], v14 offset:3208
    v_and_b32_dpp v166, v166, v15 row_shr:1 row_mask:0xf bank_mask:0xf bound_ctrl:0
    v_and_b32_dpp v167, v167, v15 row_shr:1 row_mask:0xf bank_mask:0xf bound_ctrl:0
    v_and_b32_dpp v168, v168, v15 row_shr:1 row_mask:0xf bank_mask:0xf bound_ctrl:0
    v_mfma_f32_32x32x16_bf16 v[144:159], v[196:199], v[84:87], v[144:159]
    ds_read_b64 v[228:229], v14 offset:3232
    ds_read_b64 v[230:231], v14 offset:3240
    v_and_b32_dpp v169, v169, v15 row_shr:1 row_mask:0xf bank_mask:0xf bound_ctrl:0
    v_and_b32_dpp v170, v170, v15 row_shr:1 row_mask:0xf bank_mask:0xf bound_ctrl:0
    v_and_b32_dpp v171, v171, v15 row_shr:1 row_mask:0xf bank_mask:0xf bound_ctrl:0
    v_mfma_f32_32x32x16_bf16 v[144:159], v[200:203], v[88:91], v[144:159]
    ds_read_b64 v[232:233], v14 offset:3264
    ds_read_b64 v[234:235], v14 offset:3272
    v_and_b32_dpp v172, v172, v15 row_shr:1 row_mask:0xf bank_mask:0xf bound_ctrl:0
    v_and_b32_dpp v173, v173, v15 row_shr:1 row_mask:0xf bank_mask:0xf bound_ctrl:0
    v_mfma_f32_32x32x16_bf16 v[144:159], v[204:207], v[92:95], v[144:159]
    ds_read_b64 v[236:237], v14 offset:3296
    ds_read_b64 v[238:239], v14 offset:3304
    v_and_b32_dpp v174, v174, v15 row_shr:1 row_mask:0xf bank_mask:0xf bound_ctrl:0
    v_and_b32_dpp v175, v175, v15 row_shr:1 row_mask:0xf bank_mask:0xf bound_ctrl:0
    v_lshlrev_b32 v16, 4, v0
    s_mov_b32 s39, 5484544
    buffer_load_dwordx4 a[24:27], v16, s[28:31], s39 offen
    v_mfma_f32_32x32x16_bf16 v[128:143], v[176:179], v[32:35], v[128:143]
    s_nop 4
    v_mfma_f32_32x32x16_bf16 v[128:143], v[180:183], v[36:39], v[128:143]
    s_nop 4
    v_mfma_f32_32x32x16_bf16 v[128:143], v[184:187], v[40:43], v[128:143]
    v_mov_b32_dpp v144, v144 row_shr:1 row_mask:0xf bank_mask:0xf bound_ctrl:0
    v_mov_b32_dpp v145, v145 row_shr:1 row_mask:0xf bank_mask:0xf bound_ctrl:0
    v_mov_b32_dpp v146, v146 row_shr:1 row_mask:0xf bank_mask:0xf bound_ctrl:0
    v_mfma_f32_32x32x16_bf16 v[128:143], v[188:191], v[44:47], v[128:143]
    v_mov_b32_dpp v147, v147 row_shr:1 row_mask:0xf bank_mask:0xf bound_ctrl:0
    v_mov_b32_dpp v148, v148 row_shr:1 row_mask:0xf bank_mask:0xf bound_ctrl:0
    v_mov_b32_dpp v149, v149 row_shr:1 row_mask:0xf bank_mask:0xf bound_ctrl:0
    v_mfma_f32_32x32x16_bf16 v[128:143], v[192:195], v[48:51], v[128:143]
    v_mov_b32_dpp v150, v150 row_shr:1 row_mask:0xf bank_mask:0xf bound_ctrl:0
    v_mov_b32_dpp v151, v151 row_shr:1 row_mask:0xf bank_mask:0xf bound_ctrl:0
    v_mov_b32_dpp v152, v152 row_shr:1 row_mask:0xf bank_mask:0xf bound_ctrl:0
    v_mfma_f32_32x32x16_bf16 v[128:143], v[196:199], v[52:55], v[128:143]
    v_mov_b32_dpp v153, v153 row_shr:1 row_mask:0xf bank_mask:0xf bound_ctrl:0
    v_mov_b32_dpp v154, v154 row_shr:1 row_mask:0xf bank_mask:0xf bound_ctrl:0
    v_mov_b32_dpp v155, v155 row_shr:1 row_mask:0xf bank_mask:0xf bound_ctrl:0
    v_mfma_f32_32x32x16_bf16 v[128:143], v[200:203], v[56:59], v[128:143]
    v_mov_b32_dpp v156, v156 row_shr:1 row_mask:0xf bank_mask:0xf bound_ctrl:0
    v_mov_b32_dpp v157, v157 row_shr:1 row_mask:0xf bank_mask:0xf bound_ctrl:0
    v_mfma_f32_32x32x16_bf16 v[128:143], v[204:207], v[60:63], v[128:143]
    v_mov_b32_dpp v158, v158 row_shr:1 row_mask:0xf bank_mask:0xf bound_ctrl:0
    v_mov_b32_dpp v159, v159 row_shr:1 row_mask:0xf bank_mask:0xf bound_ctrl:0
    s_waitcnt lgkmcnt(0)
    v_mfma_f32_32x32x16_bf16 v[160:175], v[208:211], v[96:99], v[160:175]
    ds_read_b64 v[176:177], v14 offset:768
    ds_read_b64 v[178:179], v14 offset:776
    ds_read_b64 v[180:181], v14 offset:800
    ds_read_b64 v[182:183], v14 offset:808
    s_nop 0
    v_mfma_f32_32x32x16_bf16 v[160:175], v[212:215], v[100:103], v[160:175]
    ds_read_b64 v[184:185], v14 offset:832
    ds_read_b64 v[186:187], v14 offset:840
    ds_read_b64 v[188:189], v14 offset:864
    s_nop 1
    v_mfma_f32_32x32x16_bf16 v[160:175], v[216:219], v[104:107], v[160:175]
    ds_read_b64 v[190:191], v14 offset:872
    ds_read_b64 v[192:193], v14 offset:896
    ds_read_b64 v[194:195], v14 offset:904
    v_mov_b32_dpp v128, v128 row_shr:1 row_mask:0xf bank_mask:0xf bound_ctrl:0
    v_mov_b32_dpp v129, v129 row_shr:1 row_mask:0xf bank_mask:0xf bound_ctrl:0
    v_mov_b32_dpp v130, v130 row_shr:1 row_mask:0xf bank_mask:0xf bound_ctrl:0
    v_mfma_f32_32x32x16_bf16 v[160:175], v[220:223], v[108:111], v[160:175]
    ds_read_b64 v[196:197], v14 offset:928
    ds_read_b64 v[198:199], v14 offset:936
    ds_read_b64 v[200:201], v14 offset:960
    v_mov_b32_dpp v131, v131 row_shr:1 row_mask:0xf bank_mask:0xf bound_ctrl:0
    v_mov_b32_dpp v132, v132 row_shr:1 row_mask:0xf bank_mask:0xf bound_ctrl:0
    v_mov_b32_dpp v133, v133 row_shr:1 row_mask:0xf bank_mask:0xf bound_ctrl:0
    v_mfma_f32_32x32x16_bf16 v[160:175], v[224:227], v[112:115], v[160:175]
    ds_read_b64 v[202:203], v14 offset:968
    ds_read_b64 v[204:205], v14 offset:992
    ds_read_b64 v[206:207], v14 offset:1000
    v_mov_b32_dpp v134, v134 row_shr:1 row_mask:0xf bank_mask:0xf bound_ctrl:0
    v_mov_b32_dpp v135, v135 row_shr:1 row_mask:0xf bank_mask:0xf bound_ctrl:0
    v_mov_b32_dpp v136, v136 row_shr:1 row_mask:0xf bank_mask:0xf bound_ctrl:0
    v_mfma_f32_32x32x16_bf16 v[160:175], v[228:231], v[116:119], v[160:175]
    v_mov_b32_dpp v137, v137 row_shr:1 row_mask:0xf bank_mask:0xf bound_ctrl:0
    v_mov_b32_dpp v138, v138 row_shr:1 row_mask:0xf bank_mask:0xf bound_ctrl:0
    v_mov_b32_dpp v139, v139 row_shr:1 row_mask:0xf bank_mask:0xf bound_ctrl:0
    v_mfma_f32_32x32x16_bf16 v[160:175], v[232:235], v[120:123], v[160:175]
    v_mov_b32_dpp v140, v140 row_shr:1 row_mask:0xf bank_mask:0xf bound_ctrl:0
    v_mov_b32_dpp v141, v141 row_shr:1 row_mask:0xf bank_mask:0xf bound_ctrl:0
    v_mfma_f32_32x32x16_bf16 v[160:175], v[236:239], v[124:127], v[160:175]
    v_mov_b32_dpp v142, v142 row_shr:1 row_mask:0xf bank_mask:0xf bound_ctrl:0
    v_mov_b32_dpp v143, v143 row_shr:1 row_mask:0xf bank_mask:0xf bound_ctrl:0
    s_add_u32 s39, s38, 4820992
    buffer_load_dwordx4 a[12:15], v4, s[28:31], s39 offen
    s_waitcnt lgkmcnt(0)
    v_mfma_f32_32x32x16_bf16 v[144:159], v[176:179], v[64:67], v[144:159]
    ds_read_b64 v[208:209], v14 offset:2816
    ds_read_b64 v[210:211], v14 offset:2824
    s_nop 2
    v_mfma_f32_32x32x16_bf16 v[144:159], v[180:183], v[68:71], v[144:159]
    ds_read_b64 v[212:213], v14 offset:2848
    ds_read_b64 v[214:215], v14 offset:2856
    s_nop 2
    v_mfma_f32_32x32x16_bf16 v[144:159], v[184:187], v[72:75], v[144:159]
    ds_read_b64 v[216:217], v14 offset:2880
    ds_read_b64 v[218:219], v14 offset:2888
    v_and_b32_dpp v160, v160, v15 row_shr:1 row_mask:0xf bank_mask:0xf bound_ctrl:0
    v_and_b32_dpp v161, v161, v15 row_shr:1 row_mask:0xf bank_mask:0xf bound_ctrl:0
    v_and_b32_dpp v162, v162, v15 row_shr:1 row_mask:0xf bank_mask:0xf bound_ctrl:0
    v_mfma_f32_32x32x16_bf16 v[144:159], v[188:191], v[76:79], v[144:159]
    ds_read_b64 v[220:221], v14 offset:2912
    ds_read_b64 v[222:223], v14 offset:2920
    v_and_b32_dpp v163, v163, v15 row_shr:1 row_mask:0xf bank_mask:0xf bound_ctrl:0
    v_and_b32_dpp v164, v164, v15 row_shr:1 row_mask:0xf bank_mask:0xf bound_ctrl:0
    v_and_b32_dpp v165, v165, v15 row_shr:1 row_mask:0xf bank_mask:0xf bound_ctrl:0
    v_mfma_f32_32x32x16_bf16 v[144:159], v[192:195], v[80:83], v[144:159]
    ds_read_b64 v[224:225], v14 offset:2944
    ds_read_b64 v[226:227], v14 offset:2952
    v_and_b32_dpp v166, v166, v15 row_shr:1 row_mask:0xf bank_mask:0xf bound_ctrl:0
    v_and_b32_dpp v167, v167, v15 row_shr:1 row_mask:0xf bank_mask:0xf bound_ctrl:0
    v_and_b32_dpp v168, v168, v15 row_shr:1 row_mask:0xf bank_mask:0xf bound_ctrl:0
    v_mfma_f32_32x32x16_bf16 v[144:159], v[196:199], v[84:87], v[144:159]
    ds_read_b64 v[228:229], v14 offset:2976
    ds_read_b64 v[230:231], v14 offset:2984
    v_and_b32_dpp v169, v169, v15 row_shr:1 row_mask:0xf bank_mask:0xf bound_ctrl:0
    v_and_b32_dpp v170, v170, v15 row_shr:1 row_mask:0xf bank_mask:0xf bound_ctrl:0
    v_and_b32_dpp v171, v171, v15 row_shr:1 row_mask:0xf bank_mask:0xf bound_ctrl:0
    v_mfma_f32_32x32x16_bf16 v[144:159], v[200:203], v[88:91], v[144:159]
    ds_read_b64 v[232:233], v14 offset:3008
    ds_read_b64 v[234:235], v14 offset:3016
    v_and_b32_dpp v172, v172, v15 row_shr:1 row_mask:0xf bank_mask:0xf bound_ctrl:0
    v_and_b32_dpp v173, v173, v15 row_shr:1 row_mask:0xf bank_mask:0xf bound_ctrl:0
    v_mfma_f32_32x32x16_bf16 v[144:159], v[204:207], v[92:95], v[144:159]
    ds_read_b64 v[236:237], v14 offset:3040
    ds_read_b64 v[238:239], v14 offset:3048
    v_and_b32_dpp v174, v174, v15 row_shr:1 row_mask:0xf bank_mask:0xf bound_ctrl:0
    v_and_b32_dpp v175, v175, v15 row_shr:1 row_mask:0xf bank_mask:0xf bound_ctrl:0
    v_lshlrev_b32 v16, 4, v0
    s_mov_b32 s39, 5488640
    buffer_load_dwordx4 a[28:31], v16, s[28:31], s39 offen
    v_mfma_f32_32x32x16_bf16 v[128:143], v[176:179], v[32:35], v[128:143]
    s_nop 4
    v_mfma_f32_32x32x16_bf16 v[128:143], v[180:183], v[36:39], v[128:143]
    s_nop 4
    v_mfma_f32_32x32x16_bf16 v[128:143], v[184:187], v[40:43], v[128:143]
    v_mov_b32_dpp v144, v144 row_shr:1 row_mask:0xf bank_mask:0xf bound_ctrl:0
    v_mov_b32_dpp v145, v145 row_shr:1 row_mask:0xf bank_mask:0xf bound_ctrl:0
    v_mov_b32_dpp v146, v146 row_shr:1 row_mask:0xf bank_mask:0xf bound_ctrl:0
    v_mfma_f32_32x32x16_bf16 v[128:143], v[188:191], v[44:47], v[128:143]
    v_mov_b32_dpp v147, v147 row_shr:1 row_mask:0xf bank_mask:0xf bound_ctrl:0
    v_mov_b32_dpp v148, v148 row_shr:1 row_mask:0xf bank_mask:0xf bound_ctrl:0
    v_mov_b32_dpp v149, v149 row_shr:1 row_mask:0xf bank_mask:0xf bound_ctrl:0
    v_mfma_f32_32x32x16_bf16 v[128:143], v[192:195], v[48:51], v[128:143]
    v_mov_b32_dpp v150, v150 row_shr:1 row_mask:0xf bank_mask:0xf bound_ctrl:0
    v_mov_b32_dpp v151, v151 row_shr:1 row_mask:0xf bank_mask:0xf bound_ctrl:0
    v_mov_b32_dpp v152, v152 row_shr:1 row_mask:0xf bank_mask:0xf bound_ctrl:0
    v_mfma_f32_32x32x16_bf16 v[128:143], v[196:199], v[52:55], v[128:143]
    v_mov_b32_dpp v153, v153 row_shr:1 row_mask:0xf bank_mask:0xf bound_ctrl:0
    v_mov_b32_dpp v154, v154 row_shr:1 row_mask:0xf bank_mask:0xf bound_ctrl:0
    v_mov_b32_dpp v155, v155 row_shr:1 row_mask:0xf bank_mask:0xf bound_ctrl:0
    v_mfma_f32_32x32x16_bf16 v[128:143], v[200:203], v[56:59], v[128:143]
    v_mov_b32_dpp v156, v156 row_shr:1 row_mask:0xf bank_mask:0xf bound_ctrl:0
    v_mov_b32_dpp v157, v157 row_shr:1 row_mask:0xf bank_mask:0xf bound_ctrl:0
    v_mfma_f32_32x32x16_bf16 v[128:143], v[204:207], v[60:63], v[128:143]
    v_mov_b32_dpp v158, v158 row_shr:1 row_mask:0xf bank_mask:0xf bound_ctrl:0
    v_mov_b32_dpp v159, v159 row_shr:1 row_mask:0xf bank_mask:0xf bound_ctrl:0
    s_waitcnt lgkmcnt(0)
    v_mfma_f32_32x32x16_bf16 v[160:175], v[208:211], v[96:99], v[160:175]
    ds_read_b64 v[176:177], v14 offset:512
    ds_read_b64 v[178:179], v14 offset:520
    ds_read_b64 v[180:181], v14 offset:544
    ds_read_b64 v[182:183], v14 offset:552
    s_nop 0
    v_mfma_f32_32x32x16_bf16 v[160:175], v[212:215], v[100:103], v[160:175]
    ds_read_b64 v[184:185], v14 offset:576
    ds_read_b64 v[186:187], v14 offset:584
    ds_read_b64 v[188:189], v14 offset:608
    s_nop 1
    v_mfma_f32_32x32x16_bf16 v[160:175], v[216:219], v[104:107], v[160:175]
    ds_read_b64 v[190:191], v14 offset:616
    ds_read_b64 v[192:193], v14 offset:640
    ds_read_b64 v[194:195], v14 offset:648
    v_mov_b32_dpp v128, v128 row_shr:1 row_mask:0xf bank_mask:0xf bound_ctrl:0
    v_mov_b32_dpp v129, v129 row_shr:1 row_mask:0xf bank_mask:0xf bound_ctrl:0
    v_mov_b32_dpp v130, v130 row_shr:1 row_mask:0xf bank_mask:0xf bound_ctrl:0
    v_mfma_f32_32x32x16_bf16 v[160:175], v[220:223], v[108:111], v[160:175]
    ds_read_b64 v[196:197], v14 offset:672
    ds_read_b64 v[198:199], v14 offset:680
    ds_read_b64 v[200:201], v14 offset:704
    v_mov_b32_dpp v131, v131 row_shr:1 row_mask:0xf bank_mask:0xf bound_ctrl:0
    v_mov_b32_dpp v132, v132 row_shr:1 row_mask:0xf bank_mask:0xf bound_ctrl:0
    v_mov_b32_dpp v133, v133 row_shr:1 row_mask:0xf bank_mask:0xf bound_ctrl:0
    v_mfma_f32_32x32x16_bf16 v[160:175], v[224:227], v[112:115], v[160:175]
    ds_read_b64 v[202:203], v14 offset:712
    ds_read_b64 v[204:205], v14 offset:736
    ds_read_b64 v[206:207], v14 offset:744
    v_mov_b32_dpp v134, v134 row_shr:1 row_mask:0xf bank_mask:0xf bound_ctrl:0
    v_mov_b32_dpp v135, v135 row_shr:1 row_mask:0xf bank_mask:0xf bound_ctrl:0
    v_mov_b32_dpp v136, v136 row_shr:1 row_mask:0xf bank_mask:0xf bound_ctrl:0
    v_mfma_f32_32x32x16_bf16 v[160:175], v[228:231], v[116:119], v[160:175]
    v_mov_b32_dpp v137, v137 row_shr:1 row_mask:0xf bank_mask:0xf bound_ctrl:0
    v_mov_b32_dpp v138, v138 row_shr:1 row_mask:0xf bank_mask:0xf bound_ctrl:0
    v_mov_b32_dpp v139, v139 row_shr:1 row_mask:0xf bank_mask:0xf bound_ctrl:0
    v_mfma_f32_32x32x16_bf16 v[160:175], v[232:235], v[120:123], v[160:175]
    v_mov_b32_dpp v140, v140 row_shr:1 row_mask:0xf bank_mask:0xf bound_ctrl:0
    v_mov_b32_dpp v141, v141 row_shr:1 row_mask:0xf bank_mask:0xf bound_ctrl:0
    v_mfma_f32_32x32x16_bf16 v[160:175], v[236:239], v[124:127], v[160:175]
    v_mov_b32_dpp v142, v142 row_shr:1 row_mask:0xf bank_mask:0xf bound_ctrl:0
    v_mov_b32_dpp v143, v143 row_shr:1 row_mask:0xf bank_mask:0xf bound_ctrl:0
    s_waitcnt lgkmcnt(0)
    v_mfma_f32_32x32x16_bf16 v[144:159], v[176:179], v[64:67], v[144:159]
    ds_read_b64 v[208:209], v14 offset:2560
    ds_read_b64 v[210:211], v14 offset:2568
    s_nop 2
    v_mfma_f32_32x32x16_bf16 v[144:159], v[180:183], v[68:71], v[144:159]
    ds_read_b64 v[212:213], v14 offset:2592
    ds_read_b64 v[214:215], v14 offset:2600
    s_nop 2
    v_mfma_f32_32x32x16_bf16 v[144:159], v[184:187], v[72:75], v[144:159]
    ds_read_b64 v[216:217], v14 offset:2624
    ds_read_b64 v[218:219], v14 offset:2632
    v_and_b32_dpp v160, v160, v15 row_shr:1 row_mask:0xf bank_mask:0xf bound_ctrl:0
    v_and_b32_dpp v161, v161, v15 row_shr:1 row_mask:0xf bank_mask:0xf bound_ctrl:0
    v_and_b32_dpp v162, v162, v15 row_shr:1 row_mask:0xf bank_mask:0xf bound_ctrl:0
    v_mfma_f32_32x32x16_bf16 v[144:159], v[188:191], v[76:79], v[144:159]
    ds_read_b64 v[220:221], v14 offset:2656
    ds_read_b64 v[222:223], v14 offset:2664
    v_and_b32_dpp v163, v163, v15 row_shr:1 row_mask:0xf bank_mask:0xf bound_ctrl:0
    v_and_b32_dpp v164, v164, v15 row_shr:1 row_mask:0xf bank_mask:0xf bound_ctrl:0
    v_and_b32_dpp v165, v165, v15 row_shr:1 row_mask:0xf bank_mask:0xf bound_ctrl:0
    v_mfma_f32_32x32x16_bf16 v[144:159], v[192:195], v[80:83], v[144:159]
    ds_read_b64 v[224:225], v14 offset:2688
    ds_read_b64 v[226:227], v14 offset:2696
    v_and_b32_dpp v166, v166, v15 row_shr:1 row_mask:0xf bank_mask:0xf bound_ctrl:0
    v_and_b32_dpp v167, v167, v15 row_shr:1 row_mask:0xf bank_mask:0xf bound_ctrl:0
    v_and_b32_dpp v168, v168, v15 row_shr:1 row_mask:0xf bank_mask:0xf bound_ctrl:0
    v_mfma_f32_32x32x16_bf16 v[144:159], v[196:199], v[84:87], v[144:159]
    ds_read_b64 v[228:229], v14 offset:2720
    ds_read_b64 v[230:231], v14 offset:2728
    v_and_b32_dpp v169, v169, v15 row_shr:1 row_mask:0xf bank_mask:0xf bound_ctrl:0
    v_and_b32_dpp v170, v170, v15 row_shr:1 row_mask:0xf bank_mask:0xf bound_ctrl:0
    v_and_b32_dpp v171, v171, v15 row_shr:1 row_mask:0xf bank_mask:0xf bound_ctrl:0
    v_mfma_f32_32x32x16_bf16 v[144:159], v[200:203], v[88:91], v[144:159]
    ds_read_b64 v[232:233], v14 offset:2752
    ds_read_b64 v[234:235], v14 offset:2760
    v_and_b32_dpp v172, v172, v15 row_shr:1 row_mask:0xf bank_mask:0xf bound_ctrl:0
    v_and_b32_dpp v173, v173, v15 row_shr:1 row_mask:0xf bank_mask:0xf bound_ctrl:0
    v_mfma_f32_32x32x16_bf16 v[144:159], v[204:207], v[92:95], v[144:159]
    ds_read_b64 v[236:237], v14 offset:2784
    ds_read_b64 v[238:239], v14 offset:2792
    v_and_b32_dpp v174, v174, v15 row_shr:1 row_mask:0xf bank_mask:0xf bound_ctrl:0
    v_and_b32_dpp v175, v175, v15 row_shr:1 row_mask:0xf bank_mask:0xf bound_ctrl:0
    v_mfma_f32_32x32x16_bf16 v[128:143], v[176:179], v[32:35], v[128:143]
    s_nop 4
    v_mfma_f32_32x32x16_bf16 v[128:143], v[180:183], v[36:39], v[128:143]
    s_nop 4
    v_mfma_f32_32x32x16_bf16 v[128:143], v[184:187], v[40:43], v[128:143]
    v_mov_b32_dpp v144, v144 row_shr:1 row_mask:0xf bank_mask:0xf bound_ctrl:0
    v_mov_b32_dpp v145, v145 row_shr:1 row_mask:0xf bank_mask:0xf bound_ctrl:0
    v_mov_b32_dpp v146, v146 row_shr:1 row_mask:0xf bank_mask:0xf bound_ctrl:0
    v_mfma_f32_32x32x16_bf16 v[128:143], v[188:191], v[44:47], v[128:143]
    v_mov_b32_dpp v147, v147 row_shr:1 row_mask:0xf bank_mask:0xf bound_ctrl:0
    v_mov_b32_dpp v148, v148 row_shr:1 row_mask:0xf bank_mask:0xf bound_ctrl:0
    v_mov_b32_dpp v149, v149 row_shr:1 row_mask:0xf bank_mask:0xf bound_ctrl:0
    v_mfma_f32_32x32x16_bf16 v[128:143], v[192:195], v[48:51], v[128:143]
    v_mov_b32_dpp v150, v150 row_shr:1 row_mask:0xf bank_mask:0xf bound_ctrl:0
    v_mov_b32_dpp v151, v151 row_shr:1 row_mask:0xf bank_mask:0xf bound_ctrl:0
    v_mov_b32_dpp v152, v152 row_shr:1 row_mask:0xf bank_mask:0xf bound_ctrl:0
    v_mfma_f32_32x32x16_bf16 v[128:143], v[196:199], v[52:55], v[128:143]
    v_mov_b32_dpp v153, v153 row_shr:1 row_mask:0xf bank_mask:0xf bound_ctrl:0
    v_mov_b32_dpp v154, v154 row_shr:1 row_mask:0xf bank_mask:0xf bound_ctrl:0
    v_mov_b32_dpp v155, v155 row_shr:1 row_mask:0xf bank_mask:0xf bound_ctrl:0
    v_mfma_f32_32x32x16_bf16 v[128:143], v[200:203], v[56:59], v[128:143]
    v_mov_b32_dpp v156, v156 row_shr:1 row_mask:0xf bank_mask:0xf bound_ctrl:0
    v_mov_b32_dpp v157, v157 row_shr:1 row_mask:0xf bank_mask:0xf bound_ctrl:0
    v_mfma_f32_32x32x16_bf16 v[128:143], v[204:207], v[60:63], v[128:143]
    v_mov_b32_dpp v158, v158 row_shr:1 row_mask:0xf bank_mask:0xf bound_ctrl:0
    v_mov_b32_dpp v159, v159 row_shr:1 row_mask:0xf bank_mask:0xf bound_ctrl:0
    s_waitcnt lgkmcnt(0)
    v_mfma_f32_32x32x16_bf16 v[160:175], v[208:211], v[96:99], v[160:175]
    ds_read_b64 v[176:177], v14 offset:256
    ds_read_b64 v[178:179], v14 offset:264
    ds_read_b64 v[180:181], v14 offset:288
    ds_read_b64 v[182:183], v14 offset:296
    s_nop 0
    v_mfma_f32_32x32x16_bf16 v[160:175], v[212:215], v[100:103], v[160:175]
    ds_read_b64 v[184:185], v14 offset:320
    ds_read_b64 v[186:187], v14 offset:328
    ds_read_b64 v[188:189], v14 offset:352
    s_nop 1
    v_mfma_f32_32x32x16_bf16 v[160:175], v[216:219], v[104:107], v[160:175]
    ds_read_b64 v[190:191], v14 offset:360
    ds_read_b64 v[192:193], v14 offset:384
    ds_read_b64 v[194:195], v14 offset:392
    v_mov_b32_dpp v128, v128 row_shr:1 row_mask:0xf bank_mask:0xf bound_ctrl:0
    v_mov_b32_dpp v129, v129 row_shr:1 row_mask:0xf bank_mask:0xf bound_ctrl:0
    v_mov_b32_dpp v130, v130 row_shr:1 row_mask:0xf bank_mask:0xf bound_ctrl:0
    v_mfma_f32_32x32x16_bf16 v[160:175], v[220:223], v[108:111], v[160:175]
    ds_read_b64 v[196:197], v14 offset:416
    ds_read_b64 v[198:199], v14 offset:424
    ds_read_b64 v[200:201], v14 offset:448
    v_mov_b32_dpp v131, v131 row_shr:1 row_mask:0xf bank_mask:0xf bound_ctrl:0
    v_mov_b32_dpp v132, v132 row_shr:1 row_mask:0xf bank_mask:0xf bound_ctrl:0
    v_mov_b32_dpp v133, v133 row_shr:1 row_mask:0xf bank_mask:0xf bound_ctrl:0
    v_mfma_f32_32x32x16_bf16 v[160:175], v[224:227], v[112:115], v[160:175]
    ds_read_b64 v[202:203], v14 offset:456
    ds_read_b64 v[204:205], v14 offset:480
    ds_read_b64 v[206:207], v14 offset:488
    v_mov_b32_dpp v134, v134 row_shr:1 row_mask:0xf bank_mask:0xf bound_ctrl:0
    v_mov_b32_dpp v135, v135 row_shr:1 row_mask:0xf bank_mask:0xf bound_ctrl:0
    v_mov_b32_dpp v136, v136 row_shr:1 row_mask:0xf bank_mask:0xf bound_ctrl:0
    v_mfma_f32_32x32x16_bf16 v[160:175], v[228:231], v[116:119], v[160:175]
    v_mov_b32_dpp v137, v137 row_shr:1 row_mask:0xf bank_mask:0xf bound_ctrl:0
    v_mov_b32_dpp v138, v138 row_shr:1 row_mask:0xf bank_mask:0xf bound_ctrl:0
    v_mov_b32_dpp v139, v139 row_shr:1 row_mask:0xf bank_mask:0xf bound_ctrl:0
    v_mfma_f32_32x32x16_bf16 v[160:175], v[232:235], v[120:123], v[160:175]
    v_mov_b32_dpp v140, v140 row_shr:1 row_mask:0xf bank_mask:0xf bound_ctrl:0
    v_mov_b32_dpp v141, v141 row_shr:1 row_mask:0xf bank_mask:0xf bound_ctrl:0
    v_mfma_f32_32x32x16_bf16 v[160:175], v[236:239], v[124:127], v[160:175]
    v_mov_b32_dpp v142, v142 row_shr:1 row_mask:0xf bank_mask:0xf bound_ctrl:0
    v_mov_b32_dpp v143, v143 row_shr:1 row_mask:0xf bank_mask:0xf bound_ctrl:0
    s_waitcnt lgkmcnt(0)
    v_mfma_f32_32x32x16_bf16 v[144:159], v[176:179], v[64:67], v[144:159]
    ds_read_b64 v[208:209], v14 offset:2304
    ds_read_b64 v[210:211], v14 offset:2312
    s_nop 2
    v_mfma_f32_32x32x16_bf16 v[144:159], v[180:183], v[68:71], v[144:159]
    ds_read_b64 v[212:213], v14 offset:2336
    ds_read_b64 v[214:215], v14 offset:2344
    s_nop 2
    v_mfma_f32_32x32x16_bf16 v[144:159], v[184:187], v[72:75], v[144:159]
    ds_read_b64 v[216:217], v14 offset:2368
    ds_read_b64 v[218:219], v14 offset:2376
    v_and_b32_dpp v160, v160, v15 row_shr:1 row_mask:0xf bank_mask:0xf bound_ctrl:0
    v_and_b32_dpp v161, v161, v15 row_shr:1 row_mask:0xf bank_mask:0xf bound_ctrl:0
    v_and_b32_dpp v162, v162, v15 row_shr:1 row_mask:0xf bank_mask:0xf bound_ctrl:0
    v_mfma_f32_32x32x16_bf16 v[144:159], v[188:191], v[76:79], v[144:159]
    ds_read_b64 v[220:221], v14 offset:2400
    ds_read_b64 v[222:223], v14 offset:2408
    v_and_b32_dpp v163, v163, v15 row_shr:1 row_mask:0xf bank_mask:0xf bound_ctrl:0
    v_and_b32_dpp v164, v164, v15 row_shr:1 row_mask:0xf bank_mask:0xf bound_ctrl:0
    v_and_b32_dpp v165, v165, v15 row_shr:1 row_mask:0xf bank_mask:0xf bound_ctrl:0
    v_mfma_f32_32x32x16_bf16 v[144:159], v[192:195], v[80:83], v[144:159]
    ds_read_b64 v[224:225], v14 offset:2432
    ds_read_b64 v[226:227], v14 offset:2440
    v_and_b32_dpp v166, v166, v15 row_shr:1 row_mask:0xf bank_mask:0xf bound_ctrl:0
    v_and_b32_dpp v167, v167, v15 row_shr:1 row_mask:0xf bank_mask:0xf bound_ctrl:0
    v_and_b32_dpp v168, v168, v15 row_shr:1 row_mask:0xf bank_mask:0xf bound_ctrl:0
    v_mfma_f32_32x32x16_bf16 v[144:159], v[196:199], v[84:87], v[144:159]
    ds_read_b64 v[228:229], v14 offset:2464
    ds_read_b64 v[230:231], v14 offset:2472
    v_and_b32_dpp v169, v169, v15 row_shr:1 row_mask:0xf bank_mask:0xf bound_ctrl:0
    v_and_b32_dpp v170, v170, v15 row_shr:1 row_mask:0xf bank_mask:0xf bound_ctrl:0
    v_and_b32_dpp v171, v171, v15 row_shr:1 row_mask:0xf bank_mask:0xf bound_ctrl:0
    v_mfma_f32_32x32x16_bf16 v[144:159], v[200:203], v[88:91], v[144:159]
    ds_read_b64 v[232:233], v14 offset:2496
    ds_read_b64 v[234:235], v14 offset:2504
    v_and_b32_dpp v172, v172, v15 row_shr:1 row_mask:0xf bank_mask:0xf bound_ctrl:0
    v_and_b32_dpp v173, v173, v15 row_shr:1 row_mask:0xf bank_mask:0xf bound_ctrl:0
    v_mfma_f32_32x32x16_bf16 v[144:159], v[204:207], v[92:95], v[144:159]
    ds_read_b64 v[236:237], v14 offset:2528
    ds_read_b64 v[238:239], v14 offset:2536
    v_and_b32_dpp v174, v174, v15 row_shr:1 row_mask:0xf bank_mask:0xf bound_ctrl:0
    v_and_b32_dpp v175, v175, v15 row_shr:1 row_mask:0xf bank_mask:0xf bound_ctrl:0
    v_mfma_f32_32x32x16_bf16 v[128:143], v[176:179], v[32:35], v[128:143]
    s_nop 4
    v_mfma_f32_32x32x16_bf16 v[128:143], v[180:183], v[36:39], v[128:143]
    s_nop 4
    v_mfma_f32_32x32x16_bf16 v[128:143], v[184:187], v[40:43], v[128:143]
    v_mov_b32_dpp v144, v144 row_shr:1 row_mask:0xf bank_mask:0xf bound_ctrl:0
    v_mov_b32_dpp v145, v145 row_shr:1 row_mask:0xf bank_mask:0xf bound_ctrl:0
    v_mov_b32_dpp v146, v146 row_shr:1 row_mask:0xf bank_mask:0xf bound_ctrl:0
    v_mfma_f32_32x32x16_bf16 v[128:143], v[188:191], v[44:47], v[128:143]
    v_mov_b32_dpp v147, v147 row_shr:1 row_mask:0xf bank_mask:0xf bound_ctrl:0
    v_mov_b32_dpp v148, v148 row_shr:1 row_mask:0xf bank_mask:0xf bound_ctrl:0
    v_mov_b32_dpp v149, v149 row_shr:1 row_mask:0xf bank_mask:0xf bound_ctrl:0
    v_mfma_f32_32x32x16_bf16 v[128:143], v[192:195], v[48:51], v[128:143]
    v_mov_b32_dpp v150, v150 row_shr:1 row_mask:0xf bank_mask:0xf bound_ctrl:0
    v_mov_b32_dpp v151, v151 row_shr:1 row_mask:0xf bank_mask:0xf bound_ctrl:0
    v_mov_b32_dpp v152, v152 row_shr:1 row_mask:0xf bank_mask:0xf bound_ctrl:0
    v_mfma_f32_32x32x16_bf16 v[128:143], v[196:199], v[52:55], v[128:143]
    v_mov_b32_dpp v153, v153 row_shr:1 row_mask:0xf bank_mask:0xf bound_ctrl:0
    v_mov_b32_dpp v154, v154 row_shr:1 row_mask:0xf bank_mask:0xf bound_ctrl:0
    v_mov_b32_dpp v155, v155 row_shr:1 row_mask:0xf bank_mask:0xf bound_ctrl:0
    v_mfma_f32_32x32x16_bf16 v[128:143], v[200:203], v[56:59], v[128:143]
    v_mov_b32_dpp v156, v156 row_shr:1 row_mask:0xf bank_mask:0xf bound_ctrl:0
    v_mov_b32_dpp v157, v157 row_shr:1 row_mask:0xf bank_mask:0xf bound_ctrl:0
    v_mfma_f32_32x32x16_bf16 v[128:143], v[204:207], v[60:63], v[128:143]
    v_mov_b32_dpp v158, v158 row_shr:1 row_mask:0xf bank_mask:0xf bound_ctrl:0
    v_mov_b32_dpp v159, v159 row_shr:1 row_mask:0xf bank_mask:0xf bound_ctrl:0
    s_waitcnt lgkmcnt(0)
    v_mfma_f32_32x32x16_bf16 v[160:175], v[208:211], v[96:99], v[160:175]
    ds_read_b64 v[176:177], v14 offset:0
    ds_read_b64 v[178:179], v14 offset:8
    ds_read_b64 v[180:181], v14 offset:32
    ds_read_b64 v[182:183], v14 offset:40
    s_nop 0
    v_mfma_f32_32x32x16_bf16 v[160:175], v[212:215], v[100:103], v[160:175]
    ds_read_b64 v[184:185], v14 offset:64
    ds_read_b64 v[186:187], v14 offset:72
    ds_read_b64 v[188:189], v14 offset:96
    s_nop 1
    v_mfma_f32_32x32x16_bf16 v[160:175], v[216:219], v[104:107], v[160:175]
    ds_read_b64 v[190:191], v14 offset:104
    ds_read_b64 v[192:193], v14 offset:128
    ds_read_b64 v[194:195], v14 offset:136
    v_mov_b32_dpp v128, v128 row_shr:1 row_mask:0xf bank_mask:0xf bound_ctrl:0
    v_mov_b32_dpp v129, v129 row_shr:1 row_mask:0xf bank_mask:0xf bound_ctrl:0
    v_mov_b32_dpp v130, v130 row_shr:1 row_mask:0xf bank_mask:0xf bound_ctrl:0
    v_mfma_f32_32x32x16_bf16 v[160:175], v[220:223], v[108:111], v[160:175]
    ds_read_b64 v[196:197], v14 offset:160
    ds_read_b64 v[198:199], v14 offset:168
    ds_read_b64 v[200:201], v14 offset:192
    v_mov_b32_dpp v131, v131 row_shr:1 row_mask:0xf bank_mask:0xf bound_ctrl:0
    v_mov_b32_dpp v132, v132 row_shr:1 row_mask:0xf bank_mask:0xf bound_ctrl:0
    v_mov_b32_dpp v133, v133 row_shr:1 row_mask:0xf bank_mask:0xf bound_ctrl:0
    v_mfma_f32_32x32x16_bf16 v[160:175], v[224:227], v[112:115], v[160:175]
    ds_read_b64 v[202:203], v14 offset:200
    ds_read_b64 v[204:205], v14 offset:224
    ds_read_b64 v[206:207], v14 offset:232
    v_mov_b32_dpp v134, v134 row_shr:1 row_mask:0xf bank_mask:0xf bound_ctrl:0
    v_mov_b32_dpp v135, v135 row_shr:1 row_mask:0xf bank_mask:0xf bound_ctrl:0
    v_mov_b32_dpp v136, v136 row_shr:1 row_mask:0xf bank_mask:0xf bound_ctrl:0
    v_mfma_f32_32x32x16_bf16 v[160:175], v[228:231], v[116:119], v[160:175]
    v_mov_b32_dpp v137, v137 row_shr:1 row_mask:0xf bank_mask:0xf bound_ctrl:0
    v_mov_b32_dpp v138, v138 row_shr:1 row_mask:0xf bank_mask:0xf bound_ctrl:0
    v_mov_b32_dpp v139, v139 row_shr:1 row_mask:0xf bank_mask:0xf bound_ctrl:0
    v_mfma_f32_32x32x16_bf16 v[160:175], v[232:235], v[120:123], v[160:175]
    v_mov_b32_dpp v140, v140 row_shr:1 row_mask:0xf bank_mask:0xf bound_ctrl:0
    v_mov_b32_dpp v141, v141 row_shr:1 row_mask:0xf bank_mask:0xf bound_ctrl:0
    v_mfma_f32_32x32x16_bf16 v[160:175], v[236:239], v[124:127], v[160:175]
    v_mov_b32_dpp v142, v142 row_shr:1 row_mask:0xf bank_mask:0xf bound_ctrl:0
    v_mov_b32_dpp v143, v143 row_shr:1 row_mask:0xf bank_mask:0xf bound_ctrl:0
    s_waitcnt lgkmcnt(0)
    v_mfma_f32_32x32x16_bf16 v[144:159], v[176:179], v[64:67], v[144:159]
    ds_read_b64 v[208:209], v14 offset:2048
    ds_read_b64 v[210:211], v14 offset:2056
    s_nop 2
    v_mfma_f32_32x32x16_bf16 v[144:159], v[180:183], v[68:71], v[144:159]
    ds_read_b64 v[212:213], v14 offset:2080
    ds_read_b64 v[214:215], v14 offset:2088
    s_nop 2
    v_mfma_f32_32x32x16_bf16 v[144:159], v[184:187], v[72:75], v[144:159]
    ds_read_b64 v[216:217], v14 offset:2112
    ds_read_b64 v[218:219], v14 offset:2120
    v_and_b32_dpp v160, v160, v15 row_shr:1 row_mask:0xf bank_mask:0xf bound_ctrl:0
    v_and_b32_dpp v161, v161, v15 row_shr:1 row_mask:0xf bank_mask:0xf bound_ctrl:0
    v_and_b32_dpp v162, v162, v15 row_shr:1 row_mask:0xf bank_mask:0xf bound_ctrl:0
    v_mfma_f32_32x32x16_bf16 v[144:159], v[188:191], v[76:79], v[144:159]
    ds_read_b64 v[220:221], v14 offset:2144
    ds_read_b64 v[222:223], v14 offset:2152
    v_and_b32_dpp v163, v163, v15 row_shr:1 row_mask:0xf bank_mask:0xf bound_ctrl:0
    v_and_b32_dpp v164, v164, v15 row_shr:1 row_mask:0xf bank_mask:0xf bound_ctrl:0
    v_and_b32_dpp v165, v165, v15 row_shr:1 row_mask:0xf bank_mask:0xf bound_ctrl:0
    v_mfma_f32_32x32x16_bf16 v[144:159], v[192:195], v[80:83], v[144:159]
    ds_read_b64 v[224:225], v14 offset:2176
    ds_read_b64 v[226:227], v14 offset:2184
    v_and_b32_dpp v166, v166, v15 row_shr:1 row_mask:0xf bank_mask:0xf bound_ctrl:0
    v_and_b32_dpp v167, v167, v15 row_shr:1 row_mask:0xf bank_mask:0xf bound_ctrl:0
    v_and_b32_dpp v168, v168, v15 row_shr:1 row_mask:0xf bank_mask:0xf bound_ctrl:0
    v_mfma_f32_32x32x16_bf16 v[144:159], v[196:199], v[84:87], v[144:159]
    ds_read_b64 v[228:229], v14 offset:2208
    ds_read_b64 v[230:231], v14 offset:2216
    v_and_b32_dpp v169, v169, v15 row_shr:1 row_mask:0xf bank_mask:0xf bound_ctrl:0
    v_and_b32_dpp v170, v170, v15 row_shr:1 row_mask:0xf bank_mask:0xf bound_ctrl:0
    v_and_b32_dpp v171, v171, v15 row_shr:1 row_mask:0xf bank_mask:0xf bound_ctrl:0
    v_mfma_f32_32x32x16_bf16 v[144:159], v[200:203], v[88:91], v[144:159]
    ds_read_b64 v[232:233], v14 offset:2240
    ds_read_b64 v[234:235], v14 offset:2248
    v_and_b32_dpp v172, v172, v15 row_shr:1 row_mask:0xf bank_mask:0xf bound_ctrl:0
    v_and_b32_dpp v173, v173, v15 row_shr:1 row_mask:0xf bank_mask:0xf bound_ctrl:0
    v_mfma_f32_32x32x16_bf16 v[144:159], v[204:207], v[92:95], v[144:159]
    ds_read_b64 v[236:237], v14 offset:2272
    ds_read_b64 v[238:239], v14 offset:2280
    v_and_b32_dpp v174, v174, v15 row_shr:1 row_mask:0xf bank_mask:0xf bound_ctrl:0
    v_and_b32_dpp v175, v175, v15 row_shr:1 row_mask:0xf bank_mask:0xf bound_ctrl:0
    v_mfma_f32_32x32x16_bf16 v[128:143], v[176:179], v[32:35], v[128:143]
    v_mfma_f32_32x32x16_bf16 v[128:143], v[180:183], v[36:39], v[128:143]
    v_mfma_f32_32x32x16_bf16 v[128:143], v[184:187], v[40:43], v[128:143]
    v_mfma_f32_32x32x16_bf16 v[128:143], v[188:191], v[44:47], v[128:143]
    v_mfma_f32_32x32x16_bf16 v[128:143], v[192:195], v[48:51], v[128:143]
    v_mfma_f32_32x32x16_bf16 v[128:143], v[196:199], v[52:55], v[128:143]
    v_mfma_f32_32x32x16_bf16 v[128:143], v[200:203], v[56:59], v[128:143]
    v_mfma_f32_32x32x16_bf16 v[128:143], v[204:207], v[60:63], v[128:143]
    s_waitcnt lgkmcnt(0)
    v_mfma_f32_32x32x16_bf16 v[160:175], v[208:211], v[96:99], v[160:175]
    v_mfma_f32_32x32x16_bf16 v[160:175], v[212:215], v[100:103], v[160:175]
    v_mfma_f32_32x32x16_bf16 v[160:175], v[216:219], v[104:107], v[160:175]
    v_mfma_f32_32x32x16_bf16 v[160:175], v[220:223], v[108:111], v[160:175]
    v_mfma_f32_32x32x16_bf16 v[160:175], v[224:227], v[112:115], v[160:175]
    v_mfma_f32_32x32x16_bf16 v[160:175], v[228:231], v[116:119], v[160:175]
    v_mfma_f32_32x32x16_bf16 v[160:175], v[232:235], v[120:123], v[160:175]
    v_mfma_f32_32x32x16_bf16 v[160:175], v[236:239], v[124:127], v[160:175]
    s_nop 11
    v_add_f32_dpp v128, v160, v128 row_shr:8 row_mask:0xf bank_mask:0xf bound_ctrl:0
    v_add_f32_dpp v129, v161, v129 row_shr:8 row_mask:0xf bank_mask:0xf bound_ctrl:0
    v_add_f32_dpp v130, v162, v130 row_shr:8 row_mask:0xf bank_mask:0xf bound_ctrl:0
    v_add_f32_dpp v131, v163, v131 row_shr:8 row_mask:0xf bank_mask:0xf bound_ctrl:0
    v_add_f32_dpp v132, v164, v132 row_shr:8 row_mask:0xf bank_mask:0xf bound_ctrl:0
    v_add_f32_dpp v133, v165, v133 row_shr:8 row_mask:0xf bank_mask:0xf bound_ctrl:0
    v_add_f32_dpp v134, v166, v134 row_shr:8 row_mask:0xf bank_mask:0xf bound_ctrl:0
    v_add_f32_dpp v135, v167, v135 row_shr:8 row_mask:0xf bank_mask:0xf bound_ctrl:0
    v_add_f32_dpp v136, v168, v136 row_shr:8 row_mask:0xf bank_mask:0xf bound_ctrl:0
    v_add_f32_dpp v137, v169, v137 row_shr:8 row_mask:0xf bank_mask:0xf bound_ctrl:0
    v_add_f32_dpp v138, v170, v138 row_shr:8 row_mask:0xf bank_mask:0xf bound_ctrl:0
    v_add_f32_dpp v139, v171, v139 row_shr:8 row_mask:0xf bank_mask:0xf bound_ctrl:0
    v_add_f32_dpp v140, v172, v140 row_shr:8 row_mask:0xf bank_mask:0xf bound_ctrl:0
    v_add_f32_dpp v141, v173, v141 row_shr:8 row_mask:0xf bank_mask:0xf bound_ctrl:0
    v_add_f32_dpp v142, v174, v142 row_shr:8 row_mask:0xf bank_mask:0xf bound_ctrl:0
    v_add_f32_dpp v143, v175, v143 row_shr:8 row_mask:0xf bank_mask:0xf bound_ctrl:0
    s_mov_b32 s42, 0xff00ff00
    s_mov_b32 s43, 0xff00ff00
    s_mov_b64 exec, s[42:43]
    v_add_f32 v144, v160, v144
    v_add_f32 v145, v161, v145
    v_add_f32 v146, v162, v146
    v_add_f32 v147, v163, v147
    v_add_f32 v148, v164, v148
    v_add_f32 v149, v165, v149
    v_add_f32 v150, v166, v150
    v_add_f32 v151, v167, v151
    v_add_f32 v152, v168, v152
    v_add_f32 v153, v169, v153
    v_add_f32 v154, v170, v154
    v_add_f32 v155, v171, v155
    v_add_f32 v156, v172, v156
    v_add_f32 v157, v173, v157
    v_add_f32 v158, v174, v158
    v_add_f32 v159, v175, v159
    s_mov_b64 exec, -1
    v_mul_u32_u24 v16, 264, v7
    v_lshl_add_u32 v16, v9, 5, v16
    v_lshl_add_u32 v16, v8, 2, v16
    v_add_u32 v16, s34, v16
    v_cvt_pk_bf16_f32 v32, v128, v144
    v_cvt_pk_bf16_f32 v33, v129, v145
    v_cvt_pk_bf16_f32 v34, v130, v146
    v_cvt_pk_bf16_f32 v35, v131, v147
    v_cvt_pk_bf16_f32 v36, v132, v148
    v_cvt_pk_bf16_f32 v37, v133, v149
    v_cvt_pk_bf16_f32 v38, v134, v150
    v_cvt_pk_bf16_f32 v39, v135, v151
    v_cvt_pk_bf16_f32 v40, v136, v152
    v_cvt_pk_bf16_f32 v41, v137, v153
    v_cvt_pk_bf16_f32 v42, v138, v154
    v_cvt_pk_bf16_f32 v43, v139, v155
    v_cvt_pk_bf16_f32 v44, v140, v156
    v_cvt_pk_bf16_f32 v45, v141, v157
    v_cvt_pk_bf16_f32 v46, v142, v158
    v_cvt_pk_bf16_f32 v47, v143, v159
    ds_write_b32 v16, v32 offset:0
    ds_write_b32 v16, v33 offset:8
    ds_write_b32 v16, v34 offset:16
    ds_write_b32 v16, v35 offset:24
    ds_write_b32 v16, v36 offset:64
    ds_write_b32 v16, v37 offset:72
    ds_write_b32 v16, v38 offset:80
    ds_write_b32 v16, v39 offset:88
    ds_write_b32 v16, v40 offset:128
    ds_write_b32 v16, v41 offset:136
    ds_write_b32 v16, v42 offset:144
    ds_write_b32 v16, v43 offset:152
    ds_write_b32 v16, v44 offset:192
    ds_write_b32 v16, v45 offset:200
    ds_write_b32 v16, v46 offset:208
    ds_write_b32 v16, v47 offset:216
    s_lshl_b32 s44, s32, 16
    s_and_b32 s45, s32, 0xffff0000
    s_lshl_b32 s46, s33, 16
    s_and_b32 s47, s33, 0xffff0000
    v_mul_u32_u24 v17, 264, v2
    v_lshl_add_u32 v17, v1, 2, v17
    s_waitcnt lgkmcnt(0)
    s_barrier
    v_mul_u32_u24 v19, 272, v2
    v_lshlrev_b32 v18, 2, v1
    v_sub_u32 v19, v19, v18
    v_add_u32 v19, 4604, v19
    ds_read_b32 v48, v17 offset:0
    ds_read_b32 v49, v17 offset:9472
    ds_read_b32 v50, v17 offset:18944
    ds_read_b32 v51, v17 offset:28416
    ds_read_b32 v52, v17 offset:1056
    ds_read_b32 v53, v17 offset:10528
    ds_read_b32 v54, v17 offset:20000
    ds_read_b32 v55, v17 offset:29472
    ds_read_b32 v56, v17 offset:2112
    ds_read_b32 v57, v17 offset:11584
    ds_read_b32 v58, v17 offset:21056
    ds_read_b32 v59, v17 offset:30528
    ds_read_b32 v60, v17 offset:3168
    ds_read_b32 v61, v17 offset:12640
    ds_read_b32 v62, v17 offset:22112
    ds_read_b32 v63, v17 offset:31584
    s_waitcnt lgkmcnt(0)
    ds_read_b32 v224, v19 offset:0
    ds_read_b32 v225, v19 offset:9472
    ds_read_b32 v226, v19 offset:18944
    ds_read_b32 v227, v19 offset:28416
    ds_read_b32 v228, v19 offset:1088
    ds_read_b32 v229, v19 offset:10560
    ds_read_b32 v230, v19 offset:20032
    ds_read_b32 v231, v19 offset:29504
    ds_read_b32 v232, v19 offset:2176
    ds_read_b32 v233, v19 offset:11648
    ds_read_b32 v234, v19 offset:21120
    ds_read_b32 v235, v19 offset:30592
    ds_read_b32 v236, v19 offset:3264
    ds_read_b32 v237, v19 offset:12736
    ds_read_b32 v238, v19 offset:22208
    ds_read_b32 v239, v19 offset:31680
    v_mov_b32 v28, s44
    v_mov_b32 v29, s45
    v_mov_b32 v30, s46
    v_mov_b32 v31, s47
    s_waitcnt vmcnt(0)
    v_accvgpr_read_b32 v176, a0
    v_accvgpr_read_b32 v144, a16
    v_accvgpr_read_b32 v177, a1
    v_accvgpr_read_b32 v145, a17
    v_accvgpr_read_b32 v178, a2
    v_accvgpr_read_b32 v146, a18
    v_accvgpr_read_b32 v179, a3
    v_accvgpr_read_b32 v147, a19
    v_accvgpr_read_b32 v180, a4
    v_accvgpr_read_b32 v148, a20
    v_accvgpr_read_b32 v181, a5
    v_accvgpr_read_b32 v149, a21
    v_accvgpr_read_b32 v182, a6
    v_accvgpr_read_b32 v150, a22
    v_accvgpr_read_b32 v183, a7
    v_accvgpr_read_b32 v151, a23
    v_accvgpr_read_b32 v184, a8
    v_accvgpr_read_b32 v152, a24
    v_accvgpr_read_b32 v185, a9
    v_accvgpr_read_b32 v153, a25
    v_accvgpr_read_b32 v186, a10
    v_accvgpr_read_b32 v154, a26
    v_accvgpr_read_b32 v187, a11
    v_accvgpr_read_b32 v155, a27
    v_accvgpr_read_b32 v188, a12
    v_accvgpr_read_b32 v156, a28
    v_accvgpr_read_b32 v189, a13
    v_accvgpr_read_b32 v157, a29
    v_accvgpr_read_b32 v190, a14
    v_accvgpr_read_b32 v158, a30
    v_accvgpr_read_b32 v191, a15
    v_accvgpr_read_b32 v159, a31
    v_mov_b32 v192, s68
    v_mov_b32 v193, s69
    v_mov_b32 v194, s70
    v_mov_b32 v195, s71
    v_mov_b32 v208, s72
    v_mov_b32 v209, s73
    v_mov_b32 v210, s74
    v_mov_b32 v211, s75
    v_mov_b32 v240, s76
    v_mov_b32 v241, s77
    v_mov_b32 v242, s78
    v_mov_b32 v243, s79
    v_add_f32 v192, s80, v192
    v_add_f32 v193, s81, v193
    v_add_f32 v194, s82, v194
    v_add_f32 v195, s83, v195
    v_add_f32 v208, s84, v208
    v_add_f32 v209, s85, v209
    v_add_f32 v210, s86, v210
    v_add_f32 v211, s87, v211
    v_add_f32 v240, s12, v240
    v_add_f32 v241, s13, v241
    v_add_f32 v242, s14, v242
    v_add_f32 v243, s15, v243
    v_add_f32 v192, s16, v192
    v_add_f32 v193, s17, v193
    v_add_f32 v194, s18, v194
    v_add_f32 v195, s19, v195
    v_add_f32 v208, s48, v208
    v_add_f32 v209, s49, v209
    v_add_f32 v210, s50, v210
    v_add_f32 v211, s51, v211
    v_add_f32 v240, s52, v240
    v_add_f32 v241, s53, v241
    v_add_f32 v242, s54, v242
    v_add_f32 v243, s55, v243
    v_add_f32 v192, s56, v192
    v_add_f32 v193, s57, v193
    v_add_f32 v194, s58, v194
    v_add_f32 v195, s59, v195
    v_add_f32 v208, s60, v208
    v_add_f32 v209, s61, v209
    v_add_f32 v210, s62, v210
    v_add_f32 v211, s63, v211
    v_add_f32 v240, s64, v240
    v_add_f32 v241, s65, v241
    v_add_f32 v242, s66, v242
    v_add_f32 v243, s67, v243
    v_cvt_pk_bf16_f32 v196, v192, v193
    v_lshlrev_b32 v192, 16, v196
    v_and_b32 v193, 0xffff0000, v196
    v_cvt_pk_bf16_f32 v196, v194, v195
    v_lshlrev_b32 v194, 16, v196
    v_and_b32 v195, 0xffff0000, v196
    v_cvt_pk_bf16_f32 v212, v208, v209
    v_lshlrev_b32 v208, 16, v212
    v_and_b32 v209, 0xffff0000, v212
    v_cvt_pk_bf16_f32 v212, v210, v211
    v_lshlrev_b32 v210, 16, v212
    v_and_b32 v211, 0xffff0000, v212
    v_cvt_pk_bf16_f32 v244, v240, v241
    v_lshlrev_b32 v240, 16, v244
    v_and_b32 v241, 0xffff0000, v244
    v_cvt_pk_bf16_f32 v244, v242, v243
    v_lshlrev_b32 v242, 16, v244
    v_and_b32 v243, 0xffff0000, v244
    v_add_f32 v208, 1.0, v208
    v_add_f32 v209, 1.0, v209
    v_add_f32 v210, 1.0, v210
    v_add_f32 v211, 1.0, v211
    v_cvt_pk_bf16_f32 v212, v208, v209
    v_lshlrev_b32 v208, 16, v212
    v_and_b32 v209, 0xffff0000, v212
    v_cvt_pk_bf16_f32 v212, v210, v211
    v_lshlrev_b32 v210, 16, v212
    v_and_b32 v211, 0xffff0000, v212
    v_mul_f32 v160, v208, v240
    v_mul_f32 v164, v192, v240
    v_mul_f32 v161, v209, v241
    v_mul_f32 v165, v193, v241
    v_mul_f32 v162, v210, v242
    v_mul_f32 v166, v194, v242
    v_mul_f32 v163, v211, v243
    v_mul_f32 v167, v195, v243
    s_waitcnt lgkmcnt(0)
    v_lshlrev_b32 v68, 16, v224
    v_and_b32 v64, 0xffff0000, v224
    v_lshlrev_b32 v69, 16, v225
    v_and_b32 v65, 0xffff0000, v225
    v_lshlrev_b32 v70, 16, v226
    v_and_b32 v66, 0xffff0000, v226
    v_lshlrev_b32 v71, 16, v227
    v_and_b32 v67, 0xffff0000, v227
    v_pk_mul_f32 v[64:65], v[64:65], v[28:29]
    v_pk_mul_f32 v[66:67], v[66:67], v[30:31]
    v_pk_mul_f32 v[68:69], v[68:69], v[28:29]
    v_pk_mul_f32 v[70:71], v[70:71], v[30:31]
    v_cvt_pk_bf16_f32 v72, v64, v65
    v_lshlrev_b32 v64, 16, v72
    v_and_b32 v65, 0xffff0000, v72
    v_cvt_pk_bf16_f32 v72, v66, v67
    v_lshlrev_b32 v66, 16, v72
    v_and_b32 v67, 0xffff0000, v72
    v_cvt_pk_bf16_f32 v72, v68, v69
    v_lshlrev_b32 v68, 16, v72
    v_and_b32 v69, 0xffff0000, v72
    v_cvt_pk_bf16_f32 v72, v70, v71
    v_lshlrev_b32 v70, 16, v72
    v_and_b32 v71, 0xffff0000, v72
    v_lshlrev_b32 v74, 16, v48
    v_and_b32 v78, 0xffff0000, v48
    v_lshlrev_b32 v75, 16, v49
    v_and_b32 v79, 0xffff0000, v49
    v_lshlrev_b32 v76, 16, v50
    v_and_b32 v80, 0xffff0000, v50
    v_lshlrev_b32 v77, 16, v51
    v_and_b32 v81, 0xffff0000, v51
    v_lshlrev_b32 v112, 16, v176
    v_and_b32 v113, 0xffff0000, v176
    v_lshlrev_b32 v114, 16, v177
    v_and_b32 v115, 0xffff0000, v177
    v_lshlrev_b32 v116, 16, v178
    v_and_b32 v117, 0xffff0000, v178
    v_lshlrev_b32 v118, 16, v179
    v_and_b32 v119, 0xffff0000, v179
    v_pk_add_f32 v[64:65], v[64:65], v[74:75]
    v_pk_add_f32 v[66:67], v[66:67], v[76:77]
    v_pk_add_f32 v[68:69], v[68:69], v[78:79]
    v_pk_add_f32 v[70:71], v[70:71], v[80:81]
    v_pk_fma_f32 v[120:121], v[112:113], v[144:145], v[144:145] op_sel:[0,1,0] op_sel_hi:[1,1,0]
    v_pk_fma_f32 v[122:123], v[114:115], v[144:145], v[144:145] op_sel:[0,1,0] op_sel_hi:[1,1,0]
    v_pk_fma_f32 v[124:125], v[116:117], v[146:147], v[146:147] op_sel:[0,1,0] op_sel_hi:[1,1,0]
    v_pk_fma_f32 v[126:127], v[118:119], v[146:147], v[146:147] op_sel:[0,1,0] op_sel_hi:[1,1,0]
    v_pk_fma_f32 v[120:121], v[120:121], v[160:161], v[164:165]
    v_pk_fma_f32 v[122:123], v[122:123], v[162:163], v[166:167]
    v_pk_fma_f32 v[124:125], v[124:125], v[160:161], v[164:165]
    v_pk_fma_f32 v[126:127], v[126:127], v[162:163], v[166:167]
    v_pk_fma_f32 v[64:65], v[64:65], v[120:121], v[112:113]
    v_pk_fma_f32 v[66:67], v[66:67], v[122:123], v[114:115]
    v_pk_fma_f32 v[68:69], v[68:69], v[124:125], v[116:117]
    v_pk_fma_f32 v[70:71], v[70:71], v[126:127], v[118:119]
    v_cvt_pk_bf16_f32 v96, v64, v65
    v_cvt_pk_bf16_f32 v97, v66, v67
    v_cvt_pk_bf16_f32 v98, v68, v69
    v_cvt_pk_bf16_f32 v99, v70, v71
    v_lshlrev_b32 v68, 16, v228
    v_and_b32 v64, 0xffff0000, v228
    v_lshlrev_b32 v69, 16, v229
    v_and_b32 v65, 0xffff0000, v229
    v_lshlrev_b32 v70, 16, v230
    v_and_b32 v66, 0xffff0000, v230
    v_lshlrev_b32 v71, 16, v231
    v_and_b32 v67, 0xffff0000, v231
    v_pk_mul_f32 v[64:65], v[64:65], v[28:29]
    v_pk_mul_f32 v[66:67], v[66:67], v[30:31]
    v_pk_mul_f32 v[68:69], v[68:69], v[28:29]
    v_pk_mul_f32 v[70:71], v[70:71], v[30:31]
    v_cvt_pk_bf16_f32 v72, v64, v65
    v_lshlrev_b32 v64, 16, v72
    v_and_b32 v65, 0xffff0000, v72
    v_cvt_pk_bf16_f32 v72, v66, v67
    v_lshlrev_b32 v66, 16, v72
    v_and_b32 v67, 0xffff0000, v72
    v_cvt_pk_bf16_f32 v72, v68, v69
    v_lshlrev_b32 v68, 16, v72
    v_and_b32 v69, 0xffff0000, v72
    v_cvt_pk_bf16_f32 v72, v70, v71
    v_lshlrev_b32 v70, 16, v72
    v_and_b32 v71, 0xffff0000, v72
    v_lshlrev_b32 v74, 16, v52
    v_and_b32 v78, 0xffff0000, v52
    v_lshlrev_b32 v75, 16, v53
    v_and_b32 v79, 0xffff0000, v53
    v_lshlrev_b32 v76, 16, v54
    v_and_b32 v80, 0xffff0000, v54
    v_lshlrev_b32 v77, 16, v55
    v_and_b32 v81, 0xffff0000, v55
    v_lshlrev_b32 v112, 16, v180
    v_and_b32 v113, 0xffff0000, v180
    v_lshlrev_b32 v114, 16, v181
    v_and_b32 v115, 0xffff0000, v181
    v_lshlrev_b32 v116, 16, v182
    v_and_b32 v117, 0xffff0000, v182
    v_lshlrev_b32 v118, 16, v183
    v_and_b32 v119, 0xffff0000, v183
    v_pk_add_f32 v[64:65], v[64:65], v[74:75]
    v_pk_add_f32 v[66:67], v[66:67], v[76:77]
    v_pk_add_f32 v[68:69], v[68:69], v[78:79]
    v_pk_add_f32 v[70:71], v[70:71], v[80:81]
    v_pk_fma_f32 v[120:121], v[112:113], v[148:149], v[148:149] op_sel:[0,1,0] op_sel_hi:[1,1,0]
    v_pk_fma_f32 v[122:123], v[114:115], v[148:149], v[148:149] op_sel:[0,1,0] op_sel_hi:[1,1,0]
    v_pk_fma_f32 v[124:125], v[116:117], v[150:151], v[150:151] op_sel:[0,1,0] op_sel_hi:[1,1,0]
    v_pk_fma_f32 v[126:127], v[118:119], v[150:151], v[150:151] op_sel:[0,1,0] op_sel_hi:[1,1,0]
    v_pk_fma_f32 v[120:121], v[120:121], v[160:161], v[164:165]
    v_pk_fma_f32 v[122:123], v[122:123], v[162:163], v[166:167]
    v_pk_fma_f32 v[124:125], v[124:125], v[160:161], v[164:165]
    v_pk_fma_f32 v[126:127], v[126:127], v[162:163], v[166:167]
    v_pk_fma_f32 v[64:65], v[64:65], v[120:121], v[112:113]
    v_pk_fma_f32 v[66:67], v[66:67], v[122:123], v[114:115]
    v_pk_fma_f32 v[68:69], v[68:69], v[124:125], v[116:117]
    v_pk_fma_f32 v[70:71], v[70:71], v[126:127], v[118:119]
    v_cvt_pk_bf16_f32 v100, v64, v65
    v_cvt_pk_bf16_f32 v101, v66, v67
    v_cvt_pk_bf16_f32 v102, v68, v69
    v_cvt_pk_bf16_f32 v103, v70, v71
    v_lshlrev_b32 v68, 16, v232
    v_and_b32 v64, 0xffff0000, v232
    v_lshlrev_b32 v69, 16, v233
    v_and_b32 v65, 0xffff0000, v233
    v_lshlrev_b32 v70, 16, v234
    v_and_b32 v66, 0xffff0000, v234
    v_lshlrev_b32 v71, 16, v235
    v_and_b32 v67, 0xffff0000, v235
    v_pk_mul_f32 v[64:65], v[64:65], v[28:29]
    v_pk_mul_f32 v[66:67], v[66:67], v[30:31]
    v_pk_mul_f32 v[68:69], v[68:69], v[28:29]
    v_pk_mul_f32 v[70:71], v[70:71], v[30:31]
    v_cvt_pk_bf16_f32 v72, v64, v65
    v_lshlrev_b32 v64, 16, v72
    v_and_b32 v65, 0xffff0000, v72
    v_cvt_pk_bf16_f32 v72, v66, v67
    v_lshlrev_b32 v66, 16, v72
    v_and_b32 v67, 0xffff0000, v72
    v_cvt_pk_bf16_f32 v72, v68, v69
    v_lshlrev_b32 v68, 16, v72
    v_and_b32 v69, 0xffff0000, v72
    v_cvt_pk_bf16_f32 v72, v70, v71
    v_lshlrev_b32 v70, 16, v72
    v_and_b32 v71, 0xffff0000, v72
    v_lshlrev_b32 v74, 16, v56
    v_and_b32 v78, 0xffff0000, v56
    v_lshlrev_b32 v75, 16, v57
    v_and_b32 v79, 0xffff0000, v57
    v_lshlrev_b32 v76, 16, v58
    v_and_b32 v80, 0xffff0000, v58
    v_lshlrev_b32 v77, 16, v59
    v_and_b32 v81, 0xffff0000, v59
    v_lshlrev_b32 v112, 16, v184
    v_and_b32 v113, 0xffff0000, v184
    v_lshlrev_b32 v114, 16, v185
    v_and_b32 v115, 0xffff0000, v185
    v_lshlrev_b32 v116, 16, v186
    v_and_b32 v117, 0xffff0000, v186
    v_lshlrev_b32 v118, 16, v187
    v_and_b32 v119, 0xffff0000, v187
    v_pk_add_f32 v[64:65], v[64:65], v[74:75]
    v_pk_add_f32 v[66:67], v[66:67], v[76:77]
    v_pk_add_f32 v[68:69], v[68:69], v[78:79]
    v_pk_add_f32 v[70:71], v[70:71], v[80:81]
    v_pk_fma_f32 v[120:121], v[112:113], v[152:153], v[152:153] op_sel:[0,1,0] op_sel_hi:[1,1,0]
    v_pk_fma_f32 v[122:123], v[114:115], v[152:153], v[152:153] op_sel:[0,1,0] op_sel_hi:[1,1,0]
    v_pk_fma_f32 v[124:125], v[116:117], v[154:155], v[154:155] op_sel:[0,1,0] op_sel_hi:[1,1,0]
    v_pk_fma_f32 v[126:127], v[118:119], v[154:155], v[154:155] op_sel:[0,1,0] op_sel_hi:[1,1,0]
    v_pk_fma_f32 v[120:121], v[120:121], v[160:161], v[164:165]
    v_pk_fma_f32 v[122:123], v[122:123], v[162:163], v[166:167]
    v_pk_fma_f32 v[124:125], v[124:125], v[160:161], v[164:165]
    v_pk_fma_f32 v[126:127], v[126:127], v[162:163], v[166:167]
    v_pk_fma_f32 v[64:65], v[64:65], v[120:121], v[112:113]
    v_pk_fma_f32 v[66:67], v[66:67], v[122:123], v[114:115]
    v_pk_fma_f32 v[68:69], v[68:69], v[124:125], v[116:117]
    v_pk_fma_f32 v[70:71], v[70:71], v[126:127], v[118:119]
    v_cvt_pk_bf16_f32 v104, v64, v65
    v_cvt_pk_bf16_f32 v105, v66, v67
    v_cvt_pk_bf16_f32 v106, v68, v69
    v_cvt_pk_bf16_f32 v107, v70, v71
    v_lshlrev_b32 v68, 16, v236
    v_and_b32 v64, 0xffff0000, v236
    v_lshlrev_b32 v69, 16, v237
    v_and_b32 v65, 0xffff0000, v237
    v_lshlrev_b32 v70, 16, v238
    v_and_b32 v66, 0xffff0000, v238
    v_lshlrev_b32 v71, 16, v239
    v_and_b32 v67, 0xffff0000, v239
    v_pk_mul_f32 v[64:65], v[64:65], v[28:29]
    v_pk_mul_f32 v[66:67], v[66:67], v[30:31]
    v_pk_mul_f32 v[68:69], v[68:69], v[28:29]
    v_pk_mul_f32 v[70:71], v[70:71], v[30:31]
    v_cvt_pk_bf16_f32 v72, v64, v65
    v_lshlrev_b32 v64, 16, v72
    v_and_b32 v65, 0xffff0000, v72
    v_cvt_pk_bf16_f32 v72, v66, v67
    v_lshlrev_b32 v66, 16, v72
    v_and_b32 v67, 0xffff0000, v72
    v_cvt_pk_bf16_f32 v72, v68, v69
    v_lshlrev_b32 v68, 16, v72
    v_and_b32 v69, 0xffff0000, v72
    v_cvt_pk_bf16_f32 v72, v70, v71
    v_lshlrev_b32 v70, 16, v72
    v_and_b32 v71, 0xffff0000, v72
    v_lshlrev_b32 v74, 16, v60
    v_and_b32 v78, 0xffff0000, v60
    v_lshlrev_b32 v75, 16, v61
    v_and_b32 v79, 0xffff0000, v61
    v_lshlrev_b32 v76, 16, v62
    v_and_b32 v80, 0xffff0000, v62
    v_lshlrev_b32 v77, 16, v63
    v_and_b32 v81, 0xffff0000, v63
    v_lshlrev_b32 v112, 16, v188
    v_and_b32 v113, 0xffff0000, v188
    v_lshlrev_b32 v114, 16, v189
    v_and_b32 v115, 0xffff0000, v189
    v_lshlrev_b32 v116, 16, v190
    v_and_b32 v117, 0xffff0000, v190
    v_lshlrev_b32 v118, 16, v191
    v_and_b32 v119, 0xffff0000, v191
    v_pk_add_f32 v[64:65], v[64:65], v[74:75]
    v_pk_add_f32 v[66:67], v[66:67], v[76:77]
    v_pk_add_f32 v[68:69], v[68:69], v[78:79]
    v_pk_add_f32 v[70:71], v[70:71], v[80:81]
    v_pk_fma_f32 v[120:121], v[112:113], v[156:157], v[156:157] op_sel:[0,1,0] op_sel_hi:[1,1,0]
    v_pk_fma_f32 v[122:123], v[114:115], v[156:157], v[156:157] op_sel:[0,1,0] op_sel_hi:[1,1,0]
    v_pk_fma_f32 v[124:125], v[116:117], v[158:159], v[158:159] op_sel:[0,1,0] op_sel_hi:[1,1,0]
    v_pk_fma_f32 v[126:127], v[118:119], v[158:159], v[158:159] op_sel:[0,1,0] op_sel_hi:[1,1,0]
    v_pk_fma_f32 v[120:121], v[120:121], v[160:161], v[164:165]
    v_pk_fma_f32 v[122:123], v[122:123], v[162:163], v[166:167]
    v_pk_fma_f32 v[124:125], v[124:125], v[160:161], v[164:165]
    v_pk_fma_f32 v[126:127], v[126:127], v[162:163], v[166:167]
    v_pk_fma_f32 v[64:65], v[64:65], v[120:121], v[112:113]
    v_pk_fma_f32 v[66:67], v[66:67], v[122:123], v[114:115]
    v_pk_fma_f32 v[68:69], v[68:69], v[124:125], v[116:117]
    v_pk_fma_f32 v[70:71], v[70:71], v[126:127], v[118:119]
    v_cvt_pk_bf16_f32 v108, v64, v65
    v_cvt_pk_bf16_f32 v109, v66, v67
    v_cvt_pk_bf16_f32 v110, v68, v69
    v_cvt_pk_bf16_f32 v111, v70, v71
    s_add_u32 s39, s38, 5492736
    buffer_store_dwordx4 v[96:99], v4, s[28:31], s39 offen sc1
    s_add_u32 s39, s39, 655360
    buffer_store_dwordx4 v[100:103], v4, s[28:31], s39 offen sc1
    s_add_u32 s39, s39, 655360
    buffer_store_dwordx4 v[104:107], v4, s[28:31], s39 offen sc1
    s_add_u32 s39, s39, 655360
    buffer_store_dwordx4 v[108:111], v4, s[28:31], s39 offen sc1
    s_add_u32 s39, s39, 655360
    s_waitcnt vmcnt(0)
    s_endpgm
k1_help:
    s_mul_i32 s21, s58, 12
    s_add_u32 s21, s21, s59
    s_sub_u32 s21, s21, 20
    s_mul_i32 s22, s20, 96
    s_add_u32 s21, s21, s22
    s_mul_i32 s34, s20, 9472
    s_cmp_lt_u32 s21, 120
    s_cbranch_scc1 k1_mod0
    s_sub_u32 s21, s21, 120
    s_cmp_lt_u32 s21, 154
    s_cbranch_scc1 k1_pack
    s_sub_u32 s21, s21, 154
    s_cmp_lt_u32 s21, 30
    s_cbranch_scc1 k1_fin
    s_endpgm
k1_mod0:
    s_add_u32 s21, s21, 120
k1_mod:
    s_lshr_b32 s32, s21, 2
    s_and_b32 s33, s21, 3
    v_lshrrev_b32 v4, 3, v1
    v_and_b32 v3, 7, v1
    s_mul_i32 s34, s33, 160
    v_add_u32 v4, s34, v4
    v_lshlrev_b32 v5, 1, v4
    v_mul_u32_u24 v6, 7680, v4
    s_lshl_b32 s36, s32, 7
    v_lshl_add_u32 v7, v3, 4, s36
    v_add_u32 v6, v6, v7
    s_mov_b32 s16, s52
    s_mov_b32 s17, s53
    s_mov_b32 s18, 1280
    s_mov_b32 s19, 0x00020000
    s_mov_b32 s24, s62
    s_mov_b32 s25, s63
    s_mov_b32 s26, 4915200
    s_mov_b32 s27, 0x00020000
    buffer_load_ushort v8, v5, s[16:19], 0 offen offset:0
    buffer_load_ushort v9, v5, s[16:19], 0 offen offset:16
    buffer_load_ushort v10, v5, s[16:19], 0 offen offset:32
    buffer_load_ushort v11, v5, s[16:19], 0 offen offset:48
    buffer_load_ushort v12, v5, s[16:19], 0 offen offset:64
    buffer_load_ushort v13, v5, s[16:19], 0 offen offset:80
    buffer_load_ushort v14, v5, s[16:19], 0 offen offset:96
    buffer_load_ushort v15, v5, s[16:19], 0 offen offset:112
    buffer_load_ushort v16, v5, s[16:19], 0 offen offset:128
    buffer_load_ushort v17, v5, s[16:19], 0 offen offset:144
    buffer_load_ushort v18, v5, s[16:19], 0 offen offset:160
    buffer_load_ushort v19, v5, s[16:19], 0 offen offset:176
    buffer_load_ushort v20, v5, s[16:19], 0 offen offset:192
    buffer_load_ushort v21, v5, s[16:19], 0 offen offset:208
    buffer_load_ushort v22, v5, s[16:19], 0 offen offset:224
    buffer_load_ushort v23, v5, s[16:19], 0 offen offset:240
    buffer_load_ushort v24, v5, s[16:19], 0 offen offset:256
    buffer_load_ushort v25, v5, s[16:19], 0 offen offset:272
    buffer_load_ushort v26, v5, s[16:19], 0 offen offset:288
    buffer_load_ushort v27, v5, s[16:19], 0 offen offset:304
    s_mov_b32 s37, 0
    buffer_load_dwordx4 v[32:35], v6, s[24:27], s37 offen nt
    s_add_u32 s37, s37, 61440
    buffer_load_dwordx4 v[36:39], v6, s[24:27], s37 offen nt
    s_add_u32 s37, s37, 61440
    buffer_load_dwordx4 v[40:43], v6, s[24:27], s37 offen nt
    s_add_u32 s37, s37, 61440
    buffer_load_dwordx4 v[44:47], v6, s[24:27], s37 offen nt
    s_add_u32 s37, s37, 61440
    buffer_load_dwordx4 v[48:51], v6, s[24:27], s37 offen nt
    s_add_u32 s37, s37, 61440
    buffer_load_dwordx4 v[52:55], v6, s[24:27], s37 offen nt
    s_add_u32 s37, s37, 61440
    buffer_load_dwordx4 v[56:59], v6, s[24:27], s37 offen nt
    s_add_u32 s37, s37, 61440
    buffer_load_dwordx4 v[60:63], v6, s[24:27], s37 offen nt
    s_add_u32 s37, s37, 61440
    buffer_load_dwordx4 v[64:67], v6, s[24:27], s37 offen nt
    s_add_u32 s37, s37, 61440
    buffer_load_dwordx4 v[68:71], v6, s[24:27], s37 offen nt
    s_add_u32 s37, s37, 61440
    buffer_load_dwordx4 v[72:75], v6, s[24:27], s37 offen nt
    s_add_u32 s37, s37, 61440
    buffer_load_dwordx4 v[76:79], v6, s[24:27], s37 offen nt
    s_add_u32 s37, s37, 61440
    buffer_load_dwordx4 v[80:83], v6, s[24:27], s37 offen nt
    s_add_u32 s37, s37, 61440
    buffer_load_dwordx4 v[84:87], v6, s[24:27], s37 offen nt
    s_add_u32 s37, s37, 61440
    buffer_load_dwordx4 v[88:91], v6, s[24:27], s37 offen nt
    s_add_u32 s37, s37, 61440
    buffer_load_dwordx4 v[92:95], v6, s[24:27], s37 offen nt
    s_add_u32 s37, s37, 61440
    buffer_load_dwordx4 v[96:99], v6, s[24:27], s37 offen nt
    s_add_u32 s37, s37, 61440
    buffer_load_dwordx4 v[100:103], v6, s[24:27], s37 offen nt
    s_add_u32 s37, s37, 61440
    buffer_load_dwordx4 v[104:107], v6, s[24:27], s37 offen nt
    s_add_u32 s37, s37, 61440
    buffer_load_dwordx4 v[108:111], v6, s[24:27], s37 offen nt
    s_waitcnt vmcnt(20)
    v_lshlrev_b32 v8, 16, v8
    v_lshlrev_b32 v9, 16, v9
    v_lshlrev_b32 v10, 16, v10
    v_lshlrev_b32 v11, 16, v11
    v_mul_f32 v120, 0xbfb8aa3b, v8
    v_mul_f32 v121, 0xbfb8aa3b, v9
    v_mul_f32 v122, 0xbfb8aa3b, v10
    v_mul_f32 v123, 0xbfb8aa3b, v11
    v_exp_f32 v120, v120
    v_exp_f32 v121, v121
    v_exp_f32 v122, v122
    v_exp_f32 v123, v123
    v_add_f32 v120, 1.0, v120
    v_add_f32 v121, 1.0, v121
    v_add_f32 v122, 1.0, v122
    v_add_f32 v123, 1.0, v123
    v_rcp_f32 v120, v120
    v_rcp_f32 v121, v121
    v_rcp_f32 v122, v122
    v_rcp_f32 v123, v123
    s_nop 0
    v_mul_f32 v8, v8, v120
    v_mul_f32 v9, v9, v121
    v_mul_f32 v10, v10, v122
    v_mul_f32 v11, v11, v123
    v_cvt_pk_bf16_f32 v120, v8, v9
    v_lshlrev_b32 v8, 16, v120
    v_and_b32 v9, 0xffff0000, v120
    v_cvt_pk_bf16_f32 v120, v10, v11
    v_lshlrev_b32 v10, 16, v120
    v_and_b32 v11, 0xffff0000, v120
    v_lshlrev_b32 v12, 16, v12
    v_lshlrev_b32 v13, 16, v13
    v_lshlrev_b32 v14, 16, v14
    v_lshlrev_b32 v15, 16, v15
    v_mul_f32 v120, 0xbfb8aa3b, v12
    v_mul_f32 v121, 0xbfb8aa3b, v13
    v_mul_f32 v122, 0xbfb8aa3b, v14
    v_mul_f32 v123, 0xbfb8aa3b, v15
    v_exp_f32 v120, v120
    v_exp_f32 v121, v121
    v_exp_f32 v122, v122
    v_exp_f32 v123, v123
    v_add_f32 v120, 1.0, v120
    v_add_f32 v121, 1.0, v121
    v_add_f32 v122, 1.0, v122
    v_add_f32 v123, 1.0, v123
    v_rcp_f32 v120, v120
    v_rcp_f32 v121, v121
    v_rcp_f32 v122, v122
    v_rcp_f32 v123, v123
    s_nop 0
    v_mul_f32 v12, v12, v120
    v_mul_f32 v13, v13, v121
    v_mul_f32 v14, v14, v122
    v_mul_f32 v15, v15, v123
    v_cvt_pk_bf16_f32 v120, v12, v13
    v_lshlrev_b32 v12, 16, v120
    v_and_b32 v13, 0xffff0000, v120
    v_cvt_pk_bf16_f32 v120, v14, v15
    v_lshlrev_b32 v14, 16, v120
    v_and_b32 v15, 0xffff0000, v120
    v_lshlrev_b32 v16, 16, v16
    v_lshlrev_b32 v17, 16, v17
    v_lshlrev_b32 v18, 16, v18
    v_lshlrev_b32 v19, 16, v19
    v_mul_f32 v120, 0xbfb8aa3b, v16
    v_mul_f32 v121, 0xbfb8aa3b, v17
    v_mul_f32 v122, 0xbfb8aa3b, v18
    v_mul_f32 v123, 0xbfb8aa3b, v19
    v_exp_f32 v120, v120
    v_exp_f32 v121, v121
    v_exp_f32 v122, v122
    v_exp_f32 v123, v123
    v_add_f32 v120, 1.0, v120
    v_add_f32 v121, 1.0, v121
    v_add_f32 v122, 1.0, v122
    v_add_f32 v123, 1.0, v123
    v_rcp_f32 v120, v120
    v_rcp_f32 v121, v121
    v_rcp_f32 v122, v122
    v_rcp_f32 v123, v123
    s_nop 0
    v_mul_f32 v16, v16, v120
    v_mul_f32 v17, v17, v121
    v_mul_f32 v18, v18, v122
    v_mul_f32 v19, v19, v123
    v_cvt_pk_bf16_f32 v120, v16, v17
    v_lshlrev_b32 v16, 16, v120
    v_and_b32 v17, 0xffff0000, v120
    v_cvt_pk_bf16_f32 v120, v18, v19
    v_lshlrev_b32 v18, 16, v120
    v_and_b32 v19, 0xffff0000, v120
    v_lshlrev_b32 v20, 16, v20
    v_lshlrev_b32 v21, 16, v21
    v_lshlrev_b32 v22, 16, v22
    v_lshlrev_b32 v23, 16, v23
    v_mul_f32 v120, 0xbfb8aa3b, v20
    v_mul_f32 v121, 0xbfb8aa3b, v21
    v_mul_f32 v122, 0xbfb8aa3b, v22
    v_mul_f32 v123, 0xbfb8aa3b, v23
    v_exp_f32 v120, v120
    v_exp_f32 v121, v121
    v_exp_f32 v122, v122
    v_exp_f32 v123, v123
    v_add_f32 v120, 1.0, v120
    v_add_f32 v121, 1.0, v121
    v_add_f32 v122, 1.0, v122
    v_add_f32 v123, 1.0, v123
    v_rcp_f32 v120, v120
    v_rcp_f32 v121, v121
    v_rcp_f32 v122, v122
    v_rcp_f32 v123, v123
    s_nop 0
    v_mul_f32 v20, v20, v120
    v_mul_f32 v21, v21, v121
    v_mul_f32 v22, v22, v122
    v_mul_f32 v23, v23, v123
    v_cvt_pk_bf16_f32 v120, v20, v21
    v_lshlrev_b32 v20, 16, v120
    v_and_b32 v21, 0xffff0000, v120
    v_cvt_pk_bf16_f32 v120, v22, v23
    v_lshlrev_b32 v22, 16, v120
    v_and_b32 v23, 0xffff0000, v120
    v_lshlrev_b32 v24, 16, v24
    v_lshlrev_b32 v25, 16, v25
    v_lshlrev_b32 v26, 16, v26
    v_lshlrev_b32 v27, 16, v27
    v_mul_f32 v120, 0xbfb8aa3b, v24
    v_mul_f32 v121, 0xbfb8aa3b, v25
    v_mul_f32 v122, 0xbfb8aa3b, v26
    v_mul_f32 v123, 0xbfb8aa3b, v27
    v_exp_f32 v120, v120
    v_exp_f32 v121, v121
    v_exp_f32 v122, v122
    v_exp_f32 v123, v123
    v_add_f32 v120, 1.0, v120
    v_add_f32 v121, 1.0, v121
    v_add_f32 v122, 1.0, v122
    v_add_f32 v123, 1.0, v123
    v_rcp_f32 v120, v120
    v_rcp_f32 v121, v121
    v_rcp_f32 v122, v122
    v_rcp_f32 v123, v123
    s_nop 0
    v_mul_f32 v24, v24, v120
    v_mul_f32 v25, v25, v121
    v_mul_f32 v26, v26, v122
    v_mul_f32 v27, v27, v123
    v_cvt_pk_bf16_f32 v120, v24, v25
    v_lshlrev_b32 v24, 16, v120
    v_and_b32 v25, 0xffff0000, v120
    v_cvt_pk_bf16_f32 v120, v26, v27
    v_lshlrev_b32 v26, 16, v120
    v_and_b32 v27, 0xffff0000, v120
    v_mov_b32 v112, 0
    v_mov_b32 v113, 0
    v_mov_b32 v114, 0
    v_mov_b32 v115, 0
    v_mov_b32 v116, 0
    v_mov_b32 v117, 0
    v_mov_b32 v118, 0
    v_mov_b32 v119, 0
    s_waitcnt vmcnt(19)
    v_lshlrev_b32 v120, 16, v32
    v_and_b32 v121, 0xffff0000, v32
    v_lshlrev_b32 v122, 16, v33
    v_and_b32 v123, 0xffff0000, v33
    v_lshlrev_b32 v124, 16, v34
    v_and_b32 v125, 0xffff0000, v34
    v_lshlrev_b32 v126, 16, v35
    v_and_b32 v127, 0xffff0000, v35
    v_pk_fma_f32 v[112:113], v[120:121], v[8:9], v[112:113] op_sel:[0,0,0] op_sel_hi:[1,0,1]
    v_pk_fma_f32 v[114:115], v[122:123], v[8:9], v[114:115] op_sel:[0,0,0] op_sel_hi:[1,0,1]
    v_pk_fma_f32 v[116:117], v[124:125], v[8:9], v[116:117] op_sel:[0,0,0] op_sel_hi:[1,0,1]
    v_pk_fma_f32 v[118:119], v[126:127], v[8:9], v[118:119] op_sel:[0,0,0] op_sel_hi:[1,0,1]
    s_waitcnt vmcnt(18)
    v_lshlrev_b32 v120, 16, v36
    v_and_b32 v121, 0xffff0000, v36
    v_lshlrev_b32 v122, 16, v37
    v_and_b32 v123, 0xffff0000, v37
    v_lshlrev_b32 v124, 16, v38
    v_and_b32 v125, 0xffff0000, v38
    v_lshlrev_b32 v126, 16, v39
    v_and_b32 v127, 0xffff0000, v39
    v_pk_fma_f32 v[112:113], v[120:121], v[8:9], v[112:113] op_sel:[0,1,0] op_sel_hi:[1,1,1]
    v_pk_fma_f32 v[114:115], v[122:123], v[8:9], v[114:115] op_sel:[0,1,0] op_sel_hi:[1,1,1]
    v_pk_fma_f32 v[116:117], v[124:125], v[8:9], v[116:117] op_sel:[0,1,0] op_sel_hi:[1,1,1]
    v_pk_fma_f32 v[118:119], v[126:127], v[8:9], v[118:119] op_sel:[0,1,0] op_sel_hi:[1,1,1]
    s_waitcnt vmcnt(17)
    v_lshlrev_b32 v120, 16, v40
    v_and_b32 v121, 0xffff0000, v40
    v_lshlrev_b32 v122, 16, v41
    v_and_b32 v123, 0xffff0000, v41
    v_lshlrev_b32 v124, 16, v42
    v_and_b32 v125, 0xffff0000, v42
    v_lshlrev_b32 v126, 16, v43
    v_and_b32 v127, 0xffff0000, v43
    v_pk_fma_f32 v[112:113], v[120:121], v[10:11], v[112:113] op_sel:[0,0,0] op_sel_hi:[1,0,1]
    v_pk_fma_f32 v[114:115], v[122:123], v[10:11], v[114:115] op_sel:[0,0,0] op_sel_hi:[1,0,1]
    v_pk_fma_f32 v[116:117], v[124:125], v[10:11], v[116:117] op_sel:[0,0,0] op_sel_hi:[1,0,1]
    v_pk_fma_f32 v[118:119], v[126:127], v[10:11], v[118:119] op_sel:[0,0,0] op_sel_hi:[1,0,1]
    s_waitcnt vmcnt(16)
    v_lshlrev_b32 v120, 16, v44
    v_and_b32 v121, 0xffff0000, v44
    v_lshlrev_b32 v122, 16, v45
    v_and_b32 v123, 0xffff0000, v45
    v_lshlrev_b32 v124, 16, v46
    v_and_b32 v125, 0xffff0000, v46
    v_lshlrev_b32 v126, 16, v47
    v_and_b32 v127, 0xffff0000, v47
    v_pk_fma_f32 v[112:113], v[120:121], v[10:11], v[112:113] op_sel:[0,1,0] op_sel_hi:[1,1,1]
    v_pk_fma_f32 v[114:115], v[122:123], v[10:11], v[114:115] op_sel:[0,1,0] op_sel_hi:[1,1,1]
    v_pk_fma_f32 v[116:117], v[124:125], v[10:11], v[116:117] op_sel:[0,1,0] op_sel_hi:[1,1,1]
    v_pk_fma_f32 v[118:119], v[126:127], v[10:11], v[118:119] op_sel:[0,1,0] op_sel_hi:[1,1,1]
    s_waitcnt vmcnt(15)
    v_lshlrev_b32 v120, 16, v48
    v_and_b32 v121, 0xffff0000, v48
    v_lshlrev_b32 v122, 16, v49
    v_and_b32 v123, 0xffff0000, v49
    v_lshlrev_b32 v124, 16, v50
    v_and_b32 v125, 0xffff0000, v50
    v_lshlrev_b32 v126, 16, v51
    v_and_b32 v127, 0xffff0000, v51
    v_pk_fma_f32 v[112:113], v[120:121], v[12:13], v[112:113] op_sel:[0,0,0] op_sel_hi:[1,0,1]
    v_pk_fma_f32 v[114:115], v[122:123], v[12:13], v[114:115] op_sel:[0,0,0] op_sel_hi:[1,0,1]
    v_pk_fma_f32 v[116:117], v[124:125], v[12:13], v[116:117] op_sel:[0,0,0] op_sel_hi:[1,0,1]
    v_pk_fma_f32 v[118:119], v[126:127], v[12:13], v[118:119] op_sel:[0,0,0] op_sel_hi:[1,0,1]
    s_waitcnt vmcnt(14)
    v_lshlrev_b32 v120, 16, v52
    v_and_b32 v121, 0xffff0000, v52
    v_lshlrev_b32 v122, 16, v53
    v_and_b32 v123, 0xffff0000, v53
    v_lshlrev_b32 v124, 16, v54
    v_and_b32 v125, 0xffff0000, v54
    v_lshlrev_b32 v126, 16, v55
    v_and_b32 v127, 0xffff0000, v55
    v_pk_fma_f32 v[112:113], v[120:121], v[12:13], v[112:113] op_sel:[0,1,0] op_sel_hi:[1,1,1]
    v_pk_fma_f32 v[114:115], v[122:123], v[12:13], v[114:115] op_sel:[0,1,0] op_sel_hi:[1,1,1]
    v_pk_fma_f32 v[116:117], v[124:125], v[12:13], v[116:117] op_sel:[0,1,0] op_sel_hi:[1,1,1]
    v_pk_fma_f32 v[118:119], v[126:127], v[12:13], v[118:119] op_sel:[0,1,0] op_sel_hi:[1,1,1]
    s_waitcnt vmcnt(13)
    v_lshlrev_b32 v120, 16, v56
    v_and_b32 v121, 0xffff0000, v56
    v_lshlrev_b32 v122, 16, v57
    v_and_b32 v123, 0xffff0000, v57
    v_lshlrev_b32 v124, 16, v58
    v_and_b32 v125, 0xffff0000, v58
    v_lshlrev_b32 v126, 16, v59
    v_and_b32 v127, 0xffff0000, v59
    v_pk_fma_f32 v[112:113], v[120:121], v[14:15], v[112:113] op_sel:[0,0,0] op_sel_hi:[1,0,1]
    v_pk_fma_f32 v[114:115], v[122:123], v[14:15], v[114:115] op_sel:[0,0,0] op_sel_hi:[1,0,1]
    v_pk_fma_f32 v[116:117], v[124:125], v[14:15], v[116:117] op_sel:[0,0,0] op_sel_hi:[1,0,1]
    v_pk_fma_f32 v[118:119], v[126:127], v[14:15], v[118:119] op_sel:[0,0,0] op_sel_hi:[1,0,1]
    s_waitcnt vmcnt(12)
    v_lshlrev_b32 v120, 16, v60
    v_and_b32 v121, 0xffff0000, v60
    v_lshlrev_b32 v122, 16, v61
    v_and_b32 v123, 0xffff0000, v61
    v_lshlrev_b32 v124, 16, v62
    v_and_b32 v125, 0xffff0000, v62
    v_lshlrev_b32 v126, 16, v63
    v_and_b32 v127, 0xffff0000, v63
    v_pk_fma_f32 v[112:113], v[120:121], v[14:15], v[112:113] op_sel:[0,1,0] op_sel_hi:[1,1,1]
    v_pk_fma_f32 v[114:115], v[122:123], v[14:15], v[114:115] op_sel:[0,1,0] op_sel_hi:[1,1,1]
    v_pk_fma_f32 v[116:117], v[124:125], v[14:15], v[116:117] op_sel:[0,1,0] op_sel_hi:[1,1,1]
    v_pk_fma_f32 v[118:119], v[126:127], v[14:15], v[118:119] op_sel:[0,1,0] op_sel_hi:[1,1,1]
    s_waitcnt vmcnt(11)
    v_lshlrev_b32 v120, 16, v64
    v_and_b32 v121, 0xffff0000, v64
    v_lshlrev_b32 v122, 16, v65
    v_and_b32 v123, 0xffff0000, v65
    v_lshlrev_b32 v124, 16, v66
    v_and_b32 v125, 0xffff0000, v66
    v_lshlrev_b32 v126, 16, v67
    v_and_b32 v127, 0xffff0000, v67
    v_pk_fma_f32 v[112:113], v[120:121], v[16:17], v[112:113] op_sel:[0,0,0] op_sel_hi:[1,0,1]
    v_pk_fma_f32 v[114:115], v[122:123], v[16:17], v[114:115] op_sel:[0,0,0] op_sel_hi:[1,0,1]
    v_pk_fma_f32 v[116:117], v[124:125], v[16:17], v[116:117] op_sel:[0,0,0] op_sel_hi:[1,0,1]
    v_pk_fma_f32 v[118:119], v[126:127], v[16:17], v[118:119] op_sel:[0,0,0] op_sel_hi:[1,0,1]
    s_waitcnt vmcnt(10)
    v_lshlrev_b32 v120, 16, v68
    v_and_b32 v121, 0xffff0000, v68
    v_lshlrev_b32 v122, 16, v69
    v_and_b32 v123, 0xffff0000, v69
    v_lshlrev_b32 v124, 16, v70
    v_and_b32 v125, 0xffff0000, v70
    v_lshlrev_b32 v126, 16, v71
    v_and_b32 v127, 0xffff0000, v71
    v_pk_fma_f32 v[112:113], v[120:121], v[16:17], v[112:113] op_sel:[0,1,0] op_sel_hi:[1,1,1]
    v_pk_fma_f32 v[114:115], v[122:123], v[16:17], v[114:115] op_sel:[0,1,0] op_sel_hi:[1,1,1]
    v_pk_fma_f32 v[116:117], v[124:125], v[16:17], v[116:117] op_sel:[0,1,0] op_sel_hi:[1,1,1]
    v_pk_fma_f32 v[118:119], v[126:127], v[16:17], v[118:119] op_sel:[0,1,0] op_sel_hi:[1,1,1]
    s_waitcnt vmcnt(9)
    v_lshlrev_b32 v120, 16, v72
    v_and_b32 v121, 0xffff0000, v72
    v_lshlrev_b32 v122, 16, v73
    v_and_b32 v123, 0xffff0000, v73
    v_lshlrev_b32 v124, 16, v74
    v_and_b32 v125, 0xffff0000, v74
    v_lshlrev_b32 v126, 16, v75
    v_and_b32 v127, 0xffff0000, v75
    v_pk_fma_f32 v[112:113], v[120:121], v[18:19], v[112:113] op_sel:[0,0,0] op_sel_hi:[1,0,1]
    v_pk_fma_f32 v[114:115], v[122:123], v[18:19], v[114:115] op_sel:[0,0,0] op_sel_hi:[1,0,1]
    v_pk_fma_f32 v[116:117], v[124:125], v[18:19], v[116:117] op_sel:[0,0,0] op_sel_hi:[1,0,1]
    v_pk_fma_f32 v[118:119], v[126:127], v[18:19], v[118:119] op_sel:[0,0,0] op_sel_hi:[1,0,1]
    s_waitcnt vmcnt(8)
    v_lshlrev_b32 v120, 16, v76
    v_and_b32 v121, 0xffff0000, v76
    v_lshlrev_b32 v122, 16, v77
    v_and_b32 v123, 0xffff0000, v77
    v_lshlrev_b32 v124, 16, v78
    v_and_b32 v125, 0xffff0000, v78
    v_lshlrev_b32 v126, 16, v79
    v_and_b32 v127, 0xffff0000, v79
    v_pk_fma_f32 v[112:113], v[120:121], v[18:19], v[112:113] op_sel:[0,1,0] op_sel_hi:[1,1,1]
    v_pk_fma_f32 v[114:115], v[122:123], v[18:19], v[114:115] op_sel:[0,1,0] op_sel_hi:[1,1,1]
    v_pk_fma_f32 v[116:117], v[124:125], v[18:19], v[116:117] op_sel:[0,1,0] op_sel_hi:[1,1,1]
    v_pk_fma_f32 v[118:119], v[126:127], v[18:19], v[118:119] op_sel:[0,1,0] op_sel_hi:[1,1,1]
    s_waitcnt vmcnt(7)
    v_lshlrev_b32 v120, 16, v80
    v_and_b32 v121, 0xffff0000, v80
    v_lshlrev_b32 v122, 16, v81
    v_and_b32 v123, 0xffff0000, v81
    v_lshlrev_b32 v124, 16, v82
    v_and_b32 v125, 0xffff0000, v82
    v_lshlrev_b32 v126, 16, v83
    v_and_b32 v127, 0xffff0000, v83
    v_pk_fma_f32 v[112:113], v[120:121], v[20:21], v[112:113] op_sel:[0,0,0] op_sel_hi:[1,0,1]
    v_pk_fma_f32 v[114:115], v[122:123], v[20:21], v[114:115] op_sel:[0,0,0] op_sel_hi:[1,0,1]
    v_pk_fma_f32 v[116:117], v[124:125], v[20:21], v[116:117] op_sel:[0,0,0] op_sel_hi:[1,0,1]
    v_pk_fma_f32 v[118:119], v[126:127], v[20:21], v[118:119] op_sel:[0,0,0] op_sel_hi:[1,0,1]
    s_waitcnt vmcnt(6)
    v_lshlrev_b32 v120, 16, v84
    v_and_b32 v121, 0xffff0000, v84
    v_lshlrev_b32 v122, 16, v85
    v_and_b32 v123, 0xffff0000, v85
    v_lshlrev_b32 v124, 16, v86
    v_and_b32 v125, 0xffff0000, v86
    v_lshlrev_b32 v126, 16, v87
    v_and_b32 v127, 0xffff0000, v87
    v_pk_fma_f32 v[112:113], v[120:121], v[20:21], v[112:113] op_sel:[0,1,0] op_sel_hi:[1,1,1]
    v_pk_fma_f32 v[114:115], v[122:123], v[20:21], v[114:115] op_sel:[0,1,0] op_sel_hi:[1,1,1]
    v_pk_fma_f32 v[116:117], v[124:125], v[20:21], v[116:117] op_sel:[0,1,0] op_sel_hi:[1,1,1]
    v_pk_fma_f32 v[118:119], v[126:127], v[20:21], v[118:119] op_sel:[0,1,0] op_sel_hi:[1,1,1]
    s_waitcnt vmcnt(5)
    v_lshlrev_b32 v120, 16, v88
    v_and_b32 v121, 0xffff0000, v88
    v_lshlrev_b32 v122, 16, v89
    v_and_b32 v123, 0xffff0000, v89
    v_lshlrev_b32 v124, 16, v90
    v_and_b32 v125, 0xffff0000, v90
    v_lshlrev_b32 v126, 16, v91
    v_and_b32 v127, 0xffff0000, v91
    v_pk_fma_f32 v[112:113], v[120:121], v[22:23], v[112:113] op_sel:[0,0,0] op_sel_hi:[1,0,1]
    v_pk_fma_f32 v[114:115], v[122:123], v[22:23], v[114:115] op_sel:[0,0,0] op_sel_hi:[1,0,1]
    v_pk_fma_f32 v[116:117], v[124:125], v[22:23], v[116:117] op_sel:[0,0,0] op_sel_hi:[1,0,1]
    v_pk_fma_f32 v[118:119], v[126:127], v[22:23], v[118:119] op_sel:[0,0,0] op_sel_hi:[1,0,1]
    s_waitcnt vmcnt(4)
    v_lshlrev_b32 v120, 16, v92
    v_and_b32 v121, 0xffff0000, v92
    v_lshlrev_b32 v122, 16, v93
    v_and_b32 v123, 0xffff0000, v93
    v_lshlrev_b32 v124, 16, v94
    v_and_b32 v125, 0xffff0000, v94
    v_lshlrev_b32 v126, 16, v95
    v_and_b32 v127, 0xffff0000, v95
    v_pk_fma_f32 v[112:113], v[120:121], v[22:23], v[112:113] op_sel:[0,1,0] op_sel_hi:[1,1,1]
    v_pk_fma_f32 v[114:115], v[122:123], v[22:23], v[114:115] op_sel:[0,1,0] op_sel_hi:[1,1,1]
    v_pk_fma_f32 v[116:117], v[124:125], v[22:23], v[116:117] op_sel:[0,1,0] op_sel_hi:[1,1,1]
    v_pk_fma_f32 v[118:119], v[126:127], v[22:23], v[118:119] op_sel:[0,1,0] op_sel_hi:[1,1,1]
    s_waitcnt vmcnt(3)
    v_lshlrev_b32 v120, 16, v96
    v_and_b32 v121, 0xffff0000, v96
    v_lshlrev_b32 v122, 16, v97
    v_and_b32 v123, 0xffff0000, v97
    v_lshlrev_b32 v124, 16, v98
    v_and_b32 v125, 0xffff0000, v98
    v_lshlrev_b32 v126, 16, v99
    v_and_b32 v127, 0xffff0000, v99
    v_pk_fma_f32 v[112:113], v[120:121], v[24:25], v[112:113] op_sel:[0,0,0] op_sel_hi:[1,0,1]
    v_pk_fma_f32 v[114:115], v[122:123], v[24:25], v[114:115] op_sel:[0,0,0] op_sel_hi:[1,0,1]
    v_pk_fma_f32 v[116:117], v[124:125], v[24:25], v[116:117] op_sel:[0,0,0] op_sel_hi:[1,0,1]
    v_pk_fma_f32 v[118:119], v[126:127], v[24:25], v[118:119] op_sel:[0,0,0] op_sel_hi:[1,0,1]
    s_waitcnt vmcnt(2)
    v_lshlrev_b32 v120, 16, v100
    v_and_b32 v121, 0xffff0000, v100
    v_lshlrev_b32 v122, 16, v101
    v_and_b32 v123, 0xffff0000, v101
    v_lshlrev_b32 v124, 16, v102
    v_and_b32 v125, 0xffff0000, v102
    v_lshlrev_b32 v126, 16, v103
    v_and_b32 v127, 0xffff0000, v103
    v_pk_fma_f32 v[112:113], v[120:121], v[24:25], v[112:113] op_sel:[0,1,0] op_sel_hi:[1,1,1]
    v_pk_fma_f32 v[114:115], v[122:123], v[24:25], v[114:115] op_sel:[0,1,0] op_sel_hi:[1,1,1]
    v_pk_fma_f32 v[116:117], v[124:125], v[24:25], v[116:117] op_sel:[0,1,0] op_sel_hi:[1,1,1]
    v_pk_fma_f32 v[118:119], v[126:127], v[24:25], v[118:119] op_sel:[0,1,0] op_sel_hi:[1,1,1]
    s_waitcnt vmcnt(1)
    v_lshlrev_b32 v120, 16, v104
    v_and_b32 v121, 0xffff0000, v104
    v_lshlrev_b32 v122, 16, v105
    v_and_b32 v123, 0xffff0000, v105
    v_lshlrev_b32 v124, 16, v106
    v_and_b32 v125, 0xffff0000, v106
    v_lshlrev_b32 v126, 16, v107
    v_and_b32 v127, 0xffff0000, v107
    v_pk_fma_f32 v[112:113], v[120:121], v[26:27], v[112:113] op_sel:[0,0,0] op_sel_hi:[1,0,1]
    v_pk_fma_f32 v[114:115], v[122:123], v[26:27], v[114:115] op_sel:[0,0,0] op_sel_hi:[1,0,1]
    v_pk_fma_f32 v[116:117], v[124:125], v[26:27], v[116:117] op_sel:[0,0,0] op_sel_hi:[1,0,1]
    v_pk_fma_f32 v[118:119], v[126:127], v[26:27], v[118:119] op_sel:[0,0,0] op_sel_hi:[1,0,1]
    s_waitcnt vmcnt(0)
    v_lshlrev_b32 v120, 16, v108
    v_and_b32 v121, 0xffff0000, v108
    v_lshlrev_b32 v122, 16, v109
    v_and_b32 v123, 0xffff0000, v109
    v_lshlrev_b32 v124, 16, v110
    v_and_b32 v125, 0xffff0000, v110
    v_lshlrev_b32 v126, 16, v111
    v_and_b32 v127, 0xffff0000, v111
    v_pk_fma_f32 v[112:113], v[120:121], v[26:27], v[112:113] op_sel:[0,1,0] op_sel_hi:[1,1,1]
    v_pk_fma_f32 v[114:115], v[122:123], v[26:27], v[114:115] op_sel:[0,1,0] op_sel_hi:[1,1,1]
    v_pk_fma_f32 v[116:117], v[124:125], v[26:27], v[116:117] op_sel:[0,1,0] op_sel_hi:[1,1,1]
    v_pk_fma_f32 v[118:119], v[126:127], v[26:27], v[118:119] op_sel:[0,1,0] op_sel_hi:[1,1,1]
    s_nop 1
    v_add_f32_dpp v112, v112, v112 row_ror:8 row_mask:0xf bank_mask:0xf
    v_add_f32_dpp v113, v113, v113 row_ror:8 row_mask:0xf bank_mask:0xf
    v_add_f32_dpp v114, v114, v114 row_ror:8 row_mask:0xf bank_mask:0xf
    v_add_f32_dpp v115, v115, v115 row_ror:8 row_mask:0xf bank_mask:0xf
    v_add_f32_dpp v116, v116, v116 row_ror:8 row_mask:0xf bank_mask:0xf
    v_add_f32_dpp v117, v117, v117 row_ror:8 row_mask:0xf bank_mask:0xf
    v_add_f32_dpp v118, v118, v118 row_ror:8 row_mask:0xf bank_mask:0xf
    v_add_f32_dpp v119, v119, v119 row_ror:8 row_mask:0xf bank_mask:0xf
    v_mov_b32 v120, v112
    v_mov_b32 v121, v113
    v_mov_b32 v122, v114
    v_mov_b32 v123, v115
    v_mov_b32 v124, v116
    v_mov_b32 v125, v117
    v_mov_b32 v126, v118
    v_mov_b32 v127, v119
    s_nop 1
    v_permlane32_swap_b32 v120, v112
    v_permlane32_swap_b32 v121, v113
    v_permlane32_swap_b32 v122, v114
    v_permlane32_swap_b32 v123, v115
    v_permlane32_swap_b32 v124, v116
    v_permlane32_swap_b32 v125, v117
    v_permlane32_swap_b32 v126, v118
    v_permlane32_swap_b32 v127, v119
    s_nop 1
    v_add_f32 v112, v112, v120
    v_add_f32 v113, v113, v121
    v_add_f32 v114, v114, v122
    v_add_f32 v115, v115, v123
    v_add_f32 v116, v116, v124
    v_add_f32 v117, v117, v125
    v_add_f32 v118, v118, v126
    v_add_f32 v119, v119, v127
    v_mov_b32 v120, v112
    v_mov_b32 v121, v113
    v_mov_b32 v122, v114
    v_mov_b32 v123, v115
    v_mov_b32 v124, v116
    v_mov_b32 v125, v117
    v_mov_b32 v126, v118
    v_mov_b32 v127, v119
    s_nop 1
    v_permlane16_swap_b32 v120, v112
    v_permlane16_swap_b32 v121, v113
    v_permlane16_swap_b32 v122, v114
    v_permlane16_swap_b32 v123, v115
    v_permlane16_swap_b32 v124, v116
    v_permlane16_swap_b32 v125, v117
    v_permlane16_swap_b32 v126, v118
    v_permlane16_swap_b32 v127, v119
    s_nop 1
    v_add_f32 v112, v112, v120
    v_add_f32 v113, v113, v121
    v_add_f32 v114, v114, v122
    v_add_f32 v115, v115, v123
    v_add_f32 v116, v116, v124
    v_add_f32 v117, v117, v125
    v_add_f32 v118, v118, v126
    v_add_f32 v119, v119, v127
    v_lshlrev_b32 v7, 5, v3
    s_mul_i32 s36, s33, 15360
    s_lshl_b32 s37, s32, 8
    s_add_u32 s37, s37, s36
    s_add_u32 s37, s37, 2793472
    s_lshl_b32 s44, s21, 7
    s_add_u32 s44, s44, 29593600
    s_mov_b64 exec, 0xff
    buffer_store_dwordx4 v[112:115], v7, s[28:31], s37 offen sc1
    buffer_store_dwordx4 v[116:119], v7, s[28:31], s37 offen offset:16 sc1
    s_mov_b64 exec, -1
    s_waitcnt vmcnt(0)
    v_mov_b32 v132, s46
    v_mov_b32 v133, 0
    s_mov_b64 exec, 1
    buffer_store_dword v132, v133, s[28:31], s44 offen sc1
    s_endpgm
k1_fin:
    s_add_u32 s21, s21, 30
    s_lshl_b32 s40, s21, 9
    s_add_u32 s40, s40, 29593600
    v_lshlrev_b32 v16, 7, v1
    s_mov_b32 s47, 0
    s_mov_b64 exec, 15
k1_kernel_pl1:
    buffer_load_dword v17, v16, s[28:31], s40 offen sc1
    s_add_u32 s47, s47, 1
    s_waitcnt vmcnt(0)
    v_cmp_ne_u32 vcc, s46, v17
    s_cmp_ge_u32 s47, 20000
    s_cbranch_scc1 k1_kernel_pd2
    s_cbranch_vccnz k1_kernel_pl1
k1_kernel_pd2:
    s_mov_b64 exec, -1
    v_lshlrev_b32 v7, 2, v1
    s_lshl_b32 s22, s21, 8
    s_add_u32 s23, s22, 2793472
    buffer_load_dword v10, v7, s[28:31], s23 offen sc1
    s_add_u32 s23, s23, 15360
    buffer_load_dword v11, v7, s[28:31], s23 offen sc1
    s_add_u32 s23, s23, 15360
    buffer_load_dword v12, v7, s[28:31], s23 offen sc1
    s_add_u32 s23, s23, 15360
    buffer_load_dword v13, v7, s[28:31], s23 offen sc1
    s_waitcnt vmcnt(0)
    v_add_f32 v10, v10, v11
    v_add_f32 v12, v12, v13
    s_nop 0
    v_add_f32 v10, v10, v12
    s_nop 0
    v_cvt_pk_bf16_f32 v10, v10, v10
    s_nop 0
    v_lshlrev_b32 v10, 16, v10
    s_sub_u32 s24, s21, 10
    s_cmp_lt_u32 s24, 10
    s_cbranch_scc1 k1_kernel_f13
    s_sub_u32 s24, s21, 40
    s_cmp_lt_u32 s24, 10
    s_cbranch_scc0 k1_kernel_f24
k1_kernel_f13:
    v_add_f32 v10, 1.0, v10
    s_nop 0
    v_cvt_pk_bf16_f32 v10, v10, v10
    s_nop 0
    v_lshlrev_b32 v10, 16, v10
k1_kernel_f24:
    s_add_u32 s22, s22, 8114176
    buffer_store_dword v10, v7, s[28:31], s22 offen sc1
    s_endpgm
k1_pack:
    v_lshrrev_b32 v3, 3, v1
    v_and_b32 v4, 7, v1
    v_mul_u32_u24 v5, 144, v3
    v_lshl_add_u32 v5, v4, 4, v5
    v_add_u32 v5, s34, v5
    v_and_b32 v6, 15, v1
    v_lshrrev_b32 v7, 4, v1
    v_lshrrev_b32 v8, 2, v6
    v_lshl_add_u32 v8, v7, 3, v8
    v_mul_u32_u24 v8, 144, v8
    v_and_b32 v9, 3, v6
    v_lshl_add_u32 v8, v9, 3, v8
    v_add_u32 v8, s34, v8
    v_lshlrev_b32 v9, 4, v1
    s_cmp_lt_u32 s21, 20
    s_cbranch_scc1 k1_kernel_pk5
    s_cmp_lt_u32 s21, 40
    s_cbranch_scc1 k1_kernel_pk6
    s_cmp_lt_u32 s21, 94
    s_cbranch_scc1 k1_kernel_pk7
    s_branch k1_kernel_pk8
k1_kernel_pk5:
    s_mov_b32 s24, s12
    s_mov_b32 s25, s13
    s_mov_b32 s26, 819200
    s_mov_b32 s27, 0x00020000
    s_sub_u32 s32, s21, 0
    s_mul_i32 s33, s32, 52429
    s_lshr_b32 s33, s33, 19
    s_mul_i32 s35, s33, 10
    s_sub_u32 s35, s32, s35
    v_mul_u32_u24 v10, 1280, v3
    v_lshl_add_u32 v10, v4, 4, v10
    s_mul_i32 s36, s33, 409600
    s_lshl_b32 s37, s35, 7
    s_add_u32 s36, s36, s37
    buffer_load_dwordx4 v[32:35], v10, s[24:27], s36 offen nt
    s_add_u32 s36, s36, 10240
    buffer_load_dwordx4 v[36:39], v10, s[24:27], s36 offen nt
    s_add_u32 s36, s36, 10240
    buffer_load_dwordx4 v[40:43], v10, s[24:27], s36 offen nt
    s_add_u32 s36, s36, 10240
    buffer_load_dwordx4 v[44:47], v10, s[24:27], s36 offen nt
    s_add_u32 s36, s36, 10240
    buffer_load_dwordx4 v[48:51], v10, s[24:27], s36 offen nt
    s_add_u32 s36, s36, 10240
    buffer_load_dwordx4 v[52:55], v10, s[24:27], s36 offen nt
    s_add_u32 s36, s36, 10240
    buffer_load_dwordx4 v[56:59], v10, s[24:27], s36 offen nt
    s_add_u32 s36, s36, 10240
    buffer_load_dwordx4 v[60:63], v10, s[24:27], s36 offen nt
    s_add_u32 s36, s36, 10240
    buffer_load_dwordx4 v[64:67], v10, s[24:27], s36 offen nt
    s_add_u32 s36, s36, 10240
    buffer_load_dwordx4 v[68:71], v10, s[24:27], s36 offen nt
    s_add_u32 s36, s36, 10240
    buffer_load_dwordx4 v[72:75], v10, s[24:27], s36 offen nt
    s_add_u32 s36, s36, 10240
    buffer_load_dwordx4 v[76:79], v10, s[24:27], s36 offen nt
    s_add_u32 s36, s36, 10240
    buffer_load_dwordx4 v[80:83], v10, s[24:27], s36 offen nt
    s_add_u32 s36, s36, 10240
    buffer_load_dwordx4 v[84:87], v10, s[24:27], s36 offen nt
    s_add_u32 s36, s36, 10240
    buffer_load_dwordx4 v[88:91], v10, s[24:27], s36 offen nt
    s_add_u32 s36, s36, 10240
    buffer_load_dwordx4 v[92:95], v10, s[24:27], s36 offen nt
    s_add_u32 s36, s36, 10240
    buffer_load_dwordx4 v[96:99], v10, s[24:27], s36 offen nt
    s_add_u32 s36, s36, 10240
    buffer_load_dwordx4 v[100:103], v10, s[24:27], s36 offen nt
    s_add_u32 s36, s36, 10240
    buffer_load_dwordx4 v[104:107], v10, s[24:27], s36 offen nt
    s_add_u32 s36, s36, 10240
    buffer_load_dwordx4 v[108:111], v10, s[24:27], s36 offen nt
    s_add_u32 s36, s36, 10240
    buffer_load_dwordx4 v[112:115], v10, s[24:27], s36 offen nt
    s_add_u32 s36, s36, 10240
    buffer_load_dwordx4 v[116:119], v10, s[24:27], s36 offen nt
    s_add_u32 s36, s36, 10240
    buffer_load_dwordx4 v[120:123], v10, s[24:27], s36 offen nt
    s_add_u32 s36, s36, 10240
    buffer_load_dwordx4 v[124:127], v10, s[24:27], s36 offen nt
    s_add_u32 s36, s36, 10240
    buffer_load_dwordx4 v[128:131], v10, s[24:27], s36 offen nt
    s_add_u32 s36, s36, 10240
    buffer_load_dwordx4 v[132:135], v10, s[24:27], s36 offen nt
    s_add_u32 s36, s36, 10240
    buffer_load_dwordx4 v[136:139], v10, s[24:27], s36 offen nt
    s_add_u32 s36, s36, 10240
    buffer_load_dwordx4 v[140:143], v10, s[24:27], s36 offen nt
    s_add_u32 s36, s36, 10240
    buffer_load_dwordx4 v[144:147], v10, s[24:27], s36 offen nt
    s_add_u32 s36, s36, 10240
    buffer_load_dwordx4 v[148:151], v10, s[24:27], s36 offen nt
    s_add_u32 s36, s36, 10240
    buffer_load_dwordx4 v[152:155], v10, s[24:27], s36 offen nt
    s_add_u32 s36, s36, 10240
    buffer_load_dwordx4 v[156:159], v10, s[24:27], s36 offen nt
    s_add_u32 s36, s36, 10240
    buffer_load_dwordx4 v[160:163], v10, s[24:27], s36 offen nt
    s_add_u32 s36, s36, 10240
    buffer_load_dwordx4 v[164:167], v10, s[24:27], s36 offen nt
    s_add_u32 s36, s36, 10240
    buffer_load_dwordx4 v[168:171], v10, s[24:27], s36 offen nt
    s_add_u32 s36, s36, 10240
    buffer_load_dwordx4 v[172:175], v10, s[24:27], s36 offen nt
    s_add_u32 s36, s36, 10240
    buffer_load_dwordx4 v[176:179], v10, s[24:27], s36 offen nt
    s_add_u32 s36, s36, 10240
    buffer_load_dwordx4 v[180:183], v10, s[24:27], s36 offen nt
    s_add_u32 s36, s36, 10240
    buffer_load_dwordx4 v[184:187], v10, s[24:27], s36 offen nt
    s_add_u32 s36, s36, 10240
    buffer_load_dwordx4 v[188:191], v10, s[24:27], s36 offen nt
    s_lshl_b32 s36, s35, 2
    s_add_u32 s36, s36, 0
    s_mul_i32 s38, s36, 6554
    s_lshr_b32 s38, s38, 16
    s_mul_i32 s39, s38, 10
    s_sub_u32 s39, s36, s39
    s_cmp_ge_u32 s39, 5
    s_cselect_b32 s40, 1, 0
    s_sub_u32 s41, s39, 6
    s_cmp_eq_u32 s39, 5
    s_cselect_b32 s41, 4, s41
    s_cmp_eq_u32 s40, 1
    s_cselect_b32 s39, s41, s39
    s_mul_i32 s37, s38, 200
    s_mul_i32 s40, s40, 100
    s_add_u32 s37, s37, s40
    s_mul_i32 s40, s33, 50
    s_add_u32 s37, s37, s40
    s_add_u32 s37, s37, s39
    s_lshl_b32 s37, s37, 10
    s_add_u32 s44, s37, 23236608
    s_movk_i32 s48, 5120
    s_lshl_b32 s36, s35, 2
    s_add_u32 s36, s36, 1
    s_mul_i32 s38, s36, 6554
    s_lshr_b32 s38, s38, 16
    s_mul_i32 s39, s38, 10
    s_sub_u32 s39, s36, s39
    s_cmp_ge_u32 s39, 5
    s_cselect_b32 s40, 1, 0
    s_sub_u32 s41, s39, 6
    s_cmp_eq_u32 s39, 5
    s_cselect_b32 s41, 4, s41
    s_cmp_eq_u32 s40, 1
    s_cselect_b32 s39, s41, s39
    s_mul_i32 s37, s38, 200
    s_mul_i32 s40, s40, 100
    s_add_u32 s37, s37, s40
    s_mul_i32 s40, s33, 50
    s_add_u32 s37, s37, s40
    s_add_u32 s37, s37, s39
    s_lshl_b32 s37, s37, 10
    s_add_u32 s45, s37, 23236608
    s_movk_i32 s49, 5120
    s_lshl_b32 s36, s35, 2
    s_add_u32 s36, s36, 2
    s_mul_i32 s38, s36, 6554
    s_lshr_b32 s38, s38, 16
    s_mul_i32 s39, s38, 10
    s_sub_u32 s39, s36, s39
    s_cmp_ge_u32 s39, 5
    s_cselect_b32 s40, 1, 0
    s_sub_u32 s41, s39, 6
    s_cmp_eq_u32 s39, 5
    s_cselect_b32 s41, 4, s41
    s_cmp_eq_u32 s40, 1
    s_cselect_b32 s39, s41, s39
    s_mul_i32 s37, s38, 200
    s_mul_i32 s40, s40, 100
    s_add_u32 s37, s37, s40
    s_mul_i32 s40, s33, 50
    s_add_u32 s37, s37, s40
    s_add_u32 s37, s37, s39
    s_lshl_b32 s37, s37, 10
    s_add_u32 s46, s37, 23236608
    s_movk_i32 s50, 5120
    s_lshl_b32 s36, s35, 2
    s_add_u32 s36, s36, 3
    s_mul_i32 s38, s36, 6554
    s_lshr_b32 s38, s38, 16
    s_mul_i32 s39, s38, 10
    s_sub_u32 s39, s36, s39
    s_cmp_ge_u32 s39, 5
    s_cselect_b32 s40, 1, 0
    s_sub_u32 s41, s39, 6
    s_cmp_eq_u32 s39, 5
    s_cselect_b32 s41, 4, s41
    s_cmp_eq_u32 s40, 1
    s_cselect_b32 s39, s41, s39
    s_mul_i32 s37, s38, 200
    s_mul_i32 s40, s40, 100
    s_add_u32 s37, s37, s40
    s_mul_i32 s40, s33, 50
    s_add_u32 s37, s37, s40
    s_add_u32 s37, s37, s39
    s_lshl_b32 s37, s37, 10
    s_add_u32 s47, s37, 23236608
    s_movk_i32 s51, 5120
    v_mov_b32 v12, 0
    v_mov_b32 v13, 0
    v_mov_b32 v14, 0
    v_mov_b32 v15, 0
    v_mov_b32 v16, 0x3f803f80
    s_waitcnt vmcnt(36)
    ds_write_b128 v5, v[32:35] offset:0
    ds_write_b128 v5, v[36:39] offset:1152
    ds_write_b128 v5, v[40:43] offset:2304
    ds_write_b128 v5, v[44:47] offset:3456
    s_waitcnt lgkmcnt(0)
    ds_read_b64_tr_b16 v[200:201], v8 offset:0
    ds_read_b64_tr_b16 v[202:203], v8 offset:576
    ds_read_b64_tr_b16 v[204:205], v8 offset:32
    ds_read_b64_tr_b16 v[206:207], v8 offset:608
    ds_read_b64_tr_b16 v[208:209], v8 offset:64
    ds_read_b64_tr_b16 v[210:211], v8 offset:640
    ds_read_b64_tr_b16 v[212:213], v8 offset:96
    ds_read_b64_tr_b16 v[214:215], v8 offset:672
    s_waitcnt vmcnt(32)
    ds_write_b128 v5, v[48:51] offset:4608
    ds_write_b128 v5, v[52:55] offset:5760
    ds_write_b128 v5, v[56:59] offset:6912
    ds_write_b128 v5, v[60:63] offset:8064
    s_waitcnt lgkmcnt(4)
    buffer_store_dwordx4 v[200:203], v9, s[28:31], s44 offen sc1
    s_add_u32 s44, s44, s48
    v_dot2_f32_bf16 v12, v200, v16, v12
    v_dot2_f32_bf16 v12, v201, v16, v12
    v_dot2_f32_bf16 v12, v202, v16, v12
    v_dot2_f32_bf16 v12, v203, v16, v12
    buffer_store_dwordx4 v[204:207], v9, s[28:31], s45 offen sc1
    s_add_u32 s45, s45, s49
    v_dot2_f32_bf16 v13, v204, v16, v13
    v_dot2_f32_bf16 v13, v205, v16, v13
    v_dot2_f32_bf16 v13, v206, v16, v13
    v_dot2_f32_bf16 v13, v207, v16, v13
    buffer_store_dwordx4 v[208:211], v9, s[28:31], s46 offen sc1
    s_add_u32 s46, s46, s50
    v_dot2_f32_bf16 v14, v208, v16, v14
    v_dot2_f32_bf16 v14, v209, v16, v14
    v_dot2_f32_bf16 v14, v210, v16, v14
    v_dot2_f32_bf16 v14, v211, v16, v14
    buffer_store_dwordx4 v[212:215], v9, s[28:31], s47 offen sc1
    s_add_u32 s47, s47, s51
    v_dot2_f32_bf16 v15, v212, v16, v15
    v_dot2_f32_bf16 v15, v213, v16, v15
    v_dot2_f32_bf16 v15, v214, v16, v15
    v_dot2_f32_bf16 v15, v215, v16, v15
    s_waitcnt lgkmcnt(0)
    ds_read_b64_tr_b16 v[216:217], v8 offset:4608
    ds_read_b64_tr_b16 v[218:219], v8 offset:5184
    ds_read_b64_tr_b16 v[220:221], v8 offset:4640
    ds_read_b64_tr_b16 v[222:223], v8 offset:5216
    ds_read_b64_tr_b16 v[224:225], v8 offset:4672
    ds_read_b64_tr_b16 v[226:227], v8 offset:5248
    ds_read_b64_tr_b16 v[228:229], v8 offset:4704
    ds_read_b64_tr_b16 v[230:231], v8 offset:5280
    s_waitcnt vmcnt(32)
    ds_write_b128 v5, v[64:67] offset:0
    ds_write_b128 v5, v[68:71] offset:1152
    ds_write_b128 v5, v[72:75] offset:2304
    ds_write_b128 v5, v[76:79] offset:3456
    s_waitcnt lgkmcnt(4)
    buffer_store_dwordx4 v[216:219], v9, s[28:31], s44 offen sc1
    s_add_u32 s44, s44, s48
    v_dot2_f32_bf16 v12, v216, v16, v12
    v_dot2_f32_bf16 v12, v217, v16, v12
    v_dot2_f32_bf16 v12, v218, v16, v12
    v_dot2_f32_bf16 v12, v219, v16, v12
    buffer_store_dwordx4 v[220:223], v9, s[28:31], s45 offen sc1
    s_add_u32 s45, s45, s49
    v_dot2_f32_bf16 v13, v220, v16, v13
    v_dot2_f32_bf16 v13, v221, v16, v13
    v_dot2_f32_bf16 v13, v222, v16, v13
    v_dot2_f32_bf16 v13, v223, v16, v13
    buffer_store_dwordx4 v[224:227], v9, s[28:31], s46 offen sc1
    s_add_u32 s46, s46, s50
    v_dot2_f32_bf16 v14, v224, v16, v14
    v_dot2_f32_bf16 v14, v225, v16, v14
    v_dot2_f32_bf16 v14, v226, v16, v14
    v_dot2_f32_bf16 v14, v227, v16, v14
    buffer_store_dwordx4 v[228:231], v9, s[28:31], s47 offen sc1
    s_add_u32 s47, s47, s51
    v_dot2_f32_bf16 v15, v228, v16, v15
    v_dot2_f32_bf16 v15, v229, v16, v15
    v_dot2_f32_bf16 v15, v230, v16, v15
    v_dot2_f32_bf16 v15, v231, v16, v15
    s_waitcnt lgkmcnt(0)
    ds_read_b64_tr_b16 v[200:201], v8 offset:0
    ds_read_b64_tr_b16 v[202:203], v8 offset:576
    ds_read_b64_tr_b16 v[204:205], v8 offset:32
    ds_read_b64_tr_b16 v[206:207], v8 offset:608
    ds_read_b64_tr_b16 v[208:209], v8 offset:64
    ds_read_b64_tr_b16 v[210:211], v8 offset:640
    ds_read_b64_tr_b16 v[212:213], v8 offset:96
    ds_read_b64_tr_b16 v[214:215], v8 offset:672
    s_waitcnt vmcnt(32)
    ds_write_b128 v5, v[80:83] offset:4608
    ds_write_b128 v5, v[84:87] offset:5760
    ds_write_b128 v5, v[88:91] offset:6912
    ds_write_b128 v5, v[92:95] offset:8064
    s_waitcnt lgkmcnt(4)
    buffer_store_dwordx4 v[200:203], v9, s[28:31], s44 offen sc1
    s_add_u32 s44, s44, s48
    v_dot2_f32_bf16 v12, v200, v16, v12
    v_dot2_f32_bf16 v12, v201, v16, v12
    v_dot2_f32_bf16 v12, v202, v16, v12
    v_dot2_f32_bf16 v12, v203, v16, v12
    buffer_store_dwordx4 v[204:207], v9, s[28:31], s45 offen sc1
    s_add_u32 s45, s45, s49
    v_dot2_f32_bf16 v13, v204, v16, v13
    v_dot2_f32_bf16 v13, v205, v16, v13
    v_dot2_f32_bf16 v13, v206, v16, v13
    v_dot2_f32_bf16 v13, v207, v16, v13
    buffer_store_dwordx4 v[208:211], v9, s[28:31], s46 offen sc1
    s_add_u32 s46, s46, s50
    v_dot2_f32_bf16 v14, v208, v16, v14
    v_dot2_f32_bf16 v14, v209, v16, v14
    v_dot2_f32_bf16 v14, v210, v16, v14
    v_dot2_f32_bf16 v14, v211, v16, v14
    buffer_store_dwordx4 v[212:215], v9, s[28:31], s47 offen sc1
    s_add_u32 s47, s47, s51
    v_dot2_f32_bf16 v15, v212, v16, v15
    v_dot2_f32_bf16 v15, v213, v16, v15
    v_dot2_f32_bf16 v15, v214, v16, v15
    v_dot2_f32_bf16 v15, v215, v16, v15
    s_waitcnt lgkmcnt(0)
    ds_read_b64_tr_b16 v[216:217], v8 offset:4608
    ds_read_b64_tr_b16 v[218:219], v8 offset:5184
    ds_read_b64_tr_b16 v[220:221], v8 offset:4640
    ds_read_b64_tr_b16 v[222:223], v8 offset:5216
    ds_read_b64_tr_b16 v[224:225], v8 offset:4672
    ds_read_b64_tr_b16 v[226:227], v8 offset:5248
    ds_read_b64_tr_b16 v[228:229], v8 offset:4704
    ds_read_b64_tr_b16 v[230:231], v8 offset:5280
    s_waitcnt vmcnt(32)
    ds_write_b128 v5, v[96:99] offset:0
    ds_write_b128 v5, v[100:103] offset:1152
    ds_write_b128 v5, v[104:107] offset:2304
    ds_write_b128 v5, v[108:111] offset:3456
    s_waitcnt lgkmcnt(4)
    buffer_store_dwordx4 v[216:219], v9, s[28:31], s44 offen sc1
    s_add_u32 s44, s44, s48
    v_dot2_f32_bf16 v12, v216, v16, v12
    v_dot2_f32_bf16 v12, v217, v16, v12
    v_dot2_f32_bf16 v12, v218, v16, v12
    v_dot2_f32_bf16 v12, v219, v16, v12
    buffer_store_dwordx4 v[220:223], v9, s[28:31], s45 offen sc1
    s_add_u32 s45, s45, s49
    v_dot2_f32_bf16 v13, v220, v16, v13
    v_dot2_f32_bf16 v13, v221, v16, v13
    v_dot2_f32_bf16 v13, v222, v16, v13
    v_dot2_f32_bf16 v13, v223, v16, v13
    buffer_store_dwordx4 v[224:227], v9, s[28:31], s46 offen sc1
    s_add_u32 s46, s46, s50
    v_dot2_f32_bf16 v14, v224, v16, v14
    v_dot2_f32_bf16 v14, v225, v16, v14
    v_dot2_f32_bf16 v14, v226, v16, v14
    v_dot2_f32_bf16 v14, v227, v16, v14
    buffer_store_dwordx4 v[228:231], v9, s[28:31], s47 offen sc1
    s_add_u32 s47, s47, s51
    v_dot2_f32_bf16 v15, v228, v16, v15
    v_dot2_f32_bf16 v15, v229, v16, v15
    v_dot2_f32_bf16 v15, v230, v16, v15
    v_dot2_f32_bf16 v15, v231, v16, v15
    s_waitcnt lgkmcnt(0)
    ds_read_b64_tr_b16 v[200:201], v8 offset:0
    ds_read_b64_tr_b16 v[202:203], v8 offset:576
    ds_read_b64_tr_b16 v[204:205], v8 offset:32
    ds_read_b64_tr_b16 v[206:207], v8 offset:608
    ds_read_b64_tr_b16 v[208:209], v8 offset:64
    ds_read_b64_tr_b16 v[210:211], v8 offset:640
    ds_read_b64_tr_b16 v[212:213], v8 offset:96
    ds_read_b64_tr_b16 v[214:215], v8 offset:672
    s_waitcnt vmcnt(32)
    ds_write_b128 v5, v[112:115] offset:4608
    ds_write_b128 v5, v[116:119] offset:5760
    ds_write_b128 v5, v[120:123] offset:6912
    ds_write_b128 v5, v[124:127] offset:8064
    s_waitcnt lgkmcnt(4)
    buffer_store_dwordx4 v[200:203], v9, s[28:31], s44 offen sc1
    s_add_u32 s44, s44, s48
    v_dot2_f32_bf16 v12, v200, v16, v12
    v_dot2_f32_bf16 v12, v201, v16, v12
    v_dot2_f32_bf16 v12, v202, v16, v12
    v_dot2_f32_bf16 v12, v203, v16, v12
    buffer_store_dwordx4 v[204:207], v9, s[28:31], s45 offen sc1
    s_add_u32 s45, s45, s49
    v_dot2_f32_bf16 v13, v204, v16, v13
    v_dot2_f32_bf16 v13, v205, v16, v13
    v_dot2_f32_bf16 v13, v206, v16, v13
    v_dot2_f32_bf16 v13, v207, v16, v13
    buffer_store_dwordx4 v[208:211], v9, s[28:31], s46 offen sc1
    s_add_u32 s46, s46, s50
    v_dot2_f32_bf16 v14, v208, v16, v14
    v_dot2_f32_bf16 v14, v209, v16, v14
    v_dot2_f32_bf16 v14, v210, v16, v14
    v_dot2_f32_bf16 v14, v211, v16, v14
    buffer_store_dwordx4 v[212:215], v9, s[28:31], s47 offen sc1
    s_add_u32 s47, s47, s51
    v_dot2_f32_bf16 v15, v212, v16, v15
    v_dot2_f32_bf16 v15, v213, v16, v15
    v_dot2_f32_bf16 v15, v214, v16, v15
    v_dot2_f32_bf16 v15, v215, v16, v15
    s_waitcnt lgkmcnt(0)
    ds_read_b64_tr_b16 v[216:217], v8 offset:4608
    ds_read_b64_tr_b16 v[218:219], v8 offset:5184
    ds_read_b64_tr_b16 v[220:221], v8 offset:4640
    ds_read_b64_tr_b16 v[222:223], v8 offset:5216
    ds_read_b64_tr_b16 v[224:225], v8 offset:4672
    ds_read_b64_tr_b16 v[226:227], v8 offset:5248
    ds_read_b64_tr_b16 v[228:229], v8 offset:4704
    ds_read_b64_tr_b16 v[230:231], v8 offset:5280
    s_waitcnt vmcnt(32)
    ds_write_b128 v5, v[128:131] offset:0
    ds_write_b128 v5, v[132:135] offset:1152
    ds_write_b128 v5, v[136:139] offset:2304
    ds_write_b128 v5, v[140:143] offset:3456
    s_waitcnt lgkmcnt(4)
    buffer_store_dwordx4 v[216:219], v9, s[28:31], s44 offen sc1
    s_add_u32 s44, s44, s48
    v_dot2_f32_bf16 v12, v216, v16, v12
    v_dot2_f32_bf16 v12, v217, v16, v12
    v_dot2_f32_bf16 v12, v218, v16, v12
    v_dot2_f32_bf16 v12, v219, v16, v12
    buffer_store_dwordx4 v[220:223], v9, s[28:31], s45 offen sc1
    s_add_u32 s45, s45, s49
    v_dot2_f32_bf16 v13, v220, v16, v13
    v_dot2_f32_bf16 v13, v221, v16, v13
    v_dot2_f32_bf16 v13, v222, v16, v13
    v_dot2_f32_bf16 v13, v223, v16, v13
    buffer_store_dwordx4 v[224:227], v9, s[28:31], s46 offen sc1
    s_add_u32 s46, s46, s50
    v_dot2_f32_bf16 v14, v224, v16, v14
    v_dot2_f32_bf16 v14, v225, v16, v14
    v_dot2_f32_bf16 v14, v226, v16, v14
    v_dot2_f32_bf16 v14, v227, v16, v14
    buffer_store_dwordx4 v[228:231], v9, s[28:31], s47 offen sc1
    s_add_u32 s47, s47, s51
    v_dot2_f32_bf16 v15, v228, v16, v15
    v_dot2_f32_bf16 v15, v229, v16, v15
    v_dot2_f32_bf16 v15, v230, v16, v15
    v_dot2_f32_bf16 v15, v231, v16, v15
    s_waitcnt lgkmcnt(0)
    ds_read_b64_tr_b16 v[200:201], v8 offset:0
    ds_read_b64_tr_b16 v[202:203], v8 offset:576
    ds_read_b64_tr_b16 v[204:205], v8 offset:32
    ds_read_b64_tr_b16 v[206:207], v8 offset:608
    ds_read_b64_tr_b16 v[208:209], v8 offset:64
    ds_read_b64_tr_b16 v[210:211], v8 offset:640
    ds_read_b64_tr_b16 v[212:213], v8 offset:96
    ds_read_b64_tr_b16 v[214:215], v8 offset:672
    s_waitcnt vmcnt(32)
    ds_write_b128 v5, v[144:147] offset:4608
    ds_write_b128 v5, v[148:151] offset:5760
    ds_write_b128 v5, v[152:155] offset:6912
    ds_write_b128 v5, v[156:159] offset:8064
    s_waitcnt lgkmcnt(4)
    buffer_store_dwordx4 v[200:203], v9, s[28:31], s44 offen sc1
    s_add_u32 s44, s44, s48
    v_dot2_f32_bf16 v12, v200, v16, v12
    v_dot2_f32_bf16 v12, v201, v16, v12
    v_dot2_f32_bf16 v12, v202, v16, v12
    v_dot2_f32_bf16 v12, v203, v16, v12
    buffer_store_dwordx4 v[204:207], v9, s[28:31], s45 offen sc1
    s_add_u32 s45, s45, s49
    v_dot2_f32_bf16 v13, v204, v16, v13
    v_dot2_f32_bf16 v13, v205, v16, v13
    v_dot2_f32_bf16 v13, v206, v16, v13
    v_dot2_f32_bf16 v13, v207, v16, v13
    buffer_store_dwordx4 v[208:211], v9, s[28:31], s46 offen sc1
    s_add_u32 s46, s46, s50
    v_dot2_f32_bf16 v14, v208, v16, v14
    v_dot2_f32_bf16 v14, v209, v16, v14
    v_dot2_f32_bf16 v14, v210, v16, v14
    v_dot2_f32_bf16 v14, v211, v16, v14
    buffer_store_dwordx4 v[212:215], v9, s[28:31], s47 offen sc1
    s_add_u32 s47, s47, s51
    v_dot2_f32_bf16 v15, v212, v16, v15
    v_dot2_f32_bf16 v15, v213, v16, v15
    v_dot2_f32_bf16 v15, v214, v16, v15
    v_dot2_f32_bf16 v15, v215, v16, v15
    s_waitcnt lgkmcnt(0)
    ds_read_b64_tr_b16 v[216:217], v8 offset:4608
    ds_read_b64_tr_b16 v[218:219], v8 offset:5184
    ds_read_b64_tr_b16 v[220:221], v8 offset:4640
    ds_read_b64_tr_b16 v[222:223], v8 offset:5216
    ds_read_b64_tr_b16 v[224:225], v8 offset:4672
    ds_read_b64_tr_b16 v[226:227], v8 offset:5248
    ds_read_b64_tr_b16 v[228:229], v8 offset:4704
    ds_read_b64_tr_b16 v[230:231], v8 offset:5280
    s_waitcnt vmcnt(32)
    ds_write_b128 v5, v[160:163] offset:0
    ds_write_b128 v5, v[164:167] offset:1152
    ds_write_b128 v5, v[168:171] offset:2304
    ds_write_b128 v5, v[172:175] offset:3456
    s_waitcnt lgkmcnt(4)
    buffer_store_dwordx4 v[216:219], v9, s[28:31], s44 offen sc1
    s_add_u32 s44, s44, s48
    v_dot2_f32_bf16 v12, v216, v16, v12
    v_dot2_f32_bf16 v12, v217, v16, v12
    v_dot2_f32_bf16 v12, v218, v16, v12
    v_dot2_f32_bf16 v12, v219, v16, v12
    buffer_store_dwordx4 v[220:223], v9, s[28:31], s45 offen sc1
    s_add_u32 s45, s45, s49
    v_dot2_f32_bf16 v13, v220, v16, v13
    v_dot2_f32_bf16 v13, v221, v16, v13
    v_dot2_f32_bf16 v13, v222, v16, v13
    v_dot2_f32_bf16 v13, v223, v16, v13
    buffer_store_dwordx4 v[224:227], v9, s[28:31], s46 offen sc1
    s_add_u32 s46, s46, s50
    v_dot2_f32_bf16 v14, v224, v16, v14
    v_dot2_f32_bf16 v14, v225, v16, v14
    v_dot2_f32_bf16 v14, v226, v16, v14
    v_dot2_f32_bf16 v14, v227, v16, v14
    buffer_store_dwordx4 v[228:231], v9, s[28:31], s47 offen sc1
    s_add_u32 s47, s47, s51
    v_dot2_f32_bf16 v15, v228, v16, v15
    v_dot2_f32_bf16 v15, v229, v16, v15
    v_dot2_f32_bf16 v15, v230, v16, v15
    v_dot2_f32_bf16 v15, v231, v16, v15
    s_waitcnt lgkmcnt(0)
    ds_read_b64_tr_b16 v[200:201], v8 offset:0
    ds_read_b64_tr_b16 v[202:203], v8 offset:576
    ds_read_b64_tr_b16 v[204:205], v8 offset:32
    ds_read_b64_tr_b16 v[206:207], v8 offset:608
    ds_read_b64_tr_b16 v[208:209], v8 offset:64
    ds_read_b64_tr_b16 v[210:211], v8 offset:640
    ds_read_b64_tr_b16 v[212:213], v8 offset:96
    ds_read_b64_tr_b16 v[214:215], v8 offset:672
    s_waitcnt vmcnt(32)
    ds_write_b128 v5, v[176:179] offset:4608
    ds_write_b128 v5, v[180:183] offset:5760
    ds_write_b128 v5, v[184:187] offset:6912
    ds_write_b128 v5, v[188:191] offset:8064
    s_waitcnt lgkmcnt(4)
    buffer_store_dwordx4 v[200:203], v9, s[28:31], s44 offen sc1
    s_add_u32 s44, s44, s48
    v_dot2_f32_bf16 v12, v200, v16, v12
    v_dot2_f32_bf16 v12, v201, v16, v12
    v_dot2_f32_bf16 v12, v202, v16, v12
    v_dot2_f32_bf16 v12, v203, v16, v12
    buffer_store_dwordx4 v[204:207], v9, s[28:31], s45 offen sc1
    s_add_u32 s45, s45, s49
    v_dot2_f32_bf16 v13, v204, v16, v13
    v_dot2_f32_bf16 v13, v205, v16, v13
    v_dot2_f32_bf16 v13, v206, v16, v13
    v_dot2_f32_bf16 v13, v207, v16, v13
    buffer_store_dwordx4 v[208:211], v9, s[28:31], s46 offen sc1
    s_add_u32 s46, s46, s50
    v_dot2_f32_bf16 v14, v208, v16, v14
    v_dot2_f32_bf16 v14, v209, v16, v14
    v_dot2_f32_bf16 v14, v210, v16, v14
    v_dot2_f32_bf16 v14, v211, v16, v14
    buffer_store_dwordx4 v[212:215], v9, s[28:31], s47 offen sc1
    s_add_u32 s47, s47, s51
    v_dot2_f32_bf16 v15, v212, v16, v15
    v_dot2_f32_bf16 v15, v213, v16, v15
    v_dot2_f32_bf16 v15, v214, v16, v15
    v_dot2_f32_bf16 v15, v215, v16, v15
    s_waitcnt lgkmcnt(0)
    ds_read_b64_tr_b16 v[216:217], v8 offset:4608
    ds_read_b64_tr_b16 v[218:219], v8 offset:5184
    ds_read_b64_tr_b16 v[220:221], v8 offset:4640
    ds_read_b64_tr_b16 v[222:223], v8 offset:5216
    ds_read_b64_tr_b16 v[224:225], v8 offset:4672
    ds_read_b64_tr_b16 v[226:227], v8 offset:5248
    ds_read_b64_tr_b16 v[228:229], v8 offset:4704
    ds_read_b64_tr_b16 v[230:231], v8 offset:5280
    s_waitcnt lgkmcnt(0)
    buffer_store_dwordx4 v[216:219], v9, s[28:31], s44 offen sc1
    s_add_u32 s44, s44, s48
    v_dot2_f32_bf16 v12, v216, v16, v12
    v_dot2_f32_bf16 v12, v217, v16, v12
    v_dot2_f32_bf16 v12, v218, v16, v12
    v_dot2_f32_bf16 v12, v219, v16, v12
    buffer_store_dwordx4 v[220:223], v9, s[28:31], s45 offen sc1
    s_add_u32 s45, s45, s49
    v_dot2_f32_bf16 v13, v220, v16, v13
    v_dot2_f32_bf16 v13, v221, v16, v13
    v_dot2_f32_bf16 v13, v222, v16, v13
    v_dot2_f32_bf16 v13, v223, v16, v13
    buffer_store_dwordx4 v[224:227], v9, s[28:31], s46 offen sc1
    s_add_u32 s46, s46, s50
    v_dot2_f32_bf16 v14, v224, v16, v14
    v_dot2_f32_bf16 v14, v225, v16, v14
    v_dot2_f32_bf16 v14, v226, v16, v14
    v_dot2_f32_bf16 v14, v227, v16, v14
    buffer_store_dwordx4 v[228:231], v9, s[28:31], s47 offen sc1
    s_add_u32 s47, s47, s51
    v_dot2_f32_bf16 v15, v228, v16, v15
    v_dot2_f32_bf16 v15, v229, v16, v15
    v_dot2_f32_bf16 v15, v230, v16, v15
    v_dot2_f32_bf16 v15, v231, v16, v15
    s_nop 2
    v_mov_b32 v20, v12
    v_mov_b32 v21, v13
    v_mov_b32 v22, v14
    v_mov_b32 v23, v15
    s_nop 1
    v_permlane32_swap_b32 v20, v12
    v_permlane32_swap_b32 v21, v13
    v_permlane32_swap_b32 v22, v14
    v_permlane32_swap_b32 v23, v15
    s_nop 1
    v_add_f32 v12, v12, v20
    v_add_f32 v13, v13, v21
    v_add_f32 v14, v14, v22
    v_add_f32 v15, v15, v23
    v_mov_b32 v20, v12
    v_mov_b32 v21, v13
    v_mov_b32 v22, v14
    v_mov_b32 v23, v15
    s_nop 1
    v_permlane16_swap_b32 v20, v12
    v_permlane16_swap_b32 v21, v13
    v_permlane16_swap_b32 v22, v14
    v_permlane16_swap_b32 v23, v15
    s_nop 1
    v_add_f32 v12, v12, v20
    v_add_f32 v13, v13, v21
    v_add_f32 v14, v14, v22
    v_add_f32 v15, v15, v23
    s_mul_i32 s38, s33, 7168
    s_lshl_b32 s39, s35, 8
    s_add_u32 s38, s38, s39
    s_add_u32 s38, s38, 8146944
    v_lshlrev_b32 v17, 2, v1
    s_mov_b64 exec, 0xffff
    buffer_store_dword v12, v17, s[28:31], s38 offen offset:0 sc1
    buffer_store_dword v13, v17, s[28:31], s38 offen offset:64 sc1
    buffer_store_dword v14, v17, s[28:31], s38 offen offset:128 sc1
    buffer_store_dword v15, v17, s[28:31], s38 offen offset:192 sc1
    s_endpgm
k1_kernel_pk6:
    s_mov_b32 s24, s14
    s_mov_b32 s25, s15
    s_mov_b32 s26, 819200
    s_mov_b32 s27, 0x00020000
    s_sub_u32 s32, s21, 20
    s_mul_i32 s33, s32, 52429
    s_lshr_b32 s33, s33, 19
    s_mul_i32 s35, s33, 10
    s_sub_u32 s35, s32, s35
    v_mul_u32_u24 v10, 1280, v3
    v_lshl_add_u32 v10, v4, 4, v10
    s_mul_i32 s36, s33, 409600
    s_lshl_b32 s37, s35, 7
    s_add_u32 s36, s36, s37
    buffer_load_dwordx4 v[32:35], v10, s[24:27], s36 offen nt
    s_add_u32 s36, s36, 10240
    buffer_load_dwordx4 v[36:39], v10, s[24:27], s36 offen nt
    s_add_u32 s36, s36, 10240
    buffer_load_dwordx4 v[40:43], v10, s[24:27], s36 offen nt
    s_add_u32 s36, s36, 10240
    buffer_load_dwordx4 v[44:47], v10, s[24:27], s36 offen nt
    s_add_u32 s36, s36, 10240
    buffer_load_dwordx4 v[48:51], v10, s[24:27], s36 offen nt
    s_add_u32 s36, s36, 10240
    buffer_load_dwordx4 v[52:55], v10, s[24:27], s36 offen nt
    s_add_u32 s36, s36, 10240
    buffer_load_dwordx4 v[56:59], v10, s[24:27], s36 offen nt
    s_add_u32 s36, s36, 10240
    buffer_load_dwordx4 v[60:63], v10, s[24:27], s36 offen nt
    s_add_u32 s36, s36, 10240
    buffer_load_dwordx4 v[64:67], v10, s[24:27], s36 offen nt
    s_add_u32 s36, s36, 10240
    buffer_load_dwordx4 v[68:71], v10, s[24:27], s36 offen nt
    s_add_u32 s36, s36, 10240
    buffer_load_dwordx4 v[72:75], v10, s[24:27], s36 offen nt
    s_add_u32 s36, s36, 10240
    buffer_load_dwordx4 v[76:79], v10, s[24:27], s36 offen nt
    s_add_u32 s36, s36, 10240
    buffer_load_dwordx4 v[80:83], v10, s[24:27], s36 offen nt
    s_add_u32 s36, s36, 10240
    buffer_load_dwordx4 v[84:87], v10, s[24:27], s36 offen nt
    s_add_u32 s36, s36, 10240
    buffer_load_dwordx4 v[88:91], v10, s[24:27], s36 offen nt
    s_add_u32 s36, s36, 10240
    buffer_load_dwordx4 v[92:95], v10, s[24:27], s36 offen nt
    s_add_u32 s36, s36, 10240
    buffer_load_dwordx4 v[96:99], v10, s[24:27], s36 offen nt
    s_add_u32 s36, s36, 10240
    buffer_load_dwordx4 v[100:103], v10, s[24:27], s36 offen nt
    s_add_u32 s36, s36, 10240
    buffer_load_dwordx4 v[104:107], v10, s[24:27], s36 offen nt
    s_add_u32 s36, s36, 10240
    buffer_load_dwordx4 v[108:111], v10, s[24:27], s36 offen nt
    s_add_u32 s36, s36, 10240
    buffer_load_dwordx4 v[112:115], v10, s[24:27], s36 offen nt
    s_add_u32 s36, s36, 10240
    buffer_load_dwordx4 v[116:119], v10, s[24:27], s36 offen nt
    s_add_u32 s36, s36, 10240
    buffer_load_dwordx4 v[120:123], v10, s[24:27], s36 offen nt
    s_add_u32 s36, s36, 10240
    buffer_load_dwordx4 v[124:127], v10, s[24:27], s36 offen nt
    s_add_u32 s36, s36, 10240
    buffer_load_dwordx4 v[128:131], v10, s[24:27], s36 offen nt
    s_add_u32 s36, s36, 10240
    buffer_load_dwordx4 v[132:135], v10, s[24:27], s36 offen nt
    s_add_u32 s36, s36, 10240
    buffer_load_dwordx4 v[136:139], v10, s[24:27], s36 offen nt
    s_add_u32 s36, s36, 10240
    buffer_load_dwordx4 v[140:143], v10, s[24:27], s36 offen nt
    s_add_u32 s36, s36, 10240
    buffer_load_dwordx4 v[144:147], v10, s[24:27], s36 offen nt
    s_add_u32 s36, s36, 10240
    buffer_load_dwordx4 v[148:151], v10, s[24:27], s36 offen nt
    s_add_u32 s36, s36, 10240
    buffer_load_dwordx4 v[152:155], v10, s[24:27], s36 offen nt
    s_add_u32 s36, s36, 10240
    buffer_load_dwordx4 v[156:159], v10, s[24:27], s36 offen nt
    s_add_u32 s36, s36, 10240
    buffer_load_dwordx4 v[160:163], v10, s[24:27], s36 offen nt
    s_add_u32 s36, s36, 10240
    buffer_load_dwordx4 v[164:167], v10, s[24:27], s36 offen nt
    s_add_u32 s36, s36, 10240
    buffer_load_dwordx4 v[168:171], v10, s[24:27], s36 offen nt
    s_add_u32 s36, s36, 10240
    buffer_load_dwordx4 v[172:175], v10, s[24:27], s36 offen nt
    s_add_u32 s36, s36, 10240
    buffer_load_dwordx4 v[176:179], v10, s[24:27], s36 offen nt
    s_add_u32 s36, s36, 10240
    buffer_load_dwordx4 v[180:183], v10, s[24:27], s36 offen nt
    s_add_u32 s36, s36, 10240
    buffer_load_dwordx4 v[184:187], v10, s[24:27], s36 offen nt
    s_add_u32 s36, s36, 10240
    buffer_load_dwordx4 v[188:191], v10, s[24:27], s36 offen nt
    s_lshl_b32 s36, s35, 2
    s_add_u32 s36, s36, 0
    s_mul_i32 s38, s36, 6554
    s_lshr_b32 s38, s38, 16
    s_mul_i32 s39, s38, 10
    s_sub_u32 s39, s36, s39
    s_cmp_ge_u32 s39, 5
    s_cselect_b32 s40, 1, 0
    s_sub_u32 s41, s39, 6
    s_cmp_eq_u32 s39, 5
    s_cselect_b32 s41, 4, s41
    s_cmp_eq_u32 s40, 1
    s_cselect_b32 s39, s41, s39
    s_mul_i32 s37, s38, 200
    s_mul_i32 s40, s40, 100
    s_add_u32 s37, s37, s40
    s_mul_i32 s40, s33, 50
    s_add_u32 s37, s37, s40
    s_add_u32 s37, s37, s39
    s_lshl_b32 s37, s37, 10
    s_add_u32 s44, s37, 24055808
    s_movk_i32 s48, 5120
    s_lshl_b32 s36, s35, 2
    s_add_u32 s36, s36, 1
    s_mul_i32 s38, s36, 6554
    s_lshr_b32 s38, s38, 16
    s_mul_i32 s39, s38, 10
    s_sub_u32 s39, s36, s39
    s_cmp_ge_u32 s39, 5
    s_cselect_b32 s40, 1, 0
    s_sub_u32 s41, s39, 6
    s_cmp_eq_u32 s39, 5
    s_cselect_b32 s41, 4, s41
    s_cmp_eq_u32 s40, 1
    s_cselect_b32 s39, s41, s39
    s_mul_i32 s37, s38, 200
    s_mul_i32 s40, s40, 100
    s_add_u32 s37, s37, s40
    s_mul_i32 s40, s33, 50
    s_add_u32 s37, s37, s40
    s_add_u32 s37, s37, s39
    s_lshl_b32 s37, s37, 10
    s_add_u32 s45, s37, 24055808
    s_movk_i32 s49, 5120
    s_lshl_b32 s36, s35, 2
    s_add_u32 s36, s36, 2
    s_mul_i32 s38, s36, 6554
    s_lshr_b32 s38, s38, 16
    s_mul_i32 s39, s38, 10
    s_sub_u32 s39, s36, s39
    s_cmp_ge_u32 s39, 5
    s_cselect_b32 s40, 1, 0
    s_sub_u32 s41, s39, 6
    s_cmp_eq_u32 s39, 5
    s_cselect_b32 s41, 4, s41
    s_cmp_eq_u32 s40, 1
    s_cselect_b32 s39, s41, s39
    s_mul_i32 s37, s38, 200
    s_mul_i32 s40, s40, 100
    s_add_u32 s37, s37, s40
    s_mul_i32 s40, s33, 50
    s_add_u32 s37, s37, s40
    s_add_u32 s37, s37, s39
    s_lshl_b32 s37, s37, 10
    s_add_u32 s46, s37, 24055808
    s_movk_i32 s50, 5120
    s_lshl_b32 s36, s35, 2
    s_add_u32 s36, s36, 3
    s_mul_i32 s38, s36, 6554
    s_lshr_b32 s38, s38, 16
    s_mul_i32 s39, s38, 10
    s_sub_u32 s39, s36, s39
    s_cmp_ge_u32 s39, 5
    s_cselect_b32 s40, 1, 0
    s_sub_u32 s41, s39, 6
    s_cmp_eq_u32 s39, 5
    s_cselect_b32 s41, 4, s41
    s_cmp_eq_u32 s40, 1
    s_cselect_b32 s39, s41, s39
    s_mul_i32 s37, s38, 200
    s_mul_i32 s40, s40, 100
    s_add_u32 s37, s37, s40
    s_mul_i32 s40, s33, 50
    s_add_u32 s37, s37, s40
    s_add_u32 s37, s37, s39
    s_lshl_b32 s37, s37, 10
    s_add_u32 s47, s37, 24055808
    s_movk_i32 s51, 5120
    s_waitcnt vmcnt(36)
    ds_write_b128 v5, v[32:35] offset:0
    ds_write_b128 v5, v[36:39] offset:1152
    ds_write_b128 v5, v[40:43] offset:2304
    ds_write_b128 v5, v[44:47] offset:3456
    s_waitcnt lgkmcnt(0)
    ds_read_b64_tr_b16 v[200:201], v8 offset:0
    ds_read_b64_tr_b16 v[202:203], v8 offset:576
    ds_read_b64_tr_b16 v[204:205], v8 offset:32
    ds_read_b64_tr_b16 v[206:207], v8 offset:608
    ds_read_b64_tr_b16 v[208:209], v8 offset:64
    ds_read_b64_tr_b16 v[210:211], v8 offset:640
    ds_read_b64_tr_b16 v[212:213], v8 offset:96
    ds_read_b64_tr_b16 v[214:215], v8 offset:672
    s_waitcnt vmcnt(32)
    ds_write_b128 v5, v[48:51] offset:4608
    ds_write_b128 v5, v[52:55] offset:5760
    ds_write_b128 v5, v[56:59] offset:6912
    ds_write_b128 v5, v[60:63] offset:8064
    s_waitcnt lgkmcnt(4)
    buffer_store_dwordx4 v[200:203], v9, s[28:31], s44 offen sc1
    s_add_u32 s44, s44, s48
    buffer_store_dwordx4 v[204:207], v9, s[28:31], s45 offen sc1
    s_add_u32 s45, s45, s49
    buffer_store_dwordx4 v[208:211], v9, s[28:31], s46 offen sc1
    s_add_u32 s46, s46, s50
    buffer_store_dwordx4 v[212:215], v9, s[28:31], s47 offen sc1
    s_add_u32 s47, s47, s51
    s_waitcnt lgkmcnt(0)
    ds_read_b64_tr_b16 v[216:217], v8 offset:4608
    ds_read_b64_tr_b16 v[218:219], v8 offset:5184
    ds_read_b64_tr_b16 v[220:221], v8 offset:4640
    ds_read_b64_tr_b16 v[222:223], v8 offset:5216
    ds_read_b64_tr_b16 v[224:225], v8 offset:4672
    ds_read_b64_tr_b16 v[226:227], v8 offset:5248
    ds_read_b64_tr_b16 v[228:229], v8 offset:4704
    ds_read_b64_tr_b16 v[230:231], v8 offset:5280
    s_waitcnt vmcnt(32)
    ds_write_b128 v5, v[64:67] offset:0
    ds_write_b128 v5, v[68:71] offset:1152
    ds_write_b128 v5, v[72:75] offset:2304
    ds_write_b128 v5, v[76:79] offset:3456
    s_waitcnt lgkmcnt(4)
    buffer_store_dwordx4 v[216:219], v9, s[28:31], s44 offen sc1
    s_add_u32 s44, s44, s48
    buffer_store_dwordx4 v[220:223], v9, s[28:31], s45 offen sc1
    s_add_u32 s45, s45, s49
    buffer_store_dwordx4 v[224:227], v9, s[28:31], s46 offen sc1
    s_add_u32 s46, s46, s50
    buffer_store_dwordx4 v[228:231], v9, s[28:31], s47 offen sc1
    s_add_u32 s47, s47, s51
    s_waitcnt lgkmcnt(0)
    ds_read_b64_tr_b16 v[200:201], v8 offset:0
    ds_read_b64_tr_b16 v[202:203], v8 offset:576
    ds_read_b64_tr_b16 v[204:205], v8 offset:32
    ds_read_b64_tr_b16 v[206:207], v8 offset:608
    ds_read_b64_tr_b16 v[208:209], v8 offset:64
    ds_read_b64_tr_b16 v[210:211], v8 offset:640
    ds_read_b64_tr_b16 v[212:213], v8 offset:96
    ds_read_b64_tr_b16 v[214:215], v8 offset:672
    s_waitcnt vmcnt(32)
    ds_write_b128 v5, v[80:83] offset:4608
    ds_write_b128 v5, v[84:87] offset:5760
    ds_write_b128 v5, v[88:91] offset:6912
    ds_write_b128 v5, v[92:95] offset:8064
    s_waitcnt lgkmcnt(4)
    buffer_store_dwordx4 v[200:203], v9, s[28:31], s44 offen sc1
    s_add_u32 s44, s44, s48
    buffer_store_dwordx4 v[204:207], v9, s[28:31], s45 offen sc1
    s_add_u32 s45, s45, s49
    buffer_store_dwordx4 v[208:211], v9, s[28:31], s46 offen sc1
    s_add_u32 s46, s46, s50
    buffer_store_dwordx4 v[212:215], v9, s[28:31], s47 offen sc1
    s_add_u32 s47, s47, s51
    s_waitcnt lgkmcnt(0)
    ds_read_b64_tr_b16 v[216:217], v8 offset:4608
    ds_read_b64_tr_b16 v[218:219], v8 offset:5184
    ds_read_b64_tr_b16 v[220:221], v8 offset:4640
    ds_read_b64_tr_b16 v[222:223], v8 offset:5216
    ds_read_b64_tr_b16 v[224:225], v8 offset:4672
    ds_read_b64_tr_b16 v[226:227], v8 offset:5248
    ds_read_b64_tr_b16 v[228:229], v8 offset:4704
    ds_read_b64_tr_b16 v[230:231], v8 offset:5280
    s_waitcnt vmcnt(32)
    ds_write_b128 v5, v[96:99] offset:0
    ds_write_b128 v5, v[100:103] offset:1152
    ds_write_b128 v5, v[104:107] offset:2304
    ds_write_b128 v5, v[108:111] offset:3456
    s_waitcnt lgkmcnt(4)
    buffer_store_dwordx4 v[216:219], v9, s[28:31], s44 offen sc1
    s_add_u32 s44, s44, s48
    buffer_store_dwordx4 v[220:223], v9, s[28:31], s45 offen sc1
    s_add_u32 s45, s45, s49
    buffer_store_dwordx4 v[224:227], v9, s[28:31], s46 offen sc1
    s_add_u32 s46, s46, s50
    buffer_store_dwordx4 v[228:231], v9, s[28:31], s47 offen sc1
    s_add_u32 s47, s47, s51
    s_waitcnt lgkmcnt(0)
    ds_read_b64_tr_b16 v[200:201], v8 offset:0
    ds_read_b64_tr_b16 v[202:203], v8 offset:576
    ds_read_b64_tr_b16 v[204:205], v8 offset:32
    ds_read_b64_tr_b16 v[206:207], v8 offset:608
    ds_read_b64_tr_b16 v[208:209], v8 offset:64
    ds_read_b64_tr_b16 v[210:211], v8 offset:640
    ds_read_b64_tr_b16 v[212:213], v8 offset:96
    ds_read_b64_tr_b16 v[214:215], v8 offset:672
    s_waitcnt vmcnt(32)
    ds_write_b128 v5, v[112:115] offset:4608
    ds_write_b128 v5, v[116:119] offset:5760
    ds_write_b128 v5, v[120:123] offset:6912
    ds_write_b128 v5, v[124:127] offset:8064
    s_waitcnt lgkmcnt(4)
    buffer_store_dwordx4 v[200:203], v9, s[28:31], s44 offen sc1
    s_add_u32 s44, s44, s48
    buffer_store_dwordx4 v[204:207], v9, s[28:31], s45 offen sc1
    s_add_u32 s45, s45, s49
    buffer_store_dwordx4 v[208:211], v9, s[28:31], s46 offen sc1
    s_add_u32 s46, s46, s50
    buffer_store_dwordx4 v[212:215], v9, s[28:31], s47 offen sc1
    s_add_u32 s47, s47, s51
    s_waitcnt lgkmcnt(0)
    ds_read_b64_tr_b16 v[216:217], v8 offset:4608
    ds_read_b64_tr_b16 v[218:219], v8 offset:5184
    ds_read_b64_tr_b16 v[220:221], v8 offset:4640
    ds_read_b64_tr_b16 v[222:223], v8 offset:5216
    ds_read_b64_tr_b16 v[224:225], v8 offset:4672
    ds_read_b64_tr_b16 v[226:227], v8 offset:5248
    ds_read_b64_tr_b16 v[228:229], v8 offset:4704
    ds_read_b64_tr_b16 v[230:231], v8 offset:5280
    s_waitcnt vmcnt(32)
    ds_write_b128 v5, v[128:131] offset:0
    ds_write_b128 v5, v[132:135] offset:1152
    ds_write_b128 v5, v[136:139] offset:2304
    ds_write_b128 v5, v[140:143] offset:3456
    s_waitcnt lgkmcnt(4)
    buffer_store_dwordx4 v[216:219], v9, s[28:31], s44 offen sc1
    s_add_u32 s44, s44, s48
    buffer_store_dwordx4 v[220:223], v9, s[28:31], s45 offen sc1
    s_add_u32 s45, s45, s49
    buffer_store_dwordx4 v[224:227], v9, s[28:31], s46 offen sc1
    s_add_u32 s46, s46, s50
    buffer_store_dwordx4 v[228:231], v9, s[28:31], s47 offen sc1
    s_add_u32 s47, s47, s51
    s_waitcnt lgkmcnt(0)
    ds_read_b64_tr_b16 v[200:201], v8 offset:0
    ds_read_b64_tr_b16 v[202:203], v8 offset:576
    ds_read_b64_tr_b16 v[204:205], v8 offset:32
    ds_read_b64_tr_b16 v[206:207], v8 offset:608
    ds_read_b64_tr_b16 v[208:209], v8 offset:64
    ds_read_b64_tr_b16 v[210:211], v8 offset:640
    ds_read_b64_tr_b16 v[212:213], v8 offset:96
    ds_read_b64_tr_b16 v[214:215], v8 offset:672
    s_waitcnt vmcnt(32)
    ds_write_b128 v5, v[144:147] offset:4608
    ds_write_b128 v5, v[148:151] offset:5760
    ds_write_b128 v5, v[152:155] offset:6912
    ds_write_b128 v5, v[156:159] offset:8064
    s_waitcnt lgkmcnt(4)
    buffer_store_dwordx4 v[200:203], v9, s[28:31], s44 offen sc1
    s_add_u32 s44, s44, s48
    buffer_store_dwordx4 v[204:207], v9, s[28:31], s45 offen sc1
    s_add_u32 s45, s45, s49
    buffer_store_dwordx4 v[208:211], v9, s[28:31], s46 offen sc1
    s_add_u32 s46, s46, s50
    buffer_store_dwordx4 v[212:215], v9, s[28:31], s47 offen sc1
    s_add_u32 s47, s47, s51
    s_waitcnt lgkmcnt(0)
    ds_read_b64_tr_b16 v[216:217], v8 offset:4608
    ds_read_b64_tr_b16 v[218:219], v8 offset:5184
    ds_read_b64_tr_b16 v[220:221], v8 offset:4640
    ds_read_b64_tr_b16 v[222:223], v8 offset:5216
    ds_read_b64_tr_b16 v[224:225], v8 offset:4672
    ds_read_b64_tr_b16 v[226:227], v8 offset:5248
    ds_read_b64_tr_b16 v[228:229], v8 offset:4704
    ds_read_b64_tr_b16 v[230:231], v8 offset:5280
    s_waitcnt vmcnt(32)
    ds_write_b128 v5, v[160:163] offset:0
    ds_write_b128 v5, v[164:167] offset:1152
    ds_write_b128 v5, v[168:171] offset:2304
    ds_write_b128 v5, v[172:175] offset:3456
    s_waitcnt lgkmcnt(4)
    buffer_store_dwordx4 v[216:219], v9, s[28:31], s44 offen sc1
    s_add_u32 s44, s44, s48
    buffer_store_dwordx4 v[220:223], v9, s[28:31], s45 offen sc1
    s_add_u32 s45, s45, s49
    buffer_store_dwordx4 v[224:227], v9, s[28:31], s46 offen sc1
    s_add_u32 s46, s46, s50
    buffer_store_dwordx4 v[228:231], v9, s[28:31], s47 offen sc1
    s_add_u32 s47, s47, s51
    s_waitcnt lgkmcnt(0)
    ds_read_b64_tr_b16 v[200:201], v8 offset:0
    ds_read_b64_tr_b16 v[202:203], v8 offset:576
    ds_read_b64_tr_b16 v[204:205], v8 offset:32
    ds_read_b64_tr_b16 v[206:207], v8 offset:608
    ds_read_b64_tr_b16 v[208:209], v8 offset:64
    ds_read_b64_tr_b16 v[210:211], v8 offset:640
    ds_read_b64_tr_b16 v[212:213], v8 offset:96
    ds_read_b64_tr_b16 v[214:215], v8 offset:672
    s_waitcnt vmcnt(32)
    ds_write_b128 v5, v[176:179] offset:4608
    ds_write_b128 v5, v[180:183] offset:5760
    ds_write_b128 v5, v[184:187] offset:6912
    ds_write_b128 v5, v[188:191] offset:8064
    s_waitcnt lgkmcnt(4)
    buffer_store_dwordx4 v[200:203], v9, s[28:31], s44 offen sc1
    s_add_u32 s44, s44, s48
    buffer_store_dwordx4 v[204:207], v9, s[28:31], s45 offen sc1
    s_add_u32 s45, s45, s49
    buffer_store_dwordx4 v[208:211], v9, s[28:31], s46 offen sc1
    s_add_u32 s46, s46, s50
    buffer_store_dwordx4 v[212:215], v9, s[28:31], s47 offen sc1
    s_add_u32 s47, s47, s51
    s_waitcnt lgkmcnt(0)
    ds_read_b64_tr_b16 v[216:217], v8 offset:4608
    ds_read_b64_tr_b16 v[218:219], v8 offset:5184
    ds_read_b64_tr_b16 v[220:221], v8 offset:4640
    ds_read_b64_tr_b16 v[222:223], v8 offset:5216
    ds_read_b64_tr_b16 v[224:225], v8 offset:4672
    ds_read_b64_tr_b16 v[226:227], v8 offset:5248
    ds_read_b64_tr_b16 v[228:229], v8 offset:4704
    ds_read_b64_tr_b16 v[230:231], v8 offset:5280
    s_waitcnt lgkmcnt(0)
    buffer_store_dwordx4 v[216:219], v9, s[28:31], s44 offen sc1
    s_add_u32 s44, s44, s48
    buffer_store_dwordx4 v[220:223], v9, s[28:31], s45 offen sc1
    s_add_u32 s45, s45, s49
    buffer_store_dwordx4 v[224:227], v9, s[28:31], s46 offen sc1
    s_add_u32 s46, s46, s50
    buffer_store_dwordx4 v[228:231], v9, s[28:31], s47 offen sc1
    s_add_u32 s47, s47, s51
    s_endpgm
k1_kernel_pk7:
    s_mov_b32 s24, s16
    s_mov_b32 s25, s17
    s_mov_b32 s26, 2211840
    s_mov_b32 s27, 0x00020000
    s_sub_u32 s32, s21, 40
    s_mul_i32 s33, s32, 2428
    s_lshr_b32 s33, s33, 16
    s_mul_i32 s35, s33, 27
    s_sub_u32 s35, s32, s35
    v_mul_u32_u24 v10, 3456, v3
    v_lshl_add_u32 v10, v4, 4, v10
    s_mul_i32 s36, s33, 1105920
    s_lshl_b32 s37, s35, 7
    s_add_u32 s36, s36, s37
    buffer_load_dwordx4 v[32:35], v10, s[24:27], s36 offen nt
    s_add_u32 s36, s36, 27648
    buffer_load_dwordx4 v[36:39], v10, s[24:27], s36 offen nt
    s_add_u32 s36, s36, 27648
    buffer_load_dwordx4 v[40:43], v10, s[24:27], s36 offen nt
    s_add_u32 s36, s36, 27648
    buffer_load_dwordx4 v[44:47], v10, s[24:27], s36 offen nt
    s_add_u32 s36, s36, 27648
    buffer_load_dwordx4 v[48:51], v10, s[24:27], s36 offen nt
    s_add_u32 s36, s36, 27648
    buffer_load_dwordx4 v[52:55], v10, s[24:27], s36 offen nt
    s_add_u32 s36, s36, 27648
    buffer_load_dwordx4 v[56:59], v10, s[24:27], s36 offen nt
    s_add_u32 s36, s36, 27648
    buffer_load_dwordx4 v[60:63], v10, s[24:27], s36 offen nt
    s_add_u32 s36, s36, 27648
    buffer_load_dwordx4 v[64:67], v10, s[24:27], s36 offen nt
    s_add_u32 s36, s36, 27648
    buffer_load_dwordx4 v[68:71], v10, s[24:27], s36 offen nt
    s_add_u32 s36, s36, 27648
    buffer_load_dwordx4 v[72:75], v10, s[24:27], s36 offen nt
    s_add_u32 s36, s36, 27648
    buffer_load_dwordx4 v[76:79], v10, s[24:27], s36 offen nt
    s_add_u32 s36, s36, 27648
    buffer_load_dwordx4 v[80:83], v10, s[24:27], s36 offen nt
    s_add_u32 s36, s36, 27648
    buffer_load_dwordx4 v[84:87], v10, s[24:27], s36 offen nt
    s_add_u32 s36, s36, 27648
    buffer_load_dwordx4 v[88:91], v10, s[24:27], s36 offen nt
    s_add_u32 s36, s36, 27648
    buffer_load_dwordx4 v[92:95], v10, s[24:27], s36 offen nt
    s_add_u32 s36, s36, 27648
    buffer_load_dwordx4 v[96:99], v10, s[24:27], s36 offen nt
    s_add_u32 s36, s36, 27648
    buffer_load_dwordx4 v[100:103], v10, s[24:27], s36 offen nt
    s_add_u32 s36, s36, 27648
    buffer_load_dwordx4 v[104:107], v10, s[24:27], s36 offen nt
    s_add_u32 s36, s36, 27648
    buffer_load_dwordx4 v[108:111], v10, s[24:27], s36 offen nt
    s_add_u32 s36, s36, 27648
    buffer_load_dwordx4 v[112:115], v10, s[24:27], s36 offen nt
    s_add_u32 s36, s36, 27648
    buffer_load_dwordx4 v[116:119], v10, s[24:27], s36 offen nt
    s_add_u32 s36, s36, 27648
    buffer_load_dwordx4 v[120:123], v10, s[24:27], s36 offen nt
    s_add_u32 s36, s36, 27648
    buffer_load_dwordx4 v[124:127], v10, s[24:27], s36 offen nt
    s_add_u32 s36, s36, 27648
    buffer_load_dwordx4 v[128:131], v10, s[24:27], s36 offen nt
    s_add_u32 s36, s36, 27648
    buffer_load_dwordx4 v[132:135], v10, s[24:27], s36 offen nt
    s_add_u32 s36, s36, 27648
    buffer_load_dwordx4 v[136:139], v10, s[24:27], s36 offen nt
    s_add_u32 s36, s36, 27648
    buffer_load_dwordx4 v[140:143], v10, s[24:27], s36 offen nt
    s_add_u32 s36, s36, 27648
    buffer_load_dwordx4 v[144:147], v10, s[24:27], s36 offen nt
    s_add_u32 s36, s36, 27648
    buffer_load_dwordx4 v[148:151], v10, s[24:27], s36 offen nt
    s_add_u32 s36, s36, 27648
    buffer_load_dwordx4 v[152:155], v10, s[24:27], s36 offen nt
    s_add_u32 s36, s36, 27648
    buffer_load_dwordx4 v[156:159], v10, s[24:27], s36 offen nt
    s_add_u32 s36, s36, 27648
    buffer_load_dwordx4 v[160:163], v10, s[24:27], s36 offen nt
    s_add_u32 s36, s36, 27648
    buffer_load_dwordx4 v[164:167], v10, s[24:27], s36 offen nt
    s_add_u32 s36, s36, 27648
    buffer_load_dwordx4 v[168:171], v10, s[24:27], s36 offen nt
    s_add_u32 s36, s36, 27648
    buffer_load_dwordx4 v[172:175], v10, s[24:27], s36 offen nt
    s_add_u32 s36, s36, 27648
    buffer_load_dwordx4 v[176:179], v10, s[24:27], s36 offen nt
    s_add_u32 s36, s36, 27648
    buffer_load_dwordx4 v[180:183], v10, s[24:27], s36 offen nt
    s_add_u32 s36, s36, 27648
    buffer_load_dwordx4 v[184:187], v10, s[24:27], s36 offen nt
    s_add_u32 s36, s36, 27648
    buffer_load_dwordx4 v[188:191], v10, s[24:27], s36 offen nt
    s_lshl_b32 s36, s35, 2
    s_add_u32 s36, s36, 0
    s_mul_i32 s38, s36, 9363
    s_lshr_b32 s38, s38, 16
    s_mul_i32 s39, s38, 7
    s_sub_u32 s39, s36, s39
    s_sub_u32 s41, s39, 1
    s_cmp_eq_u32 s39, 0
    s_cselect_b32 s41, 6, s41
    s_and_b32 s40, s38, 1
    s_cmp_eq_u32 s40, 1
    s_cselect_b32 s39, s41, s39
    s_mov_b32 s41, 4
    s_mov_b32 s40, s39
    s_cmp_ge_u32 s39, 4
    s_cselect_b32 s41, 2, s41
    s_add_u32 s42, s39, 76
    s_cmp_ge_u32 s39, 4
    s_cselect_b32 s40, s42, s40
    s_cmp_eq_u32 s39, 6
    s_cselect_b32 s41, 1, s41
    s_cselect_b32 s40, 120, s40
    s_mul_i32 s42, s33, 10
    s_mul_i32 s42, s42, s41
    s_add_u32 s40, s40, s42
    s_mul_i32 s37, s38, 140
    s_add_u32 s37, s37, s40
    s_lshl_b32 s37, s37, 10
    s_add_u32 s44, s37, 24875008
    s_lshl_b32 s48, s41, 10
    s_lshl_b32 s36, s35, 2
    s_add_u32 s36, s36, 1
    s_mul_i32 s38, s36, 9363
    s_lshr_b32 s38, s38, 16
    s_mul_i32 s39, s38, 7
    s_sub_u32 s39, s36, s39
    s_sub_u32 s41, s39, 1
    s_cmp_eq_u32 s39, 0
    s_cselect_b32 s41, 6, s41
    s_and_b32 s40, s38, 1
    s_cmp_eq_u32 s40, 1
    s_cselect_b32 s39, s41, s39
    s_mov_b32 s41, 4
    s_mov_b32 s40, s39
    s_cmp_ge_u32 s39, 4
    s_cselect_b32 s41, 2, s41
    s_add_u32 s42, s39, 76
    s_cmp_ge_u32 s39, 4
    s_cselect_b32 s40, s42, s40
    s_cmp_eq_u32 s39, 6
    s_cselect_b32 s41, 1, s41
    s_cselect_b32 s40, 120, s40
    s_mul_i32 s42, s33, 10
    s_mul_i32 s42, s42, s41
    s_add_u32 s40, s40, s42
    s_mul_i32 s37, s38, 140
    s_add_u32 s37, s37, s40
    s_lshl_b32 s37, s37, 10
    s_add_u32 s45, s37, 24875008
    s_lshl_b32 s49, s41, 10
    s_lshl_b32 s36, s35, 2
    s_add_u32 s36, s36, 2
    s_mul_i32 s38, s36, 9363
    s_lshr_b32 s38, s38, 16
    s_mul_i32 s39, s38, 7
    s_sub_u32 s39, s36, s39
    s_sub_u32 s41, s39, 1
    s_cmp_eq_u32 s39, 0
    s_cselect_b32 s41, 6, s41
    s_and_b32 s40, s38, 1
    s_cmp_eq_u32 s40, 1
    s_cselect_b32 s39, s41, s39
    s_mov_b32 s41, 4
    s_mov_b32 s40, s39
    s_cmp_ge_u32 s39, 4
    s_cselect_b32 s41, 2, s41
    s_add_u32 s42, s39, 76
    s_cmp_ge_u32 s39, 4
    s_cselect_b32 s40, s42, s40
    s_cmp_eq_u32 s39, 6
    s_cselect_b32 s41, 1, s41
    s_cselect_b32 s40, 120, s40
    s_mul_i32 s42, s33, 10
    s_mul_i32 s42, s42, s41
    s_add_u32 s40, s40, s42
    s_mul_i32 s37, s38, 140
    s_add_u32 s37, s37, s40
    s_lshl_b32 s37, s37, 10
    s_add_u32 s46, s37, 24875008
    s_lshl_b32 s50, s41, 10
    s_lshl_b32 s36, s35, 2
    s_add_u32 s36, s36, 3
    s_mul_i32 s38, s36, 9363
    s_lshr_b32 s38, s38, 16
    s_mul_i32 s39, s38, 7
    s_sub_u32 s39, s36, s39
    s_sub_u32 s41, s39, 1
    s_cmp_eq_u32 s39, 0
    s_cselect_b32 s41, 6, s41
    s_and_b32 s40, s38, 1
    s_cmp_eq_u32 s40, 1
    s_cselect_b32 s39, s41, s39
    s_mov_b32 s41, 4
    s_mov_b32 s40, s39
    s_cmp_ge_u32 s39, 4
    s_cselect_b32 s41, 2, s41
    s_add_u32 s42, s39, 76
    s_cmp_ge_u32 s39, 4
    s_cselect_b32 s40, s42, s40
    s_cmp_eq_u32 s39, 6
    s_cselect_b32 s41, 1, s41
    s_cselect_b32 s40, 120, s40
    s_mul_i32 s42, s33, 10
    s_mul_i32 s42, s42, s41
    s_add_u32 s40, s40, s42
    s_mul_i32 s37, s38, 140
    s_add_u32 s37, s37, s40
    s_lshl_b32 s37, s37, 10
    s_add_u32 s47, s37, 24875008
    s_lshl_b32 s51, s41, 10
    v_mov_b32 v12, 0
    v_mov_b32 v13, 0
    v_mov_b32 v14, 0
    v_mov_b32 v15, 0
    v_mov_b32 v16, 0x3f803f80
    s_waitcnt vmcnt(36)
    ds_write_b128 v5, v[32:35] offset:0
    ds_write_b128 v5, v[36:39] offset:1152
    ds_write_b128 v5, v[40:43] offset:2304
    ds_write_b128 v5, v[44:47] offset:3456
    s_waitcnt lgkmcnt(0)
    ds_read_b64_tr_b16 v[200:201], v8 offset:0
    ds_read_b64_tr_b16 v[202:203], v8 offset:576
    ds_read_b64_tr_b16 v[204:205], v8 offset:32
    ds_read_b64_tr_b16 v[206:207], v8 offset:608
    ds_read_b64_tr_b16 v[208:209], v8 offset:64
    ds_read_b64_tr_b16 v[210:211], v8 offset:640
    ds_read_b64_tr_b16 v[212:213], v8 offset:96
    ds_read_b64_tr_b16 v[214:215], v8 offset:672
    s_waitcnt vmcnt(32)
    ds_write_b128 v5, v[48:51] offset:4608
    ds_write_b128 v5, v[52:55] offset:5760
    ds_write_b128 v5, v[56:59] offset:6912
    ds_write_b128 v5, v[60:63] offset:8064
    s_waitcnt lgkmcnt(4)
    buffer_store_dwordx4 v[200:203], v9, s[28:31], s44 offen sc1
    s_add_u32 s44, s44, s48
    v_dot2_f32_bf16 v12, v200, v16, v12
    v_dot2_f32_bf16 v12, v201, v16, v12
    v_dot2_f32_bf16 v12, v202, v16, v12
    v_dot2_f32_bf16 v12, v203, v16, v12
    buffer_store_dwordx4 v[204:207], v9, s[28:31], s45 offen sc1
    s_add_u32 s45, s45, s49
    v_dot2_f32_bf16 v13, v204, v16, v13
    v_dot2_f32_bf16 v13, v205, v16, v13
    v_dot2_f32_bf16 v13, v206, v16, v13
    v_dot2_f32_bf16 v13, v207, v16, v13
    buffer_store_dwordx4 v[208:211], v9, s[28:31], s46 offen sc1
    s_add_u32 s46, s46, s50
    v_dot2_f32_bf16 v14, v208, v16, v14
    v_dot2_f32_bf16 v14, v209, v16, v14
    v_dot2_f32_bf16 v14, v210, v16, v14
    v_dot2_f32_bf16 v14, v211, v16, v14
    buffer_store_dwordx4 v[212:215], v9, s[28:31], s47 offen sc1
    s_add_u32 s47, s47, s51
    v_dot2_f32_bf16 v15, v212, v16, v15
    v_dot2_f32_bf16 v15, v213, v16, v15
    v_dot2_f32_bf16 v15, v214, v16, v15
    v_dot2_f32_bf16 v15, v215, v16, v15
    s_waitcnt lgkmcnt(0)
    ds_read_b64_tr_b16 v[216:217], v8 offset:4608
    ds_read_b64_tr_b16 v[218:219], v8 offset:5184
    ds_read_b64_tr_b16 v[220:221], v8 offset:4640
    ds_read_b64_tr_b16 v[222:223], v8 offset:5216
    ds_read_b64_tr_b16 v[224:225], v8 offset:4672
    ds_read_b64_tr_b16 v[226:227], v8 offset:5248
    ds_read_b64_tr_b16 v[228:229], v8 offset:4704
    ds_read_b64_tr_b16 v[230:231], v8 offset:5280
    s_waitcnt vmcnt(32)
    ds_write_b128 v5, v[64:67] offset:0
    ds_write_b128 v5, v[68:71] offset:1152
    ds_write_b128 v5, v[72:75] offset:2304
    ds_write_b128 v5, v[76:79] offset:3456
    s_waitcnt lgkmcnt(4)
    buffer_store_dwordx4 v[216:219], v9, s[28:31], s44 offen sc1
    s_add_u32 s44, s44, s48
    v_dot2_f32_bf16 v12, v216, v16, v12
    v_dot2_f32_bf16 v12, v217, v16, v12
    v_dot2_f32_bf16 v12, v218, v16, v12
    v_dot2_f32_bf16 v12, v219, v16, v12
    buffer_store_dwordx4 v[220:223], v9, s[28:31], s45 offen sc1
    s_add_u32 s45, s45, s49
    v_dot2_f32_bf16 v13, v220, v16, v13
    v_dot2_f32_bf16 v13, v221, v16, v13
    v_dot2_f32_bf16 v13, v222, v16, v13
    v_dot2_f32_bf16 v13, v223, v16, v13
    buffer_store_dwordx4 v[224:227], v9, s[28:31], s46 offen sc1
    s_add_u32 s46, s46, s50
    v_dot2_f32_bf16 v14, v224, v16, v14
    v_dot2_f32_bf16 v14, v225, v16, v14
    v_dot2_f32_bf16 v14, v226, v16, v14
    v_dot2_f32_bf16 v14, v227, v16, v14
    buffer_store_dwordx4 v[228:231], v9, s[28:31], s47 offen sc1
    s_add_u32 s47, s47, s51
    v_dot2_f32_bf16 v15, v228, v16, v15
    v_dot2_f32_bf16 v15, v229, v16, v15
    v_dot2_f32_bf16 v15, v230, v16, v15
    v_dot2_f32_bf16 v15, v231, v16, v15
    s_waitcnt lgkmcnt(0)
    ds_read_b64_tr_b16 v[200:201], v8 offset:0
    ds_read_b64_tr_b16 v[202:203], v8 offset:576
    ds_read_b64_tr_b16 v[204:205], v8 offset:32
    ds_read_b64_tr_b16 v[206:207], v8 offset:608
    ds_read_b64_tr_b16 v[208:209], v8 offset:64
    ds_read_b64_tr_b16 v[210:211], v8 offset:640
    ds_read_b64_tr_b16 v[212:213], v8 offset:96
    ds_read_b64_tr_b16 v[214:215], v8 offset:672
    s_waitcnt vmcnt(32)
    ds_write_b128 v5, v[80:83] offset:4608
    ds_write_b128 v5, v[84:87] offset:5760
    ds_write_b128 v5, v[88:91] offset:6912
    ds_write_b128 v5, v[92:95] offset:8064
    s_waitcnt lgkmcnt(4)
    buffer_store_dwordx4 v[200:203], v9, s[28:31], s44 offen sc1
    s_add_u32 s44, s44, s48
    v_dot2_f32_bf16 v12, v200, v16, v12
    v_dot2_f32_bf16 v12, v201, v16, v12
    v_dot2_f32_bf16 v12, v202, v16, v12
    v_dot2_f32_bf16 v12, v203, v16, v12
    buffer_store_dwordx4 v[204:207], v9, s[28:31], s45 offen sc1
    s_add_u32 s45, s45, s49
    v_dot2_f32_bf16 v13, v204, v16, v13
    v_dot2_f32_bf16 v13, v205, v16, v13
    v_dot2_f32_bf16 v13, v206, v16, v13
    v_dot2_f32_bf16 v13, v207, v16, v13
    buffer_store_dwordx4 v[208:211], v9, s[28:31], s46 offen sc1
    s_add_u32 s46, s46, s50
    v_dot2_f32_bf16 v14, v208, v16, v14
    v_dot2_f32_bf16 v14, v209, v16, v14
    v_dot2_f32_bf16 v14, v210, v16, v14
    v_dot2_f32_bf16 v14, v211, v16, v14
    buffer_store_dwordx4 v[212:215], v9, s[28:31], s47 offen sc1
    s_add_u32 s47, s47, s51
    v_dot2_f32_bf16 v15, v212, v16, v15
    v_dot2_f32_bf16 v15, v213, v16, v15
    v_dot2_f32_bf16 v15, v214, v16, v15
    v_dot2_f32_bf16 v15, v215, v16, v15
    s_waitcnt lgkmcnt(0)
    ds_read_b64_tr_b16 v[216:217], v8 offset:4608
    ds_read_b64_tr_b16 v[218:219], v8 offset:5184
    ds_read_b64_tr_b16 v[220:221], v8 offset:4640
    ds_read_b64_tr_b16 v[222:223], v8 offset:5216
    ds_read_b64_tr_b16 v[224:225], v8 offset:4672
    ds_read_b64_tr_b16 v[226:227], v8 offset:5248
    ds_read_b64_tr_b16 v[228:229], v8 offset:4704
    ds_read_b64_tr_b16 v[230:231], v8 offset:5280
    s_waitcnt vmcnt(32)
    ds_write_b128 v5, v[96:99] offset:0
    ds_write_b128 v5, v[100:103] offset:1152
    ds_write_b128 v5, v[104:107] offset:2304
    ds_write_b128 v5, v[108:111] offset:3456
    s_waitcnt lgkmcnt(4)
    buffer_store_dwordx4 v[216:219], v9, s[28:31], s44 offen sc1
    s_add_u32 s44, s44, s48
    v_dot2_f32_bf16 v12, v216, v16, v12
    v_dot2_f32_bf16 v12, v217, v16, v12
    v_dot2_f32_bf16 v12, v218, v16, v12
    v_dot2_f32_bf16 v12, v219, v16, v12
    buffer_store_dwordx4 v[220:223], v9, s[28:31], s45 offen sc1
    s_add_u32 s45, s45, s49
    v_dot2_f32_bf16 v13, v220, v16, v13
    v_dot2_f32_bf16 v13, v221, v16, v13
    v_dot2_f32_bf16 v13, v222, v16, v13
    v_dot2_f32_bf16 v13, v223, v16, v13
    buffer_store_dwordx4 v[224:227], v9, s[28:31], s46 offen sc1
    s_add_u32 s46, s46, s50
    v_dot2_f32_bf16 v14, v224, v16, v14
    v_dot2_f32_bf16 v14, v225, v16, v14
    v_dot2_f32_bf16 v14, v226, v16, v14
    v_dot2_f32_bf16 v14, v227, v16, v14
    buffer_store_dwordx4 v[228:231], v9, s[28:31], s47 offen sc1
    s_add_u32 s47, s47, s51
    v_dot2_f32_bf16 v15, v228, v16, v15
    v_dot2_f32_bf16 v15, v229, v16, v15
    v_dot2_f32_bf16 v15, v230, v16, v15
    v_dot2_f32_bf16 v15, v231, v16, v15
    s_waitcnt lgkmcnt(0)
    ds_read_b64_tr_b16 v[200:201], v8 offset:0
    ds_read_b64_tr_b16 v[202:203], v8 offset:576
    ds_read_b64_tr_b16 v[204:205], v8 offset:32
    ds_read_b64_tr_b16 v[206:207], v8 offset:608
    ds_read_b64_tr_b16 v[208:209], v8 offset:64
    ds_read_b64_tr_b16 v[210:211], v8 offset:640
    ds_read_b64_tr_b16 v[212:213], v8 offset:96
    ds_read_b64_tr_b16 v[214:215], v8 offset:672
    s_waitcnt vmcnt(32)
    ds_write_b128 v5, v[112:115] offset:4608
    ds_write_b128 v5, v[116:119] offset:5760
    ds_write_b128 v5, v[120:123] offset:6912
    ds_write_b128 v5, v[124:127] offset:8064
    s_waitcnt lgkmcnt(4)
    buffer_store_dwordx4 v[200:203], v9, s[28:31], s44 offen sc1
    s_add_u32 s44, s44, s48
    v_dot2_f32_bf16 v12, v200, v16, v12
    v_dot2_f32_bf16 v12, v201, v16, v12
    v_dot2_f32_bf16 v12, v202, v16, v12
    v_dot2_f32_bf16 v12, v203, v16, v12
    buffer_store_dwordx4 v[204:207], v9, s[28:31], s45 offen sc1
    s_add_u32 s45, s45, s49
    v_dot2_f32_bf16 v13, v204, v16, v13
    v_dot2_f32_bf16 v13, v205, v16, v13
    v_dot2_f32_bf16 v13, v206, v16, v13
    v_dot2_f32_bf16 v13, v207, v16, v13
    buffer_store_dwordx4 v[208:211], v9, s[28:31], s46 offen sc1
    s_add_u32 s46, s46, s50
    v_dot2_f32_bf16 v14, v208, v16, v14
    v_dot2_f32_bf16 v14, v209, v16, v14
    v_dot2_f32_bf16 v14, v210, v16, v14
    v_dot2_f32_bf16 v14, v211, v16, v14
    buffer_store_dwordx4 v[212:215], v9, s[28:31], s47 offen sc1
    s_add_u32 s47, s47, s51
    v_dot2_f32_bf16 v15, v212, v16, v15
    v_dot2_f32_bf16 v15, v213, v16, v15
    v_dot2_f32_bf16 v15, v214, v16, v15
    v_dot2_f32_bf16 v15, v215, v16, v15
    s_waitcnt lgkmcnt(0)
    ds_read_b64_tr_b16 v[216:217], v8 offset:4608
    ds_read_b64_tr_b16 v[218:219], v8 offset:5184
    ds_read_b64_tr_b16 v[220:221], v8 offset:4640
    ds_read_b64_tr_b16 v[222:223], v8 offset:5216
    ds_read_b64_tr_b16 v[224:225], v8 offset:4672
    ds_read_b64_tr_b16 v[226:227], v8 offset:5248
    ds_read_b64_tr_b16 v[228:229], v8 offset:4704
    ds_read_b64_tr_b16 v[230:231], v8 offset:5280
    s_waitcnt vmcnt(32)
    ds_write_b128 v5, v[128:131] offset:0
    ds_write_b128 v5, v[132:135] offset:1152
    ds_write_b128 v5, v[136:139] offset:2304
    ds_write_b128 v5, v[140:143] offset:3456
    s_waitcnt lgkmcnt(4)
    buffer_store_dwordx4 v[216:219], v9, s[28:31], s44 offen sc1
    s_add_u32 s44, s44, s48
    v_dot2_f32_bf16 v12, v216, v16, v12
    v_dot2_f32_bf16 v12, v217, v16, v12
    v_dot2_f32_bf16 v12, v218, v16, v12
    v_dot2_f32_bf16 v12, v219, v16, v12
    buffer_store_dwordx4 v[220:223], v9, s[28:31], s45 offen sc1
    s_add_u32 s45, s45, s49
    v_dot2_f32_bf16 v13, v220, v16, v13
    v_dot2_f32_bf16 v13, v221, v16, v13
    v_dot2_f32_bf16 v13, v222, v16, v13
    v_dot2_f32_bf16 v13, v223, v16, v13
    buffer_store_dwordx4 v[224:227], v9, s[28:31], s46 offen sc1
    s_add_u32 s46, s46, s50
    v_dot2_f32_bf16 v14, v224, v16, v14
    v_dot2_f32_bf16 v14, v225, v16, v14
    v_dot2_f32_bf16 v14, v226, v16, v14
    v_dot2_f32_bf16 v14, v227, v16, v14
    buffer_store_dwordx4 v[228:231], v9, s[28:31], s47 offen sc1
    s_add_u32 s47, s47, s51
    v_dot2_f32_bf16 v15, v228, v16, v15
    v_dot2_f32_bf16 v15, v229, v16, v15
    v_dot2_f32_bf16 v15, v230, v16, v15
    v_dot2_f32_bf16 v15, v231, v16, v15
    s_waitcnt lgkmcnt(0)
    ds_read_b64_tr_b16 v[200:201], v8 offset:0
    ds_read_b64_tr_b16 v[202:203], v8 offset:576
    ds_read_b64_tr_b16 v[204:205], v8 offset:32
    ds_read_b64_tr_b16 v[206:207], v8 offset:608
    ds_read_b64_tr_b16 v[208:209], v8 offset:64
    ds_read_b64_tr_b16 v[210:211], v8 offset:640
    ds_read_b64_tr_b16 v[212:213], v8 offset:96
    ds_read_b64_tr_b16 v[214:215], v8 offset:672
    s_waitcnt vmcnt(32)
    ds_write_b128 v5, v[144:147] offset:4608
    ds_write_b128 v5, v[148:151] offset:5760
    ds_write_b128 v5, v[152:155] offset:6912
    ds_write_b128 v5, v[156:159] offset:8064
    s_waitcnt lgkmcnt(4)
    buffer_store_dwordx4 v[200:203], v9, s[28:31], s44 offen sc1
    s_add_u32 s44, s44, s48
    v_dot2_f32_bf16 v12, v200, v16, v12
    v_dot2_f32_bf16 v12, v201, v16, v12
    v_dot2_f32_bf16 v12, v202, v16, v12
    v_dot2_f32_bf16 v12, v203, v16, v12
    buffer_store_dwordx4 v[204:207], v9, s[28:31], s45 offen sc1
    s_add_u32 s45, s45, s49
    v_dot2_f32_bf16 v13, v204, v16, v13
    v_dot2_f32_bf16 v13, v205, v16, v13
    v_dot2_f32_bf16 v13, v206, v16, v13
    v_dot2_f32_bf16 v13, v207, v16, v13
    buffer_store_dwordx4 v[208:211], v9, s[28:31], s46 offen sc1
    s_add_u32 s46, s46, s50
    v_dot2_f32_bf16 v14, v208, v16, v14
    v_dot2_f32_bf16 v14, v209, v16, v14
    v_dot2_f32_bf16 v14, v210, v16, v14
    v_dot2_f32_bf16 v14, v211, v16, v14
    buffer_store_dwordx4 v[212:215], v9, s[28:31], s47 offen sc1
    s_add_u32 s47, s47, s51
    v_dot2_f32_bf16 v15, v212, v16, v15
    v_dot2_f32_bf16 v15, v213, v16, v15
    v_dot2_f32_bf16 v15, v214, v16, v15
    v_dot2_f32_bf16 v15, v215, v16, v15
    s_waitcnt lgkmcnt(0)
    ds_read_b64_tr_b16 v[216:217], v8 offset:4608
    ds_read_b64_tr_b16 v[218:219], v8 offset:5184
    ds_read_b64_tr_b16 v[220:221], v8 offset:4640
    ds_read_b64_tr_b16 v[222:223], v8 offset:5216
    ds_read_b64_tr_b16 v[224:225], v8 offset:4672
    ds_read_b64_tr_b16 v[226:227], v8 offset:5248
    ds_read_b64_tr_b16 v[228:229], v8 offset:4704
    ds_read_b64_tr_b16 v[230:231], v8 offset:5280
    s_waitcnt vmcnt(32)
    ds_write_b128 v5, v[160:163] offset:0
    ds_write_b128 v5, v[164:167] offset:1152
    ds_write_b128 v5, v[168:171] offset:2304
    ds_write_b128 v5, v[172:175] offset:3456
    s_waitcnt lgkmcnt(4)
    buffer_store_dwordx4 v[216:219], v9, s[28:31], s44 offen sc1
    s_add_u32 s44, s44, s48
    v_dot2_f32_bf16 v12, v216, v16, v12
    v_dot2_f32_bf16 v12, v217, v16, v12
    v_dot2_f32_bf16 v12, v218, v16, v12
    v_dot2_f32_bf16 v12, v219, v16, v12
    buffer_store_dwordx4 v[220:223], v9, s[28:31], s45 offen sc1
    s_add_u32 s45, s45, s49
    v_dot2_f32_bf16 v13, v220, v16, v13
    v_dot2_f32_bf16 v13, v221, v16, v13
    v_dot2_f32_bf16 v13, v222, v16, v13
    v_dot2_f32_bf16 v13, v223, v16, v13
    buffer_store_dwordx4 v[224:227], v9, s[28:31], s46 offen sc1
    s_add_u32 s46, s46, s50
    v_dot2_f32_bf16 v14, v224, v16, v14
    v_dot2_f32_bf16 v14, v225, v16, v14
    v_dot2_f32_bf16 v14, v226, v16, v14
    v_dot2_f32_bf16 v14, v227, v16, v14
    buffer_store_dwordx4 v[228:231], v9, s[28:31], s47 offen sc1
    s_add_u32 s47, s47, s51
    v_dot2_f32_bf16 v15, v228, v16, v15
    v_dot2_f32_bf16 v15, v229, v16, v15
    v_dot2_f32_bf16 v15, v230, v16, v15
    v_dot2_f32_bf16 v15, v231, v16, v15
    s_waitcnt lgkmcnt(0)
    ds_read_b64_tr_b16 v[200:201], v8 offset:0
    ds_read_b64_tr_b16 v[202:203], v8 offset:576
    ds_read_b64_tr_b16 v[204:205], v8 offset:32
    ds_read_b64_tr_b16 v[206:207], v8 offset:608
    ds_read_b64_tr_b16 v[208:209], v8 offset:64
    ds_read_b64_tr_b16 v[210:211], v8 offset:640
    ds_read_b64_tr_b16 v[212:213], v8 offset:96
    ds_read_b64_tr_b16 v[214:215], v8 offset:672
    s_waitcnt vmcnt(32)
    ds_write_b128 v5, v[176:179] offset:4608
    ds_write_b128 v5, v[180:183] offset:5760
    ds_write_b128 v5, v[184:187] offset:6912
    ds_write_b128 v5, v[188:191] offset:8064
    s_waitcnt lgkmcnt(4)
    buffer_store_dwordx4 v[200:203], v9, s[28:31], s44 offen sc1
    s_add_u32 s44, s44, s48
    v_dot2_f32_bf16 v12, v200, v16, v12
    v_dot2_f32_bf16 v12, v201, v16, v12
    v_dot2_f32_bf16 v12, v202, v16, v12
    v_dot2_f32_bf16 v12, v203, v16, v12
    buffer_store_dwordx4 v[204:207], v9, s[28:31], s45 offen sc1
    s_add_u32 s45, s45, s49
    v_dot2_f32_bf16 v13, v204, v16, v13
    v_dot2_f32_bf16 v13, v205, v16, v13
    v_dot2_f32_bf16 v13, v206, v16, v13
    v_dot2_f32_bf16 v13, v207, v16, v13
    buffer_store_dwordx4 v[208:211], v9, s[28:31], s46 offen sc1
    s_add_u32 s46, s46, s50
    v_dot2_f32_bf16 v14, v208, v16, v14
    v_dot2_f32_bf16 v14, v209, v16, v14
    v_dot2_f32_bf16 v14, v210, v16, v14
    v_dot2_f32_bf16 v14, v211, v16, v14
    buffer_store_dwordx4 v[212:215], v9, s[28:31], s47 offen sc1
    s_add_u32 s47, s47, s51
    v_dot2_f32_bf16 v15, v212, v16, v15
    v_dot2_f32_bf16 v15, v213, v16, v15
    v_dot2_f32_bf16 v15, v214, v16, v15
    v_dot2_f32_bf16 v15, v215, v16, v15
    s_waitcnt lgkmcnt(0)
    ds_read_b64_tr_b16 v[216:217], v8 offset:4608
    ds_read_b64_tr_b16 v[218:219], v8 offset:5184
    ds_read_b64_tr_b16 v[220:221], v8 offset:4640
    ds_read_b64_tr_b16 v[222:223], v8 offset:5216
    ds_read_b64_tr_b16 v[224:225], v8 offset:4672
    ds_read_b64_tr_b16 v[226:227], v8 offset:5248
    ds_read_b64_tr_b16 v[228:229], v8 offset:4704
    ds_read_b64_tr_b16 v[230:231], v8 offset:5280
    s_waitcnt lgkmcnt(0)
    buffer_store_dwordx4 v[216:219], v9, s[28:31], s44 offen sc1
    s_add_u32 s44, s44, s48
    v_dot2_f32_bf16 v12, v216, v16, v12
    v_dot2_f32_bf16 v12, v217, v16, v12
    v_dot2_f32_bf16 v12, v218, v16, v12
    v_dot2_f32_bf16 v12, v219, v16, v12
    buffer_store_dwordx4 v[220:223], v9, s[28:31], s45 offen sc1
    s_add_u32 s45, s45, s49
    v_dot2_f32_bf16 v13, v220, v16, v13
    v_dot2_f32_bf16 v13, v221, v16, v13
    v_dot2_f32_bf16 v13, v222, v16, v13
    v_dot2_f32_bf16 v13, v223, v16, v13
    buffer_store_dwordx4 v[224:227], v9, s[28:31], s46 offen sc1
    s_add_u32 s46, s46, s50
    v_dot2_f32_bf16 v14, v224, v16, v14
    v_dot2_f32_bf16 v14, v225, v16, v14
    v_dot2_f32_bf16 v14, v226, v16, v14
    v_dot2_f32_bf16 v14, v227, v16, v14
    buffer_store_dwordx4 v[228:231], v9, s[28:31], s47 offen sc1
    s_add_u32 s47, s47, s51
    v_dot2_f32_bf16 v15, v228, v16, v15
    v_dot2_f32_bf16 v15, v229, v16, v15
    v_dot2_f32_bf16 v15, v230, v16, v15
    v_dot2_f32_bf16 v15, v231, v16, v15
    s_nop 2
    v_mov_b32 v20, v12
    v_mov_b32 v21, v13
    v_mov_b32 v22, v14
    v_mov_b32 v23, v15
    s_nop 1
    v_permlane32_swap_b32 v20, v12
    v_permlane32_swap_b32 v21, v13
    v_permlane32_swap_b32 v22, v14
    v_permlane32_swap_b32 v23, v15
    s_nop 1
    v_add_f32 v12, v12, v20
    v_add_f32 v13, v13, v21
    v_add_f32 v14, v14, v22
    v_add_f32 v15, v15, v23
    v_mov_b32 v20, v12
    v_mov_b32 v21, v13
    v_mov_b32 v22, v14
    v_mov_b32 v23, v15
    s_nop 1
    v_permlane16_swap_b32 v20, v12
    v_permlane16_swap_b32 v21, v13
    v_permlane16_swap_b32 v22, v14
    v_permlane16_swap_b32 v23, v15
    s_nop 1
    v_add_f32 v12, v12, v20
    v_add_f32 v13, v13, v21
    v_add_f32 v14, v14, v22
    v_add_f32 v15, v15, v23
    s_mul_i32 s38, s33, 7168
    s_lshl_b32 s39, s35, 8
    s_add_u32 s38, s38, s39
    s_add_u32 s38, s38, 8130560
    v_lshlrev_b32 v17, 2, v1
    s_mov_b64 exec, 0xffff
    buffer_store_dword v12, v17, s[28:31], s38 offen offset:0 sc1
    buffer_store_dword v13, v17, s[28:31], s38 offen offset:64 sc1
    buffer_store_dword v14, v17, s[28:31], s38 offen offset:128 sc1
    buffer_store_dword v15, v17, s[28:31], s38 offen offset:192 sc1
    s_endpgm
k1_kernel_pk8:
    s_mov_b32 s24, s18
    s_mov_b32 s25, s19
    s_mov_b32 s26, 2211840
    s_mov_b32 s27, 0x00020000
    s_sub_u32 s32, s21, 94
    s_mul_i32 s33, s32, 52429
    s_lshr_b32 s33, s33, 19
    s_mul_i32 s35, s33, 10
    s_sub_u32 s35, s32, s35
    v_mul_u32_u24 v10, 1280, v3
    v_lshl_add_u32 v10, v4, 4, v10
    s_mul_i32 s36, s33, 368640
    s_lshl_b32 s37, s35, 7
    s_add_u32 s36, s36, s37
    buffer_load_dwordx4 v[32:35], v10, s[24:27], s36 offen nt
    s_add_u32 s36, s36, 10240
    buffer_load_dwordx4 v[36:39], v10, s[24:27], s36 offen nt
    s_add_u32 s36, s36, 10240
    buffer_load_dwordx4 v[40:43], v10, s[24:27], s36 offen nt
    s_add_u32 s36, s36, 10240
    buffer_load_dwordx4 v[44:47], v10, s[24:27], s36 offen nt
    s_add_u32 s36, s36, 10240
    buffer_load_dwordx4 v[48:51], v10, s[24:27], s36 offen nt
    s_add_u32 s36, s36, 10240
    buffer_load_dwordx4 v[52:55], v10, s[24:27], s36 offen nt
    s_add_u32 s36, s36, 10240
    buffer_load_dwordx4 v[56:59], v10, s[24:27], s36 offen nt
    s_add_u32 s36, s36, 10240
    buffer_load_dwordx4 v[60:63], v10, s[24:27], s36 offen nt
    s_add_u32 s36, s36, 10240
    buffer_load_dwordx4 v[64:67], v10, s[24:27], s36 offen nt
    s_add_u32 s36, s36, 10240
    buffer_load_dwordx4 v[68:71], v10, s[24:27], s36 offen nt
    s_add_u32 s36, s36, 10240
    buffer_load_dwordx4 v[72:75], v10, s[24:27], s36 offen nt
    s_add_u32 s36, s36, 10240
    buffer_load_dwordx4 v[76:79], v10, s[24:27], s36 offen nt
    s_add_u32 s36, s36, 10240
    buffer_load_dwordx4 v[80:83], v10, s[24:27], s36 offen nt
    s_add_u32 s36, s36, 10240
    buffer_load_dwordx4 v[84:87], v10, s[24:27], s36 offen nt
    s_add_u32 s36, s36, 10240
    buffer_load_dwordx4 v[88:91], v10, s[24:27], s36 offen nt
    s_add_u32 s36, s36, 10240
    buffer_load_dwordx4 v[92:95], v10, s[24:27], s36 offen nt
    s_add_u32 s36, s36, 10240
    buffer_load_dwordx4 v[96:99], v10, s[24:27], s36 offen nt
    s_add_u32 s36, s36, 10240
    buffer_load_dwordx4 v[100:103], v10, s[24:27], s36 offen nt
    s_add_u32 s36, s36, 10240
    buffer_load_dwordx4 v[104:107], v10, s[24:27], s36 offen nt
    s_add_u32 s36, s36, 10240
    buffer_load_dwordx4 v[108:111], v10, s[24:27], s36 offen nt
    s_add_u32 s36, s36, 10240
    buffer_load_dwordx4 v[112:115], v10, s[24:27], s36 offen nt
    s_add_u32 s36, s36, 10240
    buffer_load_dwordx4 v[116:119], v10, s[24:27], s36 offen nt
    s_add_u32 s36, s36, 10240
    buffer_load_dwordx4 v[120:123], v10, s[24:27], s36 offen nt
    s_add_u32 s36, s36, 10240
    buffer_load_dwordx4 v[124:127], v10, s[24:27], s36 offen nt
    s_add_u32 s36, s36, 10240
    buffer_load_dwordx4 v[128:131], v10, s[24:27], s36 offen nt
    s_add_u32 s36, s36, 10240
    buffer_load_dwordx4 v[132:135], v10, s[24:27], s36 offen nt
    s_add_u32 s36, s36, 10240
    buffer_load_dwordx4 v[136:139], v10, s[24:27], s36 offen nt
    s_add_u32 s36, s36, 10240
    buffer_load_dwordx4 v[140:143], v10, s[24:27], s36 offen nt
    s_add_u32 s36, s36, 10240
    buffer_load_dwordx4 v[144:147], v10, s[24:27], s36 offen nt
    s_add_u32 s36, s36, 10240
    buffer_load_dwordx4 v[148:151], v10, s[24:27], s36 offen nt
    s_add_u32 s36, s36, 10240
    buffer_load_dwordx4 v[152:155], v10, s[24:27], s36 offen nt
    s_add_u32 s36, s36, 10240
    buffer_load_dwordx4 v[156:159], v10, s[24:27], s36 offen nt
    s_add_u32 s36, s36, 10240
    buffer_load_dwordx4 v[160:163], v10, s[24:27], s36 offen nt
    s_add_u32 s36, s36, 10240
    buffer_load_dwordx4 v[164:167], v10, s[24:27], s36 offen nt
    s_add_u32 s36, s36, 10240
    buffer_load_dwordx4 v[168:171], v10, s[24:27], s36 offen nt
    s_add_u32 s36, s36, 10240
    buffer_load_dwordx4 v[172:175], v10, s[24:27], s36 offen nt
    s_lshl_b32 s36, s35, 2
    s_add_u32 s36, s36, 0
    s_mul_i32 s38, s36, 13108
    s_lshr_b32 s38, s38, 16
    s_mul_i32 s39, s38, 5
    s_sub_u32 s39, s36, s39
    s_sub_u32 s41, s39, 1
    s_cmp_eq_u32 s39, 0
    s_cselect_b32 s41, 4, s41
    s_and_b32 s40, s38, 1
    s_cmp_eq_u32 s40, 1
    s_cselect_b32 s39, s41, s39
    s_mul_i32 s40, s33, 21846
    s_lshr_b32 s40, s40, 16
    s_mul_i32 s41, s40, 3
    s_sub_u32 s41, s33, s41
    s_mul_i32 s37, s38, 270
    s_mul_i32 s41, s41, 90
    s_add_u32 s37, s37, s41
    s_mul_i32 s40, s40, 5
    s_add_u32 s37, s37, s40
    s_add_u32 s37, s37, s39
    s_lshl_b32 s37, s37, 10
    s_add_u32 s44, s37, 27168768
    s_movk_i32 s48, 10240
    s_lshl_b32 s36, s35, 2
    s_add_u32 s36, s36, 1
    s_mul_i32 s38, s36, 13108
    s_lshr_b32 s38, s38, 16
    s_mul_i32 s39, s38, 5
    s_sub_u32 s39, s36, s39
    s_sub_u32 s41, s39, 1
    s_cmp_eq_u32 s39, 0
    s_cselect_b32 s41, 4, s41
    s_and_b32 s40, s38, 1
    s_cmp_eq_u32 s40, 1
    s_cselect_b32 s39, s41, s39
    s_mul_i32 s40, s33, 21846
    s_lshr_b32 s40, s40, 16
    s_mul_i32 s41, s40, 3
    s_sub_u32 s41, s33, s41
    s_mul_i32 s37, s38, 270
    s_mul_i32 s41, s41, 90
    s_add_u32 s37, s37, s41
    s_mul_i32 s40, s40, 5
    s_add_u32 s37, s37, s40
    s_add_u32 s37, s37, s39
    s_lshl_b32 s37, s37, 10
    s_add_u32 s45, s37, 27168768
    s_movk_i32 s49, 10240
    s_lshl_b32 s36, s35, 2
    s_add_u32 s36, s36, 2
    s_mul_i32 s38, s36, 13108
    s_lshr_b32 s38, s38, 16
    s_mul_i32 s39, s38, 5
    s_sub_u32 s39, s36, s39
    s_sub_u32 s41, s39, 1
    s_cmp_eq_u32 s39, 0
    s_cselect_b32 s41, 4, s41
    s_and_b32 s40, s38, 1
    s_cmp_eq_u32 s40, 1
    s_cselect_b32 s39, s41, s39
    s_mul_i32 s40, s33, 21846
    s_lshr_b32 s40, s40, 16
    s_mul_i32 s41, s40, 3
    s_sub_u32 s41, s33, s41
    s_mul_i32 s37, s38, 270
    s_mul_i32 s41, s41, 90
    s_add_u32 s37, s37, s41
    s_mul_i32 s40, s40, 5
    s_add_u32 s37, s37, s40
    s_add_u32 s37, s37, s39
    s_lshl_b32 s37, s37, 10
    s_add_u32 s46, s37, 27168768
    s_movk_i32 s50, 10240
    s_lshl_b32 s36, s35, 2
    s_add_u32 s36, s36, 3
    s_mul_i32 s38, s36, 13108
    s_lshr_b32 s38, s38, 16
    s_mul_i32 s39, s38, 5
    s_sub_u32 s39, s36, s39
    s_sub_u32 s41, s39, 1
    s_cmp_eq_u32 s39, 0
    s_cselect_b32 s41, 4, s41
    s_and_b32 s40, s38, 1
    s_cmp_eq_u32 s40, 1
    s_cselect_b32 s39, s41, s39
    s_mul_i32 s40, s33, 21846
    s_lshr_b32 s40, s40, 16
    s_mul_i32 s41, s40, 3
    s_sub_u32 s41, s33, s41
    s_mul_i32 s37, s38, 270
    s_mul_i32 s41, s41, 90
    s_add_u32 s37, s37, s41
    s_mul_i32 s40, s40, 5
    s_add_u32 s37, s37, s40
    s_add_u32 s37, s37, s39
    s_lshl_b32 s37, s37, 10
    s_add_u32 s47, s37, 27168768
    s_movk_i32 s51, 10240
    s_waitcnt vmcnt(32)
    ds_write_b128 v5, v[32:35] offset:0
    ds_write_b128 v5, v[36:39] offset:1152
    ds_write_b128 v5, v[40:43] offset:2304
    ds_write_b128 v5, v[44:47] offset:3456
    s_waitcnt lgkmcnt(0)
    ds_read_b64_tr_b16 v[200:201], v8 offset:0
    ds_read_b64_tr_b16 v[202:203], v8 offset:576
    ds_read_b64_tr_b16 v[204:205], v8 offset:32
    ds_read_b64_tr_b16 v[206:207], v8 offset:608
    ds_read_b64_tr_b16 v[208:209], v8 offset:64
    ds_read_b64_tr_b16 v[210:211], v8 offset:640
    ds_read_b64_tr_b16 v[212:213], v8 offset:96
    ds_read_b64_tr_b16 v[214:215], v8 offset:672
    s_waitcnt vmcnt(28)
    ds_write_b128 v5, v[48:51] offset:4608
    ds_write_b128 v5, v[52:55] offset:5760
    ds_write_b128 v5, v[56:59] offset:6912
    ds_write_b128 v5, v[60:63] offset:8064
    s_waitcnt lgkmcnt(4)
    buffer_store_dwordx4 v[200:203], v9, s[28:31], s44 offen sc1
    s_add_u32 s44, s44, s48
    buffer_store_dwordx4 v[204:207], v9, s[28:31], s45 offen sc1
    s_add_u32 s45, s45, s49
    buffer_store_dwordx4 v[208:211], v9, s[28:31], s46 offen sc1
    s_add_u32 s46, s46, s50
    buffer_store_dwordx4 v[212:215], v9, s[28:31], s47 offen sc1
    s_add_u32 s47, s47, s51
    s_waitcnt lgkmcnt(0)
    ds_read_b64_tr_b16 v[216:217], v8 offset:4608
    ds_read_b64_tr_b16 v[218:219], v8 offset:5184
    ds_read_b64_tr_b16 v[220:221], v8 offset:4640
    ds_read_b64_tr_b16 v[222:223], v8 offset:5216
    ds_read_b64_tr_b16 v[224:225], v8 offset:4672
    ds_read_b64_tr_b16 v[226:227], v8 offset:5248
    ds_read_b64_tr_b16 v[228:229], v8 offset:4704
    ds_read_b64_tr_b16 v[230:231], v8 offset:5280
    s_waitcnt vmcnt(28)
    ds_write_b128 v5, v[64:67] offset:0
    ds_write_b128 v5, v[68:71] offset:1152
    ds_write_b128 v5, v[72:75] offset:2304
    ds_write_b128 v5, v[76:79] offset:3456
    s_waitcnt lgkmcnt(4)
    buffer_store_dwordx4 v[216:219], v9, s[28:31], s44 offen sc1
    s_add_u32 s44, s44, s48
    buffer_store_dwordx4 v[220:223], v9, s[28:31], s45 offen sc1
    s_add_u32 s45, s45, s49
    buffer_store_dwordx4 v[224:227], v9, s[28:31], s46 offen sc1
    s_add_u32 s46, s46, s50
    buffer_store_dwordx4 v[228:231], v9, s[28:31], s47 offen sc1
    s_add_u32 s47, s47, s51
    s_waitcnt lgkmcnt(0)
    ds_read_b64_tr_b16 v[200:201], v8 offset:0
    ds_read_b64_tr_b16 v[202:203], v8 offset:576
    ds_read_b64_tr_b16 v[204:205], v8 offset:32
    ds_read_b64_tr_b16 v[206:207], v8 offset:608
    ds_read_b64_tr_b16 v[208:209], v8 offset:64
    ds_read_b64_tr_b16 v[210:211], v8 offset:640
    ds_read_b64_tr_b16 v[212:213], v8 offset:96
    ds_read_b64_tr_b16 v[214:215], v8 offset:672
    s_waitcnt vmcnt(28)
    ds_write_b128 v5, v[80:83] offset:4608
    ds_write_b128 v5, v[84:87] offset:5760
    ds_write_b128 v5, v[88:91] offset:6912
    ds_write_b128 v5, v[92:95] offset:8064
    s_waitcnt lgkmcnt(4)
    buffer_store_dwordx4 v[200:203], v9, s[28:31], s44 offen sc1
    s_add_u32 s44, s44, s48
    buffer_store_dwordx4 v[204:207], v9, s[28:31], s45 offen sc1
    s_add_u32 s45, s45, s49
    buffer_store_dwordx4 v[208:211], v9, s[28:31], s46 offen sc1
    s_add_u32 s46, s46, s50
    buffer_store_dwordx4 v[212:215], v9, s[28:31], s47 offen sc1
    s_add_u32 s47, s47, s51
    s_waitcnt lgkmcnt(0)
    ds_read_b64_tr_b16 v[216:217], v8 offset:4608
    ds_read_b64_tr_b16 v[218:219], v8 offset:5184
    ds_read_b64_tr_b16 v[220:221], v8 offset:4640
    ds_read_b64_tr_b16 v[222:223], v8 offset:5216
    ds_read_b64_tr_b16 v[224:225], v8 offset:4672
    ds_read_b64_tr_b16 v[226:227], v8 offset:5248
    ds_read_b64_tr_b16 v[228:229], v8 offset:4704
    ds_read_b64_tr_b16 v[230:231], v8 offset:5280
    s_waitcnt vmcnt(28)
    ds_write_b128 v5, v[96:99] offset:0
    ds_write_b128 v5, v[100:103] offset:1152
    ds_write_b128 v5, v[104:107] offset:2304
    ds_write_b128 v5, v[108:111] offset:3456
    s_waitcnt lgkmcnt(4)
    buffer_store_dwordx4 v[216:219], v9, s[28:31], s44 offen sc1
    s_add_u32 s44, s44, s48
    buffer_store_dwordx4 v[220:223], v9, s[28:31], s45 offen sc1
    s_add_u32 s45, s45, s49
    buffer_store_dwordx4 v[224:227], v9, s[28:31], s46 offen sc1
    s_add_u32 s46, s46, s50
    buffer_store_dwordx4 v[228:231], v9, s[28:31], s47 offen sc1
    s_add_u32 s47, s47, s51
    s_waitcnt lgkmcnt(0)
    ds_read_b64_tr_b16 v[200:201], v8 offset:0
    ds_read_b64_tr_b16 v[202:203], v8 offset:576
    ds_read_b64_tr_b16 v[204:205], v8 offset:32
    ds_read_b64_tr_b16 v[206:207], v8 offset:608
    ds_read_b64_tr_b16 v[208:209], v8 offset:64
    ds_read_b64_tr_b16 v[210:211], v8 offset:640
    ds_read_b64_tr_b16 v[212:213], v8 offset:96
    ds_read_b64_tr_b16 v[214:215], v8 offset:672
    s_waitcnt vmcnt(28)
    ds_write_b128 v5, v[112:115] offset:4608
    ds_write_b128 v5, v[116:119] offset:5760
    ds_write_b128 v5, v[120:123] offset:6912
    ds_write_b128 v5, v[124:127] offset:8064
    s_waitcnt lgkmcnt(4)
    buffer_store_dwordx4 v[200:203], v9, s[28:31], s44 offen sc1
    s_add_u32 s44, s44, s48
    buffer_store_dwordx4 v[204:207], v9, s[28:31], s45 offen sc1
    s_add_u32 s45, s45, s49
    buffer_store_dwordx4 v[208:211], v9, s[28:31], s46 offen sc1
    s_add_u32 s46, s46, s50
    buffer_store_dwordx4 v[212:215], v9, s[28:31], s47 offen sc1
    s_add_u32 s47, s47, s51
    s_waitcnt lgkmcnt(0)
    ds_read_b64_tr_b16 v[216:217], v8 offset:4608
    ds_read_b64_tr_b16 v[218:219], v8 offset:5184
    ds_read_b64_tr_b16 v[220:221], v8 offset:4640
    ds_read_b64_tr_b16 v[222:223], v8 offset:5216
    ds_read_b64_tr_b16 v[224:225], v8 offset:4672
    ds_read_b64_tr_b16 v[226:227], v8 offset:5248
    ds_read_b64_tr_b16 v[228:229], v8 offset:4704
    ds_read_b64_tr_b16 v[230:231], v8 offset:5280
    s_waitcnt vmcnt(28)
    ds_write_b128 v5, v[128:131] offset:0
    ds_write_b128 v5, v[132:135] offset:1152
    ds_write_b128 v5, v[136:139] offset:2304
    ds_write_b128 v5, v[140:143] offset:3456
    s_waitcnt lgkmcnt(4)
    buffer_store_dwordx4 v[216:219], v9, s[28:31], s44 offen sc1
    s_add_u32 s44, s44, s48
    buffer_store_dwordx4 v[220:223], v9, s[28:31], s45 offen sc1
    s_add_u32 s45, s45, s49
    buffer_store_dwordx4 v[224:227], v9, s[28:31], s46 offen sc1
    s_add_u32 s46, s46, s50
    buffer_store_dwordx4 v[228:231], v9, s[28:31], s47 offen sc1
    s_add_u32 s47, s47, s51
    s_waitcnt lgkmcnt(0)
    ds_read_b64_tr_b16 v[200:201], v8 offset:0
    ds_read_b64_tr_b16 v[202:203], v8 offset:576
    ds_read_b64_tr_b16 v[204:205], v8 offset:32
    ds_read_b64_tr_b16 v[206:207], v8 offset:608
    ds_read_b64_tr_b16 v[208:209], v8 offset:64
    ds_read_b64_tr_b16 v[210:211], v8 offset:640
    ds_read_b64_tr_b16 v[212:213], v8 offset:96
    ds_read_b64_tr_b16 v[214:215], v8 offset:672
    s_waitcnt vmcnt(28)
    ds_write_b128 v5, v[144:147] offset:4608
    ds_write_b128 v5, v[148:151] offset:5760
    ds_write_b128 v5, v[152:155] offset:6912
    ds_write_b128 v5, v[156:159] offset:8064
    s_waitcnt lgkmcnt(4)
    buffer_store_dwordx4 v[200:203], v9, s[28:31], s44 offen sc1
    s_add_u32 s44, s44, s48
    buffer_store_dwordx4 v[204:207], v9, s[28:31], s45 offen sc1
    s_add_u32 s45, s45, s49
    buffer_store_dwordx4 v[208:211], v9, s[28:31], s46 offen sc1
    s_add_u32 s46, s46, s50
    buffer_store_dwordx4 v[212:215], v9, s[28:31], s47 offen sc1
    s_add_u32 s47, s47, s51
    s_waitcnt lgkmcnt(0)
    ds_read_b64_tr_b16 v[216:217], v8 offset:4608
    ds_read_b64_tr_b16 v[218:219], v8 offset:5184
    ds_read_b64_tr_b16 v[220:221], v8 offset:4640
    ds_read_b64_tr_b16 v[222:223], v8 offset:5216
    ds_read_b64_tr_b16 v[224:225], v8 offset:4672
    ds_read_b64_tr_b16 v[226:227], v8 offset:5248
    ds_read_b64_tr_b16 v[228:229], v8 offset:4704
    ds_read_b64_tr_b16 v[230:231], v8 offset:5280
    s_waitcnt vmcnt(28)
    ds_write_b128 v5, v[160:163] offset:0
    ds_write_b128 v5, v[164:167] offset:1152
    ds_write_b128 v5, v[168:171] offset:2304
    ds_write_b128 v5, v[172:175] offset:3456
    s_waitcnt lgkmcnt(4)
    buffer_store_dwordx4 v[216:219], v9, s[28:31], s44 offen sc1
    s_add_u32 s44, s44, s48
    buffer_store_dwordx4 v[220:223], v9, s[28:31], s45 offen sc1
    s_add_u32 s45, s45, s49
    buffer_store_dwordx4 v[224:227], v9, s[28:31], s46 offen sc1
    s_add_u32 s46, s46, s50
    buffer_store_dwordx4 v[228:231], v9, s[28:31], s47 offen sc1
    s_add_u32 s47, s47, s51
    s_waitcnt lgkmcnt(0)
    ds_read_b64_tr_b16 v[200:201], v8 offset:0
    ds_read_b64_tr_b16 v[202:203], v8 offset:576
    ds_read_b64_tr_b16 v[204:205], v8 offset:32
    ds_read_b64_tr_b16 v[206:207], v8 offset:608
    ds_read_b64_tr_b16 v[208:209], v8 offset:64
    ds_read_b64_tr_b16 v[210:211], v8 offset:640
    ds_read_b64_tr_b16 v[212:213], v8 offset:96
    ds_read_b64_tr_b16 v[214:215], v8 offset:672
    s_waitcnt lgkmcnt(0)
    buffer_store_dwordx4 v[200:203], v9, s[28:31], s44 offen sc1
    s_add_u32 s44, s44, s48
    buffer_store_dwordx4 v[204:207], v9, s[28:31], s45 offen sc1
    s_add_u32 s45, s45, s49
    buffer_store_dwordx4 v[208:211], v9, s[28:31], s46 offen sc1
    s_add_u32 s46, s46, s50
    buffer_store_dwordx4 v[212:215], v9, s[28:31], s47 offen sc1
    s_add_u32 s47, s47, s51
    s_endpgm
k1_end:
    s_endpgm
.globl chain_kernel
.p2align 8
.type chain_kernel,@function
chain_kernel:
    s_cmp_ge_u32 s2, 256
    s_cbranch_scc1 chain_end
    s_load_dwordx2 s[4:5], s[0:1], 0
    s_load_dwordx2 s[6:7], s[0:1], 104
    s_load_dwordx2 s[10:11], s[0:1], 120
    v_lshrrev_b32 v2, 6, v0
    v_and_b32 v1, 63, v0
    v_readfirstlane_b32 s20, v2
    s_and_b32 s25, s2, 7
    s_lshr_b32 s26, s2, 3
    s_lshl_b32 s23, s25, 3
    s_lshr_b32 s27, s26, 2
    s_add_u32 s23, s23, s27
    s_and_b32 s24, s26, 3
    s_and_b32 s21, s20, 1
    s_lshr_b32 s22, s20, 1
    v_lshrrev_b32 v3, 4, v1
    v_and_b32 v4, 15, v1
    v_lshlrev_b32 v8, 4, v1
    s_waitcnt lgkmcnt(0)
    s_mov_b32 s28, s10
    s_mov_b32 s29, s11
    s_mov_b32 s30, 268435456
    s_mov_b32 s31, 0x00020000
    s_mul_i32 s25, s20, 10240
    s_add_u32 s10, s25, 0
    s_mul_i32 s11, s23, 40960
    s_add_u32 s11, s11, s25
    s_add_u32 s11, s11, 5492736
    s_lshl_b32 s12, s20, 10
    s_add_u32 s13, s12, 8121856
    s_add_u32 s12, s12, 130560
    s_lshl_b32 s14, s21, 10
    s_add_u32 s14, s14, 139264
    s_mul_i32 s15, s21, 7168
    s_mul_i32 s25, s24, 640
    s_add_u32 s15, s15, s25
    s_add_u32 s15, s15, 8146944
    s_mov_b32 m0, s10
    s_add_u32 s10, s10, 4096
    buffer_load_dwordx4 v8, s[28:31], s11 offen offset:0 lds
    buffer_load_dwordx4 v8, s[28:31], s11 offen offset:1024 lds
    buffer_load_dwordx4 v8, s[28:31], s11 offen offset:2048 lds
    buffer_load_dwordx4 v8, s[28:31], s11 offen offset:3072 lds
    s_add_u32 s11, s11, 4096
    s_mov_b32 m0, s10
    s_add_u32 s10, s10, 4096
    buffer_load_dwordx4 v8, s[28:31], s11 offen offset:0 lds
    buffer_load_dwordx4 v8, s[28:31], s11 offen offset:1024 lds
    buffer_load_dwordx4 v8, s[28:31], s11 offen offset:2048 lds
    buffer_load_dwordx4 v8, s[28:31], s11 offen offset:3072 lds
    s_add_u32 s11, s11, 4096
    s_mov_b32 m0, s10
    s_add_u32 s10, s10, 4096
    buffer_load_dwordx4 v8, s[28:31], s11 offen offset:0 lds
    buffer_load_dwordx4 v8, s[28:31], s11 offen offset:1024 lds
    s_mov_b32 m0, s12
    s_nop 0
    buffer_load_dwordx4 v8, s[28:31], s13 offen lds
    s_mov_b32 m0, 134656
    s_mov_b32 s13, 8125952
    buffer_load_dwordx4 v8, s[28:31], s13 offen lds
    s_mov_b32 m0, s14
    s_nop 0
    buffer_load_dwordx4 v8, s[28:31], s15 offen lds
    s_mov_b32 s32, s6
    s_mov_b32 s33, s7
    s_mov_b32 s34, 2621440
    s_mov_b32 s35, 0x00020000
    s_mul_i32 s36, s24, 200
    s_mul_i32 s37, s21, 100
    s_add_u32 s36, s36, s37
    s_mul_i32 s37, s22, 50
    s_add_u32 s36, s36, s37
    s_lshl_b32 s36, s36, 10
    s_add_u32 s37, s36, 24055808
    s_add_u32 s36, s36, 23236608
    v_lshrrev_b32 v2, 1, v3
    s_lshl_b32 s26, s21, 2
    v_add_u32 v2, s26, v2
    v_and_b32 v7, 7, v4
    v_xor_b32 v2, v2, v7
    v_lshlrev_b32 v2, 4, v2
    buffer_load_dwordx4 a[0:3], v8, s[28:31], s36 offen offset:0
    v_lshl_add_u32 v226, v4, 8, v2
    v_and_b32 v2, 1, v3
    v_lshl_add_u32 v226, v2, 3, v226
    s_mul_i32 s26, s22, 20480
    s_add_u32 s27, s26, 0
    v_add_u32 v226, s27, v226
    v_lshlrev_b32 v227, 5, v4
    v_add_u32 v227, 122880, v227
    s_lshl_b32 s27, s21, 3
    v_add_u32 v2, s27, v3
    v_xor_b32 v2, v2, v7
    v_lshlrev_b32 v2, 4, v2
    v_and_b32 v7, 3, v4
    v_lshl_add_u32 v2, v7, 8, v2
    v_lshrrev_b32 v7, 2, v4
    v_lshl_add_u32 v2, v7, 10, v2
    s_add_u32 s27, s26, 40960
    v_add_u32 v228, s27, v2
    v_xor_b32 v2, v4, v3
    buffer_load_dwordx4 a[4:7], v8, s[28:31], s36 offen offset:1024
    v_lshlrev_b32 v2, 4, v2
    v_lshl_add_u32 v2, v3, 8, v2
    v_xor_b32 v7, 64, v2
    s_mul_i32 s26, s22, 30720
    s_add_u32 s26, s26, 40960
    s_mul_i32 s27, s22, 10240
    s_sub_u32 s27, 61440, s27
    v_add_u32 v229, s26, v2
    v_add_u32 v230, s26, v7
    v_add_u32 v231, s27, v2
    v_add_u32 v232, s27, v7
    v_lshlrev_b32 v2, 4, v3
    s_mul_i32 s26, s21, 384
    s_add_u32 s26, s26, 139264
    v_add_u32 v233, s26, v2
    s_mul_i32 s26, s21, 64
    s_add_u32 s26, s26, 139520
    v_add_u32 v234, s26, v2
    buffer_load_dwordx4 a[8:11], v8, s[28:31], s36 offen offset:2048
    s_lshl_b32 s26, s22, 7
    s_add_u32 s26, s26, 138240
    v_lshl_add_u32 v235, v4, 3, s26
    s_mul_i32 s39, s24, 5
    s_mul_i32 s40, s21, 3
    s_add_u32 s40, s40, s39
    s_add_u32 s41, s39, 2
    v_lshrrev_b32 v12, 1, v3
    v_and_b32 v13, 1, v3
    v_lshlrev_b32 v13, 3, v13
    s_add_u32 s26, s40, 0
    v_add_u32 v14, 0, v12
    s_and_b32 s27, s26, 1
    s_lshl_b32 s27, s27, 2
    v_add_u32 v15, s27, v14
    v_xor_b32 v15, v15, v4
    v_lshlrev_b32 v15, 4, v15
    v_lshl_add_u32 v15, v14, 8, v15
    buffer_load_dwordx4 a[12:15], v8, s[28:31], s36 offen offset:3072
    v_add_u32 v15, v15, v13
    s_mul_i32 s27, s22, 20
    s_add_u32 s27, s27, s26
    s_lshl_b32 s27, s27, 10
    s_add_u32 s27, s27, 40960
    v_add_u32 v236, s27, v15
    s_add_u32 s26, s40, 0
    v_add_u32 v14, 2, v12
    s_and_b32 s27, s26, 1
    s_lshl_b32 s27, s27, 2
    v_add_u32 v15, s27, v14
    v_xor_b32 v15, v15, v4
    v_lshlrev_b32 v15, 4, v15
    v_lshl_add_u32 v15, v14, 8, v15
    v_add_u32 v15, v15, v13
    s_mul_i32 s27, s22, 20
    s_add_u32 s27, s27, s26
    s_lshl_b32 s27, s27, 10
    s_add_u32 s36, s36, 4096
    buffer_load_dwordx4 a[16:19], v8, s[28:31], s36 offen offset:0
    s_add_u32 s27, s27, 40960
    v_add_u32 v237, s27, v15
    s_add_u32 s26, s40, 1
    v_add_u32 v14, 0, v12
    s_and_b32 s27, s26, 1
    s_lshl_b32 s27, s27, 2
    v_add_u32 v15, s27, v14
    v_xor_b32 v15, v15, v4
    v_lshlrev_b32 v15, 4, v15
    v_lshl_add_u32 v15, v14, 8, v15
    v_add_u32 v15, v15, v13
    s_mul_i32 s27, s22, 20
    s_add_u32 s27, s27, s26
    s_lshl_b32 s27, s27, 10
    s_add_u32 s27, s27, 40960
    v_add_u32 v238, s27, v15
    s_add_u32 s26, s40, 1
    v_add_u32 v14, 2, v12
    buffer_load_dwordx4 a[20:23], v8, s[28:31], s36 offen offset:1024
    s_and_b32 s27, s26, 1
    s_lshl_b32 s27, s27, 2
    v_add_u32 v15, s27, v14
    v_xor_b32 v15, v15, v4
    v_lshlrev_b32 v15, 4, v15
    v_lshl_add_u32 v15, v14, 8, v15
    v_add_u32 v15, v15, v13
    s_mul_i32 s27, s22, 20
    s_add_u32 s27, s27, s26
    s_lshl_b32 s27, s27, 10
    s_add_u32 s27, s27, 40960
    v_add_u32 v239, s27, v15
    s_mov_b32 s26, s41
    s_lshl_b32 s27, s21, 1
    v_add_u32 v14, s27, v12
    s_and_b32 s27, s26, 1
    s_lshl_b32 s27, s27, 2
    v_add_u32 v15, s27, v14
    buffer_load_dwordx4 a[24:27], v8, s[28:31], s36 offen offset:2048
    v_xor_b32 v15, v15, v4
    v_lshlrev_b32 v15, 4, v15
    v_lshl_add_u32 v15, v14, 8, v15
    v_add_u32 v15, v15, v13
    s_mul_i32 s27, s22, 20
    s_add_u32 s27, s27, s26
    s_lshl_b32 s27, s27, 10
    s_add_u32 s27, s27, 40960
    v_add_u32 v240, s27, v15
    s_lshr_b32 s26, s24, 1
    s_add_u32 s26, s26, 1
    s_sub_u32 s27, 0, s26
    s_and_b32 s42, s24, 1
    s_cmp_eq_u32 s42, 1
    s_cselect_b32 s42, s27, s26
    s_lshl_b32 s43, s23, 5
    s_lshl_b32 s26, s22, 4
    s_add_u32 s43, s43, s26
    buffer_load_dwordx4 a[28:31], v8, s[28:31], s36 offen offset:3072
    v_add_u32 v241, s43, v4
    v_add_u32 v241, s42, v241
    s_movk_i32 s27, 2048
    v_cmp_gt_u32 s[60:61], s27, v241
    v_lshrrev_b32 v242, 4, v241
    v_and_b32 v241, 15, v241
    s_mov_b32 s27, 20480
    v_mul_lo_u32 v242, v242, s27
    v_lshl_add_u32 v242, v241, 4, v242
    v_and_b32 v241, 1, v3
    v_lshlrev_b32 v241, 9, v241
    v_lshrrev_b32 v2, 1, v3
    v_lshl_add_u32 v241, v2, 8, v241
    v_add_u32 v241, v241, v242
    s_lshl_b32 s27, s21, 9
    v_lshl_add_u32 v242, v2, 8, v242
    v_add_u32 v242, s27, v242
    v_and_b32 v2, 1, v3
    v_lshl_add_u32 v242, v2, 3, v242
    s_add_u32 s36, s36, 4096
    buffer_load_dwordx4 a[32:35], v8, s[28:31], s36 offen offset:0
    v_add_u32 v243, s43, v4
    v_lshrrev_b32 v244, 4, v243
    v_and_b32 v243, 15, v243
    s_mov_b32 s27, 20480
    v_mul_lo_u32 v244, v244, s27
    v_lshl_add_u32 v244, v243, 4, v244
    v_and_b32 v243, 1, v3
    v_lshlrev_b32 v243, 9, v243
    v_lshrrev_b32 v2, 1, v3
    v_lshl_add_u32 v243, v2, 8, v243
    v_add_u32 v243, v243, v244
    s_lshl_b32 s27, s21, 9
    v_lshl_add_u32 v244, v2, 8, v244
    v_add_u32 v244, s27, v244
    v_and_b32 v2, 1, v3
    v_lshl_add_u32 v244, v2, 3, v244
    s_lshl_b32 s44, s40, 10
    s_add_u32 s38, s44, 13406208
    s_add_u32 s44, s44, 10784768
    buffer_load_dwordx4 a[36:39], v8, s[28:31], s36 offen offset:1024
    s_lshl_b32 s45, s41, 10
    s_add_u32 s39, s45, 13406208
    s_add_u32 s45, s45, 10784768
    s_lshl_b32 s46, s23, 2
    s_add_u32 s46, s46, s24
    s_lshl_b32 s46, s46, 7
    s_add_u32 s49, s46, 29413376
    s_add_u32 s46, s46, 29380608
    v_add_u32 v7, 1, v1
    v_lshrrev_b32 v7, 1, v7
    v_add_u32 v7, s23, v7
    v_subrev_u32 v7, 1, v7
    v_max_i32 v7, 0, v7
    v_min_i32 v7, 63, v7
    v_lshrrev_b32 v2, 1, v1
    s_lshl_b32 s26, s22, 1
    v_add_u32 v2, s26, v2
    v_lshl_add_u32 v7, v7, 2, v2
    buffer_load_dwordx4 a[40:43], v8, s[28:31], s36 offen offset:2048
    v_lshlrev_b32 v245, 7, v7
    s_lshl_b32 s26, s23, 1
    s_add_u32 s27, s26, s22
    s_mul_i32 s27, s27, 20
    s_mul_i32 s3, s22, 10
    s_add_u32 s27, s27, s3
    s_lshl_b32 s27, s27, 10
    s_add_u32 s50, s27, 10784768
    s_add_u32 s27, s26, 1
    s_sub_u32 s27, s27, s22
    s_mul_i32 s27, s27, 20
    s_add_u32 s27, s27, s3
    s_lshl_b32 s27, s27, 10
    s_add_u32 s51, s27, 10784768
    s_mul_i32 s26, s20, 5120
    s_add_u32 s26, s26, 143360
    v_add_u32 v246, s26, v8
    s_xor_b32 s27, s20, 2
    buffer_load_dwordx4 a[44:47], v8, s[28:31], s36 offen offset:3072
    s_mul_i32 s27, s27, 5120
    s_add_u32 s27, s27, 143360
    v_add_u32 v247, s27, v8
    s_lshr_b32 s26, s2, 3
    s_and_b32 s3, s2, 7
    s_and_b32 s4, s3, 1
    s_lshr_b32 s3, s3, 1
    s_and_b32 s52, s26, 7
    s_lshl_b32 s27, s4, 3
    s_add_u32 s52, s52, s27
    s_lshr_b32 s27, s26, 3
    s_lshl_b32 s53, s3, 2
    s_add_u32 s53, s53, s27
    s_and_b32 s57, s26, 3
    s_lshl_b32 s27, s4, 2
    s_add_u32 s57, s57, s27
    s_lshr_b32 s27, s26, 2
    s_lshl_b32 s58, s3, 3
    s_add_u32 s36, s36, 4096
    buffer_load_dwordx4 a[48:51], v8, s[28:31], s36 offen offset:0
    s_add_u32 s58, s58, s27
    s_and_b32 s57, s26, 7
    s_lshr_b32 s27, s26, 3
    s_and_b32 s58, s2, 7
    s_lshl_b32 s58, s58, 2
    s_add_u32 s58, s58, s27
    s_mul_i32 s54, s52, 143360
    s_add_u32 s54, s54, 24875008
    s_mul_i32 s59, s57, 276480
    s_add_u32 s59, s59, 27168768
    v_mov_b32 v224, 0x3f803f80
    v_mov_b32 v216, 0
    v_mov_b32 v217, 0
    v_mov_b32 v220, 0
    v_mov_b32 v221, 0
    v_mov_b32 v218, 0
    v_mov_b32 v219, 0
    v_mov_b32 v222, 0
    buffer_load_dwordx4 a[52:55], v8, s[28:31], s36 offen offset:1024
    v_mov_b32 v223, 0
    s_waitcnt vmcnt(14)
    s_barrier
    v_xor_b32 v12, 32, v226
    ds_read_b64 v[32:33], v226 offset:0
    ds_read_b64 v[34:35], v226 offset:128
    ds_read_b64 v[36:37], v12 offset:0
    ds_read_b64 v[38:39], v12 offset:128
    ds_read_b64 v[40:41], v226 offset:4096
    buffer_load_dwordx4 a[56:59], v8, s[28:31], s36 offen offset:2048
    ds_read_b64 v[42:43], v226 offset:4224
    s_waitcnt lgkmcnt(4)
    v_dot2_f32_bf16 v220, v32, v224, v220
    v_lshlrev_b32 v72, 16, v32
    v_dot2_f32_bf16 v221, v32, v32, v221
    v_and_b32 v73, 0xffff0000, v32
    v_dot2_f32_bf16 v220, v33, v224, v220
    ds_read_b64 v[44:45], v12 offset:4096
    v_lshlrev_b32 v74, 16, v33
    v_dot2_f32_bf16 v221, v33, v33, v221
    v_and_b32 v75, 0xffff0000, v33
    v_dot2_f32_bf16 v220, v34, v224, v220
    ds_read_b64 v[46:47], v12 offset:4224
    buffer_load_dwordx4 a[60:63], v8, s[28:31], s36 offen offset:3072
    v_lshlrev_b32 v76, 16, v34
    v_dot2_f32_bf16 v221, v34, v34, v221
    v_and_b32 v77, 0xffff0000, v34
    v_dot2_f32_bf16 v220, v35, v224, v220
    v_lshlrev_b32 v78, 16, v35
    v_dot2_f32_bf16 v221, v35, v35, v221
    v_and_b32 v79, 0xffff0000, v35
    s_waitcnt lgkmcnt(4)
    v_dot2_f32_bf16 v222, v36, v224, v222
    v_lshlrev_b32 v80, 16, v36
    v_dot2_f32_bf16 v223, v36, v36, v223
    v_and_b32 v81, 0xffff0000, v36
    v_dot2_f32_bf16 v222, v37, v224, v222
    ds_read_b64 v[48:49], v226 offset:8192
    v_lshlrev_b32 v82, 16, v37
    v_dot2_f32_bf16 v223, v37, v37, v223
    v_and_b32 v83, 0xffff0000, v37
    s_add_u32 s36, s36, 4096
    buffer_load_dwordx4 a[64:67], v8, s[28:31], s36 offen offset:0
    v_dot2_f32_bf16 v222, v38, v224, v222
    ds_read_b64 v[50:51], v226 offset:8320
    v_lshlrev_b32 v84, 16, v38
    v_dot2_f32_bf16 v223, v38, v38, v223
    v_and_b32 v85, 0xffff0000, v38
    v_dot2_f32_bf16 v222, v39, v224, v222
    v_lshlrev_b32 v86, 16, v39
    v_dot2_f32_bf16 v223, v39, v39, v223
    v_and_b32 v87, 0xffff0000, v39
    s_waitcnt lgkmcnt(4)
    v_dot2_f32_bf16 v220, v40, v224, v220
    v_lshlrev_b32 v88, 16, v40
    v_dot2_f32_bf16 v221, v40, v40, v221
    v_and_b32 v89, 0xffff0000, v40
    v_dot2_f32_bf16 v220, v41, v224, v220
    ds_read_b64 v[52:53], v12 offset:8192
    buffer_load_dwordx4 a[68:71], v8, s[28:31], s36 offen offset:1024
    v_lshlrev_b32 v90, 16, v41
    v_dot2_f32_bf16 v221, v41, v41, v221
    v_and_b32 v91, 0xffff0000, v41
    v_dot2_f32_bf16 v220, v42, v224, v220
    ds_read_b64 v[54:55], v12 offset:8320
    v_lshlrev_b32 v92, 16, v42
    v_dot2_f32_bf16 v221, v42, v42, v221
    v_and_b32 v93, 0xffff0000, v42
    v_dot2_f32_bf16 v220, v43, v224, v220
    v_lshlrev_b32 v94, 16, v43
    v_dot2_f32_bf16 v221, v43, v43, v221
    v_and_b32 v95, 0xffff0000, v43
    s_waitcnt lgkmcnt(4)
    v_dot2_f32_bf16 v222, v44, v224, v222
    v_lshlrev_b32 v96, 16, v44
    v_dot2_f32_bf16 v223, v44, v44, v223
    v_and_b32 v97, 0xffff0000, v44
    buffer_load_dwordx4 a[72:75], v8, s[28:31], s36 offen offset:2048
    v_dot2_f32_bf16 v222, v45, v224, v222
    ds_read_b64 v[56:57], v226 offset:12288
    v_lshlrev_b32 v98, 16, v45
    v_dot2_f32_bf16 v223, v45, v45, v223
    v_and_b32 v99, 0xffff0000, v45
    v_dot2_f32_bf16 v222, v46, v224, v222
    ds_read_b64 v[58:59], v226 offset:12416
    v_lshlrev_b32 v100, 16, v46
    v_dot2_f32_bf16 v223, v46, v46, v223
    v_and_b32 v101, 0xffff0000, v46
    v_dot2_f32_bf16 v222, v47, v224, v222
    v_lshlrev_b32 v102, 16, v47
    v_dot2_f32_bf16 v223, v47, v47, v223
    v_and_b32 v103, 0xffff0000, v47
    s_waitcnt lgkmcnt(4)
    buffer_load_dwordx4 a[76:79], v8, s[28:31], s36 offen offset:3072
    v_dot2_f32_bf16 v220, v48, v224, v220
    v_lshlrev_b32 v104, 16, v48
    v_dot2_f32_bf16 v221, v48, v48, v221
    v_and_b32 v105, 0xffff0000, v48
    v_dot2_f32_bf16 v220, v49, v224, v220
    ds_read_b64 v[60:61], v12 offset:12288
    v_lshlrev_b32 v106, 16, v49
    v_dot2_f32_bf16 v221, v49, v49, v221
    v_and_b32 v107, 0xffff0000, v49
    v_dot2_f32_bf16 v220, v50, v224, v220
    ds_read_b64 v[62:63], v12 offset:12416
    v_lshlrev_b32 v108, 16, v50
    v_dot2_f32_bf16 v221, v50, v50, v221
    v_and_b32 v109, 0xffff0000, v50
    v_dot2_f32_bf16 v220, v51, v224, v220
    s_add_u32 s36, s36, 4096
    buffer_load_dwordx4 a[80:83], v8, s[28:31], s36 offen offset:0
    v_lshlrev_b32 v110, 16, v51
    v_dot2_f32_bf16 v221, v51, v51, v221
    v_and_b32 v111, 0xffff0000, v51
    s_waitcnt lgkmcnt(4)
    v_dot2_f32_bf16 v222, v52, v224, v222
    v_lshlrev_b32 v112, 16, v52
    v_dot2_f32_bf16 v223, v52, v52, v223
    v_and_b32 v113, 0xffff0000, v52
    v_dot2_f32_bf16 v222, v53, v224, v222
    ds_read_b64 v[64:65], v226 offset:16384
    v_lshlrev_b32 v114, 16, v53
    v_dot2_f32_bf16 v223, v53, v53, v223
    v_and_b32 v115, 0xffff0000, v53
    v_dot2_f32_bf16 v222, v54, v224, v222
    ds_read_b64 v[66:67], v226 offset:16512
    buffer_load_dwordx4 a[84:87], v8, s[28:31], s36 offen offset:1024
    v_lshlrev_b32 v116, 16, v54
    v_dot2_f32_bf16 v223, v54, v54, v223
    v_and_b32 v117, 0xffff0000, v54
    v_dot2_f32_bf16 v222, v55, v224, v222
    v_lshlrev_b32 v118, 16, v55
    v_dot2_f32_bf16 v223, v55, v55, v223
    v_and_b32 v119, 0xffff0000, v55
    s_waitcnt lgkmcnt(4)
    v_dot2_f32_bf16 v220, v56, v224, v220
    v_lshlrev_b32 v120, 16, v56
    v_dot2_f32_bf16 v221, v56, v56, v221
    v_and_b32 v121, 0xffff0000, v56
    v_dot2_f32_bf16 v220, v57, v224, v220
    ds_read_b64 v[68:69], v12 offset:16384
    v_lshlrev_b32 v122, 16, v57
    v_dot2_f32_bf16 v221, v57, v57, v221
    v_and_b32 v123, 0xffff0000, v57
    buffer_load_dwordx4 a[88:91], v8, s[28:31], s36 offen offset:2048
    v_dot2_f32_bf16 v220, v58, v224, v220
    ds_read_b64 v[70:71], v12 offset:16512
    v_lshlrev_b32 v124, 16, v58
    v_dot2_f32_bf16 v221, v58, v58, v221
    v_and_b32 v125, 0xffff0000, v58
    v_dot2_f32_bf16 v220, v59, v224, v220
    v_lshlrev_b32 v126, 16, v59
    v_dot2_f32_bf16 v221, v59, v59, v221
    v_and_b32 v127, 0xffff0000, v59
    s_waitcnt lgkmcnt(4)
    v_dot2_f32_bf16 v222, v60, v224, v222
    v_lshlrev_b32 v128, 16, v60
    v_dot2_f32_bf16 v223, v60, v60, v223
    v_and_b32 v129, 0xffff0000, v60
    v_dot2_f32_bf16 v222, v61, v224, v222
    v_lshlrev_b32 v130, 16, v61
    v_dot2_f32_bf16 v223, v61, v61, v223
    buffer_load_dwordx4 a[92:95], v8, s[28:31], s36 offen offset:3072
    v_and_b32 v131, 0xffff0000, v61
    v_dot2_f32_bf16 v222, v62, v224, v222
    v_lshlrev_b32 v132, 16, v62
    v_dot2_f32_bf16 v223, v62, v62, v223
    v_and_b32 v133, 0xffff0000, v62
    v_dot2_f32_bf16 v222, v63, v224, v222
    v_lshlrev_b32 v134, 16, v63
    v_dot2_f32_bf16 v223, v63, v63, v223
    v_and_b32 v135, 0xffff0000, v63
    s_waitcnt lgkmcnt(2)
    v_dot2_f32_bf16 v220, v64, v224, v220
    v_lshlrev_b32 v136, 16, v64
    v_dot2_f32_bf16 v221, v64, v64, v221
    v_and_b32 v137, 0xffff0000, v64
    v_dot2_f32_bf16 v220, v65, v224, v220
    v_lshlrev_b32 v138, 16, v65
    v_dot2_f32_bf16 v221, v65, v65, v221
    v_and_b32 v139, 0xffff0000, v65
    v_dot2_f32_bf16 v220, v66, v224, v220
    s_add_u32 s36, s36, 4096
    buffer_load_dwordx4 a[96:99], v8, s[28:31], s36 offen offset:0
    v_lshlrev_b32 v140, 16, v66
    v_dot2_f32_bf16 v221, v66, v66, v221
    v_and_b32 v141, 0xffff0000, v66
    v_dot2_f32_bf16 v220, v67, v224, v220
    v_lshlrev_b32 v142, 16, v67
    v_dot2_f32_bf16 v221, v67, v67, v221
    v_and_b32 v143, 0xffff0000, v67
    s_waitcnt lgkmcnt(0)
    v_dot2_f32_bf16 v222, v68, v224, v222
    v_lshlrev_b32 v144, 16, v68
    v_dot2_f32_bf16 v223, v68, v68, v223
    v_and_b32 v145, 0xffff0000, v68
    v_dot2_f32_bf16 v222, v69, v224, v222
    v_lshlrev_b32 v146, 16, v69
    v_dot2_f32_bf16 v223, v69, v69, v223
    v_and_b32 v147, 0xffff0000, v69
    v_dot2_f32_bf16 v222, v70, v224, v222
    v_lshlrev_b32 v148, 16, v70
    v_dot2_f32_bf16 v223, v70, v70, v223
    buffer_load_dwordx4 a[100:103], v8, s[28:31], s36 offen offset:1024
    v_and_b32 v149, 0xffff0000, v70
    v_dot2_f32_bf16 v222, v71, v224, v222
    v_lshlrev_b32 v150, 16, v71
    v_dot2_f32_bf16 v223, v71, v71, v223
    v_and_b32 v151, 0xffff0000, v71
    s_nop 2
    s_nop 1
    v_add_f32_dpp v220, v220, v220 quad_perm:[1,0,3,2] row_mask:0xf bank_mask:0xf
    v_add_f32_dpp v221, v221, v221 quad_perm:[1,0,3,2] row_mask:0xf bank_mask:0xf
    v_add_f32_dpp v222, v222, v222 quad_perm:[1,0,3,2] row_mask:0xf bank_mask:0xf
    v_add_f32_dpp v223, v223, v223 quad_perm:[1,0,3,2] row_mask:0xf bank_mask:0xf
    v_add_f32_dpp v220, v220, v220 quad_perm:[2,3,0,1] row_mask:0xf bank_mask:0xf
    v_add_f32_dpp v221, v221, v221 quad_perm:[2,3,0,1] row_mask:0xf bank_mask:0xf
    v_add_f32_dpp v222, v222, v222 quad_perm:[2,3,0,1] row_mask:0xf bank_mask:0xf
    v_add_f32_dpp v223, v223, v223 quad_perm:[2,3,0,1] row_mask:0xf bank_mask:0xf
    v_add_f32_dpp v220, v220, v220 row_half_mirror row_mask:0xf bank_mask:0xf
    v_add_f32_dpp v221, v221, v221 row_half_mirror row_mask:0xf bank_mask:0xf
    v_add_f32_dpp v222, v222, v222 row_half_mirror row_mask:0xf bank_mask:0xf
    v_add_f32_dpp v223, v223, v223 row_half_mirror row_mask:0xf bank_mask:0xf
    buffer_load_dwordx4 a[104:107], v8, s[28:31], s36 offen offset:2048
    v_add_f32_dpp v220, v220, v220 row_mirror row_mask:0xf bank_mask:0xf
    v_add_f32_dpp v221, v221, v221 row_mirror row_mask:0xf bank_mask:0xf
    v_add_f32_dpp v222, v222, v222 row_mirror row_mask:0xf bank_mask:0xf
    v_add_f32_dpp v223, v223, v223 row_mirror row_mask:0xf bank_mask:0xf
    v_mul_f32 v220, 0x3acccccd, v220
    v_mul_f32 v222, 0x3acccccd, v222
    v_mul_f32 v221, 0x3acccccd, v221
    v_mul_f32 v223, 0x3acccccd, v223
    v_fma_f32 v221, -v220, v220, v221
    v_fma_f32 v223, -v222, v222, v223
    v_max_f32 v221, 0, v221
    v_max_f32 v223, 0, v223
    v_cvt_pk_bf16_f32 v192, v220, v221
    v_cvt_pk_bf16_f32 v193, v222, v223
    v_lshlrev_b32 v220, 16, v192
    v_lshlrev_b32 v222, 16, v193
    v_and_b32 v221, 0xffff0000, v192
    v_and_b32 v223, 0xffff0000, v193
    v_add_f32 v221, 0x3727c5ac, v221
    buffer_load_dwordx4 a[108:111], v8, s[28:31], s36 offen offset:3072
    v_add_f32 v223, 0x3727c5ac, v223
    v_cvt_pk_bf16_f32 v192, v221, v221
    v_cvt_pk_bf16_f32 v193, v223, v223
    v_lshlrev_b32 v221, 16, v192
    v_lshlrev_b32 v223, 16, v193
    v_sqrt_f32 v221, v221
    v_sqrt_f32 v223, v223
    s_nop 0
    s_nop 0
    v_cvt_pk_bf16_f32 v192, v221, v221
    v_cvt_pk_bf16_f32 v193, v223, v223
    v_lshlrev_b32 v221, 16, v192
    v_lshlrev_b32 v223, 16, v193
    v_rcp_f32 v221, v221
    v_rcp_f32 v223, v223
    s_add_u32 s36, s36, 4096
    buffer_load_dwordx4 a[112:115], v8, s[28:31], s36 offen offset:0
    s_nop 0
    s_nop 0
    v_mul_f32 v220, v220, v221
    v_mul_f32 v222, v222, v223
    v_sub_f32 v220, 0, v220
    v_sub_f32 v222, 0, v222
    v_mov_b32 v216, 0
    v_mov_b32 v217, 0
    v_mov_b32 v218, 0
    v_mov_b32 v219, 0
    v_xor_b32 v12, 64, v228
    ds_read_b128 v[152:155], v227 offset:10240
    ds_read_b128 v[156:159], v227 offset:10256
    ds_read_b128 v[160:163], v227 offset:7680
    buffer_load_dwordx4 a[116:119], v8, s[28:31], s36 offen offset:1024
    ds_read_b128 v[164:167], v227 offset:7696
    s_waitcnt lgkmcnt(0)
    v_pk_fma_f32 v[72:73], v[72:73], v[220:221], v[220:221] op_sel:[0,1,0] op_sel_hi:[1,1,0]
    v_pk_fma_f32 v[74:75], v[74:75], v[220:221], v[220:221] op_sel:[0,1,0] op_sel_hi:[1,1,0]
    v_pk_fma_f32 v[76:77], v[76:77], v[220:221], v[220:221] op_sel:[0,1,0] op_sel_hi:[1,1,0]
    ds_read_b128 v[168:171], v227 offset:10752
    v_pk_fma_f32 v[78:79], v[78:79], v[220:221], v[220:221] op_sel:[0,1,0] op_sel_hi:[1,1,0]
    v_pk_fma_f32 v[72:73], v[72:73], v[152:153], v[160:161]
    v_pk_fma_f32 v[74:75], v[74:75], v[154:155], v[162:163]
    ds_read_b128 v[172:175], v227 offset:10768
    v_pk_fma_f32 v[76:77], v[76:77], v[156:157], v[164:165]
    v_pk_fma_f32 v[78:79], v[78:79], v[158:159], v[166:167]
    v_cvt_pk_bf16_f32 v32, v72, v73
    buffer_load_dwordx4 a[120:123], v8, s[28:31], s36 offen offset:2048
    ds_read_b128 v[176:179], v227 offset:8192
    v_cvt_pk_bf16_f32 v33, v74, v75
    v_cvt_pk_bf16_f32 v34, v76, v77
    v_cvt_pk_bf16_f32 v35, v78, v79
    ds_read_b128 v[180:183], v227 offset:8208
    v_dot2_f32_bf16 v216, v32, v224, v216
    v_dot2_f32_bf16 v217, v32, v32, v217
    v_dot2_f32_bf16 v216, v33, v224, v216
    v_dot2_f32_bf16 v217, v33, v33, v217
    v_dot2_f32_bf16 v216, v34, v224, v216
    v_dot2_f32_bf16 v217, v34, v34, v217
    v_dot2_f32_bf16 v216, v35, v224, v216
    v_dot2_f32_bf16 v217, v35, v35, v217
    ds_write_b128 v228, v[32:35] offset:0
    buffer_load_dwordx4 a[124:127], v8, s[28:31], s36 offen offset:3072
    v_pk_fma_f32 v[80:81], v[80:81], v[222:223], v[222:223] op_sel:[0,1,0] op_sel_hi:[1,1,0]
    v_pk_fma_f32 v[82:83], v[82:83], v[222:223], v[222:223] op_sel:[0,1,0] op_sel_hi:[1,1,0]
    v_pk_fma_f32 v[84:85], v[84:85], v[222:223], v[222:223] op_sel:[0,1,0] op_sel_hi:[1,1,0]
    v_pk_fma_f32 v[86:87], v[86:87], v[222:223], v[222:223] op_sel:[0,1,0] op_sel_hi:[1,1,0]
    v_pk_fma_f32 v[80:81], v[80:81], v[152:153], v[160:161]
    v_pk_fma_f32 v[82:83], v[82:83], v[154:155], v[162:163]
    v_pk_fma_f32 v[84:85], v[84:85], v[156:157], v[164:165]
    v_pk_fma_f32 v[86:87], v[86:87], v[158:159], v[166:167]
    v_cvt_pk_bf16_f32 v36, v80, v81
    v_cvt_pk_bf16_f32 v37, v82, v83
    v_cvt_pk_bf16_f32 v38, v84, v85
    v_cvt_pk_bf16_f32 v39, v86, v87
    v_dot2_f32_bf16 v218, v36, v224, v218
    v_dot2_f32_bf16 v219, v36, v36, v219
    v_dot2_f32_bf16 v218, v37, v224, v218
    v_dot2_f32_bf16 v219, v37, v37, v219
    v_dot2_f32_bf16 v218, v38, v224, v218
    v_dot2_f32_bf16 v219, v38, v38, v219
    v_dot2_f32_bf16 v218, v39, v224, v218
    s_add_u32 s36, s36, 4096
    buffer_load_dwordx4 a[128:131], v8, s[28:31], s36 offen offset:0
    v_dot2_f32_bf16 v219, v39, v39, v219
    ds_write_b128 v12, v[36:39] offset:0
    s_waitcnt lgkmcnt(1)
    v_pk_fma_f32 v[88:89], v[88:89], v[220:221], v[220:221] op_sel:[0,1,0] op_sel_hi:[1,1,0]
    v_pk_fma_f32 v[90:91], v[90:91], v[220:221], v[220:221] op_sel:[0,1,0] op_sel_hi:[1,1,0]
    v_pk_fma_f32 v[92:93], v[92:93], v[220:221], v[220:221] op_sel:[0,1,0] op_sel_hi:[1,1,0]
    ds_read_b128 v[152:155], v227 offset:11264
    v_pk_fma_f32 v[94:95], v[94:95], v[220:221], v[220:221] op_sel:[0,1,0] op_sel_hi:[1,1,0]
    v_pk_fma_f32 v[88:89], v[88:89], v[168:169], v[176:177]
    v_pk_fma_f32 v[90:91], v[90:91], v[170:171], v[178:179]
    buffer_load_dwordx4 a[132:135], v8, s[28:31], s36 offen offset:1024
    ds_read_b128 v[156:159], v227 offset:11280
    v_pk_fma_f32 v[92:93], v[92:93], v[172:173], v[180:181]
    v_pk_fma_f32 v[94:95], v[94:95], v[174:175], v[182:183]
    v_cvt_pk_bf16_f32 v40, v88, v89
    ds_read_b128 v[160:163], v227 offset:8704
    v_cvt_pk_bf16_f32 v41, v90, v91
    v_cvt_pk_bf16_f32 v42, v92, v93
    v_cvt_pk_bf16_f32 v43, v94, v95
    ds_read_b128 v[164:167], v227 offset:8720
    v_dot2_f32_bf16 v216, v40, v224, v216
    v_dot2_f32_bf16 v217, v40, v40, v217
    v_dot2_f32_bf16 v216, v41, v224, v216
    v_dot2_f32_bf16 v217, v41, v41, v217
    buffer_load_dwordx4 a[136:139], v8, s[28:31], s36 offen offset:2048
    v_dot2_f32_bf16 v216, v42, v224, v216
    v_dot2_f32_bf16 v217, v42, v42, v217
    v_dot2_f32_bf16 v216, v43, v224, v216
    v_dot2_f32_bf16 v217, v43, v43, v217
    ds_write_b128 v228, v[40:43] offset:4096
    v_pk_fma_f32 v[96:97], v[96:97], v[222:223], v[222:223] op_sel:[0,1,0] op_sel_hi:[1,1,0]
    v_pk_fma_f32 v[98:99], v[98:99], v[222:223], v[222:223] op_sel:[0,1,0] op_sel_hi:[1,1,0]
    v_pk_fma_f32 v[100:101], v[100:101], v[222:223], v[222:223] op_sel:[0,1,0] op_sel_hi:[1,1,0]
    v_pk_fma_f32 v[102:103], v[102:103], v[222:223], v[222:223] op_sel:[0,1,0] op_sel_hi:[1,1,0]
    v_pk_fma_f32 v[96:97], v[96:97], v[168:169], v[176:177]
    v_pk_fma_f32 v[98:99], v[98:99], v[170:171], v[178:179]
    v_pk_fma_f32 v[100:101], v[100:101], v[172:173], v[180:181]
    buffer_load_dwordx4 a[140:143], v8, s[28:31], s36 offen offset:3072
    v_pk_fma_f32 v[102:103], v[102:103], v[174:175], v[182:183]
    v_cvt_pk_bf16_f32 v44, v96, v97
    v_cvt_pk_bf16_f32 v45, v98, v99
    v_cvt_pk_bf16_f32 v46, v100, v101
    v_cvt_pk_bf16_f32 v47, v102, v103
    v_dot2_f32_bf16 v218, v44, v224, v218
    v_dot2_f32_bf16 v219, v44, v44, v219
    v_dot2_f32_bf16 v218, v45, v224, v218
    v_dot2_f32_bf16 v219, v45, v45, v219
    v_dot2_f32_bf16 v218, v46, v224, v218
    v_dot2_f32_bf16 v219, v46, v46, v219
    v_dot2_f32_bf16 v218, v47, v224, v218
    v_dot2_f32_bf16 v219, v47, v47, v219
    ds_write_b128 v12, v[44:47] offset:4096
    s_add_u32 s36, s36, 4096
    buffer_load_dwordx4 a[144:147], v8, s[28:31], s36 offen offset:0
    s_waitcnt lgkmcnt(1)
    v_pk_fma_f32 v[104:105], v[104:105], v[220:221], v[220:221] op_sel:[0,1,0] op_sel_hi:[1,1,0]
    v_pk_fma_f32 v[106:107], v[106:107], v[220:221], v[220:221] op_sel:[0,1,0] op_sel_hi:[1,1,0]
    v_pk_fma_f32 v[108:109], v[108:109], v[220:221], v[220:221] op_sel:[0,1,0] op_sel_hi:[1,1,0]
    ds_read_b128 v[168:171], v227 offset:11776
    v_pk_fma_f32 v[110:111], v[110:111], v[220:221], v[220:221] op_sel:[0,1,0] op_sel_hi:[1,1,0]
    v_pk_fma_f32 v[104:105], v[104:105], v[152:153], v[160:161]
    v_pk_fma_f32 v[106:107], v[106:107], v[154:155], v[162:163]
    ds_read_b128 v[172:175], v227 offset:11792
    v_pk_fma_f32 v[108:109], v[108:109], v[156:157], v[164:165]
    v_pk_fma_f32 v[110:111], v[110:111], v[158:159], v[166:167]
    v_cvt_pk_bf16_f32 v48, v104, v105
    ds_read_b128 v[176:179], v227 offset:9216
    buffer_load_dwordx4 a[148:151], v8, s[28:31], s36 offen offset:1024
    v_cvt_pk_bf16_f32 v49, v106, v107
    v_cvt_pk_bf16_f32 v50, v108, v109
    v_cvt_pk_bf16_f32 v51, v110, v111
    ds_read_b128 v[180:183], v227 offset:9232
    v_dot2_f32_bf16 v216, v48, v224, v216
    v_dot2_f32_bf16 v217, v48, v48, v217
    v_dot2_f32_bf16 v216, v49, v224, v216
    v_dot2_f32_bf16 v217, v49, v49, v217
    v_dot2_f32_bf16 v216, v50, v224, v216
    v_dot2_f32_bf16 v217, v50, v50, v217
    v_dot2_f32_bf16 v216, v51, v224, v216
    v_dot2_f32_bf16 v217, v51, v51, v217
    ds_write_b128 v228, v[48:51] offset:8192
    buffer_load_dwordx4 a[152:155], v8, s[28:31], s36 offen offset:2048
    v_pk_fma_f32 v[112:113], v[112:113], v[222:223], v[222:223] op_sel:[0,1,0] op_sel_hi:[1,1,0]
    v_pk_fma_f32 v[114:115], v[114:115], v[222:223], v[222:223] op_sel:[0,1,0] op_sel_hi:[1,1,0]
    v_pk_fma_f32 v[116:117], v[116:117], v[222:223], v[222:223] op_sel:[0,1,0] op_sel_hi:[1,1,0]
    v_pk_fma_f32 v[118:119], v[118:119], v[222:223], v[222:223] op_sel:[0,1,0] op_sel_hi:[1,1,0]
    v_pk_fma_f32 v[112:113], v[112:113], v[152:153], v[160:161]
    v_pk_fma_f32 v[114:115], v[114:115], v[154:155], v[162:163]
    v_pk_fma_f32 v[116:117], v[116:117], v[156:157], v[164:165]
    v_pk_fma_f32 v[118:119], v[118:119], v[158:159], v[166:167]
    v_cvt_pk_bf16_f32 v52, v112, v113
    v_cvt_pk_bf16_f32 v53, v114, v115
    v_cvt_pk_bf16_f32 v54, v116, v117
    v_cvt_pk_bf16_f32 v55, v118, v119
    v_dot2_f32_bf16 v218, v52, v224, v218
    v_dot2_f32_bf16 v219, v52, v52, v219
    v_dot2_f32_bf16 v218, v53, v224, v218
    v_dot2_f32_bf16 v219, v53, v53, v219
    v_dot2_f32_bf16 v218, v54, v224, v218
    v_dot2_f32_bf16 v219, v54, v54, v219
    v_dot2_f32_bf16 v218, v55, v224, v218
    buffer_load_dwordx4 a[156:159], v8, s[28:31], s36 offen offset:3072
    v_dot2_f32_bf16 v219, v55, v55, v219
    ds_write_b128 v12, v[52:55] offset:8192
    s_waitcnt lgkmcnt(1)
    v_pk_fma_f32 v[120:121], v[120:121], v[220:221], v[220:221] op_sel:[0,1,0] op_sel_hi:[1,1,0]
    v_pk_fma_f32 v[122:123], v[122:123], v[220:221], v[220:221] op_sel:[0,1,0] op_sel_hi:[1,1,0]
    v_pk_fma_f32 v[124:125], v[124:125], v[220:221], v[220:221] op_sel:[0,1,0] op_sel_hi:[1,1,0]
    ds_read_b128 v[152:155], v227 offset:12288
    v_pk_fma_f32 v[126:127], v[126:127], v[220:221], v[220:221] op_sel:[0,1,0] op_sel_hi:[1,1,0]
    v_pk_fma_f32 v[120:121], v[120:121], v[168:169], v[176:177]
    v_pk_fma_f32 v[122:123], v[122:123], v[170:171], v[178:179]
    s_add_u32 s36, s36, 4096
    buffer_load_dwordx4 a[160:163], v8, s[28:31], s36 offen offset:0
    ds_read_b128 v[156:159], v227 offset:12304
    v_pk_fma_f32 v[124:125], v[124:125], v[172:173], v[180:181]
    v_pk_fma_f32 v[126:127], v[126:127], v[174:175], v[182:183]
    v_cvt_pk_bf16_f32 v56, v120, v121
    ds_read_b128 v[160:163], v227 offset:9728
    v_cvt_pk_bf16_f32 v57, v122, v123
    v_cvt_pk_bf16_f32 v58, v124, v125
    v_cvt_pk_bf16_f32 v59, v126, v127
    ds_read_b128 v[164:167], v227 offset:9744
    v_dot2_f32_bf16 v216, v56, v224, v216
    v_dot2_f32_bf16 v217, v56, v56, v217
    v_dot2_f32_bf16 v216, v57, v224, v216
    v_dot2_f32_bf16 v217, v57, v57, v217
    buffer_load_dwordx4 a[164:167], v8, s[28:31], s36 offen offset:1024
    v_dot2_f32_bf16 v216, v58, v224, v216
    v_dot2_f32_bf16 v217, v58, v58, v217
    v_dot2_f32_bf16 v216, v59, v224, v216
    v_dot2_f32_bf16 v217, v59, v59, v217
    ds_write_b128 v228, v[56:59] offset:12288
    v_pk_fma_f32 v[128:129], v[128:129], v[222:223], v[222:223] op_sel:[0,1,0] op_sel_hi:[1,1,0]
    v_pk_fma_f32 v[130:131], v[130:131], v[222:223], v[222:223] op_sel:[0,1,0] op_sel_hi:[1,1,0]
    v_pk_fma_f32 v[132:133], v[132:133], v[222:223], v[222:223] op_sel:[0,1,0] op_sel_hi:[1,1,0]
    v_pk_fma_f32 v[134:135], v[134:135], v[222:223], v[222:223] op_sel:[0,1,0] op_sel_hi:[1,1,0]
    v_pk_fma_f32 v[128:129], v[128:129], v[168:169], v[176:177]
    v_pk_fma_f32 v[130:131], v[130:131], v[170:171], v[178:179]
    v_pk_fma_f32 v[132:133], v[132:133], v[172:173], v[180:181]
    buffer_load_dwordx4 a[168:171], v8, s[28:31], s36 offen offset:2048
    v_pk_fma_f32 v[134:135], v[134:135], v[174:175], v[182:183]
    v_cvt_pk_bf16_f32 v60, v128, v129
    v_cvt_pk_bf16_f32 v61, v130, v131
    v_cvt_pk_bf16_f32 v62, v132, v133
    v_cvt_pk_bf16_f32 v63, v134, v135
    v_dot2_f32_bf16 v218, v60, v224, v218
    v_dot2_f32_bf16 v219, v60, v60, v219
    v_dot2_f32_bf16 v218, v61, v224, v218
    v_dot2_f32_bf16 v219, v61, v61, v219
    v_dot2_f32_bf16 v218, v62, v224, v218
    v_dot2_f32_bf16 v219, v62, v62, v219
    v_dot2_f32_bf16 v218, v63, v224, v218
    v_dot2_f32_bf16 v219, v63, v63, v219
    ds_write_b128 v12, v[60:63] offset:12288
    buffer_load_dwordx4 a[172:175], v8, s[28:31], s36 offen offset:3072
    s_waitcnt lgkmcnt(1)
    v_pk_fma_f32 v[136:137], v[136:137], v[220:221], v[220:221] op_sel:[0,1,0] op_sel_hi:[1,1,0]
    v_pk_fma_f32 v[138:139], v[138:139], v[220:221], v[220:221] op_sel:[0,1,0] op_sel_hi:[1,1,0]
    v_pk_fma_f32 v[140:141], v[140:141], v[220:221], v[220:221] op_sel:[0,1,0] op_sel_hi:[1,1,0]
    v_pk_fma_f32 v[142:143], v[142:143], v[220:221], v[220:221] op_sel:[0,1,0] op_sel_hi:[1,1,0]
    v_pk_fma_f32 v[136:137], v[136:137], v[152:153], v[160:161]
    v_pk_fma_f32 v[138:139], v[138:139], v[154:155], v[162:163]
    v_pk_fma_f32 v[140:141], v[140:141], v[156:157], v[164:165]
    v_pk_fma_f32 v[142:143], v[142:143], v[158:159], v[166:167]
    v_cvt_pk_bf16_f32 v64, v136, v137
    v_cvt_pk_bf16_f32 v65, v138, v139
    v_cvt_pk_bf16_f32 v66, v140, v141
    v_cvt_pk_bf16_f32 v67, v142, v143
    v_dot2_f32_bf16 v216, v64, v224, v216
    v_dot2_f32_bf16 v217, v64, v64, v217
    v_dot2_f32_bf16 v216, v65, v224, v216
    v_dot2_f32_bf16 v217, v65, v65, v217
    v_dot2_f32_bf16 v216, v66, v224, v216
    v_dot2_f32_bf16 v217, v66, v66, v217
    s_add_u32 s36, s36, 4096
    buffer_load_dwordx4 a[176:179], v8, s[28:31], s36 offen offset:0
    v_dot2_f32_bf16 v216, v67, v224, v216
    v_dot2_f32_bf16 v217, v67, v67, v217
    ds_write_b128 v228, v[64:67] offset:16384
    v_pk_fma_f32 v[144:145], v[144:145], v[222:223], v[222:223] op_sel:[0,1,0] op_sel_hi:[1,1,0]
    v_pk_fma_f32 v[146:147], v[146:147], v[222:223], v[222:223] op_sel:[0,1,0] op_sel_hi:[1,1,0]
    v_pk_fma_f32 v[148:149], v[148:149], v[222:223], v[222:223] op_sel:[0,1,0] op_sel_hi:[1,1,0]
    v_pk_fma_f32 v[150:151], v[150:151], v[222:223], v[222:223] op_sel:[0,1,0] op_sel_hi:[1,1,0]
    v_pk_fma_f32 v[144:145], v[144:145], v[152:153], v[160:161]
    v_pk_fma_f32 v[146:147], v[146:147], v[154:155], v[162:163]
    v_pk_fma_f32 v[148:149], v[148:149], v[156:157], v[164:165]
    v_pk_fma_f32 v[150:151], v[150:151], v[158:159], v[166:167]
    v_cvt_pk_bf16_f32 v68, v144, v145
    buffer_load_dwordx4 a[180:183], v8, s[28:31], s36 offen offset:1024
    v_cvt_pk_bf16_f32 v69, v146, v147
    v_cvt_pk_bf16_f32 v70, v148, v149
    v_cvt_pk_bf16_f32 v71, v150, v151
    v_dot2_f32_bf16 v218, v68, v224, v218
    v_dot2_f32_bf16 v219, v68, v68, v219
    v_dot2_f32_bf16 v218, v69, v224, v218
    v_dot2_f32_bf16 v219, v69, v69, v219
    v_dot2_f32_bf16 v218, v70, v224, v218
    v_dot2_f32_bf16 v219, v70, v70, v219
    v_dot2_f32_bf16 v218, v71, v224, v218
    v_dot2_f32_bf16 v219, v71, v71, v219
    ds_write_b128 v12, v[68:71] offset:16384
    buffer_load_dwordx4 a[184:187], v8, s[28:31], s36 offen offset:2048
    buffer_load_dwordx4 a[188:191], v8, s[28:31], s36 offen offset:3072
    s_add_u32 s36, s36, 4096
    buffer_load_dwordx4 a[192:195], v8, s[28:31], s36 offen offset:0
    buffer_load_dwordx4 a[196:199], v8, s[28:31], s36 offen offset:1024
    s_nop 1
    s_nop 1
    v_add_f32_dpp v216, v216, v216 quad_perm:[1,0,3,2] row_mask:0xf bank_mask:0xf
    v_add_f32_dpp v217, v217, v217 quad_perm:[1,0,3,2] row_mask:0xf bank_mask:0xf
    v_add_f32_dpp v218, v218, v218 quad_perm:[1,0,3,2] row_mask:0xf bank_mask:0xf
    v_add_f32_dpp v219, v219, v219 quad_perm:[1,0,3,2] row_mask:0xf bank_mask:0xf
    v_add_f32_dpp v216, v216, v216 quad_perm:[2,3,0,1] row_mask:0xf bank_mask:0xf
    v_add_f32_dpp v217, v217, v217 quad_perm:[2,3,0,1] row_mask:0xf bank_mask:0xf
    buffer_load_dwordx4 a[200:203], v8, s[28:31], s37 offen offset:0
    v_add_f32_dpp v218, v218, v218 quad_perm:[2,3,0,1] row_mask:0xf bank_mask:0xf
    v_add_f32_dpp v219, v219, v219 quad_perm:[2,3,0,1] row_mask:0xf bank_mask:0xf
    v_add_f32_dpp v216, v216, v216 row_half_mirror row_mask:0xf bank_mask:0xf
    v_add_f32_dpp v217, v217, v217 row_half_mirror row_mask:0xf bank_mask:0xf
    v_add_f32_dpp v218, v218, v218 row_half_mirror row_mask:0xf bank_mask:0xf
    v_add_f32_dpp v219, v219, v219 row_half_mirror row_mask:0xf bank_mask:0xf
    v_add_f32_dpp v216, v216, v216 row_mirror row_mask:0xf bank_mask:0xf
    v_add_f32_dpp v217, v217, v217 row_mirror row_mask:0xf bank_mask:0xf
    v_add_f32_dpp v218, v218, v218 row_mirror row_mask:0xf bank_mask:0xf
    v_add_f32_dpp v219, v219, v219 row_mirror row_mask:0xf bank_mask:0xf
    v_mul_f32 v216, 0x3acccccd, v216
    v_mul_f32 v218, 0x3acccccd, v218
    v_mul_f32 v217, 0x3acccccd, v217
    v_mul_f32 v219, 0x3acccccd, v219
    v_fma_f32 v217, -v216, v216, v217
    v_fma_f32 v219, -v218, v218, v219
    v_max_f32 v217, 0, v217
    v_max_f32 v219, 0, v219
    v_cvt_pk_bf16_f32 v192, v216, v217
    buffer_load_dwordx4 a[204:207], v8, s[28:31], s37 offen offset:1024
    v_cvt_pk_bf16_f32 v193, v218, v219
    v_lshlrev_b32 v216, 16, v192
    v_lshlrev_b32 v218, 16, v193
    v_and_b32 v217, 0xffff0000, v192
    v_and_b32 v219, 0xffff0000, v193
    v_add_f32 v217, 0x3727c5ac, v217
    v_add_f32 v219, 0x3727c5ac, v219
    v_cvt_pk_bf16_f32 v192, v217, v217
    v_cvt_pk_bf16_f32 v193, v219, v219
    v_lshlrev_b32 v217, 16, v192
    v_lshlrev_b32 v219, 16, v193
    v_sqrt_f32 v217, v217
    v_sqrt_f32 v219, v219
    s_nop 0
    s_nop 0
    v_cvt_pk_bf16_f32 v192, v217, v217
    v_cvt_pk_bf16_f32 v193, v219, v219
    buffer_load_dwordx4 a[208:211], v8, s[28:31], s37 offen offset:2048
    v_lshlrev_b32 v217, 16, v192
    v_lshlrev_b32 v219, 16, v193
    v_rcp_f32 v217, v217
    v_rcp_f32 v219, v219
    s_nop 0
    s_nop 0
    v_mul_f32 v216, v216, v217
    v_mul_f32 v218, v218, v219
    v_sub_f32 v216, 0, v216
    v_sub_f32 v218, 0, v218
    s_lshl_b32 s26, s20, 6
    v_lshl_add_u32 v2, v3, 3, s26
    v_add_u32 v2, 138240, v2
    ds_write_b64 v2, v[216:217]
    buffer_load_dwordx4 a[212:215], v8, s[28:31], s37 offen offset:3072
    ds_write_b64 v2, v[218:219] offset:32
    s_waitcnt lgkmcnt(0)
    s_barrier
    ds_read_b128 v[72:75], v229 offset:0
    ds_read_b128 v[76:79], v231 offset:0
    s_waitcnt vmcnt(49) lgkmcnt(0)
    v_mfma_f32_16x16x32_bf16 v[32:35], a[0:3], v[72:75], 0
    s_add_u32 s37, s37, 4096
    buffer_load_dwordx4 a[216:219], v8, s[28:31], s37 offen offset:0
    v_mfma_f32_16x16x32_bf16 v[52:55], a[0:3], v[76:79], 0
    ds_read_b128 v[80:83], v230 offset:1024
    v_mfma_f32_16x16x32_bf16 v[36:39], a[4:7], v[72:75], 0
    v_mfma_f32_16x16x32_bf16 v[56:59], a[4:7], v[76:79], 0
    ds_read_b128 v[84:87], v232 offset:1024
    v_mfma_f32_16x16x32_bf16 v[40:43], a[8:11], v[72:75], 0
    buffer_load_dwordx4 a[220:223], v8, s[28:31], s37 offen offset:1024
    v_mfma_f32_16x16x32_bf16 v[60:63], a[8:11], v[76:79], 0
    ds_read_b128 v[112:115], v233 offset:0
    v_mfma_f32_16x16x32_bf16 v[44:47], a[12:15], v[72:75], 0
    v_mfma_f32_16x16x32_bf16 v[64:67], a[12:15], v[76:79], 0
    ds_read_b128 v[132:135], v233 offset:1024
    v_mfma_f32_16x16x32_bf16 v[48:51], a[16:19], v[72:75], 0
    buffer_load_dwordx4 a[224:227], v8, s[28:31], s37 offen offset:2048
    v_mfma_f32_16x16x32_bf16 v[68:71], a[16:19], v[76:79], 0
    s_waitcnt vmcnt(47) lgkmcnt(0)
    v_mfma_f32_16x16x32_bf16 v[32:35], a[20:23], v[80:83], v[32:35]
    v_mfma_f32_16x16x32_bf16 v[52:55], a[20:23], v[84:87], v[52:55]
    ds_read_b128 v[72:75], v229 offset:2048
    v_mfma_f32_16x16x32_bf16 v[36:39], a[24:27], v[80:83], v[36:39]
    buffer_load_dwordx4 a[228:231], v8, s[28:31], s37 offen offset:3072
    v_mfma_f32_16x16x32_bf16 v[56:59], a[24:27], v[84:87], v[56:59]
    ds_read_b128 v[76:79], v231 offset:2048
    v_mfma_f32_16x16x32_bf16 v[40:43], a[28:31], v[80:83], v[40:43]
    v_mfma_f32_16x16x32_bf16 v[60:63], a[28:31], v[84:87], v[60:63]
    ds_read_b128 v[116:119], v233 offset:64
    v_mfma_f32_16x16x32_bf16 v[44:47], a[32:35], v[80:83], v[44:47]
    s_add_u32 s37, s37, 4096
    buffer_load_dwordx4 a[232:235], v8, s[28:31], s37 offen offset:0
    v_mfma_f32_16x16x32_bf16 v[64:67], a[32:35], v[84:87], v[64:67]
    ds_read_b128 v[136:139], v233 offset:1088
    v_mfma_f32_16x16x32_bf16 v[48:51], a[36:39], v[80:83], v[48:51]
    v_mfma_f32_16x16x32_bf16 v[68:71], a[36:39], v[84:87], v[68:71]
    s_waitcnt vmcnt(44) lgkmcnt(0)
    v_mfma_f32_16x16x32_bf16 v[32:35], a[40:43], v[72:75], v[32:35]
    buffer_load_dwordx4 a[236:239], v8, s[28:31], s37 offen offset:1024
    v_mfma_f32_16x16x32_bf16 v[52:55], a[40:43], v[76:79], v[52:55]
    ds_read_b128 v[80:83], v230 offset:3072
    v_mfma_f32_16x16x32_bf16 v[36:39], a[44:47], v[72:75], v[36:39]
    v_mfma_f32_16x16x32_bf16 v[56:59], a[44:47], v[76:79], v[56:59]
    ds_read_b128 v[84:87], v232 offset:3072
    v_mfma_f32_16x16x32_bf16 v[40:43], a[48:51], v[72:75], v[40:43]
    buffer_load_dwordx4 a[240:243], v8, s[28:31], s37 offen offset:2048
    v_mfma_f32_16x16x32_bf16 v[60:63], a[48:51], v[76:79], v[60:63]
    ds_read_b128 v[120:123], v233 offset:128
    v_mfma_f32_16x16x32_bf16 v[44:47], a[52:55], v[72:75], v[44:47]
    v_mfma_f32_16x16x32_bf16 v[64:67], a[52:55], v[76:79], v[64:67]
    ds_read_b128 v[140:143], v233 offset:1152
    v_mfma_f32_16x16x32_bf16 v[48:51], a[56:59], v[72:75], v[48:51]
    buffer_load_dwordx4 a[244:247], v8, s[28:31], s37 offen offset:3072
    v_mfma_f32_16x16x32_bf16 v[68:71], a[56:59], v[76:79], v[68:71]
    s_waitcnt vmcnt(42) lgkmcnt(0)
    v_mfma_f32_16x16x32_bf16 v[32:35], a[60:63], v[80:83], v[32:35]
    v_mfma_f32_16x16x32_bf16 v[52:55], a[60:63], v[84:87], v[52:55]
    ds_read_b128 v[72:75], v229 offset:4096
    v_mfma_f32_16x16x32_bf16 v[36:39], a[64:67], v[80:83], v[36:39]
    s_add_u32 s37, s37, 4096
    buffer_load_dwordx4 a[248:251], v8, s[28:31], s37 offen offset:0
    v_mfma_f32_16x16x32_bf16 v[56:59], a[64:67], v[84:87], v[56:59]
    ds_read_b128 v[76:79], v231 offset:4096
    v_mfma_f32_16x16x32_bf16 v[40:43], a[68:71], v[80:83], v[40:43]
    v_mfma_f32_16x16x32_bf16 v[60:63], a[68:71], v[84:87], v[60:63]
    ds_read_b128 v[124:127], v233 offset:192
    v_mfma_f32_16x16x32_bf16 v[44:47], a[72:75], v[80:83], v[44:47]
    buffer_load_dwordx4 a[252:255], v8, s[28:31], s37 offen offset:1024
    v_mfma_f32_16x16x32_bf16 v[64:67], a[72:75], v[84:87], v[64:67]
    ds_read_b128 v[144:147], v233 offset:1216
    v_mfma_f32_16x16x32_bf16 v[48:51], a[76:79], v[80:83], v[48:51]
    v_mfma_f32_16x16x32_bf16 v[68:71], a[76:79], v[84:87], v[68:71]
    s_waitcnt vmcnt(39) lgkmcnt(0)
    v_mfma_f32_16x16x32_bf16 v[32:35], a[80:83], v[72:75], v[32:35]
    buffer_load_dwordx4 a[0:3], v8, s[28:31], s37 offen offset:2048
    v_mfma_f32_16x16x32_bf16 v[52:55], a[80:83], v[76:79], v[52:55]
    ds_read_b128 v[80:83], v230 offset:5120
    v_mfma_f32_16x16x32_bf16 v[36:39], a[84:87], v[72:75], v[36:39]
    v_mfma_f32_16x16x32_bf16 v[56:59], a[84:87], v[76:79], v[56:59]
    ds_read_b128 v[84:87], v232 offset:5120
    v_mfma_f32_16x16x32_bf16 v[40:43], a[88:91], v[72:75], v[40:43]
    buffer_load_dwordx4 a[4:7], v8, s[28:31], s37 offen offset:3072
    v_mfma_f32_16x16x32_bf16 v[60:63], a[88:91], v[76:79], v[60:63]
    ds_read_b128 v[128:131], v234
    v_mfma_f32_16x16x32_bf16 v[44:47], a[92:95], v[72:75], v[44:47]
    v_mfma_f32_16x16x32_bf16 v[64:67], a[92:95], v[76:79], v[64:67]
    ds_read_b128 v[148:151], v234 offset:1024
    v_mfma_f32_16x16x32_bf16 v[48:51], a[96:99], v[72:75], v[48:51]
    s_add_u32 s37, s37, 4096
    buffer_load_dwordx4 a[8:11], v8, s[28:31], s37 offen offset:0
    v_mfma_f32_16x16x32_bf16 v[68:71], a[96:99], v[76:79], v[68:71]
    s_waitcnt vmcnt(37) lgkmcnt(0)
    v_mfma_f32_16x16x32_bf16 v[32:35], a[100:103], v[80:83], v[32:35]
    v_mfma_f32_16x16x32_bf16 v[52:55], a[100:103], v[84:87], v[52:55]
    ds_read_b128 v[72:75], v229 offset:6144
    v_mfma_f32_16x16x32_bf16 v[36:39], a[104:107], v[80:83], v[36:39]
    buffer_load_dwordx4 a[12:15], v8, s[28:31], s37 offen offset:1024
    v_mfma_f32_16x16x32_bf16 v[56:59], a[104:107], v[84:87], v[56:59]
    ds_read_b128 v[76:79], v231 offset:6144
    v_mfma_f32_16x16x32_bf16 v[40:43], a[108:111], v[80:83], v[40:43]
    v_mfma_f32_16x16x32_bf16 v[60:63], a[108:111], v[84:87], v[60:63]
    ds_read_b64 v[152:153], v235
    v_mfma_f32_16x16x32_bf16 v[44:47], a[112:115], v[80:83], v[44:47]
    buffer_load_dwordx4 a[16:19], v8, s[28:31], s37 offen offset:2048
    v_mfma_f32_16x16x32_bf16 v[64:67], a[112:115], v[84:87], v[64:67]
    ds_read_b64 v[16:17], v236
    v_mfma_f32_16x16x32_bf16 v[48:51], a[116:119], v[80:83], v[48:51]
    v_mfma_f32_16x16x32_bf16 v[68:71], a[116:119], v[84:87], v[68:71]
    s_waitcnt vmcnt(34) lgkmcnt(0)
    v_mfma_f32_16x16x32_bf16 v[32:35], a[120:123], v[72:75], v[32:35]
    buffer_load_dwordx4 a[20:23], v8, s[28:31], s37 offen offset:3072
    v_mfma_f32_16x16x32_bf16 v[52:55], a[120:123], v[76:79], v[52:55]
    ds_read_b128 v[80:83], v230 offset:7168
    v_mfma_f32_16x16x32_bf16 v[36:39], a[124:127], v[72:75], v[36:39]
    v_mfma_f32_16x16x32_bf16 v[56:59], a[124:127], v[76:79], v[56:59]
    ds_read_b128 v[84:87], v232 offset:7168
    v_mfma_f32_16x16x32_bf16 v[40:43], a[128:131], v[72:75], v[40:43]
    s_add_u32 s37, s37, 4096
    buffer_load_dwordx4 a[24:27], v8, s[28:31], s37 offen offset:0
    v_mfma_f32_16x16x32_bf16 v[60:63], a[128:131], v[76:79], v[60:63]
    ds_read_b64 v[18:19], v237
    v_mfma_f32_16x16x32_bf16 v[44:47], a[132:135], v[72:75], v[44:47]
    v_mfma_f32_16x16x32_bf16 v[64:67], a[132:135], v[76:79], v[64:67]
    ds_read_b64 v[20:21], v238
    v_mfma_f32_16x16x32_bf16 v[48:51], a[136:139], v[72:75], v[48:51]
    buffer_load_dwordx4 a[28:31], v8, s[28:31], s37 offen offset:1024
    v_mfma_f32_16x16x32_bf16 v[68:71], a[136:139], v[76:79], v[68:71]
    s_waitcnt vmcnt(32) lgkmcnt(0)
    v_mfma_f32_16x16x32_bf16 v[32:35], a[140:143], v[80:83], v[32:35]
    v_mfma_f32_16x16x32_bf16 v[52:55], a[140:143], v[84:87], v[52:55]
    ds_read_b128 v[72:75], v229 offset:8192
    v_mfma_f32_16x16x32_bf16 v[36:39], a[144:147], v[80:83], v[36:39]
    buffer_load_dwordx4 a[32:35], v8, s[28:31], s37 offen offset:2048
    v_mfma_f32_16x16x32_bf16 v[56:59], a[144:147], v[84:87], v[56:59]
    ds_read_b128 v[76:79], v231 offset:8192
    v_mfma_f32_16x16x32_bf16 v[40:43], a[148:151], v[80:83], v[40:43]
    v_mfma_f32_16x16x32_bf16 v[60:63], a[148:151], v[84:87], v[60:63]
    ds_read_b64 v[22:23], v239
    v_mfma_f32_16x16x32_bf16 v[44:47], a[152:155], v[80:83], v[44:47]
    buffer_load_dwordx4 a[36:39], v8, s[28:31], s37 offen offset:3072
    v_mfma_f32_16x16x32_bf16 v[64:67], a[152:155], v[84:87], v[64:67]
    ds_read_b64 v[24:25], v240
    v_mfma_f32_16x16x32_bf16 v[48:51], a[156:159], v[80:83], v[48:51]
    v_mfma_f32_16x16x32_bf16 v[68:71], a[156:159], v[84:87], v[68:71]
    s_waitcnt vmcnt(29) lgkmcnt(0)
    v_mfma_f32_16x16x32_bf16 v[32:35], a[160:163], v[72:75], v[32:35]
    s_add_u32 s37, s37, 4096
    buffer_load_dwordx4 a[40:43], v8, s[28:31], s37 offen offset:0
    v_mfma_f32_16x16x32_bf16 v[52:55], a[160:163], v[76:79], v[52:55]
    ds_read_b128 v[80:83], v230 offset:9216
    v_mfma_f32_16x16x32_bf16 v[36:39], a[164:167], v[72:75], v[36:39]
    v_mfma_f32_16x16x32_bf16 v[56:59], a[164:167], v[76:79], v[56:59]
    ds_read_b128 v[84:87], v232 offset:9216
    v_mfma_f32_16x16x32_bf16 v[40:43], a[168:171], v[72:75], v[40:43]
    buffer_load_dwordx4 a[44:47], v8, s[28:31], s37 offen offset:1024
    v_mfma_f32_16x16x32_bf16 v[60:63], a[168:171], v[76:79], v[60:63]
    v_mfma_f32_16x16x32_bf16 v[44:47], a[172:175], v[72:75], v[44:47]
    v_mfma_f32_16x16x32_bf16 v[64:67], a[172:175], v[76:79], v[64:67]
    v_mfma_f32_16x16x32_bf16 v[48:51], a[176:179], v[72:75], v[48:51]
    v_mfma_f32_16x16x32_bf16 v[68:71], a[176:179], v[76:79], v[68:71]
    buffer_load_dwordx4 a[48:51], v8, s[28:31], s37 offen offset:2048
    s_waitcnt vmcnt(27) lgkmcnt(0)
    v_mfma_f32_16x16x32_bf16 v[32:35], a[180:183], v[80:83], v[32:35]
    v_mfma_f32_16x16x32_bf16 v[52:55], a[180:183], v[84:87], v[52:55]
    v_mfma_f32_16x16x32_bf16 v[36:39], a[184:187], v[80:83], v[36:39]
    v_mfma_f32_16x16x32_bf16 v[56:59], a[184:187], v[84:87], v[56:59]
    v_mfma_f32_16x16x32_bf16 v[40:43], a[188:191], v[80:83], v[40:43]
    buffer_load_dwordx4 a[52:55], v8, s[28:31], s37 offen offset:3072
    v_mfma_f32_16x16x32_bf16 v[60:63], a[188:191], v[84:87], v[60:63]
    v_mfma_f32_16x16x32_bf16 v[44:47], a[192:195], v[80:83], v[44:47]
    v_mfma_f32_16x16x32_bf16 v[64:67], a[192:195], v[84:87], v[64:67]
    v_mfma_f32_16x16x32_bf16 v[48:51], a[196:199], v[80:83], v[48:51]
    v_mfma_f32_16x16x32_bf16 v[68:71], a[196:199], v[84:87], v[68:71]
    s_add_u32 s37, s37, 4096
    buffer_load_dwordx4 a[56:59], v8, s[28:31], s37 offen offset:0
    s_waitcnt lgkmcnt(0)
    s_nop 4
    ds_write_b128 v246, v[52:55] offset:0
    ds_write_b128 v246, v[56:59] offset:1024
    buffer_load_dwordx4 a[60:63], v8, s[28:31], s37 offen offset:1024
    ds_write_b128 v246, v[60:63] offset:2048
    ds_write_b128 v246, v[64:67] offset:3072
    ds_write_b128 v246, v[68:71] offset:4096
    buffer_load_dwordx4 a[64:67], v8, s[28:31], s37 offen offset:2048
    v_pk_add_f32 v[112:113], v[112:113], v[132:133]
    v_pk_add_f32 v[114:115], v[114:115], v[134:135]
    v_pk_add_f32 v[116:117], v[116:117], v[136:137]
    v_pk_add_f32 v[118:119], v[118:119], v[138:139]
    v_pk_add_f32 v[120:121], v[120:121], v[140:141]
    v_pk_add_f32 v[122:123], v[122:123], v[142:143]
    v_pk_add_f32 v[124:125], v[124:125], v[144:145]
    v_pk_add_f32 v[126:127], v[126:127], v[146:147]
    v_pk_add_f32 v[128:129], v[128:129], v[148:149]
    v_pk_add_f32 v[130:131], v[130:131], v[150:151]
    v_pk_mul_f32 v[112:113], v[112:113], v[152:153] op_sel_hi:[1,0]
    v_pk_mul_f32 v[114:115], v[114:115], v[152:153] op_sel_hi:[1,0]
    v_pk_mul_f32 v[116:117], v[116:117], v[152:153] op_sel_hi:[1,0]
    v_pk_mul_f32 v[118:119], v[118:119], v[152:153] op_sel_hi:[1,0]
    v_pk_mul_f32 v[120:121], v[120:121], v[152:153] op_sel_hi:[1,0]
    v_pk_mul_f32 v[122:123], v[122:123], v[152:153] op_sel_hi:[1,0]
    v_pk_mul_f32 v[124:125], v[124:125], v[152:153] op_sel_hi:[1,0]
    v_pk_mul_f32 v[126:127], v[126:127], v[152:153] op_sel_hi:[1,0]
    v_pk_mul_f32 v[128:129], v[128:129], v[152:153] op_sel_hi:[1,0]
    buffer_load_dwordx4 a[68:71], v8, s[28:31], s37 offen offset:3072
    v_pk_mul_f32 v[130:131], v[130:131], v[152:153] op_sel_hi:[1,0]
    v_mov_b32 v30, 0xbdd2d3e8
    v_mov_b32 v31, 0xc0135761
    s_waitcnt lgkmcnt(0)
    s_barrier
    ds_read_b128 v[88:91], v247 offset:0
    ds_read_b128 v[92:95], v247 offset:1024
    ds_read_b128 v[96:99], v247 offset:2048
    ds_read_b128 v[100:103], v247 offset:3072
    ds_read_b128 v[104:107], v247 offset:4096
    s_add_u32 s37, s37, 4096
    buffer_load_dwordx4 a[72:75], v8, s[28:31], s37 offen offset:0
    s_waitcnt lgkmcnt(4)
    v_pk_add_f32 v[32:33], v[32:33], v[88:89]
    v_pk_add_f32 v[34:35], v[34:35], v[90:91]
    s_waitcnt lgkmcnt(3)
    v_pk_add_f32 v[36:37], v[36:37], v[92:93]
    v_pk_add_f32 v[38:39], v[38:39], v[94:95]
    s_waitcnt lgkmcnt(2)
    v_pk_add_f32 v[40:41], v[40:41], v[96:97]
    v_pk_add_f32 v[42:43], v[42:43], v[98:99]
    s_waitcnt lgkmcnt(1)
    v_pk_add_f32 v[44:45], v[44:45], v[100:101]
    v_pk_add_f32 v[46:47], v[46:47], v[102:103]
    s_waitcnt lgkmcnt(0)
    v_pk_add_f32 v[48:49], v[48:49], v[104:105]
    v_pk_add_f32 v[50:51], v[50:51], v[106:107]
    v_pk_fma_f32 v[32:33], v[32:33], v[152:153], v[112:113] op_sel:[0,1,0] op_sel_hi:[1,1,1]
    v_pk_fma_f32 v[34:35], v[34:35], v[152:153], v[114:115] op_sel:[0,1,0] op_sel_hi:[1,1,1]
    v_pk_fma_f32 v[36:37], v[36:37], v[152:153], v[116:117] op_sel:[0,1,0] op_sel_hi:[1,1,1]
    v_pk_fma_f32 v[38:39], v[38:39], v[152:153], v[118:119] op_sel:[0,1,0] op_sel_hi:[1,1,1]
    buffer_load_dwordx4 a[76:79], v8, s[28:31], s37 offen offset:1024
    v_pk_fma_f32 v[40:41], v[40:41], v[152:153], v[120:121] op_sel:[0,1,0] op_sel_hi:[1,1,1]
    v_pk_fma_f32 v[42:43], v[42:43], v[152:153], v[122:123] op_sel:[0,1,0] op_sel_hi:[1,1,1]
    v_pk_fma_f32 v[44:45], v[44:45], v[152:153], v[124:125] op_sel:[0,1,0] op_sel_hi:[1,1,1]
    v_pk_fma_f32 v[46:47], v[46:47], v[152:153], v[126:127] op_sel:[0,1,0] op_sel_hi:[1,1,1]
    v_pk_fma_f32 v[48:49], v[48:49], v[152:153], v[128:129] op_sel:[0,1,0] op_sel_hi:[1,1,1]
    v_pk_fma_f32 v[50:51], v[50:51], v[152:153], v[130:131] op_sel:[0,1,0] op_sel_hi:[1,1,1]
    v_pk_mul_f32 v[192:193], v[32:33], v[32:33]
    v_pk_mul_f32 v[194:195], v[34:35], v[34:35]
    v_pk_mul_f32 v[196:197], v[36:37], v[36:37]
    v_pk_mul_f32 v[198:199], v[38:39], v[38:39]
    v_pk_mul_f32 v[200:201], v[40:41], v[40:41]
    v_pk_mul_f32 v[202:203], v[42:43], v[42:43]
    v_pk_mul_f32 v[204:205], v[44:45], v[44:45]
    v_pk_mul_f32 v[206:207], v[46:47], v[46:47]
    v_pk_mul_f32 v[208:209], v[48:49], v[48:49]
    v_pk_mul_f32 v[210:211], v[50:51], v[50:51]
    v_pk_fma_f32 v[192:193], v[192:193], v[30:31], v[30:31] op_sel:[0,0,1] op_sel_hi:[1,0,1]
    v_pk_fma_f32 v[194:195], v[194:195], v[30:31], v[30:31] op_sel:[0,0,1] op_sel_hi:[1,0,1]
    v_pk_fma_f32 v[196:197], v[196:197], v[30:31], v[30:31] op_sel:[0,0,1] op_sel_hi:[1,0,1]
    buffer_load_dwordx4 a[80:83], v8, s[28:31], s37 offen offset:2048
    v_pk_fma_f32 v[198:199], v[198:199], v[30:31], v[30:31] op_sel:[0,0,1] op_sel_hi:[1,0,1]
    v_pk_fma_f32 v[200:201], v[200:201], v[30:31], v[30:31] op_sel:[0,0,1] op_sel_hi:[1,0,1]
    v_pk_fma_f32 v[202:203], v[202:203], v[30:31], v[30:31] op_sel:[0,0,1] op_sel_hi:[1,0,1]
    v_pk_fma_f32 v[204:205], v[204:205], v[30:31], v[30:31] op_sel:[0,0,1] op_sel_hi:[1,0,1]
    v_pk_fma_f32 v[206:207], v[206:207], v[30:31], v[30:31] op_sel:[0,0,1] op_sel_hi:[1,0,1]
    v_pk_fma_f32 v[208:209], v[208:209], v[30:31], v[30:31] op_sel:[0,0,1] op_sel_hi:[1,0,1]
    v_pk_fma_f32 v[210:211], v[210:211], v[30:31], v[30:31] op_sel:[0,0,1] op_sel_hi:[1,0,1]
    v_pk_mul_f32 v[192:193], v[192:193], v[32:33]
    v_pk_mul_f32 v[194:195], v[194:195], v[34:35]
    v_pk_mul_f32 v[196:197], v[196:197], v[36:37]
    v_pk_mul_f32 v[198:199], v[198:199], v[38:39]
    v_pk_mul_f32 v[200:201], v[200:201], v[40:41]
    v_pk_mul_f32 v[202:203], v[202:203], v[42:43]
    v_pk_mul_f32 v[204:205], v[204:205], v[44:45]
    v_pk_mul_f32 v[206:207], v[206:207], v[46:47]
    v_pk_mul_f32 v[208:209], v[208:209], v[48:49]
    v_pk_mul_f32 v[210:211], v[210:211], v[50:51]
    v_exp_f32 v192, v192
    buffer_load_dwordx4 a[84:87], v8, s[28:31], s37 offen offset:3072
    v_exp_f32 v193, v193
    v_exp_f32 v194, v194
    v_exp_f32 v195, v195
    v_exp_f32 v196, v196
    v_exp_f32 v197, v197
    v_exp_f32 v198, v198
    v_exp_f32 v199, v199
    v_exp_f32 v200, v200
    v_exp_f32 v201, v201
    v_exp_f32 v202, v202
    s_add_u32 s37, s37, 4096
    buffer_load_dwordx4 a[88:91], v8, s[28:31], s37 offen offset:0
    v_exp_f32 v203, v203
    v_exp_f32 v204, v204
    v_exp_f32 v205, v205
    v_exp_f32 v206, v206
    v_exp_f32 v207, v207
    v_exp_f32 v208, v208
    v_exp_f32 v209, v209
    v_exp_f32 v210, v210
    v_exp_f32 v211, v211
    v_pk_add_f32 v[192:193], v[192:193], 1.0 op_sel_hi:[1,0]
    buffer_load_dwordx4 a[92:95], v8, s[28:31], s37 offen offset:1024
    v_pk_add_f32 v[194:195], v[194:195], 1.0 op_sel_hi:[1,0]
    v_pk_add_f32 v[196:197], v[196:197], 1.0 op_sel_hi:[1,0]
    v_pk_add_f32 v[198:199], v[198:199], 1.0 op_sel_hi:[1,0]
    v_pk_add_f32 v[200:201], v[200:201], 1.0 op_sel_hi:[1,0]
    v_pk_add_f32 v[202:203], v[202:203], 1.0 op_sel_hi:[1,0]
    v_pk_add_f32 v[204:205], v[204:205], 1.0 op_sel_hi:[1,0]
    v_pk_add_f32 v[206:207], v[206:207], 1.0 op_sel_hi:[1,0]
    v_pk_add_f32 v[208:209], v[208:209], 1.0 op_sel_hi:[1,0]
    v_pk_add_f32 v[210:211], v[210:211], 1.0 op_sel_hi:[1,0]
    v_rcp_f32 v192, v192
    v_rcp_f32 v193, v193
    v_rcp_f32 v194, v194
    v_rcp_f32 v195, v195
    v_rcp_f32 v196, v196
    buffer_load_dwordx4 a[96:99], v8, s[28:31], s37 offen offset:2048
    v_rcp_f32 v197, v197
    v_rcp_f32 v198, v198
    v_rcp_f32 v199, v199
    v_rcp_f32 v200, v200
    v_rcp_f32 v201, v201
    v_rcp_f32 v202, v202
    v_rcp_f32 v203, v203
    v_rcp_f32 v204, v204
    v_rcp_f32 v205, v205
    v_rcp_f32 v206, v206
    buffer_load_dwordx4 a[100:103], v8, s[28:31], s37 offen offset:3072
    v_rcp_f32 v207, v207
    v_rcp_f32 v208, v208
    v_rcp_f32 v209, v209
    v_rcp_f32 v210, v210
    v_rcp_f32 v211, v211
    v_pk_mul_f32 v[32:33], v[32:33], v[192:193]
    v_pk_mul_f32 v[34:35], v[34:35], v[194:195]
    v_pk_mul_f32 v[36:37], v[36:37], v[196:197]
    v_pk_mul_f32 v[38:39], v[38:39], v[198:199]
    v_pk_mul_f32 v[40:41], v[40:41], v[200:201]
    v_pk_mul_f32 v[42:43], v[42:43], v[202:203]
    v_pk_mul_f32 v[44:45], v[44:45], v[204:205]
    v_pk_mul_f32 v[46:47], v[46:47], v[206:207]
    v_pk_mul_f32 v[48:49], v[48:49], v[208:209]
    s_add_u32 s37, s37, 4096
    buffer_load_dwordx4 a[104:107], v8, s[28:31], s37 offen offset:0
    v_pk_mul_f32 v[50:51], v[50:51], v[210:211]
    v_cvt_pk_bf16_f32 v180, v32, v33
    v_cvt_pk_bf16_f32 v181, v34, v35
    v_cvt_pk_bf16_f32 v182, v36, v37
    v_cvt_pk_bf16_f32 v183, v38, v39
    v_cvt_pk_bf16_f32 v184, v40, v41
    v_cvt_pk_bf16_f32 v185, v42, v43
    v_cvt_pk_bf16_f32 v186, v44, v45
    v_cvt_pk_bf16_f32 v187, v46, v47
    v_cvt_pk_bf16_f32 v188, v48, v49
    v_cvt_pk_bf16_f32 v189, v50, v51
    s_nop 1
    v_permlane16_swap_b32 v180, v182
    v_permlane16_swap_b32 v181, v183
    v_permlane16_swap_b32 v184, v186
    v_permlane16_swap_b32 v185, v187
    s_mov_b64 exec, s[60:61]
    buffer_store_dwordx4 v[180:183], v241, s[28:31], s44 offen sc1
    buffer_store_dwordx4 v[184:187], v241, s[28:31], s44 offen offset:1024 sc1
    buffer_store_dwordx2 v[188:189], v242, s[28:31], s45 offen sc1
    s_mov_b64 exec, -1
    s_waitcnt vmcnt(0)
    s_barrier
    s_cmp_lg_u32 s20, 0
    s_cbranch_scc1 chain_kernel_sig1
    v_mov_b32 v2, 1
    v_mov_b32 v7, 0
    s_mov_b64 exec, 1
    buffer_store_dword v2, v7, s[28:31], s46 offen sc1
    s_mov_b64 exec, -1
chain_kernel_sig1:
    buffer_load_dwordx4 a[108:111], v8, s[28:31], s37 offen offset:1024
    buffer_load_dwordx4 a[112:115], v8, s[28:31], s37 offen offset:2048
    buffer_load_dwordx4 a[116:119], v8, s[28:31], s37 offen offset:3072
    s_add_u32 s37, s37, 4096
    buffer_load_dwordx4 a[120:123], v8, s[28:31], s37 offen offset:0
    buffer_load_dwordx4 a[124:127], v8, s[28:31], s37 offen offset:1024
    buffer_load_dwordx4 a[128:131], v8, s[28:31], s37 offen offset:2048
    buffer_load_dwordx4 a[132:135], v8, s[28:31], s37 offen offset:3072
    s_add_u32 s37, s37, 4096
    buffer_load_dwordx4 a[136:139], v8, s[28:31], s37 offen offset:0
    buffer_load_dwordx4 a[140:143], v8, s[28:31], s37 offen offset:1024
    s_mul_i32 s25, s20, 10
    s_lshl_b32 s25, s25, 10
    s_add_u32 s62, s25, 0
    s_add_u32 s63, s25, s54
    s_add_u32 s63, s63, 0
    s_mov_b32 m0, s62
    buffer_load_dwordx4 v8, s[28:31], s63 offen offset:0 lds
    buffer_load_dwordx4 v8, s[28:31], s63 offen offset:1024 lds
    buffer_load_dwordx4 v8, s[28:31], s63 offen offset:2048 lds
    buffer_load_dwordx4 v8, s[28:31], s63 offen offset:3072 lds
    s_add_u32 s62, s62, 4096
    s_add_u32 s63, s63, 4096
    s_mov_b32 m0, s62
    buffer_load_dwordx4 v8, s[28:31], s63 offen offset:0 lds
    buffer_load_dwordx4 v8, s[28:31], s63 offen offset:1024 lds
    buffer_load_dwordx4 v8, s[28:31], s63 offen offset:2048 lds
    buffer_load_dwordx4 v8, s[28:31], s63 offen offset:3072 lds
    s_add_u32 s62, s62, 4096
    s_add_u32 s63, s63, 4096
    s_mov_b32 m0, s62
    buffer_load_dwordx4 v8, s[28:31], s63 offen offset:0 lds
    buffer_load_dwordx4 v8, s[28:31], s63 offen offset:1024 lds
    s_mov_b32 s48, 29380608
    s_mov_b32 s47, 0
    s_mov_b64 exec, 15
chain_kernel_poll2:
    buffer_load_dword v2, v245, s[28:31], s48 offen sc1
    s_add_u32 s47, s47, 1
    s_waitcnt vmcnt(0)
    v_cmp_ne_u32 vcc, 1, v2
    s_cmp_ge_u32 s47, 20000
    s_cbranch_scc1 chain_kernel_polld3
    s_cbranch_vccnz chain_kernel_poll2
chain_kernel_polld3:
    s_mov_b64 exec, -1
    buffer_load_dwordx4 v[72:75], v8, s[28:31], s50 offen offset:0 sc1
    buffer_load_dwordx4 v[76:79], v8, s[28:31], s51 offen offset:0 sc1
    buffer_load_dwordx4 v[80:83], v8, s[28:31], s50 offen offset:1024 sc1
    buffer_load_dwordx4 v[84:87], v8, s[28:31], s51 offen offset:1024 sc1
    buffer_load_dwordx4 v[88:91], v8, s[28:31], s50 offen offset:2048 sc1
    buffer_load_dwordx4 v[92:95], v8, s[28:31], s51 offen offset:2048 sc1
    buffer_load_dwordx4 v[96:99], v8, s[28:31], s50 offen offset:3072 sc1
    buffer_load_dwordx4 v[100:103], v8, s[28:31], s51 offen offset:3072 sc1
    s_add_u32 s50, s50, 4096
    s_add_u32 s51, s51, 4096
    buffer_load_dwordx4 v[104:107], v8, s[28:31], s50 offen offset:0 sc1
    buffer_load_dwordx4 v[108:111], v8, s[28:31], s51 offen offset:0 sc1
    s_lshl_b32 s26, s53, 3
    s_lshl_b32 s27, s20, 1
    s_add_u32 s56, s26, s27
    s_mul_i32 s6, s56, 20480
    s_add_u32 s6, s6, 13406208
    s_add_u32 s7, s6, 20480
    s_lshl_b32 s26, s53, 2
    s_add_u32 s26, s26, s20
    s_lshl_b32 s26, s26, 9
    s_add_u32 s8, s26, 29413376
    v_lshlrev_b32 v228, 3, v4
    v_lshl_add_u32 v228, v3, 8, v228
    s_lshl_b32 s9, s56, 10
    s_add_u32 s9, s9, 23105536
    s_and_b32 s42, s52, 1
    s_mul_i32 s12, s52, 7
    s_add_u32 s13, s12, 1
    s_lshr_b32 s13, s13, 1
    s_add_u32 s26, s13, 3
    s_sub_u32 s27, s13, 1
    s_cmp_eq_u32 s42, 1
    s_cselect_b32 s12, s27, s26
    s_lshl_b32 s13, s13, 10
    s_add_u32 s13, s13, 16027648
    s_lshl_b32 s12, s12, 10
    s_add_u32 s12, s12, 16027648
    s_lshl_b32 s14, s56, 4
    s_lshl_b32 s15, s53, 4
    s_add_u32 s15, s15, s52
    s_lshl_b32 s15, s15, 2
    s_add_u32 s15, s15, s20
    s_lshl_b32 s15, s15, 7
    s_add_u32 s15, s15, 29446144
    s_lshr_b32 s26, s43, 4
    s_lshl_b32 s26, s26, 3
    s_lshl_b32 s27, s24, 1
    s_add_u32 s26, s26, s27
    s_add_u32 s26, s26, s21
    s_lshl_b32 s26, s26, 7
    s_add_u32 s19, s26, 23105536
    v_add_u32 v226, s14, v4
    v_lshrrev_b32 v227, 4, v226
    v_and_b32 v226, 15, v226
    s_mov_b32 s27, 55296
    v_mul_lo_u32 v227, v227, s27
    v_lshl_add_u32 v227, v226, 4, v227
    v_and_b32 v226, 1, v3
    v_lshlrev_b32 v226, 9, v226
    v_lshrrev_b32 v2, 1, v3
    v_lshl_add_u32 v226, v2, 8, v226
    v_add_u32 v226, v226, v227
    s_lshl_b32 s27, s42, 9
    v_lshl_add_u32 v227, v2, 8, v227
    v_add_u32 v227, s27, v227
    v_and_b32 v2, 1, v3
    v_lshl_add_u32 v227, v2, 3, v227
    s_waitcnt vmcnt(8)
    v_mfma_f32_16x16x32_bf16 v[32:35], a[200:203], v[72:75], 0
    v_mfma_f32_16x16x32_bf16 v[52:55], a[200:203], v[76:79], 0
    buffer_load_dwordx4 v[112:115], v8, s[28:31], s50 offen offset:1024 sc1
    v_mfma_f32_16x16x32_bf16 v[36:39], a[204:207], v[72:75], 0
    v_mfma_f32_16x16x32_bf16 v[56:59], a[204:207], v[76:79], 0
    v_mfma_f32_16x16x32_bf16 v[40:43], a[208:211], v[72:75], 0
    v_mfma_f32_16x16x32_bf16 v[60:63], a[208:211], v[76:79], 0
    buffer_load_dwordx4 v[116:119], v8, s[28:31], s51 offen offset:1024 sc1
    v_mfma_f32_16x16x32_bf16 v[44:47], a[212:215], v[72:75], 0
    v_mfma_f32_16x16x32_bf16 v[64:67], a[212:215], v[76:79], 0
    v_mfma_f32_16x16x32_bf16 v[48:51], a[216:219], v[72:75], 0
    v_mfma_f32_16x16x32_bf16 v[68:71], a[216:219], v[76:79], 0
    s_waitcnt vmcnt(8)
    v_mfma_f32_16x16x32_bf16 v[32:35], a[220:223], v[80:83], v[32:35]
    v_mfma_f32_16x16x32_bf16 v[52:55], a[220:223], v[84:87], v[52:55]
    buffer_load_dwordx4 v[120:123], v8, s[28:31], s50 offen offset:2048 sc1
    v_mfma_f32_16x16x32_bf16 v[36:39], a[224:227], v[80:83], v[36:39]
    v_mfma_f32_16x16x32_bf16 v[56:59], a[224:227], v[84:87], v[56:59]
    v_mfma_f32_16x16x32_bf16 v[40:43], a[228:231], v[80:83], v[40:43]
    v_mfma_f32_16x16x32_bf16 v[60:63], a[228:231], v[84:87], v[60:63]
    buffer_load_dwordx4 v[124:127], v8, s[28:31], s51 offen offset:2048 sc1
    v_mfma_f32_16x16x32_bf16 v[44:47], a[232:235], v[80:83], v[44:47]
    v_mfma_f32_16x16x32_bf16 v[64:67], a[232:235], v[84:87], v[64:67]
    v_mfma_f32_16x16x32_bf16 v[48:51], a[236:239], v[80:83], v[48:51]
    v_mfma_f32_16x16x32_bf16 v[68:71], a[236:239], v[84:87], v[68:71]
    s_waitcnt vmcnt(8)
    v_mfma_f32_16x16x32_bf16 v[32:35], a[240:243], v[88:91], v[32:35]
    v_mfma_f32_16x16x32_bf16 v[52:55], a[240:243], v[92:95], v[52:55]
    buffer_load_dwordx4 v[128:131], v8, s[28:31], s50 offen offset:3072 sc1
    v_mfma_f32_16x16x32_bf16 v[36:39], a[244:247], v[88:91], v[36:39]
    v_mfma_f32_16x16x32_bf16 v[56:59], a[244:247], v[92:95], v[56:59]
    v_mfma_f32_16x16x32_bf16 v[40:43], a[248:251], v[88:91], v[40:43]
    v_mfma_f32_16x16x32_bf16 v[60:63], a[248:251], v[92:95], v[60:63]
    buffer_load_dwordx4 v[132:135], v8, s[28:31], s51 offen offset:3072 sc1
    v_mfma_f32_16x16x32_bf16 v[44:47], a[252:255], v[88:91], v[44:47]
    v_mfma_f32_16x16x32_bf16 v[64:67], a[252:255], v[92:95], v[64:67]
    v_mfma_f32_16x16x32_bf16 v[48:51], a[0:3], v[88:91], v[48:51]
    v_mfma_f32_16x16x32_bf16 v[68:71], a[0:3], v[92:95], v[68:71]
    s_waitcnt vmcnt(8)
    v_mfma_f32_16x16x32_bf16 v[32:35], a[4:7], v[96:99], v[32:35]
    v_mfma_f32_16x16x32_bf16 v[52:55], a[4:7], v[100:103], v[52:55]
    s_add_u32 s50, s50, 4096
    s_add_u32 s51, s51, 4096
    buffer_load_dwordx4 v[136:139], v8, s[28:31], s50 offen offset:0 sc1
    v_mfma_f32_16x16x32_bf16 v[36:39], a[8:11], v[96:99], v[36:39]
    v_mfma_f32_16x16x32_bf16 v[56:59], a[8:11], v[100:103], v[56:59]
    v_mfma_f32_16x16x32_bf16 v[40:43], a[12:15], v[96:99], v[40:43]
    v_mfma_f32_16x16x32_bf16 v[60:63], a[12:15], v[100:103], v[60:63]
    buffer_load_dwordx4 v[140:143], v8, s[28:31], s51 offen offset:0 sc1
    v_mfma_f32_16x16x32_bf16 v[44:47], a[16:19], v[96:99], v[44:47]
    v_mfma_f32_16x16x32_bf16 v[64:67], a[16:19], v[100:103], v[64:67]
    v_mfma_f32_16x16x32_bf16 v[48:51], a[20:23], v[96:99], v[48:51]
    v_mfma_f32_16x16x32_bf16 v[68:71], a[20:23], v[100:103], v[68:71]
    s_waitcnt vmcnt(8)
    v_mfma_f32_16x16x32_bf16 v[32:35], a[24:27], v[104:107], v[32:35]
    v_mfma_f32_16x16x32_bf16 v[52:55], a[24:27], v[108:111], v[52:55]
    buffer_load_dwordx4 v[144:147], v8, s[28:31], s50 offen offset:1024 sc1
    v_mfma_f32_16x16x32_bf16 v[36:39], a[28:31], v[104:107], v[36:39]
    v_mfma_f32_16x16x32_bf16 v[56:59], a[28:31], v[108:111], v[56:59]
    v_mfma_f32_16x16x32_bf16 v[40:43], a[32:35], v[104:107], v[40:43]
    v_mfma_f32_16x16x32_bf16 v[60:63], a[32:35], v[108:111], v[60:63]
    buffer_load_dwordx4 v[148:151], v8, s[28:31], s51 offen offset:1024 sc1
    v_mfma_f32_16x16x32_bf16 v[44:47], a[36:39], v[104:107], v[44:47]
    v_mfma_f32_16x16x32_bf16 v[64:67], a[36:39], v[108:111], v[64:67]
    s_mul_i32 s25, s20, 20
    s_lshl_b32 s25, s25, 10
    s_add_u32 s62, s25, 40960
    s_add_u32 s63, s25, s54
    s_add_u32 s63, s63, 40960
    s_mov_b32 m0, s62
    buffer_load_dwordx4 v8, s[28:31], s63 offen offset:0 lds
    v_mfma_f32_16x16x32_bf16 v[48:51], a[40:43], v[104:107], v[48:51]
    v_mfma_f32_16x16x32_bf16 v[68:71], a[40:43], v[108:111], v[68:71]
    s_waitcnt vmcnt(9)
    v_mfma_f32_16x16x32_bf16 v[32:35], a[44:47], v[112:115], v[32:35]
    v_mfma_f32_16x16x32_bf16 v[52:55], a[44:47], v[116:119], v[52:55]
    buffer_load_dwordx4 v8, s[28:31], s63 offen offset:1024 lds
    v_mfma_f32_16x16x32_bf16 v[36:39], a[48:51], v[112:115], v[36:39]
    v_mfma_f32_16x16x32_bf16 v[56:59], a[48:51], v[116:119], v[56:59]
    buffer_load_dwordx4 v8, s[28:31], s63 offen offset:2048 lds
    v_mfma_f32_16x16x32_bf16 v[40:43], a[52:55], v[112:115], v[40:43]
    v_mfma_f32_16x16x32_bf16 v[60:63], a[52:55], v[116:119], v[60:63]
    v_mfma_f32_16x16x32_bf16 v[44:47], a[56:59], v[112:115], v[44:47]
    v_mfma_f32_16x16x32_bf16 v[64:67], a[56:59], v[116:119], v[64:67]
    buffer_load_dwordx4 v8, s[28:31], s63 offen offset:3072 lds
    v_mfma_f32_16x16x32_bf16 v[48:51], a[60:63], v[112:115], v[48:51]
    v_mfma_f32_16x16x32_bf16 v[68:71], a[60:63], v[116:119], v[68:71]
    s_waitcnt vmcnt(10)
    v_mfma_f32_16x16x32_bf16 v[32:35], a[64:67], v[120:123], v[32:35]
    v_mfma_f32_16x16x32_bf16 v[52:55], a[64:67], v[124:127], v[52:55]
    s_add_u32 s62, s62, 4096
    s_add_u32 s63, s63, 4096
    s_mov_b32 m0, s62
    buffer_load_dwordx4 v8, s[28:31], s63 offen offset:0 lds
    v_mfma_f32_16x16x32_bf16 v[36:39], a[68:71], v[120:123], v[36:39]
    v_mfma_f32_16x16x32_bf16 v[56:59], a[68:71], v[124:127], v[56:59]
    buffer_load_dwordx4 v8, s[28:31], s63 offen offset:1024 lds
    v_mfma_f32_16x16x32_bf16 v[40:43], a[72:75], v[120:123], v[40:43]
    v_mfma_f32_16x16x32_bf16 v[60:63], a[72:75], v[124:127], v[60:63]
    v_mfma_f32_16x16x32_bf16 v[44:47], a[76:79], v[120:123], v[44:47]
    v_mfma_f32_16x16x32_bf16 v[64:67], a[76:79], v[124:127], v[64:67]
    buffer_load_dwordx4 v8, s[28:31], s63 offen offset:2048 lds
    v_mfma_f32_16x16x32_bf16 v[48:51], a[80:83], v[120:123], v[48:51]
    v_mfma_f32_16x16x32_bf16 v[68:71], a[80:83], v[124:127], v[68:71]
    s_waitcnt vmcnt(11)
    v_mfma_f32_16x16x32_bf16 v[32:35], a[84:87], v[128:131], v[32:35]
    v_mfma_f32_16x16x32_bf16 v[52:55], a[84:87], v[132:135], v[52:55]
    buffer_load_dwordx4 v8, s[28:31], s63 offen offset:3072 lds
    v_mfma_f32_16x16x32_bf16 v[36:39], a[88:91], v[128:131], v[36:39]
    v_mfma_f32_16x16x32_bf16 v[56:59], a[88:91], v[132:135], v[56:59]
    s_add_u32 s62, s62, 4096
    s_add_u32 s63, s63, 4096
    s_mov_b32 m0, s62
    buffer_load_dwordx4 v8, s[28:31], s63 offen offset:0 lds
    v_mfma_f32_16x16x32_bf16 v[40:43], a[92:95], v[128:131], v[40:43]
    v_mfma_f32_16x16x32_bf16 v[60:63], a[92:95], v[132:135], v[60:63]
    v_mfma_f32_16x16x32_bf16 v[44:47], a[96:99], v[128:131], v[44:47]
    v_mfma_f32_16x16x32_bf16 v[64:67], a[96:99], v[132:135], v[64:67]
    buffer_load_dwordx4 v8, s[28:31], s63 offen offset:1024 lds
    v_mfma_f32_16x16x32_bf16 v[48:51], a[100:103], v[128:131], v[48:51]
    v_mfma_f32_16x16x32_bf16 v[68:71], a[100:103], v[132:135], v[68:71]
    s_waitcnt vmcnt(12)
    v_mfma_f32_16x16x32_bf16 v[32:35], a[104:107], v[136:139], v[32:35]
    v_mfma_f32_16x16x32_bf16 v[52:55], a[104:107], v[140:143], v[52:55]
    buffer_load_dwordx4 v8, s[28:31], s63 offen offset:2048 lds
    v_mfma_f32_16x16x32_bf16 v[36:39], a[108:111], v[136:139], v[36:39]
    v_mfma_f32_16x16x32_bf16 v[56:59], a[108:111], v[140:143], v[56:59]
    buffer_load_dwordx4 v8, s[28:31], s63 offen offset:3072 lds
    v_mfma_f32_16x16x32_bf16 v[40:43], a[112:115], v[136:139], v[40:43]
    v_mfma_f32_16x16x32_bf16 v[60:63], a[112:115], v[140:143], v[60:63]
    v_mfma_f32_16x16x32_bf16 v[44:47], a[116:119], v[136:139], v[44:47]
    v_mfma_f32_16x16x32_bf16 v[64:67], a[116:119], v[140:143], v[64:67]
    s_add_u32 s62, s62, 4096
    s_add_u32 s63, s63, 4096
    s_mov_b32 m0, s62
    buffer_load_dwordx4 v8, s[28:31], s63 offen offset:0 lds
    v_mfma_f32_16x16x32_bf16 v[48:51], a[120:123], v[136:139], v[48:51]
    v_mfma_f32_16x16x32_bf16 v[68:71], a[120:123], v[140:143], v[68:71]
    s_waitcnt vmcnt(13)
    v_mfma_f32_16x16x32_bf16 v[32:35], a[124:127], v[144:147], v[32:35]
    v_mfma_f32_16x16x32_bf16 v[52:55], a[124:127], v[148:151], v[52:55]
    buffer_load_dwordx4 v8, s[28:31], s63 offen offset:1024 lds
    v_mfma_f32_16x16x32_bf16 v[36:39], a[128:131], v[144:147], v[36:39]
    v_mfma_f32_16x16x32_bf16 v[56:59], a[128:131], v[148:151], v[56:59]
    buffer_load_dwordx4 v8, s[28:31], s63 offen offset:2048 lds
    v_mfma_f32_16x16x32_bf16 v[40:43], a[132:135], v[144:147], v[40:43]
    v_mfma_f32_16x16x32_bf16 v[60:63], a[132:135], v[148:151], v[60:63]
    v_mfma_f32_16x16x32_bf16 v[44:47], a[136:139], v[144:147], v[44:47]
    v_mfma_f32_16x16x32_bf16 v[64:67], a[136:139], v[148:151], v[64:67]
    buffer_load_dwordx4 v8, s[28:31], s63 offen offset:3072 lds
    v_mfma_f32_16x16x32_bf16 v[48:51], a[140:143], v[144:147], v[48:51]
    v_mfma_f32_16x16x32_bf16 v[68:71], a[140:143], v[148:151], v[68:71]
    s_nop 4
    ds_write_b128 v246, v[52:55] offset:0
    ds_write_b128 v246, v[56:59] offset:1024
    ds_write_b128 v246, v[60:63] offset:2048
    ds_write_b128 v246, v[64:67] offset:3072
    ds_write_b128 v246, v[68:71] offset:4096
    v_lshlrev_b32 v112, 16, v16
    v_and_b32 v113, 0xffff0000, v16
    v_lshlrev_b32 v114, 16, v17
    v_and_b32 v115, 0xffff0000, v17
    v_lshlrev_b32 v116, 16, v18
    v_and_b32 v117, 0xffff0000, v18
    v_lshlrev_b32 v118, 16, v19
    v_and_b32 v119, 0xffff0000, v19
    v_lshlrev_b32 v120, 16, v20
    v_and_b32 v121, 0xffff0000, v20
    v_lshlrev_b32 v122, 16, v21
    v_and_b32 v123, 0xffff0000, v21
    v_lshlrev_b32 v124, 16, v22
    v_and_b32 v125, 0xffff0000, v22
    v_lshlrev_b32 v126, 16, v23
    v_and_b32 v127, 0xffff0000, v23
    v_lshlrev_b32 v128, 16, v24
    v_and_b32 v129, 0xffff0000, v24
    v_lshlrev_b32 v130, 16, v25
    v_and_b32 v131, 0xffff0000, v25
    v_pk_add_f32 v[32:33], v[32:33], v[112:113]
    v_pk_add_f32 v[34:35], v[34:35], v[114:115]
    v_pk_add_f32 v[36:37], v[36:37], v[116:117]
    v_pk_add_f32 v[38:39], v[38:39], v[118:119]
    v_pk_add_f32 v[40:41], v[40:41], v[120:121]
    v_pk_add_f32 v[42:43], v[42:43], v[122:123]
    v_pk_add_f32 v[44:45], v[44:45], v[124:125]
    v_pk_add_f32 v[46:47], v[46:47], v[126:127]
    v_pk_add_f32 v[48:49], v[48:49], v[128:129]
    v_pk_add_f32 v[50:51], v[50:51], v[130:131]
    v_mov_b32 v28, 0
    v_mov_b32 v29, 0
    s_add_u32 s62, s62, 4096
    s_add_u32 s63, s63, 4096
    s_mov_b32 m0, s62
    buffer_load_dwordx4 v8, s[28:31], s63 offen offset:0 lds
    buffer_load_dwordx4 v8, s[28:31], s63 offen offset:1024 lds
    buffer_load_dwordx4 v8, s[28:31], s63 offen offset:2048 lds
    buffer_load_dwordx4 v8, s[28:31], s63 offen offset:3072 lds
    s_mul_i32 s25, s20, 5
    s_lshl_b32 s25, s25, 10
    s_add_u32 s62, s25, 122880
    s_add_u32 s63, s25, s54
    s_add_u32 s63, s63, 122880
    s_mov_b32 m0, s62
    buffer_load_dwordx4 v8, s[28:31], s63 offen offset:0 lds
    buffer_load_dwordx4 v8, s[28:31], s63 offen offset:1024 lds
    buffer_load_dwordx4 v8, s[28:31], s63 offen offset:2048 lds
    buffer_load_dwordx4 v8, s[28:31], s63 offen offset:3072 lds
    s_add_u32 s62, s62, 4096
    s_add_u32 s63, s63, 4096
    s_mov_b32 m0, s62
    buffer_load_dwordx4 v8, s[28:31], s63 offen offset:0 lds
    s_waitcnt lgkmcnt(0)
    s_barrier
    ds_read_b128 v[88:91], v247 offset:0
    ds_read_b128 v[92:95], v247 offset:1024
    ds_read_b128 v[96:99], v247 offset:2048
    ds_read_b128 v[100:103], v247 offset:3072
    ds_read_b128 v[104:107], v247 offset:4096
    s_waitcnt lgkmcnt(4)
    v_pk_add_f32 v[32:33], v[32:33], v[88:89]
    v_pk_add_f32 v[34:35], v[34:35], v[90:91]
    v_cvt_pk_bf16_f32 v180, v32, v33
    v_cvt_pk_bf16_f32 v181, v34, v35
    s_waitcnt lgkmcnt(3)
    v_pk_add_f32 v[36:37], v[36:37], v[92:93]
    v_pk_add_f32 v[38:39], v[38:39], v[94:95]
    v_cvt_pk_bf16_f32 v182, v36, v37
    v_cvt_pk_bf16_f32 v183, v38, v39
    s_waitcnt lgkmcnt(2)
    v_pk_add_f32 v[40:41], v[40:41], v[96:97]
    v_pk_add_f32 v[42:43], v[42:43], v[98:99]
    v_cvt_pk_bf16_f32 v184, v40, v41
    v_cvt_pk_bf16_f32 v185, v42, v43
    s_waitcnt lgkmcnt(1)
    v_pk_add_f32 v[44:45], v[44:45], v[100:101]
    v_pk_add_f32 v[46:47], v[46:47], v[102:103]
    v_cvt_pk_bf16_f32 v186, v44, v45
    v_cvt_pk_bf16_f32 v187, v46, v47
    s_waitcnt lgkmcnt(0)
    v_pk_add_f32 v[48:49], v[48:49], v[104:105]
    v_pk_add_f32 v[50:51], v[50:51], v[106:107]
    v_cvt_pk_bf16_f32 v188, v48, v49
    v_cvt_pk_bf16_f32 v189, v50, v51
    v_dot2_f32_bf16 v28, v180, v224, v28
    v_dot2_f32_bf16 v29, v180, v180, v29
    v_dot2_f32_bf16 v28, v181, v224, v28
    v_dot2_f32_bf16 v29, v181, v181, v29
    v_dot2_f32_bf16 v28, v182, v224, v28
    v_dot2_f32_bf16 v29, v182, v182, v29
    v_dot2_f32_bf16 v28, v183, v224, v28
    v_dot2_f32_bf16 v29, v183, v183, v29
    v_dot2_f32_bf16 v28, v184, v224, v28
    v_dot2_f32_bf16 v29, v184, v184, v29
    v_dot2_f32_bf16 v28, v185, v224, v28
    v_dot2_f32_bf16 v29, v185, v185, v29
    v_dot2_f32_bf16 v28, v186, v224, v28
    v_dot2_f32_bf16 v29, v186, v186, v29
    v_dot2_f32_bf16 v28, v187, v224, v28
    v_dot2_f32_bf16 v29, v187, v187, v29
    v_dot2_f32_bf16 v28, v188, v224, v28
    v_dot2_f32_bf16 v29, v188, v188, v29
    v_dot2_f32_bf16 v28, v189, v224, v28
    v_dot2_f32_bf16 v29, v189, v189, v29
    s_nop 1
    v_permlane16_swap_b32 v180, v182
    v_permlane16_swap_b32 v181, v183
    v_permlane16_swap_b32 v184, v186
    v_permlane16_swap_b32 v185, v187
    buffer_store_dwordx4 v[180:183], v243, s[28:31], s38 offen sc1
    buffer_store_dwordx4 v[184:187], v243, s[28:31], s38 offen offset:1024 sc1
    buffer_store_dwordx2 v[188:189], v244, s[28:31], s39 offen sc1
    v_mov_b32 v160, v28
    v_mov_b32 v161, v29
    s_nop 1
    v_permlane32_swap_b32 v160, v28
    v_permlane32_swap_b32 v161, v29
    s_nop 1
    v_add_f32 v28, v28, v160
    v_add_f32 v29, v29, v161
    v_mov_b32 v160, v28
    v_mov_b32 v161, v29
    s_nop 1
    v_permlane16_swap_b32 v160, v28
    v_permlane16_swap_b32 v161, v29
    s_nop 1
    v_add_f32 v28, v28, v160
    v_add_f32 v29, v29, v161
    v_lshlrev_b32 v2, 3, v4
    s_mov_b64 exec, 0xffff
    buffer_store_dwordx2 v[28:29], v2, s[28:31], s19 offen sc1
    s_mov_b64 exec, -1
    s_waitcnt vmcnt(0)
    s_barrier
    s_cmp_lg_u32 s20, 0
    s_cbranch_scc1 chain_kernel_sig4
    v_mov_b32 v2, 1
    v_mov_b32 v7, 0
    s_mov_b64 exec, 1
    buffer_store_dword v2, v7, s[28:31], s49 offen sc1
    s_mov_b64 exec, -1
chain_kernel_sig4:
    v_and_b32 v2, 31, v1
    v_lshlrev_b32 v2, 4, v2
    v_lshrrev_b32 v7, 5, v1
    v_mul_u32_u24 v7, 7168, v7
    v_add_u32 v2, v2, v7
    s_mul_i32 s26, s52, 448
    s_add_u32 s26, s26, 8130560
    s_mov_b32 m0, 162816
    v_lshlrev_b32 v7, 7, v1
    buffer_load_dwordx4 v2, s[28:31], s26 offen lds
    s_mov_b32 s47, 0
    s_mov_b64 exec, 15
chain_kernel_poll5:
    buffer_load_dword v2, v7, s[28:31], s8 offen sc1
    s_add_u32 s47, s47, 1
    s_waitcnt vmcnt(0)
    v_cmp_ne_u32 vcc, 1, v2
    s_cmp_ge_u32 s47, 20000
    s_cbranch_scc1 chain_kernel_polld6
    s_cbranch_vccnz chain_kernel_poll5
chain_kernel_polld6:
    s_mov_b64 exec, -1
    buffer_load_dwordx4 a[0:3], v8, s[28:31], s6 offen offset:0 sc1
    buffer_load_dwordx4 a[4:7], v8, s[28:31], s7 offen offset:0 sc1
    buffer_load_dwordx4 a[8:11], v8, s[28:31], s6 offen offset:1024 sc1
    buffer_load_dwordx4 a[12:15], v8, s[28:31], s7 offen offset:1024 sc1
    buffer_load_dwordx4 a[16:19], v8, s[28:31], s6 offen offset:2048 sc1
    buffer_load_dwordx4 a[20:23], v8, s[28:31], s7 offen offset:2048 sc1
    buffer_load_dwordx4 a[24:27], v8, s[28:31], s6 offen offset:3072 sc1
    buffer_load_dwordx4 a[28:31], v8, s[28:31], s7 offen offset:3072 sc1
    s_add_u32 s6, s6, 4096
    s_add_u32 s7, s7, 4096
    buffer_load_dwordx4 a[32:35], v8, s[28:31], s6 offen offset:0 sc1
    buffer_load_dwordx4 a[36:39], v8, s[28:31], s7 offen offset:0 sc1
    s_barrier
    s_lshl_b32 s26, s42, 6
    v_lshlrev_b32 v2, 4, v3
    v_add_u32 v7, 162816, v2
    v_add_u32 v2, s26, v7
    s_mul_i32 s26, s42, 384
    s_sub_u32 s26, 384, s26
    v_add_u32 v7, s26, v7
    ds_read_b128 v[88:91], v2 offset:0
    ds_read_b128 v[116:119], v2 offset:512
    ds_read_b128 v[92:95], v2 offset:64
    ds_read_b128 v[120:123], v2 offset:576
    ds_read_b128 v[96:99], v2 offset:128
    ds_read_b128 v[124:127], v2 offset:640
    ds_read_b128 v[100:103], v2 offset:192
    ds_read_b128 v[128:131], v2 offset:704
    ds_read_b128 v[104:107], v2 offset:256
    ds_read_b128 v[132:135], v2 offset:768
    ds_read_b128 v[108:111], v2 offset:320
    ds_read_b128 v[136:139], v2 offset:832
    ds_read_b128 v[112:115], v7
    ds_read_b128 v[140:143], v7 offset:512
    s_and_b32 s36, s57, 1
    s_lshl_b32 s43, s58, 6
    s_lshl_b32 s26, s21, 5
    s_add_u32 s43, s43, s26
    s_lshl_b32 s26, s22, 4
    s_add_u32 s43, s43, s26
    s_mul_i32 s40, s57, 5
    s_add_u32 s41, s40, 1
    s_lshr_b32 s41, s41, 1
    s_add_u32 s26, s41, 2
    s_sub_u32 s27, s41, 1
    s_cmp_eq_u32 s36, 1
    s_cselect_b32 s40, s27, s26
    s_lshl_b32 s44, s41, 10
    s_lshl_b32 s45, s40, 10
    s_lshl_b32 s26, s36, 9
    s_add_u32 s45, s45, s26
    s_lshr_b32 s26, s58, 1
    s_lshl_b32 s26, s26, 4
    s_mul_i32 s27, s22, 7
    s_add_u32 s26, s26, s27
    s_lshl_b32 s26, s26, 2
    s_and_b32 s27, s58, 1
    s_lshl_b32 s27, s27, 1
    s_add_u32 s26, s26, s27
    s_add_u32 s26, s26, s21
    s_lshl_b32 s26, s26, 7
    s_add_u32 s48, s26, 29446144
    v_lshlrev_b32 v234, 9, v1
    s_lshl_b32 s26, s58, 2
    s_lshl_b32 s27, s21, 1
    s_add_u32 s26, s26, s27
    s_add_u32 s27, s26, s22
    s_mul_i32 s27, s27, 54
    s_mul_i32 s39, s22, 27
    s_add_u32 s27, s27, s39
    s_lshl_b32 s27, s27, 10
    s_add_u32 s50, s27, 16027648
    s_add_u32 s27, s26, 1
    s_sub_u32 s27, s27, s22
    s_mul_i32 s27, s27, 54
    s_add_u32 s27, s27, s39
    s_lshl_b32 s27, s27, 10
    s_add_u32 s51, s27, 16027648
    v_add_u32 v9, s43, v4
    v_lshrrev_b32 v11, 4, v9
    v_and_b32 v10, 15, v9
    v_mul_u32_u24 v11, 20480, v11
    v_lshl_add_u32 v11, v10, 4, v11
    v_lshrrev_b32 v2, 1, v3
    v_lshl_add_u32 v11, v2, 8, v11
    v_and_b32 v7, 1, v3
    v_lshl_add_u32 v230, v7, 3, v11
    v_mul_u32_u24 v9, 1280, v9
    v_lshlrev_b32 v7, 5, v7
    v_lshl_add_u32 v7, v2, 4, v7
    v_add_u32 v231, v9, v7
    v_lshl_add_u32 v232, v3, 3, v9
    v_lshlrev_b32 v233, 4, v3
    v_add_u32 v9, s43, v4
    v_lshrrev_b32 v10, 4, v9
    v_mul_u32_u24 v10, 20480, v10
    v_and_b32 v11, 1, v9
    v_lshl_add_u32 v10, v11, 3, v10
    v_lshl_add_u32 v10, v3, 7, v10
    v_bfe_u32 v11, v9, 1, 3
    s_mul_i32 s26, s57, 20
    s_lshl_b32 s27, s36, 2
    s_add_u32 s27, s27, s26
    s_mul_i32 s3, s36, 16
    s_sub_u32 s3, 16, s3
    s_add_u32 s3, s3, s26
    s_add_u32 s4, s27, 0
    v_add_u32 v2, s4, v3
    v_bfe_u32 v2, v2, 1, 3
    v_xor_b32 v2, v2, v11
    v_lshl_add_u32 v2, v2, 4, v10
    s_lshl_b32 s4, s4, 7
    v_add_u32 v235, s4, v2
    s_add_u32 s4, s27, 4
    v_add_u32 v2, s4, v3
    v_bfe_u32 v2, v2, 1, 3
    v_xor_b32 v2, v2, v11
    v_lshl_add_u32 v2, v2, 4, v10
    s_lshl_b32 s4, s4, 7
    v_add_u32 v236, s4, v2
    s_add_u32 s4, s27, 8
    v_add_u32 v2, s4, v3
    v_bfe_u32 v2, v2, 1, 3
    v_xor_b32 v2, v2, v11
    v_lshl_add_u32 v2, v2, 4, v10
    s_lshl_b32 s4, s4, 7
    v_add_u32 v237, s4, v2
    s_add_u32 s4, s27, 12
    v_add_u32 v2, s4, v3
    v_bfe_u32 v2, v2, 1, 3
    v_xor_b32 v2, v2, v11
    v_lshl_add_u32 v2, v2, 4, v10
    s_lshl_b32 s4, s4, 7
    v_add_u32 v238, s4, v2
    s_mov_b32 s4, s3
    v_add_u32 v2, s4, v3
    v_bfe_u32 v2, v2, 1, 3
    v_xor_b32 v2, v2, v11
    v_lshl_add_u32 v2, v2, 4, v10
    s_lshl_b32 s4, s4, 7
    v_add_u32 v239, s4, v2
    s_mul_i32 s37, s57, 320
    s_add_u32 s37, s37, 8126976
    s_mul_i32 s26, s36, 256
    s_sub_u32 s26, 256, s26
    s_add_u32 s38, s37, s26
    s_lshl_b32 s26, s36, 6
    s_add_u32 s37, s37, s26
    s_mul_i32 s26, s57, 160
    s_lshl_b32 s27, s36, 5
    s_add_u32 s46, s26, s27
    s_mul_i32 s27, s36, 128
    s_sub_u32 s27, 128, s27
    s_add_u32 s49, s26, s27
    s_waitcnt lgkmcnt(0)
    v_pk_add_f32 v[88:89], v[88:89], v[116:117]
    v_pk_add_f32 v[90:91], v[90:91], v[118:119]
    v_pk_add_f32 v[92:93], v[92:93], v[120:121]
    v_pk_add_f32 v[94:95], v[94:95], v[122:123]
    v_pk_add_f32 v[96:97], v[96:97], v[124:125]
    v_pk_add_f32 v[98:99], v[98:99], v[126:127]
    v_pk_add_f32 v[100:101], v[100:101], v[128:129]
    v_pk_add_f32 v[102:103], v[102:103], v[130:131]
    v_pk_add_f32 v[104:105], v[104:105], v[132:133]
    v_pk_add_f32 v[106:107], v[106:107], v[134:135]
    v_pk_add_f32 v[108:109], v[108:109], v[136:137]
    v_pk_add_f32 v[110:111], v[110:111], v[138:139]
    v_pk_add_f32 v[112:113], v[112:113], v[140:141]
    v_pk_add_f32 v[114:115], v[114:115], v[142:143]
    v_mov_b32 v12, v8
    v_add_u32 v13, 0x10000, v8
    v_add_u32 v14, 0x20000, v8
    ds_read_b128 a[160:163], v12 offset:0
    ds_read_b128 a[164:167], v12 offset:1024
    ds_read_b128 a[168:171], v12 offset:2048
    ds_read_b128 a[172:175], v12 offset:3072
    ds_read_b128 a[176:179], v12 offset:4096
    ds_read_b128 a[180:183], v12 offset:5120
    ds_read_b128 a[184:187], v12 offset:6144
    s_waitcnt vmcnt(8) lgkmcnt(6)
    v_mfma_f32_16x16x32_bf16 v[32:35], a[160:163], a[0:3], 0
    v_mfma_f32_16x16x32_bf16 v[60:63], a[160:163], a[4:7], 0
    ds_read_b128 a[188:191], v12 offset:7168
    buffer_load_dwordx4 a[40:43], v8, s[28:31], s6 offen offset:1024 sc1
    s_waitcnt lgkmcnt(6)
    v_mfma_f32_16x16x32_bf16 v[36:39], a[164:167], a[0:3], 0
    v_mfma_f32_16x16x32_bf16 v[64:67], a[164:167], a[4:7], 0
    ds_read_b128 a[160:163], v12 offset:8192
    s_waitcnt lgkmcnt(6)
    v_mfma_f32_16x16x32_bf16 v[40:43], a[168:171], a[0:3], 0
    v_mfma_f32_16x16x32_bf16 v[68:71], a[168:171], a[4:7], 0
    ds_read_b128 a[164:167], v12 offset:9216
    buffer_load_dwordx4 a[44:47], v8, s[28:31], s7 offen offset:1024 sc1
    s_waitcnt lgkmcnt(6)
    v_mfma_f32_16x16x32_bf16 v[44:47], a[172:175], a[0:3], 0
    v_mfma_f32_16x16x32_bf16 v[72:75], a[172:175], a[4:7], 0
    ds_read_b128 a[168:171], v12 offset:10240
    s_waitcnt vmcnt(8) lgkmcnt(6)
    v_mfma_f32_16x16x32_bf16 v[32:35], a[176:179], a[8:11], v[32:35]
    v_mfma_f32_16x16x32_bf16 v[60:63], a[176:179], a[12:15], v[60:63]
    ds_read_b128 a[172:175], v12 offset:11264
    buffer_load_dwordx4 a[48:51], v8, s[28:31], s6 offen offset:2048 sc1
    s_waitcnt lgkmcnt(6)
    v_mfma_f32_16x16x32_bf16 v[36:39], a[180:183], a[8:11], v[36:39]
    v_mfma_f32_16x16x32_bf16 v[64:67], a[180:183], a[12:15], v[64:67]
    ds_read_b128 a[176:179], v12 offset:12288
    s_waitcnt lgkmcnt(6)
    v_mfma_f32_16x16x32_bf16 v[40:43], a[184:187], a[8:11], v[40:43]
    v_mfma_f32_16x16x32_bf16 v[68:71], a[184:187], a[12:15], v[68:71]
    ds_read_b128 a[180:183], v12 offset:13312
    buffer_load_dwordx4 a[52:55], v8, s[28:31], s7 offen offset:2048 sc1
    s_waitcnt lgkmcnt(6)
    v_mfma_f32_16x16x32_bf16 v[44:47], a[188:191], a[8:11], v[44:47]
    v_mfma_f32_16x16x32_bf16 v[72:75], a[188:191], a[12:15], v[72:75]
    ds_read_b128 a[184:187], v12 offset:14336
    s_waitcnt vmcnt(8) lgkmcnt(6)
    v_mfma_f32_16x16x32_bf16 v[32:35], a[160:163], a[16:19], v[32:35]
    v_mfma_f32_16x16x32_bf16 v[60:63], a[160:163], a[20:23], v[60:63]
    ds_read_b128 a[188:191], v12 offset:15360
    buffer_load_dwordx4 a[56:59], v8, s[28:31], s6 offen offset:3072 sc1
    s_waitcnt lgkmcnt(6)
    v_mfma_f32_16x16x32_bf16 v[36:39], a[164:167], a[16:19], v[36:39]
    v_mfma_f32_16x16x32_bf16 v[64:67], a[164:167], a[20:23], v[64:67]
    ds_read_b128 a[160:163], v12 offset:16384
    s_waitcnt lgkmcnt(6)
    v_mfma_f32_16x16x32_bf16 v[40:43], a[168:171], a[16:19], v[40:43]
    v_mfma_f32_16x16x32_bf16 v[68:71], a[168:171], a[20:23], v[68:71]
    ds_read_b128 a[164:167], v12 offset:17408
    buffer_load_dwordx4 a[60:63], v8, s[28:31], s7 offen offset:3072 sc1
    s_waitcnt lgkmcnt(6)
    v_mfma_f32_16x16x32_bf16 v[44:47], a[172:175], a[16:19], v[44:47]
    v_mfma_f32_16x16x32_bf16 v[72:75], a[172:175], a[20:23], v[72:75]
    ds_read_b128 a[168:171], v12 offset:18432
    s_waitcnt vmcnt(8) lgkmcnt(6)
    v_mfma_f32_16x16x32_bf16 v[32:35], a[176:179], a[24:27], v[32:35]
    v_mfma_f32_16x16x32_bf16 v[60:63], a[176:179], a[28:31], v[60:63]
    ds_read_b128 a[172:175], v12 offset:19456
    s_add_u32 s6, s6, 4096
    s_add_u32 s7, s7, 4096
    buffer_load_dwordx4 a[64:67], v8, s[28:31], s6 offen offset:0 sc1
    s_waitcnt lgkmcnt(6)
    v_mfma_f32_16x16x32_bf16 v[36:39], a[180:183], a[24:27], v[36:39]
    v_mfma_f32_16x16x32_bf16 v[64:67], a[180:183], a[28:31], v[64:67]
    ds_read_b128 a[176:179], v12 offset:20480
    s_waitcnt lgkmcnt(6)
    v_mfma_f32_16x16x32_bf16 v[40:43], a[184:187], a[24:27], v[40:43]
    v_mfma_f32_16x16x32_bf16 v[68:71], a[184:187], a[28:31], v[68:71]
    ds_read_b128 a[180:183], v12 offset:21504
    buffer_load_dwordx4 a[68:71], v8, s[28:31], s7 offen offset:0 sc1
    s_waitcnt lgkmcnt(6)
    v_mfma_f32_16x16x32_bf16 v[44:47], a[188:191], a[24:27], v[44:47]
    v_mfma_f32_16x16x32_bf16 v[72:75], a[188:191], a[28:31], v[72:75]
    ds_read_b128 a[184:187], v12 offset:22528
    s_waitcnt vmcnt(8) lgkmcnt(6)
    v_mfma_f32_16x16x32_bf16 v[32:35], a[160:163], a[32:35], v[32:35]
    v_mfma_f32_16x16x32_bf16 v[60:63], a[160:163], a[36:39], v[60:63]
    ds_read_b128 a[188:191], v12 offset:23552
    buffer_load_dwordx4 a[72:75], v8, s[28:31], s6 offen offset:1024 sc1
    s_waitcnt lgkmcnt(6)
    v_mfma_f32_16x16x32_bf16 v[36:39], a[164:167], a[32:35], v[36:39]
    v_mfma_f32_16x16x32_bf16 v[64:67], a[164:167], a[36:39], v[64:67]
    ds_read_b128 a[160:163], v12 offset:24576
    s_waitcnt lgkmcnt(6)
    v_mfma_f32_16x16x32_bf16 v[40:43], a[168:171], a[32:35], v[40:43]
    v_mfma_f32_16x16x32_bf16 v[68:71], a[168:171], a[36:39], v[68:71]
    ds_read_b128 a[164:167], v12 offset:25600
    buffer_load_dwordx4 a[76:79], v8, s[28:31], s7 offen offset:1024 sc1
    s_waitcnt lgkmcnt(6)
    v_mfma_f32_16x16x32_bf16 v[44:47], a[172:175], a[32:35], v[44:47]
    v_mfma_f32_16x16x32_bf16 v[72:75], a[172:175], a[36:39], v[72:75]
    ds_read_b128 a[168:171], v12 offset:26624
    s_waitcnt vmcnt(8) lgkmcnt(6)
    v_mfma_f32_16x16x32_bf16 v[32:35], a[176:179], a[40:43], v[32:35]
    v_mfma_f32_16x16x32_bf16 v[60:63], a[176:179], a[44:47], v[60:63]
    ds_read_b128 a[172:175], v12 offset:27648
    buffer_load_dwordx4 a[80:83], v8, s[28:31], s6 offen offset:2048 sc1
    s_waitcnt lgkmcnt(6)
    v_mfma_f32_16x16x32_bf16 v[36:39], a[180:183], a[40:43], v[36:39]
    v_mfma_f32_16x16x32_bf16 v[64:67], a[180:183], a[44:47], v[64:67]
    ds_read_b128 a[176:179], v12 offset:28672
    s_waitcnt lgkmcnt(6)
    v_mfma_f32_16x16x32_bf16 v[40:43], a[184:187], a[40:43], v[40:43]
    v_mfma_f32_16x16x32_bf16 v[68:71], a[184:187], a[44:47], v[68:71]
    ds_read_b128 a[180:183], v12 offset:29696
    buffer_load_dwordx4 a[84:87], v8, s[28:31], s7 offen offset:2048 sc1
    s_waitcnt lgkmcnt(6)
    v_mfma_f32_16x16x32_bf16 v[44:47], a[188:191], a[40:43], v[44:47]
    v_mfma_f32_16x16x32_bf16 v[72:75], a[188:191], a[44:47], v[72:75]
    ds_read_b128 a[184:187], v12 offset:30720
    s_waitcnt vmcnt(8) lgkmcnt(6)
    v_mfma_f32_16x16x32_bf16 v[32:35], a[160:163], a[48:51], v[32:35]
    v_mfma_f32_16x16x32_bf16 v[60:63], a[160:163], a[52:55], v[60:63]
    ds_read_b128 a[188:191], v12 offset:31744
    buffer_load_dwordx4 a[88:91], v8, s[28:31], s6 offen offset:3072 sc1
    s_waitcnt lgkmcnt(6)
    v_mfma_f32_16x16x32_bf16 v[36:39], a[164:167], a[48:51], v[36:39]
    v_mfma_f32_16x16x32_bf16 v[64:67], a[164:167], a[52:55], v[64:67]
    ds_read_b128 a[160:163], v12 offset:32768
    s_waitcnt lgkmcnt(6)
    v_mfma_f32_16x16x32_bf16 v[40:43], a[168:171], a[48:51], v[40:43]
    v_mfma_f32_16x16x32_bf16 v[68:71], a[168:171], a[52:55], v[68:71]
    ds_read_b128 a[164:167], v12 offset:33792
    buffer_load_dwordx4 a[92:95], v8, s[28:31], s7 offen offset:3072 sc1
    s_waitcnt lgkmcnt(6)
    v_mfma_f32_16x16x32_bf16 v[44:47], a[172:175], a[48:51], v[44:47]
    v_mfma_f32_16x16x32_bf16 v[72:75], a[172:175], a[52:55], v[72:75]
    ds_read_b128 a[168:171], v12 offset:34816
    s_waitcnt vmcnt(8) lgkmcnt(6)
    v_mfma_f32_16x16x32_bf16 v[32:35], a[176:179], a[56:59], v[32:35]
    v_mfma_f32_16x16x32_bf16 v[60:63], a[176:179], a[60:63], v[60:63]
    ds_read_b128 a[172:175], v12 offset:35840
    s_add_u32 s6, s6, 4096
    s_add_u32 s7, s7, 4096
    buffer_load_dwordx4 a[96:99], v8, s[28:31], s6 offen offset:0 sc1
    s_waitcnt lgkmcnt(6)
    v_mfma_f32_16x16x32_bf16 v[36:39], a[180:183], a[56:59], v[36:39]
    v_mfma_f32_16x16x32_bf16 v[64:67], a[180:183], a[60:63], v[64:67]
    ds_read_b128 a[176:179], v12 offset:36864
    s_waitcnt lgkmcnt(6)
    v_mfma_f32_16x16x32_bf16 v[40:43], a[184:187], a[56:59], v[40:43]
    v_mfma_f32_16x16x32_bf16 v[68:71], a[184:187], a[60:63], v[68:71]
    ds_read_b128 a[180:183], v12 offset:37888
    buffer_load_dwordx4 a[100:103], v8, s[28:31], s7 offen offset:0 sc1
    s_waitcnt lgkmcnt(6)
    v_mfma_f32_16x16x32_bf16 v[44:47], a[188:191], a[56:59], v[44:47]
    v_mfma_f32_16x16x32_bf16 v[72:75], a[188:191], a[60:63], v[72:75]
    ds_read_b128 a[184:187], v12 offset:38912
    s_waitcnt vmcnt(8) lgkmcnt(6)
    v_mfma_f32_16x16x32_bf16 v[32:35], a[160:163], a[64:67], v[32:35]
    v_mfma_f32_16x16x32_bf16 v[60:63], a[160:163], a[68:71], v[60:63]
    ds_read_b128 a[188:191], v12 offset:39936
    buffer_load_dwordx4 a[104:107], v8, s[28:31], s6 offen offset:1024 sc1
    s_waitcnt lgkmcnt(6)
    v_mfma_f32_16x16x32_bf16 v[36:39], a[164:167], a[64:67], v[36:39]
    v_mfma_f32_16x16x32_bf16 v[64:67], a[164:167], a[68:71], v[64:67]
    ds_read_b128 a[160:163], v12 offset:40960
    s_waitcnt lgkmcnt(6)
    v_mfma_f32_16x16x32_bf16 v[40:43], a[168:171], a[64:67], v[40:43]
    v_mfma_f32_16x16x32_bf16 v[68:71], a[168:171], a[68:71], v[68:71]
    ds_read_b128 a[164:167], v12 offset:41984
    buffer_load_dwordx4 a[108:111], v8, s[28:31], s7 offen offset:1024 sc1
    s_waitcnt lgkmcnt(6)
    v_mfma_f32_16x16x32_bf16 v[44:47], a[172:175], a[64:67], v[44:47]
    v_mfma_f32_16x16x32_bf16 v[72:75], a[172:175], a[68:71], v[72:75]
    ds_read_b128 a[168:171], v12 offset:43008
    s_waitcnt vmcnt(8) lgkmcnt(6)
    v_mfma_f32_16x16x32_bf16 v[32:35], a[176:179], a[72:75], v[32:35]
    v_mfma_f32_16x16x32_bf16 v[60:63], a[176:179], a[76:79], v[60:63]
    ds_read_b128 a[172:175], v12 offset:44032
    buffer_load_dwordx4 a[112:115], v8, s[28:31], s6 offen offset:2048 sc1
    s_waitcnt lgkmcnt(6)
    v_mfma_f32_16x16x32_bf16 v[36:39], a[180:183], a[72:75], v[36:39]
    v_mfma_f32_16x16x32_bf16 v[64:67], a[180:183], a[76:79], v[64:67]
    ds_read_b128 a[176:179], v12 offset:45056
    s_waitcnt lgkmcnt(6)
    v_mfma_f32_16x16x32_bf16 v[40:43], a[184:187], a[72:75], v[40:43]
    v_mfma_f32_16x16x32_bf16 v[68:71], a[184:187], a[76:79], v[68:71]
    ds_read_b128 a[180:183], v12 offset:46080
    buffer_load_dwordx4 a[116:119], v8, s[28:31], s7 offen offset:2048 sc1
    s_waitcnt lgkmcnt(6)
    v_mfma_f32_16x16x32_bf16 v[44:47], a[188:191], a[72:75], v[44:47]
    v_mfma_f32_16x16x32_bf16 v[72:75], a[188:191], a[76:79], v[72:75]
    ds_read_b128 a[184:187], v12 offset:47104
    s_waitcnt vmcnt(8) lgkmcnt(6)
    v_mfma_f32_16x16x32_bf16 v[32:35], a[160:163], a[80:83], v[32:35]
    v_mfma_f32_16x16x32_bf16 v[60:63], a[160:163], a[84:87], v[60:63]
    ds_read_b128 a[188:191], v12 offset:48128
    buffer_load_dwordx4 a[120:123], v8, s[28:31], s6 offen offset:3072 sc1
    s_waitcnt lgkmcnt(6)
    v_mfma_f32_16x16x32_bf16 v[36:39], a[164:167], a[80:83], v[36:39]
    v_mfma_f32_16x16x32_bf16 v[64:67], a[164:167], a[84:87], v[64:67]
    ds_read_b128 a[160:163], v12 offset:49152
    s_waitcnt lgkmcnt(6)
    v_mfma_f32_16x16x32_bf16 v[40:43], a[168:171], a[80:83], v[40:43]
    v_mfma_f32_16x16x32_bf16 v[68:71], a[168:171], a[84:87], v[68:71]
    ds_read_b128 a[164:167], v12 offset:50176
    buffer_load_dwordx4 a[124:127], v8, s[28:31], s7 offen offset:3072 sc1
    s_waitcnt lgkmcnt(6)
    v_mfma_f32_16x16x32_bf16 v[44:47], a[172:175], a[80:83], v[44:47]
    v_mfma_f32_16x16x32_bf16 v[72:75], a[172:175], a[84:87], v[72:75]
    ds_read_b128 a[168:171], v12 offset:51200
    s_waitcnt vmcnt(8) lgkmcnt(6)
    v_mfma_f32_16x16x32_bf16 v[32:35], a[176:179], a[88:91], v[32:35]
    v_mfma_f32_16x16x32_bf16 v[60:63], a[176:179], a[92:95], v[60:63]
    ds_read_b128 a[172:175], v12 offset:52224
    s_add_u32 s6, s6, 4096
    s_add_u32 s7, s7, 4096
    buffer_load_dwordx4 a[128:131], v8, s[28:31], s6 offen offset:0 sc1
    s_waitcnt lgkmcnt(6)
    v_mfma_f32_16x16x32_bf16 v[36:39], a[180:183], a[88:91], v[36:39]
    v_mfma_f32_16x16x32_bf16 v[64:67], a[180:183], a[92:95], v[64:67]
    ds_read_b128 a[176:179], v12 offset:53248
    s_waitcnt lgkmcnt(6)
    v_mfma_f32_16x16x32_bf16 v[40:43], a[184:187], a[88:91], v[40:43]
    v_mfma_f32_16x16x32_bf16 v[68:71], a[184:187], a[92:95], v[68:71]
    ds_read_b128 a[180:183], v12 offset:54272
    buffer_load_dwordx4 a[132:135], v8, s[28:31], s7 offen offset:0 sc1
    s_waitcnt lgkmcnt(6)
    v_mfma_f32_16x16x32_bf16 v[44:47], a[188:191], a[88:91], v[44:47]
    v_mfma_f32_16x16x32_bf16 v[72:75], a[188:191], a[92:95], v[72:75]
    ds_read_b128 a[184:187], v12 offset:55296
    s_waitcnt vmcnt(8) lgkmcnt(6)
    v_mfma_f32_16x16x32_bf16 v[32:35], a[160:163], a[96:99], v[32:35]
    v_mfma_f32_16x16x32_bf16 v[60:63], a[160:163], a[100:103], v[60:63]
    ds_read_b128 a[188:191], v12 offset:56320
    buffer_load_dwordx4 a[136:139], v8, s[28:31], s6 offen offset:1024 sc1
    s_waitcnt lgkmcnt(6)
    v_mfma_f32_16x16x32_bf16 v[36:39], a[164:167], a[96:99], v[36:39]
    v_mfma_f32_16x16x32_bf16 v[64:67], a[164:167], a[100:103], v[64:67]
    ds_read_b128 a[160:163], v12 offset:57344
    s_waitcnt lgkmcnt(6)
    v_mfma_f32_16x16x32_bf16 v[40:43], a[168:171], a[96:99], v[40:43]
    v_mfma_f32_16x16x32_bf16 v[68:71], a[168:171], a[100:103], v[68:71]
    ds_read_b128 a[164:167], v12 offset:58368
    buffer_load_dwordx4 a[140:143], v8, s[28:31], s7 offen offset:1024 sc1
    s_waitcnt lgkmcnt(6)
    v_mfma_f32_16x16x32_bf16 v[44:47], a[172:175], a[96:99], v[44:47]
    v_mfma_f32_16x16x32_bf16 v[72:75], a[172:175], a[100:103], v[72:75]
    ds_read_b128 a[168:171], v12 offset:59392
    s_waitcnt vmcnt(8) lgkmcnt(6)
    v_mfma_f32_16x16x32_bf16 v[32:35], a[176:179], a[104:107], v[32:35]
    v_mfma_f32_16x16x32_bf16 v[60:63], a[176:179], a[108:111], v[60:63]
    ds_read_b128 a[172:175], v12 offset:60416
    buffer_load_dwordx4 a[144:147], v8, s[28:31], s6 offen offset:2048 sc1
    s_waitcnt lgkmcnt(6)
    v_mfma_f32_16x16x32_bf16 v[36:39], a[180:183], a[104:107], v[36:39]
    v_mfma_f32_16x16x32_bf16 v[64:67], a[180:183], a[108:111], v[64:67]
    ds_read_b128 a[176:179], v12 offset:61440
    s_waitcnt lgkmcnt(6)
    v_mfma_f32_16x16x32_bf16 v[40:43], a[184:187], a[104:107], v[40:43]
    v_mfma_f32_16x16x32_bf16 v[68:71], a[184:187], a[108:111], v[68:71]
    ds_read_b128 a[180:183], v12 offset:62464
    buffer_load_dwordx4 a[148:151], v8, s[28:31], s7 offen offset:2048 sc1
    s_waitcnt lgkmcnt(6)
    v_mfma_f32_16x16x32_bf16 v[44:47], a[188:191], a[104:107], v[44:47]
    v_mfma_f32_16x16x32_bf16 v[72:75], a[188:191], a[108:111], v[72:75]
    ds_read_b128 a[184:187], v12 offset:63488
    s_waitcnt vmcnt(8) lgkmcnt(6)
    v_mfma_f32_16x16x32_bf16 v[32:35], a[160:163], a[112:115], v[32:35]
    v_mfma_f32_16x16x32_bf16 v[60:63], a[160:163], a[116:119], v[60:63]
    ds_read_b128 a[188:191], v12 offset:64512
    buffer_load_dwordx4 a[152:155], v8, s[28:31], s6 offen offset:3072 sc1
    s_waitcnt lgkmcnt(6)
    v_mfma_f32_16x16x32_bf16 v[36:39], a[164:167], a[112:115], v[36:39]
    v_mfma_f32_16x16x32_bf16 v[64:67], a[164:167], a[116:119], v[64:67]
    ds_read_b128 a[160:163], v13 offset:0
    s_waitcnt lgkmcnt(6)
    v_mfma_f32_16x16x32_bf16 v[40:43], a[168:171], a[112:115], v[40:43]
    v_mfma_f32_16x16x32_bf16 v[68:71], a[168:171], a[116:119], v[68:71]
    ds_read_b128 a[164:167], v13 offset:1024
    buffer_load_dwordx4 a[156:159], v8, s[28:31], s7 offen offset:3072 sc1
    s_waitcnt lgkmcnt(6)
    v_mfma_f32_16x16x32_bf16 v[44:47], a[172:175], a[112:115], v[44:47]
    v_mfma_f32_16x16x32_bf16 v[72:75], a[172:175], a[116:119], v[72:75]
    ds_read_b128 a[168:171], v13 offset:2048
    s_waitcnt vmcnt(8) lgkmcnt(6)
    v_mfma_f32_16x16x32_bf16 v[32:35], a[176:179], a[120:123], v[32:35]
    v_mfma_f32_16x16x32_bf16 v[60:63], a[176:179], a[124:127], v[60:63]
    ds_read_b128 a[172:175], v13 offset:3072
    buffer_load_dwordx2 v[16:17], v228, s[28:31], s9 offen offset:0 sc1
    s_waitcnt lgkmcnt(6)
    v_mfma_f32_16x16x32_bf16 v[36:39], a[180:183], a[120:123], v[36:39]
    v_mfma_f32_16x16x32_bf16 v[64:67], a[180:183], a[124:127], v[64:67]
    ds_read_b128 a[176:179], v13 offset:4096
    s_waitcnt lgkmcnt(6)
    v_mfma_f32_16x16x32_bf16 v[40:43], a[184:187], a[120:123], v[40:43]
    v_mfma_f32_16x16x32_bf16 v[68:71], a[184:187], a[124:127], v[68:71]
    ds_read_b128 a[180:183], v13 offset:5120
    buffer_load_dwordx2 v[18:19], v228, s[28:31], s9 offen offset:128 sc1
    s_waitcnt lgkmcnt(6)
    v_mfma_f32_16x16x32_bf16 v[44:47], a[188:191], a[120:123], v[44:47]
    v_mfma_f32_16x16x32_bf16 v[72:75], a[188:191], a[124:127], v[72:75]
    ds_read_b128 a[184:187], v13 offset:6144
    s_waitcnt vmcnt(8) lgkmcnt(6)
    v_mfma_f32_16x16x32_bf16 v[32:35], a[160:163], a[128:131], v[32:35]
    v_mfma_f32_16x16x32_bf16 v[60:63], a[160:163], a[132:135], v[60:63]
    ds_read_b128 a[188:191], v13 offset:7168
    buffer_load_dwordx2 v[20:21], v228, s[28:31], s9 offen offset:1024 sc1
    s_waitcnt lgkmcnt(6)
    v_mfma_f32_16x16x32_bf16 v[36:39], a[164:167], a[128:131], v[36:39]
    v_mfma_f32_16x16x32_bf16 v[64:67], a[164:167], a[132:135], v[64:67]
    ds_read_b128 a[160:163], v13 offset:8192
    s_waitcnt lgkmcnt(6)
    v_mfma_f32_16x16x32_bf16 v[40:43], a[168:171], a[128:131], v[40:43]
    v_mfma_f32_16x16x32_bf16 v[68:71], a[168:171], a[132:135], v[68:71]
    ds_read_b128 a[164:167], v13 offset:9216
    buffer_load_dwordx2 v[22:23], v228, s[28:31], s9 offen offset:1152 sc1
    s_waitcnt lgkmcnt(6)
    v_mfma_f32_16x16x32_bf16 v[44:47], a[172:175], a[128:131], v[44:47]
    v_mfma_f32_16x16x32_bf16 v[72:75], a[172:175], a[132:135], v[72:75]
    ds_read_b128 a[168:171], v13 offset:10240
    s_waitcnt vmcnt(8) lgkmcnt(6)
    v_mfma_f32_16x16x32_bf16 v[32:35], a[176:179], a[136:139], v[32:35]
    v_mfma_f32_16x16x32_bf16 v[60:63], a[176:179], a[140:143], v[60:63]
    ds_read_b128 a[172:175], v13 offset:11264
    s_waitcnt lgkmcnt(6)
    v_mfma_f32_16x16x32_bf16 v[36:39], a[180:183], a[136:139], v[36:39]
    v_mfma_f32_16x16x32_bf16 v[64:67], a[180:183], a[140:143], v[64:67]
    ds_read_b128 a[176:179], v13 offset:12288
    s_mul_i32 s25, s20, 3
    s_min_u32 s25, s25, 7
    s_lshl_b32 s25, s25, 10
    s_add_u32 s62, s25, 143360
    s_add_u32 s63, s25, s59
    s_add_u32 s63, s63, 0
    s_mov_b32 m0, s62
    buffer_load_dwordx4 v8, s[28:31], s63 offen offset:0 lds
    s_waitcnt lgkmcnt(6)
    v_mfma_f32_16x16x32_bf16 v[40:43], a[184:187], a[136:139], v[40:43]
    v_mfma_f32_16x16x32_bf16 v[68:71], a[184:187], a[140:143], v[68:71]
    ds_read_b128 a[180:183], v13 offset:13312
    s_waitcnt lgkmcnt(6)
    v_mfma_f32_16x16x32_bf16 v[44:47], a[188:191], a[136:139], v[44:47]
    v_mfma_f32_16x16x32_bf16 v[72:75], a[188:191], a[140:143], v[72:75]
    ds_read_b128 a[184:187], v13 offset:14336
    buffer_load_dwordx4 v8, s[28:31], s63 offen offset:1024 lds
    s_waitcnt vmcnt(8) lgkmcnt(6)
    v_mfma_f32_16x16x32_bf16 v[32:35], a[160:163], a[144:147], v[32:35]
    v_mfma_f32_16x16x32_bf16 v[60:63], a[160:163], a[148:151], v[60:63]
    ds_read_b128 a[188:191], v13 offset:15360
    s_waitcnt lgkmcnt(6)
    v_mfma_f32_16x16x32_bf16 v[36:39], a[164:167], a[144:147], v[36:39]
    v_mfma_f32_16x16x32_bf16 v[64:67], a[164:167], a[148:151], v[64:67]
    ds_read_b128 a[160:163], v13 offset:16384
    buffer_load_dwordx4 v8, s[28:31], s63 offen offset:2048 lds
    s_waitcnt lgkmcnt(6)
    v_mfma_f32_16x16x32_bf16 v[40:43], a[168:171], a[144:147], v[40:43]
    v_mfma_f32_16x16x32_bf16 v[68:71], a[168:171], a[148:151], v[68:71]
    ds_read_b128 a[164:167], v13 offset:17408
    s_waitcnt lgkmcnt(6)
    v_mfma_f32_16x16x32_bf16 v[44:47], a[172:175], a[144:147], v[44:47]
    v_mfma_f32_16x16x32_bf16 v[72:75], a[172:175], a[148:151], v[72:75]
    ds_read_b128 a[168:171], v13 offset:18432
    s_waitcnt vmcnt(7) lgkmcnt(6)
    v_mfma_f32_16x16x32_bf16 v[32:35], a[176:179], a[152:155], v[32:35]
    v_mfma_f32_16x16x32_bf16 v[60:63], a[176:179], a[156:159], v[60:63]
    ds_read_b128 a[172:175], v13 offset:19456
    s_waitcnt lgkmcnt(6)
    v_mfma_f32_16x16x32_bf16 v[36:39], a[180:183], a[152:155], v[36:39]
    v_mfma_f32_16x16x32_bf16 v[64:67], a[180:183], a[156:159], v[64:67]
    ds_read_b128 a[176:179], v13 offset:20480
    s_waitcnt lgkmcnt(6)
    v_mfma_f32_16x16x32_bf16 v[40:43], a[184:187], a[152:155], v[40:43]
    v_mfma_f32_16x16x32_bf16 v[68:71], a[184:187], a[156:159], v[68:71]
    ds_read_b128 a[180:183], v13 offset:21504
    s_waitcnt lgkmcnt(6)
    v_mfma_f32_16x16x32_bf16 v[44:47], a[188:191], a[152:155], v[44:47]
    v_mfma_f32_16x16x32_bf16 v[72:75], a[188:191], a[156:159], v[72:75]
    ds_read_b128 a[184:187], v13 offset:22528
    s_waitcnt lgkmcnt(6)
    v_mfma_f32_16x16x32_bf16 v[48:51], a[160:163], a[0:3], 0
    v_mfma_f32_16x16x32_bf16 v[76:79], a[160:163], a[4:7], 0
    ds_read_b128 a[188:191], v13 offset:23552
    s_waitcnt lgkmcnt(6)
    v_mfma_f32_16x16x32_bf16 v[52:55], a[164:167], a[0:3], 0
    v_mfma_f32_16x16x32_bf16 v[80:83], a[164:167], a[4:7], 0
    ds_read_b128 a[160:163], v13 offset:24576
    s_barrier
    s_waitcnt lgkmcnt(6)
    v_mfma_f32_16x16x32_bf16 v[48:51], a[168:171], a[8:11], v[48:51]
    v_mfma_f32_16x16x32_bf16 v[76:79], a[168:171], a[12:15], v[76:79]
    ds_read_b128 a[164:167], v13 offset:25600
    s_mul_i32 s25, s20, 20
    s_lshl_b32 s25, s25, 10
    s_add_u32 s62, s25, 0
    s_add_u32 s63, s25, s59
    s_add_u32 s63, s63, 10240
    s_mov_b32 m0, s62
    buffer_load_dwordx4 v8, s[28:31], s63 offen offset:0 lds
    s_waitcnt lgkmcnt(6)
    v_mfma_f32_16x16x32_bf16 v[52:55], a[172:175], a[8:11], v[52:55]
    v_mfma_f32_16x16x32_bf16 v[80:83], a[172:175], a[12:15], v[80:83]
    ds_read_b128 a[168:171], v13 offset:26624
    s_waitcnt lgkmcnt(6)
    v_mfma_f32_16x16x32_bf16 v[48:51], a[176:179], a[16:19], v[48:51]
    v_mfma_f32_16x16x32_bf16 v[76:79], a[176:179], a[20:23], v[76:79]
    ds_read_b128 a[172:175], v13 offset:27648
    buffer_load_dwordx4 v8, s[28:31], s63 offen offset:1024 lds
    s_waitcnt lgkmcnt(6)
    v_mfma_f32_16x16x32_bf16 v[52:55], a[180:183], a[16:19], v[52:55]
    v_mfma_f32_16x16x32_bf16 v[80:83], a[180:183], a[20:23], v[80:83]
    ds_read_b128 a[176:179], v13 offset:28672
    s_waitcnt lgkmcnt(6)
    v_mfma_f32_16x16x32_bf16 v[48:51], a[184:187], a[24:27], v[48:51]
    v_mfma_f32_16x16x32_bf16 v[76:79], a[184:187], a[28:31], v[76:79]
    ds_read_b128 a[180:183], v13 offset:29696
    buffer_load_dwordx4 v8, s[28:31], s63 offen offset:2048 lds
    s_waitcnt lgkmcnt(6)
    v_mfma_f32_16x16x32_bf16 v[52:55], a[188:191], a[24:27], v[52:55]
    v_mfma_f32_16x16x32_bf16 v[80:83], a[188:191], a[28:31], v[80:83]
    ds_read_b128 a[184:187], v13 offset:30720
    s_waitcnt lgkmcnt(6)
    v_mfma_f32_16x16x32_bf16 v[48:51], a[160:163], a[32:35], v[48:51]
    v_mfma_f32_16x16x32_bf16 v[76:79], a[160:163], a[36:39], v[76:79]
    ds_read_b128 a[188:191], v13 offset:31744
    buffer_load_dwordx4 v8, s[28:31], s63 offen offset:3072 lds
    s_waitcnt lgkmcnt(6)
    v_mfma_f32_16x16x32_bf16 v[52:55], a[164:167], a[32:35], v[52:55]
    v_mfma_f32_16x16x32_bf16 v[80:83], a[164:167], a[36:39], v[80:83]
    ds_read_b128 a[160:163], v13 offset:32768
    s_waitcnt lgkmcnt(6)
    v_mfma_f32_16x16x32_bf16 v[48:51], a[168:171], a[40:43], v[48:51]
    v_mfma_f32_16x16x32_bf16 v[76:79], a[168:171], a[44:47], v[76:79]
    ds_read_b128 a[164:167], v13 offset:33792
    s_add_u32 s62, s62, 4096
    s_add_u32 s63, s63, 4096
    s_mov_b32 m0, s62
    buffer_load_dwordx4 v8, s[28:31], s63 offen offset:0 lds
    s_waitcnt lgkmcnt(6)
    v_mfma_f32_16x16x32_bf16 v[52:55], a[172:175], a[40:43], v[52:55]
    v_mfma_f32_16x16x32_bf16 v[80:83], a[172:175], a[44:47], v[80:83]
    ds_read_b128 a[168:171], v13 offset:34816
    s_waitcnt lgkmcnt(6)
    v_mfma_f32_16x16x32_bf16 v[48:51], a[176:179], a[48:51], v[48:51]
    v_mfma_f32_16x16x32_bf16 v[76:79], a[176:179], a[52:55], v[76:79]
    ds_read_b128 a[172:175], v13 offset:35840
    buffer_load_dwordx4 v8, s[28:31], s63 offen offset:1024 lds
    s_waitcnt lgkmcnt(6)
    v_mfma_f32_16x16x32_bf16 v[52:55], a[180:183], a[48:51], v[52:55]
    v_mfma_f32_16x16x32_bf16 v[80:83], a[180:183], a[52:55], v[80:83]
    ds_read_b128 a[176:179], v13 offset:36864
    s_waitcnt lgkmcnt(6)
    v_mfma_f32_16x16x32_bf16 v[48:51], a[184:187], a[56:59], v[48:51]
    v_mfma_f32_16x16x32_bf16 v[76:79], a[184:187], a[60:63], v[76:79]
    ds_read_b128 a[180:183], v13 offset:37888
    buffer_load_dwordx4 v8, s[28:31], s63 offen offset:2048 lds
    s_waitcnt lgkmcnt(6)
    v_mfma_f32_16x16x32_bf16 v[52:55], a[188:191], a[56:59], v[52:55]
    v_mfma_f32_16x16x32_bf16 v[80:83], a[188:191], a[60:63], v[80:83]
    ds_read_b128 a[184:187], v13 offset:38912
    s_waitcnt lgkmcnt(6)
    v_mfma_f32_16x16x32_bf16 v[48:51], a[160:163], a[64:67], v[48:51]
    v_mfma_f32_16x16x32_bf16 v[76:79], a[160:163], a[68:71], v[76:79]
    ds_read_b128 a[188:191], v13 offset:39936
    buffer_load_dwordx4 v8, s[28:31], s63 offen offset:3072 lds
    s_waitcnt lgkmcnt(6)
    v_mfma_f32_16x16x32_bf16 v[52:55], a[164:167], a[64:67], v[52:55]
    v_mfma_f32_16x16x32_bf16 v[80:83], a[164:167], a[68:71], v[80:83]
    ds_read_b128 a[160:163], v13 offset:40960
    s_waitcnt lgkmcnt(6)
    v_mfma_f32_16x16x32_bf16 v[48:51], a[168:171], a[72:75], v[48:51]
    v_mfma_f32_16x16x32_bf16 v[76:79], a[168:171], a[76:79], v[76:79]
    ds_read_b128 a[164:167], v13 offset:41984
    s_add_u32 s62, s62, 4096
    s_add_u32 s63, s63, 4096
    s_mov_b32 m0, s62
    buffer_load_dwordx4 v8, s[28:31], s63 offen offset:0 lds
    s_waitcnt lgkmcnt(6)
    v_mfma_f32_16x16x32_bf16 v[52:55], a[172:175], a[72:75], v[52:55]
    v_mfma_f32_16x16x32_bf16 v[80:83], a[172:175], a[76:79], v[80:83]
    ds_read_b128 a[168:171], v13 offset:43008
    s_waitcnt lgkmcnt(6)
    v_mfma_f32_16x16x32_bf16 v[48:51], a[176:179], a[80:83], v[48:51]
    v_mfma_f32_16x16x32_bf16 v[76:79], a[176:179], a[84:87], v[76:79]
    ds_read_b128 a[172:175], v13 offset:44032
    buffer_load_dwordx4 v8, s[28:31], s63 offen offset:1024 lds
    s_waitcnt lgkmcnt(6)
    v_mfma_f32_16x16x32_bf16 v[52:55], a[180:183], a[80:83], v[52:55]
    v_mfma_f32_16x16x32_bf16 v[80:83], a[180:183], a[84:87], v[80:83]
    ds_read_b128 a[176:179], v13 offset:45056
    s_waitcnt lgkmcnt(6)
    v_mfma_f32_16x16x32_bf16 v[48:51], a[184:187], a[88:91], v[48:51]
    v_mfma_f32_16x16x32_bf16 v[76:79], a[184:187], a[92:95], v[76:79]
    ds_read_b128 a[180:183], v13 offset:46080
    buffer_load_dwordx4 v8, s[28:31], s63 offen offset:2048 lds
    s_waitcnt lgkmcnt(6)
    v_mfma_f32_16x16x32_bf16 v[52:55], a[188:191], a[88:91], v[52:55]
    v_mfma_f32_16x16x32_bf16 v[80:83], a[188:191], a[92:95], v[80:83]
    ds_read_b128 a[184:187], v13 offset:47104
    s_waitcnt lgkmcnt(6)
    v_mfma_f32_16x16x32_bf16 v[48:51], a[160:163], a[96:99], v[48:51]
    v_mfma_f32_16x16x32_bf16 v[76:79], a[160:163], a[100:103], v[76:79]
    ds_read_b128 a[188:191], v13 offset:48128
    buffer_load_dwordx4 v8, s[28:31], s63 offen offset:3072 lds
    s_waitcnt lgkmcnt(6)
    v_mfma_f32_16x16x32_bf16 v[52:55], a[164:167], a[96:99], v[52:55]
    v_mfma_f32_16x16x32_bf16 v[80:83], a[164:167], a[100:103], v[80:83]
    ds_read_b128 a[160:163], v13 offset:49152
    s_waitcnt lgkmcnt(6)
    v_mfma_f32_16x16x32_bf16 v[48:51], a[168:171], a[104:107], v[48:51]
    v_mfma_f32_16x16x32_bf16 v[76:79], a[168:171], a[108:111], v[76:79]
    ds_read_b128 a[164:167], v13 offset:50176
    s_add_u32 s62, s62, 4096
    s_add_u32 s63, s63, 4096
    s_mov_b32 m0, s62
    buffer_load_dwordx4 v8, s[28:31], s63 offen offset:0 lds
    s_waitcnt lgkmcnt(6)
    v_mfma_f32_16x16x32_bf16 v[52:55], a[172:175], a[104:107], v[52:55]
    v_mfma_f32_16x16x32_bf16 v[80:83], a[172:175], a[108:111], v[80:83]
    ds_read_b128 a[168:171], v13 offset:51200
    s_waitcnt lgkmcnt(6)
    v_mfma_f32_16x16x32_bf16 v[48:51], a[176:179], a[112:115], v[48:51]
    v_mfma_f32_16x16x32_bf16 v[76:79], a[176:179], a[116:119], v[76:79]
    ds_read_b128 a[172:175], v13 offset:52224
    buffer_load_dwordx4 v8, s[28:31], s63 offen offset:1024 lds
    s_waitcnt lgkmcnt(6)
    v_mfma_f32_16x16x32_bf16 v[52:55], a[180:183], a[112:115], v[52:55]
    v_mfma_f32_16x16x32_bf16 v[80:83], a[180:183], a[116:119], v[80:83]
    ds_read_b128 a[176:179], v13 offset:53248
    s_waitcnt lgkmcnt(6)
    v_mfma_f32_16x16x32_bf16 v[48:51], a[184:187], a[120:123], v[48:51]
    v_mfma_f32_16x16x32_bf16 v[76:79], a[184:187], a[124:127], v[76:79]
    ds_read_b128 a[180:183], v13 offset:54272
    buffer_load_dwordx4 v8, s[28:31], s63 offen offset:2048 lds
    s_waitcnt lgkmcnt(6)
    v_mfma_f32_16x16x32_bf16 v[52:55], a[188:191], a[120:123], v[52:55]
    v_mfma_f32_16x16x32_bf16 v[80:83], a[188:191], a[124:127], v[80:83]
    ds_read_b128 a[184:187], v13 offset:55296
    s_waitcnt lgkmcnt(6)
    v_mfma_f32_16x16x32_bf16 v[48:51], a[160:163], a[128:131], v[48:51]
    v_mfma_f32_16x16x32_bf16 v[76:79], a[160:163], a[132:135], v[76:79]
    ds_read_b128 a[188:191], v13 offset:56320
    buffer_load_dwordx4 v8, s[28:31], s63 offen offset:3072 lds
    s_waitcnt lgkmcnt(6)
    v_mfma_f32_16x16x32_bf16 v[52:55], a[164:167], a[128:131], v[52:55]
    v_mfma_f32_16x16x32_bf16 v[80:83], a[164:167], a[132:135], v[80:83]
    ds_read_b128 a[160:163], v13 offset:57344
    s_waitcnt lgkmcnt(6)
    v_mfma_f32_16x16x32_bf16 v[48:51], a[168:171], a[136:139], v[48:51]
    v_mfma_f32_16x16x32_bf16 v[76:79], a[168:171], a[140:143], v[76:79]
    ds_read_b128 a[164:167], v13 offset:58368
    s_add_u32 s62, s62, 4096
    s_add_u32 s63, s63, 4096
    s_mov_b32 m0, s62
    buffer_load_dwordx4 v8, s[28:31], s63 offen offset:0 lds
    s_waitcnt lgkmcnt(6)
    v_mfma_f32_16x16x32_bf16 v[52:55], a[172:175], a[136:139], v[52:55]
    v_mfma_f32_16x16x32_bf16 v[80:83], a[172:175], a[140:143], v[80:83]
    ds_read_b128 a[168:171], v13 offset:59392
    s_waitcnt lgkmcnt(6)
    v_mfma_f32_16x16x32_bf16 v[48:51], a[176:179], a[144:147], v[48:51]
    v_mfma_f32_16x16x32_bf16 v[76:79], a[176:179], a[148:151], v[76:79]
    ds_read_b128 a[172:175], v13 offset:60416
    buffer_load_dwordx4 v8, s[28:31], s63 offen offset:1024 lds
    s_waitcnt lgkmcnt(6)
    v_mfma_f32_16x16x32_bf16 v[52:55], a[180:183], a[144:147], v[52:55]
    v_mfma_f32_16x16x32_bf16 v[80:83], a[180:183], a[148:151], v[80:83]
    ds_read_b128 a[176:179], v13 offset:61440
    s_waitcnt lgkmcnt(6)
    v_mfma_f32_16x16x32_bf16 v[48:51], a[184:187], a[152:155], v[48:51]
    v_mfma_f32_16x16x32_bf16 v[76:79], a[184:187], a[156:159], v[76:79]
    ds_read_b128 a[180:183], v13 offset:62464
    buffer_load_dwordx4 v8, s[28:31], s63 offen offset:2048 lds
    s_waitcnt lgkmcnt(6)
    v_mfma_f32_16x16x32_bf16 v[52:55], a[188:191], a[152:155], v[52:55]
    v_mfma_f32_16x16x32_bf16 v[80:83], a[188:191], a[156:159], v[80:83]
    ds_read_b128 a[184:187], v13 offset:63488
    s_waitcnt lgkmcnt(6)
    v_mfma_f32_16x16x32_bf16 v[56:59], a[160:163], a[0:3], 0
    v_mfma_f32_16x16x32_bf16 v[84:87], a[160:163], a[4:7], 0
    ds_read_b128 a[188:191], v13 offset:64512
    s_waitcnt lgkmcnt(6)
    v_mfma_f32_16x16x32_bf16 v[56:59], a[164:167], a[8:11], v[56:59]
    v_mfma_f32_16x16x32_bf16 v[84:87], a[164:167], a[12:15], v[84:87]
    ds_read_b128 a[160:163], v14 offset:0
    buffer_load_dwordx4 v8, s[28:31], s63 offen offset:3072 lds
    s_waitcnt lgkmcnt(6)
    v_mfma_f32_16x16x32_bf16 v[56:59], a[168:171], a[16:19], v[56:59]
    v_mfma_f32_16x16x32_bf16 v[84:87], a[168:171], a[20:23], v[84:87]
    ds_read_b128 a[164:167], v14 offset:1024
    s_mul_i32 s25, s20, 3
    s_min_u32 s25, s25, 7
    s_lshl_b32 s25, s25, 10
    s_add_u32 s62, s25, 153600
    s_add_u32 s63, s25, s59
    s_add_u32 s63, s63, 92160
    s_mov_b32 m0, s62
    buffer_load_dwordx4 v8, s[28:31], s63 offen offset:0 lds
    s_waitcnt lgkmcnt(6)
    v_mfma_f32_16x16x32_bf16 v[56:59], a[172:175], a[24:27], v[56:59]
    v_mfma_f32_16x16x32_bf16 v[84:87], a[172:175], a[28:31], v[84:87]
    ds_read_b128 a[168:171], v14 offset:2048
    buffer_load_dwordx4 v8, s[28:31], s63 offen offset:1024 lds
    s_waitcnt lgkmcnt(6)
    v_mfma_f32_16x16x32_bf16 v[56:59], a[176:179], a[32:35], v[56:59]
    v_mfma_f32_16x16x32_bf16 v[84:87], a[176:179], a[36:39], v[84:87]
    ds_read_b128 a[172:175], v14 offset:3072
    buffer_load_dwordx4 v8, s[28:31], s63 offen offset:2048 lds
    s_waitcnt lgkmcnt(6)
    v_mfma_f32_16x16x32_bf16 v[56:59], a[180:183], a[40:43], v[56:59]
    v_mfma_f32_16x16x32_bf16 v[84:87], a[180:183], a[44:47], v[84:87]
    ds_read_b128 a[176:179], v14 offset:4096
    s_waitcnt lgkmcnt(6)
    v_mfma_f32_16x16x32_bf16 v[56:59], a[184:187], a[48:51], v[56:59]
    v_mfma_f32_16x16x32_bf16 v[84:87], a[184:187], a[52:55], v[84:87]
    ds_read_b128 a[180:183], v14 offset:5120
    s_waitcnt lgkmcnt(6)
    v_mfma_f32_16x16x32_bf16 v[56:59], a[188:191], a[56:59], v[56:59]
    v_mfma_f32_16x16x32_bf16 v[84:87], a[188:191], a[60:63], v[84:87]
    ds_read_b128 a[184:187], v14 offset:6144
    s_waitcnt lgkmcnt(6)
    v_mfma_f32_16x16x32_bf16 v[56:59], a[160:163], a[64:67], v[56:59]
    v_mfma_f32_16x16x32_bf16 v[84:87], a[160:163], a[68:71], v[84:87]
    ds_read_b128 a[188:191], v14 offset:7168
    s_waitcnt lgkmcnt(6)
    v_mfma_f32_16x16x32_bf16 v[56:59], a[164:167], a[72:75], v[56:59]
    v_mfma_f32_16x16x32_bf16 v[84:87], a[164:167], a[76:79], v[84:87]
    ds_read_b128 a[160:163], v14 offset:8192
    s_waitcnt lgkmcnt(6)
    v_mfma_f32_16x16x32_bf16 v[56:59], a[168:171], a[80:83], v[56:59]
    v_mfma_f32_16x16x32_bf16 v[84:87], a[168:171], a[84:87], v[84:87]
    ds_read_b128 a[164:167], v14 offset:9216
    s_waitcnt lgkmcnt(6)
    v_mfma_f32_16x16x32_bf16 v[56:59], a[172:175], a[88:91], v[56:59]
    v_mfma_f32_16x16x32_bf16 v[84:87], a[172:175], a[92:95], v[84:87]
    ds_read_b128 a[168:171], v14 offset:10240
    s_waitcnt lgkmcnt(6)
    v_mfma_f32_16x16x32_bf16 v[56:59], a[176:179], a[96:99], v[56:59]
    v_mfma_f32_16x16x32_bf16 v[84:87], a[176:179], a[100:103], v[84:87]
    ds_read_b128 a[172:175], v14 offset:11264
    s_waitcnt lgkmcnt(6)
    v_mfma_f32_16x16x32_bf16 v[56:59], a[180:183], a[104:107], v[56:59]
    v_mfma_f32_16x16x32_bf16 v[84:87], a[180:183], a[108:111], v[84:87]
    s_waitcnt lgkmcnt(5)
    v_mfma_f32_16x16x32_bf16 v[56:59], a[184:187], a[112:115], v[56:59]
    v_mfma_f32_16x16x32_bf16 v[84:87], a[184:187], a[116:119], v[84:87]
    s_waitcnt lgkmcnt(4)
    v_mfma_f32_16x16x32_bf16 v[56:59], a[188:191], a[120:123], v[56:59]
    v_mfma_f32_16x16x32_bf16 v[84:87], a[188:191], a[124:127], v[84:87]
    s_waitcnt lgkmcnt(3)
    v_mfma_f32_16x16x32_bf16 v[56:59], a[160:163], a[128:131], v[56:59]
    v_mfma_f32_16x16x32_bf16 v[84:87], a[160:163], a[132:135], v[84:87]
    s_waitcnt lgkmcnt(2)
    v_mfma_f32_16x16x32_bf16 v[56:59], a[164:167], a[136:139], v[56:59]
    v_mfma_f32_16x16x32_bf16 v[84:87], a[164:167], a[140:143], v[84:87]
    s_waitcnt lgkmcnt(1)
    v_mfma_f32_16x16x32_bf16 v[56:59], a[168:171], a[144:147], v[56:59]
    v_mfma_f32_16x16x32_bf16 v[84:87], a[168:171], a[148:151], v[84:87]
    s_waitcnt lgkmcnt(0)
    v_mfma_f32_16x16x32_bf16 v[56:59], a[172:175], a[152:155], v[56:59]
    v_mfma_f32_16x16x32_bf16 v[84:87], a[172:175], a[156:159], v[84:87]
    s_barrier
    s_waitcnt vmcnt(26)
    v_add_f32 v16, v16, v18
    v_add_f32 v17, v17, v19
    v_add_f32 v20, v20, v22
    v_add_f32 v21, v21, v23
    s_nop 0
    v_mov_b32 v24, v16
    v_mov_b32 v25, v17
    v_mov_b32 v26, v20
    v_mov_b32 v27, v21
    s_nop 1
    v_permlane32_swap_b32 v24, v16
    v_permlane32_swap_b32 v25, v17
    v_permlane32_swap_b32 v26, v20
    v_permlane32_swap_b32 v27, v21
    s_nop 1
    v_add_f32 v16, v16, v24
    v_add_f32 v17, v17, v25
    v_add_f32 v20, v20, v26
    v_add_f32 v21, v21, v27
    v_mov_b32 v24, v16
    v_mov_b32 v25, v17
    v_mov_b32 v26, v20
    v_mov_b32 v27, v21
    s_nop 1
    v_permlane16_swap_b32 v24, v16
    v_permlane16_swap_b32 v25, v17
    v_permlane16_swap_b32 v26, v20
    v_permlane16_swap_b32 v27, v21
    s_nop 1
    v_add_f32 v16, v16, v24
    v_add_f32 v17, v17, v25
    v_add_f32 v20, v20, v26
    v_add_f32 v21, v21, v27
    v_mul_f32 v16, 0x3acccccd, v16
    v_mul_f32 v20, 0x3acccccd, v20
    v_mul_f32 v17, 0x3acccccd, v17
    v_mul_f32 v21, 0x3acccccd, v21
    v_fma_f32 v17, -v16, v16, v17
    v_fma_f32 v21, -v20, v20, v21
    v_max_f32 v17, 0, v17
    v_max_f32 v21, 0, v21
    v_cvt_pk_bf16_f32 v18, v16, v17
    v_cvt_pk_bf16_f32 v22, v20, v21
    v_lshlrev_b32 v16, 16, v18
    v_lshlrev_b32 v20, 16, v22
    v_and_b32 v17, 0xffff0000, v18
    v_and_b32 v21, 0xffff0000, v22
    v_add_f32 v17, 0x3727c5ac, v17
    v_add_f32 v21, 0x3727c5ac, v21
    v_cvt_pk_bf16_f32 v18, v17, v17
    v_cvt_pk_bf16_f32 v22, v21, v21
    v_lshlrev_b32 v17, 16, v18
    v_lshlrev_b32 v21, 16, v22
    v_sqrt_f32 v17, v17
    v_sqrt_f32 v21, v21
    s_nop 0
    s_nop 0
    v_cvt_pk_bf16_f32 v18, v17, v17
    v_cvt_pk_bf16_f32 v22, v21, v21
    v_lshlrev_b32 v17, 16, v18
    v_lshlrev_b32 v21, 16, v22
    v_rcp_f32 v17, v17
    v_rcp_f32 v21, v21
    s_nop 0
    s_nop 0
    v_mul_f32 v16, v16, v17
    v_mul_f32 v20, v20, v21
    v_sub_f32 v16, 0, v16
    v_sub_f32 v20, 0, v20
    v_mov_b32 v30, 0xbdd2d3e8
    v_mov_b32 v31, 0xc0135761
    v_pk_mul_f32 v[176:177], v[88:89], v[16:17] op_sel_hi:[1,0]
    v_pk_mul_f32 v[178:179], v[90:91], v[16:17] op_sel_hi:[1,0]
    v_pk_mul_f32 v[180:181], v[92:93], v[16:17] op_sel_hi:[1,0]
    v_pk_mul_f32 v[182:183], v[94:95], v[16:17] op_sel_hi:[1,0]
    v_pk_mul_f32 v[184:185], v[96:97], v[16:17] op_sel_hi:[1,0]
    v_pk_mul_f32 v[186:187], v[98:99], v[16:17] op_sel_hi:[1,0]
    v_pk_mul_f32 v[188:189], v[100:101], v[16:17] op_sel_hi:[1,0]
    v_pk_mul_f32 v[190:191], v[102:103], v[16:17] op_sel_hi:[1,0]
    v_pk_mul_f32 v[192:193], v[104:105], v[16:17] op_sel_hi:[1,0]
    v_pk_mul_f32 v[194:195], v[106:107], v[16:17] op_sel_hi:[1,0]
    v_pk_mul_f32 v[196:197], v[108:109], v[16:17] op_sel_hi:[1,0]
    v_pk_mul_f32 v[198:199], v[110:111], v[16:17] op_sel_hi:[1,0]
    v_pk_mul_f32 v[200:201], v[112:113], v[16:17] op_sel_hi:[1,0]
    v_pk_mul_f32 v[202:203], v[114:115], v[16:17] op_sel_hi:[1,0]
    v_pk_fma_f32 v[32:33], v[32:33], v[16:17], v[176:177] op_sel:[0,1,0] op_sel_hi:[1,1,1]
    v_pk_fma_f32 v[34:35], v[34:35], v[16:17], v[178:179] op_sel:[0,1,0] op_sel_hi:[1,1,1]
    v_pk_fma_f32 v[36:37], v[36:37], v[16:17], v[180:181] op_sel:[0,1,0] op_sel_hi:[1,1,1]
    v_pk_fma_f32 v[38:39], v[38:39], v[16:17], v[182:183] op_sel:[0,1,0] op_sel_hi:[1,1,1]
    v_pk_fma_f32 v[40:41], v[40:41], v[16:17], v[184:185] op_sel:[0,1,0] op_sel_hi:[1,1,1]
    v_pk_fma_f32 v[42:43], v[42:43], v[16:17], v[186:187] op_sel:[0,1,0] op_sel_hi:[1,1,1]
    v_pk_fma_f32 v[44:45], v[44:45], v[16:17], v[188:189] op_sel:[0,1,0] op_sel_hi:[1,1,1]
    v_pk_fma_f32 v[46:47], v[46:47], v[16:17], v[190:191] op_sel:[0,1,0] op_sel_hi:[1,1,1]
    v_pk_fma_f32 v[48:49], v[48:49], v[16:17], v[192:193] op_sel:[0,1,0] op_sel_hi:[1,1,1]
    v_pk_fma_f32 v[50:51], v[50:51], v[16:17], v[194:195] op_sel:[0,1,0] op_sel_hi:[1,1,1]
    v_pk_fma_f32 v[52:53], v[52:53], v[16:17], v[196:197] op_sel:[0,1,0] op_sel_hi:[1,1,1]
    v_pk_fma_f32 v[54:55], v[54:55], v[16:17], v[198:199] op_sel:[0,1,0] op_sel_hi:[1,1,1]
    v_pk_fma_f32 v[56:57], v[56:57], v[16:17], v[200:201] op_sel:[0,1,0] op_sel_hi:[1,1,1]
    v_pk_fma_f32 v[58:59], v[58:59], v[16:17], v[202:203] op_sel:[0,1,0] op_sel_hi:[1,1,1]
    v_pk_mul_f32 v[176:177], v[32:33], v[32:33]
    v_pk_mul_f32 v[178:179], v[34:35], v[34:35]
    v_pk_mul_f32 v[180:181], v[36:37], v[36:37]
    v_pk_mul_f32 v[182:183], v[38:39], v[38:39]
    v_pk_mul_f32 v[184:185], v[40:41], v[40:41]
    v_pk_mul_f32 v[186:187], v[42:43], v[42:43]
    s_mul_i32 s25, s20, 15
    s_lshl_b32 s25, s25, 10
    s_add_u32 s62, s25, 81920
    s_add_u32 s63, s25, s59
    s_add_u32 s63, s63, 102400
    s_mov_b32 m0, s62
    buffer_load_dwordx4 v8, s[28:31], s63 offen offset:0 lds
    v_pk_mul_f32 v[188:189], v[44:45], v[44:45]
    v_pk_mul_f32 v[190:191], v[46:47], v[46:47]
    v_pk_mul_f32 v[192:193], v[48:49], v[48:49]
    v_pk_mul_f32 v[194:195], v[50:51], v[50:51]
    v_pk_mul_f32 v[196:197], v[52:53], v[52:53]
    v_pk_mul_f32 v[198:199], v[54:55], v[54:55]
    v_pk_mul_f32 v[200:201], v[56:57], v[56:57]
    v_pk_mul_f32 v[202:203], v[58:59], v[58:59]
    v_pk_fma_f32 v[176:177], v[176:177], v[30:31], v[30:31] op_sel:[0,0,1] op_sel_hi:[1,0,1]
    v_pk_fma_f32 v[178:179], v[178:179], v[30:31], v[30:31] op_sel:[0,0,1] op_sel_hi:[1,0,1]
    v_pk_fma_f32 v[180:181], v[180:181], v[30:31], v[30:31] op_sel:[0,0,1] op_sel_hi:[1,0,1]
    v_pk_fma_f32 v[182:183], v[182:183], v[30:31], v[30:31] op_sel:[0,0,1] op_sel_hi:[1,0,1]
    buffer_load_dwordx4 v8, s[28:31], s63 offen offset:1024 lds
    v_pk_fma_f32 v[184:185], v[184:185], v[30:31], v[30:31] op_sel:[0,0,1] op_sel_hi:[1,0,1]
    v_pk_fma_f32 v[186:187], v[186:187], v[30:31], v[30:31] op_sel:[0,0,1] op_sel_hi:[1,0,1]
    v_pk_fma_f32 v[188:189], v[188:189], v[30:31], v[30:31] op_sel:[0,0,1] op_sel_hi:[1,0,1]
    v_pk_fma_f32 v[190:191], v[190:191], v[30:31], v[30:31] op_sel:[0,0,1] op_sel_hi:[1,0,1]
    v_pk_fma_f32 v[192:193], v[192:193], v[30:31], v[30:31] op_sel:[0,0,1] op_sel_hi:[1,0,1]
    v_pk_fma_f32 v[194:195], v[194:195], v[30:31], v[30:31] op_sel:[0,0,1] op_sel_hi:[1,0,1]
    v_pk_fma_f32 v[196:197], v[196:197], v[30:31], v[30:31] op_sel:[0,0,1] op_sel_hi:[1,0,1]
    v_pk_fma_f32 v[198:199], v[198:199], v[30:31], v[30:31] op_sel:[0,0,1] op_sel_hi:[1,0,1]
    v_pk_fma_f32 v[200:201], v[200:201], v[30:31], v[30:31] op_sel:[0,0,1] op_sel_hi:[1,0,1]
    v_pk_fma_f32 v[202:203], v[202:203], v[30:31], v[30:31] op_sel:[0,0,1] op_sel_hi:[1,0,1]
    v_pk_mul_f32 v[176:177], v[176:177], v[32:33]
    v_pk_mul_f32 v[178:179], v[178:179], v[34:35]
    buffer_load_dwordx4 v8, s[28:31], s63 offen offset:2048 lds
    v_pk_mul_f32 v[180:181], v[180:181], v[36:37]
    v_pk_mul_f32 v[182:183], v[182:183], v[38:39]
    v_pk_mul_f32 v[184:185], v[184:185], v[40:41]
    v_pk_mul_f32 v[186:187], v[186:187], v[42:43]
    v_pk_mul_f32 v[188:189], v[188:189], v[44:45]
    v_pk_mul_f32 v[190:191], v[190:191], v[46:47]
    v_pk_mul_f32 v[192:193], v[192:193], v[48:49]
    v_pk_mul_f32 v[194:195], v[194:195], v[50:51]
    v_pk_mul_f32 v[196:197], v[196:197], v[52:53]
    v_pk_mul_f32 v[198:199], v[198:199], v[54:55]
    v_pk_mul_f32 v[200:201], v[200:201], v[56:57]
    v_pk_mul_f32 v[202:203], v[202:203], v[58:59]
    buffer_load_dwordx4 v8, s[28:31], s63 offen offset:3072 lds
    v_exp_f32 v176, v176
    v_exp_f32 v177, v177
    v_exp_f32 v178, v178
    v_exp_f32 v179, v179
    v_exp_f32 v180, v180
    v_exp_f32 v181, v181
    v_exp_f32 v182, v182
    v_exp_f32 v183, v183
    v_exp_f32 v184, v184
    v_exp_f32 v185, v185
    v_exp_f32 v186, v186
    v_exp_f32 v187, v187
    s_add_u32 s62, s62, 4096
    s_add_u32 s63, s63, 4096
    s_mov_b32 m0, s62
    buffer_load_dwordx4 v8, s[28:31], s63 offen offset:0 lds
    v_exp_f32 v188, v188
    v_exp_f32 v189, v189
    v_exp_f32 v190, v190
    v_exp_f32 v191, v191
    v_exp_f32 v192, v192
    v_exp_f32 v193, v193
    v_exp_f32 v194, v194
    v_exp_f32 v195, v195
    v_exp_f32 v196, v196
    v_exp_f32 v197, v197
    v_exp_f32 v198, v198
    v_exp_f32 v199, v199
    buffer_load_dwordx4 v8, s[28:31], s63 offen offset:1024 lds
    v_exp_f32 v200, v200
    v_exp_f32 v201, v201
    v_exp_f32 v202, v202
    v_exp_f32 v203, v203
    v_pk_add_f32 v[176:177], v[176:177], 1.0 op_sel_hi:[1,0]
    v_pk_add_f32 v[178:179], v[178:179], 1.0 op_sel_hi:[1,0]
    v_pk_add_f32 v[180:181], v[180:181], 1.0 op_sel_hi:[1,0]
    v_pk_add_f32 v[182:183], v[182:183], 1.0 op_sel_hi:[1,0]
    v_pk_add_f32 v[184:185], v[184:185], 1.0 op_sel_hi:[1,0]
    v_pk_add_f32 v[186:187], v[186:187], 1.0 op_sel_hi:[1,0]
    v_pk_add_f32 v[188:189], v[188:189], 1.0 op_sel_hi:[1,0]
    v_pk_add_f32 v[190:191], v[190:191], 1.0 op_sel_hi:[1,0]
    buffer_load_dwordx4 v8, s[28:31], s63 offen offset:2048 lds
    v_pk_add_f32 v[192:193], v[192:193], 1.0 op_sel_hi:[1,0]
    v_pk_add_f32 v[194:195], v[194:195], 1.0 op_sel_hi:[1,0]
    v_pk_add_f32 v[196:197], v[196:197], 1.0 op_sel_hi:[1,0]
    v_pk_add_f32 v[198:199], v[198:199], 1.0 op_sel_hi:[1,0]
    v_pk_add_f32 v[200:201], v[200:201], 1.0 op_sel_hi:[1,0]
    v_pk_add_f32 v[202:203], v[202:203], 1.0 op_sel_hi:[1,0]
    v_rcp_f32 v176, v176
    v_rcp_f32 v177, v177
    v_rcp_f32 v178, v178
    v_rcp_f32 v179, v179
    v_rcp_f32 v180, v180
    v_rcp_f32 v181, v181
    buffer_load_dwordx4 v8, s[28:31], s63 offen offset:3072 lds
    v_rcp_f32 v182, v182
    v_rcp_f32 v183, v183
    v_rcp_f32 v184, v184
    v_rcp_f32 v185, v185
    v_rcp_f32 v186, v186
    v_rcp_f32 v187, v187
    v_rcp_f32 v188, v188
    v_rcp_f32 v189, v189
    v_rcp_f32 v190, v190
    v_rcp_f32 v191, v191
    v_rcp_f32 v192, v192
    v_rcp_f32 v193, v193
    s_add_u32 s62, s62, 4096
    s_add_u32 s63, s63, 4096
    s_mov_b32 m0, s62
    buffer_load_dwordx4 v8, s[28:31], s63 offen offset:0 lds
    v_rcp_f32 v194, v194
    v_rcp_f32 v195, v195
    v_rcp_f32 v196, v196
    v_rcp_f32 v197, v197
    v_rcp_f32 v198, v198
    v_rcp_f32 v199, v199
    v_rcp_f32 v200, v200
    v_rcp_f32 v201, v201
    v_rcp_f32 v202, v202
    v_rcp_f32 v203, v203
    v_pk_mul_f32 v[32:33], v[32:33], v[176:177]
    v_pk_mul_f32 v[34:35], v[34:35], v[178:179]
    buffer_load_dwordx4 v8, s[28:31], s63 offen offset:1024 lds
    v_pk_mul_f32 v[36:37], v[36:37], v[180:181]
    v_pk_mul_f32 v[38:39], v[38:39], v[182:183]
    v_pk_mul_f32 v[40:41], v[40:41], v[184:185]
    v_pk_mul_f32 v[42:43], v[42:43], v[186:187]
    v_pk_mul_f32 v[44:45], v[44:45], v[188:189]
    v_pk_mul_f32 v[46:47], v[46:47], v[190:191]
    v_pk_mul_f32 v[48:49], v[48:49], v[192:193]
    v_pk_mul_f32 v[50:51], v[50:51], v[194:195]
    v_pk_mul_f32 v[52:53], v[52:53], v[196:197]
    v_pk_mul_f32 v[54:55], v[54:55], v[198:199]
    v_pk_mul_f32 v[56:57], v[56:57], v[200:201]
    v_pk_mul_f32 v[58:59], v[58:59], v[202:203]
    buffer_load_dwordx4 v8, s[28:31], s63 offen offset:2048 lds
    v_cvt_pk_bf16_f32 v144, v32, v33
    v_cvt_pk_bf16_f32 v145, v34, v35
    v_cvt_pk_bf16_f32 v146, v36, v37
    v_cvt_pk_bf16_f32 v147, v38, v39
    v_cvt_pk_bf16_f32 v148, v40, v41
    v_cvt_pk_bf16_f32 v149, v42, v43
    v_cvt_pk_bf16_f32 v150, v44, v45
    v_cvt_pk_bf16_f32 v151, v46, v47
    v_cvt_pk_bf16_f32 v152, v48, v49
    v_cvt_pk_bf16_f32 v153, v50, v51
    v_cvt_pk_bf16_f32 v154, v52, v53
    v_cvt_pk_bf16_f32 v155, v54, v55
    v_cvt_pk_bf16_f32 v156, v56, v57
    v_cvt_pk_bf16_f32 v157, v58, v59
    s_nop 1
    v_permlane16_swap_b32 v144, v146
    v_permlane16_swap_b32 v145, v147
    v_permlane16_swap_b32 v148, v150
    v_permlane16_swap_b32 v149, v151
    v_permlane16_swap_b32 v152, v154
    v_permlane16_swap_b32 v153, v155
    s_add_u32 s26, s13, 0
    s_add_u32 s27, s12, 0
    buffer_store_dwordx4 v[144:147], v226, s[28:31], s26 offen sc1
    buffer_store_dwordx2 v[156:157], v227, s[28:31], s27 offen sc1
    s_cmp_eq_u32 s52, 15
    s_cbranch_scc1 chain_kernel_j157
    buffer_store_dwordx4 v[148:151], v226, s[28:31], s26 offen offset:1024 sc1
    buffer_store_dwordx4 v[152:155], v226, s[28:31], s26 offen offset:2048 sc1
chain_kernel_j157:
    v_pk_mul_f32 v[176:177], v[88:89], v[20:21] op_sel_hi:[1,0]
    v_pk_mul_f32 v[178:179], v[90:91], v[20:21] op_sel_hi:[1,0]
    v_pk_mul_f32 v[180:181], v[92:93], v[20:21] op_sel_hi:[1,0]
    v_pk_mul_f32 v[182:183], v[94:95], v[20:21] op_sel_hi:[1,0]
    v_pk_mul_f32 v[184:185], v[96:97], v[20:21] op_sel_hi:[1,0]
    v_pk_mul_f32 v[186:187], v[98:99], v[20:21] op_sel_hi:[1,0]
    v_pk_mul_f32 v[188:189], v[100:101], v[20:21] op_sel_hi:[1,0]
    v_pk_mul_f32 v[190:191], v[102:103], v[20:21] op_sel_hi:[1,0]
    v_pk_mul_f32 v[192:193], v[104:105], v[20:21] op_sel_hi:[1,0]
    v_pk_mul_f32 v[194:195], v[106:107], v[20:21] op_sel_hi:[1,0]
    v_pk_mul_f32 v[196:197], v[108:109], v[20:21] op_sel_hi:[1,0]
    v_pk_mul_f32 v[198:199], v[110:111], v[20:21] op_sel_hi:[1,0]
    v_pk_mul_f32 v[200:201], v[112:113], v[20:21] op_sel_hi:[1,0]
    v_pk_mul_f32 v[202:203], v[114:115], v[20:21] op_sel_hi:[1,0]
    v_pk_fma_f32 v[60:61], v[60:61], v[20:21], v[176:177] op_sel:[0,1,0] op_sel_hi:[1,1,1]
    v_pk_fma_f32 v[62:63], v[62:63], v[20:21], v[178:179] op_sel:[0,1,0] op_sel_hi:[1,1,1]
    v_pk_fma_f32 v[64:65], v[64:65], v[20:21], v[180:181] op_sel:[0,1,0] op_sel_hi:[1,1,1]
    v_pk_fma_f32 v[66:67], v[66:67], v[20:21], v[182:183] op_sel:[0,1,0] op_sel_hi:[1,1,1]
    v_pk_fma_f32 v[68:69], v[68:69], v[20:21], v[184:185] op_sel:[0,1,0] op_sel_hi:[1,1,1]
    v_pk_fma_f32 v[70:71], v[70:71], v[20:21], v[186:187] op_sel:[0,1,0] op_sel_hi:[1,1,1]
    v_pk_fma_f32 v[72:73], v[72:73], v[20:21], v[188:189] op_sel:[0,1,0] op_sel_hi:[1,1,1]
    v_pk_fma_f32 v[74:75], v[74:75], v[20:21], v[190:191] op_sel:[0,1,0] op_sel_hi:[1,1,1]
    v_pk_fma_f32 v[76:77], v[76:77], v[20:21], v[192:193] op_sel:[0,1,0] op_sel_hi:[1,1,1]
    v_pk_fma_f32 v[78:79], v[78:79], v[20:21], v[194:195] op_sel:[0,1,0] op_sel_hi:[1,1,1]
    v_pk_fma_f32 v[80:81], v[80:81], v[20:21], v[196:197] op_sel:[0,1,0] op_sel_hi:[1,1,1]
    v_pk_fma_f32 v[82:83], v[82:83], v[20:21], v[198:199] op_sel:[0,1,0] op_sel_hi:[1,1,1]
    v_pk_fma_f32 v[84:85], v[84:85], v[20:21], v[200:201] op_sel:[0,1,0] op_sel_hi:[1,1,1]
    v_pk_fma_f32 v[86:87], v[86:87], v[20:21], v[202:203] op_sel:[0,1,0] op_sel_hi:[1,1,1]
    v_pk_mul_f32 v[176:177], v[60:61], v[60:61]
    v_pk_mul_f32 v[178:179], v[62:63], v[62:63]
    v_pk_mul_f32 v[180:181], v[64:65], v[64:65]
    v_pk_mul_f32 v[182:183], v[66:67], v[66:67]
    v_pk_mul_f32 v[184:185], v[68:69], v[68:69]
    v_pk_mul_f32 v[186:187], v[70:71], v[70:71]
    buffer_load_dwordx4 v8, s[28:31], s63 offen offset:3072 lds
    v_pk_mul_f32 v[188:189], v[72:73], v[72:73]
    v_pk_mul_f32 v[190:191], v[74:75], v[74:75]
    v_pk_mul_f32 v[192:193], v[76:77], v[76:77]
    v_pk_mul_f32 v[194:195], v[78:79], v[78:79]
    v_pk_mul_f32 v[196:197], v[80:81], v[80:81]
    v_pk_mul_f32 v[198:199], v[82:83], v[82:83]
    v_pk_mul_f32 v[200:201], v[84:85], v[84:85]
    v_pk_mul_f32 v[202:203], v[86:87], v[86:87]
    v_pk_fma_f32 v[176:177], v[176:177], v[30:31], v[30:31] op_sel:[0,0,1] op_sel_hi:[1,0,1]
    v_pk_fma_f32 v[178:179], v[178:179], v[30:31], v[30:31] op_sel:[0,0,1] op_sel_hi:[1,0,1]
    v_pk_fma_f32 v[180:181], v[180:181], v[30:31], v[30:31] op_sel:[0,0,1] op_sel_hi:[1,0,1]
    v_pk_fma_f32 v[182:183], v[182:183], v[30:31], v[30:31] op_sel:[0,0,1] op_sel_hi:[1,0,1]
    s_add_u32 s62, s62, 4096
    s_add_u32 s63, s63, 4096
    s_mov_b32 m0, s62
    buffer_load_dwordx4 v8, s[28:31], s63 offen offset:0 lds
    v_pk_fma_f32 v[184:185], v[184:185], v[30:31], v[30:31] op_sel:[0,0,1] op_sel_hi:[1,0,1]
    v_pk_fma_f32 v[186:187], v[186:187], v[30:31], v[30:31] op_sel:[0,0,1] op_sel_hi:[1,0,1]
    v_pk_fma_f32 v[188:189], v[188:189], v[30:31], v[30:31] op_sel:[0,0,1] op_sel_hi:[1,0,1]
    v_pk_fma_f32 v[190:191], v[190:191], v[30:31], v[30:31] op_sel:[0,0,1] op_sel_hi:[1,0,1]
    v_pk_fma_f32 v[192:193], v[192:193], v[30:31], v[30:31] op_sel:[0,0,1] op_sel_hi:[1,0,1]
    v_pk_fma_f32 v[194:195], v[194:195], v[30:31], v[30:31] op_sel:[0,0,1] op_sel_hi:[1,0,1]
    v_pk_fma_f32 v[196:197], v[196:197], v[30:31], v[30:31] op_sel:[0,0,1] op_sel_hi:[1,0,1]
    v_pk_fma_f32 v[198:199], v[198:199], v[30:31], v[30:31] op_sel:[0,0,1] op_sel_hi:[1,0,1]
    v_pk_fma_f32 v[200:201], v[200:201], v[30:31], v[30:31] op_sel:[0,0,1] op_sel_hi:[1,0,1]
    v_pk_fma_f32 v[202:203], v[202:203], v[30:31], v[30:31] op_sel:[0,0,1] op_sel_hi:[1,0,1]
    v_pk_mul_f32 v[176:177], v[176:177], v[60:61]
    v_pk_mul_f32 v[178:179], v[178:179], v[62:63]
    buffer_load_dwordx4 v8, s[28:31], s63 offen offset:1024 lds
    v_pk_mul_f32 v[180:181], v[180:181], v[64:65]
    v_pk_mul_f32 v[182:183], v[182:183], v[66:67]
    v_pk_mul_f32 v[184:185], v[184:185], v[68:69]
    v_pk_mul_f32 v[186:187], v[186:187], v[70:71]
    v_pk_mul_f32 v[188:189], v[188:189], v[72:73]
    v_pk_mul_f32 v[190:191], v[190:191], v[74:75]
    v_pk_mul_f32 v[192:193], v[192:193], v[76:77]
    v_pk_mul_f32 v[194:195], v[194:195], v[78:79]
    v_pk_mul_f32 v[196:197], v[196:197], v[80:81]
    v_pk_mul_f32 v[198:199], v[198:199], v[82:83]
    v_pk_mul_f32 v[200:201], v[200:201], v[84:85]
    v_pk_mul_f32 v[202:203], v[202:203], v[86:87]
    buffer_load_dwordx4 v8, s[28:31], s63 offen offset:2048 lds
    v_exp_f32 v176, v176
    v_exp_f32 v177, v177
    v_exp_f32 v178, v178
    v_exp_f32 v179, v179
    v_exp_f32 v180, v180
    v_exp_f32 v181, v181
    v_exp_f32 v182, v182
    v_exp_f32 v183, v183
    v_exp_f32 v184, v184
    v_exp_f32 v185, v185
    v_exp_f32 v186, v186
    v_exp_f32 v187, v187
    v_exp_f32 v188, v188
    v_exp_f32 v189, v189
    v_exp_f32 v190, v190
    v_exp_f32 v191, v191
    v_exp_f32 v192, v192
    v_exp_f32 v193, v193
    v_exp_f32 v194, v194
    v_exp_f32 v195, v195
    v_exp_f32 v196, v196
    v_exp_f32 v197, v197
    v_exp_f32 v198, v198
    v_exp_f32 v199, v199
    v_exp_f32 v200, v200
    v_exp_f32 v201, v201
    v_exp_f32 v202, v202
    v_exp_f32 v203, v203
    v_pk_add_f32 v[176:177], v[176:177], 1.0 op_sel_hi:[1,0]
    v_pk_add_f32 v[178:179], v[178:179], 1.0 op_sel_hi:[1,0]
    v_pk_add_f32 v[180:181], v[180:181], 1.0 op_sel_hi:[1,0]
    v_pk_add_f32 v[182:183], v[182:183], 1.0 op_sel_hi:[1,0]
    v_pk_add_f32 v[184:185], v[184:185], 1.0 op_sel_hi:[1,0]
    v_pk_add_f32 v[186:187], v[186:187], 1.0 op_sel_hi:[1,0]
    v_pk_add_f32 v[188:189], v[188:189], 1.0 op_sel_hi:[1,0]
    v_pk_add_f32 v[190:191], v[190:191], 1.0 op_sel_hi:[1,0]
    v_pk_add_f32 v[192:193], v[192:193], 1.0 op_sel_hi:[1,0]
    v_pk_add_f32 v[194:195], v[194:195], 1.0 op_sel_hi:[1,0]
    v_pk_add_f32 v[196:197], v[196:197], 1.0 op_sel_hi:[1,0]
    v_pk_add_f32 v[198:199], v[198:199], 1.0 op_sel_hi:[1,0]
    v_pk_add_f32 v[200:201], v[200:201], 1.0 op_sel_hi:[1,0]
    v_pk_add_f32 v[202:203], v[202:203], 1.0 op_sel_hi:[1,0]
    v_rcp_f32 v176, v176
    v_rcp_f32 v177, v177
    v_rcp_f32 v178, v178
    v_rcp_f32 v179, v179
    v_rcp_f32 v180, v180
    v_rcp_f32 v181, v181
    v_rcp_f32 v182, v182
    v_rcp_f32 v183, v183
    v_rcp_f32 v184, v184
    v_rcp_f32 v185, v185
    v_rcp_f32 v186, v186
    v_rcp_f32 v187, v187
    v_rcp_f32 v188, v188
    v_rcp_f32 v189, v189
    v_rcp_f32 v190, v190
    v_rcp_f32 v191, v191
    v_rcp_f32 v192, v192
    v_rcp_f32 v193, v193
    v_rcp_f32 v194, v194
    v_rcp_f32 v195, v195
    v_rcp_f32 v196, v196
    v_rcp_f32 v197, v197
    v_rcp_f32 v198, v198
    v_rcp_f32 v199, v199
    v_rcp_f32 v200, v200
    v_rcp_f32 v201, v201
    v_rcp_f32 v202, v202
    v_rcp_f32 v203, v203
    v_pk_mul_f32 v[60:61], v[60:61], v[176:177]
    v_pk_mul_f32 v[62:63], v[62:63], v[178:179]
    v_pk_mul_f32 v[64:65], v[64:65], v[180:181]
    v_pk_mul_f32 v[66:67], v[66:67], v[182:183]
    v_pk_mul_f32 v[68:69], v[68:69], v[184:185]
    v_pk_mul_f32 v[70:71], v[70:71], v[186:187]
    v_pk_mul_f32 v[72:73], v[72:73], v[188:189]
    v_pk_mul_f32 v[74:75], v[74:75], v[190:191]
    v_pk_mul_f32 v[76:77], v[76:77], v[192:193]
    v_pk_mul_f32 v[78:79], v[78:79], v[194:195]
    v_pk_mul_f32 v[80:81], v[80:81], v[196:197]
    v_pk_mul_f32 v[82:83], v[82:83], v[198:199]
    v_pk_mul_f32 v[84:85], v[84:85], v[200:201]
    v_pk_mul_f32 v[86:87], v[86:87], v[202:203]
    v_cvt_pk_bf16_f32 v160, v60, v61
    v_cvt_pk_bf16_f32 v161, v62, v63
    v_cvt_pk_bf16_f32 v162, v64, v65
    v_cvt_pk_bf16_f32 v163, v66, v67
    v_cvt_pk_bf16_f32 v164, v68, v69
    v_cvt_pk_bf16_f32 v165, v70, v71
    v_cvt_pk_bf16_f32 v166, v72, v73
    v_cvt_pk_bf16_f32 v167, v74, v75
    v_cvt_pk_bf16_f32 v168, v76, v77
    v_cvt_pk_bf16_f32 v169, v78, v79
    v_cvt_pk_bf16_f32 v170, v80, v81
    v_cvt_pk_bf16_f32 v171, v82, v83
    v_cvt_pk_bf16_f32 v172, v84, v85
    v_cvt_pk_bf16_f32 v173, v86, v87
    s_nop 1
    v_permlane16_swap_b32 v160, v162
    v_permlane16_swap_b32 v161, v163
    v_permlane16_swap_b32 v164, v166
    v_permlane16_swap_b32 v165, v167
    v_permlane16_swap_b32 v168, v170
    v_permlane16_swap_b32 v169, v171
    s_add_u32 s26, s13, 55296
    s_add_u32 s27, s12, 55296
    buffer_store_dwordx4 v[160:163], v226, s[28:31], s26 offen sc1
    buffer_store_dwordx2 v[172:173], v227, s[28:31], s27 offen sc1
    s_cmp_eq_u32 s52, 15
    s_cbranch_scc1 chain_kernel_j158
    buffer_store_dwordx4 v[164:167], v226, s[28:31], s26 offen offset:1024 sc1
    buffer_store_dwordx4 v[168:171], v226, s[28:31], s26 offen offset:2048 sc1
chain_kernel_j158:
    s_waitcnt vmcnt(0)
    v_mov_b32 v2, 1
    v_mov_b32 v7, 0
    s_mov_b64 exec, 1
    buffer_store_dword v2, v7, s[28:31], s15 offen sc1
    s_mov_b64 exec, -1
    s_mov_b32 s47, 0
    s_mov_b64 exec, 511
chain_kernel_poll9:
    buffer_load_dword v2, v234, s[28:31], s48 offen sc1
    s_add_u32 s47, s47, 1
    s_waitcnt vmcnt(0)
    v_cmp_ne_u32 vcc, 1, v2
    s_cmp_ge_u32 s47, 20000
    s_cbranch_scc1 chain_kernel_polld10
    s_cbranch_vccnz chain_kernel_poll9
chain_kernel_polld10:
    s_mov_b64 exec, -1
    buffer_load_dwordx4 a[0:3], v8, s[28:31], s50 offen offset:0 sc1
    buffer_load_dwordx4 a[4:7], v8, s[28:31], s51 offen offset:0 sc1
    buffer_load_dwordx4 a[8:11], v8, s[28:31], s50 offen offset:1024 sc1
    buffer_load_dwordx4 a[12:15], v8, s[28:31], s51 offen offset:1024 sc1
    buffer_load_dwordx4 a[16:19], v8, s[28:31], s50 offen offset:2048 sc1
    buffer_load_dwordx4 a[20:23], v8, s[28:31], s51 offen offset:2048 sc1
    buffer_load_dwordx4 a[24:27], v8, s[28:31], s50 offen offset:3072 sc1
    buffer_load_dwordx4 a[28:31], v8, s[28:31], s51 offen offset:3072 sc1
    s_add_u32 s50, s50, 4096
    s_add_u32 s51, s51, 4096
    buffer_load_dwordx4 a[32:35], v8, s[28:31], s50 offen offset:0 sc1
    buffer_load_dwordx4 a[36:39], v8, s[28:31], s51 offen offset:0 sc1
    s_barrier
    s_mul_i32 s26, s22, 5120
    v_add_u32 v12, s26, v8
    v_add_u32 v13, 0x10000, v12
    v_add_u32 v14, 0x20000, v12
    ds_read_b128 a[216:219], v14 offset:12288
    ds_read_b128 a[220:223], v14 offset:13312
    ds_read_b128 a[224:227], v14 offset:14336
    ds_read_b128 a[228:231], v14 offset:15360
    ds_read_b128 a[232:235], v14 offset:16384
    ds_read_b128 a[236:239], v12 offset:0
    ds_read_b128 a[240:243], v12 offset:1024
    s_waitcnt vmcnt(8) lgkmcnt(6)
    v_mfma_f32_16x16x32_bf16 v[32:35], a[216:219], a[0:3], 0
    v_mfma_f32_16x16x32_bf16 v[52:55], a[216:219], a[4:7], 0
    ds_read_b128 a[244:247], v12 offset:2048
    buffer_load_dwordx4 a[40:43], v8, s[28:31], s50 offen offset:1024 sc1
    s_waitcnt lgkmcnt(6)
    v_mfma_f32_16x16x32_bf16 v[36:39], a[220:223], a[0:3], 0
    v_mfma_f32_16x16x32_bf16 v[56:59], a[220:223], a[4:7], 0
    ds_read_b128 a[216:219], v12 offset:3072
    buffer_load_dwordx4 a[44:47], v8, s[28:31], s51 offen offset:1024 sc1
    s_waitcnt lgkmcnt(6)
    v_mfma_f32_16x16x32_bf16 v[40:43], a[224:227], a[0:3], 0
    v_mfma_f32_16x16x32_bf16 v[60:63], a[224:227], a[4:7], 0
    ds_read_b128 a[220:223], v12 offset:4096
    buffer_load_dwordx4 a[48:51], v8, s[28:31], s50 offen offset:2048 sc1
    s_waitcnt lgkmcnt(6)
    v_mfma_f32_16x16x32_bf16 v[44:47], a[228:231], a[0:3], 0
    v_mfma_f32_16x16x32_bf16 v[64:67], a[228:231], a[4:7], 0
    ds_read_b128 a[224:227], v12 offset:10240
    buffer_load_dwordx4 a[52:55], v8, s[28:31], s51 offen offset:2048 sc1
    s_waitcnt lgkmcnt(6)
    v_mfma_f32_16x16x32_bf16 v[48:51], a[232:235], a[0:3], 0
    v_mfma_f32_16x16x32_bf16 v[68:71], a[232:235], a[4:7], 0
    ds_read_b128 a[228:231], v12 offset:11264
    buffer_load_dwordx4 a[56:59], v8, s[28:31], s50 offen offset:3072 sc1
    s_waitcnt vmcnt(11) lgkmcnt(6)
    v_mfma_f32_16x16x32_bf16 v[32:35], a[236:239], a[8:11], v[32:35]
    v_mfma_f32_16x16x32_bf16 v[52:55], a[236:239], a[12:15], v[52:55]
    ds_read_b128 a[232:235], v12 offset:12288
    buffer_load_dwordx4 a[60:63], v8, s[28:31], s51 offen offset:3072 sc1
    s_waitcnt lgkmcnt(6)
    v_mfma_f32_16x16x32_bf16 v[36:39], a[240:243], a[8:11], v[36:39]
    v_mfma_f32_16x16x32_bf16 v[56:59], a[240:243], a[12:15], v[56:59]
    ds_read_b128 a[236:239], v12 offset:13312
    s_add_u32 s50, s50, 4096
    s_add_u32 s51, s51, 4096
    buffer_load_dwordx4 a[64:67], v8, s[28:31], s50 offen offset:0 sc1
    s_waitcnt lgkmcnt(6)
    v_mfma_f32_16x16x32_bf16 v[40:43], a[244:247], a[8:11], v[40:43]
    v_mfma_f32_16x16x32_bf16 v[60:63], a[244:247], a[12:15], v[60:63]
    ds_read_b128 a[240:243], v12 offset:14336
    buffer_load_dwordx4 a[68:71], v8, s[28:31], s51 offen offset:0 sc1
    s_waitcnt lgkmcnt(6)
    v_mfma_f32_16x16x32_bf16 v[44:47], a[216:219], a[8:11], v[44:47]
    v_mfma_f32_16x16x32_bf16 v[64:67], a[216:219], a[12:15], v[64:67]
    ds_read_b128 a[244:247], v12 offset:20480
    buffer_load_dwordx4 a[72:75], v8, s[28:31], s50 offen offset:1024 sc1
    s_waitcnt lgkmcnt(6)
    v_mfma_f32_16x16x32_bf16 v[48:51], a[220:223], a[8:11], v[48:51]
    v_mfma_f32_16x16x32_bf16 v[68:71], a[220:223], a[12:15], v[68:71]
    ds_read_b128 a[216:219], v12 offset:21504
    buffer_load_dwordx4 a[76:79], v8, s[28:31], s51 offen offset:1024 sc1
    s_waitcnt vmcnt(14) lgkmcnt(6)
    v_mfma_f32_16x16x32_bf16 v[32:35], a[224:227], a[16:19], v[32:35]
    v_mfma_f32_16x16x32_bf16 v[52:55], a[224:227], a[20:23], v[52:55]
    ds_read_b128 a[220:223], v12 offset:22528
    buffer_load_dwordx4 a[80:83], v8, s[28:31], s50 offen offset:2048 sc1
    s_waitcnt lgkmcnt(6)
    v_mfma_f32_16x16x32_bf16 v[36:39], a[228:231], a[16:19], v[36:39]
    v_mfma_f32_16x16x32_bf16 v[56:59], a[228:231], a[20:23], v[56:59]
    ds_read_b128 a[224:227], v12 offset:23552
    buffer_load_dwordx4 a[84:87], v8, s[28:31], s51 offen offset:2048 sc1
    s_waitcnt lgkmcnt(6)
    v_mfma_f32_16x16x32_bf16 v[40:43], a[232:235], a[16:19], v[40:43]
    v_mfma_f32_16x16x32_bf16 v[60:63], a[232:235], a[20:23], v[60:63]
    ds_read_b128 a[228:231], v12 offset:24576
    buffer_load_dwordx4 a[88:91], v8, s[28:31], s50 offen offset:3072 sc1
    s_waitcnt lgkmcnt(6)
    v_mfma_f32_16x16x32_bf16 v[44:47], a[236:239], a[16:19], v[44:47]
    v_mfma_f32_16x16x32_bf16 v[64:67], a[236:239], a[20:23], v[64:67]
    s_waitcnt lgkmcnt(5)
    s_barrier
    ds_read_b128 a[232:235], v12 offset:30720
    buffer_load_dwordx4 a[92:95], v8, s[28:31], s51 offen offset:3072 sc1
    s_waitcnt lgkmcnt(6)
    v_mfma_f32_16x16x32_bf16 v[48:51], a[240:243], a[16:19], v[48:51]
    v_mfma_f32_16x16x32_bf16 v[68:71], a[240:243], a[20:23], v[68:71]
    ds_read_b128 a[236:239], v12 offset:31744
    s_add_u32 s50, s50, 4096
    s_add_u32 s51, s51, 4096
    buffer_load_dwordx4 a[96:99], v8, s[28:31], s50 offen offset:0 sc1
    s_waitcnt vmcnt(17) lgkmcnt(6)
    v_mfma_f32_16x16x32_bf16 v[32:35], a[244:247], a[24:27], v[32:35]
    v_mfma_f32_16x16x32_bf16 v[52:55], a[244:247], a[28:31], v[52:55]
    ds_read_b128 a[240:243], v12 offset:32768
    buffer_load_dwordx4 a[100:103], v8, s[28:31], s51 offen offset:0 sc1
    s_waitcnt lgkmcnt(6)
    v_mfma_f32_16x16x32_bf16 v[36:39], a[216:219], a[24:27], v[36:39]
    v_mfma_f32_16x16x32_bf16 v[56:59], a[216:219], a[28:31], v[56:59]
    ds_read_b128 a[244:247], v12 offset:33792
    buffer_load_dwordx4 a[104:107], v8, s[28:31], s50 offen offset:1024 sc1
    s_waitcnt lgkmcnt(6)
    v_mfma_f32_16x16x32_bf16 v[40:43], a[220:223], a[24:27], v[40:43]
    v_mfma_f32_16x16x32_bf16 v[60:63], a[220:223], a[28:31], v[60:63]
    ds_read_b128 a[216:219], v12 offset:34816
    buffer_load_dwordx4 a[108:111], v8, s[28:31], s51 offen offset:1024 sc1
    s_waitcnt lgkmcnt(6)
    v_mfma_f32_16x16x32_bf16 v[44:47], a[224:227], a[24:27], v[44:47]
    v_mfma_f32_16x16x32_bf16 v[64:67], a[224:227], a[28:31], v[64:67]
    ds_read_b128 a[220:223], v12 offset:40960
    buffer_load_dwordx4 a[112:115], v8, s[28:31], s50 offen offset:2048 sc1
    s_waitcnt lgkmcnt(6)
    v_mfma_f32_16x16x32_bf16 v[48:51], a[228:231], a[24:27], v[48:51]
    v_mfma_f32_16x16x32_bf16 v[68:71], a[228:231], a[28:31], v[68:71]
    ds_read_b128 a[224:227], v12 offset:41984
    buffer_load_dwordx4 a[116:119], v8, s[28:31], s51 offen offset:2048 sc1
    s_waitcnt vmcnt(20) lgkmcnt(6)
    v_mfma_f32_16x16x32_bf16 v[32:35], a[232:235], a[32:35], v[32:35]
    v_mfma_f32_16x16x32_bf16 v[52:55], a[232:235], a[36:39], v[52:55]
    ds_read_b128 a[228:231], v12 offset:43008
    buffer_load_dwordx4 a[120:123], v8, s[28:31], s50 offen offset:3072 sc1
    s_waitcnt lgkmcnt(6)
    v_mfma_f32_16x16x32_bf16 v[36:39], a[236:239], a[32:35], v[36:39]
    v_mfma_f32_16x16x32_bf16 v[56:59], a[236:239], a[36:39], v[56:59]
    ds_read_b128 a[232:235], v12 offset:44032
    buffer_load_dwordx4 a[124:127], v8, s[28:31], s51 offen offset:3072 sc1
    s_waitcnt lgkmcnt(6)
    v_mfma_f32_16x16x32_bf16 v[40:43], a[240:243], a[32:35], v[40:43]
    v_mfma_f32_16x16x32_bf16 v[60:63], a[240:243], a[36:39], v[60:63]
    ds_read_b128 a[236:239], v12 offset:45056
    s_mul_i32 s25, s20, 3
    s_min_u32 s25, s25, 7
    s_lshl_b32 s25, s25, 10
    s_add_u32 s62, s25, 143360
    s_add_u32 s63, s25, s59
    s_add_u32 s63, s63, 163840
    s_mov_b32 m0, s62
    buffer_load_dwordx4 v8, s[28:31], s63 offen offset:0 lds
    s_waitcnt lgkmcnt(6)
    v_mfma_f32_16x16x32_bf16 v[44:47], a[244:247], a[32:35], v[44:47]
    v_mfma_f32_16x16x32_bf16 v[64:67], a[244:247], a[36:39], v[64:67]
    ds_read_b128 a[240:243], v12 offset:51200
    buffer_load_dwordx4 v8, s[28:31], s63 offen offset:1024 lds
    s_waitcnt lgkmcnt(6)
    v_mfma_f32_16x16x32_bf16 v[48:51], a[216:219], a[32:35], v[48:51]
    v_mfma_f32_16x16x32_bf16 v[68:71], a[216:219], a[36:39], v[68:71]
    ds_read_b128 a[244:247], v12 offset:52224
    buffer_load_dwordx4 v8, s[28:31], s63 offen offset:2048 lds
    s_waitcnt vmcnt(23) lgkmcnt(6)
    v_mfma_f32_16x16x32_bf16 v[32:35], a[220:223], a[40:43], v[32:35]
    v_mfma_f32_16x16x32_bf16 v[52:55], a[220:223], a[44:47], v[52:55]
    ds_read_b128 a[216:219], v12 offset:53248
    s_mul_i32 s25, s20, 5
    s_lshl_b32 s25, s25, 10
    s_add_u32 s62, s25, 0
    s_add_u32 s63, s25, s59
    s_add_u32 s63, s63, 174080
    s_mov_b32 m0, s62
    buffer_load_dwordx4 v8, s[28:31], s63 offen offset:0 lds
    s_waitcnt lgkmcnt(6)
    v_mfma_f32_16x16x32_bf16 v[36:39], a[224:227], a[40:43], v[36:39]
    v_mfma_f32_16x16x32_bf16 v[56:59], a[224:227], a[44:47], v[56:59]
    ds_read_b128 a[220:223], v12 offset:54272
    buffer_load_dwordx4 v8, s[28:31], s63 offen offset:1024 lds
    s_waitcnt lgkmcnt(6)
    v_mfma_f32_16x16x32_bf16 v[40:43], a[228:231], a[40:43], v[40:43]
    v_mfma_f32_16x16x32_bf16 v[60:63], a[228:231], a[44:47], v[60:63]
    ds_read_b128 a[224:227], v12 offset:55296
    buffer_load_dwordx4 v8, s[28:31], s63 offen offset:2048 lds
    s_waitcnt lgkmcnt(6)
    v_mfma_f32_16x16x32_bf16 v[44:47], a[232:235], a[40:43], v[44:47]
    v_mfma_f32_16x16x32_bf16 v[64:67], a[232:235], a[44:47], v[64:67]
    s_waitcnt lgkmcnt(5)
    s_barrier
    ds_read_b128 a[228:231], v12 offset:61440
    buffer_load_dwordx4 v8, s[28:31], s63 offen offset:3072 lds
    s_waitcnt lgkmcnt(6)
    v_mfma_f32_16x16x32_bf16 v[48:51], a[236:239], a[40:43], v[48:51]
    v_mfma_f32_16x16x32_bf16 v[68:71], a[236:239], a[44:47], v[68:71]
    ds_read_b128 a[232:235], v12 offset:62464
    s_add_u32 s62, s62, 4096
    s_add_u32 s63, s63, 4096
    s_mov_b32 m0, s62
    buffer_load_dwordx4 v8, s[28:31], s63 offen offset:0 lds
    s_waitcnt vmcnt(26) lgkmcnt(6)
    v_mfma_f32_16x16x32_bf16 v[32:35], a[240:243], a[48:51], v[32:35]
    v_mfma_f32_16x16x32_bf16 v[52:55], a[240:243], a[52:55], v[52:55]
    ds_read_b128 a[236:239], v12 offset:63488
    s_add_u32 s50, s50, 4096
    s_add_u32 s51, s51, 4096
    buffer_load_dwordx4 a[128:131], v8, s[28:31], s50 offen offset:0 sc1
    s_waitcnt lgkmcnt(6)
    v_mfma_f32_16x16x32_bf16 v[36:39], a[244:247], a[48:51], v[36:39]
    v_mfma_f32_16x16x32_bf16 v[56:59], a[244:247], a[52:55], v[56:59]
    ds_read_b128 a[240:243], v12 offset:64512
    buffer_load_dwordx4 a[132:135], v8, s[28:31], s51 offen offset:0 sc1
    s_waitcnt lgkmcnt(6)
    v_mfma_f32_16x16x32_bf16 v[40:43], a[216:219], a[48:51], v[40:43]
    v_mfma_f32_16x16x32_bf16 v[60:63], a[216:219], a[52:55], v[60:63]
    ds_read_b128 a[244:247], v13 offset:0
    buffer_load_dwordx4 a[136:139], v8, s[28:31], s50 offen offset:1024 sc1
    s_waitcnt lgkmcnt(6)
    v_mfma_f32_16x16x32_bf16 v[44:47], a[220:223], a[48:51], v[44:47]
    v_mfma_f32_16x16x32_bf16 v[64:67], a[220:223], a[52:55], v[64:67]
    ds_read_b128 a[216:219], v13 offset:6144
    buffer_load_dwordx4 a[140:143], v8, s[28:31], s51 offen offset:1024 sc1
    s_waitcnt lgkmcnt(6)
    v_mfma_f32_16x16x32_bf16 v[48:51], a[224:227], a[48:51], v[48:51]
    v_mfma_f32_16x16x32_bf16 v[68:71], a[224:227], a[52:55], v[68:71]
    ds_read_b128 a[220:223], v13 offset:7168
    buffer_load_dwordx4 a[144:147], v8, s[28:31], s50 offen offset:2048 sc1
    s_waitcnt vmcnt(29) lgkmcnt(6)
    v_mfma_f32_16x16x32_bf16 v[32:35], a[228:231], a[56:59], v[32:35]
    v_mfma_f32_16x16x32_bf16 v[52:55], a[228:231], a[60:63], v[52:55]
    ds_read_b128 a[224:227], v13 offset:8192
    buffer_load_dwordx4 a[148:151], v8, s[28:31], s51 offen offset:2048 sc1
    s_waitcnt lgkmcnt(6)
    v_mfma_f32_16x16x32_bf16 v[36:39], a[232:235], a[56:59], v[36:39]
    v_mfma_f32_16x16x32_bf16 v[56:59], a[232:235], a[60:63], v[56:59]
    ds_read_b128 a[228:231], v13 offset:9216
    s_mul_i32 s25, s20, 8
    s_min_u32 s25, s25, 22
    s_lshl_b32 s25, s25, 10
    s_add_u32 s62, s25, 20480
    s_add_u32 s63, s25, s59
    s_add_u32 s63, s63, 194560
    s_mov_b32 m0, s62
    buffer_load_dwordx4 v8, s[28:31], s63 offen offset:0 lds
    s_waitcnt lgkmcnt(6)
    v_mfma_f32_16x16x32_bf16 v[40:43], a[236:239], a[56:59], v[40:43]
    v_mfma_f32_16x16x32_bf16 v[60:63], a[236:239], a[60:63], v[60:63]
    ds_read_b128 a[232:235], v13 offset:10240
    buffer_load_dwordx4 v8, s[28:31], s63 offen offset:1024 lds
    s_waitcnt lgkmcnt(6)
    v_mfma_f32_16x16x32_bf16 v[44:47], a[240:243], a[56:59], v[44:47]
    v_mfma_f32_16x16x32_bf16 v[64:67], a[240:243], a[60:63], v[64:67]
    ds_read_b128 a[236:239], v14 offset:22528
    buffer_load_dwordx4 v8, s[28:31], s63 offen offset:2048 lds
    s_waitcnt lgkmcnt(6)
    v_mfma_f32_16x16x32_bf16 v[48:51], a[244:247], a[56:59], v[48:51]
    v_mfma_f32_16x16x32_bf16 v[68:71], a[244:247], a[60:63], v[68:71]
    ds_read_b128 a[240:243], v14 offset:23552
    buffer_load_dwordx4 v8, s[28:31], s63 offen offset:3072 lds
    s_waitcnt vmcnt(32) lgkmcnt(6)
    v_mfma_f32_16x16x32_bf16 v[32:35], a[216:219], a[64:67], v[32:35]
    v_mfma_f32_16x16x32_bf16 v[52:55], a[216:219], a[68:71], v[52:55]
    ds_read_b128 a[244:247], v14 offset:24576
    s_add_u32 s62, s62, 4096
    s_add_u32 s63, s63, 4096
    s_mov_b32 m0, s62
    buffer_load_dwordx4 v8, s[28:31], s63 offen offset:0 lds
    s_waitcnt lgkmcnt(6)
    v_mfma_f32_16x16x32_bf16 v[36:39], a[220:223], a[64:67], v[36:39]
    v_mfma_f32_16x16x32_bf16 v[56:59], a[220:223], a[68:71], v[56:59]
    ds_read_b128 a[216:219], v14 offset:25600
    buffer_load_dwordx4 v8, s[28:31], s63 offen offset:1024 lds
    s_waitcnt lgkmcnt(6)
    v_mfma_f32_16x16x32_bf16 v[40:43], a[224:227], a[64:67], v[40:43]
    v_mfma_f32_16x16x32_bf16 v[60:63], a[224:227], a[68:71], v[60:63]
    ds_read_b128 a[220:223], v14 offset:26624
    buffer_load_dwordx4 v8, s[28:31], s63 offen offset:2048 lds
    s_waitcnt lgkmcnt(6)
    v_mfma_f32_16x16x32_bf16 v[44:47], a[228:231], a[64:67], v[44:47]
    v_mfma_f32_16x16x32_bf16 v[64:67], a[228:231], a[68:71], v[64:67]
    s_waitcnt lgkmcnt(5)
    s_barrier
    ds_read_b128 a[224:227], v13 offset:16384
    buffer_load_dwordx4 v8, s[28:31], s63 offen offset:3072 lds
    s_waitcnt lgkmcnt(6)
    v_mfma_f32_16x16x32_bf16 v[48:51], a[232:235], a[64:67], v[48:51]
    v_mfma_f32_16x16x32_bf16 v[68:71], a[232:235], a[68:71], v[68:71]
    ds_read_b128 a[228:231], v13 offset:17408
    buffer_load_dwordx4 a[152:155], v8, s[28:31], s50 offen offset:3072 sc1
    s_waitcnt vmcnt(35) lgkmcnt(6)
    v_mfma_f32_16x16x32_bf16 v[32:35], a[236:239], a[72:75], v[32:35]
    v_mfma_f32_16x16x32_bf16 v[52:55], a[236:239], a[76:79], v[52:55]
    ds_read_b128 a[232:235], v13 offset:18432
    buffer_load_dwordx4 a[156:159], v8, s[28:31], s51 offen offset:3072 sc1
    s_waitcnt lgkmcnt(6)
    v_mfma_f32_16x16x32_bf16 v[36:39], a[240:243], a[72:75], v[36:39]
    v_mfma_f32_16x16x32_bf16 v[56:59], a[240:243], a[76:79], v[56:59]
    ds_read_b128 a[236:239], v13 offset:19456
    s_add_u32 s50, s50, 4096
    s_add_u32 s51, s51, 4096
    buffer_load_dwordx4 a[160:163], v8, s[28:31], s50 offen offset:0 sc1
    s_waitcnt lgkmcnt(6)
    v_mfma_f32_16x16x32_bf16 v[40:43], a[244:247], a[72:75], v[40:43]
    v_mfma_f32_16x16x32_bf16 v[60:63], a[244:247], a[76:79], v[60:63]
    ds_read_b128 a[240:243], v13 offset:20480
    buffer_load_dwordx4 a[164:167], v8, s[28:31], s51 offen offset:0 sc1
    s_waitcnt lgkmcnt(6)
    v_mfma_f32_16x16x32_bf16 v[44:47], a[216:219], a[72:75], v[44:47]
    v_mfma_f32_16x16x32_bf16 v[64:67], a[216:219], a[76:79], v[64:67]
    ds_read_b128 a[244:247], v13 offset:26624
    buffer_load_dwordx4 a[168:171], v8, s[28:31], s50 offen offset:1024 sc1
    s_waitcnt lgkmcnt(6)
    v_mfma_f32_16x16x32_bf16 v[48:51], a[220:223], a[72:75], v[48:51]
    v_mfma_f32_16x16x32_bf16 v[68:71], a[220:223], a[76:79], v[68:71]
    ds_read_b128 a[216:219], v13 offset:27648
    buffer_load_dwordx4 a[172:175], v8, s[28:31], s51 offen offset:1024 sc1
    s_waitcnt vmcnt(38) lgkmcnt(6)
    v_mfma_f32_16x16x32_bf16 v[32:35], a[224:227], a[80:83], v[32:35]
    v_mfma_f32_16x16x32_bf16 v[52:55], a[224:227], a[84:87], v[52:55]
    ds_read_b128 a[220:223], v13 offset:28672
    s_mul_i32 s25, s20, 8
    s_min_u32 s25, s25, 22
    s_lshl_b32 s25, s25, 10
    s_add_u32 s62, s25, 51200
    s_add_u32 s63, s25, s59
    s_add_u32 s63, s63, 225280
    s_mov_b32 m0, s62
    buffer_load_dwordx4 v8, s[28:31], s63 offen offset:0 lds
    s_waitcnt lgkmcnt(6)
    v_mfma_f32_16x16x32_bf16 v[36:39], a[228:231], a[80:83], v[36:39]
    v_mfma_f32_16x16x32_bf16 v[56:59], a[228:231], a[84:87], v[56:59]
    ds_read_b128 a[224:227], v13 offset:29696
    buffer_load_dwordx4 v8, s[28:31], s63 offen offset:1024 lds
    s_waitcnt lgkmcnt(6)
    v_mfma_f32_16x16x32_bf16 v[40:43], a[232:235], a[80:83], v[40:43]
    v_mfma_f32_16x16x32_bf16 v[60:63], a[232:235], a[84:87], v[60:63]
    ds_read_b128 a[228:231], v13 offset:30720
    buffer_load_dwordx4 v8, s[28:31], s63 offen offset:2048 lds
    s_waitcnt lgkmcnt(6)
    v_mfma_f32_16x16x32_bf16 v[44:47], a[236:239], a[80:83], v[44:47]
    v_mfma_f32_16x16x32_bf16 v[64:67], a[236:239], a[84:87], v[64:67]
    ds_read_b128 a[232:235], v13 offset:36864
    buffer_load_dwordx4 v8, s[28:31], s63 offen offset:3072 lds
    s_waitcnt lgkmcnt(6)
    v_mfma_f32_16x16x32_bf16 v[48:51], a[240:243], a[80:83], v[48:51]
    v_mfma_f32_16x16x32_bf16 v[68:71], a[240:243], a[84:87], v[68:71]
    ds_read_b128 a[236:239], v13 offset:37888
    s_add_u32 s62, s62, 4096
    s_add_u32 s63, s63, 4096
    s_mov_b32 m0, s62
    buffer_load_dwordx4 v8, s[28:31], s63 offen offset:0 lds
    s_waitcnt vmcnt(41) lgkmcnt(6)
    v_mfma_f32_16x16x32_bf16 v[32:35], a[244:247], a[88:91], v[32:35]
    v_mfma_f32_16x16x32_bf16 v[52:55], a[244:247], a[92:95], v[52:55]
    ds_read_b128 a[240:243], v13 offset:38912
    buffer_load_dwordx4 v8, s[28:31], s63 offen offset:1024 lds
    s_waitcnt lgkmcnt(6)
    v_mfma_f32_16x16x32_bf16 v[36:39], a[216:219], a[88:91], v[36:39]
    v_mfma_f32_16x16x32_bf16 v[56:59], a[216:219], a[92:95], v[56:59]
    ds_read_b128 a[244:247], v13 offset:39936
    buffer_load_dwordx4 v8, s[28:31], s63 offen offset:2048 lds
    s_waitcnt lgkmcnt(6)
    v_mfma_f32_16x16x32_bf16 v[40:43], a[220:223], a[88:91], v[40:43]
    v_mfma_f32_16x16x32_bf16 v[60:63], a[220:223], a[92:95], v[60:63]
    ds_read_b128 a[216:219], v13 offset:40960
    buffer_load_dwordx4 v8, s[28:31], s63 offen offset:3072 lds
    s_waitcnt lgkmcnt(6)
    v_mfma_f32_16x16x32_bf16 v[44:47], a[224:227], a[88:91], v[44:47]
    v_mfma_f32_16x16x32_bf16 v[64:67], a[224:227], a[92:95], v[64:67]
    s_waitcnt lgkmcnt(5)
    s_barrier
    ds_read_b128 a[220:223], v13 offset:47104
    buffer_load_dwordx4 a[176:179], v8, s[28:31], s50 offen offset:2048 sc1
    s_waitcnt lgkmcnt(6)
    v_mfma_f32_16x16x32_bf16 v[48:51], a[228:231], a[88:91], v[48:51]
    v_mfma_f32_16x16x32_bf16 v[68:71], a[228:231], a[92:95], v[68:71]
    ds_read_b128 a[224:227], v13 offset:48128
    buffer_load_dwordx4 a[180:183], v8, s[28:31], s51 offen offset:2048 sc1
    s_waitcnt vmcnt(44) lgkmcnt(6)
    v_mfma_f32_16x16x32_bf16 v[32:35], a[232:235], a[96:99], v[32:35]
    v_mfma_f32_16x16x32_bf16 v[52:55], a[232:235], a[100:103], v[52:55]
    ds_read_b128 a[228:231], v13 offset:49152
    buffer_load_dwordx4 a[184:187], v8, s[28:31], s50 offen offset:3072 sc1
    s_waitcnt lgkmcnt(6)
    v_mfma_f32_16x16x32_bf16 v[36:39], a[236:239], a[96:99], v[36:39]
    v_mfma_f32_16x16x32_bf16 v[56:59], a[236:239], a[100:103], v[56:59]
    ds_read_b128 a[232:235], v13 offset:50176
    buffer_load_dwordx4 a[188:191], v8, s[28:31], s51 offen offset:3072 sc1
    s_waitcnt lgkmcnt(6)
    v_mfma_f32_16x16x32_bf16 v[40:43], a[240:243], a[96:99], v[40:43]
    v_mfma_f32_16x16x32_bf16 v[60:63], a[240:243], a[100:103], v[60:63]
    ds_read_b128 a[236:239], v13 offset:51200
    s_add_u32 s50, s50, 4096
    s_add_u32 s51, s51, 4096
    buffer_load_dwordx4 a[192:195], v8, s[28:31], s50 offen offset:0 sc1
    s_waitcnt lgkmcnt(6)
    v_mfma_f32_16x16x32_bf16 v[44:47], a[244:247], a[96:99], v[44:47]
    v_mfma_f32_16x16x32_bf16 v[64:67], a[244:247], a[100:103], v[64:67]
    ds_read_b128 a[240:243], v13 offset:57344
    buffer_load_dwordx4 a[196:199], v8, s[28:31], s51 offen offset:0 sc1
    s_waitcnt lgkmcnt(6)
    v_mfma_f32_16x16x32_bf16 v[48:51], a[216:219], a[96:99], v[48:51]
    v_mfma_f32_16x16x32_bf16 v[68:71], a[216:219], a[100:103], v[68:71]
    ds_read_b128 a[244:247], v13 offset:58368
    s_mul_i32 s25, s20, 3
    s_min_u32 s25, s25, 7
    s_lshl_b32 s25, s25, 10
    s_add_u32 s62, s25, 153600
    s_add_u32 s63, s25, s59
    s_add_u32 s63, s63, 256000
    s_mov_b32 m0, s62
    buffer_load_dwordx4 v8, s[28:31], s63 offen offset:0 lds
    s_waitcnt vmcnt(47) lgkmcnt(6)
    v_mfma_f32_16x16x32_bf16 v[32:35], a[220:223], a[104:107], v[32:35]
    v_mfma_f32_16x16x32_bf16 v[52:55], a[220:223], a[108:111], v[52:55]
    ds_read_b128 a[216:219], v13 offset:59392
    buffer_load_dwordx4 v8, s[28:31], s63 offen offset:1024 lds
    s_waitcnt lgkmcnt(6)
    v_mfma_f32_16x16x32_bf16 v[36:39], a[224:227], a[104:107], v[36:39]
    v_mfma_f32_16x16x32_bf16 v[56:59], a[224:227], a[108:111], v[56:59]
    ds_read_b128 a[220:223], v13 offset:60416
    buffer_load_dwordx4 v8, s[28:31], s63 offen offset:2048 lds
    s_waitcnt lgkmcnt(6)
    v_mfma_f32_16x16x32_bf16 v[40:43], a[228:231], a[104:107], v[40:43]
    v_mfma_f32_16x16x32_bf16 v[60:63], a[228:231], a[108:111], v[60:63]
    ds_read_b128 a[224:227], v13 offset:61440
    s_mul_i32 s25, s20, 3
    s_min_u32 s25, s25, 7
    s_lshl_b32 s25, s25, 10
    s_add_u32 s62, s25, 81920
    s_add_u32 s63, s25, s59
    s_add_u32 s63, s63, 266240
    s_mov_b32 m0, s62
    buffer_load_dwordx4 v8, s[28:31], s63 offen offset:0 lds
    s_waitcnt lgkmcnt(6)
    v_mfma_f32_16x16x32_bf16 v[44:47], a[232:235], a[104:107], v[44:47]
    v_mfma_f32_16x16x32_bf16 v[64:67], a[232:235], a[108:111], v[64:67]
    ds_read_b128 a[228:231], v14 offset:2048
    buffer_load_dwordx4 v8, s[28:31], s63 offen offset:1024 lds
    s_waitcnt lgkmcnt(6)
    v_mfma_f32_16x16x32_bf16 v[48:51], a[236:239], a[104:107], v[48:51]
    v_mfma_f32_16x16x32_bf16 v[68:71], a[236:239], a[108:111], v[68:71]
    ds_read_b128 a[232:235], v14 offset:3072
    buffer_load_dwordx4 v8, s[28:31], s63 offen offset:2048 lds
    s_waitcnt vmcnt(50) lgkmcnt(6)
    v_mfma_f32_16x16x32_bf16 v[32:35], a[240:243], a[112:115], v[32:35]
    v_mfma_f32_16x16x32_bf16 v[52:55], a[240:243], a[116:119], v[52:55]
    ds_read_b128 a[236:239], v14 offset:4096
    buffer_load_dwordx4 a[200:203], v8, s[28:31], s50 offen offset:1024 sc1
    s_waitcnt lgkmcnt(6)
    v_mfma_f32_16x16x32_bf16 v[36:39], a[244:247], a[112:115], v[36:39]
    v_mfma_f32_16x16x32_bf16 v[56:59], a[244:247], a[116:119], v[56:59]
    ds_read_b128 a[240:243], v14 offset:5120
    buffer_load_dwordx4 a[204:207], v8, s[28:31], s51 offen offset:1024 sc1
    s_waitcnt lgkmcnt(6)
    v_mfma_f32_16x16x32_bf16 v[40:43], a[216:219], a[112:115], v[40:43]
    v_mfma_f32_16x16x32_bf16 v[60:63], a[216:219], a[116:119], v[60:63]
    ds_read_b128 a[244:247], v14 offset:6144
    buffer_load_dwordx4 a[208:211], v8, s[28:31], s50 offen offset:2048 sc1
    s_waitcnt lgkmcnt(6)
    v_mfma_f32_16x16x32_bf16 v[44:47], a[220:223], a[112:115], v[44:47]
    v_mfma_f32_16x16x32_bf16 v[64:67], a[220:223], a[116:119], v[64:67]
    s_waitcnt vmcnt(43) lgkmcnt(5)
    s_barrier
    ds_read_b128 a[216:219], v14 offset:12288
    buffer_load_dwordx4 a[212:215], v8, s[28:31], s51 offen offset:2048 sc1
    s_waitcnt lgkmcnt(6)
    v_mfma_f32_16x16x32_bf16 v[48:51], a[224:227], a[112:115], v[48:51]
    v_mfma_f32_16x16x32_bf16 v[68:71], a[224:227], a[116:119], v[68:71]
    ds_read_b128 a[220:223], v14 offset:13312
    s_add_u32 s26, s44, 13406208
    buffer_load_dwordx2 v[96:97], v230, s[28:31], s26 offen sc1
    s_waitcnt lgkmcnt(6)
    v_mfma_f32_16x16x32_bf16 v[32:35], a[228:231], a[120:123], v[32:35]
    v_mfma_f32_16x16x32_bf16 v[52:55], a[228:231], a[124:127], v[52:55]
    ds_read_b128 a[224:227], v14 offset:14336
    s_mov_b32 s26, 5492736
    buffer_load_dwordx2 v[106:107], v235, s[28:31], s26 offen
    s_waitcnt lgkmcnt(6)
    v_mfma_f32_16x16x32_bf16 v[36:39], a[232:235], a[120:123], v[36:39]
    v_mfma_f32_16x16x32_bf16 v[56:59], a[232:235], a[124:127], v[56:59]
    ds_read_b128 a[228:231], v14 offset:15360
    s_add_u32 s26, s44, 13406720
    buffer_load_dwordx2 v[98:99], v230, s[28:31], s26 offen sc1
    s_waitcnt lgkmcnt(6)
    v_mfma_f32_16x16x32_bf16 v[40:43], a[236:239], a[120:123], v[40:43]
    v_mfma_f32_16x16x32_bf16 v[60:63], a[236:239], a[124:127], v[60:63]
    ds_read_b128 a[232:235], v14 offset:16384
    s_mov_b32 s26, 5492736
    buffer_load_dwordx2 v[108:109], v236, s[28:31], s26 offen
    s_waitcnt lgkmcnt(6)
    v_mfma_f32_16x16x32_bf16 v[44:47], a[240:243], a[120:123], v[44:47]
    v_mfma_f32_16x16x32_bf16 v[64:67], a[240:243], a[124:127], v[64:67]
    ds_read_b128 a[236:239], v12 offset:0
    s_add_u32 s26, s44, 13407232
    buffer_load_dwordx2 v[100:101], v230, s[28:31], s26 offen sc1
    s_waitcnt lgkmcnt(6)
    v_mfma_f32_16x16x32_bf16 v[48:51], a[244:247], a[120:123], v[48:51]
    v_mfma_f32_16x16x32_bf16 v[68:71], a[244:247], a[124:127], v[68:71]
    ds_read_b128 a[240:243], v12 offset:1024
    s_mov_b32 s26, 5492736
    buffer_load_dwordx2 v[110:111], v237, s[28:31], s26 offen
    s_waitcnt vmcnt(48) lgkmcnt(6)
    v_mfma_f32_16x16x32_bf16 v[32:35], a[216:219], a[128:131], v[32:35]
    v_mfma_f32_16x16x32_bf16 v[52:55], a[216:219], a[132:135], v[52:55]
    ds_read_b128 a[244:247], v12 offset:2048
    s_add_u32 s26, s44, 13407744
    buffer_load_dwordx2 v[102:103], v230, s[28:31], s26 offen sc1
    s_waitcnt lgkmcnt(6)
    v_mfma_f32_16x16x32_bf16 v[36:39], a[220:223], a[128:131], v[36:39]
    v_mfma_f32_16x16x32_bf16 v[56:59], a[220:223], a[132:135], v[56:59]
    ds_read_b128 a[216:219], v12 offset:3072
    s_mov_b32 s26, 5492736
    buffer_load_dwordx2 v[112:113], v238, s[28:31], s26 offen
    s_waitcnt lgkmcnt(6)
    v_mfma_f32_16x16x32_bf16 v[40:43], a[224:227], a[128:131], v[40:43]
    v_mfma_f32_16x16x32_bf16 v[60:63], a[224:227], a[132:135], v[60:63]
    ds_read_b128 a[220:223], v12 offset:4096
    s_add_u32 s26, s45, 13406208
    buffer_load_dwordx2 v[104:105], v230, s[28:31], s26 offen sc1
    s_waitcnt lgkmcnt(6)
    v_mfma_f32_16x16x32_bf16 v[44:47], a[228:231], a[128:131], v[44:47]
    v_mfma_f32_16x16x32_bf16 v[64:67], a[228:231], a[132:135], v[64:67]
    ds_read_b128 a[224:227], v12 offset:10240
    s_mov_b32 s26, 5492736
    buffer_load_dwordx2 v[114:115], v239, s[28:31], s26 offen
    s_waitcnt lgkmcnt(6)
    v_mfma_f32_16x16x32_bf16 v[48:51], a[232:235], a[128:131], v[48:51]
    v_mfma_f32_16x16x32_bf16 v[68:71], a[232:235], a[132:135], v[68:71]
    ds_read_b128 a[228:231], v12 offset:11264
    buffer_load_dwordx4 v[116:119], v233, s[28:31], s37 offen offset:0
    s_waitcnt vmcnt(51) lgkmcnt(6)
    v_mfma_f32_16x16x32_bf16 v[32:35], a[236:239], a[136:139], v[32:35]
    v_mfma_f32_16x16x32_bf16 v[52:55], a[236:239], a[140:143], v[52:55]
    ds_read_b128 a[232:235], v12 offset:12288
    buffer_load_dwordx4 v[120:123], v233, s[28:31], s37 offen offset:64
    s_waitcnt lgkmcnt(6)
    v_mfma_f32_16x16x32_bf16 v[36:39], a[240:243], a[136:139], v[36:39]
    v_mfma_f32_16x16x32_bf16 v[56:59], a[240:243], a[140:143], v[56:59]
    ds_read_b128 a[236:239], v12 offset:13312
    buffer_load_dwordx4 v[124:127], v233, s[28:31], s37 offen offset:128
    s_waitcnt lgkmcnt(6)
    v_mfma_f32_16x16x32_bf16 v[40:43], a[244:247], a[136:139], v[40:43]
    v_mfma_f32_16x16x32_bf16 v[60:63], a[244:247], a[140:143], v[60:63]
    ds_read_b128 a[240:243], v12 offset:14336
    buffer_load_dwordx4 v[128:131], v233, s[28:31], s37 offen offset:192
    s_waitcnt lgkmcnt(6)
    v_mfma_f32_16x16x32_bf16 v[44:47], a[216:219], a[136:139], v[44:47]
    v_mfma_f32_16x16x32_bf16 v[64:67], a[216:219], a[140:143], v[64:67]
    s_waitcnt vmcnt(44) lgkmcnt(5)
    s_barrier
    ds_read_b128 a[244:247], v12 offset:20480
    buffer_load_dwordx4 v[132:135], v233, s[28:31], s38 offen
    s_waitcnt lgkmcnt(6)
    v_mfma_f32_16x16x32_bf16 v[48:51], a[220:223], a[136:139], v[48:51]
    v_mfma_f32_16x16x32_bf16 v[68:71], a[220:223], a[140:143], v[68:71]
    ds_read_b128 a[216:219], v12 offset:21504
    s_waitcnt lgkmcnt(6)
    v_mfma_f32_16x16x32_bf16 v[32:35], a[224:227], a[144:147], v[32:35]
    v_mfma_f32_16x16x32_bf16 v[52:55], a[224:227], a[148:151], v[52:55]
    ds_read_b128 a[220:223], v12 offset:22528
    s_waitcnt lgkmcnt(6)
    v_mfma_f32_16x16x32_bf16 v[36:39], a[228:231], a[144:147], v[36:39]
    v_mfma_f32_16x16x32_bf16 v[56:59], a[228:231], a[148:151], v[56:59]
    ds_read_b128 a[224:227], v12 offset:23552
    s_waitcnt lgkmcnt(6)
    v_mfma_f32_16x16x32_bf16 v[40:43], a[232:235], a[144:147], v[40:43]
    v_mfma_f32_16x16x32_bf16 v[60:63], a[232:235], a[148:151], v[60:63]
    ds_read_b128 a[228:231], v12 offset:24576
    s_waitcnt lgkmcnt(6)
    v_mfma_f32_16x16x32_bf16 v[44:47], a[236:239], a[144:147], v[44:47]
    v_mfma_f32_16x16x32_bf16 v[64:67], a[236:239], a[148:151], v[64:67]
    ds_read_b128 a[232:235], v12 offset:30720
    s_waitcnt lgkmcnt(6)
    v_mfma_f32_16x16x32_bf16 v[48:51], a[240:243], a[144:147], v[48:51]
    v_mfma_f32_16x16x32_bf16 v[68:71], a[240:243], a[148:151], v[68:71]
    ds_read_b128 a[236:239], v12 offset:31744
    s_waitcnt vmcnt(43) lgkmcnt(6)
    v_mfma_f32_16x16x32_bf16 v[32:35], a[244:247], a[152:155], v[32:35]
    v_mfma_f32_16x16x32_bf16 v[52:55], a[244:247], a[156:159], v[52:55]
    ds_read_b128 a[240:243], v12 offset:32768
    s_waitcnt lgkmcnt(6)
    v_mfma_f32_16x16x32_bf16 v[36:39], a[216:219], a[152:155], v[36:39]
    v_mfma_f32_16x16x32_bf16 v[56:59], a[216:219], a[156:159], v[56:59]
    ds_read_b128 a[244:247], v12 offset:33792
    s_waitcnt lgkmcnt(6)
    v_mfma_f32_16x16x32_bf16 v[40:43], a[220:223], a[152:155], v[40:43]
    v_mfma_f32_16x16x32_bf16 v[60:63], a[220:223], a[156:159], v[60:63]
    ds_read_b128 a[216:219], v12 offset:34816
    s_waitcnt lgkmcnt(6)
    v_mfma_f32_16x16x32_bf16 v[44:47], a[224:227], a[152:155], v[44:47]
    v_mfma_f32_16x16x32_bf16 v[64:67], a[224:227], a[156:159], v[64:67]
    ds_read_b128 a[220:223], v12 offset:40960
    s_waitcnt lgkmcnt(6)
    v_mfma_f32_16x16x32_bf16 v[48:51], a[228:231], a[152:155], v[48:51]
    v_mfma_f32_16x16x32_bf16 v[68:71], a[228:231], a[156:159], v[68:71]
    ds_read_b128 a[224:227], v12 offset:41984
    s_waitcnt vmcnt(41) lgkmcnt(6)
    v_mfma_f32_16x16x32_bf16 v[32:35], a[232:235], a[160:163], v[32:35]
    v_mfma_f32_16x16x32_bf16 v[52:55], a[232:235], a[164:167], v[52:55]
    ds_read_b128 a[228:231], v12 offset:43008
    s_waitcnt lgkmcnt(6)
    v_mfma_f32_16x16x32_bf16 v[36:39], a[236:239], a[160:163], v[36:39]
    v_mfma_f32_16x16x32_bf16 v[56:59], a[236:239], a[164:167], v[56:59]
    ds_read_b128 a[232:235], v12 offset:44032
    s_waitcnt lgkmcnt(6)
    v_mfma_f32_16x16x32_bf16 v[40:43], a[240:243], a[160:163], v[40:43]
    v_mfma_f32_16x16x32_bf16 v[60:63], a[240:243], a[164:167], v[60:63]
    ds_read_b128 a[236:239], v12 offset:45056
    s_waitcnt lgkmcnt(6)
    v_mfma_f32_16x16x32_bf16 v[44:47], a[244:247], a[160:163], v[44:47]
    v_mfma_f32_16x16x32_bf16 v[64:67], a[244:247], a[164:167], v[64:67]
    s_waitcnt vmcnt(31) lgkmcnt(5)
    s_barrier
    ds_read_b128 a[240:243], v12 offset:51200
    s_waitcnt lgkmcnt(6)
    v_mfma_f32_16x16x32_bf16 v[48:51], a[216:219], a[160:163], v[48:51]
    v_mfma_f32_16x16x32_bf16 v[68:71], a[216:219], a[164:167], v[68:71]
    ds_read_b128 a[244:247], v12 offset:52224
    s_waitcnt lgkmcnt(6)
    v_mfma_f32_16x16x32_bf16 v[32:35], a[220:223], a[168:171], v[32:35]
    v_mfma_f32_16x16x32_bf16 v[52:55], a[220:223], a[172:175], v[52:55]
    ds_read_b128 a[216:219], v12 offset:53248
    s_waitcnt lgkmcnt(6)
    v_mfma_f32_16x16x32_bf16 v[36:39], a[224:227], a[168:171], v[36:39]
    v_mfma_f32_16x16x32_bf16 v[56:59], a[224:227], a[172:175], v[56:59]
    ds_read_b128 a[220:223], v12 offset:54272
    s_waitcnt lgkmcnt(6)
    v_mfma_f32_16x16x32_bf16 v[40:43], a[228:231], a[168:171], v[40:43]
    v_mfma_f32_16x16x32_bf16 v[60:63], a[228:231], a[172:175], v[60:63]
    ds_read_b128 a[224:227], v12 offset:55296
    s_waitcnt lgkmcnt(6)
    v_mfma_f32_16x16x32_bf16 v[44:47], a[232:235], a[168:171], v[44:47]
    v_mfma_f32_16x16x32_bf16 v[64:67], a[232:235], a[172:175], v[64:67]
    ds_read_b128 a[228:231], v12 offset:61440
    s_waitcnt lgkmcnt(6)
    v_mfma_f32_16x16x32_bf16 v[48:51], a[236:239], a[168:171], v[48:51]
    v_mfma_f32_16x16x32_bf16 v[68:71], a[236:239], a[172:175], v[68:71]
    ds_read_b128 a[232:235], v12 offset:62464
    s_waitcnt vmcnt(29) lgkmcnt(6)
    v_mfma_f32_16x16x32_bf16 v[32:35], a[240:243], a[176:179], v[32:35]
    v_mfma_f32_16x16x32_bf16 v[52:55], a[240:243], a[180:183], v[52:55]
    ds_read_b128 a[236:239], v12 offset:63488
    s_waitcnt lgkmcnt(6)
    v_mfma_f32_16x16x32_bf16 v[36:39], a[244:247], a[176:179], v[36:39]
    v_mfma_f32_16x16x32_bf16 v[56:59], a[244:247], a[180:183], v[56:59]
    ds_read_b128 a[240:243], v12 offset:64512
    s_waitcnt lgkmcnt(6)
    v_mfma_f32_16x16x32_bf16 v[40:43], a[216:219], a[176:179], v[40:43]
    v_mfma_f32_16x16x32_bf16 v[60:63], a[216:219], a[180:183], v[60:63]
    ds_read_b128 a[244:247], v13 offset:0
    s_waitcnt lgkmcnt(6)
    v_mfma_f32_16x16x32_bf16 v[44:47], a[220:223], a[176:179], v[44:47]
    v_mfma_f32_16x16x32_bf16 v[64:67], a[220:223], a[180:183], v[64:67]
    ds_read_b128 a[216:219], v13 offset:6144
    s_waitcnt lgkmcnt(6)
    v_mfma_f32_16x16x32_bf16 v[48:51], a[224:227], a[176:179], v[48:51]
    v_mfma_f32_16x16x32_bf16 v[68:71], a[224:227], a[180:183], v[68:71]
    ds_read_b128 a[220:223], v13 offset:7168
    s_waitcnt vmcnt(27) lgkmcnt(6)
    v_mfma_f32_16x16x32_bf16 v[32:35], a[228:231], a[184:187], v[32:35]
    v_mfma_f32_16x16x32_bf16 v[52:55], a[228:231], a[188:191], v[52:55]
    ds_read_b128 a[224:227], v13 offset:8192
    s_waitcnt lgkmcnt(6)
    v_mfma_f32_16x16x32_bf16 v[36:39], a[232:235], a[184:187], v[36:39]
    v_mfma_f32_16x16x32_bf16 v[56:59], a[232:235], a[188:191], v[56:59]
    ds_read_b128 a[228:231], v13 offset:9216
    s_waitcnt lgkmcnt(6)
    v_mfma_f32_16x16x32_bf16 v[40:43], a[236:239], a[184:187], v[40:43]
    v_mfma_f32_16x16x32_bf16 v[60:63], a[236:239], a[188:191], v[60:63]
    ds_read_b128 a[232:235], v13 offset:10240
    s_waitcnt lgkmcnt(6)
    v_mfma_f32_16x16x32_bf16 v[44:47], a[240:243], a[184:187], v[44:47]
    v_mfma_f32_16x16x32_bf16 v[64:67], a[240:243], a[188:191], v[64:67]
    s_waitcnt vmcnt(19) lgkmcnt(5)
    s_barrier
    ds_read_b128 a[236:239], v14 offset:22528
    s_waitcnt lgkmcnt(6)
    v_mfma_f32_16x16x32_bf16 v[48:51], a[244:247], a[184:187], v[48:51]
    v_mfma_f32_16x16x32_bf16 v[68:71], a[244:247], a[188:191], v[68:71]
    ds_read_b128 a[240:243], v14 offset:23552
    s_waitcnt lgkmcnt(6)
    v_mfma_f32_16x16x32_bf16 v[32:35], a[216:219], a[192:195], v[32:35]
    v_mfma_f32_16x16x32_bf16 v[52:55], a[216:219], a[196:199], v[52:55]
    ds_read_b128 a[244:247], v14 offset:24576
    s_waitcnt lgkmcnt(6)
    v_mfma_f32_16x16x32_bf16 v[36:39], a[220:223], a[192:195], v[36:39]
    v_mfma_f32_16x16x32_bf16 v[56:59], a[220:223], a[196:199], v[56:59]
    ds_read_b128 a[216:219], v14 offset:25600
    s_waitcnt lgkmcnt(6)
    v_mfma_f32_16x16x32_bf16 v[40:43], a[224:227], a[192:195], v[40:43]
    v_mfma_f32_16x16x32_bf16 v[60:63], a[224:227], a[196:199], v[60:63]
    ds_read_b128 a[220:223], v14 offset:26624
    s_waitcnt lgkmcnt(6)
    v_mfma_f32_16x16x32_bf16 v[44:47], a[228:231], a[192:195], v[44:47]
    v_mfma_f32_16x16x32_bf16 v[64:67], a[228:231], a[196:199], v[64:67]
    ds_read_b128 a[224:227], v13 offset:16384
    s_waitcnt lgkmcnt(6)
    v_mfma_f32_16x16x32_bf16 v[48:51], a[232:235], a[192:195], v[48:51]
    v_mfma_f32_16x16x32_bf16 v[68:71], a[232:235], a[196:199], v[68:71]
    ds_read_b128 a[228:231], v13 offset:17408
    s_waitcnt vmcnt(17) lgkmcnt(6)
    v_mfma_f32_16x16x32_bf16 v[32:35], a[236:239], a[200:203], v[32:35]
    v_mfma_f32_16x16x32_bf16 v[52:55], a[236:239], a[204:207], v[52:55]
    ds_read_b128 a[232:235], v13 offset:18432
    s_waitcnt lgkmcnt(6)
    v_mfma_f32_16x16x32_bf16 v[36:39], a[240:243], a[200:203], v[36:39]
    v_mfma_f32_16x16x32_bf16 v[56:59], a[240:243], a[204:207], v[56:59]
    ds_read_b128 a[236:239], v13 offset:19456
    s_waitcnt lgkmcnt(6)
    v_mfma_f32_16x16x32_bf16 v[40:43], a[244:247], a[200:203], v[40:43]
    v_mfma_f32_16x16x32_bf16 v[60:63], a[244:247], a[204:207], v[60:63]
    ds_read_b128 a[240:243], v13 offset:20480
    s_waitcnt lgkmcnt(6)
    v_mfma_f32_16x16x32_bf16 v[44:47], a[216:219], a[200:203], v[44:47]
    v_mfma_f32_16x16x32_bf16 v[64:67], a[216:219], a[204:207], v[64:67]
    s_waitcnt lgkmcnt(5)
    v_mfma_f32_16x16x32_bf16 v[48:51], a[220:223], a[200:203], v[48:51]
    v_mfma_f32_16x16x32_bf16 v[68:71], a[220:223], a[204:207], v[68:71]
    s_waitcnt vmcnt(15) lgkmcnt(4)
    v_mfma_f32_16x16x32_bf16 v[32:35], a[224:227], a[208:211], v[32:35]
    v_mfma_f32_16x16x32_bf16 v[52:55], a[224:227], a[212:215], v[52:55]
    s_waitcnt lgkmcnt(3)
    v_mfma_f32_16x16x32_bf16 v[36:39], a[228:231], a[208:211], v[36:39]
    v_mfma_f32_16x16x32_bf16 v[56:59], a[228:231], a[212:215], v[56:59]
    s_waitcnt lgkmcnt(2)
    v_mfma_f32_16x16x32_bf16 v[40:43], a[232:235], a[208:211], v[40:43]
    v_mfma_f32_16x16x32_bf16 v[60:63], a[232:235], a[212:215], v[60:63]
    s_waitcnt lgkmcnt(1)
    v_mfma_f32_16x16x32_bf16 v[44:47], a[236:239], a[208:211], v[44:47]
    v_mfma_f32_16x16x32_bf16 v[64:67], a[236:239], a[212:215], v[64:67]
    s_waitcnt lgkmcnt(0)
    v_mfma_f32_16x16x32_bf16 v[48:51], a[240:243], a[208:211], v[48:51]
    v_mfma_f32_16x16x32_bf16 v[68:71], a[240:243], a[212:215], v[68:71]
    s_barrier
    s_nop 4
    ds_write_b128 v246, v[52:55] offset:0
    ds_write_b128 v246, v[56:59] offset:1024
    ds_write_b128 v246, v[60:63] offset:2048
    ds_write_b128 v246, v[64:67] offset:3072
    ds_write_b128 v246, v[68:71] offset:4096
    s_waitcnt vmcnt(0)
    v_lshlrev_b32 v136, 16, v96
    v_and_b32 v137, 0xffff0000, v96
    v_lshlrev_b32 v138, 16, v97
    v_and_b32 v139, 0xffff0000, v97
    v_lshlrev_b32 v156, 16, v106
    v_and_b32 v157, 0xffff0000, v106
    v_lshlrev_b32 v158, 16, v107
    v_and_b32 v159, 0xffff0000, v107
    v_lshlrev_b32 v140, 16, v98
    v_and_b32 v141, 0xffff0000, v98
    v_lshlrev_b32 v142, 16, v99
    v_and_b32 v143, 0xffff0000, v99
    v_lshlrev_b32 v160, 16, v108
    v_and_b32 v161, 0xffff0000, v108
    v_lshlrev_b32 v162, 16, v109
    v_and_b32 v163, 0xffff0000, v109
    v_lshlrev_b32 v144, 16, v100
    v_and_b32 v145, 0xffff0000, v100
    v_lshlrev_b32 v146, 16, v101
    v_and_b32 v147, 0xffff0000, v101
    v_lshlrev_b32 v164, 16, v110
    v_and_b32 v165, 0xffff0000, v110
    v_lshlrev_b32 v166, 16, v111
    v_and_b32 v167, 0xffff0000, v111
    v_lshlrev_b32 v148, 16, v102
    v_and_b32 v149, 0xffff0000, v102
    v_lshlrev_b32 v150, 16, v103
    v_and_b32 v151, 0xffff0000, v103
    v_lshlrev_b32 v168, 16, v112
    v_and_b32 v169, 0xffff0000, v112
    v_lshlrev_b32 v170, 16, v113
    v_and_b32 v171, 0xffff0000, v113
    v_lshlrev_b32 v152, 16, v104
    v_and_b32 v153, 0xffff0000, v104
    v_lshlrev_b32 v154, 16, v105
    v_and_b32 v155, 0xffff0000, v105
    v_lshlrev_b32 v172, 16, v114
    v_and_b32 v173, 0xffff0000, v114
    v_lshlrev_b32 v174, 16, v115
    v_and_b32 v175, 0xffff0000, v115
    v_pk_add_f32 v[32:33], v[32:33], v[136:137]
    v_pk_add_f32 v[34:35], v[34:35], v[138:139]
    v_pk_add_f32 v[36:37], v[36:37], v[140:141]
    v_pk_add_f32 v[38:39], v[38:39], v[142:143]
    v_pk_add_f32 v[40:41], v[40:41], v[144:145]
    v_pk_add_f32 v[42:43], v[42:43], v[146:147]
    v_pk_add_f32 v[44:45], v[44:45], v[148:149]
    v_pk_add_f32 v[46:47], v[46:47], v[150:151]
    v_pk_add_f32 v[48:49], v[48:49], v[152:153]
    v_pk_add_f32 v[50:51], v[50:51], v[154:155]
    s_waitcnt lgkmcnt(0)
    s_barrier
    ds_read_b128 v[72:75], v247 offset:0
    ds_read_b128 v[76:79], v247 offset:1024
    ds_read_b128 v[80:83], v247 offset:2048
    ds_read_b128 v[84:87], v247 offset:3072
    ds_read_b128 v[88:91], v247 offset:4096
    s_waitcnt lgkmcnt(4)
    v_pk_add_f32 v[32:33], v[32:33], v[72:73]
    v_pk_add_f32 v[34:35], v[34:35], v[74:75]
    v_pk_fma_f32 v[32:33], v[32:33], v[116:117], v[156:157]
    v_pk_fma_f32 v[34:35], v[34:35], v[118:119], v[158:159]
    v_cvt_pk_bf16_f32 v180, v32, v33
    v_cvt_pk_bf16_f32 v181, v34, v35
    s_waitcnt lgkmcnt(3)
    v_pk_add_f32 v[36:37], v[36:37], v[76:77]
    v_pk_add_f32 v[38:39], v[38:39], v[78:79]
    v_pk_fma_f32 v[36:37], v[36:37], v[120:121], v[160:161]
    v_pk_fma_f32 v[38:39], v[38:39], v[122:123], v[162:163]
    v_cvt_pk_bf16_f32 v182, v36, v37
    v_cvt_pk_bf16_f32 v183, v38, v39
    s_waitcnt lgkmcnt(2)
    v_pk_add_f32 v[40:41], v[40:41], v[80:81]
    v_pk_add_f32 v[42:43], v[42:43], v[82:83]
    v_pk_fma_f32 v[40:41], v[40:41], v[124:125], v[164:165]
    v_pk_fma_f32 v[42:43], v[42:43], v[126:127], v[166:167]
    v_cvt_pk_bf16_f32 v184, v40, v41
    v_cvt_pk_bf16_f32 v185, v42, v43
    s_waitcnt lgkmcnt(1)
    v_pk_add_f32 v[44:45], v[44:45], v[84:85]
    v_pk_add_f32 v[46:47], v[46:47], v[86:87]
    v_pk_fma_f32 v[44:45], v[44:45], v[128:129], v[168:169]
    v_pk_fma_f32 v[46:47], v[46:47], v[130:131], v[170:171]
    v_cvt_pk_bf16_f32 v186, v44, v45
    v_cvt_pk_bf16_f32 v187, v46, v47
    s_waitcnt lgkmcnt(0)
    v_pk_add_f32 v[48:49], v[48:49], v[88:89]
    v_pk_add_f32 v[50:51], v[50:51], v[90:91]
    v_pk_fma_f32 v[48:49], v[48:49], v[132:133], v[172:173]
    v_pk_fma_f32 v[50:51], v[50:51], v[134:135], v[174:175]
    v_cvt_pk_bf16_f32 v188, v48, v49
    v_cvt_pk_bf16_f32 v189, v50, v51
    s_nop 1
    v_permlane16_swap_b32 v180, v182
    v_permlane16_swap_b32 v181, v183
    v_permlane16_swap_b32 v184, v186
    v_permlane16_swap_b32 v185, v187
    buffer_store_dwordx4 v[180:183], v231, s[32:35], s46 offen sc1
    buffer_store_dwordx4 v[184:187], v231, s[32:35], s46 offen offset:64 sc1
    buffer_store_dwordx2 v[188:189], v232, s[32:35], s49 offen sc1
    s_endpgm
chain_end:
    s_endpgm
.section .rodata,"a"
.p2align 6
.amdhsa_kernel k0_kernel
  .amdhsa_next_free_vgpr 128
  .amdhsa_next_free_sgpr 72
  .amdhsa_accum_offset 128
  .amdhsa_group_segment_fixed_size 0
  .amdhsa_kernarg_size 128
  .amdhsa_user_sgpr_count 2
  .amdhsa_user_sgpr_kernarg_segment_ptr 1
  .amdhsa_system_sgpr_workgroup_id_x 1
  .amdhsa_float_denorm_mode_32 3
.end_amdhsa_kernel
.p2align 6
.amdhsa_kernel k1_kernel
  .amdhsa_next_free_vgpr 288
  .amdhsa_next_free_sgpr 100
  .amdhsa_accum_offset 256
  .amdhsa_group_segment_fixed_size 0
  .amdhsa_kernarg_size 128
  .amdhsa_user_sgpr_count 2
  .amdhsa_user_sgpr_kernarg_segment_ptr 1
  .amdhsa_system_sgpr_workgroup_id_x 1
  .amdhsa_float_denorm_mode_32 3
.end_amdhsa_kernel
.p2align 6
.amdhsa_kernel chain_kernel
  .amdhsa_next_free_vgpr 512
  .amdhsa_next_free_sgpr 100
  .amdhsa_accum_offset 256
  .amdhsa_group_segment_fixed_size 0
  .amdhsa_kernarg_size 128
  .amdhsa_user_sgpr_count 2
  .amdhsa_user_sgpr_kernarg_segment_ptr 1
  .amdhsa_system_sgpr_workgroup_id_x 1
  .amdhsa_float_denorm_mode_32 3
.end_amdhsa_kernel
```

```asm
; @launch kernel=k0_kernel grid=(512,1,1) block=(256,1,1) lds=8192
; @launch kernel=k1_kernel grid=(256,1,1) block=(256,1,1) lds=55360
; @launch kernel=chain_kernel grid=(256,1,1) block=(256,1,1) lds=163840
.amdgcn_target "amdgcn-amd-amdhsa--gfx950"
.text
.globl k0_kernel
.p2align 8
.type k0_kernel,@function
k0_kernel:
    s_cmp_ge_u32 s2, 512
    s_cbranch_scc1 k0_end
    s_load_dwordx4 s[4:7], s[0:1], 8
    s_load_dwordx2 s[8:9], s[0:1], 24
    s_load_dwordx2 s[10:11], s[0:1], 120
    s_load_dwordx2 s[60:61], s[0:1], 0
    s_load_dwordx2 s[62:63], s[0:1], 96
    s_load_dwordx2 s[52:53], s[0:1], 88
    s_load_dwordx4 s[56:59], s[0:1], 32
    v_lshrrev_b32 v2, 6, v0
    v_and_b32 v1, 63, v0
    v_readfirstlane_b32 s20, v2
    s_waitcnt lgkmcnt(0)
    s_mov_b32 s28, s10
    s_mov_b32 s29, s11
    s_mov_b32 s30, 268435456
    s_mov_b32 s31, 0x00020000
    s_cmp_ge_u32 s2, 320
    s_cbranch_scc1 p_aux
    s_mov_b32 s45, s20
    s_mov_b32 s16, s4
    s_mov_b32 s17, s5
    s_mov_b32 s18, 2621440
    s_mov_b32 s19, 0x00020000
    s_mov_b32 s20, s6
    s_mov_b32 s21, s7
    s_mov_b32 s22, 2621440
    s_mov_b32 s23, 0x00020000
    s_mov_b32 s24, s8
    s_mov_b32 s25, s9
    s_mov_b32 s26, 5120
    s_mov_b32 s27, 0x00020000
    s_mul_i32 s32, s2, 52429
    s_lshr_b32 s32, s32, 19
    s_mul_i32 s33, s32, 10
    s_sub_u32 s33, s2, s33
    v_and_b32 v1, 15, v0
    v_lshrrev_b32 v2, 4, v0
    s_lshl_b32 s34, s32, 6
    v_lshl_add_u32 v3, v2, 2, s34
    v_mul_u32_u24 v4, 1280, v3
    s_lshl_b32 s35, s33, 7
    v_lshl_add_u32 v5, v1, 3, s35
    v_add_u32 v4, v4, v5
    v_subrev_u32 v6, 3840, v4
    v_subrev_u32 v7, 2560, v4
    v_subrev_u32 v8, 1280, v4
    buffer_load_dwordx2 v[10:11], v6, s[16:19], 0 offen nt
    buffer_load_dwordx2 v[12:13], v7, s[16:19], 0 offen nt
    buffer_load_dwordx2 v[14:15], v8, s[16:19], 0 offen nt
    buffer_load_dwordx2 v[16:17], v4, s[16:19], 0 offen offset:0 nt
    buffer_load_dwordx2 v[18:19], v4, s[16:19], 0 offen offset:1280 nt
    buffer_load_dwordx2 v[20:21], v4, s[16:19], 0 offen offset:2560 nt
    buffer_load_dwordx2 v[22:23], v4, s[16:19], 0 offen offset:3840 nt
    v_lshlrev_b32 v100, 2, v5
    buffer_load_dwordx4 v[32:35], v100, s[24:27], 0 offen
    buffer_load_dwordx4 v[36:39], v100, s[24:27], 0 offen offset:16
    buffer_load_dwordx2 v[24:25], v4, s[20:23], 0 offen offset:0 nt
    buffer_load_dwordx2 v[26:27], v4, s[20:23], 0 offen offset:1280 nt
    buffer_load_dwordx2 v[28:29], v4, s[20:23], 0 offen offset:2560 nt
    buffer_load_dwordx2 v[30:31], v4, s[20:23], 0 offen offset:3840 nt
    v_lshlrev_b32 v100, 9, v1
    v_sub_u32 v101, 15, v2
    v_lshl_add_u32 v100, v101, 3, v100
    v_lshrrev_b32 v101, 3, v0
    v_mul_u32_u24 v101, 4352, v101
    v_and_b32 v102, 7, v0
    v_lshl_add_u32 v103, v102, 4, v101
    v_lshlrev_b32 v104, 4, v0
    s_mul_i32 s36, s33, 278528
    s_lshr_b32 s37, s32, 1
    s_mul_i32 s37, s37, 272
    s_add_u32 s36, s36, s37
    s_add_u32 s36, s36, 0
    s_and_b32 s37, s32, 1
    s_lshl_b32 s38, s37, 7
    s_sub_u32 s38, 128, s38
    s_add_u32 s38, s38, s36
    s_waitcnt vmcnt(4)
    v_lshlrev_b32 v40, 16, v32
    v_and_b32 v44, 0xffff0000, v32
    v_lshlrev_b32 v48, 16, v33
    v_and_b32 v52, 0xffff0000, v33
    v_lshlrev_b32 v41, 16, v34
    v_and_b32 v45, 0xffff0000, v34
    v_lshlrev_b32 v49, 16, v35
    v_and_b32 v53, 0xffff0000, v35
    v_lshlrev_b32 v42, 16, v36
    v_and_b32 v46, 0xffff0000, v36
    v_lshlrev_b32 v50, 16, v37
    v_and_b32 v54, 0xffff0000, v37
    v_lshlrev_b32 v43, 16, v38
    v_and_b32 v47, 0xffff0000, v38
    v_lshlrev_b32 v51, 16, v39
    v_and_b32 v55, 0xffff0000, v39
    v_lshlrev_b32 v56, 16, v10
    v_and_b32 v57, 0xffff0000, v10
    v_lshlrev_b32 v58, 16, v11
    v_and_b32 v59, 0xffff0000, v11
    v_lshlrev_b32 v60, 16, v12
    v_and_b32 v61, 0xffff0000, v12
    v_lshlrev_b32 v62, 16, v13
    v_and_b32 v63, 0xffff0000, v13
    v_lshlrev_b32 v64, 16, v14
    v_and_b32 v65, 0xffff0000, v14
    v_lshlrev_b32 v66, 16, v15
    v_and_b32 v67, 0xffff0000, v15
    v_lshlrev_b32 v68, 16, v16
    v_and_b32 v69, 0xffff0000, v16
    v_lshlrev_b32 v70, 16, v17
    v_and_b32 v71, 0xffff0000, v17
    v_lshlrev_b32 v72, 16, v18
    v_and_b32 v73, 0xffff0000, v18
    v_lshlrev_b32 v74, 16, v19
    v_and_b32 v75, 0xffff0000, v19
    v_lshlrev_b32 v76, 16, v20
    v_and_b32 v77, 0xffff0000, v20
    v_lshlrev_b32 v78, 16, v21
    v_and_b32 v79, 0xffff0000, v21
    v_lshlrev_b32 v80, 16, v22
    v_and_b32 v81, 0xffff0000, v22
    v_lshlrev_b32 v82, 16, v23
    v_and_b32 v83, 0xffff0000, v23
    v_pk_mul_f32 v[84:85], v[56:57], v[52:53]
    v_pk_mul_f32 v[86:87], v[58:59], v[54:55]
    v_pk_mul_f32 v[88:89], v[60:61], v[52:53]
    v_pk_mul_f32 v[90:91], v[62:63], v[54:55]
    v_pk_mul_f32 v[92:93], v[64:65], v[52:53]
    v_pk_mul_f32 v[94:95], v[66:67], v[54:55]
    v_pk_mul_f32 v[96:97], v[68:69], v[52:53]
    v_pk_mul_f32 v[98:99], v[70:71], v[54:55]
    v_pk_fma_f32 v[84:85], v[60:61], v[48:49], v[84:85]
    v_pk_fma_f32 v[86:87], v[62:63], v[50:51], v[86:87]
    v_pk_fma_f32 v[88:89], v[64:65], v[48:49], v[88:89]
    v_pk_fma_f32 v[90:91], v[66:67], v[50:51], v[90:91]
    v_pk_fma_f32 v[92:93], v[68:69], v[48:49], v[92:93]
    v_pk_fma_f32 v[94:95], v[70:71], v[50:51], v[94:95]
    v_pk_fma_f32 v[96:97], v[72:73], v[48:49], v[96:97]
    v_pk_fma_f32 v[98:99], v[74:75], v[50:51], v[98:99]
    v_pk_fma_f32 v[84:85], v[64:65], v[44:45], v[84:85]
    v_pk_fma_f32 v[86:87], v[66:67], v[46:47], v[86:87]
    v_pk_fma_f32 v[88:89], v[68:69], v[44:45], v[88:89]
    v_pk_fma_f32 v[90:91], v[70:71], v[46:47], v[90:91]
    v_pk_fma_f32 v[92:93], v[72:73], v[44:45], v[92:93]
    v_pk_fma_f32 v[94:95], v[74:75], v[46:47], v[94:95]
    v_pk_fma_f32 v[96:97], v[76:77], v[44:45], v[96:97]
    v_pk_fma_f32 v[98:99], v[78:79], v[46:47], v[98:99]
    v_pk_fma_f32 v[84:85], v[68:69], v[40:41], v[84:85]
    v_pk_fma_f32 v[86:87], v[70:71], v[42:43], v[86:87]
    v_pk_fma_f32 v[88:89], v[72:73], v[40:41], v[88:89]
    v_pk_fma_f32 v[90:91], v[74:75], v[42:43], v[90:91]
    v_pk_fma_f32 v[92:93], v[76:77], v[40:41], v[92:93]
    v_pk_fma_f32 v[94:95], v[78:79], v[42:43], v[94:95]
    v_pk_fma_f32 v[96:97], v[80:81], v[40:41], v[96:97]
    v_pk_fma_f32 v[98:99], v[82:83], v[42:43], v[98:99]
    v_cvt_pk_bf16_f32 v56, v84, v85
    v_cvt_pk_bf16_f32 v57, v86, v87
    v_cvt_pk_bf16_f32 v58, v88, v89
    v_cvt_pk_bf16_f32 v59, v90, v91
    v_cvt_pk_bf16_f32 v60, v92, v93
    v_cvt_pk_bf16_f32 v61, v94, v95
    v_cvt_pk_bf16_f32 v62, v96, v97
    v_cvt_pk_bf16_f32 v63, v98, v99
    s_waitcnt vmcnt(0)
    v_lshlrev_b32 v84, 16, v56
    v_and_b32 v85, 0xffff0000, v56
    v_lshlrev_b32 v86, 16, v57
    v_and_b32 v87, 0xffff0000, v57
    v_lshlrev_b32 v88, 16, v58
    v_and_b32 v89, 0xffff0000, v58
    v_lshlrev_b32 v90, 16, v59
    v_and_b32 v91, 0xffff0000, v59
    v_lshlrev_b32 v92, 16, v60
    v_and_b32 v93, 0xffff0000, v60
    v_lshlrev_b32 v94, 16, v61
    v_and_b32 v95, 0xffff0000, v61
    v_lshlrev_b32 v96, 16, v62
    v_and_b32 v97, 0xffff0000, v62
    v_lshlrev_b32 v98, 16, v63
    v_and_b32 v99, 0xffff0000, v63
    v_lshlrev_b32 v64, 16, v24
    v_and_b32 v65, 0xffff0000, v24
    v_pk_mul_f32 v[84:85], v[84:85], v[64:65]
    v_lshlrev_b32 v66, 16, v25
    v_and_b32 v67, 0xffff0000, v25
    v_pk_mul_f32 v[86:87], v[86:87], v[66:67]
    v_lshlrev_b32 v68, 16, v26
    v_and_b32 v69, 0xffff0000, v26
    v_pk_mul_f32 v[88:89], v[88:89], v[68:69]
    v_lshlrev_b32 v70, 16, v27
    v_and_b32 v71, 0xffff0000, v27
    v_pk_mul_f32 v[90:91], v[90:91], v[70:71]
    v_lshlrev_b32 v64, 16, v28
    v_and_b32 v65, 0xffff0000, v28
    v_pk_mul_f32 v[92:93], v[92:93], v[64:65]
    v_lshlrev_b32 v66, 16, v29
    v_and_b32 v67, 0xffff0000, v29
    v_pk_mul_f32 v[94:95], v[94:95], v[66:67]
    v_lshlrev_b32 v68, 16, v30
    v_and_b32 v69, 0xffff0000, v30
    v_pk_mul_f32 v[96:97], v[96:97], v[68:69]
    v_lshlrev_b32 v70, 16, v31
    v_and_b32 v71, 0xffff0000, v31
    v_pk_mul_f32 v[98:99], v[98:99], v[70:71]
    v_cvt_pk_bf16_f32 v64, v96, v92
    v_cvt_pk_bf16_f32 v65, v88, v84
    v_cvt_pk_bf16_f32 v66, v97, v93
    v_cvt_pk_bf16_f32 v67, v89, v85
    v_cvt_pk_bf16_f32 v68, v98, v94
    v_cvt_pk_bf16_f32 v69, v90, v86
    v_cvt_pk_bf16_f32 v70, v99, v95
    v_cvt_pk_bf16_f32 v71, v91, v87
    ds_write_b64 v100, v[64:65] offset:0
    ds_write_b64 v100, v[66:67] offset:128
    ds_write_b64 v100, v[68:69] offset:256
    ds_write_b64 v100, v[70:71] offset:384
    s_waitcnt lgkmcnt(0)
    s_barrier
    ds_read_b128 v[10:13], v104 offset:0
    ds_read_b128 v[14:17], v104 offset:4096
    s_waitcnt lgkmcnt(1)
    buffer_store_dwordx4 v[10:13], v103, s[28:31], s38 offen sc1
    s_add_u32 s38, s38, 139264
    s_waitcnt lgkmcnt(0)
    buffer_store_dwordx4 v[14:17], v103, s[28:31], s38 offen sc1
    s_add_u32 s38, s38, 139264
    v_cmp_eq_u32 vcc, 0, v102
    s_and_saveexec_b64 s[66:67], vcc
    s_cmp_eq_u32 s37, 0
    s_cbranch_scc1 k0_kernel_L1
    s_cmp_eq_u32 s32, 31
    s_cbranch_scc1 k0_kernel_L2
    buffer_store_dwordx4 v[10:13], v101, s[28:31], s36 offen offset:528 sc1
    s_add_u32 s36, s36, 139264
    buffer_store_dwordx4 v[14:17], v101, s[28:31], s36 offen offset:528 sc1
    s_add_u32 s36, s36, 139264
    s_branch k0_kernel_L2
k0_kernel_L1:
    s_cmp_lg_u32 s32, 0
    s_cbranch_scc1 k0_kernel_L2
    v_mov_b32 v108, 0
    v_mov_b32 v109, 0
    v_mov_b32 v110, 0
    v_mov_b32 v111, 0
    buffer_store_dwordx4 v[108:111], v101, s[28:31], s36 offen offset:256 sc1
    s_add_u32 s36, s36, 139264
    buffer_store_dwordx4 v[108:111], v101, s[28:31], s36 offen offset:256 sc1
    s_add_u32 s36, s36, 139264
k0_kernel_L2:
    s_endpgm
k0_end:
    s_endpgm
p_aux:
    s_sub_u32 s21, s2, 320
    s_cmp_ge_u32 s20, 2
    s_cbranch_scc1 p_misc
    s_cmp_eq_u32 s20, 1
    s_cbranch_scc1 p_aux1
    s_branch p_st
p_aux1:
    s_add_u32 s21, s21, 192
    s_cmp_lt_u32 s21, 256
    s_cbranch_scc1 p_st
    s_sub_u32 s21, s21, 256
    s_cmp_ge_u32 s21, 120
    s_cbranch_scc1 k0_end
p_mod:
    s_lshr_b32 s32, s21, 2
    s_and_b32 s33, s21, 3
    v_lshrrev_b32 v4, 3, v1
    v_and_b32 v3, 7, v1
    s_mul_i32 s34, s33, 160
    v_add_u32 v4, s34, v4
    v_lshlrev_b32 v5, 1, v4
    v_mul_u32_u24 v6, 7680, v4
    s_lshl_b32 s36, s32, 7
    v_lshl_add_u32 v7, v3, 4, s36
    v_add_u32 v6, v6, v7
    s_mov_b32 s16, s52
    s_mov_b32 s17, s53
    s_mov_b32 s18, 1280
    s_mov_b32 s19, 0x00020000
    s_mov_b32 s24, s62
    s_mov_b32 s25, s63
    s_mov_b32 s26, 4915200
    s_mov_b32 s27, 0x00020000
    s_mul_i32 s35, s33, 320
    v_lshlrev_b32 v5, 3, v1
    buffer_load_dwordx2 v[30:31], v5, s[16:19], s35 offen
    s_mov_b32 s37, 0
    buffer_load_dwordx4 v[32:35], v6, s[24:27], s37 offen nt
    s_add_u32 s37, s37, 61440
    buffer_load_dwordx4 v[36:39], v6, s[24:27], s37 offen nt
    s_add_u32 s37, s37, 61440
    buffer_load_dwordx4 v[40:43], v6, s[24:27], s37 offen nt
    s_add_u32 s37, s37, 61440
    buffer_load_dwordx4 v[44:47], v6, s[24:27], s37 offen nt
    s_add_u32 s37, s37, 61440
    buffer_load_dwordx4 v[48:51], v6, s[24:27], s37 offen nt
    s_add_u32 s37, s37, 61440
    buffer_load_dwordx4 v[52:55], v6, s[24:27], s37 offen nt
    s_add_u32 s37, s37, 61440
    buffer_load_dwordx4 v[56:59], v6, s[24:27], s37 offen nt
    s_add_u32 s37, s37, 61440
    buffer_load_dwordx4 v[60:63], v6, s[24:27], s37 offen nt
    s_add_u32 s37, s37, 61440
    buffer_load_dwordx4 v[64:67], v6, s[24:27], s37 offen nt
    s_add_u32 s37, s37, 61440
    buffer_load_dwordx4 v[68:71], v6, s[24:27], s37 offen nt
    s_add_u32 s37, s37, 61440
    buffer_load_dwordx4 v[72:75], v6, s[24:27], s37 offen nt
    s_add_u32 s37, s37, 61440
    buffer_load_dwordx4 v[76:79], v6, s[24:27], s37 offen nt
    s_add_u32 s37, s37, 61440
    buffer_load_dwordx4 v[80:83], v6, s[24:27], s37 offen nt
    s_add_u32 s37, s37, 61440
    buffer_load_dwordx4 v[84:87], v6, s[24:27], s37 offen nt
    s_add_u32 s37, s37, 61440
    buffer_load_dwordx4 v[88:91], v6, s[24:27], s37 offen nt
    s_add_u32 s37, s37, 61440
    buffer_load_dwordx4 v[92:95], v6, s[24:27], s37 offen nt
    s_add_u32 s37, s37, 61440
    buffer_load_dwordx4 v[96:99], v6, s[24:27], s37 offen nt
    s_add_u32 s37, s37, 61440
    buffer_load_dwordx4 v[100:103], v6, s[24:27], s37 offen nt
    s_add_u32 s37, s37, 61440
    buffer_load_dwordx4 v[104:107], v6, s[24:27], s37 offen nt
    s_add_u32 s37, s37, 61440
    buffer_load_dwordx4 v[108:111], v6, s[24:27], s37 offen nt
    s_mul_i32 s35, s20, 1024
    v_lshlrev_b32 v5, 4, v1
    v_add_u32 v5, s35, v5
    v_lshrrev_b32 v29, 3, v1
    v_lshlrev_b32 v29, 2, v29
    v_add_u32 v29, s35, v29
    s_waitcnt vmcnt(20)
    v_lshlrev_b32 v8, 16, v30
    v_and_b32 v9, 0xffff0000, v30
    v_lshlrev_b32 v10, 16, v31
    v_and_b32 v11, 0xffff0000, v31
    v_mul_f32 v120, 0xbfb8aa3b, v8
    v_mul_f32 v121, 0xbfb8aa3b, v9
    v_mul_f32 v122, 0xbfb8aa3b, v10
    v_mul_f32 v123, 0xbfb8aa3b, v11
    v_exp_f32 v120, v120
    v_exp_f32 v121, v121
    v_exp_f32 v122, v122
    v_exp_f32 v123, v123
    v_add_f32 v120, 1.0, v120
    v_add_f32 v121, 1.0, v121
    v_add_f32 v122, 1.0, v122
    v_add_f32 v123, 1.0, v123
    v_rcp_f32 v120, v120
    v_rcp_f32 v121, v121
    v_rcp_f32 v122, v122
    v_rcp_f32 v123, v123
    s_nop 0
    v_mul_f32 v8, v8, v120
    v_mul_f32 v9, v9, v121
    v_mul_f32 v10, v10, v122
    v_mul_f32 v11, v11, v123
    v_cvt_pk_bf16_f32 v120, v8, v9
    v_lshlrev_b32 v8, 16, v120
    v_and_b32 v9, 0xffff0000, v120
    v_cvt_pk_bf16_f32 v120, v10, v11
    v_lshlrev_b32 v10, 16, v120
    v_and_b32 v11, 0xffff0000, v120
    ds_write_b128 v5, v[8:11]
    s_waitcnt lgkmcnt(0)
    ds_read_b32 v8, v29 offset:0
    ds_read_b32 v9, v29 offset:32
    ds_read_b32 v10, v29 offset:64
    ds_read_b32 v11, v29 offset:96
    ds_read_b32 v12, v29 offset:128
    ds_read_b32 v13, v29 offset:160
    ds_read_b32 v14, v29 offset:192
    ds_read_b32 v15, v29 offset:224
    ds_read_b32 v16, v29 offset:256
    ds_read_b32 v17, v29 offset:288
    ds_read_b32 v18, v29 offset:320
    ds_read_b32 v19, v29 offset:352
    ds_read_b32 v20, v29 offset:384
    ds_read_b32 v21, v29 offset:416
    ds_read_b32 v22, v29 offset:448
    ds_read_b32 v23, v29 offset:480
    ds_read_b32 v24, v29 offset:512
    ds_read_b32 v25, v29 offset:544
    ds_read_b32 v26, v29 offset:576
    ds_read_b32 v27, v29 offset:608
    s_waitcnt lgkmcnt(0)
    v_mov_b32 v112, 0
    v_mov_b32 v113, 0
    v_mov_b32 v114, 0
    v_mov_b32 v115, 0
    v_mov_b32 v116, 0
    v_mov_b32 v117, 0
    v_mov_b32 v118, 0
    v_mov_b32 v119, 0
    s_waitcnt vmcnt(19)
    v_lshlrev_b32 v120, 16, v32
    v_and_b32 v121, 0xffff0000, v32
    v_lshlrev_b32 v122, 16, v33
    v_and_b32 v123, 0xffff0000, v33
    v_lshlrev_b32 v124, 16, v34
    v_and_b32 v125, 0xffff0000, v34
    v_lshlrev_b32 v126, 16, v35
    v_and_b32 v127, 0xffff0000, v35
    v_pk_fma_f32 v[112:113], v[120:121], v[8:9], v[112:113] op_sel:[0,0,0] op_sel_hi:[1,0,1]
    v_pk_fma_f32 v[114:115], v[122:123], v[8:9], v[114:115] op_sel:[0,0,0] op_sel_hi:[1,0,1]
    v_pk_fma_f32 v[116:117], v[124:125], v[8:9], v[116:117] op_sel:[0,0,0] op_sel_hi:[1,0,1]
    v_pk_fma_f32 v[118:119], v[126:127], v[8:9], v[118:119] op_sel:[0,0,0] op_sel_hi:[1,0,1]
    s_waitcnt vmcnt(18)
    v_lshlrev_b32 v120, 16, v36
    v_and_b32 v121, 0xffff0000, v36
    v_lshlrev_b32 v122, 16, v37
    v_and_b32 v123, 0xffff0000, v37
    v_lshlrev_b32 v124, 16, v38
    v_and_b32 v125, 0xffff0000, v38
    v_lshlrev_b32 v126, 16, v39
    v_and_b32 v127, 0xffff0000, v39
    v_pk_fma_f32 v[112:113], v[120:121], v[8:9], v[112:113] op_sel:[0,1,0] op_sel_hi:[1,1,1]
    v_pk_fma_f32 v[114:115], v[122:123], v[8:9], v[114:115] op_sel:[0,1,0] op_sel_hi:[1,1,1]
    v_pk_fma_f32 v[116:117], v[124:125], v[8:9], v[116:117] op_sel:[0,1,0] op_sel_hi:[1,1,1]
    v_pk_fma_f32 v[118:119], v[126:127], v[8:9], v[118:119] op_sel:[0,1,0] op_sel_hi:[1,1,1]
    s_waitcnt vmcnt(17)
    v_lshlrev_b32 v120, 16, v40
    v_and_b32 v121, 0xffff0000, v40
    v_lshlrev_b32 v122, 16, v41
    v_and_b32 v123, 0xffff0000, v41
    v_lshlrev_b32 v124, 16, v42
    v_and_b32 v125, 0xffff0000, v42
    v_lshlrev_b32 v126, 16, v43
    v_and_b32 v127, 0xffff0000, v43
    v_pk_fma_f32 v[112:113], v[120:121], v[10:11], v[112:113] op_sel:[0,0,0] op_sel_hi:[1,0,1]
    v_pk_fma_f32 v[114:115], v[122:123], v[10:11], v[114:115] op_sel:[0,0,0] op_sel_hi:[1,0,1]
    v_pk_fma_f32 v[116:117], v[124:125], v[10:11], v[116:117] op_sel:[0,0,0] op_sel_hi:[1,0,1]
    v_pk_fma_f32 v[118:119], v[126:127], v[10:11], v[118:119] op_sel:[0,0,0] op_sel_hi:[1,0,1]
    s_waitcnt vmcnt(16)
    v_lshlrev_b32 v120, 16, v44
    v_and_b32 v121, 0xffff0000, v44
    v_lshlrev_b32 v122, 16, v45
    v_and_b32 v123, 0xffff0000, v45
    v_lshlrev_b32 v124, 16, v46
    v_and_b32 v125, 0xffff0000, v46
    v_lshlrev_b32 v126, 16, v47
    v_and_b32 v127, 0xffff0000, v47
    v_pk_fma_f32 v[112:113], v[120:121], v[10:11], v[112:113] op_sel:[0,1,0] op_sel_hi:[1,1,1]
    v_pk_fma_f32 v[114:115], v[122:123], v[10:11], v[114:115] op_sel:[0,1,0] op_sel_hi:[1,1,1]
    v_pk_fma_f32 v[116:117], v[124:125], v[10:11], v[116:117] op_sel:[0,1,0] op_sel_hi:[1,1,1]
    v_pk_fma_f32 v[118:119], v[126:127], v[10:11], v[118:119] op_sel:[0,1,0] op_sel_hi:[1,1,1]
    s_waitcnt vmcnt(15)
    v_lshlrev_b32 v120, 16, v48
    v_and_b32 v121, 0xffff0000, v48
    v_lshlrev_b32 v122, 16, v49
    v_and_b32 v123, 0xffff0000, v49
    v_lshlrev_b32 v124, 16, v50
    v_and_b32 v125, 0xffff0000, v50
    v_lshlrev_b32 v126, 16, v51
    v_and_b32 v127, 0xffff0000, v51
    v_pk_fma_f32 v[112:113], v[120:121], v[12:13], v[112:113] op_sel:[0,0,0] op_sel_hi:[1,0,1]
    v_pk_fma_f32 v[114:115], v[122:123], v[12:13], v[114:115] op_sel:[0,0,0] op_sel_hi:[1,0,1]
    v_pk_fma_f32 v[116:117], v[124:125], v[12:13], v[116:117] op_sel:[0,0,0] op_sel_hi:[1,0,1]
    v_pk_fma_f32 v[118:119], v[126:127], v[12:13], v[118:119] op_sel:[0,0,0] op_sel_hi:[1,0,1]
    s_waitcnt vmcnt(14)
    v_lshlrev_b32 v120, 16, v52
    v_and_b32 v121, 0xffff0000, v52
    v_lshlrev_b32 v122, 16, v53
    v_and_b32 v123, 0xffff0000, v53
    v_lshlrev_b32 v124, 16, v54
    v_and_b32 v125, 0xffff0000, v54
    v_lshlrev_b32 v126, 16, v55
    v_and_b32 v127, 0xffff0000, v55
    v_pk_fma_f32 v[112:113], v[120:121], v[12:13], v[112:113] op_sel:[0,1,0] op_sel_hi:[1,1,1]
    v_pk_fma_f32 v[114:115], v[122:123], v[12:13], v[114:115] op_sel:[0,1,0] op_sel_hi:[1,1,1]
    v_pk_fma_f32 v[116:117], v[124:125], v[12:13], v[116:117] op_sel:[0,1,0] op_sel_hi:[1,1,1]
    v_pk_fma_f32 v[118:119], v[126:127], v[12:13], v[118:119] op_sel:[0,1,0] op_sel_hi:[1,1,1]
    s_waitcnt vmcnt(13)
    v_lshlrev_b32 v120, 16, v56
    v_and_b32 v121, 0xffff0000, v56
    v_lshlrev_b32 v122, 16, v57
    v_and_b32 v123, 0xffff0000, v57
    v_lshlrev_b32 v124, 16, v58
    v_and_b32 v125, 0xffff0000, v58
    v_lshlrev_b32 v126, 16, v59
    v_and_b32 v127, 0xffff0000, v59
    v_pk_fma_f32 v[112:113], v[120:121], v[14:15], v[112:113] op_sel:[0,0,0] op_sel_hi:[1,0,1]
    v_pk_fma_f32 v[114:115], v[122:123], v[14:15], v[114:115] op_sel:[0,0,0] op_sel_hi:[1,0,1]
    v_pk_fma_f32 v[116:117], v[124:125], v[14:15], v[116:117] op_sel:[0,0,0] op_sel_hi:[1,0,1]
    v_pk_fma_f32 v[118:119], v[126:127], v[14:15], v[118:119] op_sel:[0,0,0] op_sel_hi:[1,0,1]
    s_waitcnt vmcnt(12)
    v_lshlrev_b32 v120, 16, v60
    v_and_b32 v121, 0xffff0000, v60
    v_lshlrev_b32 v122, 16, v61
    v_and_b32 v123, 0xffff0000, v61
    v_lshlrev_b32 v124, 16, v62
    v_and_b32 v125, 0xffff0000, v62
    v_lshlrev_b32 v126, 16, v63
    v_and_b32 v127, 0xffff0000, v63
    v_pk_fma_f32 v[112:113], v[120:121], v[14:15], v[112:113] op_sel:[0,1,0] op_sel_hi:[1,1,1]
    v_pk_fma_f32 v[114:115], v[122:123], v[14:15], v[114:115] op_sel:[0,1,0] op_sel_hi:[1,1,1]
    v_pk_fma_f32 v[116:117], v[124:125], v[14:15], v[116:117] op_sel:[0,1,0] op_sel_hi:[1,1,1]
    v_pk_fma_f32 v[118:119], v[126:127], v[14:15], v[118:119] op_sel:[0,1,0] op_sel_hi:[1,1,1]
    s_waitcnt vmcnt(11)
    v_lshlrev_b32 v120, 16, v64
    v_and_b32 v121, 0xffff0000, v64
    v_lshlrev_b32 v122, 16, v65
    v_and_b32 v123, 0xffff0000, v65
    v_lshlrev_b32 v124, 16, v66
    v_and_b32 v125, 0xffff0000, v66
    v_lshlrev_b32 v126, 16, v67
    v_and_b32 v127, 0xffff0000, v67
    v_pk_fma_f32 v[112:113], v[120:121], v[16:17], v[112:113] op_sel:[0,0,0] op_sel_hi:[1,0,1]
    v_pk_fma_f32 v[114:115], v[122:123], v[16:17], v[114:115] op_sel:[0,0,0] op_sel_hi:[1,0,1]
    v_pk_fma_f32 v[116:117], v[124:125], v[16:17], v[116:117] op_sel:[0,0,0] op_sel_hi:[1,0,1]
    v_pk_fma_f32 v[118:119], v[126:127], v[16:17], v[118:119] op_sel:[0,0,0] op_sel_hi:[1,0,1]
    s_waitcnt vmcnt(10)
    v_lshlrev_b32 v120, 16, v68
    v_and_b32 v121, 0xffff0000, v68
    v_lshlrev_b32 v122, 16, v69
    v_and_b32 v123, 0xffff0000, v69
    v_lshlrev_b32 v124, 16, v70
    v_and_b32 v125, 0xffff0000, v70
    v_lshlrev_b32 v126, 16, v71
    v_and_b32 v127, 0xffff0000, v71
    v_pk_fma_f32 v[112:113], v[120:121], v[16:17], v[112:113] op_sel:[0,1,0] op_sel_hi:[1,1,1]
    v_pk_fma_f32 v[114:115], v[122:123], v[16:17], v[114:115] op_sel:[0,1,0] op_sel_hi:[1,1,1]
    v_pk_fma_f32 v[116:117], v[124:125], v[16:17], v[116:117] op_sel:[0,1,0] op_sel_hi:[1,1,1]
    v_pk_fma_f32 v[118:119], v[126:127], v[16:17], v[118:119] op_sel:[0,1,0] op_sel_hi:[1,1,1]
    s_waitcnt vmcnt(9)
    v_lshlrev_b32 v120, 16, v72
    v_and_b32 v121, 0xffff0000, v72
    v_lshlrev_b32 v122, 16, v73
    v_and_b32 v123, 0xffff0000, v73
    v_lshlrev_b32 v124, 16, v74
    v_and_b32 v125, 0xffff0000, v74
    v_lshlrev_b32 v126, 16, v75
    v_and_b32 v127, 0xffff0000, v75
    v_pk_fma_f32 v[112:113], v[120:121], v[18:19], v[112:113] op_sel:[0,0,0] op_sel_hi:[1,0,1]
    v_pk_fma_f32 v[114:115], v[122:123], v[18:19], v[114:115] op_sel:[0,0,0] op_sel_hi:[1,0,1]
    v_pk_fma_f32 v[116:117], v[124:125], v[18:19], v[116:117] op_sel:[0,0,0] op_sel_hi:[1,0,1]
    v_pk_fma_f32 v[118:119], v[126:127], v[18:19], v[118:119] op_sel:[0,0,0] op_sel_hi:[1,0,1]
    s_waitcnt vmcnt(8)
    v_lshlrev_b32 v120, 16, v76
    v_and_b32 v121, 0xffff0000, v76
    v_lshlrev_b32 v122, 16, v77
    v_and_b32 v123, 0xffff0000, v77
    v_lshlrev_b32 v124, 16, v78
    v_and_b32 v125, 0xffff0000, v78
    v_lshlrev_b32 v126, 16, v79
    v_and_b32 v127, 0xffff0000, v79
    v_pk_fma_f32 v[112:113], v[120:121], v[18:19], v[112:113] op_sel:[0,1,0] op_sel_hi:[1,1,1]
    v_pk_fma_f32 v[114:115], v[122:123], v[18:19], v[114:115] op_sel:[0,1,0] op_sel_hi:[1,1,1]
    v_pk_fma_f32 v[116:117], v[124:125], v[18:19], v[116:117] op_sel:[0,1,0] op_sel_hi:[1,1,1]
    v_pk_fma_f32 v[118:119], v[126:127], v[18:19], v[118:119] op_sel:[0,1,0] op_sel_hi:[1,1,1]
    s_waitcnt vmcnt(7)
    v_lshlrev_b32 v120, 16, v80
    v_and_b32 v121, 0xffff0000, v80
    v_lshlrev_b32 v122, 16, v81
    v_and_b32 v123, 0xffff0000, v81
    v_lshlrev_b32 v124, 16, v82
    v_and_b32 v125, 0xffff0000, v82
    v_lshlrev_b32 v126, 16, v83
    v_and_b32 v127, 0xffff0000, v83
    v_pk_fma_f32 v[112:113], v[120:121], v[20:21], v[112:113] op_sel:[0,0,0] op_sel_hi:[1,0,1]
    v_pk_fma_f32 v[114:115], v[122:123], v[20:21], v[114:115] op_sel:[0,0,0] op_sel_hi:[1,0,1]
    v_pk_fma_f32 v[116:117], v[124:125], v[20:21], v[116:117] op_sel:[0,0,0] op_sel_hi:[1,0,1]
    v_pk_fma_f32 v[118:119], v[126:127], v[20:21], v[118:119] op_sel:[0,0,0] op_sel_hi:[1,0,1]
    s_waitcnt vmcnt(6)
    v_lshlrev_b32 v120, 16, v84
    v_and_b32 v121, 0xffff0000, v84
    v_lshlrev_b32 v122, 16, v85
    v_and_b32 v123, 0xffff0000, v85
    v_lshlrev_b32 v124, 16, v86
    v_and_b32 v125, 0xffff0000, v86
    v_lshlrev_b32 v126, 16, v87
    v_and_b32 v127, 0xffff0000, v87
    v_pk_fma_f32 v[112:113], v[120:121], v[20:21], v[112:113] op_sel:[0,1,0] op_sel_hi:[1,1,1]
    v_pk_fma_f32 v[114:115], v[122:123], v[20:21], v[114:115] op_sel:[0,1,0] op_sel_hi:[1,1,1]
    v_pk_fma_f32 v[116:117], v[124:125], v[20:21], v[116:117] op_sel:[0,1,0] op_sel_hi:[1,1,1]
    v_pk_fma_f32 v[118:119], v[126:127], v[20:21], v[118:119] op_sel:[0,1,0] op_sel_hi:[1,1,1]
    s_waitcnt vmcnt(5)
    v_lshlrev_b32 v120, 16, v88
    v_and_b32 v121, 0xffff0000, v88
    v_lshlrev_b32 v122, 16, v89
    v_and_b32 v123, 0xffff0000, v89
    v_lshlrev_b32 v124, 16, v90
    v_and_b32 v125, 0xffff0000, v90
    v_lshlrev_b32 v126, 16, v91
    v_and_b32 v127, 0xffff0000, v91
    v_pk_fma_f32 v[112:113], v[120:121], v[22:23], v[112:113] op_sel:[0,0,0] op_sel_hi:[1,0,1]
    v_pk_fma_f32 v[114:115], v[122:123], v[22:23], v[114:115] op_sel:[0,0,0] op_sel_hi:[1,0,1]
    v_pk_fma_f32 v[116:117], v[124:125], v[22:23], v[116:117] op_sel:[0,0,0] op_sel_hi:[1,0,1]
    v_pk_fma_f32 v[118:119], v[126:127], v[22:23], v[118:119] op_sel:[0,0,0] op_sel_hi:[1,0,1]
    s_waitcnt vmcnt(4)
    v_lshlrev_b32 v120, 16, v92
    v_and_b32 v121, 0xffff0000, v92
    v_lshlrev_b32 v122, 16, v93
    v_and_b32 v123, 0xffff0000, v93
    v_lshlrev_b32 v124, 16, v94
    v_and_b32 v125, 0xffff0000, v94
    v_lshlrev_b32 v126, 16, v95
    v_and_b32 v127, 0xffff0000, v95
    v_pk_fma_f32 v[112:113], v[120:121], v[22:23], v[112:113] op_sel:[0,1,0] op_sel_hi:[1,1,1]
    v_pk_fma_f32 v[114:115], v[122:123], v[22:23], v[114:115] op_sel:[0,1,0] op_sel_hi:[1,1,1]
    v_pk_fma_f32 v[116:117], v[124:125], v[22:23], v[116:117] op_sel:[0,1,0] op_sel_hi:[1,1,1]
    v_pk_fma_f32 v[118:119], v[126:127], v[22:23], v[118:119] op_sel:[0,1,0] op_sel_hi:[1,1,1]
    s_waitcnt vmcnt(3)
    v_lshlrev_b32 v120, 16, v96
    v_and_b32 v121, 0xffff0000, v96
    v_lshlrev_b32 v122, 16, v97
    v_and_b32 v123, 0xffff0000, v97
    v_lshlrev_b32 v124, 16, v98
    v_and_b32 v125, 0xffff0000, v98
    v_lshlrev_b32 v126, 16, v99
    v_and_b32 v127, 0xffff0000, v99
    v_pk_fma_f32 v[112:113], v[120:121], v[24:25], v[112:113] op_sel:[0,0,0] op_sel_hi:[1,0,1]
    v_pk_fma_f32 v[114:115], v[122:123], v[24:25], v[114:115] op_sel:[0,0,0] op_sel_hi:[1,0,1]
    v_pk_fma_f32 v[116:117], v[124:125], v[24:25], v[116:117] op_sel:[0,0,0] op_sel_hi:[1,0,1]
    v_pk_fma_f32 v[118:119], v[126:127], v[24:25], v[118:119] op_sel:[0,0,0] op_sel_hi:[1,0,1]
    s_waitcnt vmcnt(2)
    v_lshlrev_b32 v120, 16, v100
    v_and_b32 v121, 0xffff0000, v100
    v_lshlrev_b32 v122, 16, v101
    v_and_b32 v123, 0xffff0000, v101
    v_lshlrev_b32 v124, 16, v102
    v_and_b32 v125, 0xffff0000, v102
    v_lshlrev_b32 v126, 16, v103
    v_and_b32 v127, 0xffff0000, v103
    v_pk_fma_f32 v[112:113], v[120:121], v[24:25], v[112:113] op_sel:[0,1,0] op_sel_hi:[1,1,1]
    v_pk_fma_f32 v[114:115], v[122:123], v[24:25], v[114:115] op_sel:[0,1,0] op_sel_hi:[1,1,1]
    v_pk_fma_f32 v[116:117], v[124:125], v[24:25], v[116:117] op_sel:[0,1,0] op_sel_hi:[1,1,1]
    v_pk_fma_f32 v[118:119], v[126:127], v[24:25], v[118:119] op_sel:[0,1,0] op_sel_hi:[1,1,1]
    s_waitcnt vmcnt(1)
    v_lshlrev_b32 v120, 16, v104
    v_and_b32 v121, 0xffff0000, v104
    v_lshlrev_b32 v122, 16, v105
    v_and_b32 v123, 0xffff0000, v105
    v_lshlrev_b32 v124, 16, v106
    v_and_b32 v125, 0xffff0000, v106
    v_lshlrev_b32 v126, 16, v107
    v_and_b32 v127, 0xffff0000, v107
    v_pk_fma_f32 v[112:113], v[120:121], v[26:27], v[112:113] op_sel:[0,0,0] op_sel_hi:[1,0,1]
    v_pk_fma_f32 v[114:115], v[122:123], v[26:27], v[114:115] op_sel:[0,0,0] op_sel_hi:[1,0,1]
    v_pk_fma_f32 v[116:117], v[124:125], v[26:27], v[116:117] op_sel:[0,0,0] op_sel_hi:[1,0,1]
    v_pk_fma_f32 v[118:119], v[126:127], v[26:27], v[118:119] op_sel:[0,0,0] op_sel_hi:[1,0,1]
    s_waitcnt vmcnt(0)
    v_lshlrev_b32 v120, 16, v108
    v_and_b32 v121, 0xffff0000, v108
    v_lshlrev_b32 v122, 16, v109
    v_and_b32 v123, 0xffff0000, v109
    v_lshlrev_b32 v124, 16, v110
    v_and_b32 v125, 0xffff0000, v110
    v_lshlrev_b32 v126, 16, v111
    v_and_b32 v127, 0xffff0000, v111
    v_pk_fma_f32 v[112:113], v[120:121], v[26:27], v[112:113] op_sel:[0,1,0] op_sel_hi:[1,1,1]
    v_pk_fma_f32 v[114:115], v[122:123], v[26:27], v[114:115] op_sel:[0,1,0] op_sel_hi:[1,1,1]
    v_pk_fma_f32 v[116:117], v[124:125], v[26:27], v[116:117] op_sel:[0,1,0] op_sel_hi:[1,1,1]
    v_pk_fma_f32 v[118:119], v[126:127], v[26:27], v[118:119] op_sel:[0,1,0] op_sel_hi:[1,1,1]
    s_nop 1
    v_add_f32_dpp v112, v112, v112 row_ror:8 row_mask:0xf bank_mask:0xf
    v_add_f32_dpp v113, v113, v113 row_ror:8 row_mask:0xf bank_mask:0xf
    v_add_f32_dpp v114, v114, v114 row_ror:8 row_mask:0xf bank_mask:0xf
    v_add_f32_dpp v115, v115, v115 row_ror:8 row_mask:0xf bank_mask:0xf
    v_add_f32_dpp v116, v116, v116 row_ror:8 row_mask:0xf bank_mask:0xf
    v_add_f32_dpp v117, v117, v117 row_ror:8 row_mask:0xf bank_mask:0xf
    v_add_f32_dpp v118, v118, v118 row_ror:8 row_mask:0xf bank_mask:0xf
    v_add_f32_dpp v119, v119, v119 row_ror:8 row_mask:0xf bank_mask:0xf
    v_mov_b32 v120, v112
    v_mov_b32 v121, v113
    v_mov_b32 v122, v114
    v_mov_b32 v123, v115
    v_mov_b32 v124, v116
    v_mov_b32 v125, v117
    v_mov_b32 v126, v118
    v_mov_b32 v127, v119
    s_nop 1
    v_permlane32_swap_b32 v120, v112
    v_permlane32_swap_b32 v121, v113
    v_permlane32_swap_b32 v122, v114
    v_permlane32_swap_b32 v123, v115
    v_permlane32_swap_b32 v124, v116
    v_permlane32_swap_b32 v125, v117
    v_permlane32_swap_b32 v126, v118
    v_permlane32_swap_b32 v127, v119
    s_nop 1
    v_add_f32 v112, v112, v120
    v_add_f32 v113, v113, v121
    v_add_f32 v114, v114, v122
    v_add_f32 v115, v115, v123
    v_add_f32 v116, v116, v124
    v_add_f32 v117, v117, v125
    v_add_f32 v118, v118, v126
    v_add_f32 v119, v119, v127
    v_mov_b32 v120, v112
    v_mov_b32 v121, v113
    v_mov_b32 v122, v114
    v_mov_b32 v123, v115
    v_mov_b32 v124, v116
    v_mov_b32 v125, v117
    v_mov_b32 v126, v118
    v_mov_b32 v127, v119
    s_nop 1
    v_permlane16_swap_b32 v120, v112
    v_permlane16_swap_b32 v121, v113
    v_permlane16_swap_b32 v122, v114
    v_permlane16_swap_b32 v123, v115
    v_permlane16_swap_b32 v124, v116
    v_permlane16_swap_b32 v125, v117
    v_permlane16_swap_b32 v126, v118
    v_permlane16_swap_b32 v127, v119
    s_nop 1
    v_add_f32 v112, v112, v120
    v_add_f32 v113, v113, v121
    v_add_f32 v114, v114, v122
    v_add_f32 v115, v115, v123
    v_add_f32 v116, v116, v124
    v_add_f32 v117, v117, v125
    v_add_f32 v118, v118, v126
    v_add_f32 v119, v119, v127
    v_lshlrev_b32 v7, 5, v3
    s_mul_i32 s36, s33, 15360
    s_lshl_b32 s37, s32, 8
    s_add_u32 s37, s37, s36
    s_add_u32 s37, s37, 2793472
    s_mov_b64 exec, 0xff
    buffer_store_dwordx4 v[112:115], v7, s[28:31], s37 offen sc1
    buffer_store_dwordx4 v[116:119], v7, s[28:31], s37 offen offset:16 sc1
    s_endpgm
p_st:
    s_mov_b32 s16, s60
    s_mov_b32 s17, s61
    s_mov_b32 s18, 2621440
    s_mov_b32 s19, 0x00020000
    v_lshrrev_b32 v5, 3, v1
    v_and_b32 v6, 7, v1
    s_lshl_b32 s23, s21, 3
    v_add_u32 v7, s23, v5
    v_mul_u32_u24 v9, 1280, v7
    v_lshl_add_u32 v9, v6, 4, v9
    v_mov_b32 v20, 0x3f803f80
    buffer_load_dwordx4 v[32:35], v9, s[16:19], 0 offen offset:0 nt
    buffer_load_dwordx4 v[36:39], v9, s[16:19], 0 offen offset:128 nt
    buffer_load_dwordx4 v[40:43], v9, s[16:19], 0 offen offset:256 nt
    buffer_load_dwordx4 v[44:47], v9, s[16:19], 0 offen offset:384 nt
    buffer_load_dwordx4 v[48:51], v9, s[16:19], 0 offen offset:512 nt
    buffer_load_dwordx4 v[52:55], v9, s[16:19], 0 offen offset:640 nt
    buffer_load_dwordx4 v[56:59], v9, s[16:19], 0 offen offset:768 nt
    buffer_load_dwordx4 v[60:63], v9, s[16:19], 0 offen offset:896 nt
    buffer_load_dwordx4 v[64:67], v9, s[16:19], 0 offen offset:1024 nt
    buffer_load_dwordx4 v[68:71], v9, s[16:19], 0 offen offset:1152 nt
    v_and_b32 v21, 1, v5
    v_lshl_add_u32 v21, v6, 1, v21
    v_lshlrev_b32 v21, 7, v21
    v_lshrrev_b32 v22, 1, v5
    s_and_b32 s24, s21, 1
    s_lshl_b32 s24, s24, 2
    v_add_u32 v22, s24, v22
    v_xor_b32 v22, v22, v6
    v_lshl_add_u32 v21, v22, 4, v21
    s_lshr_b32 s25, s21, 1
    s_mul_i32 s25, s25, 20480
    s_add_u32 s25, s25, 2854912
    v_mov_b32 v10, 0
    v_mov_b32 v11, 0
    v_mov_b32 v12, 0
    v_mov_b32 v13, 0
    s_waitcnt vmcnt(9)
    v_dot2_f32_bf16 v10, v32, v20, v10
    v_dot2_f32_bf16 v11, v32, v32, v11
    v_dot2_f32_bf16 v12, v33, v20, v12
    v_dot2_f32_bf16 v13, v33, v33, v13
    v_dot2_f32_bf16 v10, v34, v20, v10
    v_dot2_f32_bf16 v11, v34, v34, v11
    v_dot2_f32_bf16 v12, v35, v20, v12
    v_dot2_f32_bf16 v13, v35, v35, v13
    v_mov_b32 v120, v32
    v_mov_b32 v121, v33
    v_mov_b32 v122, v34
    v_mov_b32 v123, v35
    v_mov_b32_dpp v120, v34 row_ror:8 row_mask:0xf bank_mask:0xc
    v_mov_b32_dpp v121, v35 row_ror:8 row_mask:0xf bank_mask:0xc
    v_mov_b32_dpp v122, v32 row_ror:8 row_mask:0xf bank_mask:0x3
    v_mov_b32_dpp v123, v33 row_ror:8 row_mask:0xf bank_mask:0x3
    s_add_u32 s26, s25, 0
    buffer_store_dwordx4 v[120:123], v21, s[28:31], s26 offen sc1
    s_waitcnt vmcnt(9)
    v_dot2_f32_bf16 v10, v36, v20, v10
    v_dot2_f32_bf16 v11, v36, v36, v11
    v_dot2_f32_bf16 v12, v37, v20, v12
    v_dot2_f32_bf16 v13, v37, v37, v13
    v_dot2_f32_bf16 v10, v38, v20, v10
    v_dot2_f32_bf16 v11, v38, v38, v11
    v_dot2_f32_bf16 v12, v39, v20, v12
    v_dot2_f32_bf16 v13, v39, v39, v13
    v_mov_b32 v124, v36
    v_mov_b32 v125, v37
    v_mov_b32 v126, v38
    v_mov_b32 v127, v39
    v_mov_b32_dpp v124, v38 row_ror:8 row_mask:0xf bank_mask:0xc
    v_mov_b32_dpp v125, v39 row_ror:8 row_mask:0xf bank_mask:0xc
    v_mov_b32_dpp v126, v36 row_ror:8 row_mask:0xf bank_mask:0x3
    v_mov_b32_dpp v127, v37 row_ror:8 row_mask:0xf bank_mask:0x3
    s_add_u32 s26, s25, 2048
    buffer_store_dwordx4 v[124:127], v21, s[28:31], s26 offen sc1
    s_waitcnt vmcnt(9)
    v_dot2_f32_bf16 v10, v40, v20, v10
    v_dot2_f32_bf16 v11, v40, v40, v11
    v_dot2_f32_bf16 v12, v41, v20, v12
    v_dot2_f32_bf16 v13, v41, v41, v13
    v_dot2_f32_bf16 v10, v42, v20, v10
    v_dot2_f32_bf16 v11, v42, v42, v11
    v_dot2_f32_bf16 v12, v43, v20, v12
    v_dot2_f32_bf16 v13, v43, v43, v13
    v_mov_b32 v120, v40
    v_mov_b32 v121, v41
    v_mov_b32 v122, v42
    v_mov_b32 v123, v43
    v_mov_b32_dpp v120, v42 row_ror:8 row_mask:0xf bank_mask:0xc
    v_mov_b32_dpp v121, v43 row_ror:8 row_mask:0xf bank_mask:0xc
    v_mov_b32_dpp v122, v40 row_ror:8 row_mask:0xf bank_mask:0x3
    v_mov_b32_dpp v123, v41 row_ror:8 row_mask:0xf bank_mask:0x3
    s_add_u32 s26, s25, 4096
    buffer_store_dwordx4 v[120:123], v21, s[28:31], s26 offen sc1
    s_waitcnt vmcnt(9)
    v_dot2_f32_bf16 v10, v44, v20, v10
    v_dot2_f32_bf16 v11, v44, v44, v11
    v_dot2_f32_bf16 v12, v45, v20, v12
    v_dot2_f32_bf16 v13, v45, v45, v13
    v_dot2_f32_bf16 v10, v46, v20, v10
    v_dot2_f32_bf16 v11, v46, v46, v11
    v_dot2_f32_bf16 v12, v47, v20, v12
    v_dot2_f32_bf16 v13, v47, v47, v13
    v_mov_b32 v124, v44
    v_mov_b32 v125, v45
    v_mov_b32 v126, v46
    v_mov_b32 v127, v47
    v_mov_b32_dpp v124, v46 row_ror:8 row_mask:0xf bank_mask:0xc
    v_mov_b32_dpp v125, v47 row_ror:8 row_mask:0xf bank_mask:0xc
    v_mov_b32_dpp v126, v44 row_ror:8 row_mask:0xf bank_mask:0x3
    v_mov_b32_dpp v127, v45 row_ror:8 row_mask:0xf bank_mask:0x3
    s_add_u32 s26, s25, 6144
    buffer_store_dwordx4 v[124:127], v21, s[28:31], s26 offen sc1
    s_waitcnt vmcnt(9)
    v_dot2_f32_bf16 v10, v48, v20, v10
    v_dot2_f32_bf16 v11, v48, v48, v11
    v_dot2_f32_bf16 v12, v49, v20, v12
    v_dot2_f32_bf16 v13, v49, v49, v13
    v_dot2_f32_bf16 v10, v50, v20, v10
    v_dot2_f32_bf16 v11, v50, v50, v11
    v_dot2_f32_bf16 v12, v51, v20, v12
    v_dot2_f32_bf16 v13, v51, v51, v13
    v_mov_b32 v120, v48
    v_mov_b32 v121, v49
    v_mov_b32 v122, v50
    v_mov_b32 v123, v51
    v_mov_b32_dpp v120, v50 row_ror:8 row_mask:0xf bank_mask:0xc
    v_mov_b32_dpp v121, v51 row_ror:8 row_mask:0xf bank_mask:0xc
    v_mov_b32_dpp v122, v48 row_ror:8 row_mask:0xf bank_mask:0x3
    v_mov_b32_dpp v123, v49 row_ror:8 row_mask:0xf bank_mask:0x3
    s_add_u32 s26, s25, 8192
    buffer_store_dwordx4 v[120:123], v21, s[28:31], s26 offen sc1
    s_waitcnt vmcnt(9)
    v_dot2_f32_bf16 v10, v52, v20, v10
    v_dot2_f32_bf16 v11, v52, v52, v11
    v_dot2_f32_bf16 v12, v53, v20, v12
    v_dot2_f32_bf16 v13, v53, v53, v13
    v_dot2_f32_bf16 v10, v54, v20, v10
    v_dot2_f32_bf16 v11, v54, v54, v11
    v_dot2_f32_bf16 v12, v55, v20, v12
    v_dot2_f32_bf16 v13, v55, v55, v13
    v_mov_b32 v124, v52
    v_mov_b32 v125, v53
    v_mov_b32 v126, v54
    v_mov_b32 v127, v55
    v_mov_b32_dpp v124, v54 row_ror:8 row_mask:0xf bank_mask:0xc
    v_mov_b32_dpp v125, v55 row_ror:8 row_mask:0xf bank_mask:0xc
    v_mov_b32_dpp v126, v52 row_ror:8 row_mask:0xf bank_mask:0x3
    v_mov_b32_dpp v127, v53 row_ror:8 row_mask:0xf bank_mask:0x3
    s_add_u32 s26, s25, 10240
    buffer_store_dwordx4 v[124:127], v21, s[28:31], s26 offen sc1
    s_waitcnt vmcnt(9)
    v_dot2_f32_bf16 v10, v56, v20, v10
    v_dot2_f32_bf16 v11, v56, v56, v11
    v_dot2_f32_bf16 v12, v57, v20, v12
    v_dot2_f32_bf16 v13, v57, v57, v13
    v_dot2_f32_bf16 v10, v58, v20, v10
    v_dot2_f32_bf16 v11, v58, v58, v11
    v_dot2_f32_bf16 v12, v59, v20, v12
    v_dot2_f32_bf16 v13, v59, v59, v13
    v_mov_b32 v120, v56
    v_mov_b32 v121, v57
    v_mov_b32 v122, v58
    v_mov_b32 v123, v59
    v_mov_b32_dpp v120, v58 row_ror:8 row_mask:0xf bank_mask:0xc
    v_mov_b32_dpp v121, v59 row_ror:8 row_mask:0xf bank_mask:0xc
    v_mov_b32_dpp v122, v56 row_ror:8 row_mask:0xf bank_mask:0x3
    v_mov_b32_dpp v123, v57 row_ror:8 row_mask:0xf bank_mask:0x3
    s_add_u32 s26, s25, 12288
    buffer_store_dwordx4 v[120:123], v21, s[28:31], s26 offen sc1
    s_waitcnt vmcnt(9)
    v_dot2_f32_bf16 v10, v60, v20, v10
    v_dot2_f32_bf16 v11, v60, v60, v11
    v_dot2_f32_bf16 v12, v61, v20, v12
    v_dot2_f32_bf16 v13, v61, v61, v13
    v_dot2_f32_bf16 v10, v62, v20, v10
    v_dot2_f32_bf16 v11, v62, v62, v11
    v_dot2_f32_bf16 v12, v63, v20, v12
    v_dot2_f32_bf16 v13, v63, v63, v13
    v_mov_b32 v124, v60
    v_mov_b32 v125, v61
    v_mov_b32 v126, v62
    v_mov_b32 v127, v63
    v_mov_b32_dpp v124, v62 row_ror:8 row_mask:0xf bank_mask:0xc
    v_mov_b32_dpp v125, v63 row_ror:8 row_mask:0xf bank_mask:0xc
    v_mov_b32_dpp v126, v60 row_ror:8 row_mask:0xf bank_mask:0x3
    v_mov_b32_dpp v127, v61 row_ror:8 row_mask:0xf bank_mask:0x3
    s_add_u32 s26, s25, 14336
    buffer_store_dwordx4 v[124:127], v21, s[28:31], s26 offen sc1
    s_waitcnt vmcnt(9)
    v_dot2_f32_bf16 v10, v64, v20, v10
    v_dot2_f32_bf16 v11, v64, v64, v11
    v_dot2_f32_bf16 v12, v65, v20, v12
    v_dot2_f32_bf16 v13, v65, v65, v13
    v_dot2_f32_bf16 v10, v66, v20, v10
    v_dot2_f32_bf16 v11, v66, v66, v11
    v_dot2_f32_bf16 v12, v67, v20, v12
    v_dot2_f32_bf16 v13, v67, v67, v13
    v_mov_b32 v120, v64
    v_mov_b32 v121, v65
    v_mov_b32 v122, v66
    v_mov_b32 v123, v67
    v_mov_b32_dpp v120, v66 row_ror:8 row_mask:0xf bank_mask:0xc
    v_mov_b32_dpp v121, v67 row_ror:8 row_mask:0xf bank_mask:0xc
    v_mov_b32_dpp v122, v64 row_ror:8 row_mask:0xf bank_mask:0x3
    v_mov_b32_dpp v123, v65 row_ror:8 row_mask:0xf bank_mask:0x3
    s_add_u32 s26, s25, 16384
    buffer_store_dwordx4 v[120:123], v21, s[28:31], s26 offen sc1
    s_waitcnt vmcnt(9)
    v_dot2_f32_bf16 v10, v68, v20, v10
    v_dot2_f32_bf16 v11, v68, v68, v11
    v_dot2_f32_bf16 v12, v69, v20, v12
    v_dot2_f32_bf16 v13, v69, v69, v13
    v_dot2_f32_bf16 v10, v70, v20, v10
    v_dot2_f32_bf16 v11, v70, v70, v11
    v_dot2_f32_bf16 v12, v71, v20, v12
    v_dot2_f32_bf16 v13, v71, v71, v13
    v_mov_b32 v124, v68
    v_mov_b32 v125, v69
    v_mov_b32 v126, v70
    v_mov_b32 v127, v71
    v_mov_b32_dpp v124, v70 row_ror:8 row_mask:0xf bank_mask:0xc
    v_mov_b32_dpp v125, v71 row_ror:8 row_mask:0xf bank_mask:0xc
    v_mov_b32_dpp v126, v68 row_ror:8 row_mask:0xf bank_mask:0x3
    v_mov_b32_dpp v127, v69 row_ror:8 row_mask:0xf bank_mask:0x3
    s_add_u32 s26, s25, 18432
    buffer_store_dwordx4 v[124:127], v21, s[28:31], s26 offen sc1
    s_nop 2
    v_add_f32 v10, v10, v12
    v_add_f32 v11, v11, v13
    s_nop 1
    v_add_f32_dpp v10, v10, v10 quad_perm:[1,0,3,2] row_mask:0xf bank_mask:0xf
    v_add_f32_dpp v11, v11, v11 quad_perm:[1,0,3,2] row_mask:0xf bank_mask:0xf
    s_nop 1
    v_add_f32_dpp v10, v10, v10 quad_perm:[2,3,0,1] row_mask:0xf bank_mask:0xf
    v_add_f32_dpp v11, v11, v11 quad_perm:[2,3,0,1] row_mask:0xf bank_mask:0xf
    s_nop 1
    v_add_f32_dpp v10, v10, v10 row_half_mirror row_mask:0xf bank_mask:0xf
    v_add_f32_dpp v11, v11, v11 row_half_mirror row_mask:0xf bank_mask:0xf
    v_mul_f32 v10, 0x3acccccd, v10
    s_nop 0
    v_mul_f32 v11, 0x3acccccd, v11
    s_nop 0
    v_fma_f32 v11, -v10, v10, v11
    s_nop 0
    v_max_f32 v11, 0, v11
    s_nop 0
    v_cvt_pk_bf16_f32 v24, v10, v11
    s_nop 0
    v_lshlrev_b32 v10, 16, v24
    s_nop 0
    v_and_b32 v11, 0xffff0000, v24
    s_nop 0
    v_add_f32 v11, 0x3727c5ac, v11
    s_nop 0
    v_cvt_pk_bf16_f32 v24, v11, v11
    s_nop 0
    v_lshlrev_b32 v11, 16, v24
    s_nop 0
    v_sqrt_f32 v11, v11
    s_nop 0
    s_nop 0
    s_nop 0
    v_cvt_pk_bf16_f32 v24, v11, v11
    s_nop 0
    v_lshlrev_b32 v11, 16, v24
    s_nop 0
    v_rcp_f32 v11, v11
    s_nop 0
    s_nop 0
    s_nop 0
    v_mul_f32 v10, v10, v11
    s_nop 0
    v_sub_f32 v10, 0, v10
    s_nop 0
    v_lshlrev_b32 v7, 3, v7
    v_cmp_eq_u32 vcc, 0, v6
    s_mov_b32 s23, 5476352
    s_and_saveexec_b64 s[66:67], vcc
    buffer_store_dwordx2 v[10:11], v7, s[28:31], s23 offen sc1
    s_endpgm
p_misc:
    s_lshr_b32 s22, s21, 3
    s_mov_b32 s23, s21
    s_cmp_eq_u32 s20, 2
    s_cbranch_scc1 k0_kernel_m33
    s_cmp_ge_u32 s21, 64
    s_cbranch_scc1 k0_end
    s_add_u32 s22, s22, 24
    s_add_u32 s23, s23, 192
k0_kernel_m33:
    v_lshlrev_b32 v1, 4, v1
    v_mov_b32 v60, 0
    v_mov_b32 v61, 0
    v_mov_b32 v62, 0
    v_mov_b32 v63, 0
    s_lshl_b32 s24, s23, 10
    s_add_u32 s25, s24, 29380608
    s_add_u32 s26, s24, 10784768
    s_add_u32 s27, s24, 13365248
    s_cmp_ge_u32 s23, 20
    s_cselect_b32 s26, s27, s26
    s_cmp_ge_u32 s23, 256
    s_cbranch_scc1 k0_kernel_nz4
    buffer_store_dwordx4 v[60:63], v1, s[28:31], s25 offen sc1
k0_kernel_nz4:
    s_cmp_ge_u32 s23, 40
    s_cbranch_scc1 k0_kernel_nz5
    buffer_store_dwordx4 v[60:63], v1, s[28:31], s26 offen sc1
k0_kernel_nz5:
    s_mov_b32 s16, s56
    s_mov_b32 s17, s57
    s_mov_b32 s18, 2621440
    s_mov_b32 s19, 0x00020000
    s_and_b32 s24, s2, 7
    s_mul_i32 s24, s24, 327680
    s_mul_i32 s21, s22, 10240
    s_add_u32 s21, s21, s24
    buffer_load_dwordx4 v[8:11], v1, s[16:19], s21 offen offset:0 nt
    buffer_load_dwordx4 v[12:15], v1, s[16:19], s21 offen offset:1024 nt
    buffer_load_dwordx4 v[16:19], v1, s[16:19], s21 offen offset:2048 nt
    buffer_load_dwordx4 v[20:23], v1, s[16:19], s21 offen offset:3072 nt
    s_add_u32 s21, s21, 4096
    buffer_load_dwordx4 v[24:27], v1, s[16:19], s21 offen offset:0 nt
    buffer_load_dwordx4 v[28:31], v1, s[16:19], s21 offen offset:1024 nt
    buffer_load_dwordx4 v[32:35], v1, s[16:19], s21 offen offset:2048 nt
    buffer_load_dwordx4 v[36:39], v1, s[16:19], s21 offen offset:3072 nt
    s_add_u32 s21, s21, 4096
    buffer_load_dwordx4 v[40:43], v1, s[16:19], s21 offen offset:0 nt
    buffer_load_dwordx4 v[44:47], v1, s[16:19], s21 offen offset:1024 nt
    s_getpc_b64 s[24:25]
k0_pcref:
    s_sub_u32 s24, s24, k0_pcref-k0_kernel
    s_subb_u32 s25, s25, 0
    s_lshl_b32 s23, s22, 11
    s_add_u32 s26, s23, 0
    s_min_u32 s26, s26, (chain_end-k0_kernel-1020)&0xfffffff0
    v_add_u32 v64, s26, v1
    v_mov_b32 v5, s25
    v_add_co_u32 v4, vcc, s24, v64
    v_addc_co_u32 v5, vcc, 0, v5, vcc
    global_load_dwordx4 v[72:75], v[4:5], off
    s_add_u32 s26, s23, 1024
    s_min_u32 s26, s26, (chain_end-k0_kernel-1020)&0xfffffff0
    v_add_u32 v64, s26, v1
    v_mov_b32 v5, s25
    v_add_co_u32 v4, vcc, s24, v64
    v_addc_co_u32 v5, vcc, 0, v5, vcc
    global_load_dwordx4 v[76:79], v[4:5], off
    s_waitcnt vmcnt(0)
    s_endpgm
.globl k1_kernel
.p2align 8
.type k1_kernel,@function
k1_kernel:
    s_cmp_ge_u32 s2, 256
    s_cbranch_scc1 k1_end
    s_mov_b32 s99, s2
    s_load_dwordx4 s[4:7], s[0:1], 32
    s_load_dwordx2 s[10:11], s[0:1], 120
    s_load_dwordx8 s[12:19], s[0:1], 56
    s_load_dwordx2 s[60:61], s[0:1], 0
    s_load_dwordx2 s[62:63], s[0:1], 96
    s_load_dwordx2 s[52:53], s[0:1], 88
    v_lshrrev_b32 v2, 6, v0
    v_and_b32 v1, 63, v0
    v_readfirstlane_b32 s20, v2
    s_and_b32 s58, s2, 7
    s_lshr_b32 s59, s2, 3
    s_waitcnt lgkmcnt(0)
    s_mov_b32 s28, s10
    s_mov_b32 s29, s11
    s_mov_b32 s30, 268435456
    s_mov_b32 s31, 0x00020000
    s_mov_b32 s46, 1
    s_cmp_ge_u32 s59, 20
    s_cbranch_scc1 k1_help
    s_mul_i32 s2, s58, 20
    s_add_u32 s2, s2, s59
    s_setprio 3
    s_mov_b32 s24, s4
    s_mov_b32 s25, s5
    s_mov_b32 s26, 2621440
    s_mov_b32 s27, 0x00020000
    s_lshl_b32 s21, s2, 3
    s_add_u32 s22, s6, s21
    s_addc_u32 s23, s7, 0
    s_load_dwordx2 s[32:33], s[22:23], 0
    s_lshl_b32 s21, s2, 2
    s_add_u32 s21, s21, s20
    s_mul_i32 s34, s20, 13824
    v_lshlrev_b32 v3, 4, v1
    s_lshl_b32 s35, s21, 12
    s_add_u32 s36, s34, 256
    s_mov_b32 m0, s36
    s_mul_i32 s37, s21, 4352
    s_add_u32 s37, s37, 0
    buffer_load_dwordx4 v3, s[24:27], s35 offen offset:0 lds
    buffer_load_dwordx4 v3, s[24:27], s35 offen offset:1024 lds
    buffer_load_dwordx4 v3, s[24:27], s35 offen offset:2048 lds
    buffer_load_dwordx4 v3, s[24:27], s35 offen offset:3072 lds
    s_add_u32 s36, s34, 9728
    s_mov_b32 m0, s36
    s_add_u32 s40, s35, 8
    v_mov_b32 v16, 0
    buffer_load_dwordx4 v3, s[24:27], s40 offen offset:0 lds
    buffer_load_dwordx4 v3, s[24:27], s40 offen offset:1024 lds
    buffer_load_dwordx4 v3, s[24:27], s40 offen offset:2048 lds
    buffer_load_dwordx4 v3, s[24:27], s40 offen offset:3072 lds
    buffer_load_dwordx2 v[18:19], v16, s[24:27], s35 offen
    v_lshrrev_b32 v4, 3, v0
    v_mul_u32_u24 v4, 20480, v4
    s_lshr_b32 s38, s2, 1
    s_and_b32 s38, s38, 7
    v_and_b32 v5, 7, v0
    v_xor_b32 v5, s38, v5
    v_lshl_add_u32 v4, v5, 4, v4
    s_lshl_b32 s38, s2, 7
    s_add_u32 s36, s34, 4352
    s_mov_b32 m0, s36
    s_nop 0
    buffer_load_dwordx4 v3, s[28:31], s37 offen offset:0 lds
    buffer_load_dwordx4 v3, s[28:31], s37 offen offset:1024 lds
    buffer_load_dwordx4 v3, s[28:31], s37 offen offset:2048 lds
    buffer_load_dwordx4 v3, s[28:31], s37 offen offset:3072 lds
    s_add_u32 s36, s34, 8448
    s_mov_b32 m0, s36
    s_add_u32 s37, s37, 4096
    buffer_load_dwordx4 v3, s[28:31], s37 offen lds
    s_lshl_b32 s22, s2, 4
    s_add_u32 s22, s22, 2793472
    s_add_u32 s22, s10, s22
    s_addc_u32 s23, s11, 0
    s_load_dwordx4 s[68:71], s[22:23], 0
    s_load_dwordx4 s[72:75], s[22:23], 2560
    s_load_dwordx4 s[76:79], s[22:23], 5120
    s_load_dwordx4 s[80:83], s[22:23], 15360
    s_load_dwordx4 s[84:87], s[22:23], 17920
    s_load_dwordx4 s[12:15], s[22:23], 20480
    s_load_dwordx4 s[16:19], s[22:23], 30720
    s_load_dwordx4 s[48:51], s[22:23], 33280
    s_load_dwordx4 s[52:55], s[22:23], 35840
    s_load_dwordx4 s[56:59], s[22:23], 46080
    s_load_dwordx4 s[60:63], s[22:23], 48640
    s_load_dwordx4 s[64:67], s[22:23], 51200
    v_lshl_add_u32 v5, v1, 2, s34
    v_mov_b32 v6, 0
    ds_write_b32 v5, v6
    ds_write_b32 v5, v6 offset:9472
    v_and_b32 v7, 15, v1
    v_bfe_u32 v8, v1, 4, 1
    v_lshrrev_b32 v9, 5, v1
    v_mul_u32_u24 v10, 272, v7
    v_lshl_add_u32 v10, v9, 4, v10
    v_add_u32 v10, s34, v10
    v_add_u32 v10, 4356, v10
    v_lshlrev_b32 v11, 2, v8
    v_sub_u32 v10, v10, v11
    v_and_b32 v12, 7, v1
    v_mul_u32_u24 v13, 272, v12
    v_lshl_add_u32 v13, v9, 4, v13
    v_add_u32 v13, s34, v13
    v_add_u32 v13, 4356, v13
    v_sub_u32 v13, v13, v11
    v_bfe_u32 v11, v1, 3, 1
    v_lshlrev_b32 v11, 4, v11
    v_sub_u32 v11, 16, v11
    v_and_b32 v14, 31, v1
    v_lshlrev_b32 v14, 3, v14
    v_lshl_add_u32 v14, v9, 4, v14
    v_add_u32 v14, s34, v14
    v_and_b32 v17, 1, v1
    v_mul_u32_u24 v17, 9464, v17
    v_sub_u32 v17, 9472, v17
    v_add_u32 v14, v17, v14
    v_cmp_ne_u32 vcc, 0, v12
    v_mov_b32 v16, 0
    s_nop 1
    v_cndmask_b32 v15, v16, -1, vcc
    s_waitcnt lgkmcnt(0)
    v_mov_b32 v32, s68
    v_mov_b32 v33, s69
    v_mov_b32 v34, s70
    v_mov_b32 v35, s71
    v_mov_b32 v48, s72
    v_mov_b32 v49, s73
    v_mov_b32 v50, s74
    v_mov_b32 v51, s75
    v_mov_b32 v64, s76
    v_mov_b32 v65, s77
    v_mov_b32 v66, s78
    v_mov_b32 v67, s79
    v_add_f32 v32, s80, v32
    v_add_f32 v33, s81, v33
    v_add_f32 v34, s82, v34
    v_add_f32 v35, s83, v35
    v_add_f32 v48, s84, v48
    v_add_f32 v49, s85, v49
    v_add_f32 v50, s86, v50
    v_add_f32 v51, s87, v51
    v_add_f32 v64, s12, v64
    v_add_f32 v65, s13, v65
    v_add_f32 v66, s14, v66
    v_add_f32 v67, s15, v67
    v_add_f32 v32, s16, v32
    v_add_f32 v33, s17, v33
    v_add_f32 v34, s18, v34
    v_add_f32 v35, s19, v35
    v_add_f32 v48, s48, v48
    v_add_f32 v49, s49, v49
    v_add_f32 v50, s50, v50
    v_add_f32 v51, s51, v51
    v_add_f32 v64, s52, v64
    v_add_f32 v65, s53, v65
    v_add_f32 v66, s54, v66
    v_add_f32 v67, s55, v67
    v_add_f32 v32, s56, v32
    v_add_f32 v33, s57, v33
    v_add_f32 v34, s58, v34
    v_add_f32 v35, s59, v35
    v_add_f32 v48, s60, v48
    v_add_f32 v49, s61, v49
    v_add_f32 v50, s62, v50
    v_add_f32 v51, s63, v51
    v_add_f32 v64, s64, v64
    v_add_f32 v65, s65, v65
    v_add_f32 v66, s66, v66
    v_add_f32 v67, s67, v67
    v_cvt_pk_bf16_f32 v36, v32, v33
    v_lshlrev_b32 v32, 16, v36
    v_and_b32 v33, 0xffff0000, v36
    v_cvt_pk_bf16_f32 v36, v34, v35
    v_lshlrev_b32 v34, 16, v36
    v_and_b32 v35, 0xffff0000, v36
    v_cvt_pk_bf16_f32 v52, v48, v49
    v_lshlrev_b32 v48, 16, v52
    v_and_b32 v49, 0xffff0000, v52
    v_cvt_pk_bf16_f32 v52, v50, v51
    v_lshlrev_b32 v50, 16, v52
    v_and_b32 v51, 0xffff0000, v52
    v_cvt_pk_bf16_f32 v68, v64, v65
    v_lshlrev_b32 v64, 16, v68
    v_and_b32 v65, 0xffff0000, v68
    v_cvt_pk_bf16_f32 v68, v66, v67
    v_lshlrev_b32 v66, 16, v68
    v_and_b32 v67, 0xffff0000, v68
    v_add_f32 v48, 1.0, v48
    v_add_f32 v49, 1.0, v49
    v_add_f32 v50, 1.0, v50
    v_add_f32 v51, 1.0, v51
    v_cvt_pk_bf16_f32 v52, v48, v49
    v_lshlrev_b32 v48, 16, v52
    v_and_b32 v49, 0xffff0000, v52
    v_cvt_pk_bf16_f32 v52, v50, v51
    v_lshlrev_b32 v50, 16, v52
    v_and_b32 v51, 0xffff0000, v52
    v_mul_f32 v240, v48, v64
    v_mul_f32 v244, v32, v64
    v_mul_f32 v241, v49, v65
    v_mul_f32 v245, v33, v65
    v_mul_f32 v242, v50, v66
    v_mul_f32 v246, v34, v66
    v_mul_f32 v243, v51, v67
    v_mul_f32 v247, v35, v67
    s_add_u32 s36, s34, 9720
    v_mov_b32 v17, s36
    s_waitcnt vmcnt(0)
    s_mov_b64 exec, 1
    ds_write_b64 v17, v[18:19]
    s_mov_b64 exec, -1
    s_waitcnt lgkmcnt(0)
    ds_read_b128 v[176:179], v14 offset:1792
    ds_read_b128 v[180:183], v14 offset:1824
    ds_read_b128 v[184:187], v14 offset:1856
    ds_read_b128 v[188:191], v14 offset:1888
    ds_read_b128 v[192:195], v14 offset:1920
    ds_read_b128 v[196:199], v14 offset:1952
    ds_read_b128 v[200:203], v14 offset:1984
    ds_read_b128 v[204:207], v14 offset:2016
    ds_read2_b32 v[64:65], v10 offset0:0 offset1:1
    ds_read2_b32 v[66:67], v10 offset0:2 offset1:3
    ds_read2_b32 v[68:69], v10 offset0:8 offset1:9
    ds_read2_b32 v[70:71], v10 offset0:10 offset1:11
    ds_read2_b32 v[72:73], v10 offset0:16 offset1:17
    ds_read2_b32 v[74:75], v10 offset0:18 offset1:19
    ds_read2_b32 v[76:77], v10 offset0:24 offset1:25
    ds_read2_b32 v[78:79], v10 offset0:26 offset1:27
    ds_read2_b32 v[80:81], v10 offset0:32 offset1:33
    ds_read2_b32 v[82:83], v10 offset0:34 offset1:35
    ds_read2_b32 v[84:85], v10 offset0:40 offset1:41
    ds_read2_b32 v[86:87], v10 offset0:42 offset1:43
    ds_read2_b32 v[88:89], v10 offset0:48 offset1:49
    ds_read2_b32 v[90:91], v10 offset0:50 offset1:51
    ds_read2_b32 v[92:93], v10 offset0:56 offset1:57
    ds_read2_b32 v[94:95], v10 offset0:58 offset1:59
    s_waitcnt lgkmcnt(0)
    v_mfma_f32_32x32x16_bf16 v[144:159], v[176:179], v[64:67], 0
    ds_read_b32 v16, v10 offset:16
    ds_read_b32 v17, v10 offset:48
    ds_read_b32 v18, v10 offset:80
    ds_read_b32 v19, v10 offset:112
    ds_read_b32 v20, v10 offset:144
    ds_read_b32 v21, v10 offset:176
    ds_read_b32 v22, v10 offset:208
    ds_read_b32 v23, v10 offset:240
    ds_read2_b32 v[96:97], v13 offset0:0 offset1:1
    ds_read2_b32 v[98:99], v13 offset0:2 offset1:3
    ds_read_b32 v24, v13 offset:16
    ds_read2_b32 v[100:101], v13 offset0:8 offset1:9
    ds_read2_b32 v[102:103], v13 offset0:10 offset1:11
    ds_read_b32 v25, v13 offset:48
    ds_read2_b32 v[104:105], v13 offset0:16 offset1:17
    ds_read2_b32 v[106:107], v13 offset0:18 offset1:19
    v_mfma_f32_32x32x16_bf16 v[144:159], v[180:183], v[68:71], v[144:159]
    ds_read_b32 v26, v13 offset:80
    ds_read2_b32 v[108:109], v13 offset0:24 offset1:25
    ds_read2_b32 v[110:111], v13 offset0:26 offset1:27
    ds_read_b32 v27, v13 offset:112
    ds_read2_b32 v[112:113], v13 offset0:32 offset1:33
    ds_read2_b32 v[114:115], v13 offset0:34 offset1:35
    ds_read_b32 v28, v13 offset:144
    ds_read2_b32 v[116:117], v13 offset0:40 offset1:41
    ds_read2_b32 v[118:119], v13 offset0:42 offset1:43
    ds_read_b32 v29, v13 offset:176
    ds_read2_b32 v[120:121], v13 offset0:48 offset1:49
    ds_read2_b32 v[122:123], v13 offset0:50 offset1:51
    ds_read_b32 v30, v13 offset:208
    ds_read2_b32 v[124:125], v13 offset0:56 offset1:57
    ds_read2_b32 v[126:127], v13 offset0:58 offset1:59
    ds_read_b32 v31, v13 offset:240
    v_mfma_f32_32x32x16_bf16 v[144:159], v[184:187], v[72:75], v[144:159]
    s_waitcnt lgkmcnt(15)
    s_waitcnt lgkmcnt(0)
    v_alignbit_b32 v32, v65, v64, 16
    v_alignbit_b32 v33, v66, v65, 16
    v_alignbit_b32 v34, v67, v66, 16
    v_alignbit_b32 v35, v16, v67, 16
    v_mfma_f32_32x32x16_bf16 v[144:159], v[188:191], v[76:79], v[144:159]
    v_alignbit_b32 v36, v69, v68, 16
    v_alignbit_b32 v37, v70, v69, 16
    v_alignbit_b32 v38, v71, v70, 16
    v_alignbit_b32 v39, v17, v71, 16
    v_alignbit_b32 v40, v73, v72, 16
    v_alignbit_b32 v41, v74, v73, 16
    v_mfma_f32_32x32x16_bf16 v[144:159], v[192:195], v[80:83], v[144:159]
    v_alignbit_b32 v42, v75, v74, 16
    v_alignbit_b32 v43, v18, v75, 16
    v_alignbit_b32 v44, v77, v76, 16
    v_alignbit_b32 v45, v78, v77, 16
    v_alignbit_b32 v46, v79, v78, 16
    v_alignbit_b32 v47, v19, v79, 16
    v_mfma_f32_32x32x16_bf16 v[144:159], v[196:199], v[84:87], v[144:159]
    v_alignbit_b32 v48, v81, v80, 16
    v_alignbit_b32 v49, v82, v81, 16
    v_alignbit_b32 v50, v83, v82, 16
    v_alignbit_b32 v51, v20, v83, 16
    v_alignbit_b32 v52, v85, v84, 16
    v_alignbit_b32 v53, v86, v85, 16
    v_mfma_f32_32x32x16_bf16 v[144:159], v[200:203], v[88:91], v[144:159]
    v_alignbit_b32 v54, v87, v86, 16
    v_alignbit_b32 v55, v21, v87, 16
    v_alignbit_b32 v56, v89, v88, 16
    v_alignbit_b32 v57, v90, v89, 16
    v_alignbit_b32 v58, v91, v90, 16
    v_alignbit_b32 v59, v22, v91, 16
    v_mfma_f32_32x32x16_bf16 v[144:159], v[204:207], v[92:95], v[144:159]
    v_alignbit_b32 v60, v93, v92, 16
    v_alignbit_b32 v61, v94, v93, 16
    v_alignbit_b32 v62, v95, v94, 16
    v_alignbit_b32 v63, v23, v95, 16
    s_nop 0
    v_mfma_f32_32x32x16_bf16 v[128:143], v[176:179], v[32:35], 0
    ds_read_b128 v[208:211], v14 offset:3840
    s_nop 3
    v_mfma_f32_32x32x16_bf16 v[128:143], v[180:183], v[36:39], v[128:143]
    ds_read_b128 v[212:215], v14 offset:3872
    s_nop 3
    v_mfma_f32_32x32x16_bf16 v[128:143], v[184:187], v[40:43], v[128:143]
    ds_read_b128 v[216:219], v14 offset:3904
    v_alignbit_b32 v96, v97, v96, v11
    v_alignbit_b32 v97, v98, v97, v11
    v_alignbit_b32 v98, v99, v98, v11
    v_alignbit_b32 v99, v24, v99, v11
    v_alignbit_b32 v100, v101, v100, v11
    v_alignbit_b32 v101, v102, v101, v11
    v_alignbit_b32 v102, v103, v102, v11
    v_alignbit_b32 v103, v25, v103, v11
    v_alignbit_b32 v104, v105, v104, v11
    v_mfma_f32_32x32x16_bf16 v[128:143], v[188:191], v[44:47], v[128:143]
    ds_read_b128 v[220:223], v14 offset:3936
    v_alignbit_b32 v105, v106, v105, v11
    v_alignbit_b32 v106, v107, v106, v11
    v_alignbit_b32 v107, v26, v107, v11
    v_alignbit_b32 v108, v109, v108, v11
    v_alignbit_b32 v109, v110, v109, v11
    v_alignbit_b32 v110, v111, v110, v11
    v_alignbit_b32 v111, v27, v111, v11
    v_mov_b32_dpp v144, v144 row_shr:1 row_mask:0xf bank_mask:0xf bound_ctrl:0
    v_mfma_f32_32x32x16_bf16 v[128:143], v[192:195], v[48:51], v[128:143]
    ds_read_b128 v[224:227], v14 offset:3968
    v_mov_b32_dpp v145, v145 row_shr:1 row_mask:0xf bank_mask:0xf bound_ctrl:0
    v_mov_b32_dpp v146, v146 row_shr:1 row_mask:0xf bank_mask:0xf bound_ctrl:0
    v_mov_b32_dpp v147, v147 row_shr:1 row_mask:0xf bank_mask:0xf bound_ctrl:0
    v_mov_b32_dpp v148, v148 row_shr:1 row_mask:0xf bank_mask:0xf bound_ctrl:0
    v_mov_b32_dpp v149, v149 row_shr:1 row_mask:0xf bank_mask:0xf bound_ctrl:0
    v_mov_b32_dpp v150, v150 row_shr:1 row_mask:0xf bank_mask:0xf bound_ctrl:0
    v_mov_b32_dpp v151, v151 row_shr:1 row_mask:0xf bank_mask:0xf bound_ctrl:0
    v_mov_b32_dpp v152, v152 row_shr:1 row_mask:0xf bank_mask:0xf bound_ctrl:0
    v_mfma_f32_32x32x16_bf16 v[128:143], v[196:199], v[52:55], v[128:143]
    ds_read_b128 v[228:231], v14 offset:4000
    v_mov_b32_dpp v153, v153 row_shr:1 row_mask:0xf bank_mask:0xf bound_ctrl:0
    v_mov_b32_dpp v154, v154 row_shr:1 row_mask:0xf bank_mask:0xf bound_ctrl:0
    v_mov_b32_dpp v155, v155 row_shr:1 row_mask:0xf bank_mask:0xf bound_ctrl:0
    v_mov_b32_dpp v156, v156 row_shr:1 row_mask:0xf bank_mask:0xf bound_ctrl:0
    v_mov_b32_dpp v157, v157 row_shr:1 row_mask:0xf bank_mask:0xf bound_ctrl:0
    v_mov_b32_dpp v158, v158 row_shr:1 row_mask:0xf bank_mask:0xf bound_ctrl:0
    v_mov_b32_dpp v159, v159 row_shr:1 row_mask:0xf bank_mask:0xf bound_ctrl:0
    v_alignbit_b32 v112, v113, v112, v11
    v_mfma_f32_32x32x16_bf16 v[128:143], v[200:203], v[56:59], v[128:143]
    ds_read_b128 v[232:235], v14 offset:4032
    v_alignbit_b32 v113, v114, v113, v11
    v_alignbit_b32 v114, v115, v114, v11
    v_alignbit_b32 v115, v28, v115, v11
    v_alignbit_b32 v116, v117, v116, v11
    v_alignbit_b32 v117, v118, v117, v11
    v_alignbit_b32 v118, v119, v118, v11
    v_alignbit_b32 v119, v29, v119, v11
    v_alignbit_b32 v120, v121, v120, v11
    v_mfma_f32_32x32x16_bf16 v[128:143], v[204:207], v[60:63], v[128:143]
    ds_read_b128 v[236:239], v14 offset:4064
    v_alignbit_b32 v121, v122, v121, v11
    v_alignbit_b32 v122, v123, v122, v11
    v_alignbit_b32 v123, v30, v123, v11
    v_alignbit_b32 v124, v125, v124, v11
    v_alignbit_b32 v125, v126, v125, v11
    v_alignbit_b32 v126, v127, v126, v11
    v_alignbit_b32 v127, v31, v127, v11
    s_nop 0
    s_waitcnt lgkmcnt(0)
    v_mfma_f32_32x32x16_bf16 v[160:175], v[208:211], v[96:99], 0
    ds_read_b128 v[176:179], v14 offset:1536
    ds_read_b128 v[180:183], v14 offset:1568
    s_nop 2
    v_mfma_f32_32x32x16_bf16 v[160:175], v[212:215], v[100:103], v[160:175]
    ds_read_b128 v[184:187], v14 offset:1600
    ds_read_b128 v[188:191], v14 offset:1632
    s_nop 2
    v_mfma_f32_32x32x16_bf16 v[160:175], v[216:219], v[104:107], v[160:175]
    ds_read_b128 v[192:195], v14 offset:1664
    ds_read_b128 v[196:199], v14 offset:1696
    v_mov_b32_dpp v128, v128 row_shr:1 row_mask:0xf bank_mask:0xf bound_ctrl:0
    v_mov_b32_dpp v129, v129 row_shr:1 row_mask:0xf bank_mask:0xf bound_ctrl:0
    v_mov_b32_dpp v130, v130 row_shr:1 row_mask:0xf bank_mask:0xf bound_ctrl:0
    v_mfma_f32_32x32x16_bf16 v[160:175], v[220:223], v[108:111], v[160:175]
    ds_read_b128 v[200:203], v14 offset:1728
    v_mov_b32_dpp v131, v131 row_shr:1 row_mask:0xf bank_mask:0xf bound_ctrl:0
    v_mov_b32_dpp v132, v132 row_shr:1 row_mask:0xf bank_mask:0xf bound_ctrl:0
    v_mov_b32_dpp v133, v133 row_shr:1 row_mask:0xf bank_mask:0xf bound_ctrl:0
    v_mfma_f32_32x32x16_bf16 v[160:175], v[224:227], v[112:115], v[160:175]
    ds_read_b128 v[204:207], v14 offset:1760
    v_mov_b32_dpp v134, v134 row_shr:1 row_mask:0xf bank_mask:0xf bound_ctrl:0
    v_mov_b32_dpp v135, v135 row_shr:1 row_mask:0xf bank_mask:0xf bound_ctrl:0
    v_mov_b32_dpp v136, v136 row_shr:1 row_mask:0xf bank_mask:0xf bound_ctrl:0
    v_mfma_f32_32x32x16_bf16 v[160:175], v[228:231], v[116:119], v[160:175]
    v_mov_b32_dpp v137, v137 row_shr:1 row_mask:0xf bank_mask:0xf bound_ctrl:0
    v_mov_b32_dpp v138, v138 row_shr:1 row_mask:0xf bank_mask:0xf bound_ctrl:0
    v_mov_b32_dpp v139, v139 row_shr:1 row_mask:0xf bank_mask:0xf bound_ctrl:0
    v_mfma_f32_32x32x16_bf16 v[160:175], v[232:235], v[120:123], v[160:175]
    v_mov_b32_dpp v140, v140 row_shr:1 row_mask:0xf bank_mask:0xf bound_ctrl:0
    v_mov_b32_dpp v141, v141 row_shr:1 row_mask:0xf bank_mask:0xf bound_ctrl:0
    v_mfma_f32_32x32x16_bf16 v[160:175], v[236:239], v[124:127], v[160:175]
    v_mov_b32_dpp v142, v142 row_shr:1 row_mask:0xf bank_mask:0xf bound_ctrl:0
    v_mov_b32_dpp v143, v143 row_shr:1 row_mask:0xf bank_mask:0xf bound_ctrl:0
    s_add_u32 s39, s38, 2854912
    buffer_load_dwordx4 a[0:3], v4, s[28:31], s39 offen
    s_waitcnt lgkmcnt(0)
    v_mfma_f32_32x32x16_bf16 v[144:159], v[176:179], v[64:67], v[144:159]
    ds_read_b128 v[208:211], v14 offset:3584
    s_nop 3
    v_mfma_f32_32x32x16_bf16 v[144:159], v[180:183], v[68:71], v[144:159]
    ds_read_b128 v[212:215], v14 offset:3616
    s_nop 3
    v_mfma_f32_32x32x16_bf16 v[144:159], v[184:187], v[72:75], v[144:159]
    ds_read_b128 v[216:219], v14 offset:3648
    v_and_b32_dpp v160, v160, v15 row_shr:1 row_mask:0xf bank_mask:0xf bound_ctrl:0
    v_and_b32_dpp v161, v161, v15 row_shr:1 row_mask:0xf bank_mask:0xf bound_ctrl:0
    v_and_b32_dpp v162, v162, v15 row_shr:1 row_mask:0xf bank_mask:0xf bound_ctrl:0
    v_mfma_f32_32x32x16_bf16 v[144:159], v[188:191], v[76:79], v[144:159]
    ds_read_b128 v[220:223], v14 offset:3680
    v_and_b32_dpp v163, v163, v15 row_shr:1 row_mask:0xf bank_mask:0xf bound_ctrl:0
    v_and_b32_dpp v164, v164, v15 row_shr:1 row_mask:0xf bank_mask:0xf bound_ctrl:0
    v_and_b32_dpp v165, v165, v15 row_shr:1 row_mask:0xf bank_mask:0xf bound_ctrl:0
    v_mfma_f32_32x32x16_bf16 v[144:159], v[192:195], v[80:83], v[144:159]
    ds_read_b128 v[224:227], v14 offset:3712
    v_and_b32_dpp v166, v166, v15 row_shr:1 row_mask:0xf bank_mask:0xf bound_ctrl:0
    v_and_b32_dpp v167, v167, v15 row_shr:1 row_mask:0xf bank_mask:0xf bound_ctrl:0
    v_and_b32_dpp v168, v168, v15 row_shr:1 row_mask:0xf bank_mask:0xf bound_ctrl:0
    v_mfma_f32_32x32x16_bf16 v[144:159], v[196:199], v[84:87], v[144:159]
    ds_read_b128 v[228:231], v14 offset:3744
    v_and_b32_dpp v169, v169, v15 row_shr:1 row_mask:0xf bank_mask:0xf bound_ctrl:0
    v_and_b32_dpp v170, v170, v15 row_shr:1 row_mask:0xf bank_mask:0xf bound_ctrl:0
    v_and_b32_dpp v171, v171, v15 row_shr:1 row_mask:0xf bank_mask:0xf bound_ctrl:0
    v_mfma_f32_32x32x16_bf16 v[144:159], v[200:203], v[88:91], v[144:159]
    ds_read_b128 v[232:235], v14 offset:3776
    v_and_b32_dpp v172, v172, v15 row_shr:1 row_mask:0xf bank_mask:0xf bound_ctrl:0
    v_and_b32_dpp v173, v173, v15 row_shr:1 row_mask:0xf bank_mask:0xf bound_ctrl:0
    v_mfma_f32_32x32x16_bf16 v[144:159], v[204:207], v[92:95], v[144:159]
    ds_read_b128 v[236:239], v14 offset:3808
    v_and_b32_dpp v174, v174, v15 row_shr:1 row_mask:0xf bank_mask:0xf bound_ctrl:0
    v_and_b32_dpp v175, v175, v15 row_shr:1 row_mask:0xf bank_mask:0xf bound_ctrl:0
    v_lshlrev_b32 v16, 4, v0
    s_mov_b32 s39, 5476352
    buffer_load_dwordx4 a[16:19], v16, s[28:31], s39 offen
    v_mfma_f32_32x32x16_bf16 v[128:143], v[176:179], v[32:35], v[128:143]
    s_nop 4
    v_mfma_f32_32x32x16_bf16 v[128:143], v[180:183], v[36:39], v[128:143]
    s_nop 4
    v_mfma_f32_32x32x16_bf16 v[128:143], v[184:187], v[40:43], v[128:143]
    v_mov_b32_dpp v144, v144 row_shr:1 row_mask:0xf bank_mask:0xf bound_ctrl:0
    v_mov_b32_dpp v145, v145 row_shr:1 row_mask:0xf bank_mask:0xf bound_ctrl:0
    v_mov_b32_dpp v146, v146 row_shr:1 row_mask:0xf bank_mask:0xf bound_ctrl:0
    v_mfma_f32_32x32x16_bf16 v[128:143], v[188:191], v[44:47], v[128:143]
    v_mov_b32_dpp v147, v147 row_shr:1 row_mask:0xf bank_mask:0xf bound_ctrl:0
    v_mov_b32_dpp v148, v148 row_shr:1 row_mask:0xf bank_mask:0xf bound_ctrl:0
    v_mov_b32_dpp v149, v149 row_shr:1 row_mask:0xf bank_mask:0xf bound_ctrl:0
    v_mfma_f32_32x32x16_bf16 v[128:143], v[192:195], v[48:51], v[128:143]
    v_mov_b32_dpp v150, v150 row_shr:1 row_mask:0xf bank_mask:0xf bound_ctrl:0
    v_mov_b32_dpp v151, v151 row_shr:1 row_mask:0xf bank_mask:0xf bound_ctrl:0
    v_mov_b32_dpp v152, v152 row_shr:1 row_mask:0xf bank_mask:0xf bound_ctrl:0
    v_mfma_f32_32x32x16_bf16 v[128:143], v[196:199], v[52:55], v[128:143]
    v_mov_b32_dpp v153, v153 row_shr:1 row_mask:0xf bank_mask:0xf bound_ctrl:0
    v_mov_b32_dpp v154, v154 row_shr:1 row_mask:0xf bank_mask:0xf bound_ctrl:0
    v_mov_b32_dpp v155, v155 row_shr:1 row_mask:0xf bank_mask:0xf bound_ctrl:0
    v_mfma_f32_32x32x16_bf16 v[128:143], v[200:203], v[56:59], v[128:143]
    v_mov_b32_dpp v156, v156 row_shr:1 row_mask:0xf bank_mask:0xf bound_ctrl:0
    v_mov_b32_dpp v157, v157 row_shr:1 row_mask:0xf bank_mask:0xf bound_ctrl:0
    v_mfma_f32_32x32x16_bf16 v[128:143], v[204:207], v[60:63], v[128:143]
    v_mov_b32_dpp v158, v158 row_shr:1 row_mask:0xf bank_mask:0xf bound_ctrl:0
    v_mov_b32_dpp v159, v159 row_shr:1 row_mask:0xf bank_mask:0xf bound_ctrl:0
    s_waitcnt lgkmcnt(0)
    v_mfma_f32_32x32x16_bf16 v[160:175], v[208:211], v[96:99], v[160:175]
    ds_read_b128 v[176:179], v14 offset:1280
    ds_read_b128 v[180:183], v14 offset:1312
    s_nop 2
    v_mfma_f32_32x32x16_bf16 v[160:175], v[212:215], v[100:103], v[160:175]
    ds_read_b128 v[184:187], v14 offset:1344
    ds_read_b128 v[188:191], v14 offset:1376
    s_nop 2
    v_mfma_f32_32x32x16_bf16 v[160:175], v[216:219], v[104:107], v[160:175]
    ds_read_b128 v[192:195], v14 offset:1408
    ds_read_b128 v[196:199], v14 offset:1440
    v_mov_b32_dpp v128, v128 row_shr:1 row_mask:0xf bank_mask:0xf bound_ctrl:0
    v_mov_b32_dpp v129, v129 row_shr:1 row_mask:0xf bank_mask:0xf bound_ctrl:0
    v_mov_b32_dpp v130, v130 row_shr:1 row_mask:0xf bank_mask:0xf bound_ctrl:0
    v_mfma_f32_32x32x16_bf16 v[160:175], v[220:223], v[108:111], v[160:175]
    ds_read_b128 v[200:203], v14 offset:1472
    v_mov_b32_dpp v131, v131 row_shr:1 row_mask:0xf bank_mask:0xf bound_ctrl:0
    v_mov_b32_dpp v132, v132 row_shr:1 row_mask:0xf bank_mask:0xf bound_ctrl:0
    v_mov_b32_dpp v133, v133 row_shr:1 row_mask:0xf bank_mask:0xf bound_ctrl:0
    v_mfma_f32_32x32x16_bf16 v[160:175], v[224:227], v[112:115], v[160:175]
    ds_read_b128 v[204:207], v14 offset:1504
    v_mov_b32_dpp v134, v134 row_shr:1 row_mask:0xf bank_mask:0xf bound_ctrl:0
    v_mov_b32_dpp v135, v135 row_shr:1 row_mask:0xf bank_mask:0xf bound_ctrl:0
    v_mov_b32_dpp v136, v136 row_shr:1 row_mask:0xf bank_mask:0xf bound_ctrl:0
    v_mfma_f32_32x32x16_bf16 v[160:175], v[228:231], v[116:119], v[160:175]
    v_mov_b32_dpp v137, v137 row_shr:1 row_mask:0xf bank_mask:0xf bound_ctrl:0
    v_mov_b32_dpp v138, v138 row_shr:1 row_mask:0xf bank_mask:0xf bound_ctrl:0
    v_mov_b32_dpp v139, v139 row_shr:1 row_mask:0xf bank_mask:0xf bound_ctrl:0
    v_mfma_f32_32x32x16_bf16 v[160:175], v[232:235], v[120:123], v[160:175]
    v_mov_b32_dpp v140, v140 row_shr:1 row_mask:0xf bank_mask:0xf bound_ctrl:0
    v_mov_b32_dpp v141, v141 row_shr:1 row_mask:0xf bank_mask:0xf bound_ctrl:0
    v_mfma_f32_32x32x16_bf16 v[160:175], v[236:239], v[124:127], v[160:175]
    v_mov_b32_dpp v142, v142 row_shr:1 row_mask:0xf bank_mask:0xf bound_ctrl:0
    v_mov_b32_dpp v143, v143 row_shr:1 row_mask:0xf bank_mask:0xf bound_ctrl:0
    s_add_u32 s39, s38, 3510272
    buffer_load_dwordx4 a[4:7], v4, s[28:31], s39 offen
    s_waitcnt lgkmcnt(0)
    v_mfma_f32_32x32x16_bf16 v[144:159], v[176:179], v[64:67], v[144:159]
    ds_read_b128 v[208:211], v14 offset:3328
    s_nop 3
    v_mfma_f32_32x32x16_bf16 v[144:159], v[180:183], v[68:71], v[144:159]
    ds_read_b128 v[212:215], v14 offset:3360
    s_nop 3
    v_mfma_f32_32x32x16_bf16 v[144:159], v[184:187], v[72:75], v[144:159]
    ds_read_b128 v[216:219], v14 offset:3392
    v_and_b32_dpp v160, v160, v15 row_shr:1 row_mask:0xf bank_mask:0xf bound_ctrl:0
    v_and_b32_dpp v161, v161, v15 row_shr:1 row_mask:0xf bank_mask:0xf bound_ctrl:0
    v_and_b32_dpp v162, v162, v15 row_shr:1 row_mask:0xf bank_mask:0xf bound_ctrl:0
    v_mfma_f32_32x32x16_bf16 v[144:159], v[188:191], v[76:79], v[144:159]
    ds_read_b128 v[220:223], v14 offset:3424
    v_and_b32_dpp v163, v163, v15 row_shr:1 row_mask:0xf bank_mask:0xf bound_ctrl:0
    v_and_b32_dpp v164, v164, v15 row_shr:1 row_mask:0xf bank_mask:0xf bound_ctrl:0
    v_and_b32_dpp v165, v165, v15 row_shr:1 row_mask:0xf bank_mask:0xf bound_ctrl:0
    v_mfma_f32_32x32x16_bf16 v[144:159], v[192:195], v[80:83], v[144:159]
    ds_read_b128 v[224:227], v14 offset:3456
    v_and_b32_dpp v166, v166, v15 row_shr:1 row_mask:0xf bank_mask:0xf bound_ctrl:0
    v_and_b32_dpp v167, v167, v15 row_shr:1 row_mask:0xf bank_mask:0xf bound_ctrl:0
    v_and_b32_dpp v168, v168, v15 row_shr:1 row_mask:0xf bank_mask:0xf bound_ctrl:0
    v_mfma_f32_32x32x16_bf16 v[144:159], v[196:199], v[84:87], v[144:159]
    ds_read_b128 v[228:231], v14 offset:3488
    v_and_b32_dpp v169, v169, v15 row_shr:1 row_mask:0xf bank_mask:0xf bound_ctrl:0
    v_and_b32_dpp v170, v170, v15 row_shr:1 row_mask:0xf bank_mask:0xf bound_ctrl:0
    v_and_b32_dpp v171, v171, v15 row_shr:1 row_mask:0xf bank_mask:0xf bound_ctrl:0
    v_mfma_f32_32x32x16_bf16 v[144:159], v[200:203], v[88:91], v[144:159]
    ds_read_b128 v[232:235], v14 offset:3520
    v_and_b32_dpp v172, v172, v15 row_shr:1 row_mask:0xf bank_mask:0xf bound_ctrl:0
    v_and_b32_dpp v173, v173, v15 row_shr:1 row_mask:0xf bank_mask:0xf bound_ctrl:0
    v_mfma_f32_32x32x16_bf16 v[144:159], v[204:207], v[92:95], v[144:159]
    ds_read_b128 v[236:239], v14 offset:3552
    v_and_b32_dpp v174, v174, v15 row_shr:1 row_mask:0xf bank_mask:0xf bound_ctrl:0
    v_and_b32_dpp v175, v175, v15 row_shr:1 row_mask:0xf bank_mask:0xf bound_ctrl:0
    v_lshlrev_b32 v16, 4, v0
    s_mov_b32 s39, 5480448
    buffer_load_dwordx4 a[20:23], v16, s[28:31], s39 offen
    v_mfma_f32_32x32x16_bf16 v[128:143], v[176:179], v[32:35], v[128:143]
    s_nop 4
    v_mfma_f32_32x32x16_bf16 v[128:143], v[180:183], v[36:39], v[128:143]
    s_nop 4
    v_mfma_f32_32x32x16_bf16 v[128:143], v[184:187], v[40:43], v[128:143]
    v_mov_b32_dpp v144, v144 row_shr:1 row_mask:0xf bank_mask:0xf bound_ctrl:0
    v_mov_b32_dpp v145, v145 row_shr:1 row_mask:0xf bank_mask:0xf bound_ctrl:0
    v_mov_b32_dpp v146, v146 row_shr:1 row_mask:0xf bank_mask:0xf bound_ctrl:0
    v_mfma_f32_32x32x16_bf16 v[128:143], v[188:191], v[44:47], v[128:143]
    v_mov_b32_dpp v147, v147 row_shr:1 row_mask:0xf bank_mask:0xf bound_ctrl:0
    v_mov_b32_dpp v148, v148 row_shr:1 row_mask:0xf bank_mask:0xf bound_ctrl:0
    v_mov_b32_dpp v149, v149 row_shr:1 row_mask:0xf bank_mask:0xf bound_ctrl:0
    v_mfma_f32_32x32x16_bf16 v[128:143], v[192:195], v[48:51], v[128:143]
    v_mov_b32_dpp v150, v150 row_shr:1 row_mask:0xf bank_mask:0xf bound_ctrl:0
    v_mov_b32_dpp v151, v151 row_shr:1 row_mask:0xf bank_mask:0xf bound_ctrl:0
    v_mov_b32_dpp v152, v152 row_shr:1 row_mask:0xf bank_mask:0xf bound_ctrl:0
    v_mfma_f32_32x32x16_bf16 v[128:143], v[196:199], v[52:55], v[128:143]
    v_mov_b32_dpp v153, v153 row_shr:1 row_mask:0xf bank_mask:0xf bound_ctrl:0
    v_mov_b32_dpp v154, v154 row_shr:1 row_mask:0xf bank_mask:0xf bound_ctrl:0
    v_mov_b32_dpp v155, v155 row_shr:1 row_mask:0xf bank_mask:0xf bound_ctrl:0
    v_mfma_f32_32x32x16_bf16 v[128:143], v[200:203], v[56:59], v[128:143]
    v_mov_b32_dpp v156, v156 row_shr:1 row_mask:0xf bank_mask:0xf bound_ctrl:0
    v_mov_b32_dpp v157, v157 row_shr:1 row_mask:0xf bank_mask:0xf bound_ctrl:0
    v_mfma_f32_32x32x16_bf16 v[128:143], v[204:207], v[60:63], v[128:143]
    v_mov_b32_dpp v158, v158 row_shr:1 row_mask:0xf bank_mask:0xf bound_ctrl:0
    v_mov_b32_dpp v159, v159 row_shr:1 row_mask:0xf bank_mask:0xf bound_ctrl:0
    s_waitcnt lgkmcnt(0)
    v_mfma_f32_32x32x16_bf16 v[160:175], v[208:211], v[96:99], v[160:175]
    ds_read_b128 v[176:179], v14 offset:1024
    ds_read_b128 v[180:183], v14 offset:1056
    s_nop 2
    v_mfma_f32_32x32x16_bf16 v[160:175], v[212:215], v[100:103], v[160:175]
    ds_read_b128 v[184:187], v14 offset:1088
    ds_read_b128 v[188:191], v14 offset:1120
    s_nop 2
    v_mfma_f32_32x32x16_bf16 v[160:175], v[216:219], v[104:107], v[160:175]
    ds_read_b128 v[192:195], v14 offset:1152
    ds_read_b128 v[196:199], v14 offset:1184
    v_mov_b32_dpp v128, v128 row_shr:1 row_mask:0xf bank_mask:0xf bound_ctrl:0
    v_mov_b32_dpp v129, v129 row_shr:1 row_mask:0xf bank_mask:0xf bound_ctrl:0
    v_mov_b32_dpp v130, v130 row_shr:1 row_mask:0xf bank_mask:0xf bound_ctrl:0
    v_mfma_f32_32x32x16_bf16 v[160:175], v[220:223], v[108:111], v[160:175]
    ds_read_b128 v[200:203], v14 offset:1216
    v_mov_b32_dpp v131, v131 row_shr:1 row_mask:0xf bank_mask:0xf bound_ctrl:0
    v_mov_b32_dpp v132, v132 row_shr:1 row_mask:0xf bank_mask:0xf bound_ctrl:0
    v_mov_b32_dpp v133, v133 row_shr:1 row_mask:0xf bank_mask:0xf bound_ctrl:0
    v_mfma_f32_32x32x16_bf16 v[160:175], v[224:227], v[112:115], v[160:175]
    ds_read_b128 v[204:207], v14 offset:1248
    v_mov_b32_dpp v134, v134 row_shr:1 row_mask:0xf bank_mask:0xf bound_ctrl:0
    v_mov_b32_dpp v135, v135 row_shr:1 row_mask:0xf bank_mask:0xf bound_ctrl:0
    v_mov_b32_dpp v136, v136 row_shr:1 row_mask:0xf bank_mask:0xf bound_ctrl:0
    v_mfma_f32_32x32x16_bf16 v[160:175], v[228:231], v[116:119], v[160:175]
    v_mov_b32_dpp v137, v137 row_shr:1 row_mask:0xf bank_mask:0xf bound_ctrl:0
    v_mov_b32_dpp v138, v138 row_shr:1 row_mask:0xf bank_mask:0xf bound_ctrl:0
    v_mov_b32_dpp v139, v139 row_shr:1 row_mask:0xf bank_mask:0xf bound_ctrl:0
    v_mfma_f32_32x32x16_bf16 v[160:175], v[232:235], v[120:123], v[160:175]
    v_mov_b32_dpp v140, v140 row_shr:1 row_mask:0xf bank_mask:0xf bound_ctrl:0
    v_mov_b32_dpp v141, v141 row_shr:1 row_mask:0xf bank_mask:0xf bound_ctrl:0
    v_mfma_f32_32x32x16_bf16 v[160:175], v[236:239], v[124:127], v[160:175]
    v_mov_b32_dpp v142, v142 row_shr:1 row_mask:0xf bank_mask:0xf bound_ctrl:0
    v_mov_b32_dpp v143, v143 row_shr:1 row_mask:0xf bank_mask:0xf bound_ctrl:0
    s_add_u32 s39, s38, 4165632
    buffer_load_dwordx4 a[8:11], v4, s[28:31], s39 offen
    s_waitcnt lgkmcnt(0)
    v_mfma_f32_32x32x16_bf16 v[144:159], v[176:179], v[64:67], v[144:159]
    ds_read_b128 v[208:211], v14 offset:3072
    s_nop 3
    v_mfma_f32_32x32x16_bf16 v[144:159], v[180:183], v[68:71], v[144:159]
    ds_read_b128 v[212:215], v14 offset:3104
    s_nop 3
    v_mfma_f32_32x32x16_bf16 v[144:159], v[184:187], v[72:75], v[144:159]
    ds_read_b128 v[216:219], v14 offset:3136
    v_and_b32_dpp v160, v160, v15 row_shr:1 row_mask:0xf bank_mask:0xf bound_ctrl:0
    v_and_b32_dpp v161, v161, v15 row_shr:1 row_mask:0xf bank_mask:0xf bound_ctrl:0
    v_and_b32_dpp v162, v162, v15 row_shr:1 row_mask:0xf bank_mask:0xf bound_ctrl:0
    v_mfma_f32_32x32x16_bf16 v[144:159], v[188:191], v[76:79], v[144:159]
    ds_read_b128 v[220:223], v14 offset:3168
    v_and_b32_dpp v163, v163, v15 row_shr:1 row_mask:0xf bank_mask:0xf bound_ctrl:0
    v_and_b32_dpp v164, v164, v15 row_shr:1 row_mask:0xf bank_mask:0xf bound_ctrl:0
    v_and_b32_dpp v165, v165, v15 row_shr:1 row_mask:0xf bank_mask:0xf bound_ctrl:0
    v_mfma_f32_32x32x16_bf16 v[144:159], v[192:195], v[80:83], v[144:159]
    ds_read_b128 v[224:227], v14 offset:3200
    v_and_b32_dpp v166, v166, v15 row_shr:1 row_mask:0xf bank_mask:0xf bound_ctrl:0
    v_and_b32_dpp v167, v167, v15 row_shr:1 row_mask:0xf bank_mask:0xf bound_ctrl:0
    v_and_b32_dpp v168, v168, v15 row_shr:1 row_mask:0xf bank_mask:0xf bound_ctrl:0
    v_mfma_f32_32x32x16_bf16 v[144:159], v[196:199], v[84:87], v[144:159]
    ds_read_b128 v[228:231], v14 offset:3232
    v_and_b32_dpp v169, v169, v15 row_shr:1 row_mask:0xf bank_mask:0xf bound_ctrl:0
    v_and_b32_dpp v170, v170, v15 row_shr:1 row_mask:0xf bank_mask:0xf bound_ctrl:0
    v_and_b32_dpp v171, v171, v15 row_shr:1 row_mask:0xf bank_mask:0xf bound_ctrl:0
    v_mfma_f32_32x32x16_bf16 v[144:159], v[200:203], v[88:91], v[144:159]
    ds_read_b128 v[232:235], v14 offset:3264
    v_and_b32_dpp v172, v172, v15 row_shr:1 row_mask:0xf bank_mask:0xf bound_ctrl:0
    v_and_b32_dpp v173, v173, v15 row_shr:1 row_mask:0xf bank_mask:0xf bound_ctrl:0
    v_mfma_f32_32x32x16_bf16 v[144:159], v[204:207], v[92:95], v[144:159]
    ds_read_b128 v[236:239], v14 offset:3296
    v_and_b32_dpp v174, v174, v15 row_shr:1 row_mask:0xf bank_mask:0xf bound_ctrl:0
    v_and_b32_dpp v175, v175, v15 row_shr:1 row_mask:0xf bank_mask:0xf bound_ctrl:0
    v_lshlrev_b32 v16, 4, v0
    s_mov_b32 s39, 5484544
    buffer_load_dwordx4 a[24:27], v16, s[28:31], s39 offen
    v_mfma_f32_32x32x16_bf16 v[128:143], v[176:179], v[32:35], v[128:143]
    s_nop 4
    v_mfma_f32_32x32x16_bf16 v[128:143], v[180:183], v[36:39], v[128:143]
    s_nop 4
    v_mfma_f32_32x32x16_bf16 v[128:143], v[184:187], v[40:43], v[128:143]
    v_mov_b32_dpp v144, v144 row_shr:1 row_mask:0xf bank_mask:0xf bound_ctrl:0
    v_mov_b32_dpp v145, v145 row_shr:1 row_mask:0xf bank_mask:0xf bound_ctrl:0
    v_mov_b32_dpp v146, v146 row_shr:1 row_mask:0xf bank_mask:0xf bound_ctrl:0
    v_mfma_f32_32x32x16_bf16 v[128:143], v[188:191], v[44:47], v[128:143]
    v_mov_b32_dpp v147, v147 row_shr:1 row_mask:0xf bank_mask:0xf bound_ctrl:0
    v_mov_b32_dpp v148, v148 row_shr:1 row_mask:0xf bank_mask:0xf bound_ctrl:0
    v_mov_b32_dpp v149, v149 row_shr:1 row_mask:0xf bank_mask:0xf bound_ctrl:0
    v_mfma_f32_32x32x16_bf16 v[128:143], v[192:195], v[48:51], v[128:143]
    v_mov_b32_dpp v150, v150 row_shr:1 row_mask:0xf bank_mask:0xf bound_ctrl:0
    v_mov_b32_dpp v151, v151 row_shr:1 row_mask:0xf bank_mask:0xf bound_ctrl:0
    v_mov_b32_dpp v152, v152 row_shr:1 row_mask:0xf bank_mask:0xf bound_ctrl:0
    v_mfma_f32_32x32x16_bf16 v[128:143], v[196:199], v[52:55], v[128:143]
    v_mov_b32_dpp v153, v153 row_shr:1 row_mask:0xf bank_mask:0xf bound_ctrl:0
    v_mov_b32_dpp v154, v154 row_shr:1 row_mask:0xf bank_mask:0xf bound_ctrl:0
    v_mov_b32_dpp v155, v155 row_shr:1 row_mask:0xf bank_mask:0xf bound_ctrl:0
    v_mfma_f32_32x32x16_bf16 v[128:143], v[200:203], v[56:59], v[128:143]
    v_mov_b32_dpp v156, v156 row_shr:1 row_mask:0xf bank_mask:0xf bound_ctrl:0
    v_mov_b32_dpp v157, v157 row_shr:1 row_mask:0xf bank_mask:0xf bound_ctrl:0
    v_mfma_f32_32x32x16_bf16 v[128:143], v[204:207], v[60:63], v[128:143]
    v_mov_b32_dpp v158, v158 row_shr:1 row_mask:0xf bank_mask:0xf bound_ctrl:0
    v_mov_b32_dpp v159, v159 row_shr:1 row_mask:0xf bank_mask:0xf bound_ctrl:0
    s_waitcnt lgkmcnt(0)
    v_mfma_f32_32x32x16_bf16 v[160:175], v[208:211], v[96:99], v[160:175]
    ds_read_b128 v[176:179], v14 offset:768
    ds_read_b128 v[180:183], v14 offset:800
    s_nop 2
    v_mfma_f32_32x32x16_bf16 v[160:175], v[212:215], v[100:103], v[160:175]
    ds_read_b128 v[184:187], v14 offset:832
    ds_read_b128 v[188:191], v14 offset:864
    s_nop 2
    v_mfma_f32_32x32x16_bf16 v[160:175], v[216:219], v[104:107], v[160:175]
    ds_read_b128 v[192:195], v14 offset:896
    ds_read_b128 v[196:199], v14 offset:928
    v_mov_b32_dpp v128, v128 row_shr:1 row_mask:0xf bank_mask:0xf bound_ctrl:0
    v_mov_b32_dpp v129, v129 row_shr:1 row_mask:0xf bank_mask:0xf bound_ctrl:0
    v_mov_b32_dpp v130, v130 row_shr:1 row_mask:0xf bank_mask:0xf bound_ctrl:0
    v_mfma_f32_32x32x16_bf16 v[160:175], v[220:223], v[108:111], v[160:175]
    ds_read_b128 v[200:203], v14 offset:960
    v_mov_b32_dpp v131, v131 row_shr:1 row_mask:0xf bank_mask:0xf bound_ctrl:0
    v_mov_b32_dpp v132, v132 row_shr:1 row_mask:0xf bank_mask:0xf bound_ctrl:0
    v_mov_b32_dpp v133, v133 row_shr:1 row_mask:0xf bank_mask:0xf bound_ctrl:0
    v_mfma_f32_32x32x16_bf16 v[160:175], v[224:227], v[112:115], v[160:175]
    ds_read_b128 v[204:207], v14 offset:992
    v_mov_b32_dpp v134, v134 row_shr:1 row_mask:0xf bank_mask:0xf bound_ctrl:0
    v_mov_b32_dpp v135, v135 row_shr:1 row_mask:0xf bank_mask:0xf bound_ctrl:0
    v_mov_b32_dpp v136, v136 row_shr:1 row_mask:0xf bank_mask:0xf bound_ctrl:0
    v_mfma_f32_32x32x16_bf16 v[160:175], v[228:231], v[116:119], v[160:175]
    v_mov_b32_dpp v137, v137 row_shr:1 row_mask:0xf bank_mask:0xf bound_ctrl:0
    v_mov_b32_dpp v138, v138 row_shr:1 row_mask:0xf bank_mask:0xf bound_ctrl:0
    v_mov_b32_dpp v139, v139 row_shr:1 row_mask:0xf bank_mask:0xf bound_ctrl:0
    v_mfma_f32_32x32x16_bf16 v[160:175], v[232:235], v[120:123], v[160:175]
    v_mov_b32_dpp v140, v140 row_shr:1 row_mask:0xf bank_mask:0xf bound_ctrl:0
    v_mov_b32_dpp v141, v141 row_shr:1 row_mask:0xf bank_mask:0xf bound_ctrl:0
    v_mfma_f32_32x32x16_bf16 v[160:175], v[236:239], v[124:127], v[160:175]
    v_mov_b32_dpp v142, v142 row_shr:1 row_mask:0xf bank_mask:0xf bound_ctrl:0
    v_mov_b32_dpp v143, v143 row_shr:1 row_mask:0xf bank_mask:0xf bound_ctrl:0
    s_add_u32 s39, s38, 4820992
    buffer_load_dwordx4 a[12:15], v4, s[28:31], s39 offen
    s_waitcnt lgkmcnt(0)
    v_mfma_f32_32x32x16_bf16 v[144:159], v[176:179], v[64:67], v[144:159]
    ds_read_b128 v[208:211], v14 offset:2816
    s_nop 3
    v_mfma_f32_32x32x16_bf16 v[144:159], v[180:183], v[68:71], v[144:159]
    ds_read_b128 v[212:215], v14 offset:2848
    s_nop 3
    v_mfma_f32_32x32x16_bf16 v[144:159], v[184:187], v[72:75], v[144:159]
    ds_read_b128 v[216:219], v14 offset:2880
    v_and_b32_dpp v160, v160, v15 row_shr:1 row_mask:0xf bank_mask:0xf bound_ctrl:0
    v_and_b32_dpp v161, v161, v15 row_shr:1 row_mask:0xf bank_mask:0xf bound_ctrl:0
    v_and_b32_dpp v162, v162, v15 row_shr:1 row_mask:0xf bank_mask:0xf bound_ctrl:0
    v_mfma_f32_32x32x16_bf16 v[144:159], v[188:191], v[76:79], v[144:159]
    ds_read_b128 v[220:223], v14 offset:2912
    v_and_b32_dpp v163, v163, v15 row_shr:1 row_mask:0xf bank_mask:0xf bound_ctrl:0
    v_and_b32_dpp v164, v164, v15 row_shr:1 row_mask:0xf bank_mask:0xf bound_ctrl:0
    v_and_b32_dpp v165, v165, v15 row_shr:1 row_mask:0xf bank_mask:0xf bound_ctrl:0
    v_mfma_f32_32x32x16_bf16 v[144:159], v[192:195], v[80:83], v[144:159]
    ds_read_b128 v[224:227], v14 offset:2944
    v_and_b32_dpp v166, v166, v15 row_shr:1 row_mask:0xf bank_mask:0xf bound_ctrl:0
    v_and_b32_dpp v167, v167, v15 row_shr:1 row_mask:0xf bank_mask:0xf bound_ctrl:0
    v_and_b32_dpp v168, v168, v15 row_shr:1 row_mask:0xf bank_mask:0xf bound_ctrl:0
    v_mfma_f32_32x32x16_bf16 v[144:159], v[196:199], v[84:87], v[144:159]
    ds_read_b128 v[228:231], v14 offset:2976
    v_and_b32_dpp v169, v169, v15 row_shr:1 row_mask:0xf bank_mask:0xf bound_ctrl:0
    v_and_b32_dpp v170, v170, v15 row_shr:1 row_mask:0xf bank_mask:0xf bound_ctrl:0
    v_and_b32_dpp v171, v171, v15 row_shr:1 row_mask:0xf bank_mask:0xf bound_ctrl:0
    v_mfma_f32_32x32x16_bf16 v[144:159], v[200:203], v[88:91], v[144:159]
    ds_read_b128 v[232:235], v14 offset:3008
    v_and_b32_dpp v172, v172, v15 row_shr:1 row_mask:0xf bank_mask:0xf bound_ctrl:0
    v_and_b32_dpp v173, v173, v15 row_shr:1 row_mask:0xf bank_mask:0xf bound_ctrl:0
    v_mfma_f32_32x32x16_bf16 v[144:159], v[204:207], v[92:95], v[144:159]
    ds_read_b128 v[236:239], v14 offset:3040
    v_and_b32_dpp v174, v174, v15 row_shr:1 row_mask:0xf bank_mask:0xf bound_ctrl:0
    v_and_b32_dpp v175, v175, v15 row_shr:1 row_mask:0xf bank_mask:0xf bound_ctrl:0
    v_lshlrev_b32 v16, 4, v0
    s_mov_b32 s39, 5488640
    buffer_load_dwordx4 a[28:31], v16, s[28:31], s39 offen
    v_mfma_f32_32x32x16_bf16 v[128:143], v[176:179], v[32:35], v[128:143]
    s_nop 4
    v_mfma_f32_32x32x16_bf16 v[128:143], v[180:183], v[36:39], v[128:143]
    s_nop 4
    v_mfma_f32_32x32x16_bf16 v[128:143], v[184:187], v[40:43], v[128:143]
    v_mov_b32_dpp v144, v144 row_shr:1 row_mask:0xf bank_mask:0xf bound_ctrl:0
    v_mov_b32_dpp v145, v145 row_shr:1 row_mask:0xf bank_mask:0xf bound_ctrl:0
    v_mov_b32_dpp v146, v146 row_shr:1 row_mask:0xf bank_mask:0xf bound_ctrl:0
    v_mfma_f32_32x32x16_bf16 v[128:143], v[188:191], v[44:47], v[128:143]
    v_mov_b32_dpp v147, v147 row_shr:1 row_mask:0xf bank_mask:0xf bound_ctrl:0
    v_mov_b32_dpp v148, v148 row_shr:1 row_mask:0xf bank_mask:0xf bound_ctrl:0
    v_mov_b32_dpp v149, v149 row_shr:1 row_mask:0xf bank_mask:0xf bound_ctrl:0
    v_mfma_f32_32x32x16_bf16 v[128:143], v[192:195], v[48:51], v[128:143]
    v_mov_b32_dpp v150, v150 row_shr:1 row_mask:0xf bank_mask:0xf bound_ctrl:0
    v_mov_b32_dpp v151, v151 row_shr:1 row_mask:0xf bank_mask:0xf bound_ctrl:0
    v_mov_b32_dpp v152, v152 row_shr:1 row_mask:0xf bank_mask:0xf bound_ctrl:0
    v_mfma_f32_32x32x16_bf16 v[128:143], v[196:199], v[52:55], v[128:143]
    v_mov_b32_dpp v153, v153 row_shr:1 row_mask:0xf bank_mask:0xf bound_ctrl:0
    v_mov_b32_dpp v154, v154 row_shr:1 row_mask:0xf bank_mask:0xf bound_ctrl:0
    v_mov_b32_dpp v155, v155 row_shr:1 row_mask:0xf bank_mask:0xf bound_ctrl:0
    v_mfma_f32_32x32x16_bf16 v[128:143], v[200:203], v[56:59], v[128:143]
    v_mov_b32_dpp v156, v156 row_shr:1 row_mask:0xf bank_mask:0xf bound_ctrl:0
    v_mov_b32_dpp v157, v157 row_shr:1 row_mask:0xf bank_mask:0xf bound_ctrl:0
    v_mfma_f32_32x32x16_bf16 v[128:143], v[204:207], v[60:63], v[128:143]
    v_mov_b32_dpp v158, v158 row_shr:1 row_mask:0xf bank_mask:0xf bound_ctrl:0
    v_mov_b32_dpp v159, v159 row_shr:1 row_mask:0xf bank_mask:0xf bound_ctrl:0
    s_waitcnt lgkmcnt(0)
    v_mfma_f32_32x32x16_bf16 v[160:175], v[208:211], v[96:99], v[160:175]
    ds_read_b128 v[176:179], v14 offset:512
    ds_read_b128 v[180:183], v14 offset:544
    s_nop 2
    v_mfma_f32_32x32x16_bf16 v[160:175], v[212:215], v[100:103], v[160:175]
    ds_read_b128 v[184:187], v14 offset:576
    ds_read_b128 v[188:191], v14 offset:608
    s_nop 2
    v_mfma_f32_32x32x16_bf16 v[160:175], v[216:219], v[104:107], v[160:175]
    ds_read_b128 v[192:195], v14 offset:640
    ds_read_b128 v[196:199], v14 offset:672
    v_mov_b32_dpp v128, v128 row_shr:1 row_mask:0xf bank_mask:0xf bound_ctrl:0
    v_mov_b32_dpp v129, v129 row_shr:1 row_mask:0xf bank_mask:0xf bound_ctrl:0
    v_mov_b32_dpp v130, v130 row_shr:1 row_mask:0xf bank_mask:0xf bound_ctrl:0
    v_mfma_f32_32x32x16_bf16 v[160:175], v[220:223], v[108:111], v[160:175]
    ds_read_b128 v[200:203], v14 offset:704
    v_mov_b32_dpp v131, v131 row_shr:1 row_mask:0xf bank_mask:0xf bound_ctrl:0
    v_mov_b32_dpp v132, v132 row_shr:1 row_mask:0xf bank_mask:0xf bound_ctrl:0
    v_mov_b32_dpp v133, v133 row_shr:1 row_mask:0xf bank_mask:0xf bound_ctrl:0
    v_mfma_f32_32x32x16_bf16 v[160:175], v[224:227], v[112:115], v[160:175]
    ds_read_b128 v[204:207], v14 offset:736
    v_mov_b32_dpp v134, v134 row_shr:1 row_mask:0xf bank_mask:0xf bound_ctrl:0
    v_mov_b32_dpp v135, v135 row_shr:1 row_mask:0xf bank_mask:0xf bound_ctrl:0
    v_mov_b32_dpp v136, v136 row_shr:1 row_mask:0xf bank_mask:0xf bound_ctrl:0
    v_mfma_f32_32x32x16_bf16 v[160:175], v[228:231], v[116:119], v[160:175]
    v_mov_b32_dpp v137, v137 row_shr:1 row_mask:0xf bank_mask:0xf bound_ctrl:0
    v_mov_b32_dpp v138, v138 row_shr:1 row_mask:0xf bank_mask:0xf bound_ctrl:0
    v_mov_b32_dpp v139, v139 row_shr:1 row_mask:0xf bank_mask:0xf bound_ctrl:0
    v_mfma_f32_32x32x16_bf16 v[160:175], v[232:235], v[120:123], v[160:175]
    v_mov_b32_dpp v140, v140 row_shr:1 row_mask:0xf bank_mask:0xf bound_ctrl:0
    v_mov_b32_dpp v141, v141 row_shr:1 row_mask:0xf bank_mask:0xf bound_ctrl:0
    v_mfma_f32_32x32x16_bf16 v[160:175], v[236:239], v[124:127], v[160:175]
    v_mov_b32_dpp v142, v142 row_shr:1 row_mask:0xf bank_mask:0xf bound_ctrl:0
    v_mov_b32_dpp v143, v143 row_shr:1 row_mask:0xf bank_mask:0xf bound_ctrl:0
    s_waitcnt lgkmcnt(0)
    v_mfma_f32_32x32x16_bf16 v[144:159], v[176:179], v[64:67], v[144:159]
    ds_read_b128 v[208:211], v14 offset:2560
    s_nop 3
    v_mfma_f32_32x32x16_bf16 v[144:159], v[180:183], v[68:71], v[144:159]
    ds_read_b128 v[212:215], v14 offset:2592
    s_nop 3
    v_mfma_f32_32x32x16_bf16 v[144:159], v[184:187], v[72:75], v[144:159]
    ds_read_b128 v[216:219], v14 offset:2624
    v_and_b32_dpp v160, v160, v15 row_shr:1 row_mask:0xf bank_mask:0xf bound_ctrl:0
    v_and_b32_dpp v161, v161, v15 row_shr:1 row_mask:0xf bank_mask:0xf bound_ctrl:0
    v_and_b32_dpp v162, v162, v15 row_shr:1 row_mask:0xf bank_mask:0xf bound_ctrl:0
    v_mfma_f32_32x32x16_bf16 v[144:159], v[188:191], v[76:79], v[144:159]
    ds_read_b128 v[220:223], v14 offset:2656
    v_and_b32_dpp v163, v163, v15 row_shr:1 row_mask:0xf bank_mask:0xf bound_ctrl:0
    v_and_b32_dpp v164, v164, v15 row_shr:1 row_mask:0xf bank_mask:0xf bound_ctrl:0
    v_and_b32_dpp v165, v165, v15 row_shr:1 row_mask:0xf bank_mask:0xf bound_ctrl:0
    v_mfma_f32_32x32x16_bf16 v[144:159], v[192:195], v[80:83], v[144:159]
    ds_read_b128 v[224:227], v14 offset:2688
    v_and_b32_dpp v166, v166, v15 row_shr:1 row_mask:0xf bank_mask:0xf bound_ctrl:0
    v_and_b32_dpp v167, v167, v15 row_shr:1 row_mask:0xf bank_mask:0xf bound_ctrl:0
    v_and_b32_dpp v168, v168, v15 row_shr:1 row_mask:0xf bank_mask:0xf bound_ctrl:0
    v_mfma_f32_32x32x16_bf16 v[144:159], v[196:199], v[84:87], v[144:159]
    ds_read_b128 v[228:231], v14 offset:2720
    v_and_b32_dpp v169, v169, v15 row_shr:1 row_mask:0xf bank_mask:0xf bound_ctrl:0
    v_and_b32_dpp v170, v170, v15 row_shr:1 row_mask:0xf bank_mask:0xf bound_ctrl:0
    v_and_b32_dpp v171, v171, v15 row_shr:1 row_mask:0xf bank_mask:0xf bound_ctrl:0
    v_mfma_f32_32x32x16_bf16 v[144:159], v[200:203], v[88:91], v[144:159]
    ds_read_b128 v[232:235], v14 offset:2752
    v_and_b32_dpp v172, v172, v15 row_shr:1 row_mask:0xf bank_mask:0xf bound_ctrl:0
    v_and_b32_dpp v173, v173, v15 row_shr:1 row_mask:0xf bank_mask:0xf bound_ctrl:0
    v_mfma_f32_32x32x16_bf16 v[144:159], v[204:207], v[92:95], v[144:159]
    ds_read_b128 v[236:239], v14 offset:2784
    v_and_b32_dpp v174, v174, v15 row_shr:1 row_mask:0xf bank_mask:0xf bound_ctrl:0
    v_and_b32_dpp v175, v175, v15 row_shr:1 row_mask:0xf bank_mask:0xf bound_ctrl:0
    v_mfma_f32_32x32x16_bf16 v[128:143], v[176:179], v[32:35], v[128:143]
    s_nop 4
    v_mfma_f32_32x32x16_bf16 v[128:143], v[180:183], v[36:39], v[128:143]
    s_nop 4
    v_mfma_f32_32x32x16_bf16 v[128:143], v[184:187], v[40:43], v[128:143]
    v_mov_b32_dpp v144, v144 row_shr:1 row_mask:0xf bank_mask:0xf bound_ctrl:0
    v_mov_b32_dpp v145, v145 row_shr:1 row_mask:0xf bank_mask:0xf bound_ctrl:0
    v_mov_b32_dpp v146, v146 row_shr:1 row_mask:0xf bank_mask:0xf bound_ctrl:0
    v_mfma_f32_32x32x16_bf16 v[128:143], v[188:191], v[44:47], v[128:143]
    v_mov_b32_dpp v147, v147 row_shr:1 row_mask:0xf bank_mask:0xf bound_ctrl:0
    v_mov_b32_dpp v148, v148 row_shr:1 row_mask:0xf bank_mask:0xf bound_ctrl:0
    v_mov_b32_dpp v149, v149 row_shr:1 row_mask:0xf bank_mask:0xf bound_ctrl:0
    v_mfma_f32_32x32x16_bf16 v[128:143], v[192:195], v[48:51], v[128:143]
    v_mov_b32_dpp v150, v150 row_shr:1 row_mask:0xf bank_mask:0xf bound_ctrl:0
    v_mov_b32_dpp v151, v151 row_shr:1 row_mask:0xf bank_mask:0xf bound_ctrl:0
    v_mov_b32_dpp v152, v152 row_shr:1 row_mask:0xf bank_mask:0xf bound_ctrl:0
    v_mfma_f32_32x32x16_bf16 v[128:143], v[196:199], v[52:55], v[128:143]
    v_mov_b32_dpp v153, v153 row_shr:1 row_mask:0xf bank_mask:0xf bound_ctrl:0
    v_mov_b32_dpp v154, v154 row_shr:1 row_mask:0xf bank_mask:0xf bound_ctrl:0
    v_mov_b32_dpp v155, v155 row_shr:1 row_mask:0xf bank_mask:0xf bound_ctrl:0
    v_mfma_f32_32x32x16_bf16 v[128:143], v[200:203], v[56:59], v[128:143]
    v_mov_b32_dpp v156, v156 row_shr:1 row_mask:0xf bank_mask:0xf bound_ctrl:0
    v_mov_b32_dpp v157, v157 row_shr:1 row_mask:0xf bank_mask:0xf bound_ctrl:0
    v_mfma_f32_32x32x16_bf16 v[128:143], v[204:207], v[60:63], v[128:143]
    v_mov_b32_dpp v158, v158 row_shr:1 row_mask:0xf bank_mask:0xf bound_ctrl:0
    v_mov_b32_dpp v159, v159 row_shr:1 row_mask:0xf bank_mask:0xf bound_ctrl:0
    s_waitcnt lgkmcnt(0)
    v_mfma_f32_32x32x16_bf16 v[160:175], v[208:211], v[96:99], v[160:175]
    ds_read_b128 v[176:179], v14 offset:256
    ds_read_b128 v[180:183], v14 offset:288
    s_nop 2
    v_mfma_f32_32x32x16_bf16 v[160:175], v[212:215], v[100:103], v[160:175]
    ds_read_b128 v[184:187], v14 offset:320
    ds_read_b128 v[188:191], v14 offset:352
    s_nop 2
    v_mfma_f32_32x32x16_bf16 v[160:175], v[216:219], v[104:107], v[160:175]
    ds_read_b128 v[192:195], v14 offset:384
    ds_read_b128 v[196:199], v14 offset:416
    v_mov_b32_dpp v128, v128 row_shr:1 row_mask:0xf bank_mask:0xf bound_ctrl:0
    v_mov_b32_dpp v129, v129 row_shr:1 row_mask:0xf bank_mask:0xf bound_ctrl:0
    v_mov_b32_dpp v130, v130 row_shr:1 row_mask:0xf bank_mask:0xf bound_ctrl:0
    v_mfma_f32_32x32x16_bf16 v[160:175], v[220:223], v[108:111], v[160:175]
    ds_read_b128 v[200:203], v14 offset:448
    v_mov_b32_dpp v131, v131 row_shr:1 row_mask:0xf bank_mask:0xf bound_ctrl:0
    v_mov_b32_dpp v132, v132 row_shr:1 row_mask:0xf bank_mask:0xf bound_ctrl:0
    v_mov_b32_dpp v133, v133 row_shr:1 row_mask:0xf bank_mask:0xf bound_ctrl:0
    v_mfma_f32_32x32x16_bf16 v[160:175], v[224:227], v[112:115], v[160:175]
    ds_read_b128 v[204:207], v14 offset:480
    v_mov_b32_dpp v134, v134 row_shr:1 row_mask:0xf bank_mask:0xf bound_ctrl:0
    v_mov_b32_dpp v135, v135 row_shr:1 row_mask:0xf bank_mask:0xf bound_ctrl:0
    v_mov_b32_dpp v136, v136 row_shr:1 row_mask:0xf bank_mask:0xf bound_ctrl:0
    v_mfma_f32_32x32x16_bf16 v[160:175], v[228:231], v[116:119], v[160:175]
    v_mov_b32_dpp v137, v137 row_shr:1 row_mask:0xf bank_mask:0xf bound_ctrl:0
    v_mov_b32_dpp v138, v138 row_shr:1 row_mask:0xf bank_mask:0xf bound_ctrl:0
    v_mov_b32_dpp v139, v139 row_shr:1 row_mask:0xf bank_mask:0xf bound_ctrl:0
    v_mfma_f32_32x32x16_bf16 v[160:175], v[232:235], v[120:123], v[160:175]
    v_mov_b32_dpp v140, v140 row_shr:1 row_mask:0xf bank_mask:0xf bound_ctrl:0
    v_mov_b32_dpp v141, v141 row_shr:1 row_mask:0xf bank_mask:0xf bound_ctrl:0
    v_mfma_f32_32x32x16_bf16 v[160:175], v[236:239], v[124:127], v[160:175]
    v_mov_b32_dpp v142, v142 row_shr:1 row_mask:0xf bank_mask:0xf bound_ctrl:0
    v_mov_b32_dpp v143, v143 row_shr:1 row_mask:0xf bank_mask:0xf bound_ctrl:0
    s_waitcnt lgkmcnt(0)
    v_mfma_f32_32x32x16_bf16 v[144:159], v[176:179], v[64:67], v[144:159]
    ds_read_b128 v[208:211], v14 offset:2304
    s_nop 3
    v_mfma_f32_32x32x16_bf16 v[144:159], v[180:183], v[68:71], v[144:159]
    ds_read_b128 v[212:215], v14 offset:2336
    s_nop 3
    v_mfma_f32_32x32x16_bf16 v[144:159], v[184:187], v[72:75], v[144:159]
    ds_read_b128 v[216:219], v14 offset:2368
    v_and_b32_dpp v160, v160, v15 row_shr:1 row_mask:0xf bank_mask:0xf bound_ctrl:0
    v_and_b32_dpp v161, v161, v15 row_shr:1 row_mask:0xf bank_mask:0xf bound_ctrl:0
    v_and_b32_dpp v162, v162, v15 row_shr:1 row_mask:0xf bank_mask:0xf bound_ctrl:0
    v_mfma_f32_32x32x16_bf16 v[144:159], v[188:191], v[76:79], v[144:159]
    ds_read_b128 v[220:223], v14 offset:2400
    v_and_b32_dpp v163, v163, v15 row_shr:1 row_mask:0xf bank_mask:0xf bound_ctrl:0
    v_and_b32_dpp v164, v164, v15 row_shr:1 row_mask:0xf bank_mask:0xf bound_ctrl:0
    v_and_b32_dpp v165, v165, v15 row_shr:1 row_mask:0xf bank_mask:0xf bound_ctrl:0
    v_mfma_f32_32x32x16_bf16 v[144:159], v[192:195], v[80:83], v[144:159]
    ds_read_b128 v[224:227], v14 offset:2432
    v_and_b32_dpp v166, v166, v15 row_shr:1 row_mask:0xf bank_mask:0xf bound_ctrl:0
    v_and_b32_dpp v167, v167, v15 row_shr:1 row_mask:0xf bank_mask:0xf bound_ctrl:0
    v_and_b32_dpp v168, v168, v15 row_shr:1 row_mask:0xf bank_mask:0xf bound_ctrl:0
    v_mfma_f32_32x32x16_bf16 v[144:159], v[196:199], v[84:87], v[144:159]
    ds_read_b128 v[228:231], v14 offset:2464
    v_and_b32_dpp v169, v169, v15 row_shr:1 row_mask:0xf bank_mask:0xf bound_ctrl:0
    v_and_b32_dpp v170, v170, v15 row_shr:1 row_mask:0xf bank_mask:0xf bound_ctrl:0
    v_and_b32_dpp v171, v171, v15 row_shr:1 row_mask:0xf bank_mask:0xf bound_ctrl:0
    v_mfma_f32_32x32x16_bf16 v[144:159], v[200:203], v[88:91], v[144:159]
    ds_read_b128 v[232:235], v14 offset:2496
    v_and_b32_dpp v172, v172, v15 row_shr:1 row_mask:0xf bank_mask:0xf bound_ctrl:0
    v_and_b32_dpp v173, v173, v15 row_shr:1 row_mask:0xf bank_mask:0xf bound_ctrl:0
    v_mfma_f32_32x32x16_bf16 v[144:159], v[204:207], v[92:95], v[144:159]
    ds_read_b128 v[236:239], v14 offset:2528
    v_and_b32_dpp v174, v174, v15 row_shr:1 row_mask:0xf bank_mask:0xf bound_ctrl:0
    v_and_b32_dpp v175, v175, v15 row_shr:1 row_mask:0xf bank_mask:0xf bound_ctrl:0
    v_mfma_f32_32x32x16_bf16 v[128:143], v[176:179], v[32:35], v[128:143]
    s_nop 4
    v_mfma_f32_32x32x16_bf16 v[128:143], v[180:183], v[36:39], v[128:143]
    s_nop 4
    v_mfma_f32_32x32x16_bf16 v[128:143], v[184:187], v[40:43], v[128:143]
    v_mov_b32_dpp v144, v144 row_shr:1 row_mask:0xf bank_mask:0xf bound_ctrl:0
    v_mov_b32_dpp v145, v145 row_shr:1 row_mask:0xf bank_mask:0xf bound_ctrl:0
    v_mov_b32_dpp v146, v146 row_shr:1 row_mask:0xf bank_mask:0xf bound_ctrl:0
    v_mfma_f32_32x32x16_bf16 v[128:143], v[188:191], v[44:47], v[128:143]
    v_mov_b32_dpp v147, v147 row_shr:1 row_mask:0xf bank_mask:0xf bound_ctrl:0
    v_mov_b32_dpp v148, v148 row_shr:1 row_mask:0xf bank_mask:0xf bound_ctrl:0
    v_mov_b32_dpp v149, v149 row_shr:1 row_mask:0xf bank_mask:0xf bound_ctrl:0
    v_mfma_f32_32x32x16_bf16 v[128:143], v[192:195], v[48:51], v[128:143]
    v_mov_b32_dpp v150, v150 row_shr:1 row_mask:0xf bank_mask:0xf bound_ctrl:0
    v_mov_b32_dpp v151, v151 row_shr:1 row_mask:0xf bank_mask:0xf bound_ctrl:0
    v_mov_b32_dpp v152, v152 row_shr:1 row_mask:0xf bank_mask:0xf bound_ctrl:0
    v_mfma_f32_32x32x16_bf16 v[128:143], v[196:199], v[52:55], v[128:143]
    v_mov_b32_dpp v153, v153 row_shr:1 row_mask:0xf bank_mask:0xf bound_ctrl:0
    v_mov_b32_dpp v154, v154 row_shr:1 row_mask:0xf bank_mask:0xf bound_ctrl:0
    v_mov_b32_dpp v155, v155 row_shr:1 row_mask:0xf bank_mask:0xf bound_ctrl:0
    v_mfma_f32_32x32x16_bf16 v[128:143], v[200:203], v[56:59], v[128:143]
    v_mov_b32_dpp v156, v156 row_shr:1 row_mask:0xf bank_mask:0xf bound_ctrl:0
    v_mov_b32_dpp v157, v157 row_shr:1 row_mask:0xf bank_mask:0xf bound_ctrl:0
    v_mfma_f32_32x32x16_bf16 v[128:143], v[204:207], v[60:63], v[128:143]
    v_mov_b32_dpp v158, v158 row_shr:1 row_mask:0xf bank_mask:0xf bound_ctrl:0
    v_mov_b32_dpp v159, v159 row_shr:1 row_mask:0xf bank_mask:0xf bound_ctrl:0
    s_waitcnt lgkmcnt(0)
    v_mfma_f32_32x32x16_bf16 v[160:175], v[208:211], v[96:99], v[160:175]
    ds_read_b128 v[176:179], v14 offset:0
    ds_read_b128 v[180:183], v14 offset:32
    s_nop 2
    v_mfma_f32_32x32x16_bf16 v[160:175], v[212:215], v[100:103], v[160:175]
    ds_read_b128 v[184:187], v14 offset:64
    ds_read_b128 v[188:191], v14 offset:96
    s_nop 2
    v_mfma_f32_32x32x16_bf16 v[160:175], v[216:219], v[104:107], v[160:175]
    ds_read_b128 v[192:195], v14 offset:128
    ds_read_b128 v[196:199], v14 offset:160
    v_mov_b32_dpp v128, v128 row_shr:1 row_mask:0xf bank_mask:0xf bound_ctrl:0
    v_mov_b32_dpp v129, v129 row_shr:1 row_mask:0xf bank_mask:0xf bound_ctrl:0
    v_mov_b32_dpp v130, v130 row_shr:1 row_mask:0xf bank_mask:0xf bound_ctrl:0
    v_mfma_f32_32x32x16_bf16 v[160:175], v[220:223], v[108:111], v[160:175]
    ds_read_b128 v[200:203], v14 offset:192
    v_mov_b32_dpp v131, v131 row_shr:1 row_mask:0xf bank_mask:0xf bound_ctrl:0
    v_mov_b32_dpp v132, v132 row_shr:1 row_mask:0xf bank_mask:0xf bound_ctrl:0
    v_mov_b32_dpp v133, v133 row_shr:1 row_mask:0xf bank_mask:0xf bound_ctrl:0
    v_mfma_f32_32x32x16_bf16 v[160:175], v[224:227], v[112:115], v[160:175]
    ds_read_b128 v[204:207], v14 offset:224
    v_mov_b32_dpp v134, v134 row_shr:1 row_mask:0xf bank_mask:0xf bound_ctrl:0
    v_mov_b32_dpp v135, v135 row_shr:1 row_mask:0xf bank_mask:0xf bound_ctrl:0
    v_mov_b32_dpp v136, v136 row_shr:1 row_mask:0xf bank_mask:0xf bound_ctrl:0
    v_mfma_f32_32x32x16_bf16 v[160:175], v[228:231], v[116:119], v[160:175]
    v_mov_b32_dpp v137, v137 row_shr:1 row_mask:0xf bank_mask:0xf bound_ctrl:0
    v_mov_b32_dpp v138, v138 row_shr:1 row_mask:0xf bank_mask:0xf bound_ctrl:0
    v_mov_b32_dpp v139, v139 row_shr:1 row_mask:0xf bank_mask:0xf bound_ctrl:0
    v_mfma_f32_32x32x16_bf16 v[160:175], v[232:235], v[120:123], v[160:175]
    v_mov_b32_dpp v140, v140 row_shr:1 row_mask:0xf bank_mask:0xf bound_ctrl:0
    v_mov_b32_dpp v141, v141 row_shr:1 row_mask:0xf bank_mask:0xf bound_ctrl:0
    v_mfma_f32_32x32x16_bf16 v[160:175], v[236:239], v[124:127], v[160:175]
    v_mov_b32_dpp v142, v142 row_shr:1 row_mask:0xf bank_mask:0xf bound_ctrl:0
    v_mov_b32_dpp v143, v143 row_shr:1 row_mask:0xf bank_mask:0xf bound_ctrl:0
    s_waitcnt lgkmcnt(0)
    v_mfma_f32_32x32x16_bf16 v[144:159], v[176:179], v[64:67], v[144:159]
    ds_read_b128 v[208:211], v14 offset:2048
    s_nop 3
    v_mfma_f32_32x32x16_bf16 v[144:159], v[180:183], v[68:71], v[144:159]
    ds_read_b128 v[212:215], v14 offset:2080
    s_nop 3
    v_mfma_f32_32x32x16_bf16 v[144:159], v[184:187], v[72:75], v[144:159]
    ds_read_b128 v[216:219], v14 offset:2112
    v_and_b32_dpp v160, v160, v15 row_shr:1 row_mask:0xf bank_mask:0xf bound_ctrl:0
    v_and_b32_dpp v161, v161, v15 row_shr:1 row_mask:0xf bank_mask:0xf bound_ctrl:0
    v_and_b32_dpp v162, v162, v15 row_shr:1 row_mask:0xf bank_mask:0xf bound_ctrl:0
    v_mfma_f32_32x32x16_bf16 v[144:159], v[188:191], v[76:79], v[144:159]
    ds_read_b128 v[220:223], v14 offset:2144
    v_and_b32_dpp v163, v163, v15 row_shr:1 row_mask:0xf bank_mask:0xf bound_ctrl:0
    v_and_b32_dpp v164, v164, v15 row_shr:1 row_mask:0xf bank_mask:0xf bound_ctrl:0
    v_and_b32_dpp v165, v165, v15 row_shr:1 row_mask:0xf bank_mask:0xf bound_ctrl:0
    v_mfma_f32_32x32x16_bf16 v[144:159], v[192:195], v[80:83], v[144:159]
    ds_read_b128 v[224:227], v14 offset:2176
    v_and_b32_dpp v166, v166, v15 row_shr:1 row_mask:0xf bank_mask:0xf bound_ctrl:0
    v_and_b32_dpp v167, v167, v15 row_shr:1 row_mask:0xf bank_mask:0xf bound_ctrl:0
    v_and_b32_dpp v168, v168, v15 row_shr:1 row_mask:0xf bank_mask:0xf bound_ctrl:0
    v_mfma_f32_32x32x16_bf16 v[144:159], v[196:199], v[84:87], v[144:159]
    ds_read_b128 v[228:231], v14 offset:2208
    v_and_b32_dpp v169, v169, v15 row_shr:1 row_mask:0xf bank_mask:0xf bound_ctrl:0
    v_and_b32_dpp v170, v170, v15 row_shr:1 row_mask:0xf bank_mask:0xf bound_ctrl:0
    v_and_b32_dpp v171, v171, v15 row_shr:1 row_mask:0xf bank_mask:0xf bound_ctrl:0
    v_mfma_f32_32x32x16_bf16 v[144:159], v[200:203], v[88:91], v[144:159]
    ds_read_b128 v[232:235], v14 offset:2240
    v_and_b32_dpp v172, v172, v15 row_shr:1 row_mask:0xf bank_mask:0xf bound_ctrl:0
    v_and_b32_dpp v173, v173, v15 row_shr:1 row_mask:0xf bank_mask:0xf bound_ctrl:0
    v_mfma_f32_32x32x16_bf16 v[144:159], v[204:207], v[92:95], v[144:159]
    ds_read_b128 v[236:239], v14 offset:2272
    v_and_b32_dpp v174, v174, v15 row_shr:1 row_mask:0xf bank_mask:0xf bound_ctrl:0
    v_and_b32_dpp v175, v175, v15 row_shr:1 row_mask:0xf bank_mask:0xf bound_ctrl:0
    v_mfma_f32_32x32x16_bf16 v[128:143], v[176:179], v[32:35], v[128:143]
    v_mfma_f32_32x32x16_bf16 v[128:143], v[180:183], v[36:39], v[128:143]
    v_mfma_f32_32x32x16_bf16 v[128:143], v[184:187], v[40:43], v[128:143]
    v_mfma_f32_32x32x16_bf16 v[128:143], v[188:191], v[44:47], v[128:143]
    v_mfma_f32_32x32x16_bf16 v[128:143], v[192:195], v[48:51], v[128:143]
    v_mfma_f32_32x32x16_bf16 v[128:143], v[196:199], v[52:55], v[128:143]
    v_mfma_f32_32x32x16_bf16 v[128:143], v[200:203], v[56:59], v[128:143]
    v_mfma_f32_32x32x16_bf16 v[128:143], v[204:207], v[60:63], v[128:143]
    s_waitcnt lgkmcnt(0)
    v_mfma_f32_32x32x16_bf16 v[160:175], v[208:211], v[96:99], v[160:175]
    v_mfma_f32_32x32x16_bf16 v[160:175], v[212:215], v[100:103], v[160:175]
    v_mfma_f32_32x32x16_bf16 v[160:175], v[216:219], v[104:107], v[160:175]
    v_mfma_f32_32x32x16_bf16 v[160:175], v[220:223], v[108:111], v[160:175]
    v_mfma_f32_32x32x16_bf16 v[160:175], v[224:227], v[112:115], v[160:175]
    v_mfma_f32_32x32x16_bf16 v[160:175], v[228:231], v[116:119], v[160:175]
    v_mfma_f32_32x32x16_bf16 v[160:175], v[232:235], v[120:123], v[160:175]
    v_mfma_f32_32x32x16_bf16 v[160:175], v[236:239], v[124:127], v[160:175]
    s_nop 11
    v_add_f32_dpp v128, v160, v128 row_shr:8 row_mask:0xf bank_mask:0xf bound_ctrl:0
    v_add_f32_dpp v129, v161, v129 row_shr:8 row_mask:0xf bank_mask:0xf bound_ctrl:0
    v_add_f32_dpp v130, v162, v130 row_shr:8 row_mask:0xf bank_mask:0xf bound_ctrl:0
    v_add_f32_dpp v131, v163, v131 row_shr:8 row_mask:0xf bank_mask:0xf bound_ctrl:0
    v_add_f32_dpp v132, v164, v132 row_shr:8 row_mask:0xf bank_mask:0xf bound_ctrl:0
    v_add_f32_dpp v133, v165, v133 row_shr:8 row_mask:0xf bank_mask:0xf bound_ctrl:0
    v_add_f32_dpp v134, v166, v134 row_shr:8 row_mask:0xf bank_mask:0xf bound_ctrl:0
    v_add_f32_dpp v135, v167, v135 row_shr:8 row_mask:0xf bank_mask:0xf bound_ctrl:0
    v_add_f32_dpp v136, v168, v136 row_shr:8 row_mask:0xf bank_mask:0xf bound_ctrl:0
    v_add_f32_dpp v137, v169, v137 row_shr:8 row_mask:0xf bank_mask:0xf bound_ctrl:0
    v_add_f32_dpp v138, v170, v138 row_shr:8 row_mask:0xf bank_mask:0xf bound_ctrl:0
    v_add_f32_dpp v139, v171, v139 row_shr:8 row_mask:0xf bank_mask:0xf bound_ctrl:0
    v_add_f32_dpp v140, v172, v140 row_shr:8 row_mask:0xf bank_mask:0xf bound_ctrl:0
    v_add_f32_dpp v141, v173, v141 row_shr:8 row_mask:0xf bank_mask:0xf bound_ctrl:0
    v_add_f32_dpp v142, v174, v142 row_shr:8 row_mask:0xf bank_mask:0xf bound_ctrl:0
    v_add_f32_dpp v143, v175, v143 row_shr:8 row_mask:0xf bank_mask:0xf bound_ctrl:0
    s_mov_b32 s42, 0xff00ff00
    s_mov_b32 s43, 0xff00ff00
    s_mov_b64 exec, s[42:43]
    v_add_f32 v144, v160, v144
    v_add_f32 v145, v161, v145
    v_add_f32 v146, v162, v146
    v_add_f32 v147, v163, v147
    v_add_f32 v148, v164, v148
    v_add_f32 v149, v165, v149
    v_add_f32 v150, v166, v150
    v_add_f32 v151, v167, v151
    v_add_f32 v152, v168, v152
    v_add_f32 v153, v169, v153
    v_add_f32 v154, v170, v154
    v_add_f32 v155, v171, v155
    v_add_f32 v156, v172, v156
    v_add_f32 v157, v173, v157
    v_add_f32 v158, v174, v158
    v_add_f32 v159, v175, v159
    s_mov_b64 exec, -1
    v_mul_u32_u24 v16, 264, v7
    v_lshl_add_u32 v16, v9, 5, v16
    v_lshl_add_u32 v16, v8, 2, v16
    v_add_u32 v16, s34, v16
    v_cvt_pk_bf16_f32 v32, v128, v144
    v_cvt_pk_bf16_f32 v33, v129, v145
    v_cvt_pk_bf16_f32 v34, v130, v146
    v_cvt_pk_bf16_f32 v35, v131, v147
    v_cvt_pk_bf16_f32 v36, v132, v148
    v_cvt_pk_bf16_f32 v37, v133, v149
    v_cvt_pk_bf16_f32 v38, v134, v150
    v_cvt_pk_bf16_f32 v39, v135, v151
    v_cvt_pk_bf16_f32 v40, v136, v152
    v_cvt_pk_bf16_f32 v41, v137, v153
    v_cvt_pk_bf16_f32 v42, v138, v154
    v_cvt_pk_bf16_f32 v43, v139, v155
    v_cvt_pk_bf16_f32 v44, v140, v156
    v_cvt_pk_bf16_f32 v45, v141, v157
    v_cvt_pk_bf16_f32 v46, v142, v158
    v_cvt_pk_bf16_f32 v47, v143, v159
    ds_write_b32 v16, v32 offset:0
    ds_write_b32 v16, v33 offset:8
    ds_write_b32 v16, v34 offset:16
    ds_write_b32 v16, v35 offset:24
    ds_write_b32 v16, v36 offset:64
    ds_write_b32 v16, v37 offset:72
    ds_write_b32 v16, v38 offset:80
    ds_write_b32 v16, v39 offset:88
    ds_write_b32 v16, v40 offset:128
    ds_write_b32 v16, v41 offset:136
    ds_write_b32 v16, v42 offset:144
    ds_write_b32 v16, v43 offset:152
    ds_write_b32 v16, v44 offset:192
    ds_write_b32 v16, v45 offset:200
    ds_write_b32 v16, v46 offset:208
    ds_write_b32 v16, v47 offset:216
    s_lshl_b32 s44, s32, 16
    s_and_b32 s45, s32, 0xffff0000
    s_lshl_b32 s46, s33, 16
    s_and_b32 s47, s33, 0xffff0000
    v_mul_u32_u24 v17, 264, v2
    v_lshl_add_u32 v17, v1, 2, v17
    s_waitcnt lgkmcnt(0)
    s_barrier
    v_mul_u32_u24 v19, 272, v2
    v_lshlrev_b32 v18, 2, v1
    v_sub_u32 v19, v19, v18
    v_add_u32 v19, 4604, v19
    ds_read_b32 v48, v17 offset:0
    ds_read_b32 v49, v17 offset:13824
    ds_read_b32 v50, v17 offset:27648
    ds_read_b32 v51, v17 offset:41472
    ds_read_b32 v52, v17 offset:1056
    ds_read_b32 v53, v17 offset:14880
    ds_read_b32 v54, v17 offset:28704
    ds_read_b32 v55, v17 offset:42528
    ds_read_b32 v56, v17 offset:2112
    ds_read_b32 v57, v17 offset:15936
    ds_read_b32 v58, v17 offset:29760
    ds_read_b32 v59, v17 offset:43584
    ds_read_b32 v60, v17 offset:3168
    ds_read_b32 v61, v17 offset:16992
    ds_read_b32 v62, v17 offset:30816
    ds_read_b32 v63, v17 offset:44640
    s_waitcnt lgkmcnt(0)
    ds_read_b32 v224, v19 offset:0
    ds_read_b32 v225, v19 offset:13824
    ds_read_b32 v226, v19 offset:27648
    ds_read_b32 v227, v19 offset:41472
    ds_read_b32 v228, v19 offset:1088
    ds_read_b32 v229, v19 offset:14912
    ds_read_b32 v230, v19 offset:28736
    ds_read_b32 v231, v19 offset:42560
    ds_read_b32 v232, v19 offset:2176
    ds_read_b32 v233, v19 offset:16000
    ds_read_b32 v234, v19 offset:29824
    ds_read_b32 v235, v19 offset:43648
    ds_read_b32 v236, v19 offset:3264
    ds_read_b32 v237, v19 offset:17088
    ds_read_b32 v238, v19 offset:30912
    ds_read_b32 v239, v19 offset:44736
    v_mov_b32 v28, s44
    v_mov_b32 v29, s45
    v_mov_b32 v30, s46
    v_mov_b32 v31, s47
    s_waitcnt vmcnt(0)
    v_accvgpr_read_b32 v176, a0
    v_accvgpr_read_b32 v144, a16
    v_accvgpr_read_b32 v177, a1
    v_accvgpr_read_b32 v145, a17
    v_accvgpr_read_b32 v178, a2
    v_accvgpr_read_b32 v146, a18
    v_accvgpr_read_b32 v179, a3
    v_accvgpr_read_b32 v147, a19
    v_accvgpr_read_b32 v180, a4
    v_accvgpr_read_b32 v148, a20
    v_accvgpr_read_b32 v181, a5
    v_accvgpr_read_b32 v149, a21
    v_accvgpr_read_b32 v182, a6
    v_accvgpr_read_b32 v150, a22
    v_accvgpr_read_b32 v183, a7
    v_accvgpr_read_b32 v151, a23
    v_accvgpr_read_b32 v184, a8
    v_accvgpr_read_b32 v152, a24
    v_accvgpr_read_b32 v185, a9
    v_accvgpr_read_b32 v153, a25
    v_accvgpr_read_b32 v186, a10
    v_accvgpr_read_b32 v154, a26
    v_accvgpr_read_b32 v187, a11
    v_accvgpr_read_b32 v155, a27
    v_accvgpr_read_b32 v188, a12
    v_accvgpr_read_b32 v156, a28
    v_accvgpr_read_b32 v189, a13
    v_accvgpr_read_b32 v157, a29
    v_accvgpr_read_b32 v190, a14
    v_accvgpr_read_b32 v158, a30
    v_accvgpr_read_b32 v191, a15
    v_accvgpr_read_b32 v159, a31
    s_waitcnt lgkmcnt(0)
    v_lshlrev_b32 v68, 16, v224
    v_and_b32 v64, 0xffff0000, v224
    v_lshlrev_b32 v69, 16, v225
    v_and_b32 v65, 0xffff0000, v225
    v_lshlrev_b32 v70, 16, v226
    v_and_b32 v66, 0xffff0000, v226
    v_lshlrev_b32 v71, 16, v227
    v_and_b32 v67, 0xffff0000, v227
    v_lshlrev_b32 v74, 16, v48
    v_and_b32 v78, 0xffff0000, v48
    v_lshlrev_b32 v75, 16, v49
    v_and_b32 v79, 0xffff0000, v49
    v_lshlrev_b32 v76, 16, v50
    v_and_b32 v80, 0xffff0000, v50
    v_lshlrev_b32 v77, 16, v51
    v_and_b32 v81, 0xffff0000, v51
    v_lshlrev_b32 v112, 16, v176
    v_and_b32 v113, 0xffff0000, v176
    v_lshlrev_b32 v114, 16, v177
    v_and_b32 v115, 0xffff0000, v177
    v_lshlrev_b32 v116, 16, v178
    v_and_b32 v117, 0xffff0000, v178
    v_lshlrev_b32 v118, 16, v179
    v_and_b32 v119, 0xffff0000, v179
    v_pk_fma_f32 v[64:65], v[64:65], v[28:29], v[74:75]
    v_pk_fma_f32 v[66:67], v[66:67], v[30:31], v[76:77]
    v_pk_fma_f32 v[68:69], v[68:69], v[28:29], v[78:79]
    v_pk_fma_f32 v[70:71], v[70:71], v[30:31], v[80:81]
    v_pk_fma_f32 v[120:121], v[112:113], v[144:145], v[144:145] op_sel:[0,1,0] op_sel_hi:[1,1,0]
    v_pk_fma_f32 v[122:123], v[114:115], v[144:145], v[144:145] op_sel:[0,1,0] op_sel_hi:[1,1,0]
    v_pk_fma_f32 v[124:125], v[116:117], v[146:147], v[146:147] op_sel:[0,1,0] op_sel_hi:[1,1,0]
    v_pk_fma_f32 v[126:127], v[118:119], v[146:147], v[146:147] op_sel:[0,1,0] op_sel_hi:[1,1,0]
    v_pk_fma_f32 v[120:121], v[120:121], v[240:241], v[244:245]
    v_pk_fma_f32 v[122:123], v[122:123], v[242:243], v[246:247]
    v_pk_fma_f32 v[124:125], v[124:125], v[240:241], v[244:245]
    v_pk_fma_f32 v[126:127], v[126:127], v[242:243], v[246:247]
    v_pk_fma_f32 v[64:65], v[64:65], v[120:121], v[112:113]
    v_pk_fma_f32 v[66:67], v[66:67], v[122:123], v[114:115]
    v_pk_fma_f32 v[68:69], v[68:69], v[124:125], v[116:117]
    v_pk_fma_f32 v[70:71], v[70:71], v[126:127], v[118:119]
    v_cvt_pk_bf16_f32 v96, v64, v65
    v_cvt_pk_bf16_f32 v97, v66, v67
    v_cvt_pk_bf16_f32 v98, v68, v69
    v_cvt_pk_bf16_f32 v99, v70, v71
    v_lshlrev_b32 v68, 16, v228
    v_and_b32 v64, 0xffff0000, v228
    v_lshlrev_b32 v69, 16, v229
    v_and_b32 v65, 0xffff0000, v229
    v_lshlrev_b32 v70, 16, v230
    v_and_b32 v66, 0xffff0000, v230
    v_lshlrev_b32 v71, 16, v231
    v_and_b32 v67, 0xffff0000, v231
    v_lshlrev_b32 v74, 16, v52
    v_and_b32 v78, 0xffff0000, v52
    v_lshlrev_b32 v75, 16, v53
    v_and_b32 v79, 0xffff0000, v53
    v_lshlrev_b32 v76, 16, v54
    v_and_b32 v80, 0xffff0000, v54
    v_lshlrev_b32 v77, 16, v55
    v_and_b32 v81, 0xffff0000, v55
    v_lshlrev_b32 v112, 16, v180
    v_and_b32 v113, 0xffff0000, v180
    v_lshlrev_b32 v114, 16, v181
    v_and_b32 v115, 0xffff0000, v181
    v_lshlrev_b32 v116, 16, v182
    v_and_b32 v117, 0xffff0000, v182
    v_lshlrev_b32 v118, 16, v183
    v_and_b32 v119, 0xffff0000, v183
    v_pk_fma_f32 v[64:65], v[64:65], v[28:29], v[74:75]
    v_pk_fma_f32 v[66:67], v[66:67], v[30:31], v[76:77]
    v_pk_fma_f32 v[68:69], v[68:69], v[28:29], v[78:79]
    v_pk_fma_f32 v[70:71], v[70:71], v[30:31], v[80:81]
    v_pk_fma_f32 v[120:121], v[112:113], v[148:149], v[148:149] op_sel:[0,1,0] op_sel_hi:[1,1,0]
    v_pk_fma_f32 v[122:123], v[114:115], v[148:149], v[148:149] op_sel:[0,1,0] op_sel_hi:[1,1,0]
    v_pk_fma_f32 v[124:125], v[116:117], v[150:151], v[150:151] op_sel:[0,1,0] op_sel_hi:[1,1,0]
    v_pk_fma_f32 v[126:127], v[118:119], v[150:151], v[150:151] op_sel:[0,1,0] op_sel_hi:[1,1,0]
    v_pk_fma_f32 v[120:121], v[120:121], v[240:241], v[244:245]
    v_pk_fma_f32 v[122:123], v[122:123], v[242:243], v[246:247]
    v_pk_fma_f32 v[124:125], v[124:125], v[240:241], v[244:245]
    v_pk_fma_f32 v[126:127], v[126:127], v[242:243], v[246:247]
    v_pk_fma_f32 v[64:65], v[64:65], v[120:121], v[112:113]
    v_pk_fma_f32 v[66:67], v[66:67], v[122:123], v[114:115]
    v_pk_fma_f32 v[68:69], v[68:69], v[124:125], v[116:117]
    v_pk_fma_f32 v[70:71], v[70:71], v[126:127], v[118:119]
    v_cvt_pk_bf16_f32 v100, v64, v65
    v_cvt_pk_bf16_f32 v101, v66, v67
    v_cvt_pk_bf16_f32 v102, v68, v69
    v_cvt_pk_bf16_f32 v103, v70, v71
    v_lshlrev_b32 v68, 16, v232
    v_and_b32 v64, 0xffff0000, v232
    v_lshlrev_b32 v69, 16, v233
    v_and_b32 v65, 0xffff0000, v233
    v_lshlrev_b32 v70, 16, v234
    v_and_b32 v66, 0xffff0000, v234
    v_lshlrev_b32 v71, 16, v235
    v_and_b32 v67, 0xffff0000, v235
    v_lshlrev_b32 v74, 16, v56
    v_and_b32 v78, 0xffff0000, v56
    v_lshlrev_b32 v75, 16, v57
    v_and_b32 v79, 0xffff0000, v57
    v_lshlrev_b32 v76, 16, v58
    v_and_b32 v80, 0xffff0000, v58
    v_lshlrev_b32 v77, 16, v59
    v_and_b32 v81, 0xffff0000, v59
    v_lshlrev_b32 v112, 16, v184
    v_and_b32 v113, 0xffff0000, v184
    v_lshlrev_b32 v114, 16, v185
    v_and_b32 v115, 0xffff0000, v185
    v_lshlrev_b32 v116, 16, v186
    v_and_b32 v117, 0xffff0000, v186
    v_lshlrev_b32 v118, 16, v187
    v_and_b32 v119, 0xffff0000, v187
    v_pk_fma_f32 v[64:65], v[64:65], v[28:29], v[74:75]
    v_pk_fma_f32 v[66:67], v[66:67], v[30:31], v[76:77]
    v_pk_fma_f32 v[68:69], v[68:69], v[28:29], v[78:79]
    v_pk_fma_f32 v[70:71], v[70:71], v[30:31], v[80:81]
    v_pk_fma_f32 v[120:121], v[112:113], v[152:153], v[152:153] op_sel:[0,1,0] op_sel_hi:[1,1,0]
    v_pk_fma_f32 v[122:123], v[114:115], v[152:153], v[152:153] op_sel:[0,1,0] op_sel_hi:[1,1,0]
    v_pk_fma_f32 v[124:125], v[116:117], v[154:155], v[154:155] op_sel:[0,1,0] op_sel_hi:[1,1,0]
    v_pk_fma_f32 v[126:127], v[118:119], v[154:155], v[154:155] op_sel:[0,1,0] op_sel_hi:[1,1,0]
    v_pk_fma_f32 v[120:121], v[120:121], v[240:241], v[244:245]
    v_pk_fma_f32 v[122:123], v[122:123], v[242:243], v[246:247]
    v_pk_fma_f32 v[124:125], v[124:125], v[240:241], v[244:245]
    v_pk_fma_f32 v[126:127], v[126:127], v[242:243], v[246:247]
    v_pk_fma_f32 v[64:65], v[64:65], v[120:121], v[112:113]
    v_pk_fma_f32 v[66:67], v[66:67], v[122:123], v[114:115]
    v_pk_fma_f32 v[68:69], v[68:69], v[124:125], v[116:117]
    v_pk_fma_f32 v[70:71], v[70:71], v[126:127], v[118:119]
    v_cvt_pk_bf16_f32 v104, v64, v65
    v_cvt_pk_bf16_f32 v105, v66, v67
    v_cvt_pk_bf16_f32 v106, v68, v69
    v_cvt_pk_bf16_f32 v107, v70, v71
    v_lshlrev_b32 v68, 16, v236
    v_and_b32 v64, 0xffff0000, v236
    v_lshlrev_b32 v69, 16, v237
    v_and_b32 v65, 0xffff0000, v237
    v_lshlrev_b32 v70, 16, v238
    v_and_b32 v66, 0xffff0000, v238
    v_lshlrev_b32 v71, 16, v239
    v_and_b32 v67, 0xffff0000, v239
    v_lshlrev_b32 v74, 16, v60
    v_and_b32 v78, 0xffff0000, v60
    v_lshlrev_b32 v75, 16, v61
    v_and_b32 v79, 0xffff0000, v61
    v_lshlrev_b32 v76, 16, v62
    v_and_b32 v80, 0xffff0000, v62
    v_lshlrev_b32 v77, 16, v63
    v_and_b32 v81, 0xffff0000, v63
    v_lshlrev_b32 v112, 16, v188
    v_and_b32 v113, 0xffff0000, v188
    v_lshlrev_b32 v114, 16, v189
    v_and_b32 v115, 0xffff0000, v189
    v_lshlrev_b32 v116, 16, v190
    v_and_b32 v117, 0xffff0000, v190
    v_lshlrev_b32 v118, 16, v191
    v_and_b32 v119, 0xffff0000, v191
    v_pk_fma_f32 v[64:65], v[64:65], v[28:29], v[74:75]
    v_pk_fma_f32 v[66:67], v[66:67], v[30:31], v[76:77]
    v_pk_fma_f32 v[68:69], v[68:69], v[28:29], v[78:79]
    v_pk_fma_f32 v[70:71], v[70:71], v[30:31], v[80:81]
    v_pk_fma_f32 v[120:121], v[112:113], v[156:157], v[156:157] op_sel:[0,1,0] op_sel_hi:[1,1,0]
    v_pk_fma_f32 v[122:123], v[114:115], v[156:157], v[156:157] op_sel:[0,1,0] op_sel_hi:[1,1,0]
    v_pk_fma_f32 v[124:125], v[116:117], v[158:159], v[158:159] op_sel:[0,1,0] op_sel_hi:[1,1,0]
    v_pk_fma_f32 v[126:127], v[118:119], v[158:159], v[158:159] op_sel:[0,1,0] op_sel_hi:[1,1,0]
    v_pk_fma_f32 v[120:121], v[120:121], v[240:241], v[244:245]
    v_pk_fma_f32 v[122:123], v[122:123], v[242:243], v[246:247]
    v_pk_fma_f32 v[124:125], v[124:125], v[240:241], v[244:245]
    v_pk_fma_f32 v[126:127], v[126:127], v[242:243], v[246:247]
    v_pk_fma_f32 v[64:65], v[64:65], v[120:121], v[112:113]
    v_pk_fma_f32 v[66:67], v[66:67], v[122:123], v[114:115]
    v_pk_fma_f32 v[68:69], v[68:69], v[124:125], v[116:117]
    v_pk_fma_f32 v[70:71], v[70:71], v[126:127], v[118:119]
    v_cvt_pk_bf16_f32 v108, v64, v65
    v_cvt_pk_bf16_f32 v109, v66, v67
    v_cvt_pk_bf16_f32 v110, v68, v69
    v_cvt_pk_bf16_f32 v111, v70, v71
    s_add_u32 s39, s38, 5492736
    buffer_store_dwordx4 v[96:99], v4, s[28:31], s39 offen sc1
    s_add_u32 s39, s39, 655360
    buffer_store_dwordx4 v[100:103], v4, s[28:31], s39 offen sc1
    s_add_u32 s39, s39, 655360
    buffer_store_dwordx4 v[104:107], v4, s[28:31], s39 offen sc1
    s_add_u32 s39, s39, 655360
    buffer_store_dwordx4 v[108:111], v4, s[28:31], s39 offen sc1
    s_add_u32 s39, s39, 655360
    s_waitcnt vmcnt(0)
    s_endpgm
k1_help:
    s_mul_i32 s21, s58, 12
    s_add_u32 s21, s21, s59
    s_sub_u32 s21, s21, 20
    s_mul_i32 s22, s20, 96
    s_add_u32 s21, s21, s22
    s_mul_i32 s34, s20, 13824
    s_cmp_lt_u32 s21, 120
    s_cbranch_scc1 k1_mod0
    s_sub_u32 s21, s21, 120
    s_cmp_lt_u32 s21, 154
    s_cbranch_scc1 k1_pack
    s_sub_u32 s21, s21, 154
    s_cmp_lt_u32 s21, 30
    s_cbranch_scc1 k1_fin
    s_endpgm
k1_mod0:
    s_add_u32 s21, s21, 120
k1_mod:
    s_lshr_b32 s32, s21, 2
    s_and_b32 s33, s21, 3
    v_lshrrev_b32 v4, 3, v1
    v_and_b32 v3, 7, v1
    s_mul_i32 s34, s33, 160
    v_add_u32 v4, s34, v4
    v_lshlrev_b32 v5, 1, v4
    v_mul_u32_u24 v6, 7680, v4
    s_lshl_b32 s36, s32, 7
    v_lshl_add_u32 v7, v3, 4, s36
    v_add_u32 v6, v6, v7
    s_mov_b32 s16, s52
    s_mov_b32 s17, s53
    s_mov_b32 s18, 1280
    s_mov_b32 s19, 0x00020000
    s_mov_b32 s24, s62
    s_mov_b32 s25, s63
    s_mov_b32 s26, 4915200
    s_mov_b32 s27, 0x00020000
    s_mul_i32 s35, s33, 320
    v_lshlrev_b32 v5, 3, v1
    buffer_load_dwordx2 v[30:31], v5, s[16:19], s35 offen
    s_mov_b32 s37, 0
    buffer_load_dwordx4 v[32:35], v6, s[24:27], s37 offen nt
    s_add_u32 s37, s37, 61440
    buffer_load_dwordx4 v[36:39], v6, s[24:27], s37 offen nt
    s_add_u32 s37, s37, 61440
    buffer_load_dwordx4 v[40:43], v6, s[24:27], s37 offen nt
    s_add_u32 s37, s37, 61440
    buffer_load_dwordx4 v[44:47], v6, s[24:27], s37 offen nt
    s_add_u32 s37, s37, 61440
    buffer_load_dwordx4 v[48:51], v6, s[24:27], s37 offen nt
    s_add_u32 s37, s37, 61440
    buffer_load_dwordx4 v[52:55], v6, s[24:27], s37 offen nt
    s_add_u32 s37, s37, 61440
    buffer_load_dwordx4 v[56:59], v6, s[24:27], s37 offen nt
    s_add_u32 s37, s37, 61440
    buffer_load_dwordx4 v[60:63], v6, s[24:27], s37 offen nt
    s_add_u32 s37, s37, 61440
    buffer_load_dwordx4 v[64:67], v6, s[24:27], s37 offen nt
    s_add_u32 s37, s37, 61440
    buffer_load_dwordx4 v[68:71], v6, s[24:27], s37 offen nt
    s_add_u32 s37, s37, 61440
    buffer_load_dwordx4 v[72:75], v6, s[24:27], s37 offen nt
    s_add_u32 s37, s37, 61440
    buffer_load_dwordx4 v[76:79], v6, s[24:27], s37 offen nt
    s_add_u32 s37, s37, 61440
    buffer_load_dwordx4 v[80:83], v6, s[24:27], s37 offen nt
    s_add_u32 s37, s37, 61440
    buffer_load_dwordx4 v[84:87], v6, s[24:27], s37 offen nt
    s_add_u32 s37, s37, 61440
    buffer_load_dwordx4 v[88:91], v6, s[24:27], s37 offen nt
    s_add_u32 s37, s37, 61440
    buffer_load_dwordx4 v[92:95], v6, s[24:27], s37 offen nt
    s_add_u32 s37, s37, 61440
    buffer_load_dwordx4 v[96:99], v6, s[24:27], s37 offen nt
    s_add_u32 s37, s37, 61440
    buffer_load_dwordx4 v[100:103], v6, s[24:27], s37 offen nt
    s_add_u32 s37, s37, 61440
    buffer_load_dwordx4 v[104:107], v6, s[24:27], s37 offen nt
    s_add_u32 s37, s37, 61440
    buffer_load_dwordx4 v[108:111], v6, s[24:27], s37 offen nt
    s_mul_i32 s35, s20, 13824
    v_lshlrev_b32 v5, 4, v1
    v_add_u32 v5, s35, v5
    v_lshrrev_b32 v29, 3, v1
    v_lshlrev_b32 v29, 2, v29
    v_add_u32 v29, s35, v29
    s_waitcnt vmcnt(20)
    v_lshlrev_b32 v8, 16, v30
    v_and_b32 v9, 0xffff0000, v30
    v_lshlrev_b32 v10, 16, v31
    v_and_b32 v11, 0xffff0000, v31
    v_mul_f32 v120, 0xbfb8aa3b, v8
    v_mul_f32 v121, 0xbfb8aa3b, v9
    v_mul_f32 v122, 0xbfb8aa3b, v10
    v_mul_f32 v123, 0xbfb8aa3b, v11
    v_exp_f32 v120, v120
    v_exp_f32 v121, v121
    v_exp_f32 v122, v122
    v_exp_f32 v123, v123
    v_add_f32 v120, 1.0, v120
    v_add_f32 v121, 1.0, v121
    v_add_f32 v122, 1.0, v122
    v_add_f32 v123, 1.0, v123
    v_rcp_f32 v120, v120
    v_rcp_f32 v121, v121
    v_rcp_f32 v122, v122
    v_rcp_f32 v123, v123
    s_nop 0
    v_mul_f32 v8, v8, v120
    v_mul_f32 v9, v9, v121
    v_mul_f32 v10, v10, v122
    v_mul_f32 v11, v11, v123
    v_cvt_pk_bf16_f32 v120, v8, v9
    v_lshlrev_b32 v8, 16, v120
    v_and_b32 v9, 0xffff0000, v120
    v_cvt_pk_bf16_f32 v120, v10, v11
    v_lshlrev_b32 v10, 16, v120
    v_and_b32 v11, 0xffff0000, v120
    ds_write_b128 v5, v[8:11]
    s_waitcnt lgkmcnt(0)
    ds_read_b32 v8, v29 offset:0
    ds_read_b32 v9, v29 offset:32
    ds_read_b32 v10, v29 offset:64
    ds_read_b32 v11, v29 offset:96
    ds_read_b32 v12, v29 offset:128
    ds_read_b32 v13, v29 offset:160
    ds_read_b32 v14, v29 offset:192
    ds_read_b32 v15, v29 offset:224
    ds_read_b32 v16, v29 offset:256
    ds_read_b32 v17, v29 offset:288
    ds_read_b32 v18, v29 offset:320
    ds_read_b32 v19, v29 offset:352
    ds_read_b32 v20, v29 offset:384
    ds_read_b32 v21, v29 offset:416
    ds_read_b32 v22, v29 offset:448
    ds_read_b32 v23, v29 offset:480
    ds_read_b32 v24, v29 offset:512
    ds_read_b32 v25, v29 offset:544
    ds_read_b32 v26, v29 offset:576
    ds_read_b32 v27, v29 offset:608
    s_waitcnt lgkmcnt(0)
    v_mov_b32 v112, 0
    v_mov_b32 v113, 0
    v_mov_b32 v114, 0
    v_mov_b32 v115, 0
    v_mov_b32 v116, 0
    v_mov_b32 v117, 0
    v_mov_b32 v118, 0
    v_mov_b32 v119, 0
    s_waitcnt vmcnt(19)
    v_lshlrev_b32 v120, 16, v32
    v_and_b32 v121, 0xffff0000, v32
    v_lshlrev_b32 v122, 16, v33
    v_and_b32 v123, 0xffff0000, v33
    v_lshlrev_b32 v124, 16, v34
    v_and_b32 v125, 0xffff0000, v34
    v_lshlrev_b32 v126, 16, v35
    v_and_b32 v127, 0xffff0000, v35
    v_pk_fma_f32 v[112:113], v[120:121], v[8:9], v[112:113] op_sel:[0,0,0] op_sel_hi:[1,0,1]
    v_pk_fma_f32 v[114:115], v[122:123], v[8:9], v[114:115] op_sel:[0,0,0] op_sel_hi:[1,0,1]
    v_pk_fma_f32 v[116:117], v[124:125], v[8:9], v[116:117] op_sel:[0,0,0] op_sel_hi:[1,0,1]
    v_pk_fma_f32 v[118:119], v[126:127], v[8:9], v[118:119] op_sel:[0,0,0] op_sel_hi:[1,0,1]
    s_waitcnt vmcnt(18)
    v_lshlrev_b32 v120, 16, v36
    v_and_b32 v121, 0xffff0000, v36
    v_lshlrev_b32 v122, 16, v37
    v_and_b32 v123, 0xffff0000, v37
    v_lshlrev_b32 v124, 16, v38
    v_and_b32 v125, 0xffff0000, v38
    v_lshlrev_b32 v126, 16, v39
    v_and_b32 v127, 0xffff0000, v39
    v_pk_fma_f32 v[112:113], v[120:121], v[8:9], v[112:113] op_sel:[0,1,0] op_sel_hi:[1,1,1]
    v_pk_fma_f32 v[114:115], v[122:123], v[8:9], v[114:115] op_sel:[0,1,0] op_sel_hi:[1,1,1]
    v_pk_fma_f32 v[116:117], v[124:125], v[8:9], v[116:117] op_sel:[0,1,0] op_sel_hi:[1,1,1]
    v_pk_fma_f32 v[118:119], v[126:127], v[8:9], v[118:119] op_sel:[0,1,0] op_sel_hi:[1,1,1]
    s_waitcnt vmcnt(17)
    v_lshlrev_b32 v120, 16, v40
    v_and_b32 v121, 0xffff0000, v40
    v_lshlrev_b32 v122, 16, v41
    v_and_b32 v123, 0xffff0000, v41
    v_lshlrev_b32 v124, 16, v42
    v_and_b32 v125, 0xffff0000, v42
    v_lshlrev_b32 v126, 16, v43
    v_and_b32 v127, 0xffff0000, v43
    v_pk_fma_f32 v[112:113], v[120:121], v[10:11], v[112:113] op_sel:[0,0,0] op_sel_hi:[1,0,1]
    v_pk_fma_f32 v[114:115], v[122:123], v[10:11], v[114:115] op_sel:[0,0,0] op_sel_hi:[1,0,1]
    v_pk_fma_f32 v[116:117], v[124:125], v[10:11], v[116:117] op_sel:[0,0,0] op_sel_hi:[1,0,1]
    v_pk_fma_f32 v[118:119], v[126:127], v[10:11], v[118:119] op_sel:[0,0,0] op_sel_hi:[1,0,1]
    s_waitcnt vmcnt(16)
    v_lshlrev_b32 v120, 16, v44
    v_and_b32 v121, 0xffff0000, v44
    v_lshlrev_b32 v122, 16, v45
    v_and_b32 v123, 0xffff0000, v45
    v_lshlrev_b32 v124, 16, v46
    v_and_b32 v125, 0xffff0000, v46
    v_lshlrev_b32 v126, 16, v47
    v_and_b32 v127, 0xffff0000, v47
    v_pk_fma_f32 v[112:113], v[120:121], v[10:11], v[112:113] op_sel:[0,1,0] op_sel_hi:[1,1,1]
    v_pk_fma_f32 v[114:115], v[122:123], v[10:11], v[114:115] op_sel:[0,1,0] op_sel_hi:[1,1,1]
    v_pk_fma_f32 v[116:117], v[124:125], v[10:11], v[116:117] op_sel:[0,1,0] op_sel_hi:[1,1,1]
    v_pk_fma_f32 v[118:119], v[126:127], v[10:11], v[118:119] op_sel:[0,1,0] op_sel_hi:[1,1,1]
    s_waitcnt vmcnt(15)
    v_lshlrev_b32 v120, 16, v48
    v_and_b32 v121, 0xffff0000, v48
    v_lshlrev_b32 v122, 16, v49
    v_and_b32 v123, 0xffff0000, v49
    v_lshlrev_b32 v124, 16, v50
    v_and_b32 v125, 0xffff0000, v50
    v_lshlrev_b32 v126, 16, v51
    v_and_b32 v127, 0xffff0000, v51
    v_pk_fma_f32 v[112:113], v[120:121], v[12:13], v[112:113] op_sel:[0,0,0] op_sel_hi:[1,0,1]
    v_pk_fma_f32 v[114:115], v[122:123], v[12:13], v[114:115] op_sel:[0,0,0] op_sel_hi:[1,0,1]
    v_pk_fma_f32 v[116:117], v[124:125], v[12:13], v[116:117] op_sel:[0,0,0] op_sel_hi:[1,0,1]
    v_pk_fma_f32 v[118:119], v[126:127], v[12:13], v[118:119] op_sel:[0,0,0] op_sel_hi:[1,0,1]
    s_waitcnt vmcnt(14)
    v_lshlrev_b32 v120, 16, v52
    v_and_b32 v121, 0xffff0000, v52
    v_lshlrev_b32 v122, 16, v53
    v_and_b32 v123, 0xffff0000, v53
    v_lshlrev_b32 v124, 16, v54
    v_and_b32 v125, 0xffff0000, v54
    v_lshlrev_b32 v126, 16, v55
    v_and_b32 v127, 0xffff0000, v55
    v_pk_fma_f32 v[112:113], v[120:121], v[12:13], v[112:113] op_sel:[0,1,0] op_sel_hi:[1,1,1]
    v_pk_fma_f32 v[114:115], v[122:123], v[12:13], v[114:115] op_sel:[0,1,0] op_sel_hi:[1,1,1]
    v_pk_fma_f32 v[116:117], v[124:125], v[12:13], v[116:117] op_sel:[0,1,0] op_sel_hi:[1,1,1]
    v_pk_fma_f32 v[118:119], v[126:127], v[12:13], v[118:119] op_sel:[0,1,0] op_sel_hi:[1,1,1]
    s_waitcnt vmcnt(13)
    v_lshlrev_b32 v120, 16, v56
    v_and_b32 v121, 0xffff0000, v56
    v_lshlrev_b32 v122, 16, v57
    v_and_b32 v123, 0xffff0000, v57
    v_lshlrev_b32 v124, 16, v58
    v_and_b32 v125, 0xffff0000, v58
    v_lshlrev_b32 v126, 16, v59
    v_and_b32 v127, 0xffff0000, v59
    v_pk_fma_f32 v[112:113], v[120:121], v[14:15], v[112:113] op_sel:[0,0,0] op_sel_hi:[1,0,1]
    v_pk_fma_f32 v[114:115], v[122:123], v[14:15], v[114:115] op_sel:[0,0,0] op_sel_hi:[1,0,1]
    v_pk_fma_f32 v[116:117], v[124:125], v[14:15], v[116:117] op_sel:[0,0,0] op_sel_hi:[1,0,1]
    v_pk_fma_f32 v[118:119], v[126:127], v[14:15], v[118:119] op_sel:[0,0,0] op_sel_hi:[1,0,1]
    s_waitcnt vmcnt(12)
    v_lshlrev_b32 v120, 16, v60
    v_and_b32 v121, 0xffff0000, v60
    v_lshlrev_b32 v122, 16, v61
    v_and_b32 v123, 0xffff0000, v61
    v_lshlrev_b32 v124, 16, v62
    v_and_b32 v125, 0xffff0000, v62
    v_lshlrev_b32 v126, 16, v63
    v_and_b32 v127, 0xffff0000, v63
    v_pk_fma_f32 v[112:113], v[120:121], v[14:15], v[112:113] op_sel:[0,1,0] op_sel_hi:[1,1,1]
    v_pk_fma_f32 v[114:115], v[122:123], v[14:15], v[114:115] op_sel:[0,1,0] op_sel_hi:[1,1,1]
    v_pk_fma_f32 v[116:117], v[124:125], v[14:15], v[116:117] op_sel:[0,1,0] op_sel_hi:[1,1,1]
    v_pk_fma_f32 v[118:119], v[126:127], v[14:15], v[118:119] op_sel:[0,1,0] op_sel_hi:[1,1,1]
    s_waitcnt vmcnt(11)
    v_lshlrev_b32 v120, 16, v64
    v_and_b32 v121, 0xffff0000, v64
    v_lshlrev_b32 v122, 16, v65
    v_and_b32 v123, 0xffff0000, v65
    v_lshlrev_b32 v124, 16, v66
    v_and_b32 v125, 0xffff0000, v66
    v_lshlrev_b32 v126, 16, v67
    v_and_b32 v127, 0xffff0000, v67
    v_pk_fma_f32 v[112:113], v[120:121], v[16:17], v[112:113] op_sel:[0,0,0] op_sel_hi:[1,0,1]
    v_pk_fma_f32 v[114:115], v[122:123], v[16:17], v[114:115] op_sel:[0,0,0] op_sel_hi:[1,0,1]
    v_pk_fma_f32 v[116:117], v[124:125], v[16:17], v[116:117] op_sel:[0,0,0] op_sel_hi:[1,0,1]
    v_pk_fma_f32 v[118:119], v[126:127], v[16:17], v[118:119] op_sel:[0,0,0] op_sel_hi:[1,0,1]
    s_waitcnt vmcnt(10)
    v_lshlrev_b32 v120, 16, v68
    v_and_b32 v121, 0xffff0000, v68
    v_lshlrev_b32 v122, 16, v69
    v_and_b32 v123, 0xffff0000, v69
    v_lshlrev_b32 v124, 16, v70
    v_and_b32 v125, 0xffff0000, v70
    v_lshlrev_b32 v126, 16, v71
    v_and_b32 v127, 0xffff0000, v71
    v_pk_fma_f32 v[112:113], v[120:121], v[16:17], v[112:113] op_sel:[0,1,0] op_sel_hi:[1,1,1]
    v_pk_fma_f32 v[114:115], v[122:123], v[16:17], v[114:115] op_sel:[0,1,0] op_sel_hi:[1,1,1]
    v_pk_fma_f32 v[116:117], v[124:125], v[16:17], v[116:117] op_sel:[0,1,0] op_sel_hi:[1,1,1]
    v_pk_fma_f32 v[118:119], v[126:127], v[16:17], v[118:119] op_sel:[0,1,0] op_sel_hi:[1,1,1]
    s_waitcnt vmcnt(9)
    v_lshlrev_b32 v120, 16, v72
    v_and_b32 v121, 0xffff0000, v72
    v_lshlrev_b32 v122, 16, v73
    v_and_b32 v123, 0xffff0000, v73
    v_lshlrev_b32 v124, 16, v74
    v_and_b32 v125, 0xffff0000, v74
    v_lshlrev_b32 v126, 16, v75
    v_and_b32 v127, 0xffff0000, v75
    v_pk_fma_f32 v[112:113], v[120:121], v[18:19], v[112:113] op_sel:[0,0,0] op_sel_hi:[1,0,1]
    v_pk_fma_f32 v[114:115], v[122:123], v[18:19], v[114:115] op_sel:[0,0,0] op_sel_hi:[1,0,1]
    v_pk_fma_f32 v[116:117], v[124:125], v[18:19], v[116:117] op_sel:[0,0,0] op_sel_hi:[1,0,1]
    v_pk_fma_f32 v[118:119], v[126:127], v[18:19], v[118:119] op_sel:[0,0,0] op_sel_hi:[1,0,1]
    s_waitcnt vmcnt(8)
    v_lshlrev_b32 v120, 16, v76
    v_and_b32 v121, 0xffff0000, v76
    v_lshlrev_b32 v122, 16, v77
    v_and_b32 v123, 0xffff0000, v77
    v_lshlrev_b32 v124, 16, v78
    v_and_b32 v125, 0xffff0000, v78
    v_lshlrev_b32 v126, 16, v79
    v_and_b32 v127, 0xffff0000, v79
    v_pk_fma_f32 v[112:113], v[120:121], v[18:19], v[112:113] op_sel:[0,1,0] op_sel_hi:[1,1,1]
    v_pk_fma_f32 v[114:115], v[122:123], v[18:19], v[114:115] op_sel:[0,1,0] op_sel_hi:[1,1,1]
    v_pk_fma_f32 v[116:117], v[124:125], v[18:19], v[116:117] op_sel:[0,1,0] op_sel_hi:[1,1,1]
    v_pk_fma_f32 v[118:119], v[126:127], v[18:19], v[118:119] op_sel:[0,1,0] op_sel_hi:[1,1,1]
    s_waitcnt vmcnt(7)
    v_lshlrev_b32 v120, 16, v80
    v_and_b32 v121, 0xffff0000, v80
    v_lshlrev_b32 v122, 16, v81
    v_and_b32 v123, 0xffff0000, v81
    v_lshlrev_b32 v124, 16, v82
    v_and_b32 v125, 0xffff0000, v82
    v_lshlrev_b32 v126, 16, v83
    v_and_b32 v127, 0xffff0000, v83
    v_pk_fma_f32 v[112:113], v[120:121], v[20:21], v[112:113] op_sel:[0,0,0] op_sel_hi:[1,0,1]
    v_pk_fma_f32 v[114:115], v[122:123], v[20:21], v[114:115] op_sel:[0,0,0] op_sel_hi:[1,0,1]
    v_pk_fma_f32 v[116:117], v[124:125], v[20:21], v[116:117] op_sel:[0,0,0] op_sel_hi:[1,0,1]
    v_pk_fma_f32 v[118:119], v[126:127], v[20:21], v[118:119] op_sel:[0,0,0] op_sel_hi:[1,0,1]
    s_waitcnt vmcnt(6)
    v_lshlrev_b32 v120, 16, v84
    v_and_b32 v121, 0xffff0000, v84
    v_lshlrev_b32 v122, 16, v85
    v_and_b32 v123, 0xffff0000, v85
    v_lshlrev_b32 v124, 16, v86
    v_and_b32 v125, 0xffff0000, v86
    v_lshlrev_b32 v126, 16, v87
    v_and_b32 v127, 0xffff0000, v87
    v_pk_fma_f32 v[112:113], v[120:121], v[20:21], v[112:113] op_sel:[0,1,0] op_sel_hi:[1,1,1]
    v_pk_fma_f32 v[114:115], v[122:123], v[20:21], v[114:115] op_sel:[0,1,0] op_sel_hi:[1,1,1]
    v_pk_fma_f32 v[116:117], v[124:125], v[20:21], v[116:117] op_sel:[0,1,0] op_sel_hi:[1,1,1]
    v_pk_fma_f32 v[118:119], v[126:127], v[20:21], v[118:119] op_sel:[0,1,0] op_sel_hi:[1,1,1]
    s_waitcnt vmcnt(5)
    v_lshlrev_b32 v120, 16, v88
    v_and_b32 v121, 0xffff0000, v88
    v_lshlrev_b32 v122, 16, v89
    v_and_b32 v123, 0xffff0000, v89
    v_lshlrev_b32 v124, 16, v90
    v_and_b32 v125, 0xffff0000, v90
    v_lshlrev_b32 v126, 16, v91
    v_and_b32 v127, 0xffff0000, v91
    v_pk_fma_f32 v[112:113], v[120:121], v[22:23], v[112:113] op_sel:[0,0,0] op_sel_hi:[1,0,1]
    v_pk_fma_f32 v[114:115], v[122:123], v[22:23], v[114:115] op_sel:[0,0,0] op_sel_hi:[1,0,1]
    v_pk_fma_f32 v[116:117], v[124:125], v[22:23], v[116:117] op_sel:[0,0,0] op_sel_hi:[1,0,1]
    v_pk_fma_f32 v[118:119], v[126:127], v[22:23], v[118:119] op_sel:[0,0,0] op_sel_hi:[1,0,1]
    s_waitcnt vmcnt(4)
    v_lshlrev_b32 v120, 16, v92
    v_and_b32 v121, 0xffff0000, v92
    v_lshlrev_b32 v122, 16, v93
    v_and_b32 v123, 0xffff0000, v93
    v_lshlrev_b32 v124, 16, v94
    v_and_b32 v125, 0xffff0000, v94
    v_lshlrev_b32 v126, 16, v95
    v_and_b32 v127, 0xffff0000, v95
    v_pk_fma_f32 v[112:113], v[120:121], v[22:23], v[112:113] op_sel:[0,1,0] op_sel_hi:[1,1,1]
    v_pk_fma_f32 v[114:115], v[122:123], v[22:23], v[114:115] op_sel:[0,1,0] op_sel_hi:[1,1,1]
    v_pk_fma_f32 v[116:117], v[124:125], v[22:23], v[116:117] op_sel:[0,1,0] op_sel_hi:[1,1,1]
    v_pk_fma_f32 v[118:119], v[126:127], v[22:23], v[118:119] op_sel:[0,1,0] op_sel_hi:[1,1,1]
    s_waitcnt vmcnt(3)
    v_lshlrev_b32 v120, 16, v96
    v_and_b32 v121, 0xffff0000, v96
    v_lshlrev_b32 v122, 16, v97
    v_and_b32 v123, 0xffff0000, v97
    v_lshlrev_b32 v124, 16, v98
    v_and_b32 v125, 0xffff0000, v98
    v_lshlrev_b32 v126, 16, v99
    v_and_b32 v127, 0xffff0000, v99
    v_pk_fma_f32 v[112:113], v[120:121], v[24:25], v[112:113] op_sel:[0,0,0] op_sel_hi:[1,0,1]
    v_pk_fma_f32 v[114:115], v[122:123], v[24:25], v[114:115] op_sel:[0,0,0] op_sel_hi:[1,0,1]
    v_pk_fma_f32 v[116:117], v[124:125], v[24:25], v[116:117] op_sel:[0,0,0] op_sel_hi:[1,0,1]
    v_pk_fma_f32 v[118:119], v[126:127], v[24:25], v[118:119] op_sel:[0,0,0] op_sel_hi:[1,0,1]
    s_waitcnt vmcnt(2)
    v_lshlrev_b32 v120, 16, v100
    v_and_b32 v121, 0xffff0000, v100
    v_lshlrev_b32 v122, 16, v101
    v_and_b32 v123, 0xffff0000, v101
    v_lshlrev_b32 v124, 16, v102
    v_and_b32 v125, 0xffff0000, v102
    v_lshlrev_b32 v126, 16, v103
    v_and_b32 v127, 0xffff0000, v103
    v_pk_fma_f32 v[112:113], v[120:121], v[24:25], v[112:113] op_sel:[0,1,0] op_sel_hi:[1,1,1]
    v_pk_fma_f32 v[114:115], v[122:123], v[24:25], v[114:115] op_sel:[0,1,0] op_sel_hi:[1,1,1]
    v_pk_fma_f32 v[116:117], v[124:125], v[24:25], v[116:117] op_sel:[0,1,0] op_sel_hi:[1,1,1]
    v_pk_fma_f32 v[118:119], v[126:127], v[24:25], v[118:119] op_sel:[0,1,0] op_sel_hi:[1,1,1]
    s_waitcnt vmcnt(1)
    v_lshlrev_b32 v120, 16, v104
    v_and_b32 v121, 0xffff0000, v104
    v_lshlrev_b32 v122, 16, v105
    v_and_b32 v123, 0xffff0000, v105
    v_lshlrev_b32 v124, 16, v106
    v_and_b32 v125, 0xffff0000, v106
    v_lshlrev_b32 v126, 16, v107
    v_and_b32 v127, 0xffff0000, v107
    v_pk_fma_f32 v[112:113], v[120:121], v[26:27], v[112:113] op_sel:[0,0,0] op_sel_hi:[1,0,1]
    v_pk_fma_f32 v[114:115], v[122:123], v[26:27], v[114:115] op_sel:[0,0,0] op_sel_hi:[1,0,1]
    v_pk_fma_f32 v[116:117], v[124:125], v[26:27], v[116:117] op_sel:[0,0,0] op_sel_hi:[1,0,1]
    v_pk_fma_f32 v[118:119], v[126:127], v[26:27], v[118:119] op_sel:[0,0,0] op_sel_hi:[1,0,1]
    s_waitcnt vmcnt(0)
    v_lshlrev_b32 v120, 16, v108
    v_and_b32 v121, 0xffff0000, v108
    v_lshlrev_b32 v122, 16, v109
    v_and_b32 v123, 0xffff0000, v109
    v_lshlrev_b32 v124, 16, v110
    v_and_b32 v125, 0xffff0000, v110
    v_lshlrev_b32 v126, 16, v111
    v_and_b32 v127, 0xffff0000, v111
    v_pk_fma_f32 v[112:113], v[120:121], v[26:27], v[112:113] op_sel:[0,1,0] op_sel_hi:[1,1,1]
    v_pk_fma_f32 v[114:115], v[122:123], v[26:27], v[114:115] op_sel:[0,1,0] op_sel_hi:[1,1,1]
    v_pk_fma_f32 v[116:117], v[124:125], v[26:27], v[116:117] op_sel:[0,1,0] op_sel_hi:[1,1,1]
    v_pk_fma_f32 v[118:119], v[126:127], v[26:27], v[118:119] op_sel:[0,1,0] op_sel_hi:[1,1,1]
    s_nop 1
    v_add_f32_dpp v112, v112, v112 row_ror:8 row_mask:0xf bank_mask:0xf
    v_add_f32_dpp v113, v113, v113 row_ror:8 row_mask:0xf bank_mask:0xf
    v_add_f32_dpp v114, v114, v114 row_ror:8 row_mask:0xf bank_mask:0xf
    v_add_f32_dpp v115, v115, v115 row_ror:8 row_mask:0xf bank_mask:0xf
    v_add_f32_dpp v116, v116, v116 row_ror:8 row_mask:0xf bank_mask:0xf
    v_add_f32_dpp v117, v117, v117 row_ror:8 row_mask:0xf bank_mask:0xf
    v_add_f32_dpp v118, v118, v118 row_ror:8 row_mask:0xf bank_mask:0xf
    v_add_f32_dpp v119, v119, v119 row_ror:8 row_mask:0xf bank_mask:0xf
    v_mov_b32 v120, v112
    v_mov_b32 v121, v113
    v_mov_b32 v122, v114
    v_mov_b32 v123, v115
    v_mov_b32 v124, v116
    v_mov_b32 v125, v117
    v_mov_b32 v126, v118
    v_mov_b32 v127, v119
    s_nop 1
    v_permlane32_swap_b32 v120, v112
    v_permlane32_swap_b32 v121, v113
    v_permlane32_swap_b32 v122, v114
    v_permlane32_swap_b32 v123, v115
    v_permlane32_swap_b32 v124, v116
    v_permlane32_swap_b32 v125, v117
    v_permlane32_swap_b32 v126, v118
    v_permlane32_swap_b32 v127, v119
    s_nop 1
    v_add_f32 v112, v112, v120
    v_add_f32 v113, v113, v121
    v_add_f32 v114, v114, v122
    v_add_f32 v115, v115, v123
    v_add_f32 v116, v116, v124
    v_add_f32 v117, v117, v125
    v_add_f32 v118, v118, v126
    v_add_f32 v119, v119, v127
    v_mov_b32 v120, v112
    v_mov_b32 v121, v113
    v_mov_b32 v122, v114
    v_mov_b32 v123, v115
    v_mov_b32 v124, v116
    v_mov_b32 v125, v117
    v_mov_b32 v126, v118
    v_mov_b32 v127, v119
    s_nop 1
    v_permlane16_swap_b32 v120, v112
    v_permlane16_swap_b32 v121, v113
    v_permlane16_swap_b32 v122, v114
    v_permlane16_swap_b32 v123, v115
    v_permlane16_swap_b32 v124, v116
    v_permlane16_swap_b32 v125, v117
    v_permlane16_swap_b32 v126, v118
    v_permlane16_swap_b32 v127, v119
    s_nop 1
    v_add_f32 v112, v112, v120
    v_add_f32 v113, v113, v121
    v_add_f32 v114, v114, v122
    v_add_f32 v115, v115, v123
    v_add_f32 v116, v116, v124
    v_add_f32 v117, v117, v125
    v_add_f32 v118, v118, v126
    v_add_f32 v119, v119, v127
    v_lshlrev_b32 v7, 5, v3
    s_mul_i32 s36, s33, 15360
    s_lshl_b32 s37, s32, 8
    s_add_u32 s37, s37, s36
    s_add_u32 s37, s37, 2793472
    s_lshl_b32 s44, s21, 7
    s_add_u32 s44, s44, 29593600
    s_mov_b64 exec, 0xff
    buffer_store_dwordx4 v[112:115], v7, s[28:31], s37 offen sc1
    buffer_store_dwordx4 v[116:119], v7, s[28:31], s37 offen offset:16 sc1
    s_mov_b64 exec, -1
    s_waitcnt vmcnt(0)
    v_mov_b32 v132, s46
    v_mov_b32 v133, 0
    s_mov_b64 exec, 1
    buffer_store_dword v132, v133, s[28:31], s44 offen sc1
    s_mov_b64 exec, -1
    s_endpgm
k1_fin:
    s_add_u32 s21, s21, 30
    s_lshl_b32 s40, s21, 9
    s_add_u32 s40, s40, 29593600
    v_lshlrev_b32 v16, 7, v1
    s_mov_b32 s47, 0
    s_mov_b64 exec, 15
k1_kernel_pl1:
    buffer_load_dword v17, v16, s[28:31], s40 offen sc1
    s_add_u32 s47, s47, 1
    s_waitcnt vmcnt(0)
    v_cmp_ne_u32 vcc, s46, v17
    s_cmp_ge_u32 s47, 20000
    s_cbranch_scc1 k1_kernel_pd2
    s_cbranch_vccnz k1_kernel_pl1
k1_kernel_pd2:
    s_mov_b64 exec, -1
    v_lshlrev_b32 v7, 2, v1
    s_lshl_b32 s22, s21, 8
    s_add_u32 s23, s22, 2793472
    buffer_load_dword v10, v7, s[28:31], s23 offen sc1
    s_add_u32 s23, s23, 15360
    buffer_load_dword v11, v7, s[28:31], s23 offen sc1
    s_add_u32 s23, s23, 15360
    buffer_load_dword v12, v7, s[28:31], s23 offen sc1
    s_add_u32 s23, s23, 15360
    buffer_load_dword v13, v7, s[28:31], s23 offen sc1
    s_waitcnt vmcnt(0)
    v_add_f32 v10, v10, v11
    v_add_f32 v12, v12, v13
    s_nop 0
    v_add_f32 v10, v10, v12
    s_nop 0
    v_cvt_pk_bf16_f32 v10, v10, v10
    s_nop 0
    v_lshlrev_b32 v10, 16, v10
    s_sub_u32 s24, s21, 10
    s_cmp_lt_u32 s24, 10
    s_cbranch_scc1 k1_kernel_f13
    s_sub_u32 s24, s21, 40
    s_cmp_lt_u32 s24, 10
    s_cbranch_scc0 k1_kernel_f24
k1_kernel_f13:
    v_add_f32 v10, 1.0, v10
    s_nop 0
    v_cvt_pk_bf16_f32 v10, v10, v10
    s_nop 0
    v_lshlrev_b32 v10, 16, v10
k1_kernel_f24:
    s_add_u32 s22, s22, 8114176
    buffer_store_dword v10, v7, s[28:31], s22 offen sc1
    s_endpgm
k1_pack:
    v_lshrrev_b32 v3, 3, v1
    v_and_b32 v4, 7, v1
    v_mul_u32_u24 v5, 144, v3
    v_lshl_add_u32 v5, v4, 4, v5
    v_add_u32 v5, s34, v5
    v_and_b32 v6, 15, v1
    v_lshrrev_b32 v7, 4, v1
    v_lshrrev_b32 v8, 2, v6
    v_lshl_add_u32 v8, v7, 3, v8
    v_mul_u32_u24 v8, 144, v8
    v_and_b32 v9, 3, v6
    v_lshl_add_u32 v8, v9, 3, v8
    v_add_u32 v8, s34, v8
    v_lshlrev_b32 v9, 4, v1
    s_cmp_lt_u32 s21, 20
    s_cbranch_scc1 k1_kernel_pk5
    s_cmp_lt_u32 s21, 40
    s_cbranch_scc1 k1_kernel_pk6
    s_cmp_lt_u32 s21, 94
    s_cbranch_scc1 k1_kernel_pk7
    s_branch k1_kernel_pk8
k1_kernel_pk5:
    s_mov_b32 s24, s12
    s_mov_b32 s25, s13
    s_mov_b32 s26, 819200
    s_mov_b32 s27, 0x00020000
    s_sub_u32 s32, s21, 0
    s_mul_i32 s33, s32, 52429
    s_lshr_b32 s33, s33, 19
    s_mul_i32 s35, s33, 10
    s_sub_u32 s35, s32, s35
    v_mul_u32_u24 v10, 1280, v3
    v_lshl_add_u32 v10, v4, 4, v10
    s_mul_i32 s36, s33, 409600
    s_lshl_b32 s37, s35, 7
    s_add_u32 s36, s36, s37
    buffer_load_dwordx4 v[32:35], v10, s[24:27], s36 offen nt
    s_add_u32 s36, s36, 10240
    buffer_load_dwordx4 v[36:39], v10, s[24:27], s36 offen nt
    s_add_u32 s36, s36, 10240
    buffer_load_dwordx4 v[40:43], v10, s[24:27], s36 offen nt
    s_add_u32 s36, s36, 10240
    buffer_load_dwordx4 v[44:47], v10, s[24:27], s36 offen nt
    s_add_u32 s36, s36, 10240
    buffer_load_dwordx4 v[48:51], v10, s[24:27], s36 offen nt
    s_add_u32 s36, s36, 10240
    buffer_load_dwordx4 v[52:55], v10, s[24:27], s36 offen nt
    s_add_u32 s36, s36, 10240
    buffer_load_dwordx4 v[56:59], v10, s[24:27], s36 offen nt
    s_add_u32 s36, s36, 10240
    buffer_load_dwordx4 v[60:63], v10, s[24:27], s36 offen nt
    s_add_u32 s36, s36, 10240
    buffer_load_dwordx4 v[64:67], v10, s[24:27], s36 offen nt
    s_add_u32 s36, s36, 10240
    buffer_load_dwordx4 v[68:71], v10, s[24:27], s36 offen nt
    s_add_u32 s36, s36, 10240
    buffer_load_dwordx4 v[72:75], v10, s[24:27], s36 offen nt
    s_add_u32 s36, s36, 10240
    buffer_load_dwordx4 v[76:79], v10, s[24:27], s36 offen nt
    s_add_u32 s36, s36, 10240
    buffer_load_dwordx4 v[80:83], v10, s[24:27], s36 offen nt
    s_add_u32 s36, s36, 10240
    buffer_load_dwordx4 v[84:87], v10, s[24:27], s36 offen nt
    s_add_u32 s36, s36, 10240
    buffer_load_dwordx4 v[88:91], v10, s[24:27], s36 offen nt
    s_add_u32 s36, s36, 10240
    buffer_load_dwordx4 v[92:95], v10, s[24:27], s36 offen nt
    s_add_u32 s36, s36, 10240
    buffer_load_dwordx4 v[96:99], v10, s[24:27], s36 offen nt
    s_add_u32 s36, s36, 10240
    buffer_load_dwordx4 v[100:103], v10, s[24:27], s36 offen nt
    s_add_u32 s36, s36, 10240
    buffer_load_dwordx4 v[104:107], v10, s[24:27], s36 offen nt
    s_add_u32 s36, s36, 10240
    buffer_load_dwordx4 v[108:111], v10, s[24:27], s36 offen nt
    s_add_u32 s36, s36, 10240
    buffer_load_dwordx4 v[112:115], v10, s[24:27], s36 offen nt
    s_add_u32 s36, s36, 10240
    buffer_load_dwordx4 v[116:119], v10, s[24:27], s36 offen nt
    s_add_u32 s36, s36, 10240
    buffer_load_dwordx4 v[120:123], v10, s[24:27], s36 offen nt
    s_add_u32 s36, s36, 10240
    buffer_load_dwordx4 v[124:127], v10, s[24:27], s36 offen nt
    s_add_u32 s36, s36, 10240
    buffer_load_dwordx4 v[128:131], v10, s[24:27], s36 offen nt
    s_add_u32 s36, s36, 10240
    buffer_load_dwordx4 v[132:135], v10, s[24:27], s36 offen nt
    s_add_u32 s36, s36, 10240
    buffer_load_dwordx4 v[136:139], v10, s[24:27], s36 offen nt
    s_add_u32 s36, s36, 10240
    buffer_load_dwordx4 v[140:143], v10, s[24:27], s36 offen nt
    s_add_u32 s36, s36, 10240
    buffer_load_dwordx4 v[144:147], v10, s[24:27], s36 offen nt
    s_add_u32 s36, s36, 10240
    buffer_load_dwordx4 v[148:151], v10, s[24:27], s36 offen nt
    s_add_u32 s36, s36, 10240
    buffer_load_dwordx4 v[152:155], v10, s[24:27], s36 offen nt
    s_add_u32 s36, s36, 10240
    buffer_load_dwordx4 v[156:159], v10, s[24:27], s36 offen nt
    s_add_u32 s36, s36, 10240
    buffer_load_dwordx4 v[160:163], v10, s[24:27], s36 offen nt
    s_add_u32 s36, s36, 10240
    buffer_load_dwordx4 v[164:167], v10, s[24:27], s36 offen nt
    s_add_u32 s36, s36, 10240
    buffer_load_dwordx4 v[168:171], v10, s[24:27], s36 offen nt
    s_add_u32 s36, s36, 10240
    buffer_load_dwordx4 v[172:175], v10, s[24:27], s36 offen nt
    s_add_u32 s36, s36, 10240
    buffer_load_dwordx4 v[176:179], v10, s[24:27], s36 offen nt
    s_add_u32 s36, s36, 10240
    buffer_load_dwordx4 v[180:183], v10, s[24:27], s36 offen nt
    s_add_u32 s36, s36, 10240
    buffer_load_dwordx4 v[184:187], v10, s[24:27], s36 offen nt
    s_add_u32 s36, s36, 10240
    buffer_load_dwordx4 v[188:191], v10, s[24:27], s36 offen nt
    s_lshl_b32 s36, s35, 2
    s_add_u32 s36, s36, 0
    s_mul_i32 s38, s36, 6554
    s_lshr_b32 s38, s38, 16
    s_mul_i32 s39, s38, 10
    s_sub_u32 s39, s36, s39
    s_cmp_ge_u32 s39, 5
    s_cselect_b32 s40, 1, 0
    s_sub_u32 s41, s39, 6
    s_cmp_eq_u32 s39, 5
    s_cselect_b32 s41, 4, s41
    s_cmp_eq_u32 s40, 1
    s_cselect_b32 s39, s41, s39
    s_mul_i32 s37, s38, 200
    s_mul_i32 s40, s40, 100
    s_add_u32 s37, s37, s40
    s_mul_i32 s40, s33, 50
    s_add_u32 s37, s37, s40
    s_add_u32 s37, s37, s39
    s_lshl_b32 s37, s37, 10
    s_add_u32 s44, s37, 23236608
    s_movk_i32 s48, 5120
    s_lshl_b32 s36, s35, 2
    s_add_u32 s36, s36, 1
    s_mul_i32 s38, s36, 6554
    s_lshr_b32 s38, s38, 16
    s_mul_i32 s39, s38, 10
    s_sub_u32 s39, s36, s39
    s_cmp_ge_u32 s39, 5
    s_cselect_b32 s40, 1, 0
    s_sub_u32 s41, s39, 6
    s_cmp_eq_u32 s39, 5
    s_cselect_b32 s41, 4, s41
    s_cmp_eq_u32 s40, 1
    s_cselect_b32 s39, s41, s39
    s_mul_i32 s37, s38, 200
    s_mul_i32 s40, s40, 100
    s_add_u32 s37, s37, s40
    s_mul_i32 s40, s33, 50
    s_add_u32 s37, s37, s40
    s_add_u32 s37, s37, s39
    s_lshl_b32 s37, s37, 10
    s_add_u32 s45, s37, 23236608
    s_movk_i32 s49, 5120
    s_lshl_b32 s36, s35, 2
    s_add_u32 s36, s36, 2
    s_mul_i32 s38, s36, 6554
    s_lshr_b32 s38, s38, 16
    s_mul_i32 s39, s38, 10
    s_sub_u32 s39, s36, s39
    s_cmp_ge_u32 s39, 5
    s_cselect_b32 s40, 1, 0
    s_sub_u32 s41, s39, 6
    s_cmp_eq_u32 s39, 5
    s_cselect_b32 s41, 4, s41
    s_cmp_eq_u32 s40, 1
    s_cselect_b32 s39, s41, s39
    s_mul_i32 s37, s38, 200
    s_mul_i32 s40, s40, 100
    s_add_u32 s37, s37, s40
    s_mul_i32 s40, s33, 50
    s_add_u32 s37, s37, s40
    s_add_u32 s37, s37, s39
    s_lshl_b32 s37, s37, 10
    s_add_u32 s46, s37, 23236608
    s_movk_i32 s50, 5120
    s_lshl_b32 s36, s35, 2
    s_add_u32 s36, s36, 3
    s_mul_i32 s38, s36, 6554
    s_lshr_b32 s38, s38, 16
    s_mul_i32 s39, s38, 10
    s_sub_u32 s39, s36, s39
    s_cmp_ge_u32 s39, 5
    s_cselect_b32 s40, 1, 0
    s_sub_u32 s41, s39, 6
    s_cmp_eq_u32 s39, 5
    s_cselect_b32 s41, 4, s41
    s_cmp_eq_u32 s40, 1
    s_cselect_b32 s39, s41, s39
    s_mul_i32 s37, s38, 200
    s_mul_i32 s40, s40, 100
    s_add_u32 s37, s37, s40
    s_mul_i32 s40, s33, 50
    s_add_u32 s37, s37, s40
    s_add_u32 s37, s37, s39
    s_lshl_b32 s37, s37, 10
    s_add_u32 s47, s37, 23236608
    s_movk_i32 s51, 5120
    v_mov_b32 v12, 0
    v_mov_b32 v13, 0
    v_mov_b32 v14, 0
    v_mov_b32 v15, 0
    v_mov_b32 v16, 0x3f803f80
    s_waitcnt vmcnt(36)
    ds_write_b128 v5, v[32:35] offset:0
    ds_write_b128 v5, v[36:39] offset:1152
    ds_write_b128 v5, v[40:43] offset:2304
    ds_write_b128 v5, v[44:47] offset:3456
    s_waitcnt lgkmcnt(0)
    ds_read_b64_tr_b16 v[200:201], v8 offset:0
    ds_read_b64_tr_b16 v[202:203], v8 offset:576
    ds_read_b64_tr_b16 v[204:205], v8 offset:32
    ds_read_b64_tr_b16 v[206:207], v8 offset:608
    ds_read_b64_tr_b16 v[208:209], v8 offset:64
    ds_read_b64_tr_b16 v[210:211], v8 offset:640
    ds_read_b64_tr_b16 v[212:213], v8 offset:96
    ds_read_b64_tr_b16 v[214:215], v8 offset:672
    s_waitcnt vmcnt(32)
    ds_write_b128 v5, v[48:51] offset:4608
    ds_write_b128 v5, v[52:55] offset:5760
    ds_write_b128 v5, v[56:59] offset:6912
    ds_write_b128 v5, v[60:63] offset:8064
    s_waitcnt lgkmcnt(4)
    buffer_store_dwordx4 v[200:203], v9, s[28:31], s44 offen sc1
    s_add_u32 s44, s44, s48
    v_dot2_f32_bf16 v12, v200, v16, v12
    v_dot2_f32_bf16 v12, v201, v16, v12
    v_dot2_f32_bf16 v12, v202, v16, v12
    v_dot2_f32_bf16 v12, v203, v16, v12
    buffer_store_dwordx4 v[204:207], v9, s[28:31], s45 offen sc1
    s_add_u32 s45, s45, s49
    v_dot2_f32_bf16 v13, v204, v16, v13
    v_dot2_f32_bf16 v13, v205, v16, v13
    v_dot2_f32_bf16 v13, v206, v16, v13
    v_dot2_f32_bf16 v13, v207, v16, v13
    buffer_store_dwordx4 v[208:211], v9, s[28:31], s46 offen sc1
    s_add_u32 s46, s46, s50
    v_dot2_f32_bf16 v14, v208, v16, v14
    v_dot2_f32_bf16 v14, v209, v16, v14
    v_dot2_f32_bf16 v14, v210, v16, v14
    v_dot2_f32_bf16 v14, v211, v16, v14
    buffer_store_dwordx4 v[212:215], v9, s[28:31], s47 offen sc1
    s_add_u32 s47, s47, s51
    v_dot2_f32_bf16 v15, v212, v16, v15
    v_dot2_f32_bf16 v15, v213, v16, v15
    v_dot2_f32_bf16 v15, v214, v16, v15
    v_dot2_f32_bf16 v15, v215, v16, v15
    s_waitcnt lgkmcnt(0)
    ds_read_b64_tr_b16 v[216:217], v8 offset:4608
    ds_read_b64_tr_b16 v[218:219], v8 offset:5184
    ds_read_b64_tr_b16 v[220:221], v8 offset:4640
    ds_read_b64_tr_b16 v[222:223], v8 offset:5216
    ds_read_b64_tr_b16 v[224:225], v8 offset:4672
    ds_read_b64_tr_b16 v[226:227], v8 offset:5248
    ds_read_b64_tr_b16 v[228:229], v8 offset:4704
    ds_read_b64_tr_b16 v[230:231], v8 offset:5280
    s_waitcnt vmcnt(32)
    ds_write_b128 v5, v[64:67] offset:0
    ds_write_b128 v5, v[68:71] offset:1152
    ds_write_b128 v5, v[72:75] offset:2304
    ds_write_b128 v5, v[76:79] offset:3456
    s_waitcnt lgkmcnt(4)
    buffer_store_dwordx4 v[216:219], v9, s[28:31], s44 offen sc1
    s_add_u32 s44, s44, s48
    v_dot2_f32_bf16 v12, v216, v16, v12
    v_dot2_f32_bf16 v12, v217, v16, v12
    v_dot2_f32_bf16 v12, v218, v16, v12
    v_dot2_f32_bf16 v12, v219, v16, v12
    buffer_store_dwordx4 v[220:223], v9, s[28:31], s45 offen sc1
    s_add_u32 s45, s45, s49
    v_dot2_f32_bf16 v13, v220, v16, v13
    v_dot2_f32_bf16 v13, v221, v16, v13
    v_dot2_f32_bf16 v13, v222, v16, v13
    v_dot2_f32_bf16 v13, v223, v16, v13
    buffer_store_dwordx4 v[224:227], v9, s[28:31], s46 offen sc1
    s_add_u32 s46, s46, s50
    v_dot2_f32_bf16 v14, v224, v16, v14
    v_dot2_f32_bf16 v14, v225, v16, v14
    v_dot2_f32_bf16 v14, v226, v16, v14
    v_dot2_f32_bf16 v14, v227, v16, v14
    buffer_store_dwordx4 v[228:231], v9, s[28:31], s47 offen sc1
    s_add_u32 s47, s47, s51
    v_dot2_f32_bf16 v15, v228, v16, v15
    v_dot2_f32_bf16 v15, v229, v16, v15
    v_dot2_f32_bf16 v15, v230, v16, v15
    v_dot2_f32_bf16 v15, v231, v16, v15
    s_waitcnt lgkmcnt(0)
    ds_read_b64_tr_b16 v[200:201], v8 offset:0
    ds_read_b64_tr_b16 v[202:203], v8 offset:576
    ds_read_b64_tr_b16 v[204:205], v8 offset:32
    ds_read_b64_tr_b16 v[206:207], v8 offset:608
    ds_read_b64_tr_b16 v[208:209], v8 offset:64
    ds_read_b64_tr_b16 v[210:211], v8 offset:640
    ds_read_b64_tr_b16 v[212:213], v8 offset:96
    ds_read_b64_tr_b16 v[214:215], v8 offset:672
    s_waitcnt vmcnt(32)
    ds_write_b128 v5, v[80:83] offset:4608
    ds_write_b128 v5, v[84:87] offset:5760
    ds_write_b128 v5, v[88:91] offset:6912
    ds_write_b128 v5, v[92:95] offset:8064
    s_waitcnt lgkmcnt(4)
    buffer_store_dwordx4 v[200:203], v9, s[28:31], s44 offen sc1
    s_add_u32 s44, s44, s48
    v_dot2_f32_bf16 v12, v200, v16, v12
    v_dot2_f32_bf16 v12, v201, v16, v12
    v_dot2_f32_bf16 v12, v202, v16, v12
    v_dot2_f32_bf16 v12, v203, v16, v12
    buffer_store_dwordx4 v[204:207], v9, s[28:31], s45 offen sc1
    s_add_u32 s45, s45, s49
    v_dot2_f32_bf16 v13, v204, v16, v13
    v_dot2_f32_bf16 v13, v205, v16, v13
    v_dot2_f32_bf16 v13, v206, v16, v13
    v_dot2_f32_bf16 v13, v207, v16, v13
    buffer_store_dwordx4 v[208:211], v9, s[28:31], s46 offen sc1
    s_add_u32 s46, s46, s50
    v_dot2_f32_bf16 v14, v208, v16, v14
    v_dot2_f32_bf16 v14, v209, v16, v14
    v_dot2_f32_bf16 v14, v210, v16, v14
    v_dot2_f32_bf16 v14, v211, v16, v14
    buffer_store_dwordx4 v[212:215], v9, s[28:31], s47 offen sc1
    s_add_u32 s47, s47, s51
    v_dot2_f32_bf16 v15, v212, v16, v15
    v_dot2_f32_bf16 v15, v213, v16, v15
    v_dot2_f32_bf16 v15, v214, v16, v15
    v_dot2_f32_bf16 v15, v215, v16, v15
    s_waitcnt lgkmcnt(0)
    ds_read_b64_tr_b16 v[216:217], v8 offset:4608
    ds_read_b64_tr_b16 v[218:219], v8 offset:5184
    ds_read_b64_tr_b16 v[220:221], v8 offset:4640
    ds_read_b64_tr_b16 v[222:223], v8 offset:5216
    ds_read_b64_tr_b16 v[224:225], v8 offset:4672
    ds_read_b64_tr_b16 v[226:227], v8 offset:5248
    ds_read_b64_tr_b16 v[228:229], v8 offset:4704
    ds_read_b64_tr_b16 v[230:231], v8 offset:5280
    s_waitcnt vmcnt(32)
    ds_write_b128 v5, v[96:99] offset:0
    ds_write_b128 v5, v[100:103] offset:1152
    ds_write_b128 v5, v[104:107] offset:2304
    ds_write_b128 v5, v[108:111] offset:3456
    s_waitcnt lgkmcnt(4)
    buffer_store_dwordx4 v[216:219], v9, s[28:31], s44 offen sc1
    s_add_u32 s44, s44, s48
    v_dot2_f32_bf16 v12, v216, v16, v12
    v_dot2_f32_bf16 v12, v217, v16, v12
    v_dot2_f32_bf16 v12, v218, v16, v12
    v_dot2_f32_bf16 v12, v219, v16, v12
    buffer_store_dwordx4 v[220:223], v9, s[28:31], s45 offen sc1
    s_add_u32 s45, s45, s49
    v_dot2_f32_bf16 v13, v220, v16, v13
    v_dot2_f32_bf16 v13, v221, v16, v13
    v_dot2_f32_bf16 v13, v222, v16, v13
    v_dot2_f32_bf16 v13, v223, v16, v13
    buffer_store_dwordx4 v[224:227], v9, s[28:31], s46 offen sc1
    s_add_u32 s46, s46, s50
    v_dot2_f32_bf16 v14, v224, v16, v14
    v_dot2_f32_bf16 v14, v225, v16, v14
    v_dot2_f32_bf16 v14, v226, v16, v14
    v_dot2_f32_bf16 v14, v227, v16, v14
    buffer_store_dwordx4 v[228:231], v9, s[28:31], s47 offen sc1
    s_add_u32 s47, s47, s51
    v_dot2_f32_bf16 v15, v228, v16, v15
    v_dot2_f32_bf16 v15, v229, v16, v15
    v_dot2_f32_bf16 v15, v230, v16, v15
    v_dot2_f32_bf16 v15, v231, v16, v15
    s_waitcnt lgkmcnt(0)
    ds_read_b64_tr_b16 v[200:201], v8 offset:0
    ds_read_b64_tr_b16 v[202:203], v8 offset:576
    ds_read_b64_tr_b16 v[204:205], v8 offset:32
    ds_read_b64_tr_b16 v[206:207], v8 offset:608
    ds_read_b64_tr_b16 v[208:209], v8 offset:64
    ds_read_b64_tr_b16 v[210:211], v8 offset:640
    ds_read_b64_tr_b16 v[212:213], v8 offset:96
    ds_read_b64_tr_b16 v[214:215], v8 offset:672
    s_waitcnt vmcnt(32)
    ds_write_b128 v5, v[112:115] offset:4608
    ds_write_b128 v5, v[116:119] offset:5760
    ds_write_b128 v5, v[120:123] offset:6912
    ds_write_b128 v5, v[124:127] offset:8064
    s_waitcnt lgkmcnt(4)
    buffer_store_dwordx4 v[200:203], v9, s[28:31], s44 offen sc1
    s_add_u32 s44, s44, s48
    v_dot2_f32_bf16 v12, v200, v16, v12
    v_dot2_f32_bf16 v12, v201, v16, v12
    v_dot2_f32_bf16 v12, v202, v16, v12
    v_dot2_f32_bf16 v12, v203, v16, v12
    buffer_store_dwordx4 v[204:207], v9, s[28:31], s45 offen sc1
    s_add_u32 s45, s45, s49
    v_dot2_f32_bf16 v13, v204, v16, v13
    v_dot2_f32_bf16 v13, v205, v16, v13
    v_dot2_f32_bf16 v13, v206, v16, v13
    v_dot2_f32_bf16 v13, v207, v16, v13
    buffer_store_dwordx4 v[208:211], v9, s[28:31], s46 offen sc1
    s_add_u32 s46, s46, s50
    v_dot2_f32_bf16 v14, v208, v16, v14
    v_dot2_f32_bf16 v14, v209, v16, v14
    v_dot2_f32_bf16 v14, v210, v16, v14
    v_dot2_f32_bf16 v14, v211, v16, v14
    buffer_store_dwordx4 v[212:215], v9, s[28:31], s47 offen sc1
    s_add_u32 s47, s47, s51
    v_dot2_f32_bf16 v15, v212, v16, v15
    v_dot2_f32_bf16 v15, v213, v16, v15
    v_dot2_f32_bf16 v15, v214, v16, v15
    v_dot2_f32_bf16 v15, v215, v16, v15
    s_waitcnt lgkmcnt(0)
    ds_read_b64_tr_b16 v[216:217], v8 offset:4608
    ds_read_b64_tr_b16 v[218:219], v8 offset:5184
    ds_read_b64_tr_b16 v[220:221], v8 offset:4640
    ds_read_b64_tr_b16 v[222:223], v8 offset:5216
    ds_read_b64_tr_b16 v[224:225], v8 offset:4672
    ds_read_b64_tr_b16 v[226:227], v8 offset:5248
    ds_read_b64_tr_b16 v[228:229], v8 offset:4704
    ds_read_b64_tr_b16 v[230:231], v8 offset:5280
    s_waitcnt vmcnt(32)
    ds_write_b128 v5, v[128:131] offset:0
    ds_write_b128 v5, v[132:135] offset:1152
    ds_write_b128 v5, v[136:139] offset:2304
    ds_write_b128 v5, v[140:143] offset:3456
    s_waitcnt lgkmcnt(4)
    buffer_store_dwordx4 v[216:219], v9, s[28:31], s44 offen sc1
    s_add_u32 s44, s44, s48
    v_dot2_f32_bf16 v12, v216, v16, v12
    v_dot2_f32_bf16 v12, v217, v16, v12
    v_dot2_f32_bf16 v12, v218, v16, v12
    v_dot2_f32_bf16 v12, v219, v16, v12
    buffer_store_dwordx4 v[220:223], v9, s[28:31], s45 offen sc1
    s_add_u32 s45, s45, s49
    v_dot2_f32_bf16 v13, v220, v16, v13
    v_dot2_f32_bf16 v13, v221, v16, v13
    v_dot2_f32_bf16 v13, v222, v16, v13
    v_dot2_f32_bf16 v13, v223, v16, v13
    buffer_store_dwordx4 v[224:227], v9, s[28:31], s46 offen sc1
    s_add_u32 s46, s46, s50
    v_dot2_f32_bf16 v14, v224, v16, v14
    v_dot2_f32_bf16 v14, v225, v16, v14
    v_dot2_f32_bf16 v14, v226, v16, v14
    v_dot2_f32_bf16 v14, v227, v16, v14
    buffer_store_dwordx4 v[228:231], v9, s[28:31], s47 offen sc1
    s_add_u32 s47, s47, s51
    v_dot2_f32_bf16 v15, v228, v16, v15
    v_dot2_f32_bf16 v15, v229, v16, v15
    v_dot2_f32_bf16 v15, v230, v16, v15
    v_dot2_f32_bf16 v15, v231, v16, v15
    s_waitcnt lgkmcnt(0)
    ds_read_b64_tr_b16 v[200:201], v8 offset:0
    ds_read_b64_tr_b16 v[202:203], v8 offset:576
    ds_read_b64_tr_b16 v[204:205], v8 offset:32
    ds_read_b64_tr_b16 v[206:207], v8 offset:608
    ds_read_b64_tr_b16 v[208:209], v8 offset:64
    ds_read_b64_tr_b16 v[210:211], v8 offset:640
    ds_read_b64_tr_b16 v[212:213], v8 offset:96
    ds_read_b64_tr_b16 v[214:215], v8 offset:672
    s_waitcnt vmcnt(32)
    ds_write_b128 v5, v[144:147] offset:4608
    ds_write_b128 v5, v[148:151] offset:5760
    ds_write_b128 v5, v[152:155] offset:6912
    ds_write_b128 v5, v[156:159] offset:8064
    s_waitcnt lgkmcnt(4)
    buffer_store_dwordx4 v[200:203], v9, s[28:31], s44 offen sc1
    s_add_u32 s44, s44, s48
    v_dot2_f32_bf16 v12, v200, v16, v12
    v_dot2_f32_bf16 v12, v201, v16, v12
    v_dot2_f32_bf16 v12, v202, v16, v12
    v_dot2_f32_bf16 v12, v203, v16, v12
    buffer_store_dwordx4 v[204:207], v9, s[28:31], s45 offen sc1
    s_add_u32 s45, s45, s49
    v_dot2_f32_bf16 v13, v204, v16, v13
    v_dot2_f32_bf16 v13, v205, v16, v13
    v_dot2_f32_bf16 v13, v206, v16, v13
    v_dot2_f32_bf16 v13, v207, v16, v13
    buffer_store_dwordx4 v[208:211], v9, s[28:31], s46 offen sc1
    s_add_u32 s46, s46, s50
    v_dot2_f32_bf16 v14, v208, v16, v14
    v_dot2_f32_bf16 v14, v209, v16, v14
    v_dot2_f32_bf16 v14, v210, v16, v14
    v_dot2_f32_bf16 v14, v211, v16, v14
    buffer_store_dwordx4 v[212:215], v9, s[28:31], s47 offen sc1
    s_add_u32 s47, s47, s51
    v_dot2_f32_bf16 v15, v212, v16, v15
    v_dot2_f32_bf16 v15, v213, v16, v15
    v_dot2_f32_bf16 v15, v214, v16, v15
    v_dot2_f32_bf16 v15, v215, v16, v15
    s_waitcnt lgkmcnt(0)
    ds_read_b64_tr_b16 v[216:217], v8 offset:4608
    ds_read_b64_tr_b16 v[218:219], v8 offset:5184
    ds_read_b64_tr_b16 v[220:221], v8 offset:4640
    ds_read_b64_tr_b16 v[222:223], v8 offset:5216
    ds_read_b64_tr_b16 v[224:225], v8 offset:4672
    ds_read_b64_tr_b16 v[226:227], v8 offset:5248
    ds_read_b64_tr_b16 v[228:229], v8 offset:4704
    ds_read_b64_tr_b16 v[230:231], v8 offset:5280
    s_waitcnt vmcnt(32)
    ds_write_b128 v5, v[160:163] offset:0
    ds_write_b128 v5, v[164:167] offset:1152
    ds_write_b128 v5, v[168:171] offset:2304
    ds_write_b128 v5, v[172:175] offset:3456
    s_waitcnt lgkmcnt(4)
    buffer_store_dwordx4 v[216:219], v9, s[28:31], s44 offen sc1
    s_add_u32 s44, s44, s48
    v_dot2_f32_bf16 v12, v216, v16, v12
    v_dot2_f32_bf16 v12, v217, v16, v12
    v_dot2_f32_bf16 v12, v218, v16, v12
    v_dot2_f32_bf16 v12, v219, v16, v12
    buffer_store_dwordx4 v[220:223], v9, s[28:31], s45 offen sc1
    s_add_u32 s45, s45, s49
    v_dot2_f32_bf16 v13, v220, v16, v13
    v_dot2_f32_bf16 v13, v221, v16, v13
    v_dot2_f32_bf16 v13, v222, v16, v13
    v_dot2_f32_bf16 v13, v223, v16, v13
    buffer_store_dwordx4 v[224:227], v9, s[28:31], s46 offen sc1
    s_add_u32 s46, s46, s50
    v_dot2_f32_bf16 v14, v224, v16, v14
    v_dot2_f32_bf16 v14, v225, v16, v14
    v_dot2_f32_bf16 v14, v226, v16, v14
    v_dot2_f32_bf16 v14, v227, v16, v14
    buffer_store_dwordx4 v[228:231], v9, s[28:31], s47 offen sc1
    s_add_u32 s47, s47, s51
    v_dot2_f32_bf16 v15, v228, v16, v15
    v_dot2_f32_bf16 v15, v229, v16, v15
    v_dot2_f32_bf16 v15, v230, v16, v15
    v_dot2_f32_bf16 v15, v231, v16, v15
    s_waitcnt lgkmcnt(0)
    ds_read_b64_tr_b16 v[200:201], v8 offset:0
    ds_read_b64_tr_b16 v[202:203], v8 offset:576
    ds_read_b64_tr_b16 v[204:205], v8 offset:32
    ds_read_b64_tr_b16 v[206:207], v8 offset:608
    ds_read_b64_tr_b16 v[208:209], v8 offset:64
    ds_read_b64_tr_b16 v[210:211], v8 offset:640
    ds_read_b64_tr_b16 v[212:213], v8 offset:96
    ds_read_b64_tr_b16 v[214:215], v8 offset:672
    s_waitcnt vmcnt(32)
    ds_write_b128 v5, v[176:179] offset:4608
    ds_write_b128 v5, v[180:183] offset:5760
    ds_write_b128 v5, v[184:187] offset:6912
    ds_write_b128 v5, v[188:191] offset:8064
    s_waitcnt lgkmcnt(4)
    buffer_store_dwordx4 v[200:203], v9, s[28:31], s44 offen sc1
    s_add_u32 s44, s44, s48
    v_dot2_f32_bf16 v12, v200, v16, v12
    v_dot2_f32_bf16 v12, v201, v16, v12
    v_dot2_f32_bf16 v12, v202, v16, v12
    v_dot2_f32_bf16 v12, v203, v16, v12
    buffer_store_dwordx4 v[204:207], v9, s[28:31], s45 offen sc1
    s_add_u32 s45, s45, s49
    v_dot2_f32_bf16 v13, v204, v16, v13
    v_dot2_f32_bf16 v13, v205, v16, v13
    v_dot2_f32_bf16 v13, v206, v16, v13
    v_dot2_f32_bf16 v13, v207, v16, v13
    buffer_store_dwordx4 v[208:211], v9, s[28:31], s46 offen sc1
    s_add_u32 s46, s46, s50
    v_dot2_f32_bf16 v14, v208, v16, v14
    v_dot2_f32_bf16 v14, v209, v16, v14
    v_dot2_f32_bf16 v14, v210, v16, v14
    v_dot2_f32_bf16 v14, v211, v16, v14
    buffer_store_dwordx4 v[212:215], v9, s[28:31], s47 offen sc1
    s_add_u32 s47, s47, s51
    v_dot2_f32_bf16 v15, v212, v16, v15
    v_dot2_f32_bf16 v15, v213, v16, v15
    v_dot2_f32_bf16 v15, v214, v16, v15
    v_dot2_f32_bf16 v15, v215, v16, v15
    s_waitcnt lgkmcnt(0)
    ds_read_b64_tr_b16 v[216:217], v8 offset:4608
    ds_read_b64_tr_b16 v[218:219], v8 offset:5184
    ds_read_b64_tr_b16 v[220:221], v8 offset:4640
    ds_read_b64_tr_b16 v[222:223], v8 offset:5216
    ds_read_b64_tr_b16 v[224:225], v8 offset:4672
    ds_read_b64_tr_b16 v[226:227], v8 offset:5248
    ds_read_b64_tr_b16 v[228:229], v8 offset:4704
    ds_read_b64_tr_b16 v[230:231], v8 offset:5280
    s_waitcnt lgkmcnt(0)
    buffer_store_dwordx4 v[216:219], v9, s[28:31], s44 offen sc1
    s_add_u32 s44, s44, s48
    v_dot2_f32_bf16 v12, v216, v16, v12
    v_dot2_f32_bf16 v12, v217, v16, v12
    v_dot2_f32_bf16 v12, v218, v16, v12
    v_dot2_f32_bf16 v12, v219, v16, v12
    buffer_store_dwordx4 v[220:223], v9, s[28:31], s45 offen sc1
    s_add_u32 s45, s45, s49
    v_dot2_f32_bf16 v13, v220, v16, v13
    v_dot2_f32_bf16 v13, v221, v16, v13
    v_dot2_f32_bf16 v13, v222, v16, v13
    v_dot2_f32_bf16 v13, v223, v16, v13
    buffer_store_dwordx4 v[224:227], v9, s[28:31], s46 offen sc1
    s_add_u32 s46, s46, s50
    v_dot2_f32_bf16 v14, v224, v16, v14
    v_dot2_f32_bf16 v14, v225, v16, v14
    v_dot2_f32_bf16 v14, v226, v16, v14
    v_dot2_f32_bf16 v14, v227, v16, v14
    buffer_store_dwordx4 v[228:231], v9, s[28:31], s47 offen sc1
    s_add_u32 s47, s47, s51
    v_dot2_f32_bf16 v15, v228, v16, v15
    v_dot2_f32_bf16 v15, v229, v16, v15
    v_dot2_f32_bf16 v15, v230, v16, v15
    v_dot2_f32_bf16 v15, v231, v16, v15
    s_nop 2
    v_mov_b32 v20, v12
    v_mov_b32 v21, v13
    v_mov_b32 v22, v14
    v_mov_b32 v23, v15
    s_nop 1
    v_permlane32_swap_b32 v20, v12
    v_permlane32_swap_b32 v21, v13
    v_permlane32_swap_b32 v22, v14
    v_permlane32_swap_b32 v23, v15
    s_nop 1
    v_add_f32 v12, v12, v20
    v_add_f32 v13, v13, v21
    v_add_f32 v14, v14, v22
    v_add_f32 v15, v15, v23
    v_mov_b32 v20, v12
    v_mov_b32 v21, v13
    v_mov_b32 v22, v14
    v_mov_b32 v23, v15
    s_nop 1
    v_permlane16_swap_b32 v20, v12
    v_permlane16_swap_b32 v21, v13
    v_permlane16_swap_b32 v22, v14
    v_permlane16_swap_b32 v23, v15
    s_nop 1
    v_add_f32 v12, v12, v20
    v_add_f32 v13, v13, v21
    v_add_f32 v14, v14, v22
    v_add_f32 v15, v15, v23
    s_mul_i32 s38, s33, 7168
    s_lshl_b32 s39, s35, 8
    s_add_u32 s38, s38, s39
    s_add_u32 s38, s38, 8146944
    v_lshlrev_b32 v17, 2, v1
    s_mov_b64 exec, 0xffff
    buffer_store_dword v12, v17, s[28:31], s38 offen offset:0 sc1
    buffer_store_dword v13, v17, s[28:31], s38 offen offset:64 sc1
    buffer_store_dword v14, v17, s[28:31], s38 offen offset:128 sc1
    buffer_store_dword v15, v17, s[28:31], s38 offen offset:192 sc1
    s_endpgm
k1_kernel_pk6:
    s_mov_b32 s24, s14
    s_mov_b32 s25, s15
    s_mov_b32 s26, 819200
    s_mov_b32 s27, 0x00020000
    s_sub_u32 s32, s21, 20
    s_mul_i32 s33, s32, 52429
    s_lshr_b32 s33, s33, 19
    s_mul_i32 s35, s33, 10
    s_sub_u32 s35, s32, s35
    v_mul_u32_u24 v10, 1280, v3
    v_lshl_add_u32 v10, v4, 4, v10
    s_mul_i32 s36, s33, 409600
    s_lshl_b32 s37, s35, 7
    s_add_u32 s36, s36, s37
    buffer_load_dwordx4 v[32:35], v10, s[24:27], s36 offen nt
    s_add_u32 s36, s36, 10240
    buffer_load_dwordx4 v[36:39], v10, s[24:27], s36 offen nt
    s_add_u32 s36, s36, 10240
    buffer_load_dwordx4 v[40:43], v10, s[24:27], s36 offen nt
    s_add_u32 s36, s36, 10240
    buffer_load_dwordx4 v[44:47], v10, s[24:27], s36 offen nt
    s_add_u32 s36, s36, 10240
    buffer_load_dwordx4 v[48:51], v10, s[24:27], s36 offen nt
    s_add_u32 s36, s36, 10240
    buffer_load_dwordx4 v[52:55], v10, s[24:27], s36 offen nt
    s_add_u32 s36, s36, 10240
    buffer_load_dwordx4 v[56:59], v10, s[24:27], s36 offen nt
    s_add_u32 s36, s36, 10240
    buffer_load_dwordx4 v[60:63], v10, s[24:27], s36 offen nt
    s_add_u32 s36, s36, 10240
    buffer_load_dwordx4 v[64:67], v10, s[24:27], s36 offen nt
    s_add_u32 s36, s36, 10240
    buffer_load_dwordx4 v[68:71], v10, s[24:27], s36 offen nt
    s_add_u32 s36, s36, 10240
    buffer_load_dwordx4 v[72:75], v10, s[24:27], s36 offen nt
    s_add_u32 s36, s36, 10240
    buffer_load_dwordx4 v[76:79], v10, s[24:27], s36 offen nt
    s_add_u32 s36, s36, 10240
    buffer_load_dwordx4 v[80:83], v10, s[24:27], s36 offen nt
    s_add_u32 s36, s36, 10240
    buffer_load_dwordx4 v[84:87], v10, s[24:27], s36 offen nt
    s_add_u32 s36, s36, 10240
    buffer_load_dwordx4 v[88:91], v10, s[24:27], s36 offen nt
    s_add_u32 s36, s36, 10240
    buffer_load_dwordx4 v[92:95], v10, s[24:27], s36 offen nt
    s_add_u32 s36, s36, 10240
    buffer_load_dwordx4 v[96:99], v10, s[24:27], s36 offen nt
    s_add_u32 s36, s36, 10240
    buffer_load_dwordx4 v[100:103], v10, s[24:27], s36 offen nt
    s_add_u32 s36, s36, 10240
    buffer_load_dwordx4 v[104:107], v10, s[24:27], s36 offen nt
    s_add_u32 s36, s36, 10240
    buffer_load_dwordx4 v[108:111], v10, s[24:27], s36 offen nt
    s_add_u32 s36, s36, 10240
    buffer_load_dwordx4 v[112:115], v10, s[24:27], s36 offen nt
    s_add_u32 s36, s36, 10240
    buffer_load_dwordx4 v[116:119], v10, s[24:27], s36 offen nt
    s_add_u32 s36, s36, 10240
    buffer_load_dwordx4 v[120:123], v10, s[24:27], s36 offen nt
    s_add_u32 s36, s36, 10240
    buffer_load_dwordx4 v[124:127], v10, s[24:27], s36 offen nt
    s_add_u32 s36, s36, 10240
    buffer_load_dwordx4 v[128:131], v10, s[24:27], s36 offen nt
    s_add_u32 s36, s36, 10240
    buffer_load_dwordx4 v[132:135], v10, s[24:27], s36 offen nt
    s_add_u32 s36, s36, 10240
    buffer_load_dwordx4 v[136:139], v10, s[24:27], s36 offen nt
    s_add_u32 s36, s36, 10240
    buffer_load_dwordx4 v[140:143], v10, s[24:27], s36 offen nt
    s_add_u32 s36, s36, 10240
    buffer_load_dwordx4 v[144:147], v10, s[24:27], s36 offen nt
    s_add_u32 s36, s36, 10240
    buffer_load_dwordx4 v[148:151], v10, s[24:27], s36 offen nt
    s_add_u32 s36, s36, 10240
    buffer_load_dwordx4 v[152:155], v10, s[24:27], s36 offen nt
    s_add_u32 s36, s36, 10240
    buffer_load_dwordx4 v[156:159], v10, s[24:27], s36 offen nt
    s_add_u32 s36, s36, 10240
    buffer_load_dwordx4 v[160:163], v10, s[24:27], s36 offen nt
    s_add_u32 s36, s36, 10240
    buffer_load_dwordx4 v[164:167], v10, s[24:27], s36 offen nt
    s_add_u32 s36, s36, 10240
    buffer_load_dwordx4 v[168:171], v10, s[24:27], s36 offen nt
    s_add_u32 s36, s36, 10240
    buffer_load_dwordx4 v[172:175], v10, s[24:27], s36 offen nt
    s_add_u32 s36, s36, 10240
    buffer_load_dwordx4 v[176:179], v10, s[24:27], s36 offen nt
    s_add_u32 s36, s36, 10240
    buffer_load_dwordx4 v[180:183], v10, s[24:27], s36 offen nt
    s_add_u32 s36, s36, 10240
    buffer_load_dwordx4 v[184:187], v10, s[24:27], s36 offen nt
    s_add_u32 s36, s36, 10240
    buffer_load_dwordx4 v[188:191], v10, s[24:27], s36 offen nt
    s_lshl_b32 s36, s35, 2
    s_add_u32 s36, s36, 0
    s_mul_i32 s38, s36, 6554
    s_lshr_b32 s38, s38, 16
    s_mul_i32 s39, s38, 10
    s_sub_u32 s39, s36, s39
    s_cmp_ge_u32 s39, 5
    s_cselect_b32 s40, 1, 0
    s_sub_u32 s41, s39, 6
    s_cmp_eq_u32 s39, 5
    s_cselect_b32 s41, 4, s41
    s_cmp_eq_u32 s40, 1
    s_cselect_b32 s39, s41, s39
    s_mul_i32 s37, s38, 200
    s_mul_i32 s40, s40, 100
    s_add_u32 s37, s37, s40
    s_mul_i32 s40, s33, 50
    s_add_u32 s37, s37, s40
    s_add_u32 s37, s37, s39
    s_lshl_b32 s37, s37, 10
    s_add_u32 s44, s37, 24055808
    s_movk_i32 s48, 5120
    s_lshl_b32 s36, s35, 2
    s_add_u32 s36, s36, 1
    s_mul_i32 s38, s36, 6554
    s_lshr_b32 s38, s38, 16
    s_mul_i32 s39, s38, 10
    s_sub_u32 s39, s36, s39
    s_cmp_ge_u32 s39, 5
    s_cselect_b32 s40, 1, 0
    s_sub_u32 s41, s39, 6
    s_cmp_eq_u32 s39, 5
    s_cselect_b32 s41, 4, s41
    s_cmp_eq_u32 s40, 1
    s_cselect_b32 s39, s41, s39
    s_mul_i32 s37, s38, 200
    s_mul_i32 s40, s40, 100
    s_add_u32 s37, s37, s40
    s_mul_i32 s40, s33, 50
    s_add_u32 s37, s37, s40
    s_add_u32 s37, s37, s39
    s_lshl_b32 s37, s37, 10
    s_add_u32 s45, s37, 24055808
    s_movk_i32 s49, 5120
    s_lshl_b32 s36, s35, 2
    s_add_u32 s36, s36, 2
    s_mul_i32 s38, s36, 6554
    s_lshr_b32 s38, s38, 16
    s_mul_i32 s39, s38, 10
    s_sub_u32 s39, s36, s39
    s_cmp_ge_u32 s39, 5
    s_cselect_b32 s40, 1, 0
    s_sub_u32 s41, s39, 6
    s_cmp_eq_u32 s39, 5
    s_cselect_b32 s41, 4, s41
    s_cmp_eq_u32 s40, 1
    s_cselect_b32 s39, s41, s39
    s_mul_i32 s37, s38, 200
    s_mul_i32 s40, s40, 100
    s_add_u32 s37, s37, s40
    s_mul_i32 s40, s33, 50
    s_add_u32 s37, s37, s40
    s_add_u32 s37, s37, s39
    s_lshl_b32 s37, s37, 10
    s_add_u32 s46, s37, 24055808
    s_movk_i32 s50, 5120
    s_lshl_b32 s36, s35, 2
    s_add_u32 s36, s36, 3
    s_mul_i32 s38, s36, 6554
    s_lshr_b32 s38, s38, 16
    s_mul_i32 s39, s38, 10
    s_sub_u32 s39, s36, s39
    s_cmp_ge_u32 s39, 5
    s_cselect_b32 s40, 1, 0
    s_sub_u32 s41, s39, 6
    s_cmp_eq_u32 s39, 5
    s_cselect_b32 s41, 4, s41
    s_cmp_eq_u32 s40, 1
    s_cselect_b32 s39, s41, s39
    s_mul_i32 s37, s38, 200
    s_mul_i32 s40, s40, 100
    s_add_u32 s37, s37, s40
    s_mul_i32 s40, s33, 50
    s_add_u32 s37, s37, s40
    s_add_u32 s37, s37, s39
    s_lshl_b32 s37, s37, 10
    s_add_u32 s47, s37, 24055808
    s_movk_i32 s51, 5120
    s_waitcnt vmcnt(36)
    ds_write_b128 v5, v[32:35] offset:0
    ds_write_b128 v5, v[36:39] offset:1152
    ds_write_b128 v5, v[40:43] offset:2304
    ds_write_b128 v5, v[44:47] offset:3456
    s_waitcnt lgkmcnt(0)
    ds_read_b64_tr_b16 v[200:201], v8 offset:0
    ds_read_b64_tr_b16 v[202:203], v8 offset:576
    ds_read_b64_tr_b16 v[204:205], v8 offset:32
    ds_read_b64_tr_b16 v[206:207], v8 offset:608
    ds_read_b64_tr_b16 v[208:209], v8 offset:64
    ds_read_b64_tr_b16 v[210:211], v8 offset:640
    ds_read_b64_tr_b16 v[212:213], v8 offset:96
    ds_read_b64_tr_b16 v[214:215], v8 offset:672
    s_waitcnt vmcnt(32)
    ds_write_b128 v5, v[48:51] offset:4608
    ds_write_b128 v5, v[52:55] offset:5760
    ds_write_b128 v5, v[56:59] offset:6912
    ds_write_b128 v5, v[60:63] offset:8064
    s_waitcnt lgkmcnt(4)
    buffer_store_dwordx4 v[200:203], v9, s[28:31], s44 offen sc1
    s_add_u32 s44, s44, s48
    buffer_store_dwordx4 v[204:207], v9, s[28:31], s45 offen sc1
    s_add_u32 s45, s45, s49
    buffer_store_dwordx4 v[208:211], v9, s[28:31], s46 offen sc1
    s_add_u32 s46, s46, s50
    buffer_store_dwordx4 v[212:215], v9, s[28:31], s47 offen sc1
    s_add_u32 s47, s47, s51
    s_waitcnt lgkmcnt(0)
    ds_read_b64_tr_b16 v[216:217], v8 offset:4608
    ds_read_b64_tr_b16 v[218:219], v8 offset:5184
    ds_read_b64_tr_b16 v[220:221], v8 offset:4640
    ds_read_b64_tr_b16 v[222:223], v8 offset:5216
    ds_read_b64_tr_b16 v[224:225], v8 offset:4672
    ds_read_b64_tr_b16 v[226:227], v8 offset:5248
    ds_read_b64_tr_b16 v[228:229], v8 offset:4704
    ds_read_b64_tr_b16 v[230:231], v8 offset:5280
    s_waitcnt vmcnt(32)
    ds_write_b128 v5, v[64:67] offset:0
    ds_write_b128 v5, v[68:71] offset:1152
    ds_write_b128 v5, v[72:75] offset:2304
    ds_write_b128 v5, v[76:79] offset:3456
    s_waitcnt lgkmcnt(4)
    buffer_store_dwordx4 v[216:219], v9, s[28:31], s44 offen sc1
    s_add_u32 s44, s44, s48
    buffer_store_dwordx4 v[220:223], v9, s[28:31], s45 offen sc1
    s_add_u32 s45, s45, s49
    buffer_store_dwordx4 v[224:227], v9, s[28:31], s46 offen sc1
    s_add_u32 s46, s46, s50
    buffer_store_dwordx4 v[228:231], v9, s[28:31], s47 offen sc1
    s_add_u32 s47, s47, s51
    s_waitcnt lgkmcnt(0)
    ds_read_b64_tr_b16 v[200:201], v8 offset:0
    ds_read_b64_tr_b16 v[202:203], v8 offset:576
    ds_read_b64_tr_b16 v[204:205], v8 offset:32
    ds_read_b64_tr_b16 v[206:207], v8 offset:608
    ds_read_b64_tr_b16 v[208:209], v8 offset:64
    ds_read_b64_tr_b16 v[210:211], v8 offset:640
    ds_read_b64_tr_b16 v[212:213], v8 offset:96
    ds_read_b64_tr_b16 v[214:215], v8 offset:672
    s_waitcnt vmcnt(32)
    ds_write_b128 v5, v[80:83] offset:4608
    ds_write_b128 v5, v[84:87] offset:5760
    ds_write_b128 v5, v[88:91] offset:6912
    ds_write_b128 v5, v[92:95] offset:8064
    s_waitcnt lgkmcnt(4)
    buffer_store_dwordx4 v[200:203], v9, s[28:31], s44 offen sc1
    s_add_u32 s44, s44, s48
    buffer_store_dwordx4 v[204:207], v9, s[28:31], s45 offen sc1
    s_add_u32 s45, s45, s49
    buffer_store_dwordx4 v[208:211], v9, s[28:31], s46 offen sc1
    s_add_u32 s46, s46, s50
    buffer_store_dwordx4 v[212:215], v9, s[28:31], s47 offen sc1
    s_add_u32 s47, s47, s51
    s_waitcnt lgkmcnt(0)
    ds_read_b64_tr_b16 v[216:217], v8 offset:4608
    ds_read_b64_tr_b16 v[218:219], v8 offset:5184
    ds_read_b64_tr_b16 v[220:221], v8 offset:4640
    ds_read_b64_tr_b16 v[222:223], v8 offset:5216
    ds_read_b64_tr_b16 v[224:225], v8 offset:4672
    ds_read_b64_tr_b16 v[226:227], v8 offset:5248
    ds_read_b64_tr_b16 v[228:229], v8 offset:4704
    ds_read_b64_tr_b16 v[230:231], v8 offset:5280
    s_waitcnt vmcnt(32)
    ds_write_b128 v5, v[96:99] offset:0
    ds_write_b128 v5, v[100:103] offset:1152
    ds_write_b128 v5, v[104:107] offset:2304
    ds_write_b128 v5, v[108:111] offset:3456
    s_waitcnt lgkmcnt(4)
    buffer_store_dwordx4 v[216:219], v9, s[28:31], s44 offen sc1
    s_add_u32 s44, s44, s48
    buffer_store_dwordx4 v[220:223], v9, s[28:31], s45 offen sc1
    s_add_u32 s45, s45, s49
    buffer_store_dwordx4 v[224:227], v9, s[28:31], s46 offen sc1
    s_add_u32 s46, s46, s50
    buffer_store_dwordx4 v[228:231], v9, s[28:31], s47 offen sc1
    s_add_u32 s47, s47, s51
    s_waitcnt lgkmcnt(0)
    ds_read_b64_tr_b16 v[200:201], v8 offset:0
    ds_read_b64_tr_b16 v[202:203], v8 offset:576
    ds_read_b64_tr_b16 v[204:205], v8 offset:32
    ds_read_b64_tr_b16 v[206:207], v8 offset:608
    ds_read_b64_tr_b16 v[208:209], v8 offset:64
    ds_read_b64_tr_b16 v[210:211], v8 offset:640
    ds_read_b64_tr_b16 v[212:213], v8 offset:96
    ds_read_b64_tr_b16 v[214:215], v8 offset:672
    s_waitcnt vmcnt(32)
    ds_write_b128 v5, v[112:115] offset:4608
    ds_write_b128 v5, v[116:119] offset:5760
    ds_write_b128 v5, v[120:123] offset:6912
    ds_write_b128 v5, v[124:127] offset:8064
    s_waitcnt lgkmcnt(4)
    buffer_store_dwordx4 v[200:203], v9, s[28:31], s44 offen sc1
    s_add_u32 s44, s44, s48
    buffer_store_dwordx4 v[204:207], v9, s[28:31], s45 offen sc1
    s_add_u32 s45, s45, s49
    buffer_store_dwordx4 v[208:211], v9, s[28:31], s46 offen sc1
    s_add_u32 s46, s46, s50
    buffer_store_dwordx4 v[212:215], v9, s[28:31], s47 offen sc1
    s_add_u32 s47, s47, s51
    s_waitcnt lgkmcnt(0)
    ds_read_b64_tr_b16 v[216:217], v8 offset:4608
    ds_read_b64_tr_b16 v[218:219], v8 offset:5184
    ds_read_b64_tr_b16 v[220:221], v8 offset:4640
    ds_read_b64_tr_b16 v[222:223], v8 offset:5216
    ds_read_b64_tr_b16 v[224:225], v8 offset:4672
    ds_read_b64_tr_b16 v[226:227], v8 offset:5248
    ds_read_b64_tr_b16 v[228:229], v8 offset:4704
    ds_read_b64_tr_b16 v[230:231], v8 offset:5280
    s_waitcnt vmcnt(32)
    ds_write_b128 v5, v[128:131] offset:0
    ds_write_b128 v5, v[132:135] offset:1152
    ds_write_b128 v5, v[136:139] offset:2304
    ds_write_b128 v5, v[140:143] offset:3456
    s_waitcnt lgkmcnt(4)
    buffer_store_dwordx4 v[216:219], v9, s[28:31], s44 offen sc1
    s_add_u32 s44, s44, s48
    buffer_store_dwordx4 v[220:223], v9, s[28:31], s45 offen sc1
    s_add_u32 s45, s45, s49
    buffer_store_dwordx4 v[224:227], v9, s[28:31], s46 offen sc1
    s_add_u32 s46, s46, s50
    buffer_store_dwordx4 v[228:231], v9, s[28:31], s47 offen sc1
    s_add_u32 s47, s47, s51
    s_waitcnt lgkmcnt(0)
    ds_read_b64_tr_b16 v[200:201], v8 offset:0
    ds_read_b64_tr_b16 v[202:203], v8 offset:576
    ds_read_b64_tr_b16 v[204:205], v8 offset:32
    ds_read_b64_tr_b16 v[206:207], v8 offset:608
    ds_read_b64_tr_b16 v[208:209], v8 offset:64
    ds_read_b64_tr_b16 v[210:211], v8 offset:640
    ds_read_b64_tr_b16 v[212:213], v8 offset:96
    ds_read_b64_tr_b16 v[214:215], v8 offset:672
    s_waitcnt vmcnt(32)
    ds_write_b128 v5, v[144:147] offset:4608
    ds_write_b128 v5, v[148:151] offset:5760
    ds_write_b128 v5, v[152:155] offset:6912
    ds_write_b128 v5, v[156:159] offset:8064
    s_waitcnt lgkmcnt(4)
    buffer_store_dwordx4 v[200:203], v9, s[28:31], s44 offen sc1
    s_add_u32 s44, s44, s48
    buffer_store_dwordx4 v[204:207], v9, s[28:31], s45 offen sc1
    s_add_u32 s45, s45, s49
    buffer_store_dwordx4 v[208:211], v9, s[28:31], s46 offen sc1
    s_add_u32 s46, s46, s50
    buffer_store_dwordx4 v[212:215], v9, s[28:31], s47 offen sc1
    s_add_u32 s47, s47, s51
    s_waitcnt lgkmcnt(0)
    ds_read_b64_tr_b16 v[216:217], v8 offset:4608
    ds_read_b64_tr_b16 v[218:219], v8 offset:5184
    ds_read_b64_tr_b16 v[220:221], v8 offset:4640
    ds_read_b64_tr_b16 v[222:223], v8 offset:5216
    ds_read_b64_tr_b16 v[224:225], v8 offset:4672
    ds_read_b64_tr_b16 v[226:227], v8 offset:5248
    ds_read_b64_tr_b16 v[228:229], v8 offset:4704
    ds_read_b64_tr_b16 v[230:231], v8 offset:5280
    s_waitcnt vmcnt(32)
    ds_write_b128 v5, v[160:163] offset:0
    ds_write_b128 v5, v[164:167] offset:1152
    ds_write_b128 v5, v[168:171] offset:2304
    ds_write_b128 v5, v[172:175] offset:3456
    s_waitcnt lgkmcnt(4)
    buffer_store_dwordx4 v[216:219], v9, s[28:31], s44 offen sc1
    s_add_u32 s44, s44, s48
    buffer_store_dwordx4 v[220:223], v9, s[28:31], s45 offen sc1
    s_add_u32 s45, s45, s49
    buffer_store_dwordx4 v[224:227], v9, s[28:31], s46 offen sc1
    s_add_u32 s46, s46, s50
    buffer_store_dwordx4 v[228:231], v9, s[28:31], s47 offen sc1
    s_add_u32 s47, s47, s51
    s_waitcnt lgkmcnt(0)
    ds_read_b64_tr_b16 v[200:201], v8 offset:0
    ds_read_b64_tr_b16 v[202:203], v8 offset:576
    ds_read_b64_tr_b16 v[204:205], v8 offset:32
    ds_read_b64_tr_b16 v[206:207], v8 offset:608
    ds_read_b64_tr_b16 v[208:209], v8 offset:64
    ds_read_b64_tr_b16 v[210:211], v8 offset:640
    ds_read_b64_tr_b16 v[212:213], v8 offset:96
    ds_read_b64_tr_b16 v[214:215], v8 offset:672
    s_waitcnt vmcnt(32)
    ds_write_b128 v5, v[176:179] offset:4608
    ds_write_b128 v5, v[180:183] offset:5760
    ds_write_b128 v5, v[184:187] offset:6912
    ds_write_b128 v5, v[188:191] offset:8064
    s_waitcnt lgkmcnt(4)
    buffer_store_dwordx4 v[200:203], v9, s[28:31], s44 offen sc1
    s_add_u32 s44, s44, s48
    buffer_store_dwordx4 v[204:207], v9, s[28:31], s45 offen sc1
    s_add_u32 s45, s45, s49
    buffer_store_dwordx4 v[208:211], v9, s[28:31], s46 offen sc1
    s_add_u32 s46, s46, s50
    buffer_store_dwordx4 v[212:215], v9, s[28:31], s47 offen sc1
    s_add_u32 s47, s47, s51
    s_waitcnt lgkmcnt(0)
    ds_read_b64_tr_b16 v[216:217], v8 offset:4608
    ds_read_b64_tr_b16 v[218:219], v8 offset:5184
    ds_read_b64_tr_b16 v[220:221], v8 offset:4640
    ds_read_b64_tr_b16 v[222:223], v8 offset:5216
    ds_read_b64_tr_b16 v[224:225], v8 offset:4672
    ds_read_b64_tr_b16 v[226:227], v8 offset:5248
    ds_read_b64_tr_b16 v[228:229], v8 offset:4704
    ds_read_b64_tr_b16 v[230:231], v8 offset:5280
    s_waitcnt lgkmcnt(0)
    buffer_store_dwordx4 v[216:219], v9, s[28:31], s44 offen sc1
    s_add_u32 s44, s44, s48
    buffer_store_dwordx4 v[220:223], v9, s[28:31], s45 offen sc1
    s_add_u32 s45, s45, s49
    buffer_store_dwordx4 v[224:227], v9, s[28:31], s46 offen sc1
    s_add_u32 s46, s46, s50
    buffer_store_dwordx4 v[228:231], v9, s[28:31], s47 offen sc1
    s_add_u32 s47, s47, s51
    s_endpgm
k1_kernel_pk7:
    s_mov_b32 s24, s16
    s_mov_b32 s25, s17
    s_mov_b32 s26, 2211840
    s_mov_b32 s27, 0x00020000
    s_sub_u32 s32, s21, 40
    s_mul_i32 s33, s32, 2428
    s_lshr_b32 s33, s33, 16
    s_mul_i32 s35, s33, 27
    s_sub_u32 s35, s32, s35
    v_mul_u32_u24 v10, 3456, v3
    v_lshl_add_u32 v10, v4, 4, v10
    s_mul_i32 s36, s33, 1105920
    s_lshl_b32 s37, s35, 7
    s_add_u32 s36, s36, s37
    buffer_load_dwordx4 v[32:35], v10, s[24:27], s36 offen nt
    s_add_u32 s36, s36, 27648
    buffer_load_dwordx4 v[36:39], v10, s[24:27], s36 offen nt
    s_add_u32 s36, s36, 27648
    buffer_load_dwordx4 v[40:43], v10, s[24:27], s36 offen nt
    s_add_u32 s36, s36, 27648
    buffer_load_dwordx4 v[44:47], v10, s[24:27], s36 offen nt
    s_add_u32 s36, s36, 27648
    buffer_load_dwordx4 v[48:51], v10, s[24:27], s36 offen nt
    s_add_u32 s36, s36, 27648
    buffer_load_dwordx4 v[52:55], v10, s[24:27], s36 offen nt
    s_add_u32 s36, s36, 27648
    buffer_load_dwordx4 v[56:59], v10, s[24:27], s36 offen nt
    s_add_u32 s36, s36, 27648
    buffer_load_dwordx4 v[60:63], v10, s[24:27], s36 offen nt
    s_add_u32 s36, s36, 27648
    buffer_load_dwordx4 v[64:67], v10, s[24:27], s36 offen nt
    s_add_u32 s36, s36, 27648
    buffer_load_dwordx4 v[68:71], v10, s[24:27], s36 offen nt
    s_add_u32 s36, s36, 27648
    buffer_load_dwordx4 v[72:75], v10, s[24:27], s36 offen nt
    s_add_u32 s36, s36, 27648
    buffer_load_dwordx4 v[76:79], v10, s[24:27], s36 offen nt
    s_add_u32 s36, s36, 27648
    buffer_load_dwordx4 v[80:83], v10, s[24:27], s36 offen nt
    s_add_u32 s36, s36, 27648
    buffer_load_dwordx4 v[84:87], v10, s[24:27], s36 offen nt
    s_add_u32 s36, s36, 27648
    buffer_load_dwordx4 v[88:91], v10, s[24:27], s36 offen nt
    s_add_u32 s36, s36, 27648
    buffer_load_dwordx4 v[92:95], v10, s[24:27], s36 offen nt
    s_add_u32 s36, s36, 27648
    buffer_load_dwordx4 v[96:99], v10, s[24:27], s36 offen nt
    s_add_u32 s36, s36, 27648
    buffer_load_dwordx4 v[100:103], v10, s[24:27], s36 offen nt
    s_add_u32 s36, s36, 27648
    buffer_load_dwordx4 v[104:107], v10, s[24:27], s36 offen nt
    s_add_u32 s36, s36, 27648
    buffer_load_dwordx4 v[108:111], v10, s[24:27], s36 offen nt
    s_add_u32 s36, s36, 27648
    buffer_load_dwordx4 v[112:115], v10, s[24:27], s36 offen nt
    s_add_u32 s36, s36, 27648
    buffer_load_dwordx4 v[116:119], v10, s[24:27], s36 offen nt
    s_add_u32 s36, s36, 27648
    buffer_load_dwordx4 v[120:123], v10, s[24:27], s36 offen nt
    s_add_u32 s36, s36, 27648
    buffer_load_dwordx4 v[124:127], v10, s[24:27], s36 offen nt
    s_add_u32 s36, s36, 27648
    buffer_load_dwordx4 v[128:131], v10, s[24:27], s36 offen nt
    s_add_u32 s36, s36, 27648
    buffer_load_dwordx4 v[132:135], v10, s[24:27], s36 offen nt
    s_add_u32 s36, s36, 27648
    buffer_load_dwordx4 v[136:139], v10, s[24:27], s36 offen nt
    s_add_u32 s36, s36, 27648
    buffer_load_dwordx4 v[140:143], v10, s[24:27], s36 offen nt
    s_add_u32 s36, s36, 27648
    buffer_load_dwordx4 v[144:147], v10, s[24:27], s36 offen nt
    s_add_u32 s36, s36, 27648
    buffer_load_dwordx4 v[148:151], v10, s[24:27], s36 offen nt
    s_add_u32 s36, s36, 27648
    buffer_load_dwordx4 v[152:155], v10, s[24:27], s36 offen nt
    s_add_u32 s36, s36, 27648
    buffer_load_dwordx4 v[156:159], v10, s[24:27], s36 offen nt
    s_add_u32 s36, s36, 27648
    buffer_load_dwordx4 v[160:163], v10, s[24:27], s36 offen nt
    s_add_u32 s36, s36, 27648
    buffer_load_dwordx4 v[164:167], v10, s[24:27], s36 offen nt
    s_add_u32 s36, s36, 27648
    buffer_load_dwordx4 v[168:171], v10, s[24:27], s36 offen nt
    s_add_u32 s36, s36, 27648
    buffer_load_dwordx4 v[172:175], v10, s[24:27], s36 offen nt
    s_add_u32 s36, s36, 27648
    buffer_load_dwordx4 v[176:179], v10, s[24:27], s36 offen nt
    s_add_u32 s36, s36, 27648
    buffer_load_dwordx4 v[180:183], v10, s[24:27], s36 offen nt
    s_add_u32 s36, s36, 27648
    buffer_load_dwordx4 v[184:187], v10, s[24:27], s36 offen nt
    s_add_u32 s36, s36, 27648
    buffer_load_dwordx4 v[188:191], v10, s[24:27], s36 offen nt
    s_lshl_b32 s36, s35, 2
    s_add_u32 s36, s36, 0
    s_mul_i32 s38, s36, 9363
    s_lshr_b32 s38, s38, 16
    s_mul_i32 s39, s38, 7
    s_sub_u32 s39, s36, s39
    s_sub_u32 s41, s39, 1
    s_cmp_eq_u32 s39, 0
    s_cselect_b32 s41, 6, s41
    s_and_b32 s40, s38, 1
    s_cmp_eq_u32 s40, 1
    s_cselect_b32 s39, s41, s39
    s_mov_b32 s41, 4
    s_mov_b32 s40, s39
    s_cmp_ge_u32 s39, 4
    s_cselect_b32 s41, 2, s41
    s_add_u32 s42, s39, 76
    s_cmp_ge_u32 s39, 4
    s_cselect_b32 s40, s42, s40
    s_cmp_eq_u32 s39, 6
    s_cselect_b32 s41, 1, s41
    s_cselect_b32 s40, 120, s40
    s_mul_i32 s42, s33, 10
    s_mul_i32 s42, s42, s41
    s_add_u32 s40, s40, s42
    s_mul_i32 s37, s38, 140
    s_add_u32 s37, s37, s40
    s_lshl_b32 s37, s37, 10
    s_add_u32 s44, s37, 24875008
    s_lshl_b32 s48, s41, 10
    s_lshl_b32 s36, s35, 2
    s_add_u32 s36, s36, 1
    s_mul_i32 s38, s36, 9363
    s_lshr_b32 s38, s38, 16
    s_mul_i32 s39, s38, 7
    s_sub_u32 s39, s36, s39
    s_sub_u32 s41, s39, 1
    s_cmp_eq_u32 s39, 0
    s_cselect_b32 s41, 6, s41
    s_and_b32 s40, s38, 1
    s_cmp_eq_u32 s40, 1
    s_cselect_b32 s39, s41, s39
    s_mov_b32 s41, 4
    s_mov_b32 s40, s39
    s_cmp_ge_u32 s39, 4
    s_cselect_b32 s41, 2, s41
    s_add_u32 s42, s39, 76
    s_cmp_ge_u32 s39, 4
    s_cselect_b32 s40, s42, s40
    s_cmp_eq_u32 s39, 6
    s_cselect_b32 s41, 1, s41
    s_cselect_b32 s40, 120, s40
    s_mul_i32 s42, s33, 10
    s_mul_i32 s42, s42, s41
    s_add_u32 s40, s40, s42
    s_mul_i32 s37, s38, 140
    s_add_u32 s37, s37, s40
    s_lshl_b32 s37, s37, 10
    s_add_u32 s45, s37, 24875008
    s_lshl_b32 s49, s41, 10
    s_lshl_b32 s36, s35, 2
    s_add_u32 s36, s36, 2
    s_mul_i32 s38, s36, 9363
    s_lshr_b32 s38, s38, 16
    s_mul_i32 s39, s38, 7
    s_sub_u32 s39, s36, s39
    s_sub_u32 s41, s39, 1
    s_cmp_eq_u32 s39, 0
    s_cselect_b32 s41, 6, s41
    s_and_b32 s40, s38, 1
    s_cmp_eq_u32 s40, 1
    s_cselect_b32 s39, s41, s39
    s_mov_b32 s41, 4
    s_mov_b32 s40, s39
    s_cmp_ge_u32 s39, 4
    s_cselect_b32 s41, 2, s41
    s_add_u32 s42, s39, 76
    s_cmp_ge_u32 s39, 4
    s_cselect_b32 s40, s42, s40
    s_cmp_eq_u32 s39, 6
    s_cselect_b32 s41, 1, s41
    s_cselect_b32 s40, 120, s40
    s_mul_i32 s42, s33, 10
    s_mul_i32 s42, s42, s41
    s_add_u32 s40, s40, s42
    s_mul_i32 s37, s38, 140
    s_add_u32 s37, s37, s40
    s_lshl_b32 s37, s37, 10
    s_add_u32 s46, s37, 24875008
    s_lshl_b32 s50, s41, 10
    s_lshl_b32 s36, s35, 2
    s_add_u32 s36, s36, 3
    s_mul_i32 s38, s36, 9363
    s_lshr_b32 s38, s38, 16
    s_mul_i32 s39, s38, 7
    s_sub_u32 s39, s36, s39
    s_sub_u32 s41, s39, 1
    s_cmp_eq_u32 s39, 0
    s_cselect_b32 s41, 6, s41
    s_and_b32 s40, s38, 1
    s_cmp_eq_u32 s40, 1
    s_cselect_b32 s39, s41, s39
    s_mov_b32 s41, 4
    s_mov_b32 s40, s39
    s_cmp_ge_u32 s39, 4
    s_cselect_b32 s41, 2, s41
    s_add_u32 s42, s39, 76
    s_cmp_ge_u32 s39, 4
    s_cselect_b32 s40, s42, s40
    s_cmp_eq_u32 s39, 6
    s_cselect_b32 s41, 1, s41
    s_cselect_b32 s40, 120, s40
    s_mul_i32 s42, s33, 10
    s_mul_i32 s42, s42, s41
    s_add_u32 s40, s40, s42
    s_mul_i32 s37, s38, 140
    s_add_u32 s37, s37, s40
    s_lshl_b32 s37, s37, 10
    s_add_u32 s47, s37, 24875008
    s_lshl_b32 s51, s41, 10
    v_mov_b32 v12, 0
    v_mov_b32 v13, 0
    v_mov_b32 v14, 0
    v_mov_b32 v15, 0
    v_mov_b32 v16, 0x3f803f80
    s_waitcnt vmcnt(36)
    ds_write_b128 v5, v[32:35] offset:0
    ds_write_b128 v5, v[36:39] offset:1152
    ds_write_b128 v5, v[40:43] offset:2304
    ds_write_b128 v5, v[44:47] offset:3456
    s_waitcnt lgkmcnt(0)
    ds_read_b64_tr_b16 v[200:201], v8 offset:0
    ds_read_b64_tr_b16 v[202:203], v8 offset:576
    ds_read_b64_tr_b16 v[204:205], v8 offset:32
    ds_read_b64_tr_b16 v[206:207], v8 offset:608
    ds_read_b64_tr_b16 v[208:209], v8 offset:64
    ds_read_b64_tr_b16 v[210:211], v8 offset:640
    ds_read_b64_tr_b16 v[212:213], v8 offset:96
    ds_read_b64_tr_b16 v[214:215], v8 offset:672
    s_waitcnt vmcnt(32)
    ds_write_b128 v5, v[48:51] offset:4608
    ds_write_b128 v5, v[52:55] offset:5760
    ds_write_b128 v5, v[56:59] offset:6912
    ds_write_b128 v5, v[60:63] offset:8064
    s_waitcnt lgkmcnt(4)
    buffer_store_dwordx4 v[200:203], v9, s[28:31], s44 offen sc1
    s_add_u32 s44, s44, s48
    v_dot2_f32_bf16 v12, v200, v16, v12
    v_dot2_f32_bf16 v12, v201, v16, v12
    v_dot2_f32_bf16 v12, v202, v16, v12
    v_dot2_f32_bf16 v12, v203, v16, v12
    buffer_store_dwordx4 v[204:207], v9, s[28:31], s45 offen sc1
    s_add_u32 s45, s45, s49
    v_dot2_f32_bf16 v13, v204, v16, v13
    v_dot2_f32_bf16 v13, v205, v16, v13
    v_dot2_f32_bf16 v13, v206, v16, v13
    v_dot2_f32_bf16 v13, v207, v16, v13
    buffer_store_dwordx4 v[208:211], v9, s[28:31], s46 offen sc1
    s_add_u32 s46, s46, s50
    v_dot2_f32_bf16 v14, v208, v16, v14
    v_dot2_f32_bf16 v14, v209, v16, v14
    v_dot2_f32_bf16 v14, v210, v16, v14
    v_dot2_f32_bf16 v14, v211, v16, v14
    buffer_store_dwordx4 v[212:215], v9, s[28:31], s47 offen sc1
    s_add_u32 s47, s47, s51
    v_dot2_f32_bf16 v15, v212, v16, v15
    v_dot2_f32_bf16 v15, v213, v16, v15
    v_dot2_f32_bf16 v15, v214, v16, v15
    v_dot2_f32_bf16 v15, v215, v16, v15
    s_waitcnt lgkmcnt(0)
    ds_read_b64_tr_b16 v[216:217], v8 offset:4608
    ds_read_b64_tr_b16 v[218:219], v8 offset:5184
    ds_read_b64_tr_b16 v[220:221], v8 offset:4640
    ds_read_b64_tr_b16 v[222:223], v8 offset:5216
    ds_read_b64_tr_b16 v[224:225], v8 offset:4672
    ds_read_b64_tr_b16 v[226:227], v8 offset:5248
    ds_read_b64_tr_b16 v[228:229], v8 offset:4704
    ds_read_b64_tr_b16 v[230:231], v8 offset:5280
    s_waitcnt vmcnt(32)
    ds_write_b128 v5, v[64:67] offset:0
    ds_write_b128 v5, v[68:71] offset:1152
    ds_write_b128 v5, v[72:75] offset:2304
    ds_write_b128 v5, v[76:79] offset:3456
    s_waitcnt lgkmcnt(4)
    buffer_store_dwordx4 v[216:219], v9, s[28:31], s44 offen sc1
    s_add_u32 s44, s44, s48
    v_dot2_f32_bf16 v12, v216, v16, v12
    v_dot2_f32_bf16 v12, v217, v16, v12
    v_dot2_f32_bf16 v12, v218, v16, v12
    v_dot2_f32_bf16 v12, v219, v16, v12
    buffer_store_dwordx4 v[220:223], v9, s[28:31], s45 offen sc1
    s_add_u32 s45, s45, s49
    v_dot2_f32_bf16 v13, v220, v16, v13
    v_dot2_f32_bf16 v13, v221, v16, v13
    v_dot2_f32_bf16 v13, v222, v16, v13
    v_dot2_f32_bf16 v13, v223, v16, v13
    buffer_store_dwordx4 v[224:227], v9, s[28:31], s46 offen sc1
    s_add_u32 s46, s46, s50
    v_dot2_f32_bf16 v14, v224, v16, v14
    v_dot2_f32_bf16 v14, v225, v16, v14
    v_dot2_f32_bf16 v14, v226, v16, v14
    v_dot2_f32_bf16 v14, v227, v16, v14
    buffer_store_dwordx4 v[228:231], v9, s[28:31], s47 offen sc1
    s_add_u32 s47, s47, s51
    v_dot2_f32_bf16 v15, v228, v16, v15
    v_dot2_f32_bf16 v15, v229, v16, v15
    v_dot2_f32_bf16 v15, v230, v16, v15
    v_dot2_f32_bf16 v15, v231, v16, v15
    s_waitcnt lgkmcnt(0)
    ds_read_b64_tr_b16 v[200:201], v8 offset:0
    ds_read_b64_tr_b16 v[202:203], v8 offset:576
    ds_read_b64_tr_b16 v[204:205], v8 offset:32
    ds_read_b64_tr_b16 v[206:207], v8 offset:608
    ds_read_b64_tr_b16 v[208:209], v8 offset:64
    ds_read_b64_tr_b16 v[210:211], v8 offset:640
    ds_read_b64_tr_b16 v[212:213], v8 offset:96
    ds_read_b64_tr_b16 v[214:215], v8 offset:672
    s_waitcnt vmcnt(32)
    ds_write_b128 v5, v[80:83] offset:4608
    ds_write_b128 v5, v[84:87] offset:5760
    ds_write_b128 v5, v[88:91] offset:6912
    ds_write_b128 v5, v[92:95] offset:8064
    s_waitcnt lgkmcnt(4)
    buffer_store_dwordx4 v[200:203], v9, s[28:31], s44 offen sc1
    s_add_u32 s44, s44, s48
    v_dot2_f32_bf16 v12, v200, v16, v12
    v_dot2_f32_bf16 v12, v201, v16, v12
    v_dot2_f32_bf16 v12, v202, v16, v12
    v_dot2_f32_bf16 v12, v203, v16, v12
    buffer_store_dwordx4 v[204:207], v9, s[28:31], s45 offen sc1
    s_add_u32 s45, s45, s49
    v_dot2_f32_bf16 v13, v204, v16, v13
    v_dot2_f32_bf16 v13, v205, v16, v13
    v_dot2_f32_bf16 v13, v206, v16, v13
    v_dot2_f32_bf16 v13, v207, v16, v13
    buffer_store_dwordx4 v[208:211], v9, s[28:31], s46 offen sc1
    s_add_u32 s46, s46, s50
    v_dot2_f32_bf16 v14, v208, v16, v14
    v_dot2_f32_bf16 v14, v209, v16, v14
    v_dot2_f32_bf16 v14, v210, v16, v14
    v_dot2_f32_bf16 v14, v211, v16, v14
    buffer_store_dwordx4 v[212:215], v9, s[28:31], s47 offen sc1
    s_add_u32 s47, s47, s51
    v_dot2_f32_bf16 v15, v212, v16, v15
    v_dot2_f32_bf16 v15, v213, v16, v15
    v_dot2_f32_bf16 v15, v214, v16, v15
    v_dot2_f32_bf16 v15, v215, v16, v15
    s_waitcnt lgkmcnt(0)
    ds_read_b64_tr_b16 v[216:217], v8 offset:4608
    ds_read_b64_tr_b16 v[218:219], v8 offset:5184
    ds_read_b64_tr_b16 v[220:221], v8 offset:4640
    ds_read_b64_tr_b16 v[222:223], v8 offset:5216
    ds_read_b64_tr_b16 v[224:225], v8 offset:4672
    ds_read_b64_tr_b16 v[226:227], v8 offset:5248
    ds_read_b64_tr_b16 v[228:229], v8 offset:4704
    ds_read_b64_tr_b16 v[230:231], v8 offset:5280
    s_waitcnt vmcnt(32)
    ds_write_b128 v5, v[96:99] offset:0
    ds_write_b128 v5, v[100:103] offset:1152
    ds_write_b128 v5, v[104:107] offset:2304
    ds_write_b128 v5, v[108:111] offset:3456
    s_waitcnt lgkmcnt(4)
    buffer_store_dwordx4 v[216:219], v9, s[28:31], s44 offen sc1
    s_add_u32 s44, s44, s48
    v_dot2_f32_bf16 v12, v216, v16, v12
    v_dot2_f32_bf16 v12, v217, v16, v12
    v_dot2_f32_bf16 v12, v218, v16, v12
    v_dot2_f32_bf16 v12, v219, v16, v12
    buffer_store_dwordx4 v[220:223], v9, s[28:31], s45 offen sc1
    s_add_u32 s45, s45, s49
    v_dot2_f32_bf16 v13, v220, v16, v13
    v_dot2_f32_bf16 v13, v221, v16, v13
    v_dot2_f32_bf16 v13, v222, v16, v13
    v_dot2_f32_bf16 v13, v223, v16, v13
    buffer_store_dwordx4 v[224:227], v9, s[28:31], s46 offen sc1
    s_add_u32 s46, s46, s50
    v_dot2_f32_bf16 v14, v224, v16, v14
    v_dot2_f32_bf16 v14, v225, v16, v14
    v_dot2_f32_bf16 v14, v226, v16, v14
    v_dot2_f32_bf16 v14, v227, v16, v14
    buffer_store_dwordx4 v[228:231], v9, s[28:31], s47 offen sc1
    s_add_u32 s47, s47, s51
    v_dot2_f32_bf16 v15, v228, v16, v15
    v_dot2_f32_bf16 v15, v229, v16, v15
    v_dot2_f32_bf16 v15, v230, v16, v15
    v_dot2_f32_bf16 v15, v231, v16, v15
    s_waitcnt lgkmcnt(0)
    ds_read_b64_tr_b16 v[200:201], v8 offset:0
    ds_read_b64_tr_b16 v[202:203], v8 offset:576
    ds_read_b64_tr_b16 v[204:205], v8 offset:32
    ds_read_b64_tr_b16 v[206:207], v8 offset:608
    ds_read_b64_tr_b16 v[208:209], v8 offset:64
    ds_read_b64_tr_b16 v[210:211], v8 offset:640
    ds_read_b64_tr_b16 v[212:213], v8 offset:96
    ds_read_b64_tr_b16 v[214:215], v8 offset:672
    s_waitcnt vmcnt(32)
    ds_write_b128 v5, v[112:115] offset:4608
    ds_write_b128 v5, v[116:119] offset:5760
    ds_write_b128 v5, v[120:123] offset:6912
    ds_write_b128 v5, v[124:127] offset:8064
    s_waitcnt lgkmcnt(4)
    buffer_store_dwordx4 v[200:203], v9, s[28:31], s44 offen sc1
    s_add_u32 s44, s44, s48
    v_dot2_f32_bf16 v12, v200, v16, v12
    v_dot2_f32_bf16 v12, v201, v16, v12
    v_dot2_f32_bf16 v12, v202, v16, v12
    v_dot2_f32_bf16 v12, v203, v16, v12
    buffer_store_dwordx4 v[204:207], v9, s[28:31], s45 offen sc1
    s_add_u32 s45, s45, s49
    v_dot2_f32_bf16 v13, v204, v16, v13
    v_dot2_f32_bf16 v13, v205, v16, v13
    v_dot2_f32_bf16 v13, v206, v16, v13
    v_dot2_f32_bf16 v13, v207, v16, v13
    buffer_store_dwordx4 v[208:211], v9, s[28:31], s46 offen sc1
    s_add_u32 s46, s46, s50
    v_dot2_f32_bf16 v14, v208, v16, v14
    v_dot2_f32_bf16 v14, v209, v16, v14
    v_dot2_f32_bf16 v14, v210, v16, v14
    v_dot2_f32_bf16 v14, v211, v16, v14
    buffer_store_dwordx4 v[212:215], v9, s[28:31], s47 offen sc1
    s_add_u32 s47, s47, s51
    v_dot2_f32_bf16 v15, v212, v16, v15
    v_dot2_f32_bf16 v15, v213, v16, v15
    v_dot2_f32_bf16 v15, v214, v16, v15
    v_dot2_f32_bf16 v15, v215, v16, v15
    s_waitcnt lgkmcnt(0)
    ds_read_b64_tr_b16 v[216:217], v8 offset:4608
    ds_read_b64_tr_b16 v[218:219], v8 offset:5184
    ds_read_b64_tr_b16 v[220:221], v8 offset:4640
    ds_read_b64_tr_b16 v[222:223], v8 offset:5216
    ds_read_b64_tr_b16 v[224:225], v8 offset:4672
    ds_read_b64_tr_b16 v[226:227], v8 offset:5248
    ds_read_b64_tr_b16 v[228:229], v8 offset:4704
    ds_read_b64_tr_b16 v[230:231], v8 offset:5280
    s_waitcnt vmcnt(32)
    ds_write_b128 v5, v[128:131] offset:0
    ds_write_b128 v5, v[132:135] offset:1152
    ds_write_b128 v5, v[136:139] offset:2304
    ds_write_b128 v5, v[140:143] offset:3456
    s_waitcnt lgkmcnt(4)
    buffer_store_dwordx4 v[216:219], v9, s[28:31], s44 offen sc1
    s_add_u32 s44, s44, s48
    v_dot2_f32_bf16 v12, v216, v16, v12
    v_dot2_f32_bf16 v12, v217, v16, v12
    v_dot2_f32_bf16 v12, v218, v16, v12
    v_dot2_f32_bf16 v12, v219, v16, v12
    buffer_store_dwordx4 v[220:223], v9, s[28:31], s45 offen sc1
    s_add_u32 s45, s45, s49
    v_dot2_f32_bf16 v13, v220, v16, v13
    v_dot2_f32_bf16 v13, v221, v16, v13
    v_dot2_f32_bf16 v13, v222, v16, v13
    v_dot2_f32_bf16 v13, v223, v16, v13
    buffer_store_dwordx4 v[224:227], v9, s[28:31], s46 offen sc1
    s_add_u32 s46, s46, s50
    v_dot2_f32_bf16 v14, v224, v16, v14
    v_dot2_f32_bf16 v14, v225, v16, v14
    v_dot2_f32_bf16 v14, v226, v16, v14
    v_dot2_f32_bf16 v14, v227, v16, v14
    buffer_store_dwordx4 v[228:231], v9, s[28:31], s47 offen sc1
    s_add_u32 s47, s47, s51
    v_dot2_f32_bf16 v15, v228, v16, v15
    v_dot2_f32_bf16 v15, v229, v16, v15
    v_dot2_f32_bf16 v15, v230, v16, v15
    v_dot2_f32_bf16 v15, v231, v16, v15
    s_waitcnt lgkmcnt(0)
    ds_read_b64_tr_b16 v[200:201], v8 offset:0
    ds_read_b64_tr_b16 v[202:203], v8 offset:576
    ds_read_b64_tr_b16 v[204:205], v8 offset:32
    ds_read_b64_tr_b16 v[206:207], v8 offset:608
    ds_read_b64_tr_b16 v[208:209], v8 offset:64
    ds_read_b64_tr_b16 v[210:211], v8 offset:640
    ds_read_b64_tr_b16 v[212:213], v8 offset:96
    ds_read_b64_tr_b16 v[214:215], v8 offset:672
    s_waitcnt vmcnt(32)
    ds_write_b128 v5, v[144:147] offset:4608
    ds_write_b128 v5, v[148:151] offset:5760
    ds_write_b128 v5, v[152:155] offset:6912
    ds_write_b128 v5, v[156:159] offset:8064
    s_waitcnt lgkmcnt(4)
    buffer_store_dwordx4 v[200:203], v9, s[28:31], s44 offen sc1
    s_add_u32 s44, s44, s48
    v_dot2_f32_bf16 v12, v200, v16, v12
    v_dot2_f32_bf16 v12, v201, v16, v12
    v_dot2_f32_bf16 v12, v202, v16, v12
    v_dot2_f32_bf16 v12, v203, v16, v12
    buffer_store_dwordx4 v[204:207], v9, s[28:31], s45 offen sc1
    s_add_u32 s45, s45, s49
    v_dot2_f32_bf16 v13, v204, v16, v13
    v_dot2_f32_bf16 v13, v205, v16, v13
    v_dot2_f32_bf16 v13, v206, v16, v13
    v_dot2_f32_bf16 v13, v207, v16, v13
    buffer_store_dwordx4 v[208:211], v9, s[28:31], s46 offen sc1
    s_add_u32 s46, s46, s50
    v_dot2_f32_bf16 v14, v208, v16, v14
    v_dot2_f32_bf16 v14, v209, v16, v14
    v_dot2_f32_bf16 v14, v210, v16, v14
    v_dot2_f32_bf16 v14, v211, v16, v14
    buffer_store_dwordx4 v[212:215], v9, s[28:31], s47 offen sc1
    s_add_u32 s47, s47, s51
    v_dot2_f32_bf16 v15, v212, v16, v15
    v_dot2_f32_bf16 v15, v213, v16, v15
    v_dot2_f32_bf16 v15, v214, v16, v15
    v_dot2_f32_bf16 v15, v215, v16, v15
    s_waitcnt lgkmcnt(0)
    ds_read_b64_tr_b16 v[216:217], v8 offset:4608
    ds_read_b64_tr_b16 v[218:219], v8 offset:5184
    ds_read_b64_tr_b16 v[220:221], v8 offset:4640
    ds_read_b64_tr_b16 v[222:223], v8 offset:5216
    ds_read_b64_tr_b16 v[224:225], v8 offset:4672
    ds_read_b64_tr_b16 v[226:227], v8 offset:5248
    ds_read_b64_tr_b16 v[228:229], v8 offset:4704
    ds_read_b64_tr_b16 v[230:231], v8 offset:5280
    s_waitcnt vmcnt(32)
    ds_write_b128 v5, v[160:163] offset:0
    ds_write_b128 v5, v[164:167] offset:1152
    ds_write_b128 v5, v[168:171] offset:2304
    ds_write_b128 v5, v[172:175] offset:3456
    s_waitcnt lgkmcnt(4)
    buffer_store_dwordx4 v[216:219], v9, s[28:31], s44 offen sc1
    s_add_u32 s44, s44, s48
    v_dot2_f32_bf16 v12, v216, v16, v12
    v_dot2_f32_bf16 v12, v217, v16, v12
    v_dot2_f32_bf16 v12, v218, v16, v12
    v_dot2_f32_bf16 v12, v219, v16, v12
    buffer_store_dwordx4 v[220:223], v9, s[28:31], s45 offen sc1
    s_add_u32 s45, s45, s49
    v_dot2_f32_bf16 v13, v220, v16, v13
    v_dot2_f32_bf16 v13, v221, v16, v13
    v_dot2_f32_bf16 v13, v222, v16, v13
    v_dot2_f32_bf16 v13, v223, v16, v13
    buffer_store_dwordx4 v[224:227], v9, s[28:31], s46 offen sc1
    s_add_u32 s46, s46, s50
    v_dot2_f32_bf16 v14, v224, v16, v14
    v_dot2_f32_bf16 v14, v225, v16, v14
    v_dot2_f32_bf16 v14, v226, v16, v14
    v_dot2_f32_bf16 v14, v227, v16, v14
    buffer_store_dwordx4 v[228:231], v9, s[28:31], s47 offen sc1
    s_add_u32 s47, s47, s51
    v_dot2_f32_bf16 v15, v228, v16, v15
    v_dot2_f32_bf16 v15, v229, v16, v15
    v_dot2_f32_bf16 v15, v230, v16, v15
    v_dot2_f32_bf16 v15, v231, v16, v15
    s_waitcnt lgkmcnt(0)
    ds_read_b64_tr_b16 v[200:201], v8 offset:0
    ds_read_b64_tr_b16 v[202:203], v8 offset:576
    ds_read_b64_tr_b16 v[204:205], v8 offset:32
    ds_read_b64_tr_b16 v[206:207], v8 offset:608
    ds_read_b64_tr_b16 v[208:209], v8 offset:64
    ds_read_b64_tr_b16 v[210:211], v8 offset:640
    ds_read_b64_tr_b16 v[212:213], v8 offset:96
    ds_read_b64_tr_b16 v[214:215], v8 offset:672
    s_waitcnt vmcnt(32)
    ds_write_b128 v5, v[176:179] offset:4608
    ds_write_b128 v5, v[180:183] offset:5760
    ds_write_b128 v5, v[184:187] offset:6912
    ds_write_b128 v5, v[188:191] offset:8064
    s_waitcnt lgkmcnt(4)
    buffer_store_dwordx4 v[200:203], v9, s[28:31], s44 offen sc1
    s_add_u32 s44, s44, s48
    v_dot2_f32_bf16 v12, v200, v16, v12
    v_dot2_f32_bf16 v12, v201, v16, v12
    v_dot2_f32_bf16 v12, v202, v16, v12
    v_dot2_f32_bf16 v12, v203, v16, v12
    buffer_store_dwordx4 v[204:207], v9, s[28:31], s45 offen sc1
    s_add_u32 s45, s45, s49
    v_dot2_f32_bf16 v13, v204, v16, v13
    v_dot2_f32_bf16 v13, v205, v16, v13
    v_dot2_f32_bf16 v13, v206, v16, v13
    v_dot2_f32_bf16 v13, v207, v16, v13
    buffer_store_dwordx4 v[208:211], v9, s[28:31], s46 offen sc1
    s_add_u32 s46, s46, s50
    v_dot2_f32_bf16 v14, v208, v16, v14
    v_dot2_f32_bf16 v14, v209, v16, v14
    v_dot2_f32_bf16 v14, v210, v16, v14
    v_dot2_f32_bf16 v14, v211, v16, v14
    buffer_store_dwordx4 v[212:215], v9, s[28:31], s47 offen sc1
    s_add_u32 s47, s47, s51
    v_dot2_f32_bf16 v15, v212, v16, v15
    v_dot2_f32_bf16 v15, v213, v16, v15
    v_dot2_f32_bf16 v15, v214, v16, v15
    v_dot2_f32_bf16 v15, v215, v16, v15
    s_waitcnt lgkmcnt(0)
    ds_read_b64_tr_b16 v[216:217], v8 offset:4608
    ds_read_b64_tr_b16 v[218:219], v8 offset:5184
    ds_read_b64_tr_b16 v[220:221], v8 offset:4640
    ds_read_b64_tr_b16 v[222:223], v8 offset:5216
    ds_read_b64_tr_b16 v[224:225], v8 offset:4672
    ds_read_b64_tr_b16 v[226:227], v8 offset:5248
    ds_read_b64_tr_b16 v[228:229], v8 offset:4704
    ds_read_b64_tr_b16 v[230:231], v8 offset:5280
    s_waitcnt lgkmcnt(0)
    buffer_store_dwordx4 v[216:219], v9, s[28:31], s44 offen sc1
    s_add_u32 s44, s44, s48
    v_dot2_f32_bf16 v12, v216, v16, v12
    v_dot2_f32_bf16 v12, v217, v16, v12
    v_dot2_f32_bf16 v12, v218, v16, v12
    v_dot2_f32_bf16 v12, v219, v16, v12
    buffer_store_dwordx4 v[220:223], v9, s[28:31], s45 offen sc1
    s_add_u32 s45, s45, s49
    v_dot2_f32_bf16 v13, v220, v16, v13
    v_dot2_f32_bf16 v13, v221, v16, v13
    v_dot2_f32_bf16 v13, v222, v16, v13
    v_dot2_f32_bf16 v13, v223, v16, v13
    buffer_store_dwordx4 v[224:227], v9, s[28:31], s46 offen sc1
    s_add_u32 s46, s46, s50
    v_dot2_f32_bf16 v14, v224, v16, v14
    v_dot2_f32_bf16 v14, v225, v16, v14
    v_dot2_f32_bf16 v14, v226, v16, v14
    v_dot2_f32_bf16 v14, v227, v16, v14
    buffer_store_dwordx4 v[228:231], v9, s[28:31], s47 offen sc1
    s_add_u32 s47, s47, s51
    v_dot2_f32_bf16 v15, v228, v16, v15
    v_dot2_f32_bf16 v15, v229, v16, v15
    v_dot2_f32_bf16 v15, v230, v16, v15
    v_dot2_f32_bf16 v15, v231, v16, v15
    s_nop 2
    v_mov_b32 v20, v12
    v_mov_b32 v21, v13
    v_mov_b32 v22, v14
    v_mov_b32 v23, v15
    s_nop 1
    v_permlane32_swap_b32 v20, v12
    v_permlane32_swap_b32 v21, v13
    v_permlane32_swap_b32 v22, v14
    v_permlane32_swap_b32 v23, v15
    s_nop 1
    v_add_f32 v12, v12, v20
    v_add_f32 v13, v13, v21
    v_add_f32 v14, v14, v22
    v_add_f32 v15, v15, v23
    v_mov_b32 v20, v12
    v_mov_b32 v21, v13
    v_mov_b32 v22, v14
    v_mov_b32 v23, v15
    s_nop 1
    v_permlane16_swap_b32 v20, v12
    v_permlane16_swap_b32 v21, v13
    v_permlane16_swap_b32 v22, v14
    v_permlane16_swap_b32 v23, v15
    s_nop 1
    v_add_f32 v12, v12, v20
    v_add_f32 v13, v13, v21
    v_add_f32 v14, v14, v22
    v_add_f32 v15, v15, v23
    s_mul_i32 s38, s33, 7168
    s_lshl_b32 s39, s35, 8
    s_add_u32 s38, s38, s39
    s_add_u32 s38, s38, 8130560
    v_lshlrev_b32 v17, 2, v1
    s_mov_b64 exec, 0xffff
    buffer_store_dword v12, v17, s[28:31], s38 offen offset:0 sc1
    buffer_store_dword v13, v17, s[28:31], s38 offen offset:64 sc1
    buffer_store_dword v14, v17, s[28:31], s38 offen offset:128 sc1
    buffer_store_dword v15, v17, s[28:31], s38 offen offset:192 sc1
    s_endpgm
k1_kernel_pk8:
    s_mov_b32 s24, s18
    s_mov_b32 s25, s19
    s_mov_b32 s26, 2211840
    s_mov_b32 s27, 0x00020000
    s_sub_u32 s32, s21, 94
    s_mul_i32 s33, s32, 52429
    s_lshr_b32 s33, s33, 19
    s_mul_i32 s35, s33, 10
    s_sub_u32 s35, s32, s35
    v_mul_u32_u24 v10, 1280, v3
    v_lshl_add_u32 v10, v4, 4, v10
    s_mul_i32 s36, s33, 368640
    s_lshl_b32 s37, s35, 7
    s_add_u32 s36, s36, s37
    buffer_load_dwordx4 v[32:35], v10, s[24:27], s36 offen nt
    s_add_u32 s36, s36, 10240
    buffer_load_dwordx4 v[36:39], v10, s[24:27], s36 offen nt
    s_add_u32 s36, s36, 10240
    buffer_load_dwordx4 v[40:43], v10, s[24:27], s36 offen nt
    s_add_u32 s36, s36, 10240
    buffer_load_dwordx4 v[44:47], v10, s[24:27], s36 offen nt
    s_add_u32 s36, s36, 10240
    buffer_load_dwordx4 v[48:51], v10, s[24:27], s36 offen nt
    s_add_u32 s36, s36, 10240
    buffer_load_dwordx4 v[52:55], v10, s[24:27], s36 offen nt
    s_add_u32 s36, s36, 10240
    buffer_load_dwordx4 v[56:59], v10, s[24:27], s36 offen nt
    s_add_u32 s36, s36, 10240
    buffer_load_dwordx4 v[60:63], v10, s[24:27], s36 offen nt
    s_add_u32 s36, s36, 10240
    buffer_load_dwordx4 v[64:67], v10, s[24:27], s36 offen nt
    s_add_u32 s36, s36, 10240
    buffer_load_dwordx4 v[68:71], v10, s[24:27], s36 offen nt
    s_add_u32 s36, s36, 10240
    buffer_load_dwordx4 v[72:75], v10, s[24:27], s36 offen nt
    s_add_u32 s36, s36, 10240
    buffer_load_dwordx4 v[76:79], v10, s[24:27], s36 offen nt
    s_add_u32 s36, s36, 10240
    buffer_load_dwordx4 v[80:83], v10, s[24:27], s36 offen nt
    s_add_u32 s36, s36, 10240
    buffer_load_dwordx4 v[84:87], v10, s[24:27], s36 offen nt
    s_add_u32 s36, s36, 10240
    buffer_load_dwordx4 v[88:91], v10, s[24:27], s36 offen nt
    s_add_u32 s36, s36, 10240
    buffer_load_dwordx4 v[92:95], v10, s[24:27], s36 offen nt
    s_add_u32 s36, s36, 10240
    buffer_load_dwordx4 v[96:99], v10, s[24:27], s36 offen nt
    s_add_u32 s36, s36, 10240
    buffer_load_dwordx4 v[100:103], v10, s[24:27], s36 offen nt
    s_add_u32 s36, s36, 10240
    buffer_load_dwordx4 v[104:107], v10, s[24:27], s36 offen nt
    s_add_u32 s36, s36, 10240
    buffer_load_dwordx4 v[108:111], v10, s[24:27], s36 offen nt
    s_add_u32 s36, s36, 10240
    buffer_load_dwordx4 v[112:115], v10, s[24:27], s36 offen nt
    s_add_u32 s36, s36, 10240
    buffer_load_dwordx4 v[116:119], v10, s[24:27], s36 offen nt
    s_add_u32 s36, s36, 10240
    buffer_load_dwordx4 v[120:123], v10, s[24:27], s36 offen nt
    s_add_u32 s36, s36, 10240
    buffer_load_dwordx4 v[124:127], v10, s[24:27], s36 offen nt
    s_add_u32 s36, s36, 10240
    buffer_load_dwordx4 v[128:131], v10, s[24:27], s36 offen nt
    s_add_u32 s36, s36, 10240
    buffer_load_dwordx4 v[132:135], v10, s[24:27], s36 offen nt
    s_add_u32 s36, s36, 10240
    buffer_load_dwordx4 v[136:139], v10, s[24:27], s36 offen nt
    s_add_u32 s36, s36, 10240
    buffer_load_dwordx4 v[140:143], v10, s[24:27], s36 offen nt
    s_add_u32 s36, s36, 10240
    buffer_load_dwordx4 v[144:147], v10, s[24:27], s36 offen nt
    s_add_u32 s36, s36, 10240
    buffer_load_dwordx4 v[148:151], v10, s[24:27], s36 offen nt
    s_add_u32 s36, s36, 10240
    buffer_load_dwordx4 v[152:155], v10, s[24:27], s36 offen nt
    s_add_u32 s36, s36, 10240
    buffer_load_dwordx4 v[156:159], v10, s[24:27], s36 offen nt
    s_add_u32 s36, s36, 10240
    buffer_load_dwordx4 v[160:163], v10, s[24:27], s36 offen nt
    s_add_u32 s36, s36, 10240
    buffer_load_dwordx4 v[164:167], v10, s[24:27], s36 offen nt
    s_add_u32 s36, s36, 10240
    buffer_load_dwordx4 v[168:171], v10, s[24:27], s36 offen nt
    s_add_u32 s36, s36, 10240
    buffer_load_dwordx4 v[172:175], v10, s[24:27], s36 offen nt
    s_lshl_b32 s36, s35, 2
    s_add_u32 s36, s36, 0
    s_mul_i32 s38, s36, 13108
    s_lshr_b32 s38, s38, 16
    s_mul_i32 s39, s38, 5
    s_sub_u32 s39, s36, s39
    s_sub_u32 s41, s39, 1
    s_cmp_eq_u32 s39, 0
    s_cselect_b32 s41, 4, s41
    s_and_b32 s40, s38, 1
    s_cmp_eq_u32 s40, 1
    s_cselect_b32 s39, s41, s39
    s_mul_i32 s40, s33, 21846
    s_lshr_b32 s40, s40, 16
    s_mul_i32 s41, s40, 3
    s_sub_u32 s41, s33, s41
    s_mul_i32 s37, s38, 270
    s_mul_i32 s41, s41, 90
    s_add_u32 s37, s37, s41
    s_mul_i32 s40, s40, 5
    s_add_u32 s37, s37, s40
    s_add_u32 s37, s37, s39
    s_lshl_b32 s37, s37, 10
    s_add_u32 s44, s37, 27168768
    s_movk_i32 s48, 10240
    s_lshl_b32 s36, s35, 2
    s_add_u32 s36, s36, 1
    s_mul_i32 s38, s36, 13108
    s_lshr_b32 s38, s38, 16
    s_mul_i32 s39, s38, 5
    s_sub_u32 s39, s36, s39
    s_sub_u32 s41, s39, 1
    s_cmp_eq_u32 s39, 0
    s_cselect_b32 s41, 4, s41
    s_and_b32 s40, s38, 1
    s_cmp_eq_u32 s40, 1
    s_cselect_b32 s39, s41, s39
    s_mul_i32 s40, s33, 21846
    s_lshr_b32 s40, s40, 16
    s_mul_i32 s41, s40, 3
    s_sub_u32 s41, s33, s41
    s_mul_i32 s37, s38, 270
    s_mul_i32 s41, s41, 90
    s_add_u32 s37, s37, s41
    s_mul_i32 s40, s40, 5
    s_add_u32 s37, s37, s40
    s_add_u32 s37, s37, s39
    s_lshl_b32 s37, s37, 10
    s_add_u32 s45, s37, 27168768
    s_movk_i32 s49, 10240
    s_lshl_b32 s36, s35, 2
    s_add_u32 s36, s36, 2
    s_mul_i32 s38, s36, 13108
    s_lshr_b32 s38, s38, 16
    s_mul_i32 s39, s38, 5
    s_sub_u32 s39, s36, s39
    s_sub_u32 s41, s39, 1
    s_cmp_eq_u32 s39, 0
    s_cselect_b32 s41, 4, s41
    s_and_b32 s40, s38, 1
    s_cmp_eq_u32 s40, 1
    s_cselect_b32 s39, s41, s39
    s_mul_i32 s40, s33, 21846
    s_lshr_b32 s40, s40, 16
    s_mul_i32 s41, s40, 3
    s_sub_u32 s41, s33, s41
    s_mul_i32 s37, s38, 270
    s_mul_i32 s41, s41, 90
    s_add_u32 s37, s37, s41
    s_mul_i32 s40, s40, 5
    s_add_u32 s37, s37, s40
    s_add_u32 s37, s37, s39
    s_lshl_b32 s37, s37, 10
    s_add_u32 s46, s37, 27168768
    s_movk_i32 s50, 10240
    s_lshl_b32 s36, s35, 2
    s_add_u32 s36, s36, 3
    s_mul_i32 s38, s36, 13108
    s_lshr_b32 s38, s38, 16
    s_mul_i32 s39, s38, 5
    s_sub_u32 s39, s36, s39
    s_sub_u32 s41, s39, 1
    s_cmp_eq_u32 s39, 0
    s_cselect_b32 s41, 4, s41
    s_and_b32 s40, s38, 1
    s_cmp_eq_u32 s40, 1
    s_cselect_b32 s39, s41, s39
    s_mul_i32 s40, s33, 21846
    s_lshr_b32 s40, s40, 16
    s_mul_i32 s41, s40, 3
    s_sub_u32 s41, s33, s41
    s_mul_i32 s37, s38, 270
    s_mul_i32 s41, s41, 90
    s_add_u32 s37, s37, s41
    s_mul_i32 s40, s40, 5
    s_add_u32 s37, s37, s40
    s_add_u32 s37, s37, s39
    s_lshl_b32 s37, s37, 10
    s_add_u32 s47, s37, 27168768
    s_movk_i32 s51, 10240
    s_waitcnt vmcnt(32)
    ds_write_b128 v5, v[32:35] offset:0
    ds_write_b128 v5, v[36:39] offset:1152
    ds_write_b128 v5, v[40:43] offset:2304
    ds_write_b128 v5, v[44:47] offset:3456
    s_waitcnt lgkmcnt(0)
    ds_read_b64_tr_b16 v[200:201], v8 offset:0
    ds_read_b64_tr_b16 v[202:203], v8 offset:576
    ds_read_b64_tr_b16 v[204:205], v8 offset:32
    ds_read_b64_tr_b16 v[206:207], v8 offset:608
    ds_read_b64_tr_b16 v[208:209], v8 offset:64
    ds_read_b64_tr_b16 v[210:211], v8 offset:640
    ds_read_b64_tr_b16 v[212:213], v8 offset:96
    ds_read_b64_tr_b16 v[214:215], v8 offset:672
    s_waitcnt vmcnt(28)
    ds_write_b128 v5, v[48:51] offset:4608
    ds_write_b128 v5, v[52:55] offset:5760
    ds_write_b128 v5, v[56:59] offset:6912
    ds_write_b128 v5, v[60:63] offset:8064
    s_waitcnt lgkmcnt(4)
    buffer_store_dwordx4 v[200:203], v9, s[28:31], s44 offen sc1
    s_add_u32 s44, s44, s48
    buffer_store_dwordx4 v[204:207], v9, s[28:31], s45 offen sc1
    s_add_u32 s45, s45, s49
    buffer_store_dwordx4 v[208:211], v9, s[28:31], s46 offen sc1
    s_add_u32 s46, s46, s50
    buffer_store_dwordx4 v[212:215], v9, s[28:31], s47 offen sc1
    s_add_u32 s47, s47, s51
    s_waitcnt lgkmcnt(0)
    ds_read_b64_tr_b16 v[216:217], v8 offset:4608
    ds_read_b64_tr_b16 v[218:219], v8 offset:5184
    ds_read_b64_tr_b16 v[220:221], v8 offset:4640
    ds_read_b64_tr_b16 v[222:223], v8 offset:5216
    ds_read_b64_tr_b16 v[224:225], v8 offset:4672
    ds_read_b64_tr_b16 v[226:227], v8 offset:5248
    ds_read_b64_tr_b16 v[228:229], v8 offset:4704
    ds_read_b64_tr_b16 v[230:231], v8 offset:5280
    s_waitcnt vmcnt(28)
    ds_write_b128 v5, v[64:67] offset:0
    ds_write_b128 v5, v[68:71] offset:1152
    ds_write_b128 v5, v[72:75] offset:2304
    ds_write_b128 v5, v[76:79] offset:3456
    s_waitcnt lgkmcnt(4)
    buffer_store_dwordx4 v[216:219], v9, s[28:31], s44 offen sc1
    s_add_u32 s44, s44, s48
    buffer_store_dwordx4 v[220:223], v9, s[28:31], s45 offen sc1
    s_add_u32 s45, s45, s49
    buffer_store_dwordx4 v[224:227], v9, s[28:31], s46 offen sc1
    s_add_u32 s46, s46, s50
    buffer_store_dwordx4 v[228:231], v9, s[28:31], s47 offen sc1
    s_add_u32 s47, s47, s51
    s_waitcnt lgkmcnt(0)
    ds_read_b64_tr_b16 v[200:201], v8 offset:0
    ds_read_b64_tr_b16 v[202:203], v8 offset:576
    ds_read_b64_tr_b16 v[204:205], v8 offset:32
    ds_read_b64_tr_b16 v[206:207], v8 offset:608
    ds_read_b64_tr_b16 v[208:209], v8 offset:64
    ds_read_b64_tr_b16 v[210:211], v8 offset:640
    ds_read_b64_tr_b16 v[212:213], v8 offset:96
    ds_read_b64_tr_b16 v[214:215], v8 offset:672
    s_waitcnt vmcnt(28)
    ds_write_b128 v5, v[80:83] offset:4608
    ds_write_b128 v5, v[84:87] offset:5760
    ds_write_b128 v5, v[88:91] offset:6912
    ds_write_b128 v5, v[92:95] offset:8064
    s_waitcnt lgkmcnt(4)
    buffer_store_dwordx4 v[200:203], v9, s[28:31], s44 offen sc1
    s_add_u32 s44, s44, s48
    buffer_store_dwordx4 v[204:207], v9, s[28:31], s45 offen sc1
    s_add_u32 s45, s45, s49
    buffer_store_dwordx4 v[208:211], v9, s[28:31], s46 offen sc1
    s_add_u32 s46, s46, s50
    buffer_store_dwordx4 v[212:215], v9, s[28:31], s47 offen sc1
    s_add_u32 s47, s47, s51
    s_waitcnt lgkmcnt(0)
    ds_read_b64_tr_b16 v[216:217], v8 offset:4608
    ds_read_b64_tr_b16 v[218:219], v8 offset:5184
    ds_read_b64_tr_b16 v[220:221], v8 offset:4640
    ds_read_b64_tr_b16 v[222:223], v8 offset:5216
    ds_read_b64_tr_b16 v[224:225], v8 offset:4672
    ds_read_b64_tr_b16 v[226:227], v8 offset:5248
    ds_read_b64_tr_b16 v[228:229], v8 offset:4704
    ds_read_b64_tr_b16 v[230:231], v8 offset:5280
    s_waitcnt vmcnt(28)
    ds_write_b128 v5, v[96:99] offset:0
    ds_write_b128 v5, v[100:103] offset:1152
    ds_write_b128 v5, v[104:107] offset:2304
    ds_write_b128 v5, v[108:111] offset:3456
    s_waitcnt lgkmcnt(4)
    buffer_store_dwordx4 v[216:219], v9, s[28:31], s44 offen sc1
    s_add_u32 s44, s44, s48
    buffer_store_dwordx4 v[220:223], v9, s[28:31], s45 offen sc1
    s_add_u32 s45, s45, s49
    buffer_store_dwordx4 v[224:227], v9, s[28:31], s46 offen sc1
    s_add_u32 s46, s46, s50
    buffer_store_dwordx4 v[228:231], v9, s[28:31], s47 offen sc1
    s_add_u32 s47, s47, s51
    s_waitcnt lgkmcnt(0)
    ds_read_b64_tr_b16 v[200:201], v8 offset:0
    ds_read_b64_tr_b16 v[202:203], v8 offset:576
    ds_read_b64_tr_b16 v[204:205], v8 offset:32
    ds_read_b64_tr_b16 v[206:207], v8 offset:608
    ds_read_b64_tr_b16 v[208:209], v8 offset:64
    ds_read_b64_tr_b16 v[210:211], v8 offset:640
    ds_read_b64_tr_b16 v[212:213], v8 offset:96
    ds_read_b64_tr_b16 v[214:215], v8 offset:672
    s_waitcnt vmcnt(28)
    ds_write_b128 v5, v[112:115] offset:4608
    ds_write_b128 v5, v[116:119] offset:5760
    ds_write_b128 v5, v[120:123] offset:6912
    ds_write_b128 v5, v[124:127] offset:8064
    s_waitcnt lgkmcnt(4)
    buffer_store_dwordx4 v[200:203], v9, s[28:31], s44 offen sc1
    s_add_u32 s44, s44, s48
    buffer_store_dwordx4 v[204:207], v9, s[28:31], s45 offen sc1
    s_add_u32 s45, s45, s49
    buffer_store_dwordx4 v[208:211], v9, s[28:31], s46 offen sc1
    s_add_u32 s46, s46, s50
    buffer_store_dwordx4 v[212:215], v9, s[28:31], s47 offen sc1
    s_add_u32 s47, s47, s51
    s_waitcnt lgkmcnt(0)
    ds_read_b64_tr_b16 v[216:217], v8 offset:4608
    ds_read_b64_tr_b16 v[218:219], v8 offset:5184
    ds_read_b64_tr_b16 v[220:221], v8 offset:4640
    ds_read_b64_tr_b16 v[222:223], v8 offset:5216
    ds_read_b64_tr_b16 v[224:225], v8 offset:4672
    ds_read_b64_tr_b16 v[226:227], v8 offset:5248
    ds_read_b64_tr_b16 v[228:229], v8 offset:4704
    ds_read_b64_tr_b16 v[230:231], v8 offset:5280
    s_waitcnt vmcnt(28)
    ds_write_b128 v5, v[128:131] offset:0
    ds_write_b128 v5, v[132:135] offset:1152
    ds_write_b128 v5, v[136:139] offset:2304
    ds_write_b128 v5, v[140:143] offset:3456
    s_waitcnt lgkmcnt(4)
    buffer_store_dwordx4 v[216:219], v9, s[28:31], s44 offen sc1
    s_add_u32 s44, s44, s48
    buffer_store_dwordx4 v[220:223], v9, s[28:31], s45 offen sc1
    s_add_u32 s45, s45, s49
    buffer_store_dwordx4 v[224:227], v9, s[28:31], s46 offen sc1
    s_add_u32 s46, s46, s50
    buffer_store_dwordx4 v[228:231], v9, s[28:31], s47 offen sc1
    s_add_u32 s47, s47, s51
    s_waitcnt lgkmcnt(0)
    ds_read_b64_tr_b16 v[200:201], v8 offset:0
    ds_read_b64_tr_b16 v[202:203], v8 offset:576
    ds_read_b64_tr_b16 v[204:205], v8 offset:32
    ds_read_b64_tr_b16 v[206:207], v8 offset:608
    ds_read_b64_tr_b16 v[208:209], v8 offset:64
    ds_read_b64_tr_b16 v[210:211], v8 offset:640
    ds_read_b64_tr_b16 v[212:213], v8 offset:96
    ds_read_b64_tr_b16 v[214:215], v8 offset:672
    s_waitcnt vmcnt(28)
    ds_write_b128 v5, v[144:147] offset:4608
    ds_write_b128 v5, v[148:151] offset:5760
    ds_write_b128 v5, v[152:155] offset:6912
    ds_write_b128 v5, v[156:159] offset:8064
    s_waitcnt lgkmcnt(4)
    buffer_store_dwordx4 v[200:203], v9, s[28:31], s44 offen sc1
    s_add_u32 s44, s44, s48
    buffer_store_dwordx4 v[204:207], v9, s[28:31], s45 offen sc1
    s_add_u32 s45, s45, s49
    buffer_store_dwordx4 v[208:211], v9, s[28:31], s46 offen sc1
    s_add_u32 s46, s46, s50
    buffer_store_dwordx4 v[212:215], v9, s[28:31], s47 offen sc1
    s_add_u32 s47, s47, s51
    s_waitcnt lgkmcnt(0)
    ds_read_b64_tr_b16 v[216:217], v8 offset:4608
    ds_read_b64_tr_b16 v[218:219], v8 offset:5184
    ds_read_b64_tr_b16 v[220:221], v8 offset:4640
    ds_read_b64_tr_b16 v[222:223], v8 offset:5216
    ds_read_b64_tr_b16 v[224:225], v8 offset:4672
    ds_read_b64_tr_b16 v[226:227], v8 offset:5248
    ds_read_b64_tr_b16 v[228:229], v8 offset:4704
    ds_read_b64_tr_b16 v[230:231], v8 offset:5280
    s_waitcnt vmcnt(28)
    ds_write_b128 v5, v[160:163] offset:0
    ds_write_b128 v5, v[164:167] offset:1152
    ds_write_b128 v5, v[168:171] offset:2304
    ds_write_b128 v5, v[172:175] offset:3456
    s_waitcnt lgkmcnt(4)
    buffer_store_dwordx4 v[216:219], v9, s[28:31], s44 offen sc1
    s_add_u32 s44, s44, s48
    buffer_store_dwordx4 v[220:223], v9, s[28:31], s45 offen sc1
    s_add_u32 s45, s45, s49
    buffer_store_dwordx4 v[224:227], v9, s[28:31], s46 offen sc1
    s_add_u32 s46, s46, s50
    buffer_store_dwordx4 v[228:231], v9, s[28:31], s47 offen sc1
    s_add_u32 s47, s47, s51
    s_waitcnt lgkmcnt(0)
    ds_read_b64_tr_b16 v[200:201], v8 offset:0
    ds_read_b64_tr_b16 v[202:203], v8 offset:576
    ds_read_b64_tr_b16 v[204:205], v8 offset:32
    ds_read_b64_tr_b16 v[206:207], v8 offset:608
    ds_read_b64_tr_b16 v[208:209], v8 offset:64
    ds_read_b64_tr_b16 v[210:211], v8 offset:640
    ds_read_b64_tr_b16 v[212:213], v8 offset:96
    ds_read_b64_tr_b16 v[214:215], v8 offset:672
    s_waitcnt lgkmcnt(0)
    buffer_store_dwordx4 v[200:203], v9, s[28:31], s44 offen sc1
    s_add_u32 s44, s44, s48
    buffer_store_dwordx4 v[204:207], v9, s[28:31], s45 offen sc1
    s_add_u32 s45, s45, s49
    buffer_store_dwordx4 v[208:211], v9, s[28:31], s46 offen sc1
    s_add_u32 s46, s46, s50
    buffer_store_dwordx4 v[212:215], v9, s[28:31], s47 offen sc1
    s_add_u32 s47, s47, s51
    s_endpgm
k1_end:
    s_endpgm
.globl chain_kernel
.p2align 8
.type chain_kernel,@function
chain_kernel:
    s_cmp_ge_u32 s2, 256
    s_cbranch_scc1 chain_end
    s_load_dwordx2 s[4:5], s[0:1], 0
    s_load_dwordx2 s[6:7], s[0:1], 104
    s_load_dwordx2 s[10:11], s[0:1], 120
    v_lshrrev_b32 v2, 6, v0
    v_and_b32 v1, 63, v0
    v_readfirstlane_b32 s20, v2
    s_and_b32 s25, s2, 7
    s_lshr_b32 s26, s2, 3
    s_lshl_b32 s23, s25, 3
    s_lshr_b32 s27, s26, 2
    s_add_u32 s23, s23, s27
    s_and_b32 s24, s26, 3
    s_and_b32 s21, s20, 1
    s_lshr_b32 s22, s20, 1
    v_lshrrev_b32 v3, 4, v1
    v_and_b32 v4, 15, v1
    v_lshlrev_b32 v8, 4, v1
    s_waitcnt lgkmcnt(0)
    s_mov_b32 s28, s10
    s_mov_b32 s29, s11
    s_mov_b32 s30, 268435456
    s_mov_b32 s31, 0x00020000
    s_mul_i32 s25, s20, 10240
    s_add_u32 s10, s25, 0
    s_mul_i32 s11, s23, 40960
    s_add_u32 s11, s11, s25
    s_add_u32 s11, s11, 5492736
    s_lshl_b32 s12, s20, 10
    s_add_u32 s13, s12, 8121856
    s_add_u32 s12, s12, 130560
    s_lshl_b32 s14, s21, 10
    s_add_u32 s14, s14, 139264
    s_mul_i32 s15, s21, 7168
    s_mul_i32 s25, s24, 640
    s_add_u32 s15, s15, s25
    s_add_u32 s15, s15, 8146944
    s_mov_b32 m0, s10
    s_add_u32 s10, s10, 4096
    buffer_load_dwordx4 v8, s[28:31], s11 offen offset:0 lds
    buffer_load_dwordx4 v8, s[28:31], s11 offen offset:1024 lds
    buffer_load_dwordx4 v8, s[28:31], s11 offen offset:2048 lds
    buffer_load_dwordx4 v8, s[28:31], s11 offen offset:3072 lds
    s_add_u32 s11, s11, 4096
    s_mov_b32 m0, s10
    s_add_u32 s10, s10, 4096
    buffer_load_dwordx4 v8, s[28:31], s11 offen offset:0 lds
    buffer_load_dwordx4 v8, s[28:31], s11 offen offset:1024 lds
    buffer_load_dwordx4 v8, s[28:31], s11 offen offset:2048 lds
    buffer_load_dwordx4 v8, s[28:31], s11 offen offset:3072 lds
    s_add_u32 s11, s11, 4096
    s_mov_b32 m0, s10
    s_add_u32 s10, s10, 4096
    buffer_load_dwordx4 v8, s[28:31], s11 offen offset:0 lds
    buffer_load_dwordx4 v8, s[28:31], s11 offen offset:1024 lds
    s_mov_b32 m0, s12
    s_nop 0
    buffer_load_dwordx4 v8, s[28:31], s13 offen lds
    s_mov_b32 m0, 134656
    s_mov_b32 s13, 8125952
    buffer_load_dwordx4 v8, s[28:31], s13 offen lds
    s_mov_b32 m0, s14
    s_nop 0
    buffer_load_dwordx4 v8, s[28:31], s15 offen lds
    s_mov_b32 s32, s6
    s_mov_b32 s33, s7
    s_mov_b32 s34, 2621440
    s_mov_b32 s35, 0x00020000
    s_mul_i32 s36, s24, 200
    s_mul_i32 s37, s21, 100
    s_add_u32 s36, s36, s37
    s_mul_i32 s37, s22, 50
    s_add_u32 s36, s36, s37
    s_lshl_b32 s36, s36, 10
    s_add_u32 s37, s36, 24055808
    s_add_u32 s36, s36, 23236608
    v_lshrrev_b32 v2, 1, v3
    s_lshl_b32 s26, s21, 2
    v_add_u32 v2, s26, v2
    v_and_b32 v7, 7, v4
    buffer_load_dwordx4 a[0:3], v8, s[28:31], s36 offen offset:0
    v_xor_b32 v2, v2, v7
    v_lshlrev_b32 v2, 4, v2
    v_lshl_add_u32 v226, v4, 8, v2
    v_and_b32 v2, 1, v3
    v_lshl_add_u32 v226, v2, 3, v226
    s_mul_i32 s26, s22, 20480
    s_add_u32 s27, s26, 0
    v_add_u32 v226, s27, v226
    v_lshlrev_b32 v227, 5, v4
    v_add_u32 v227, 122880, v227
    s_lshl_b32 s27, s21, 3
    v_add_u32 v2, s27, v3
    v_xor_b32 v2, v2, v7
    v_lshlrev_b32 v2, 4, v2
    v_and_b32 v7, 3, v4
    v_lshl_add_u32 v2, v7, 8, v2
    v_lshrrev_b32 v7, 2, v4
    buffer_load_dwordx4 a[4:7], v8, s[28:31], s36 offen offset:1024
    v_lshl_add_u32 v2, v7, 10, v2
    s_add_u32 s27, s26, 40960
    v_add_u32 v228, s27, v2
    v_xor_b32 v2, v4, v3
    v_lshlrev_b32 v2, 4, v2
    v_lshl_add_u32 v2, v3, 8, v2
    v_xor_b32 v7, 64, v2
    s_mul_i32 s26, s22, 30720
    s_add_u32 s26, s26, 40960
    s_mul_i32 s27, s22, 10240
    s_sub_u32 s27, 61440, s27
    v_add_u32 v229, s26, v2
    v_add_u32 v230, s26, v7
    v_add_u32 v231, s27, v2
    v_add_u32 v232, s27, v7
    v_lshlrev_b32 v2, 4, v3
    s_mul_i32 s26, s21, 384
    buffer_load_dwordx4 a[8:11], v8, s[28:31], s36 offen offset:2048
    s_add_u32 s26, s26, 139264
    v_add_u32 v233, s26, v2
    s_mul_i32 s26, s21, 64
    s_add_u32 s26, s26, 139520
    v_add_u32 v234, s26, v2
    s_lshl_b32 s26, s22, 7
    s_add_u32 s26, s26, 138240
    v_lshl_add_u32 v235, v4, 3, s26
    s_mul_i32 s39, s24, 5
    s_mul_i32 s40, s21, 3
    s_add_u32 s40, s40, s39
    s_add_u32 s41, s39, 2
    v_lshrrev_b32 v12, 1, v3
    v_and_b32 v13, 1, v3
    v_lshlrev_b32 v13, 3, v13
    s_add_u32 s26, s40, 0
    buffer_load_dwordx4 a[12:15], v8, s[28:31], s36 offen offset:3072
    v_add_u32 v14, 0, v12
    s_and_b32 s27, s26, 1
    s_lshl_b32 s27, s27, 2
    v_add_u32 v15, s27, v14
    v_xor_b32 v15, v15, v4
    v_lshlrev_b32 v15, 4, v15
    v_lshl_add_u32 v15, v14, 8, v15
    v_add_u32 v15, v15, v13
    s_mul_i32 s27, s22, 20
    s_add_u32 s27, s27, s26
    s_lshl_b32 s27, s27, 10
    s_add_u32 s27, s27, 40960
    v_add_u32 v236, s27, v15
    s_add_u32 s26, s40, 0
    v_add_u32 v14, 2, v12
    s_and_b32 s27, s26, 1
    s_lshl_b32 s27, s27, 2
    s_add_u32 s36, s36, 4096
    buffer_load_dwordx4 a[16:19], v8, s[28:31], s36 offen offset:0
    v_add_u32 v15, s27, v14
    v_xor_b32 v15, v15, v4
    v_lshlrev_b32 v15, 4, v15
    v_lshl_add_u32 v15, v14, 8, v15
    v_add_u32 v15, v15, v13
    s_mul_i32 s27, s22, 20
    s_add_u32 s27, s27, s26
    s_lshl_b32 s27, s27, 10
    s_add_u32 s27, s27, 40960
    v_add_u32 v237, s27, v15
    s_add_u32 s26, s40, 1
    v_add_u32 v14, 0, v12
    s_and_b32 s27, s26, 1
    s_lshl_b32 s27, s27, 2
    v_add_u32 v15, s27, v14
    v_xor_b32 v15, v15, v4
    v_lshlrev_b32 v15, 4, v15
    buffer_load_dwordx4 a[20:23], v8, s[28:31], s36 offen offset:1024
    v_lshl_add_u32 v15, v14, 8, v15
    v_add_u32 v15, v15, v13
    s_mul_i32 s27, s22, 20
    s_add_u32 s27, s27, s26
    s_lshl_b32 s27, s27, 10
    s_add_u32 s27, s27, 40960
    v_add_u32 v238, s27, v15
    s_add_u32 s26, s40, 1
    v_add_u32 v14, 2, v12
    s_and_b32 s27, s26, 1
    s_lshl_b32 s27, s27, 2
    v_add_u32 v15, s27, v14
    v_xor_b32 v15, v15, v4
    v_lshlrev_b32 v15, 4, v15
    v_lshl_add_u32 v15, v14, 8, v15
    v_add_u32 v15, v15, v13
    s_mul_i32 s27, s22, 20
    buffer_load_dwordx4 a[24:27], v8, s[28:31], s36 offen offset:2048
    s_add_u32 s27, s27, s26
    s_lshl_b32 s27, s27, 10
    s_add_u32 s27, s27, 40960
    v_add_u32 v239, s27, v15
    s_mov_b32 s26, s41
    s_lshl_b32 s27, s21, 1
    v_add_u32 v14, s27, v12
    s_and_b32 s27, s26, 1
    s_lshl_b32 s27, s27, 2
    v_add_u32 v15, s27, v14
    v_xor_b32 v15, v15, v4
    v_lshlrev_b32 v15, 4, v15
    v_lshl_add_u32 v15, v14, 8, v15
    v_add_u32 v15, v15, v13
    s_mul_i32 s27, s22, 20
    s_add_u32 s27, s27, s26
    s_lshl_b32 s27, s27, 10
    buffer_load_dwordx4 a[28:31], v8, s[28:31], s36 offen offset:3072
    s_add_u32 s27, s27, 40960
    v_add_u32 v240, s27, v15
    s_lshr_b32 s26, s24, 1
    s_add_u32 s26, s26, 1
    s_sub_u32 s27, 0, s26
    s_and_b32 s42, s24, 1
    s_cmp_eq_u32 s42, 1
    s_cselect_b32 s42, s27, s26
    s_lshl_b32 s43, s23, 5
    s_lshl_b32 s26, s22, 4
    s_add_u32 s43, s43, s26
    v_add_u32 v241, s43, v4
    v_add_u32 v241, s42, v241
    s_movk_i32 s27, 2048
    v_cmp_gt_u32 s[60:61], s27, v241
    v_lshrrev_b32 v242, 4, v241
    s_add_u32 s36, s36, 4096
    buffer_load_dwordx4 a[32:35], v8, s[28:31], s36 offen offset:0
    v_and_b32 v241, 15, v241
    s_mov_b32 s27, 20480
    v_mul_lo_u32 v242, v242, s27
    v_lshl_add_u32 v242, v241, 4, v242
    v_and_b32 v241, 1, v3
    v_lshlrev_b32 v241, 9, v241
    v_lshrrev_b32 v2, 1, v3
    v_lshl_add_u32 v241, v2, 8, v241
    v_add_u32 v241, v241, v242
    s_lshl_b32 s27, s21, 9
    v_lshl_add_u32 v242, v2, 8, v242
    v_add_u32 v242, s27, v242
    v_and_b32 v2, 1, v3
    v_lshl_add_u32 v242, v2, 3, v242
    v_add_u32 v243, s43, v4
    v_lshrrev_b32 v244, 4, v243
    v_and_b32 v243, 15, v243
    buffer_load_dwordx4 a[36:39], v8, s[28:31], s36 offen offset:1024
    s_mov_b32 s27, 20480
    v_mul_lo_u32 v244, v244, s27
    v_lshl_add_u32 v244, v243, 4, v244
    v_and_b32 v243, 1, v3
    v_lshlrev_b32 v243, 9, v243
    v_lshrrev_b32 v2, 1, v3
    v_lshl_add_u32 v243, v2, 8, v243
    v_add_u32 v243, v243, v244
    s_lshl_b32 s27, s21, 9
    v_lshl_add_u32 v244, v2, 8, v244
    v_add_u32 v244, s27, v244
    v_and_b32 v2, 1, v3
    v_lshl_add_u32 v244, v2, 3, v244
    s_lshl_b32 s44, s40, 10
    s_add_u32 s38, s44, 13406208
    s_add_u32 s44, s44, 10784768
    s_lshl_b32 s45, s41, 10
    buffer_load_dwordx4 a[40:43], v8, s[28:31], s36 offen offset:2048
    s_add_u32 s39, s45, 13406208
    s_add_u32 s45, s45, 10784768
    s_lshl_b32 s46, s23, 2
    s_add_u32 s46, s46, s24
    s_lshl_b32 s46, s46, 7
    s_add_u32 s49, s46, 29413376
    s_add_u32 s46, s46, 29380608
    v_add_u32 v7, 1, v1
    v_lshrrev_b32 v7, 1, v7
    v_add_u32 v7, s23, v7
    v_subrev_u32 v7, 1, v7
    v_max_i32 v7, 0, v7
    v_min_i32 v7, 63, v7
    v_lshrrev_b32 v2, 1, v1
    s_lshl_b32 s26, s22, 1
    v_add_u32 v2, s26, v2
    v_lshl_add_u32 v7, v7, 2, v2
    buffer_load_dwordx4 a[44:47], v8, s[28:31], s36 offen offset:3072
    v_lshlrev_b32 v245, 7, v7
    s_lshl_b32 s26, s23, 1
    s_add_u32 s27, s26, s22
    s_mul_i32 s27, s27, 20
    s_mul_i32 s3, s22, 10
    s_add_u32 s27, s27, s3
    s_lshl_b32 s27, s27, 10
    s_add_u32 s50, s27, 10784768
    s_add_u32 s27, s26, 1
    s_sub_u32 s27, s27, s22
    s_mul_i32 s27, s27, 20
    s_add_u32 s27, s27, s3
    s_lshl_b32 s27, s27, 10
    s_add_u32 s51, s27, 10784768
    s_mul_i32 s26, s20, 5120
    s_add_u32 s26, s26, 143360
    s_add_u32 s36, s36, 4096
    buffer_load_dwordx4 a[48:51], v8, s[28:31], s36 offen offset:0
    v_add_u32 v246, s26, v8
    s_xor_b32 s27, s20, 2
    s_mul_i32 s27, s27, 5120
    s_add_u32 s27, s27, 143360
    v_add_u32 v247, s27, v8
    s_lshr_b32 s26, s2, 3
    s_and_b32 s3, s2, 7
    s_and_b32 s4, s3, 1
    s_lshr_b32 s3, s3, 1
    s_and_b32 s52, s26, 7
    s_lshl_b32 s27, s4, 3
    s_add_u32 s52, s52, s27
    s_lshr_b32 s27, s26, 3
    s_lshl_b32 s53, s3, 2
    s_add_u32 s53, s53, s27
    s_and_b32 s57, s26, 3
    buffer_load_dwordx4 a[52:55], v8, s[28:31], s36 offen offset:1024
    s_lshl_b32 s27, s4, 2
    s_add_u32 s57, s57, s27
    s_lshr_b32 s27, s26, 2
    s_lshl_b32 s58, s3, 3
    s_add_u32 s58, s58, s27
    s_and_b32 s57, s26, 7
    s_lshr_b32 s27, s26, 3
    s_and_b32 s58, s2, 7
    s_lshl_b32 s58, s58, 2
    s_add_u32 s58, s58, s27
    s_mul_i32 s54, s52, 143360
    s_add_u32 s54, s54, 24875008
    s_mul_i32 s59, s57, 276480
    s_add_u32 s59, s59, 27168768
    v_mov_b32 v224, 0x3f803f80
    v_mov_b32 v216, 0
    buffer_load_dwordx4 a[56:59], v8, s[28:31], s36 offen offset:2048
    v_mov_b32 v217, 0
    v_mov_b32 v220, 0
    v_mov_b32 v221, 0
    v_mov_b32 v218, 0
    v_mov_b32 v219, 0
    v_mov_b32 v222, 0
    v_mov_b32 v223, 0
    buffer_load_dwordx4 a[60:63], v8, s[28:31], s36 offen offset:3072
    s_add_u32 s36, s36, 4096
    buffer_load_dwordx4 a[64:67], v8, s[28:31], s36 offen offset:0
    s_waitcnt vmcnt(17)
    s_barrier
    buffer_load_dwordx4 a[68:71], v8, s[28:31], s36 offen offset:1024
    v_xor_b32 v12, 32, v226
    ds_read_b64 v[32:33], v226 offset:0
    ds_read_b64 v[34:35], v226 offset:128
    ds_read_b64 v[36:37], v12 offset:0
    ds_read_b64 v[38:39], v12 offset:128
    ds_read_b64 v[40:41], v226 offset:4096
    ds_read_b64 v[42:43], v226 offset:4224
    buffer_load_dwordx4 a[72:75], v8, s[28:31], s36 offen offset:2048
    s_waitcnt lgkmcnt(4)
    v_dot2_f32_bf16 v220, v32, v224, v220
    v_lshlrev_b32 v72, 16, v32
    v_dot2_f32_bf16 v221, v32, v32, v221
    v_and_b32 v73, 0xffff0000, v32
    v_dot2_f32_bf16 v220, v33, v224, v220
    ds_read_b64 v[44:45], v12 offset:4096
    v_lshlrev_b32 v74, 16, v33
    v_dot2_f32_bf16 v221, v33, v33, v221
    v_and_b32 v75, 0xffff0000, v33
    v_dot2_f32_bf16 v220, v34, v224, v220
    ds_read_b64 v[46:47], v12 offset:4224
    v_lshlrev_b32 v76, 16, v34
    buffer_load_dwordx4 a[76:79], v8, s[28:31], s36 offen offset:3072
    v_dot2_f32_bf16 v221, v34, v34, v221
    v_and_b32 v77, 0xffff0000, v34
    v_dot2_f32_bf16 v220, v35, v224, v220
    v_lshlrev_b32 v78, 16, v35
    v_dot2_f32_bf16 v221, v35, v35, v221
    v_and_b32 v79, 0xffff0000, v35
    s_waitcnt lgkmcnt(4)
    v_dot2_f32_bf16 v222, v36, v224, v222
    v_lshlrev_b32 v80, 16, v36
    v_dot2_f32_bf16 v223, v36, v36, v223
    v_and_b32 v81, 0xffff0000, v36
    v_dot2_f32_bf16 v222, v37, v224, v222
    ds_read_b64 v[48:49], v226 offset:8192
    v_lshlrev_b32 v82, 16, v37
    v_dot2_f32_bf16 v223, v37, v37, v223
    s_add_u32 s36, s36, 4096
    buffer_load_dwordx4 a[80:83], v8, s[28:31], s36 offen offset:0
    v_and_b32 v83, 0xffff0000, v37
    v_dot2_f32_bf16 v222, v38, v224, v222
    ds_read_b64 v[50:51], v226 offset:8320
    v_lshlrev_b32 v84, 16, v38
    v_dot2_f32_bf16 v223, v38, v38, v223
    v_and_b32 v85, 0xffff0000, v38
    v_dot2_f32_bf16 v222, v39, v224, v222
    v_lshlrev_b32 v86, 16, v39
    v_dot2_f32_bf16 v223, v39, v39, v223
    v_and_b32 v87, 0xffff0000, v39
    s_waitcnt lgkmcnt(4)
    v_dot2_f32_bf16 v220, v40, v224, v220
    v_lshlrev_b32 v88, 16, v40
    v_dot2_f32_bf16 v221, v40, v40, v221
    v_and_b32 v89, 0xffff0000, v40
    buffer_load_dwordx4 a[84:87], v8, s[28:31], s36 offen offset:1024
    v_dot2_f32_bf16 v220, v41, v224, v220
    ds_read_b64 v[52:53], v12 offset:8192
    v_lshlrev_b32 v90, 16, v41
    v_dot2_f32_bf16 v221, v41, v41, v221
    v_and_b32 v91, 0xffff0000, v41
    v_dot2_f32_bf16 v220, v42, v224, v220
    ds_read_b64 v[54:55], v12 offset:8320
    v_lshlrev_b32 v92, 16, v42
    v_dot2_f32_bf16 v221, v42, v42, v221
    v_and_b32 v93, 0xffff0000, v42
    v_dot2_f32_bf16 v220, v43, v224, v220
    v_lshlrev_b32 v94, 16, v43
    v_dot2_f32_bf16 v221, v43, v43, v221
    buffer_load_dwordx4 a[88:91], v8, s[28:31], s36 offen offset:2048
    v_and_b32 v95, 0xffff0000, v43
    s_waitcnt lgkmcnt(4)
    v_dot2_f32_bf16 v222, v44, v224, v222
    v_lshlrev_b32 v96, 16, v44
    v_dot2_f32_bf16 v223, v44, v44, v223
    v_and_b32 v97, 0xffff0000, v44
    v_dot2_f32_bf16 v222, v45, v224, v222
    ds_read_b64 v[56:57], v226 offset:12288
    v_lshlrev_b32 v98, 16, v45
    v_dot2_f32_bf16 v223, v45, v45, v223
    v_and_b32 v99, 0xffff0000, v45
    v_dot2_f32_bf16 v222, v46, v224, v222
    ds_read_b64 v[58:59], v226 offset:12416
    buffer_load_dwordx4 a[92:95], v8, s[28:31], s36 offen offset:3072
    v_lshlrev_b32 v100, 16, v46
    v_dot2_f32_bf16 v223, v46, v46, v223
    v_and_b32 v101, 0xffff0000, v46
    v_dot2_f32_bf16 v222, v47, v224, v222
    v_lshlrev_b32 v102, 16, v47
    v_dot2_f32_bf16 v223, v47, v47, v223
    v_and_b32 v103, 0xffff0000, v47
    s_waitcnt lgkmcnt(4)
    v_dot2_f32_bf16 v220, v48, v224, v220
    v_lshlrev_b32 v104, 16, v48
    v_dot2_f32_bf16 v221, v48, v48, v221
    v_and_b32 v105, 0xffff0000, v48
    v_dot2_f32_bf16 v220, v49, v224, v220
    ds_read_b64 v[60:61], v12 offset:12288
    v_lshlrev_b32 v106, 16, v49
    s_add_u32 s36, s36, 4096
    buffer_load_dwordx4 a[96:99], v8, s[28:31], s36 offen offset:0
    v_dot2_f32_bf16 v221, v49, v49, v221
    v_and_b32 v107, 0xffff0000, v49
    v_dot2_f32_bf16 v220, v50, v224, v220
    ds_read_b64 v[62:63], v12 offset:12416
    v_lshlrev_b32 v108, 16, v50
    v_dot2_f32_bf16 v221, v50, v50, v221
    v_and_b32 v109, 0xffff0000, v50
    v_dot2_f32_bf16 v220, v51, v224, v220
    v_lshlrev_b32 v110, 16, v51
    v_dot2_f32_bf16 v221, v51, v51, v221
    v_and_b32 v111, 0xffff0000, v51
    s_waitcnt lgkmcnt(4)
    v_dot2_f32_bf16 v222, v52, v224, v222
    v_lshlrev_b32 v112, 16, v52
    v_dot2_f32_bf16 v223, v52, v52, v223
    buffer_load_dwordx4 a[100:103], v8, s[28:31], s36 offen offset:1024
    v_and_b32 v113, 0xffff0000, v52
    v_dot2_f32_bf16 v222, v53, v224, v222
    ds_read_b64 v[64:65], v226 offset:16384
    v_lshlrev_b32 v114, 16, v53
    v_dot2_f32_bf16 v223, v53, v53, v223
    v_and_b32 v115, 0xffff0000, v53
    v_dot2_f32_bf16 v222, v54, v224, v222
    ds_read_b64 v[66:67], v226 offset:16512
    v_lshlrev_b32 v116, 16, v54
    v_dot2_f32_bf16 v223, v54, v54, v223
    v_and_b32 v117, 0xffff0000, v54
    v_dot2_f32_bf16 v222, v55, v224, v222
    v_lshlrev_b32 v118, 16, v55
    buffer_load_dwordx4 a[104:107], v8, s[28:31], s36 offen offset:2048
    v_dot2_f32_bf16 v223, v55, v55, v223
    v_and_b32 v119, 0xffff0000, v55
    s_waitcnt lgkmcnt(4)
    v_dot2_f32_bf16 v220, v56, v224, v220
    v_lshlrev_b32 v120, 16, v56
    v_dot2_f32_bf16 v221, v56, v56, v221
    v_and_b32 v121, 0xffff0000, v56
    v_dot2_f32_bf16 v220, v57, v224, v220
    ds_read_b64 v[68:69], v12 offset:16384
    v_lshlrev_b32 v122, 16, v57
    v_dot2_f32_bf16 v221, v57, v57, v221
    v_and_b32 v123, 0xffff0000, v57
    v_dot2_f32_bf16 v220, v58, v224, v220
    ds_read_b64 v[70:71], v12 offset:16512
    buffer_load_dwordx4 a[108:111], v8, s[28:31], s36 offen offset:3072
    v_lshlrev_b32 v124, 16, v58
    v_dot2_f32_bf16 v221, v58, v58, v221
    v_and_b32 v125, 0xffff0000, v58
    v_dot2_f32_bf16 v220, v59, v224, v220
    v_lshlrev_b32 v126, 16, v59
    v_dot2_f32_bf16 v221, v59, v59, v221
    v_and_b32 v127, 0xffff0000, v59
    s_waitcnt lgkmcnt(4)
    v_dot2_f32_bf16 v222, v60, v224, v222
    v_lshlrev_b32 v128, 16, v60
    v_dot2_f32_bf16 v223, v60, v60, v223
    v_and_b32 v129, 0xffff0000, v60
    v_dot2_f32_bf16 v222, v61, v224, v222
    v_lshlrev_b32 v130, 16, v61
    v_dot2_f32_bf16 v223, v61, v61, v223
    v_and_b32 v131, 0xffff0000, v61
    v_dot2_f32_bf16 v222, v62, v224, v222
    s_add_u32 s36, s36, 4096
    buffer_load_dwordx4 a[112:115], v8, s[28:31], s36 offen offset:0
    v_lshlrev_b32 v132, 16, v62
    v_dot2_f32_bf16 v223, v62, v62, v223
    v_and_b32 v133, 0xffff0000, v62
    v_dot2_f32_bf16 v222, v63, v224, v222
    v_lshlrev_b32 v134, 16, v63
    v_dot2_f32_bf16 v223, v63, v63, v223
    v_and_b32 v135, 0xffff0000, v63
    s_waitcnt lgkmcnt(2)
    v_dot2_f32_bf16 v220, v64, v224, v220
    v_lshlrev_b32 v136, 16, v64
    v_dot2_f32_bf16 v221, v64, v64, v221
    v_and_b32 v137, 0xffff0000, v64
    v_dot2_f32_bf16 v220, v65, v224, v220
    v_lshlrev_b32 v138, 16, v65
    v_dot2_f32_bf16 v221, v65, v65, v221
    v_and_b32 v139, 0xffff0000, v65
    v_dot2_f32_bf16 v220, v66, v224, v220
    buffer_load_dwordx4 a[116:119], v8, s[28:31], s36 offen offset:1024
    v_lshlrev_b32 v140, 16, v66
    v_dot2_f32_bf16 v221, v66, v66, v221
    v_and_b32 v141, 0xffff0000, v66
    v_dot2_f32_bf16 v220, v67, v224, v220
    v_lshlrev_b32 v142, 16, v67
    v_dot2_f32_bf16 v221, v67, v67, v221
    v_and_b32 v143, 0xffff0000, v67
    s_waitcnt lgkmcnt(0)
    v_dot2_f32_bf16 v222, v68, v224, v222
    v_lshlrev_b32 v144, 16, v68
    v_dot2_f32_bf16 v223, v68, v68, v223
    v_and_b32 v145, 0xffff0000, v68
    v_dot2_f32_bf16 v222, v69, v224, v222
    v_lshlrev_b32 v146, 16, v69
    v_dot2_f32_bf16 v223, v69, v69, v223
    v_and_b32 v147, 0xffff0000, v69
    v_dot2_f32_bf16 v222, v70, v224, v222
    buffer_load_dwordx4 a[120:123], v8, s[28:31], s36 offen offset:2048
    v_lshlrev_b32 v148, 16, v70
    v_dot2_f32_bf16 v223, v70, v70, v223
    v_and_b32 v149, 0xffff0000, v70
    v_dot2_f32_bf16 v222, v71, v224, v222
    v_lshlrev_b32 v150, 16, v71
    v_dot2_f32_bf16 v223, v71, v71, v223
    v_and_b32 v151, 0xffff0000, v71
    s_nop 2
    s_nop 1
    v_add_f32_dpp v220, v220, v220 quad_perm:[1,0,3,2] row_mask:0xf bank_mask:0xf
    v_add_f32_dpp v221, v221, v221 quad_perm:[1,0,3,2] row_mask:0xf bank_mask:0xf
    v_add_f32_dpp v222, v222, v222 quad_perm:[1,0,3,2] row_mask:0xf bank_mask:0xf
    v_add_f32_dpp v223, v223, v223 quad_perm:[1,0,3,2] row_mask:0xf bank_mask:0xf
    v_add_f32_dpp v220, v220, v220 quad_perm:[2,3,0,1] row_mask:0xf bank_mask:0xf
    v_add_f32_dpp v221, v221, v221 quad_perm:[2,3,0,1] row_mask:0xf bank_mask:0xf
    v_add_f32_dpp v222, v222, v222 quad_perm:[2,3,0,1] row_mask:0xf bank_mask:0xf
    v_add_f32_dpp v223, v223, v223 quad_perm:[2,3,0,1] row_mask:0xf bank_mask:0xf
    buffer_load_dwordx4 a[124:127], v8, s[28:31], s36 offen offset:3072
    v_add_f32_dpp v220, v220, v220 row_half_mirror row_mask:0xf bank_mask:0xf
    v_add_f32_dpp v221, v221, v221 row_half_mirror row_mask:0xf bank_mask:0xf
    v_add_f32_dpp v222, v222, v222 row_half_mirror row_mask:0xf bank_mask:0xf
    v_add_f32_dpp v223, v223, v223 row_half_mirror row_mask:0xf bank_mask:0xf
    v_add_f32_dpp v220, v220, v220 row_mirror row_mask:0xf bank_mask:0xf
    v_add_f32_dpp v221, v221, v221 row_mirror row_mask:0xf bank_mask:0xf
    v_add_f32_dpp v222, v222, v222 row_mirror row_mask:0xf bank_mask:0xf
    v_add_f32_dpp v223, v223, v223 row_mirror row_mask:0xf bank_mask:0xf
    v_mul_f32 v220, 0x3acccccd, v220
    v_mul_f32 v222, 0x3acccccd, v222
    v_mul_f32 v221, 0x3acccccd, v221
    v_mul_f32 v223, 0x3acccccd, v223
    v_fma_f32 v221, -v220, v220, v221
    v_fma_f32 v223, -v222, v222, v223
    v_max_f32 v221, 0, v221
    v_max_f32 v223, 0, v223
    v_cvt_pk_bf16_f32 v192, v220, v221
    s_add_u32 s36, s36, 4096
    buffer_load_dwordx4 a[128:131], v8, s[28:31], s36 offen offset:0
    v_cvt_pk_bf16_f32 v193, v222, v223
    v_lshlrev_b32 v220, 16, v192
    v_lshlrev_b32 v222, 16, v193
    v_and_b32 v221, 0xffff0000, v192
    v_and_b32 v223, 0xffff0000, v193
    v_add_f32 v221, 0x3727c5ac, v221
    v_add_f32 v223, 0x3727c5ac, v223
    v_cvt_pk_bf16_f32 v192, v221, v221
    v_cvt_pk_bf16_f32 v193, v223, v223
    v_lshlrev_b32 v221, 16, v192
    v_lshlrev_b32 v223, 16, v193
    v_sqrt_f32 v221, v221
    v_sqrt_f32 v223, v223
    s_nop 0
    s_nop 0
    v_cvt_pk_bf16_f32 v192, v221, v221
    buffer_load_dwordx4 a[132:135], v8, s[28:31], s36 offen offset:1024
    v_cvt_pk_bf16_f32 v193, v223, v223
    v_lshlrev_b32 v221, 16, v192
    v_lshlrev_b32 v223, 16, v193
    v_rcp_f32 v221, v221
    v_rcp_f32 v223, v223
    s_nop 0
    s_nop 0
    v_mul_f32 v220, v220, v221
    v_mul_f32 v222, v222, v223
    v_sub_f32 v220, 0, v220
    v_sub_f32 v222, 0, v222
    v_mov_b32 v216, 0
    v_mov_b32 v217, 0
    v_mov_b32 v218, 0
    v_mov_b32 v219, 0
    buffer_load_dwordx4 a[136:139], v8, s[28:31], s36 offen offset:2048
    v_xor_b32 v12, 64, v228
    ds_read_b128 v[152:155], v227 offset:10240
    ds_read_b128 v[156:159], v227 offset:10256
    ds_read_b128 v[160:163], v227 offset:7680
    ds_read_b128 v[164:167], v227 offset:7696
    s_waitcnt lgkmcnt(0)
    v_pk_fma_f32 v[72:73], v[72:73], v[220:221], v[220:221] op_sel:[0,1,0] op_sel_hi:[1,1,0]
    v_pk_fma_f32 v[74:75], v[74:75], v[220:221], v[220:221] op_sel:[0,1,0] op_sel_hi:[1,1,0]
    v_pk_fma_f32 v[76:77], v[76:77], v[220:221], v[220:221] op_sel:[0,1,0] op_sel_hi:[1,1,0]
    buffer_load_dwordx4 a[140:143], v8, s[28:31], s36 offen offset:3072
    ds_read_b128 v[168:171], v227 offset:10752
    v_pk_fma_f32 v[78:79], v[78:79], v[220:221], v[220:221] op_sel:[0,1,0] op_sel_hi:[1,1,0]
    v_pk_fma_f32 v[72:73], v[72:73], v[152:153], v[160:161]
    v_pk_fma_f32 v[74:75], v[74:75], v[154:155], v[162:163]
    ds_read_b128 v[172:175], v227 offset:10768
    v_pk_fma_f32 v[76:77], v[76:77], v[156:157], v[164:165]
    v_pk_fma_f32 v[78:79], v[78:79], v[158:159], v[166:167]
    v_cvt_pk_bf16_f32 v32, v72, v73
    ds_read_b128 v[176:179], v227 offset:8192
    v_cvt_pk_bf16_f32 v33, v74, v75
    v_cvt_pk_bf16_f32 v34, v76, v77
    s_add_u32 s36, s36, 4096
    buffer_load_dwordx4 a[144:147], v8, s[28:31], s36 offen offset:0
    v_cvt_pk_bf16_f32 v35, v78, v79
    ds_read_b128 v[180:183], v227 offset:8208
    v_dot2_f32_bf16 v216, v32, v224, v216
    v_dot2_f32_bf16 v217, v32, v32, v217
    v_dot2_f32_bf16 v216, v33, v224, v216
    v_dot2_f32_bf16 v217, v33, v33, v217
    v_dot2_f32_bf16 v216, v34, v224, v216
    v_dot2_f32_bf16 v217, v34, v34, v217
    v_dot2_f32_bf16 v216, v35, v224, v216
    v_dot2_f32_bf16 v217, v35, v35, v217
    ds_write_b128 v228, v[32:35] offset:0
    buffer_load_dwordx4 a[148:151], v8, s[28:31], s36 offen offset:1024
    v_pk_fma_f32 v[80:81], v[80:81], v[222:223], v[222:223] op_sel:[0,1,0] op_sel_hi:[1,1,0]
    v_pk_fma_f32 v[82:83], v[82:83], v[222:223], v[222:223] op_sel:[0,1,0] op_sel_hi:[1,1,0]
    v_pk_fma_f32 v[84:85], v[84:85], v[222:223], v[222:223] op_sel:[0,1,0] op_sel_hi:[1,1,0]
    v_pk_fma_f32 v[86:87], v[86:87], v[222:223], v[222:223] op_sel:[0,1,0] op_sel_hi:[1,1,0]
    v_pk_fma_f32 v[80:81], v[80:81], v[152:153], v[160:161]
    v_pk_fma_f32 v[82:83], v[82:83], v[154:155], v[162:163]
    v_pk_fma_f32 v[84:85], v[84:85], v[156:157], v[164:165]
    v_pk_fma_f32 v[86:87], v[86:87], v[158:159], v[166:167]
    v_cvt_pk_bf16_f32 v36, v80, v81
    v_cvt_pk_bf16_f32 v37, v82, v83
    v_cvt_pk_bf16_f32 v38, v84, v85
    v_cvt_pk_bf16_f32 v39, v86, v87
    v_dot2_f32_bf16 v218, v36, v224, v218
    v_dot2_f32_bf16 v219, v36, v36, v219
    v_dot2_f32_bf16 v218, v37, v224, v218
    v_dot2_f32_bf16 v219, v37, v37, v219
    v_dot2_f32_bf16 v218, v38, v224, v218
    buffer_load_dwordx4 a[152:155], v8, s[28:31], s36 offen offset:2048
    v_dot2_f32_bf16 v219, v38, v38, v219
    v_dot2_f32_bf16 v218, v39, v224, v218
    v_dot2_f32_bf16 v219, v39, v39, v219
    ds_write_b128 v12, v[36:39] offset:0
    s_waitcnt lgkmcnt(1)
    v_pk_fma_f32 v[88:89], v[88:89], v[220:221], v[220:221] op_sel:[0,1,0] op_sel_hi:[1,1,0]
    v_pk_fma_f32 v[90:91], v[90:91], v[220:221], v[220:221] op_sel:[0,1,0] op_sel_hi:[1,1,0]
    v_pk_fma_f32 v[92:93], v[92:93], v[220:221], v[220:221] op_sel:[0,1,0] op_sel_hi:[1,1,0]
    ds_read_b128 v[152:155], v227 offset:11264
    buffer_load_dwordx4 a[156:159], v8, s[28:31], s36 offen offset:3072
    v_pk_fma_f32 v[94:95], v[94:95], v[220:221], v[220:221] op_sel:[0,1,0] op_sel_hi:[1,1,0]
    v_pk_fma_f32 v[88:89], v[88:89], v[168:169], v[176:177]
    v_pk_fma_f32 v[90:91], v[90:91], v[170:171], v[178:179]
    ds_read_b128 v[156:159], v227 offset:11280
    v_pk_fma_f32 v[92:93], v[92:93], v[172:173], v[180:181]
    v_pk_fma_f32 v[94:95], v[94:95], v[174:175], v[182:183]
    v_cvt_pk_bf16_f32 v40, v88, v89
    ds_read_b128 v[160:163], v227 offset:8704
    v_cvt_pk_bf16_f32 v41, v90, v91
    v_cvt_pk_bf16_f32 v42, v92, v93
    v_cvt_pk_bf16_f32 v43, v94, v95
    ds_read_b128 v[164:167], v227 offset:8720
    s_add_u32 s36, s36, 4096
    buffer_load_dwordx4 a[160:163], v8, s[28:31], s36 offen offset:0
    v_dot2_f32_bf16 v216, v40, v224, v216
    v_dot2_f32_bf16 v217, v40, v40, v217
    v_dot2_f32_bf16 v216, v41, v224, v216
    v_dot2_f32_bf16 v217, v41, v41, v217
    v_dot2_f32_bf16 v216, v42, v224, v216
    v_dot2_f32_bf16 v217, v42, v42, v217
    v_dot2_f32_bf16 v216, v43, v224, v216
    v_dot2_f32_bf16 v217, v43, v43, v217
    ds_write_b128 v228, v[40:43] offset:4096
    v_pk_fma_f32 v[96:97], v[96:97], v[222:223], v[222:223] op_sel:[0,1,0] op_sel_hi:[1,1,0]
    buffer_load_dwordx4 a[164:167], v8, s[28:31], s36 offen offset:1024
    v_pk_fma_f32 v[98:99], v[98:99], v[222:223], v[222:223] op_sel:[0,1,0] op_sel_hi:[1,1,0]
    v_pk_fma_f32 v[100:101], v[100:101], v[222:223], v[222:223] op_sel:[0,1,0] op_sel_hi:[1,1,0]
    v_pk_fma_f32 v[102:103], v[102:103], v[222:223], v[222:223] op_sel:[0,1,0] op_sel_hi:[1,1,0]
    v_pk_fma_f32 v[96:97], v[96:97], v[168:169], v[176:177]
    v_pk_fma_f32 v[98:99], v[98:99], v[170:171], v[178:179]
    v_pk_fma_f32 v[100:101], v[100:101], v[172:173], v[180:181]
    v_pk_fma_f32 v[102:103], v[102:103], v[174:175], v[182:183]
    v_cvt_pk_bf16_f32 v44, v96, v97
    v_cvt_pk_bf16_f32 v45, v98, v99
    v_cvt_pk_bf16_f32 v46, v100, v101
    v_cvt_pk_bf16_f32 v47, v102, v103
    v_dot2_f32_bf16 v218, v44, v224, v218
    v_dot2_f32_bf16 v219, v44, v44, v219
    v_dot2_f32_bf16 v218, v45, v224, v218
    v_dot2_f32_bf16 v219, v45, v45, v219
    v_dot2_f32_bf16 v218, v46, v224, v218
    v_dot2_f32_bf16 v219, v46, v46, v219
    buffer_load_dwordx4 a[168:171], v8, s[28:31], s36 offen offset:2048
    v_dot2_f32_bf16 v218, v47, v224, v218
    v_dot2_f32_bf16 v219, v47, v47, v219
    ds_write_b128 v12, v[44:47] offset:4096
    s_waitcnt lgkmcnt(1)
    v_pk_fma_f32 v[104:105], v[104:105], v[220:221], v[220:221] op_sel:[0,1,0] op_sel_hi:[1,1,0]
    v_pk_fma_f32 v[106:107], v[106:107], v[220:221], v[220:221] op_sel:[0,1,0] op_sel_hi:[1,1,0]
    v_pk_fma_f32 v[108:109], v[108:109], v[220:221], v[220:221] op_sel:[0,1,0] op_sel_hi:[1,1,0]
    ds_read_b128 v[168:171], v227 offset:11776
    buffer_load_dwordx4 a[172:175], v8, s[28:31], s36 offen offset:3072
    v_pk_fma_f32 v[110:111], v[110:111], v[220:221], v[220:221] op_sel:[0,1,0] op_sel_hi:[1,1,0]
    v_pk_fma_f32 v[104:105], v[104:105], v[152:153], v[160:161]
    v_pk_fma_f32 v[106:107], v[106:107], v[154:155], v[162:163]
    ds_read_b128 v[172:175], v227 offset:11792
    v_pk_fma_f32 v[108:109], v[108:109], v[156:157], v[164:165]
    v_pk_fma_f32 v[110:111], v[110:111], v[158:159], v[166:167]
    v_cvt_pk_bf16_f32 v48, v104, v105
    ds_read_b128 v[176:179], v227 offset:9216
    v_cvt_pk_bf16_f32 v49, v106, v107
    v_cvt_pk_bf16_f32 v50, v108, v109
    v_cvt_pk_bf16_f32 v51, v110, v111
    ds_read_b128 v[180:183], v227 offset:9232
    s_add_u32 s36, s36, 4096
    buffer_load_dwordx4 a[176:179], v8, s[28:31], s36 offen offset:0
    v_dot2_f32_bf16 v216, v48, v224, v216
    v_dot2_f32_bf16 v217, v48, v48, v217
    v_dot2_f32_bf16 v216, v49, v224, v216
    v_dot2_f32_bf16 v217, v49, v49, v217
    v_dot2_f32_bf16 v216, v50, v224, v216
    v_dot2_f32_bf16 v217, v50, v50, v217
    v_dot2_f32_bf16 v216, v51, v224, v216
    v_dot2_f32_bf16 v217, v51, v51, v217
    ds_write_b128 v228, v[48:51] offset:8192
    v_pk_fma_f32 v[112:113], v[112:113], v[222:223], v[222:223] op_sel:[0,1,0] op_sel_hi:[1,1,0]
    buffer_load_dwordx4 a[180:183], v8, s[28:31], s36 offen offset:1024
    v_pk_fma_f32 v[114:115], v[114:115], v[222:223], v[222:223] op_sel:[0,1,0] op_sel_hi:[1,1,0]
    v_pk_fma_f32 v[116:117], v[116:117], v[222:223], v[222:223] op_sel:[0,1,0] op_sel_hi:[1,1,0]
    v_pk_fma_f32 v[118:119], v[118:119], v[222:223], v[222:223] op_sel:[0,1,0] op_sel_hi:[1,1,0]
    v_pk_fma_f32 v[112:113], v[112:113], v[152:153], v[160:161]
    v_pk_fma_f32 v[114:115], v[114:115], v[154:155], v[162:163]
    v_pk_fma_f32 v[116:117], v[116:117], v[156:157], v[164:165]
    v_pk_fma_f32 v[118:119], v[118:119], v[158:159], v[166:167]
    v_cvt_pk_bf16_f32 v52, v112, v113
    v_cvt_pk_bf16_f32 v53, v114, v115
    v_cvt_pk_bf16_f32 v54, v116, v117
    v_cvt_pk_bf16_f32 v55, v118, v119
    v_dot2_f32_bf16 v218, v52, v224, v218
    v_dot2_f32_bf16 v219, v52, v52, v219
    v_dot2_f32_bf16 v218, v53, v224, v218
    v_dot2_f32_bf16 v219, v53, v53, v219
    v_dot2_f32_bf16 v218, v54, v224, v218
    v_dot2_f32_bf16 v219, v54, v54, v219
    buffer_load_dwordx4 a[184:187], v8, s[28:31], s36 offen offset:2048
    v_dot2_f32_bf16 v218, v55, v224, v218
    v_dot2_f32_bf16 v219, v55, v55, v219
    ds_write_b128 v12, v[52:55] offset:8192
    s_waitcnt lgkmcnt(1)
    v_pk_fma_f32 v[120:121], v[120:121], v[220:221], v[220:221] op_sel:[0,1,0] op_sel_hi:[1,1,0]
    v_pk_fma_f32 v[122:123], v[122:123], v[220:221], v[220:221] op_sel:[0,1,0] op_sel_hi:[1,1,0]
    v_pk_fma_f32 v[124:125], v[124:125], v[220:221], v[220:221] op_sel:[0,1,0] op_sel_hi:[1,1,0]
    ds_read_b128 v[152:155], v227 offset:12288
    buffer_load_dwordx4 a[188:191], v8, s[28:31], s36 offen offset:3072
    v_pk_fma_f32 v[126:127], v[126:127], v[220:221], v[220:221] op_sel:[0,1,0] op_sel_hi:[1,1,0]
    v_pk_fma_f32 v[120:121], v[120:121], v[168:169], v[176:177]
    v_pk_fma_f32 v[122:123], v[122:123], v[170:171], v[178:179]
    ds_read_b128 v[156:159], v227 offset:12304
    v_pk_fma_f32 v[124:125], v[124:125], v[172:173], v[180:181]
    v_pk_fma_f32 v[126:127], v[126:127], v[174:175], v[182:183]
    v_cvt_pk_bf16_f32 v56, v120, v121
    ds_read_b128 v[160:163], v227 offset:9728
    v_cvt_pk_bf16_f32 v57, v122, v123
    v_cvt_pk_bf16_f32 v58, v124, v125
    v_cvt_pk_bf16_f32 v59, v126, v127
    ds_read_b128 v[164:167], v227 offset:9744
    s_add_u32 s36, s36, 4096
    buffer_load_dwordx4 a[192:195], v8, s[28:31], s36 offen offset:0
    v_dot2_f32_bf16 v216, v56, v224, v216
    v_dot2_f32_bf16 v217, v56, v56, v217
    v_dot2_f32_bf16 v216, v57, v224, v216
    v_dot2_f32_bf16 v217, v57, v57, v217
    v_dot2_f32_bf16 v216, v58, v224, v216
    v_dot2_f32_bf16 v217, v58, v58, v217
    v_dot2_f32_bf16 v216, v59, v224, v216
    v_dot2_f32_bf16 v217, v59, v59, v217
    ds_write_b128 v228, v[56:59] offset:12288
    v_pk_fma_f32 v[128:129], v[128:129], v[222:223], v[222:223] op_sel:[0,1,0] op_sel_hi:[1,1,0]
    buffer_load_dwordx4 a[196:199], v8, s[28:31], s36 offen offset:1024
    v_pk_fma_f32 v[130:131], v[130:131], v[222:223], v[222:223] op_sel:[0,1,0] op_sel_hi:[1,1,0]
    v_pk_fma_f32 v[132:133], v[132:133], v[222:223], v[222:223] op_sel:[0,1,0] op_sel_hi:[1,1,0]
    v_pk_fma_f32 v[134:135], v[134:135], v[222:223], v[222:223] op_sel:[0,1,0] op_sel_hi:[1,1,0]
    v_pk_fma_f32 v[128:129], v[128:129], v[168:169], v[176:177]
    v_pk_fma_f32 v[130:131], v[130:131], v[170:171], v[178:179]
    v_pk_fma_f32 v[132:133], v[132:133], v[172:173], v[180:181]
    v_pk_fma_f32 v[134:135], v[134:135], v[174:175], v[182:183]
    v_cvt_pk_bf16_f32 v60, v128, v129
    v_cvt_pk_bf16_f32 v61, v130, v131
    v_cvt_pk_bf16_f32 v62, v132, v133
    v_cvt_pk_bf16_f32 v63, v134, v135
    v_dot2_f32_bf16 v218, v60, v224, v218
    v_dot2_f32_bf16 v219, v60, v60, v219
    v_dot2_f32_bf16 v218, v61, v224, v218
    v_dot2_f32_bf16 v219, v61, v61, v219
    v_dot2_f32_bf16 v218, v62, v224, v218
    v_dot2_f32_bf16 v219, v62, v62, v219
    buffer_load_dwordx4 a[200:203], v8, s[28:31], s37 offen offset:0
    v_dot2_f32_bf16 v218, v63, v224, v218
    v_dot2_f32_bf16 v219, v63, v63, v219
    ds_write_b128 v12, v[60:63] offset:12288
    s_waitcnt lgkmcnt(1)
    v_pk_fma_f32 v[136:137], v[136:137], v[220:221], v[220:221] op_sel:[0,1,0] op_sel_hi:[1,1,0]
    v_pk_fma_f32 v[138:139], v[138:139], v[220:221], v[220:221] op_sel:[0,1,0] op_sel_hi:[1,1,0]
    v_pk_fma_f32 v[140:141], v[140:141], v[220:221], v[220:221] op_sel:[0,1,0] op_sel_hi:[1,1,0]
    v_pk_fma_f32 v[142:143], v[142:143], v[220:221], v[220:221] op_sel:[0,1,0] op_sel_hi:[1,1,0]
    v_pk_fma_f32 v[136:137], v[136:137], v[152:153], v[160:161]
    v_pk_fma_f32 v[138:139], v[138:139], v[154:155], v[162:163]
    buffer_load_dwordx4 a[204:207], v8, s[28:31], s37 offen offset:1024
    v_pk_fma_f32 v[140:141], v[140:141], v[156:157], v[164:165]
    v_pk_fma_f32 v[142:143], v[142:143], v[158:159], v[166:167]
    v_cvt_pk_bf16_f32 v64, v136, v137
    v_cvt_pk_bf16_f32 v65, v138, v139
    v_cvt_pk_bf16_f32 v66, v140, v141
    v_cvt_pk_bf16_f32 v67, v142, v143
    v_dot2_f32_bf16 v216, v64, v224, v216
    v_dot2_f32_bf16 v217, v64, v64, v217
    v_dot2_f32_bf16 v216, v65, v224, v216
    v_dot2_f32_bf16 v217, v65, v65, v217
    v_dot2_f32_bf16 v216, v66, v224, v216
    v_dot2_f32_bf16 v217, v66, v66, v217
    v_dot2_f32_bf16 v216, v67, v224, v216
    v_dot2_f32_bf16 v217, v67, v67, v217
    ds_write_b128 v228, v[64:67] offset:16384
    buffer_load_dwordx4 a[208:211], v8, s[28:31], s37 offen offset:2048
    v_pk_fma_f32 v[144:145], v[144:145], v[222:223], v[222:223] op_sel:[0,1,0] op_sel_hi:[1,1,0]
    v_pk_fma_f32 v[146:147], v[146:147], v[222:223], v[222:223] op_sel:[0,1,0] op_sel_hi:[1,1,0]
    v_pk_fma_f32 v[148:149], v[148:149], v[222:223], v[222:223] op_sel:[0,1,0] op_sel_hi:[1,1,0]
    v_pk_fma_f32 v[150:151], v[150:151], v[222:223], v[222:223] op_sel:[0,1,0] op_sel_hi:[1,1,0]
    v_pk_fma_f32 v[144:145], v[144:145], v[152:153], v[160:161]
    v_pk_fma_f32 v[146:147], v[146:147], v[154:155], v[162:163]
    v_pk_fma_f32 v[148:149], v[148:149], v[156:157], v[164:165]
    v_pk_fma_f32 v[150:151], v[150:151], v[158:159], v[166:167]
    v_cvt_pk_bf16_f32 v68, v144, v145
    v_cvt_pk_bf16_f32 v69, v146, v147
    v_cvt_pk_bf16_f32 v70, v148, v149
    v_cvt_pk_bf16_f32 v71, v150, v151
    v_dot2_f32_bf16 v218, v68, v224, v218
    v_dot2_f32_bf16 v219, v68, v68, v219
    v_dot2_f32_bf16 v218, v69, v224, v218
    v_dot2_f32_bf16 v219, v69, v69, v219
    v_dot2_f32_bf16 v218, v70, v224, v218
    buffer_load_dwordx4 a[212:215], v8, s[28:31], s37 offen offset:3072
    v_dot2_f32_bf16 v219, v70, v70, v219
    v_dot2_f32_bf16 v218, v71, v224, v218
    v_dot2_f32_bf16 v219, v71, v71, v219
    ds_write_b128 v12, v[68:71] offset:16384
    s_waitcnt lgkmcnt(0)
    s_barrier
    ds_read_b128 v[72:75], v229 offset:0
    ds_read_b128 v[76:79], v231 offset:0
    s_add_u32 s37, s37, 4096
    buffer_load_dwordx4 a[216:219], v8, s[28:31], s37 offen offset:0
    s_waitcnt vmcnt(50) lgkmcnt(0)
    v_mfma_f32_16x16x32_bf16 v[32:35], a[0:3], v[72:75], 0
    v_mfma_f32_16x16x32_bf16 v[52:55], a[0:3], v[76:79], 0
    ds_read_b128 v[80:83], v230 offset:1024
    v_mfma_f32_16x16x32_bf16 v[36:39], a[4:7], v[72:75], 0
    v_mfma_f32_16x16x32_bf16 v[56:59], a[4:7], v[76:79], 0
    buffer_load_dwordx4 a[220:223], v8, s[28:31], s37 offen offset:1024
    ds_read_b128 v[84:87], v232 offset:1024
    v_mfma_f32_16x16x32_bf16 v[40:43], a[8:11], v[72:75], 0
    v_mfma_f32_16x16x32_bf16 v[60:63], a[8:11], v[76:79], 0
    ds_read_b128 v[112:115], v233 offset:0
    v_mfma_f32_16x16x32_bf16 v[44:47], a[12:15], v[72:75], 0
    buffer_load_dwordx4 a[224:227], v8, s[28:31], s37 offen offset:2048
    v_mfma_f32_16x16x32_bf16 v[64:67], a[12:15], v[76:79], 0
    ds_read_b128 v[132:135], v233 offset:1024
    v_mfma_f32_16x16x32_bf16 v[48:51], a[16:19], v[72:75], 0
    v_mfma_f32_16x16x32_bf16 v[68:71], a[16:19], v[76:79], 0
    s_waitcnt vmcnt(47) lgkmcnt(0)
    v_mfma_f32_16x16x32_bf16 v[32:35], a[20:23], v[80:83], v[32:35]
    buffer_load_dwordx4 a[228:231], v8, s[28:31], s37 offen offset:3072
    v_add_f32_dpp v216, v216, v216 quad_perm:[1,0,3,2] row_mask:0xf bank_mask:0xf
    v_mfma_f32_16x16x32_bf16 v[52:55], a[20:23], v[84:87], v[52:55]
    ds_read_b128 v[72:75], v229 offset:2048
    v_mfma_f32_16x16x32_bf16 v[36:39], a[24:27], v[80:83], v[36:39]
    v_add_f32_dpp v217, v217, v217 quad_perm:[1,0,3,2] row_mask:0xf bank_mask:0xf
    v_mfma_f32_16x16x32_bf16 v[56:59], a[24:27], v[84:87], v[56:59]
    ds_read_b128 v[76:79], v231 offset:2048
    s_add_u32 s37, s37, 4096
    buffer_load_dwordx4 a[232:235], v8, s[28:31], s37 offen offset:0
    v_mfma_f32_16x16x32_bf16 v[40:43], a[28:31], v[80:83], v[40:43]
    v_add_f32_dpp v218, v218, v218 quad_perm:[1,0,3,2] row_mask:0xf bank_mask:0xf
    v_mfma_f32_16x16x32_bf16 v[60:63], a[28:31], v[84:87], v[60:63]
    ds_read_b128 v[116:119], v233 offset:64
    v_mfma_f32_16x16x32_bf16 v[44:47], a[32:35], v[80:83], v[44:47]
    v_add_f32_dpp v219, v219, v219 quad_perm:[1,0,3,2] row_mask:0xf bank_mask:0xf
    v_mfma_f32_16x16x32_bf16 v[64:67], a[32:35], v[84:87], v[64:67]
    buffer_load_dwordx4 a[236:239], v8, s[28:31], s37 offen offset:1024
    ds_read_b128 v[136:139], v233 offset:1088
    v_mfma_f32_16x16x32_bf16 v[48:51], a[36:39], v[80:83], v[48:51]
    v_add_f32_dpp v216, v216, v216 quad_perm:[2,3,0,1] row_mask:0xf bank_mask:0xf
    v_mfma_f32_16x16x32_bf16 v[68:71], a[36:39], v[84:87], v[68:71]
    v_add_f32_dpp v217, v217, v217 quad_perm:[2,3,0,1] row_mask:0xf bank_mask:0xf
    s_waitcnt vmcnt(45) lgkmcnt(0)
    v_mfma_f32_16x16x32_bf16 v[32:35], a[40:43], v[72:75], v[32:35]
    buffer_load_dwordx4 a[240:243], v8, s[28:31], s37 offen offset:2048
    v_add_f32_dpp v218, v218, v218 quad_perm:[2,3,0,1] row_mask:0xf bank_mask:0xf
    v_mfma_f32_16x16x32_bf16 v[52:55], a[40:43], v[76:79], v[52:55]
    ds_read_b128 v[80:83], v230 offset:3072
    v_mfma_f32_16x16x32_bf16 v[36:39], a[44:47], v[72:75], v[36:39]
    v_add_f32_dpp v219, v219, v219 quad_perm:[2,3,0,1] row_mask:0xf bank_mask:0xf
    v_mfma_f32_16x16x32_bf16 v[56:59], a[44:47], v[76:79], v[56:59]
    ds_read_b128 v[84:87], v232 offset:3072
    buffer_load_dwordx4 a[244:247], v8, s[28:31], s37 offen offset:3072
    v_mfma_f32_16x16x32_bf16 v[40:43], a[48:51], v[72:75], v[40:43]
    v_add_f32_dpp v216, v216, v216 row_half_mirror row_mask:0xf bank_mask:0xf
    v_mfma_f32_16x16x32_bf16 v[60:63], a[48:51], v[76:79], v[60:63]
    ds_read_b128 v[120:123], v233 offset:128
    v_mfma_f32_16x16x32_bf16 v[44:47], a[52:55], v[72:75], v[44:47]
    v_add_f32_dpp v217, v217, v217 row_half_mirror row_mask:0xf bank_mask:0xf
    v_mfma_f32_16x16x32_bf16 v[64:67], a[52:55], v[76:79], v[64:67]
    s_add_u32 s37, s37, 4096
    buffer_load_dwordx4 a[248:251], v8, s[28:31], s37 offen offset:0
    ds_read_b128 v[140:143], v233 offset:1152
    v_mfma_f32_16x16x32_bf16 v[48:51], a[56:59], v[72:75], v[48:51]
    v_add_f32_dpp v218, v218, v218 row_half_mirror row_mask:0xf bank_mask:0xf
    v_mfma_f32_16x16x32_bf16 v[68:71], a[56:59], v[76:79], v[68:71]
    v_add_f32_dpp v219, v219, v219 row_half_mirror row_mask:0xf bank_mask:0xf
    s_waitcnt vmcnt(43) lgkmcnt(0)
    v_mfma_f32_16x16x32_bf16 v[32:35], a[60:63], v[80:83], v[32:35]
    buffer_load_dwordx4 a[252:255], v8, s[28:31], s37 offen offset:1024
    v_add_f32_dpp v216, v216, v216 row_mirror row_mask:0xf bank_mask:0xf
    v_mfma_f32_16x16x32_bf16 v[52:55], a[60:63], v[84:87], v[52:55]
    ds_read_b128 v[72:75], v229 offset:4096
    v_mfma_f32_16x16x32_bf16 v[36:39], a[64:67], v[80:83], v[36:39]
    v_add_f32_dpp v217, v217, v217 row_mirror row_mask:0xf bank_mask:0xf
    v_mfma_f32_16x16x32_bf16 v[56:59], a[64:67], v[84:87], v[56:59]
    ds_read_b128 v[76:79], v231 offset:4096
    buffer_load_dwordx4 a[0:3], v8, s[28:31], s37 offen offset:2048
    v_mfma_f32_16x16x32_bf16 v[40:43], a[68:71], v[80:83], v[40:43]
    v_add_f32_dpp v218, v218, v218 row_mirror row_mask:0xf bank_mask:0xf
    v_mfma_f32_16x16x32_bf16 v[60:63], a[68:71], v[84:87], v[60:63]
    ds_read_b128 v[124:127], v233 offset:192
    v_mfma_f32_16x16x32_bf16 v[44:47], a[72:75], v[80:83], v[44:47]
    v_add_f32_dpp v219, v219, v219 row_mirror row_mask:0xf bank_mask:0xf
    v_mfma_f32_16x16x32_bf16 v[64:67], a[72:75], v[84:87], v[64:67]
    buffer_load_dwordx4 a[4:7], v8, s[28:31], s37 offen offset:3072
    ds_read_b128 v[144:147], v233 offset:1216
    v_mfma_f32_16x16x32_bf16 v[48:51], a[76:79], v[80:83], v[48:51]
    v_mul_f32 v216, 0x3acccccd, v216
    v_mfma_f32_16x16x32_bf16 v[68:71], a[76:79], v[84:87], v[68:71]
    v_mul_f32 v218, 0x3acccccd, v218
    s_waitcnt vmcnt(41) lgkmcnt(0)
    v_mfma_f32_16x16x32_bf16 v[32:35], a[80:83], v[72:75], v[32:35]
    s_add_u32 s37, s37, 4096
    buffer_load_dwordx4 a[8:11], v8, s[28:31], s37 offen offset:0
    v_mul_f32 v217, 0x3acccccd, v217
    v_mfma_f32_16x16x32_bf16 v[52:55], a[80:83], v[76:79], v[52:55]
    ds_read_b128 v[80:83], v230 offset:5120
    v_mfma_f32_16x16x32_bf16 v[36:39], a[84:87], v[72:75], v[36:39]
    v_mul_f32 v219, 0x3acccccd, v219
    v_mfma_f32_16x16x32_bf16 v[56:59], a[84:87], v[76:79], v[56:59]
    ds_read_b128 v[84:87], v232 offset:5120
    buffer_load_dwordx4 a[12:15], v8, s[28:31], s37 offen offset:1024
    v_mfma_f32_16x16x32_bf16 v[40:43], a[88:91], v[72:75], v[40:43]
    v_fma_f32 v217, -v216, v216, v217
    v_mfma_f32_16x16x32_bf16 v[60:63], a[88:91], v[76:79], v[60:63]
    ds_read_b128 v[128:131], v234
    v_mfma_f32_16x16x32_bf16 v[44:47], a[92:95], v[72:75], v[44:47]
    v_fma_f32 v219, -v218, v218, v219
    v_mfma_f32_16x16x32_bf16 v[64:67], a[92:95], v[76:79], v[64:67]
    buffer_load_dwordx4 a[16:19], v8, s[28:31], s37 offen offset:2048
    ds_read_b128 v[148:151], v234 offset:1024
    v_mfma_f32_16x16x32_bf16 v[48:51], a[96:99], v[72:75], v[48:51]
    v_max_f32 v217, 0, v217
    v_mfma_f32_16x16x32_bf16 v[68:71], a[96:99], v[76:79], v[68:71]
    v_max_f32 v219, 0, v219
    s_waitcnt vmcnt(39) lgkmcnt(0)
    v_mfma_f32_16x16x32_bf16 v[32:35], a[100:103], v[80:83], v[32:35]
    buffer_load_dwordx4 a[20:23], v8, s[28:31], s37 offen offset:3072
    v_cvt_pk_bf16_f32 v192, v216, v217
    v_mfma_f32_16x16x32_bf16 v[52:55], a[100:103], v[84:87], v[52:55]
    ds_read_b128 v[72:75], v229 offset:6144
    v_mfma_f32_16x16x32_bf16 v[36:39], a[104:107], v[80:83], v[36:39]
    v_cvt_pk_bf16_f32 v193, v218, v219
    v_mfma_f32_16x16x32_bf16 v[56:59], a[104:107], v[84:87], v[56:59]
    ds_read_b128 v[76:79], v231 offset:6144
    s_add_u32 s37, s37, 4096
    buffer_load_dwordx4 a[24:27], v8, s[28:31], s37 offen offset:0
    v_mfma_f32_16x16x32_bf16 v[40:43], a[108:111], v[80:83], v[40:43]
    v_lshlrev_b32 v216, 16, v192
    v_mfma_f32_16x16x32_bf16 v[60:63], a[108:111], v[84:87], v[60:63]
    ds_read_b64 v[16:17], v236
    v_mfma_f32_16x16x32_bf16 v[44:47], a[112:115], v[80:83], v[44:47]
    v_lshlrev_b32 v218, 16, v193
    v_mfma_f32_16x16x32_bf16 v[64:67], a[112:115], v[84:87], v[64:67]
    buffer_load_dwordx4 a[28:31], v8, s[28:31], s37 offen offset:1024
    ds_read_b64 v[18:19], v237
    v_mfma_f32_16x16x32_bf16 v[48:51], a[116:119], v[80:83], v[48:51]
    v_and_b32 v217, 0xffff0000, v192
    v_mfma_f32_16x16x32_bf16 v[68:71], a[116:119], v[84:87], v[68:71]
    v_and_b32 v219, 0xffff0000, v193
    s_waitcnt vmcnt(37) lgkmcnt(0)
    v_mfma_f32_16x16x32_bf16 v[32:35], a[120:123], v[72:75], v[32:35]
    buffer_load_dwordx4 a[32:35], v8, s[28:31], s37 offen offset:2048
    v_add_f32 v217, 0x3727c5ac, v217
    v_mfma_f32_16x16x32_bf16 v[52:55], a[120:123], v[76:79], v[52:55]
    ds_read_b128 v[80:83], v230 offset:7168
    v_mfma_f32_16x16x32_bf16 v[36:39], a[124:127], v[72:75], v[36:39]
    v_add_f32 v219, 0x3727c5ac, v219
    v_mfma_f32_16x16x32_bf16 v[56:59], a[124:127], v[76:79], v[56:59]
    ds_read_b128 v[84:87], v232 offset:7168
    buffer_load_dwordx4 a[36:39], v8, s[28:31], s37 offen offset:3072
    v_mfma_f32_16x16x32_bf16 v[40:43], a[128:131], v[72:75], v[40:43]
    v_cvt_pk_bf16_f32 v192, v217, v217
    v_mfma_f32_16x16x32_bf16 v[60:63], a[128:131], v[76:79], v[60:63]
    ds_read_b64 v[20:21], v238
    v_mfma_f32_16x16x32_bf16 v[44:47], a[132:135], v[72:75], v[44:47]
    v_cvt_pk_bf16_f32 v193, v219, v219
    v_mfma_f32_16x16x32_bf16 v[64:67], a[132:135], v[76:79], v[64:67]
    s_add_u32 s37, s37, 4096
    buffer_load_dwordx4 a[40:43], v8, s[28:31], s37 offen offset:0
    ds_read_b64 v[22:23], v239
    v_mfma_f32_16x16x32_bf16 v[48:51], a[136:139], v[72:75], v[48:51]
    v_lshlrev_b32 v217, 16, v192
    v_mfma_f32_16x16x32_bf16 v[68:71], a[136:139], v[76:79], v[68:71]
    v_lshlrev_b32 v219, 16, v193
    s_waitcnt vmcnt(35) lgkmcnt(0)
    v_mfma_f32_16x16x32_bf16 v[32:35], a[140:143], v[80:83], v[32:35]
    buffer_load_dwordx4 a[44:47], v8, s[28:31], s37 offen offset:1024
    v_sqrt_f32 v217, v217
    v_mfma_f32_16x16x32_bf16 v[52:55], a[140:143], v[84:87], v[52:55]
    ds_read_b128 v[72:75], v229 offset:8192
    v_mfma_f32_16x16x32_bf16 v[36:39], a[144:147], v[80:83], v[36:39]
    v_sqrt_f32 v219, v219
    v_mfma_f32_16x16x32_bf16 v[56:59], a[144:147], v[84:87], v[56:59]
    buffer_load_dwordx4 a[48:51], v8, s[28:31], s37 offen offset:2048
    ds_read_b128 v[76:79], v231 offset:8192
    v_mfma_f32_16x16x32_bf16 v[40:43], a[148:151], v[80:83], v[40:43]
    v_cvt_pk_bf16_f32 v192, v217, v217
    v_mfma_f32_16x16x32_bf16 v[60:63], a[148:151], v[84:87], v[60:63]
    ds_read_b64 v[24:25], v240
    v_mfma_f32_16x16x32_bf16 v[44:47], a[152:155], v[80:83], v[44:47]
    buffer_load_dwordx4 a[52:55], v8, s[28:31], s37 offen offset:3072
    v_cvt_pk_bf16_f32 v193, v219, v219
    v_mfma_f32_16x16x32_bf16 v[64:67], a[152:155], v[84:87], v[64:67]
    v_lshlrev_b32 v217, 16, v192
    v_mfma_f32_16x16x32_bf16 v[48:51], a[156:159], v[80:83], v[48:51]
    v_lshlrev_b32 v219, 16, v193
    v_mfma_f32_16x16x32_bf16 v[68:71], a[156:159], v[84:87], v[68:71]
    v_rcp_f32 v217, v217
    s_waitcnt vmcnt(33) lgkmcnt(0)
    s_add_u32 s37, s37, 4096
    buffer_load_dwordx4 a[56:59], v8, s[28:31], s37 offen offset:0
    v_mfma_f32_16x16x32_bf16 v[32:35], a[160:163], v[72:75], v[32:35]
    v_rcp_f32 v219, v219
    v_mfma_f32_16x16x32_bf16 v[52:55], a[160:163], v[76:79], v[52:55]
    ds_read_b128 v[80:83], v230 offset:9216
    v_mfma_f32_16x16x32_bf16 v[36:39], a[164:167], v[72:75], v[36:39]
    v_mul_f32 v216, v216, v217
    buffer_load_dwordx4 a[60:63], v8, s[28:31], s37 offen offset:1024
    v_mfma_f32_16x16x32_bf16 v[56:59], a[164:167], v[76:79], v[56:59]
    ds_read_b128 v[84:87], v232 offset:9216
    v_mfma_f32_16x16x32_bf16 v[40:43], a[168:171], v[72:75], v[40:43]
    v_mul_f32 v218, v218, v219
    v_mfma_f32_16x16x32_bf16 v[60:63], a[168:171], v[76:79], v[60:63]
    v_sub_f32 v216, 0, v216
    v_mfma_f32_16x16x32_bf16 v[44:47], a[172:175], v[72:75], v[44:47]
    buffer_load_dwordx4 a[64:67], v8, s[28:31], s37 offen offset:2048
    v_sub_f32 v218, 0, v218
    v_mfma_f32_16x16x32_bf16 v[64:67], a[172:175], v[76:79], v[64:67]
    s_lshl_b32 s26, s20, 6
    v_mfma_f32_16x16x32_bf16 v[48:51], a[176:179], v[72:75], v[48:51]
    v_lshl_add_u32 v2, v3, 3, s26
    v_mfma_f32_16x16x32_bf16 v[68:71], a[176:179], v[76:79], v[68:71]
    v_add_u32 v2, 138240, v2
    s_waitcnt vmcnt(31) lgkmcnt(0)
    v_mfma_f32_16x16x32_bf16 v[32:35], a[180:183], v[80:83], v[32:35]
    buffer_load_dwordx4 a[68:71], v8, s[28:31], s37 offen offset:3072
    ds_write_b64 v2, v[216:217]
    v_mfma_f32_16x16x32_bf16 v[52:55], a[180:183], v[84:87], v[52:55]
    ds_write_b64 v2, v[218:219] offset:32
    s_add_u32 s37, s37, 4096
    buffer_load_dwordx4 a[72:75], v8, s[28:31], s37 offen offset:0
    v_mfma_f32_16x16x32_bf16 v[36:39], a[184:187], v[80:83], v[36:39]
    v_mfma_f32_16x16x32_bf16 v[56:59], a[184:187], v[84:87], v[56:59]
    v_mfma_f32_16x16x32_bf16 v[40:43], a[188:191], v[80:83], v[40:43]
    v_mfma_f32_16x16x32_bf16 v[60:63], a[188:191], v[84:87], v[60:63]
    v_mfma_f32_16x16x32_bf16 v[44:47], a[192:195], v[80:83], v[44:47]
    buffer_load_dwordx4 a[76:79], v8, s[28:31], s37 offen offset:1024
    v_mfma_f32_16x16x32_bf16 v[64:67], a[192:195], v[84:87], v[64:67]
    v_mfma_f32_16x16x32_bf16 v[48:51], a[196:199], v[80:83], v[48:51]
    v_mfma_f32_16x16x32_bf16 v[68:71], a[196:199], v[84:87], v[68:71]
    s_waitcnt lgkmcnt(0)
    s_nop 4
    ds_write_b128 v246, v[52:55] offset:0
    buffer_load_dwordx4 a[80:83], v8, s[28:31], s37 offen offset:2048
    ds_write_b128 v246, v[56:59] offset:1024
    ds_write_b128 v246, v[60:63] offset:2048
    buffer_load_dwordx4 a[84:87], v8, s[28:31], s37 offen offset:3072
    ds_write_b128 v246, v[64:67] offset:3072
    ds_write_b128 v246, v[68:71] offset:4096
    s_add_u32 s37, s37, 4096
    buffer_load_dwordx4 a[88:91], v8, s[28:31], s37 offen offset:0
    v_pk_add_f32 v[112:113], v[112:113], v[132:133]
    v_pk_add_f32 v[114:115], v[114:115], v[134:135]
    v_pk_add_f32 v[116:117], v[116:117], v[136:137]
    v_pk_add_f32 v[118:119], v[118:119], v[138:139]
    v_pk_add_f32 v[120:121], v[120:121], v[140:141]
    v_pk_add_f32 v[122:123], v[122:123], v[142:143]
    v_pk_add_f32 v[124:125], v[124:125], v[144:145]
    v_pk_add_f32 v[126:127], v[126:127], v[146:147]
    v_pk_add_f32 v[128:129], v[128:129], v[148:149]
    v_pk_add_f32 v[130:131], v[130:131], v[150:151]
    v_mov_b32 v30, 0xbdd2d3e8
    v_mov_b32 v31, 0xc0135761
    s_waitcnt lgkmcnt(0)
    s_barrier
    ds_read_b64 v[152:153], v235
    buffer_load_dwordx4 a[92:95], v8, s[28:31], s37 offen offset:1024
    ds_read_b128 v[88:91], v247 offset:0
    ds_read_b128 v[92:95], v247 offset:1024
    ds_read_b128 v[96:99], v247 offset:2048
    ds_read_b128 v[100:103], v247 offset:3072
    ds_read_b128 v[104:107], v247 offset:4096
    s_waitcnt lgkmcnt(5)
    v_pk_mul_f32 v[112:113], v[112:113], v[152:153] op_sel_hi:[1,0]
    buffer_load_dwordx4 a[96:99], v8, s[28:31], s37 offen offset:2048
    v_pk_mul_f32 v[114:115], v[114:115], v[152:153] op_sel_hi:[1,0]
    v_pk_mul_f32 v[116:117], v[116:117], v[152:153] op_sel_hi:[1,0]
    v_pk_mul_f32 v[118:119], v[118:119], v[152:153] op_sel_hi:[1,0]
    v_pk_mul_f32 v[120:121], v[120:121], v[152:153] op_sel_hi:[1,0]
    v_pk_mul_f32 v[122:123], v[122:123], v[152:153] op_sel_hi:[1,0]
    v_pk_mul_f32 v[124:125], v[124:125], v[152:153] op_sel_hi:[1,0]
    v_pk_mul_f32 v[126:127], v[126:127], v[152:153] op_sel_hi:[1,0]
    v_pk_mul_f32 v[128:129], v[128:129], v[152:153] op_sel_hi:[1,0]
    v_pk_mul_f32 v[130:131], v[130:131], v[152:153] op_sel_hi:[1,0]
    s_waitcnt lgkmcnt(4)
    v_pk_add_f32 v[32:33], v[32:33], v[88:89]
    v_pk_add_f32 v[34:35], v[34:35], v[90:91]
    s_waitcnt lgkmcnt(3)
    v_pk_add_f32 v[36:37], v[36:37], v[92:93]
    v_pk_add_f32 v[38:39], v[38:39], v[94:95]
    s_waitcnt lgkmcnt(2)
    v_pk_add_f32 v[40:41], v[40:41], v[96:97]
    buffer_load_dwordx4 a[100:103], v8, s[28:31], s37 offen offset:3072
    v_pk_add_f32 v[42:43], v[42:43], v[98:99]
    s_waitcnt lgkmcnt(1)
    v_pk_add_f32 v[44:45], v[44:45], v[100:101]
    v_pk_add_f32 v[46:47], v[46:47], v[102:103]
    s_waitcnt lgkmcnt(0)
    v_pk_add_f32 v[48:49], v[48:49], v[104:105]
    v_pk_add_f32 v[50:51], v[50:51], v[106:107]
    v_pk_fma_f32 v[32:33], v[32:33], v[152:153], v[112:113] op_sel:[0,1,0] op_sel_hi:[1,1,1]
    v_pk_fma_f32 v[34:35], v[34:35], v[152:153], v[114:115] op_sel:[0,1,0] op_sel_hi:[1,1,1]
    v_pk_fma_f32 v[36:37], v[36:37], v[152:153], v[116:117] op_sel:[0,1,0] op_sel_hi:[1,1,1]
    v_pk_fma_f32 v[38:39], v[38:39], v[152:153], v[118:119] op_sel:[0,1,0] op_sel_hi:[1,1,1]
    v_pk_fma_f32 v[40:41], v[40:41], v[152:153], v[120:121] op_sel:[0,1,0] op_sel_hi:[1,1,1]
    v_pk_fma_f32 v[42:43], v[42:43], v[152:153], v[122:123] op_sel:[0,1,0] op_sel_hi:[1,1,1]
    v_pk_fma_f32 v[44:45], v[44:45], v[152:153], v[124:125] op_sel:[0,1,0] op_sel_hi:[1,1,1]
    v_pk_fma_f32 v[46:47], v[46:47], v[152:153], v[126:127] op_sel:[0,1,0] op_sel_hi:[1,1,1]
    v_pk_fma_f32 v[48:49], v[48:49], v[152:153], v[128:129] op_sel:[0,1,0] op_sel_hi:[1,1,1]
    v_pk_fma_f32 v[50:51], v[50:51], v[152:153], v[130:131] op_sel:[0,1,0] op_sel_hi:[1,1,1]
    s_add_u32 s37, s37, 4096
    buffer_load_dwordx4 a[104:107], v8, s[28:31], s37 offen offset:0
    v_pk_mul_f32 v[192:193], v[32:33], v[32:33]
    v_pk_mul_f32 v[194:195], v[34:35], v[34:35]
    v_pk_mul_f32 v[196:197], v[36:37], v[36:37]
    v_pk_mul_f32 v[198:199], v[38:39], v[38:39]
    v_pk_mul_f32 v[200:201], v[40:41], v[40:41]
    v_pk_mul_f32 v[202:203], v[42:43], v[42:43]
    v_pk_mul_f32 v[204:205], v[44:45], v[44:45]
    v_pk_mul_f32 v[206:207], v[46:47], v[46:47]
    v_pk_mul_f32 v[208:209], v[48:49], v[48:49]
    v_pk_mul_f32 v[210:211], v[50:51], v[50:51]
    v_pk_fma_f32 v[192:193], v[192:193], v[30:31], v[30:31] op_sel:[0,0,1] op_sel_hi:[1,0,1]
    v_pk_fma_f32 v[194:195], v[194:195], v[30:31], v[30:31] op_sel:[0,0,1] op_sel_hi:[1,0,1]
    v_pk_fma_f32 v[196:197], v[196:197], v[30:31], v[30:31] op_sel:[0,0,1] op_sel_hi:[1,0,1]
    v_pk_fma_f32 v[198:199], v[198:199], v[30:31], v[30:31] op_sel:[0,0,1] op_sel_hi:[1,0,1]
    v_pk_fma_f32 v[200:201], v[200:201], v[30:31], v[30:31] op_sel:[0,0,1] op_sel_hi:[1,0,1]
    v_pk_fma_f32 v[202:203], v[202:203], v[30:31], v[30:31] op_sel:[0,0,1] op_sel_hi:[1,0,1]
    v_pk_fma_f32 v[204:205], v[204:205], v[30:31], v[30:31] op_sel:[0,0,1] op_sel_hi:[1,0,1]
    buffer_load_dwordx4 a[108:111], v8, s[28:31], s37 offen offset:1024
    v_pk_fma_f32 v[206:207], v[206:207], v[30:31], v[30:31] op_sel:[0,0,1] op_sel_hi:[1,0,1]
    v_pk_fma_f32 v[208:209], v[208:209], v[30:31], v[30:31] op_sel:[0,0,1] op_sel_hi:[1,0,1]
    v_pk_fma_f32 v[210:211], v[210:211], v[30:31], v[30:31] op_sel:[0,0,1] op_sel_hi:[1,0,1]
    v_pk_mul_f32 v[192:193], v[192:193], v[32:33]
    v_pk_mul_f32 v[194:195], v[194:195], v[34:35]
    v_pk_mul_f32 v[196:197], v[196:197], v[36:37]
    v_pk_mul_f32 v[198:199], v[198:199], v[38:39]
    v_pk_mul_f32 v[200:201], v[200:201], v[40:41]
    v_pk_mul_f32 v[202:203], v[202:203], v[42:43]
    v_pk_mul_f32 v[204:205], v[204:205], v[44:45]
    v_pk_mul_f32 v[206:207], v[206:207], v[46:47]
    v_pk_mul_f32 v[208:209], v[208:209], v[48:49]
    v_pk_mul_f32 v[210:211], v[210:211], v[50:51]
    v_exp_f32 v192, v192
    v_exp_f32 v193, v193
    buffer_load_dwordx4 a[112:115], v8, s[28:31], s37 offen offset:2048
    v_exp_f32 v194, v194
    v_exp_f32 v195, v195
    v_exp_f32 v196, v196
    v_exp_f32 v197, v197
    v_exp_f32 v198, v198
    v_exp_f32 v199, v199
    v_exp_f32 v200, v200
    v_exp_f32 v201, v201
    v_exp_f32 v202, v202
    buffer_load_dwordx4 a[116:119], v8, s[28:31], s37 offen offset:3072
    v_exp_f32 v203, v203
    v_exp_f32 v204, v204
    v_exp_f32 v205, v205
    v_exp_f32 v206, v206
    v_exp_f32 v207, v207
    v_exp_f32 v208, v208
    v_exp_f32 v209, v209
    v_exp_f32 v210, v210
    v_exp_f32 v211, v211
    s_add_u32 s37, s37, 4096
    buffer_load_dwordx4 a[120:123], v8, s[28:31], s37 offen offset:0
    v_pk_add_f32 v[192:193], v[192:193], 1.0 op_sel_hi:[1,0]
    v_pk_add_f32 v[194:195], v[194:195], 1.0 op_sel_hi:[1,0]
    v_pk_add_f32 v[196:197], v[196:197], 1.0 op_sel_hi:[1,0]
    v_pk_add_f32 v[198:199], v[198:199], 1.0 op_sel_hi:[1,0]
    v_pk_add_f32 v[200:201], v[200:201], 1.0 op_sel_hi:[1,0]
    v_pk_add_f32 v[202:203], v[202:203], 1.0 op_sel_hi:[1,0]
    v_pk_add_f32 v[204:205], v[204:205], 1.0 op_sel_hi:[1,0]
    v_pk_add_f32 v[206:207], v[206:207], 1.0 op_sel_hi:[1,0]
    v_pk_add_f32 v[208:209], v[208:209], 1.0 op_sel_hi:[1,0]
    v_pk_add_f32 v[210:211], v[210:211], 1.0 op_sel_hi:[1,0]
    v_rcp_f32 v192, v192
    v_rcp_f32 v193, v193
    v_rcp_f32 v194, v194
    v_rcp_f32 v195, v195
    buffer_load_dwordx4 a[124:127], v8, s[28:31], s37 offen offset:1024
    v_rcp_f32 v196, v196
    v_rcp_f32 v197, v197
    v_rcp_f32 v198, v198
    v_rcp_f32 v199, v199
    v_rcp_f32 v200, v200
    v_rcp_f32 v201, v201
    v_rcp_f32 v202, v202
    v_rcp_f32 v203, v203
    v_rcp_f32 v204, v204
    buffer_load_dwordx4 a[128:131], v8, s[28:31], s37 offen offset:2048
    v_rcp_f32 v205, v205
    v_rcp_f32 v206, v206
    v_rcp_f32 v207, v207
    v_rcp_f32 v208, v208
    v_rcp_f32 v209, v209
    v_rcp_f32 v210, v210
    v_rcp_f32 v211, v211
    v_pk_mul_f32 v[32:33], v[32:33], v[192:193]
    v_pk_mul_f32 v[34:35], v[34:35], v[194:195]
    v_pk_mul_f32 v[36:37], v[36:37], v[196:197]
    buffer_load_dwordx4 a[132:135], v8, s[28:31], s37 offen offset:3072
    v_pk_mul_f32 v[38:39], v[38:39], v[198:199]
    v_pk_mul_f32 v[40:41], v[40:41], v[200:201]
    v_pk_mul_f32 v[42:43], v[42:43], v[202:203]
    v_pk_mul_f32 v[44:45], v[44:45], v[204:205]
    v_pk_mul_f32 v[46:47], v[46:47], v[206:207]
    v_pk_mul_f32 v[48:49], v[48:49], v[208:209]
    v_pk_mul_f32 v[50:51], v[50:51], v[210:211]
    v_cvt_pk_bf16_f32 v180, v32, v33
    v_cvt_pk_bf16_f32 v181, v34, v35
    v_cvt_pk_bf16_f32 v182, v36, v37
    v_cvt_pk_bf16_f32 v183, v38, v39
    v_cvt_pk_bf16_f32 v184, v40, v41
    v_cvt_pk_bf16_f32 v185, v42, v43
    v_cvt_pk_bf16_f32 v186, v44, v45
    v_cvt_pk_bf16_f32 v187, v46, v47
    v_cvt_pk_bf16_f32 v188, v48, v49
    v_cvt_pk_bf16_f32 v189, v50, v51
    s_nop 1
    v_permlane16_swap_b32 v180, v182
    v_permlane16_swap_b32 v181, v183
    v_permlane16_swap_b32 v184, v186
    v_permlane16_swap_b32 v185, v187
    s_mov_b64 exec, s[60:61]
    buffer_store_dwordx4 v[180:183], v241, s[28:31], s44 offen sc1
    buffer_store_dwordx4 v[184:187], v241, s[28:31], s44 offen offset:1024 sc1
    buffer_store_dwordx2 v[188:189], v242, s[28:31], s45 offen sc1
    s_mov_b64 exec, -1
    s_waitcnt vmcnt(0)
    s_barrier
    s_cmp_lg_u32 s20, 0
    s_cbranch_scc1 chain_kernel_sig1
    v_mov_b32 v2, 1
    v_mov_b32 v7, 0
    s_mov_b64 exec, 1
    buffer_store_dword v2, v7, s[28:31], s46 offen sc1
    s_mov_b64 exec, -1
chain_kernel_sig1:
    s_add_u32 s37, s37, 4096
    buffer_load_dwordx4 a[136:139], v8, s[28:31], s37 offen offset:0
    buffer_load_dwordx4 a[140:143], v8, s[28:31], s37 offen offset:1024
    s_mul_i32 s25, s20, 10
    s_lshl_b32 s25, s25, 10
    s_add_u32 s62, s25, 0
    s_add_u32 s63, s25, s54
    s_add_u32 s63, s63, 0
    s_mov_b32 m0, s62
    buffer_load_dwordx4 v8, s[28:31], s63 offen offset:0 lds
    buffer_load_dwordx4 v8, s[28:31], s63 offen offset:1024 lds
    buffer_load_dwordx4 v8, s[28:31], s63 offen offset:2048 lds
    buffer_load_dwordx4 v8, s[28:31], s63 offen offset:3072 lds
    s_add_u32 s62, s62, 4096
    s_add_u32 s63, s63, 4096
    s_mov_b32 m0, s62
    buffer_load_dwordx4 v8, s[28:31], s63 offen offset:0 lds
    buffer_load_dwordx4 v8, s[28:31], s63 offen offset:1024 lds
    buffer_load_dwordx4 v8, s[28:31], s63 offen offset:2048 lds
    buffer_load_dwordx4 v8, s[28:31], s63 offen offset:3072 lds
    s_add_u32 s62, s62, 4096
    s_add_u32 s63, s63, 4096
    s_mov_b32 m0, s62
    buffer_load_dwordx4 v8, s[28:31], s63 offen offset:0 lds
    buffer_load_dwordx4 v8, s[28:31], s63 offen offset:1024 lds
    s_lshl_b32 s26, s53, 3
    s_lshl_b32 s27, s20, 1
    s_add_u32 s56, s26, s27
    s_mul_i32 s6, s56, 20480
    s_add_u32 s6, s6, 13406208
    s_add_u32 s7, s6, 20480
    s_lshl_b32 s26, s53, 2
    s_add_u32 s26, s26, s20
    s_lshl_b32 s26, s26, 9
    s_add_u32 s8, s26, 29413376
    v_lshlrev_b32 v228, 3, v4
    v_lshl_add_u32 v228, v3, 8, v228
    s_lshl_b32 s9, s56, 10
    s_add_u32 s9, s9, 23105536
    s_and_b32 s42, s52, 1
    s_mul_i32 s12, s52, 7
    s_add_u32 s13, s12, 1
    s_lshr_b32 s13, s13, 1
    s_add_u32 s26, s13, 3
    s_sub_u32 s27, s13, 1
    s_cmp_eq_u32 s42, 1
    s_cselect_b32 s12, s27, s26
    s_lshl_b32 s13, s13, 10
    s_add_u32 s13, s13, 16027648
    s_lshl_b32 s12, s12, 10
    s_add_u32 s12, s12, 16027648
    s_lshl_b32 s14, s56, 4
    s_lshl_b32 s15, s53, 4
    s_add_u32 s15, s15, s52
    s_lshl_b32 s15, s15, 2
    s_add_u32 s15, s15, s20
    s_lshl_b32 s15, s15, 7
    s_add_u32 s15, s15, 29446144
    s_lshr_b32 s26, s43, 4
    s_lshl_b32 s26, s26, 3
    s_lshl_b32 s27, s24, 1
    s_add_u32 s26, s26, s27
    s_add_u32 s26, s26, s21
    s_lshl_b32 s26, s26, 7
    s_add_u32 s19, s26, 23105536
    v_add_u32 v226, s14, v4
    v_lshrrev_b32 v227, 4, v226
    v_and_b32 v226, 15, v226
    s_mov_b32 s27, 55296
    v_mul_lo_u32 v227, v227, s27
    v_lshl_add_u32 v227, v226, 4, v227
    v_and_b32 v226, 1, v3
    v_lshlrev_b32 v226, 9, v226
    v_lshrrev_b32 v2, 1, v3
    v_lshl_add_u32 v226, v2, 8, v226
    v_add_u32 v226, v226, v227
    s_lshl_b32 s27, s42, 9
    v_lshl_add_u32 v227, v2, 8, v227
    v_add_u32 v227, s27, v227
    v_and_b32 v2, 1, v3
    v_lshl_add_u32 v227, v2, 3, v227
    s_mov_b32 s48, 29380608
    s_mov_b32 s47, 0
    s_mov_b64 exec, 15
chain_kernel_poll2:
    buffer_load_dword v2, v245, s[28:31], s48 offen sc1
    s_add_u32 s47, s47, 1
    s_waitcnt vmcnt(0)
    v_cmp_ne_u32 vcc, 1, v2
    s_cmp_ge_u32 s47, 20000
    s_cbranch_scc1 chain_kernel_polld3
    s_cbranch_vccnz chain_kernel_poll2
chain_kernel_polld3:
    s_mov_b64 exec, -1
    buffer_load_dwordx4 v[72:75], v8, s[28:31], s50 offen offset:0 sc1
    buffer_load_dwordx4 v[76:79], v8, s[28:31], s51 offen offset:0 sc1
    buffer_load_dwordx4 v[80:83], v8, s[28:31], s50 offen offset:1024 sc1
    buffer_load_dwordx4 v[84:87], v8, s[28:31], s51 offen offset:1024 sc1
    buffer_load_dwordx4 v[88:91], v8, s[28:31], s50 offen offset:2048 sc1
    buffer_load_dwordx4 v[92:95], v8, s[28:31], s51 offen offset:2048 sc1
    buffer_load_dwordx4 v[96:99], v8, s[28:31], s50 offen offset:3072 sc1
    buffer_load_dwordx4 v[100:103], v8, s[28:31], s51 offen offset:3072 sc1
    s_add_u32 s50, s50, 4096
    s_add_u32 s51, s51, 4096
    buffer_load_dwordx4 v[104:107], v8, s[28:31], s50 offen offset:0 sc1
    buffer_load_dwordx4 v[108:111], v8, s[28:31], s51 offen offset:0 sc1
    s_waitcnt vmcnt(8)
    v_mfma_f32_16x16x32_bf16 v[32:35], a[200:203], v[72:75], 0
    v_mfma_f32_16x16x32_bf16 v[52:55], a[200:203], v[76:79], 0
    buffer_load_dwordx4 v[112:115], v8, s[28:31], s50 offen offset:1024 sc1
    v_mfma_f32_16x16x32_bf16 v[36:39], a[204:207], v[72:75], 0
    v_mfma_f32_16x16x32_bf16 v[56:59], a[204:207], v[76:79], 0
    v_mfma_f32_16x16x32_bf16 v[40:43], a[208:211], v[72:75], 0
    v_mfma_f32_16x16x32_bf16 v[60:63], a[208:211], v[76:79], 0
    buffer_load_dwordx4 v[116:119], v8, s[28:31], s51 offen offset:1024 sc1
    v_mfma_f32_16x16x32_bf16 v[44:47], a[212:215], v[72:75], 0
    v_mfma_f32_16x16x32_bf16 v[64:67], a[212:215], v[76:79], 0
    v_mfma_f32_16x16x32_bf16 v[48:51], a[216:219], v[72:75], 0
    v_mfma_f32_16x16x32_bf16 v[68:71], a[216:219], v[76:79], 0
    s_waitcnt vmcnt(8)
    v_mfma_f32_16x16x32_bf16 v[32:35], a[220:223], v[80:83], v[32:35]
    v_mfma_f32_16x16x32_bf16 v[52:55], a[220:223], v[84:87], v[52:55]
    buffer_load_dwordx4 v[120:123], v8, s[28:31], s50 offen offset:2048 sc1
    v_mfma_f32_16x16x32_bf16 v[36:39], a[224:227], v[80:83], v[36:39]
    v_mfma_f32_16x16x32_bf16 v[56:59], a[224:227], v[84:87], v[56:59]
    v_mfma_f32_16x16x32_bf16 v[40:43], a[228:231], v[80:83], v[40:43]
    v_mfma_f32_16x16x32_bf16 v[60:63], a[228:231], v[84:87], v[60:63]
    buffer_load_dwordx4 v[124:127], v8, s[28:31], s51 offen offset:2048 sc1
    v_mfma_f32_16x16x32_bf16 v[44:47], a[232:235], v[80:83], v[44:47]
    v_mfma_f32_16x16x32_bf16 v[64:67], a[232:235], v[84:87], v[64:67]
    v_mfma_f32_16x16x32_bf16 v[48:51], a[236:239], v[80:83], v[48:51]
    v_mfma_f32_16x16x32_bf16 v[68:71], a[236:239], v[84:87], v[68:71]
    s_waitcnt vmcnt(8)
    v_mfma_f32_16x16x32_bf16 v[32:35], a[240:243], v[88:91], v[32:35]
    v_mfma_f32_16x16x32_bf16 v[52:55], a[240:243], v[92:95], v[52:55]
    buffer_load_dwordx4 v[128:131], v8, s[28:31], s50 offen offset:3072 sc1
    v_mfma_f32_16x16x32_bf16 v[36:39], a[244:247], v[88:91], v[36:39]
    v_mfma_f32_16x16x32_bf16 v[56:59], a[244:247], v[92:95], v[56:59]
    v_mfma_f32_16x16x32_bf16 v[40:43], a[248:251], v[88:91], v[40:43]
    v_mfma_f32_16x16x32_bf16 v[60:63], a[248:251], v[92:95], v[60:63]
    buffer_load_dwordx4 v[132:135], v8, s[28:31], s51 offen offset:3072 sc1
    v_mfma_f32_16x16x32_bf16 v[44:47], a[252:255], v[88:91], v[44:47]
    v_mfma_f32_16x16x32_bf16 v[64:67], a[252:255], v[92:95], v[64:67]
    v_mfma_f32_16x16x32_bf16 v[48:51], a[0:3], v[88:91], v[48:51]
    v_mfma_f32_16x16x32_bf16 v[68:71], a[0:3], v[92:95], v[68:71]
    s_waitcnt vmcnt(8)
    v_mfma_f32_16x16x32_bf16 v[32:35], a[4:7], v[96:99], v[32:35]
    v_mfma_f32_16x16x32_bf16 v[52:55], a[4:7], v[100:103], v[52:55]
    s_add_u32 s50, s50, 4096
    s_add_u32 s51, s51, 4096
    buffer_load_dwordx4 v[136:139], v8, s[28:31], s50 offen offset:0 sc1
    v_mfma_f32_16x16x32_bf16 v[36:39], a[8:11], v[96:99], v[36:39]
    v_mfma_f32_16x16x32_bf16 v[56:59], a[8:11], v[100:103], v[56:59]
    v_mfma_f32_16x16x32_bf16 v[40:43], a[12:15], v[96:99], v[40:43]
    v_mfma_f32_16x16x32_bf16 v[60:63], a[12:15], v[100:103], v[60:63]
    buffer_load_dwordx4 v[140:143], v8, s[28:31], s51 offen offset:0 sc1
    v_mfma_f32_16x16x32_bf16 v[44:47], a[16:19], v[96:99], v[44:47]
    v_mfma_f32_16x16x32_bf16 v[64:67], a[16:19], v[100:103], v[64:67]
    v_mfma_f32_16x16x32_bf16 v[48:51], a[20:23], v[96:99], v[48:51]
    v_mfma_f32_16x16x32_bf16 v[68:71], a[20:23], v[100:103], v[68:71]
    s_waitcnt vmcnt(8)
    v_mfma_f32_16x16x32_bf16 v[32:35], a[24:27], v[104:107], v[32:35]
    v_mfma_f32_16x16x32_bf16 v[52:55], a[24:27], v[108:111], v[52:55]
    buffer_load_dwordx4 v[144:147], v8, s[28:31], s50 offen offset:1024 sc1
    v_mfma_f32_16x16x32_bf16 v[36:39], a[28:31], v[104:107], v[36:39]
    v_mfma_f32_16x16x32_bf16 v[56:59], a[28:31], v[108:111], v[56:59]
    v_mfma_f32_16x16x32_bf16 v[40:43], a[32:35], v[104:107], v[40:43]
    v_mfma_f32_16x16x32_bf16 v[60:63], a[32:35], v[108:111], v[60:63]
    buffer_load_dwordx4 v[148:151], v8, s[28:31], s51 offen offset:1024 sc1
    v_mfma_f32_16x16x32_bf16 v[44:47], a[36:39], v[104:107], v[44:47]
    v_mfma_f32_16x16x32_bf16 v[64:67], a[36:39], v[108:111], v[64:67]
    s_mul_i32 s25, s20, 20
    s_lshl_b32 s25, s25, 10
    s_add_u32 s62, s25, 40960
    s_add_u32 s63, s25, s54
    s_add_u32 s63, s63, 40960
    s_mov_b32 m0, s62
    buffer_load_dwordx4 v8, s[28:31], s63 offen offset:0 lds
    v_mfma_f32_16x16x32_bf16 v[48:51], a[40:43], v[104:107], v[48:51]
    v_mfma_f32_16x16x32_bf16 v[68:71], a[40:43], v[108:111], v[68:71]
    s_waitcnt vmcnt(9)
    v_mfma_f32_16x16x32_bf16 v[32:35], a[44:47], v[112:115], v[32:35]
    v_mfma_f32_16x16x32_bf16 v[52:55], a[44:47], v[116:119], v[52:55]
    buffer_load_dwordx4 v8, s[28:31], s63 offen offset:1024 lds
    v_mfma_f32_16x16x32_bf16 v[36:39], a[48:51], v[112:115], v[36:39]
    v_mfma_f32_16x16x32_bf16 v[56:59], a[48:51], v[116:119], v[56:59]
    buffer_load_dwordx4 v8, s[28:31], s63 offen offset:2048 lds
    v_mfma_f32_16x16x32_bf16 v[40:43], a[52:55], v[112:115], v[40:43]
    v_mfma_f32_16x16x32_bf16 v[60:63], a[52:55], v[116:119], v[60:63]
    v_mfma_f32_16x16x32_bf16 v[44:47], a[56:59], v[112:115], v[44:47]
    v_mfma_f32_16x16x32_bf16 v[64:67], a[56:59], v[116:119], v[64:67]
    buffer_load_dwordx4 v8, s[28:31], s63 offen offset:3072 lds
    v_mfma_f32_16x16x32_bf16 v[48:51], a[60:63], v[112:115], v[48:51]
    v_mfma_f32_16x16x32_bf16 v[68:71], a[60:63], v[116:119], v[68:71]
    s_waitcnt vmcnt(10)
    v_mfma_f32_16x16x32_bf16 v[32:35], a[64:67], v[120:123], v[32:35]
    v_mfma_f32_16x16x32_bf16 v[52:55], a[64:67], v[124:127], v[52:55]
    s_add_u32 s62, s62, 4096
    s_add_u32 s63, s63, 4096
    s_mov_b32 m0, s62
    buffer_load_dwordx4 v8, s[28:31], s63 offen offset:0 lds
    v_mfma_f32_16x16x32_bf16 v[36:39], a[68:71], v[120:123], v[36:39]
    v_mfma_f32_16x16x32_bf16 v[56:59], a[68:71], v[124:127], v[56:59]
    buffer_load_dwordx4 v8, s[28:31], s63 offen offset:1024 lds
    v_mfma_f32_16x16x32_bf16 v[40:43], a[72:75], v[120:123], v[40:43]
    v_mfma_f32_16x16x32_bf16 v[60:63], a[72:75], v[124:127], v[60:63]
    v_mfma_f32_16x16x32_bf16 v[44:47], a[76:79], v[120:123], v[44:47]
    v_mfma_f32_16x16x32_bf16 v[64:67], a[76:79], v[124:127], v[64:67]
    buffer_load_dwordx4 v8, s[28:31], s63 offen offset:2048 lds
    v_mfma_f32_16x16x32_bf16 v[48:51], a[80:83], v[120:123], v[48:51]
    v_mfma_f32_16x16x32_bf16 v[68:71], a[80:83], v[124:127], v[68:71]
    s_waitcnt vmcnt(11)
    v_mfma_f32_16x16x32_bf16 v[32:35], a[84:87], v[128:131], v[32:35]
    v_mfma_f32_16x16x32_bf16 v[52:55], a[84:87], v[132:135], v[52:55]
    buffer_load_dwordx4 v8, s[28:31], s63 offen offset:3072 lds
    v_mfma_f32_16x16x32_bf16 v[36:39], a[88:91], v[128:131], v[36:39]
    v_mfma_f32_16x16x32_bf16 v[56:59], a[88:91], v[132:135], v[56:59]
    s_add_u32 s62, s62, 4096
    s_add_u32 s63, s63, 4096
    s_mov_b32 m0, s62
    buffer_load_dwordx4 v8, s[28:31], s63 offen offset:0 lds
    v_mfma_f32_16x16x32_bf16 v[40:43], a[92:95], v[128:131], v[40:43]
    v_mfma_f32_16x16x32_bf16 v[60:63], a[92:95], v[132:135], v[60:63]
    v_mfma_f32_16x16x32_bf16 v[44:47], a[96:99], v[128:131], v[44:47]
    v_mfma_f32_16x16x32_bf16 v[64:67], a[96:99], v[132:135], v[64:67]
    buffer_load_dwordx4 v8, s[28:31], s63 offen offset:1024 lds
    v_mfma_f32_16x16x32_bf16 v[48:51], a[100:103], v[128:131], v[48:51]
    v_mfma_f32_16x16x32_bf16 v[68:71], a[100:103], v[132:135], v[68:71]
    s_waitcnt vmcnt(12)
    v_mfma_f32_16x16x32_bf16 v[32:35], a[104:107], v[136:139], v[32:35]
    v_mfma_f32_16x16x32_bf16 v[52:55], a[104:107], v[140:143], v[52:55]
    buffer_load_dwordx4 v8, s[28:31], s63 offen offset:2048 lds
    v_mfma_f32_16x16x32_bf16 v[36:39], a[108:111], v[136:139], v[36:39]
    v_mfma_f32_16x16x32_bf16 v[56:59], a[108:111], v[140:143], v[56:59]
    buffer_load_dwordx4 v8, s[28:31], s63 offen offset:3072 lds
    v_mfma_f32_16x16x32_bf16 v[40:43], a[112:115], v[136:139], v[40:43]
    v_mfma_f32_16x16x32_bf16 v[60:63], a[112:115], v[140:143], v[60:63]
    v_mfma_f32_16x16x32_bf16 v[44:47], a[116:119], v[136:139], v[44:47]
    v_mfma_f32_16x16x32_bf16 v[64:67], a[116:119], v[140:143], v[64:67]
    s_add_u32 s62, s62, 4096
    s_add_u32 s63, s63, 4096
    s_mov_b32 m0, s62
    buffer_load_dwordx4 v8, s[28:31], s63 offen offset:0 lds
    v_mfma_f32_16x16x32_bf16 v[48:51], a[120:123], v[136:139], v[48:51]
    v_mfma_f32_16x16x32_bf16 v[68:71], a[120:123], v[140:143], v[68:71]
    s_waitcnt vmcnt(13)
    v_mfma_f32_16x16x32_bf16 v[32:35], a[124:127], v[144:147], v[32:35]
    v_mfma_f32_16x16x32_bf16 v[52:55], a[124:127], v[148:151], v[52:55]
    buffer_load_dwordx4 v8, s[28:31], s63 offen offset:1024 lds
    v_mfma_f32_16x16x32_bf16 v[36:39], a[128:131], v[144:147], v[36:39]
    v_mfma_f32_16x16x32_bf16 v[56:59], a[128:131], v[148:151], v[56:59]
    buffer_load_dwordx4 v8, s[28:31], s63 offen offset:2048 lds
    v_mfma_f32_16x16x32_bf16 v[40:43], a[132:135], v[144:147], v[40:43]
    v_mfma_f32_16x16x32_bf16 v[60:63], a[132:135], v[148:151], v[60:63]
    v_mfma_f32_16x16x32_bf16 v[44:47], a[136:139], v[144:147], v[44:47]
    v_mfma_f32_16x16x32_bf16 v[64:67], a[136:139], v[148:151], v[64:67]
    buffer_load_dwordx4 v8, s[28:31], s63 offen offset:3072 lds
    v_mfma_f32_16x16x32_bf16 v[48:51], a[140:143], v[144:147], v[48:51]
    v_mfma_f32_16x16x32_bf16 v[68:71], a[140:143], v[148:151], v[68:71]
    s_nop 4
    ds_write_b128 v246, v[52:55] offset:0
    ds_write_b128 v246, v[56:59] offset:1024
    ds_write_b128 v246, v[60:63] offset:2048
    ds_write_b128 v246, v[64:67] offset:3072
    ds_write_b128 v246, v[68:71] offset:4096
    v_lshlrev_b32 v112, 16, v16
    v_and_b32 v113, 0xffff0000, v16
    v_lshlrev_b32 v114, 16, v17
    v_and_b32 v115, 0xffff0000, v17
    v_lshlrev_b32 v116, 16, v18
    v_and_b32 v117, 0xffff0000, v18
    v_lshlrev_b32 v118, 16, v19
    v_and_b32 v119, 0xffff0000, v19
    v_lshlrev_b32 v120, 16, v20
    v_and_b32 v121, 0xffff0000, v20
    v_lshlrev_b32 v122, 16, v21
    v_and_b32 v123, 0xffff0000, v21
    v_lshlrev_b32 v124, 16, v22
    v_and_b32 v125, 0xffff0000, v22
    v_lshlrev_b32 v126, 16, v23
    v_and_b32 v127, 0xffff0000, v23
    v_lshlrev_b32 v128, 16, v24
    v_and_b32 v129, 0xffff0000, v24
    v_lshlrev_b32 v130, 16, v25
    v_and_b32 v131, 0xffff0000, v25
    v_pk_add_f32 v[32:33], v[32:33], v[112:113]
    v_pk_add_f32 v[34:35], v[34:35], v[114:115]
    v_pk_add_f32 v[36:37], v[36:37], v[116:117]
    v_pk_add_f32 v[38:39], v[38:39], v[118:119]
    v_pk_add_f32 v[40:41], v[40:41], v[120:121]
    v_pk_add_f32 v[42:43], v[42:43], v[122:123]
    v_pk_add_f32 v[44:45], v[44:45], v[124:125]
    v_pk_add_f32 v[46:47], v[46:47], v[126:127]
    v_pk_add_f32 v[48:49], v[48:49], v[128:129]
    v_pk_add_f32 v[50:51], v[50:51], v[130:131]
    v_mov_b32 v28, 0
    v_mov_b32 v29, 0
    s_add_u32 s62, s62, 4096
    s_add_u32 s63, s63, 4096
    s_mov_b32 m0, s62
    buffer_load_dwordx4 v8, s[28:31], s63 offen offset:0 lds
    buffer_load_dwordx4 v8, s[28:31], s63 offen offset:1024 lds
    buffer_load_dwordx4 v8, s[28:31], s63 offen offset:2048 lds
    buffer_load_dwordx4 v8, s[28:31], s63 offen offset:3072 lds
    s_mul_i32 s25, s20, 5
    s_lshl_b32 s25, s25, 10
    s_add_u32 s62, s25, 122880
    s_add_u32 s63, s25, s54
    s_add_u32 s63, s63, 122880
    s_mov_b32 m0, s62
    buffer_load_dwordx4 v8, s[28:31], s63 offen offset:0 lds
    buffer_load_dwordx4 v8, s[28:31], s63 offen offset:1024 lds
    buffer_load_dwordx4 v8, s[28:31], s63 offen offset:2048 lds
    buffer_load_dwordx4 v8, s[28:31], s63 offen offset:3072 lds
    s_add_u32 s62, s62, 4096
    s_add_u32 s63, s63, 4096
    s_mov_b32 m0, s62
    buffer_load_dwordx4 v8, s[28:31], s63 offen offset:0 lds
    s_waitcnt lgkmcnt(0)
    s_barrier
    ds_read_b128 v[88:91], v247 offset:0
    ds_read_b128 v[92:95], v247 offset:1024
    ds_read_b128 v[96:99], v247 offset:2048
    ds_read_b128 v[100:103], v247 offset:3072
    ds_read_b128 v[104:107], v247 offset:4096
    s_waitcnt lgkmcnt(4)
    v_pk_add_f32 v[32:33], v[32:33], v[88:89]
    v_pk_add_f32 v[34:35], v[34:35], v[90:91]
    v_cvt_pk_bf16_f32 v180, v32, v33
    v_cvt_pk_bf16_f32 v181, v34, v35
    s_waitcnt lgkmcnt(3)
    v_pk_add_f32 v[36:37], v[36:37], v[92:93]
    v_pk_add_f32 v[38:39], v[38:39], v[94:95]
    v_cvt_pk_bf16_f32 v182, v36, v37
    v_cvt_pk_bf16_f32 v183, v38, v39
    s_waitcnt lgkmcnt(2)
    v_pk_add_f32 v[40:41], v[40:41], v[96:97]
    v_pk_add_f32 v[42:43], v[42:43], v[98:99]
    v_cvt_pk_bf16_f32 v184, v40, v41
    v_cvt_pk_bf16_f32 v185, v42, v43
    s_waitcnt lgkmcnt(1)
    v_pk_add_f32 v[44:45], v[44:45], v[100:101]
    v_pk_add_f32 v[46:47], v[46:47], v[102:103]
    v_cvt_pk_bf16_f32 v186, v44, v45
    v_cvt_pk_bf16_f32 v187, v46, v47
    s_waitcnt lgkmcnt(0)
    v_pk_add_f32 v[48:49], v[48:49], v[104:105]
    v_pk_add_f32 v[50:51], v[50:51], v[106:107]
    v_cvt_pk_bf16_f32 v188, v48, v49
    v_cvt_pk_bf16_f32 v189, v50, v51
    v_dot2_f32_bf16 v28, v180, v224, v28
    v_dot2_f32_bf16 v29, v180, v180, v29
    v_dot2_f32_bf16 v28, v181, v224, v28
    v_dot2_f32_bf16 v29, v181, v181, v29
    v_dot2_f32_bf16 v28, v182, v224, v28
    v_dot2_f32_bf16 v29, v182, v182, v29
    v_dot2_f32_bf16 v28, v183, v224, v28
    v_dot2_f32_bf16 v29, v183, v183, v29
    v_dot2_f32_bf16 v28, v184, v224, v28
    v_dot2_f32_bf16 v29, v184, v184, v29
    v_dot2_f32_bf16 v28, v185, v224, v28
    v_dot2_f32_bf16 v29, v185, v185, v29
    v_dot2_f32_bf16 v28, v186, v224, v28
    v_dot2_f32_bf16 v29, v186, v186, v29
    v_dot2_f32_bf16 v28, v187, v224, v28
    v_dot2_f32_bf16 v29, v187, v187, v29
    v_dot2_f32_bf16 v28, v188, v224, v28
    v_dot2_f32_bf16 v29, v188, v188, v29
    v_dot2_f32_bf16 v28, v189, v224, v28
    v_dot2_f32_bf16 v29, v189, v189, v29
    s_nop 1
    v_permlane16_swap_b32 v180, v182
    v_permlane16_swap_b32 v181, v183
    v_permlane16_swap_b32 v184, v186
    v_permlane16_swap_b32 v185, v187
    buffer_store_dwordx4 v[180:183], v243, s[28:31], s38 offen sc1
    buffer_store_dwordx4 v[184:187], v243, s[28:31], s38 offen offset:1024 sc1
    buffer_store_dwordx2 v[188:189], v244, s[28:31], s39 offen sc1
    v_mov_b32 v160, v28
    v_mov_b32 v161, v29
    s_nop 1
    v_permlane32_swap_b32 v160, v28
    v_permlane32_swap_b32 v161, v29
    s_nop 1
    v_add_f32 v28, v28, v160
    v_add_f32 v29, v29, v161
    v_mov_b32 v160, v28
    v_mov_b32 v161, v29
    s_nop 1
    v_permlane16_swap_b32 v160, v28
    v_permlane16_swap_b32 v161, v29
    s_nop 1
    v_add_f32 v28, v28, v160
    v_add_f32 v29, v29, v161
    v_lshlrev_b32 v2, 3, v4
    s_mov_b64 exec, 0xffff
    buffer_store_dwordx2 v[28:29], v2, s[28:31], s19 offen sc1
    s_mov_b64 exec, -1
    s_waitcnt vmcnt(0)
    s_barrier
    s_cmp_lg_u32 s20, 0
    s_cbranch_scc1 chain_kernel_sig4
    v_mov_b32 v2, 1
    v_mov_b32 v7, 0
    s_mov_b64 exec, 1
    buffer_store_dword v2, v7, s[28:31], s49 offen sc1
    s_mov_b64 exec, -1
chain_kernel_sig4:
    v_and_b32 v2, 31, v1
    v_lshlrev_b32 v2, 4, v2
    v_lshrrev_b32 v7, 5, v1
    v_mul_u32_u24 v7, 7168, v7
    v_add_u32 v2, v2, v7
    s_mul_i32 s26, s52, 448
    s_add_u32 s26, s26, 8130560
    s_mov_b32 m0, 162816
    s_nop 0
    buffer_load_dwordx4 v2, s[28:31], s26 offen lds
    s_and_b32 s36, s57, 1
    s_lshl_b32 s43, s58, 6
    s_lshl_b32 s26, s21, 5
    s_add_u32 s43, s43, s26
    s_lshl_b32 s26, s22, 4
    s_add_u32 s43, s43, s26
    s_mul_i32 s40, s57, 5
    s_add_u32 s41, s40, 1
    s_lshr_b32 s41, s41, 1
    s_add_u32 s26, s41, 2
    s_sub_u32 s27, s41, 1
    s_cmp_eq_u32 s36, 1
    s_cselect_b32 s40, s27, s26
    s_lshl_b32 s44, s41, 10
    s_lshl_b32 s45, s40, 10
    s_lshl_b32 s26, s36, 9
    s_add_u32 s45, s45, s26
    s_lshr_b32 s26, s58, 1
    s_lshl_b32 s26, s26, 4
    s_mul_i32 s27, s22, 7
    s_add_u32 s26, s26, s27
    s_lshl_b32 s26, s26, 2
    s_and_b32 s27, s58, 1
    s_lshl_b32 s27, s27, 1
    s_add_u32 s26, s26, s27
    s_add_u32 s26, s26, s21
    s_lshl_b32 s26, s26, 7
    s_add_u32 s48, s26, 29446144
    v_lshlrev_b32 v234, 9, v1
    s_lshl_b32 s26, s58, 2
    s_lshl_b32 s27, s21, 1
    s_add_u32 s26, s26, s27
    s_add_u32 s27, s26, s22
    s_mul_i32 s27, s27, 54
    s_mul_i32 s39, s22, 27
    s_add_u32 s27, s27, s39
    s_lshl_b32 s27, s27, 10
    s_add_u32 s50, s27, 16027648
    s_add_u32 s27, s26, 1
    s_sub_u32 s27, s27, s22
    s_mul_i32 s27, s27, 54
    s_add_u32 s27, s27, s39
    s_lshl_b32 s27, s27, 10
    s_add_u32 s51, s27, 16027648
    v_add_u32 v9, s43, v4
    v_lshrrev_b32 v11, 4, v9
    v_and_b32 v10, 15, v9
    v_mul_u32_u24 v11, 20480, v11
    v_lshl_add_u32 v11, v10, 4, v11
    v_lshrrev_b32 v2, 1, v3
    v_lshl_add_u32 v11, v2, 8, v11
    v_and_b32 v7, 1, v3
    v_lshl_add_u32 v230, v7, 3, v11
    v_mul_u32_u24 v9, 1280, v9
    v_lshlrev_b32 v7, 5, v7
    v_lshl_add_u32 v7, v2, 4, v7
    v_add_u32 v231, v9, v7
    v_lshl_add_u32 v232, v3, 3, v9
    v_lshlrev_b32 v233, 4, v3
    v_add_u32 v9, s43, v4
    v_lshrrev_b32 v10, 4, v9
    v_mul_u32_u24 v10, 20480, v10
    v_and_b32 v11, 1, v9
    v_lshl_add_u32 v10, v11, 3, v10
    v_lshl_add_u32 v10, v3, 7, v10
    v_bfe_u32 v11, v9, 1, 3
    s_mul_i32 s26, s57, 20
    s_lshl_b32 s27, s36, 2
    s_add_u32 s27, s27, s26
    s_mul_i32 s3, s36, 16
    s_sub_u32 s3, 16, s3
    s_add_u32 s3, s3, s26
    s_add_u32 s4, s27, 0
    v_add_u32 v2, s4, v3
    v_bfe_u32 v2, v2, 1, 3
    v_xor_b32 v2, v2, v11
    v_lshl_add_u32 v2, v2, 4, v10
    s_lshl_b32 s4, s4, 7
    v_add_u32 v235, s4, v2
    s_add_u32 s4, s27, 4
    v_add_u32 v2, s4, v3
    v_bfe_u32 v2, v2, 1, 3
    v_xor_b32 v2, v2, v11
    v_lshl_add_u32 v2, v2, 4, v10
    s_lshl_b32 s4, s4, 7
    v_add_u32 v236, s4, v2
    s_add_u32 s4, s27, 8
    v_add_u32 v2, s4, v3
    v_bfe_u32 v2, v2, 1, 3
    v_xor_b32 v2, v2, v11
    v_lshl_add_u32 v2, v2, 4, v10
    s_lshl_b32 s4, s4, 7
    v_add_u32 v237, s4, v2
    s_add_u32 s4, s27, 12
    v_add_u32 v2, s4, v3
    v_bfe_u32 v2, v2, 1, 3
    v_xor_b32 v2, v2, v11
    v_lshl_add_u32 v2, v2, 4, v10
    s_lshl_b32 s4, s4, 7
    v_add_u32 v238, s4, v2
    s_mov_b32 s4, s3
    v_add_u32 v2, s4, v3
    v_bfe_u32 v2, v2, 1, 3
    v_xor_b32 v2, v2, v11
    v_lshl_add_u32 v2, v2, 4, v10
    s_lshl_b32 s4, s4, 7
    v_add_u32 v239, s4, v2
    s_mul_i32 s37, s57, 320
    s_add_u32 s37, s37, 8126976
    s_mul_i32 s26, s36, 256
    s_sub_u32 s26, 256, s26
    s_add_u32 s38, s37, s26
    s_lshl_b32 s26, s36, 6
    s_add_u32 s37, s37, s26
    s_mul_i32 s26, s57, 160
    s_lshl_b32 s27, s36, 5
    s_add_u32 s46, s26, s27
    s_mul_i32 s27, s36, 128
    s_sub_u32 s27, 128, s27
    s_add_u32 s49, s26, s27
    s_waitcnt vmcnt(0)
    s_lshl_b32 s26, s42, 6
    v_lshlrev_b32 v2, 4, v3
    v_add_u32 v7, 162816, v2
    v_add_u32 v2, s26, v7
    s_mul_i32 s26, s42, 384
    s_sub_u32 s26, 384, s26
    v_add_u32 v7, s26, v7
    ds_read_b128 v[88:91], v2 offset:0
    ds_read_b128 v[116:119], v2 offset:512
    ds_read_b128 v[92:95], v2 offset:64
    ds_read_b128 v[120:123], v2 offset:576
    ds_read_b128 v[96:99], v2 offset:128
    ds_read_b128 v[124:127], v2 offset:640
    ds_read_b128 v[100:103], v2 offset:192
    ds_read_b128 v[128:131], v2 offset:704
    ds_read_b128 v[104:107], v2 offset:256
    ds_read_b128 v[132:135], v2 offset:768
    ds_read_b128 v[108:111], v2 offset:320
    ds_read_b128 v[136:139], v2 offset:832
    ds_read_b128 v[112:115], v7
    ds_read_b128 v[140:143], v7 offset:512
    s_waitcnt lgkmcnt(0)
    v_pk_add_f32 v[88:89], v[88:89], v[116:117]
    v_pk_add_f32 v[90:91], v[90:91], v[118:119]
    v_pk_add_f32 v[92:93], v[92:93], v[120:121]
    v_pk_add_f32 v[94:95], v[94:95], v[122:123]
    v_pk_add_f32 v[96:97], v[96:97], v[124:125]
    v_pk_add_f32 v[98:99], v[98:99], v[126:127]
    v_pk_add_f32 v[100:101], v[100:101], v[128:129]
    v_pk_add_f32 v[102:103], v[102:103], v[130:131]
    v_pk_add_f32 v[104:105], v[104:105], v[132:133]
    v_pk_add_f32 v[106:107], v[106:107], v[134:135]
    v_pk_add_f32 v[108:109], v[108:109], v[136:137]
    v_pk_add_f32 v[110:111], v[110:111], v[138:139]
    v_pk_add_f32 v[112:113], v[112:113], v[140:141]
    v_pk_add_f32 v[114:115], v[114:115], v[142:143]
    v_mov_b32 v12, v8
    v_add_u32 v13, 0x10000, v8
    v_add_u32 v14, 0x20000, v8
    ds_read_b128 a[160:163], v12 offset:0
    ds_read_b128 a[164:167], v12 offset:1024
    ds_read_b128 a[168:171], v12 offset:2048
    ds_read_b128 a[172:175], v12 offset:3072
    ds_read_b128 a[176:179], v13 offset:57344
    ds_read_b128 a[180:183], v12 offset:4096
    ds_read_b128 a[184:187], v12 offset:5120
    ds_read_b128 a[188:191], v12 offset:6144
    ds_read_b128 a[192:195], v12 offset:7168
    ds_read_b128 a[196:199], v13 offset:58368
    ds_read_b128 a[200:203], v12 offset:8192
    v_lshlrev_b32 v7, 7, v1
    s_mov_b32 s47, 0
    s_mov_b64 exec, 15
chain_kernel_poll5:
    buffer_load_dword v2, v7, s[28:31], s8 offen sc1
    s_add_u32 s47, s47, 1
    s_waitcnt vmcnt(0)
    v_cmp_ne_u32 vcc, 1, v2
    s_cmp_ge_u32 s47, 20000
    s_cbranch_scc1 chain_kernel_polld6
    s_cbranch_vccnz chain_kernel_poll5
chain_kernel_polld6:
    s_mov_b64 exec, -1
    buffer_load_dwordx4 a[0:3], v8, s[28:31], s6 offen offset:0 sc1
    buffer_load_dwordx4 a[4:7], v8, s[28:31], s7 offen offset:0 sc1
    buffer_load_dwordx4 a[8:11], v8, s[28:31], s6 offen offset:1024 sc1
    buffer_load_dwordx4 a[12:15], v8, s[28:31], s7 offen offset:1024 sc1
    buffer_load_dwordx4 a[16:19], v8, s[28:31], s6 offen offset:2048 sc1
    buffer_load_dwordx4 a[20:23], v8, s[28:31], s7 offen offset:2048 sc1
    buffer_load_dwordx4 a[24:27], v8, s[28:31], s6 offen offset:3072 sc1
    buffer_load_dwordx4 a[28:31], v8, s[28:31], s7 offen offset:3072 sc1
    s_add_u32 s6, s6, 4096
    s_add_u32 s7, s7, 4096
    buffer_load_dwordx4 a[32:35], v8, s[28:31], s6 offen offset:0 sc1
    buffer_load_dwordx4 a[36:39], v8, s[28:31], s7 offen offset:0 sc1
    s_waitcnt vmcnt(8) lgkmcnt(6)
    v_mfma_f32_16x16x32_bf16 v[32:35], a[160:163], a[0:3], 0
    v_mfma_f32_16x16x32_bf16 v[60:63], a[160:163], a[4:7], 0
    ds_read_b128 a[204:207], v12 offset:9216
    buffer_load_dwordx4 a[40:43], v8, s[28:31], s6 offen offset:1024 sc1
    v_mfma_f32_16x16x32_bf16 v[36:39], a[164:167], a[0:3], 0
    v_mfma_f32_16x16x32_bf16 v[64:67], a[164:167], a[4:7], 0
    ds_read_b128 a[160:163], v12 offset:10240
    v_mfma_f32_16x16x32_bf16 v[40:43], a[168:171], a[0:3], 0
    v_mfma_f32_16x16x32_bf16 v[68:71], a[168:171], a[4:7], 0
    ds_read_b128 a[164:167], v12 offset:11264
    buffer_load_dwordx4 a[44:47], v8, s[28:31], s7 offen offset:1024 sc1
    v_mfma_f32_16x16x32_bf16 v[44:47], a[172:175], a[0:3], 0
    v_mfma_f32_16x16x32_bf16 v[72:75], a[172:175], a[4:7], 0
    ds_read_b128 a[168:171], v13 offset:59392
    v_mfma_f32_16x16x32_bf16 v[56:59], a[176:179], a[0:3], 0
    v_mfma_f32_16x16x32_bf16 v[84:87], a[176:179], a[4:7], 0
    ds_read_b128 a[172:175], v12 offset:12288
    s_waitcnt vmcnt(8) lgkmcnt(6)
    v_mfma_f32_16x16x32_bf16 v[32:35], a[180:183], a[8:11], v[32:35]
    v_mfma_f32_16x16x32_bf16 v[60:63], a[180:183], a[12:15], v[60:63]
    ds_read_b128 a[176:179], v12 offset:13312
    buffer_load_dwordx4 a[48:51], v8, s[28:31], s6 offen offset:2048 sc1
    v_mfma_f32_16x16x32_bf16 v[36:39], a[184:187], a[8:11], v[36:39]
    v_mfma_f32_16x16x32_bf16 v[64:67], a[184:187], a[12:15], v[64:67]
    ds_read_b128 a[180:183], v12 offset:14336
    v_mfma_f32_16x16x32_bf16 v[40:43], a[188:191], a[8:11], v[40:43]
    v_mfma_f32_16x16x32_bf16 v[68:71], a[188:191], a[12:15], v[68:71]
    ds_read_b128 a[184:187], v12 offset:15360
    buffer_load_dwordx4 a[52:55], v8, s[28:31], s7 offen offset:2048 sc1
    v_mfma_f32_16x16x32_bf16 v[44:47], a[192:195], a[8:11], v[44:47]
    v_mfma_f32_16x16x32_bf16 v[72:75], a[192:195], a[12:15], v[72:75]
    ds_read_b128 a[188:191], v13 offset:60416
    v_mfma_f32_16x16x32_bf16 v[56:59], a[196:199], a[8:11], v[56:59]
    v_mfma_f32_16x16x32_bf16 v[84:87], a[196:199], a[12:15], v[84:87]
    ds_read_b128 a[192:195], v12 offset:16384
    s_waitcnt vmcnt(8) lgkmcnt(6)
    v_mfma_f32_16x16x32_bf16 v[32:35], a[200:203], a[16:19], v[32:35]
    v_mfma_f32_16x16x32_bf16 v[60:63], a[200:203], a[20:23], v[60:63]
    ds_read_b128 a[196:199], v12 offset:17408
    buffer_load_dwordx4 a[56:59], v8, s[28:31], s6 offen offset:3072 sc1
    v_mfma_f32_16x16x32_bf16 v[36:39], a[204:207], a[16:19], v[36:39]
    v_mfma_f32_16x16x32_bf16 v[64:67], a[204:207], a[20:23], v[64:67]
    ds_read_b128 a[200:203], v12 offset:18432
    v_mfma_f32_16x16x32_bf16 v[40:43], a[160:163], a[16:19], v[40:43]
    v_mfma_f32_16x16x32_bf16 v[68:71], a[160:163], a[20:23], v[68:71]
    ds_read_b128 a[204:207], v12 offset:19456
    buffer_load_dwordx4 a[60:63], v8, s[28:31], s7 offen offset:3072 sc1
    v_mfma_f32_16x16x32_bf16 v[44:47], a[164:167], a[16:19], v[44:47]
    v_mfma_f32_16x16x32_bf16 v[72:75], a[164:167], a[20:23], v[72:75]
    ds_read_b128 a[160:163], v13 offset:61440
    v_mfma_f32_16x16x32_bf16 v[56:59], a[168:171], a[16:19], v[56:59]
    v_mfma_f32_16x16x32_bf16 v[84:87], a[168:171], a[20:23], v[84:87]
    ds_read_b128 a[164:167], v12 offset:20480
    s_waitcnt vmcnt(8) lgkmcnt(6)
    v_mfma_f32_16x16x32_bf16 v[32:35], a[172:175], a[24:27], v[32:35]
    v_mfma_f32_16x16x32_bf16 v[60:63], a[172:175], a[28:31], v[60:63]
    ds_read_b128 a[168:171], v12 offset:21504
    s_add_u32 s6, s6, 4096
    s_add_u32 s7, s7, 4096
    buffer_load_dwordx4 a[64:67], v8, s[28:31], s6 offen offset:0 sc1
    v_mfma_f32_16x16x32_bf16 v[36:39], a[176:179], a[24:27], v[36:39]
    v_mfma_f32_16x16x32_bf16 v[64:67], a[176:179], a[28:31], v[64:67]
    ds_read_b128 a[172:175], v12 offset:22528
    v_mfma_f32_16x16x32_bf16 v[40:43], a[180:183], a[24:27], v[40:43]
    v_mfma_f32_16x16x32_bf16 v[68:71], a[180:183], a[28:31], v[68:71]
    ds_read_b128 a[176:179], v12 offset:23552
    buffer_load_dwordx4 a[68:71], v8, s[28:31], s7 offen offset:0 sc1
    v_mfma_f32_16x16x32_bf16 v[44:47], a[184:187], a[24:27], v[44:47]
    v_mfma_f32_16x16x32_bf16 v[72:75], a[184:187], a[28:31], v[72:75]
    ds_read_b128 a[180:183], v13 offset:62464
    v_mfma_f32_16x16x32_bf16 v[56:59], a[188:191], a[24:27], v[56:59]
    v_mfma_f32_16x16x32_bf16 v[84:87], a[188:191], a[28:31], v[84:87]
    ds_read_b128 a[184:187], v12 offset:24576
    s_waitcnt vmcnt(8) lgkmcnt(6)
    v_mfma_f32_16x16x32_bf16 v[32:35], a[192:195], a[32:35], v[32:35]
    v_mfma_f32_16x16x32_bf16 v[60:63], a[192:195], a[36:39], v[60:63]
    ds_read_b128 a[188:191], v12 offset:25600
    buffer_load_dwordx4 a[72:75], v8, s[28:31], s6 offen offset:1024 sc1
    v_mfma_f32_16x16x32_bf16 v[36:39], a[196:199], a[32:35], v[36:39]
    v_mfma_f32_16x16x32_bf16 v[64:67], a[196:199], a[36:39], v[64:67]
    ds_read_b128 a[192:195], v12 offset:26624
    v_mfma_f32_16x16x32_bf16 v[40:43], a[200:203], a[32:35], v[40:43]
    v_mfma_f32_16x16x32_bf16 v[68:71], a[200:203], a[36:39], v[68:71]
    ds_read_b128 a[196:199], v12 offset:27648
    buffer_load_dwordx4 a[76:79], v8, s[28:31], s7 offen offset:1024 sc1
    v_mfma_f32_16x16x32_bf16 v[44:47], a[204:207], a[32:35], v[44:47]
    v_mfma_f32_16x16x32_bf16 v[72:75], a[204:207], a[36:39], v[72:75]
    ds_read_b128 a[200:203], v13 offset:63488
    v_mfma_f32_16x16x32_bf16 v[56:59], a[160:163], a[32:35], v[56:59]
    v_mfma_f32_16x16x32_bf16 v[84:87], a[160:163], a[36:39], v[84:87]
    ds_read_b128 a[204:207], v12 offset:28672
    s_waitcnt vmcnt(8) lgkmcnt(6)
    v_mfma_f32_16x16x32_bf16 v[32:35], a[164:167], a[40:43], v[32:35]
    v_mfma_f32_16x16x32_bf16 v[60:63], a[164:167], a[44:47], v[60:63]
    ds_read_b128 a[160:163], v12 offset:29696
    buffer_load_dwordx4 a[80:83], v8, s[28:31], s6 offen offset:2048 sc1
    v_mfma_f32_16x16x32_bf16 v[36:39], a[168:171], a[40:43], v[36:39]
    v_mfma_f32_16x16x32_bf16 v[64:67], a[168:171], a[44:47], v[64:67]
    ds_read_b128 a[164:167], v12 offset:30720
    v_mfma_f32_16x16x32_bf16 v[40:43], a[172:175], a[40:43], v[40:43]
    v_mfma_f32_16x16x32_bf16 v[68:71], a[172:175], a[44:47], v[68:71]
    ds_read_b128 a[168:171], v12 offset:31744
    buffer_load_dwordx4 a[84:87], v8, s[28:31], s7 offen offset:2048 sc1
    v_mfma_f32_16x16x32_bf16 v[44:47], a[176:179], a[40:43], v[44:47]
    v_mfma_f32_16x16x32_bf16 v[72:75], a[176:179], a[44:47], v[72:75]
    ds_read_b128 a[172:175], v13 offset:64512
    v_mfma_f32_16x16x32_bf16 v[56:59], a[180:183], a[40:43], v[56:59]
    v_mfma_f32_16x16x32_bf16 v[84:87], a[180:183], a[44:47], v[84:87]
    ds_read_b128 a[176:179], v12 offset:32768
    s_waitcnt vmcnt(8) lgkmcnt(6)
    v_mfma_f32_16x16x32_bf16 v[32:35], a[184:187], a[48:51], v[32:35]
    v_mfma_f32_16x16x32_bf16 v[60:63], a[184:187], a[52:55], v[60:63]
    ds_read_b128 a[180:183], v12 offset:33792
    buffer_load_dwordx4 a[88:91], v8, s[28:31], s6 offen offset:3072 sc1
    v_mfma_f32_16x16x32_bf16 v[36:39], a[188:191], a[48:51], v[36:39]
    v_mfma_f32_16x16x32_bf16 v[64:67], a[188:191], a[52:55], v[64:67]
    ds_read_b128 a[184:187], v12 offset:34816
    v_mfma_f32_16x16x32_bf16 v[40:43], a[192:195], a[48:51], v[40:43]
    v_mfma_f32_16x16x32_bf16 v[68:71], a[192:195], a[52:55], v[68:71]
    ds_read_b128 a[188:191], v12 offset:35840
    buffer_load_dwordx4 a[92:95], v8, s[28:31], s7 offen offset:3072 sc1
    v_mfma_f32_16x16x32_bf16 v[44:47], a[196:199], a[48:51], v[44:47]
    v_mfma_f32_16x16x32_bf16 v[72:75], a[196:199], a[52:55], v[72:75]
    ds_read_b128 a[192:195], v14 offset:0
    v_mfma_f32_16x16x32_bf16 v[56:59], a[200:203], a[48:51], v[56:59]
    v_mfma_f32_16x16x32_bf16 v[84:87], a[200:203], a[52:55], v[84:87]
    ds_read_b128 a[196:199], v12 offset:36864
    s_waitcnt vmcnt(8) lgkmcnt(6)
    v_mfma_f32_16x16x32_bf16 v[32:35], a[204:207], a[56:59], v[32:35]
    v_mfma_f32_16x16x32_bf16 v[60:63], a[204:207], a[60:63], v[60:63]
    ds_read_b128 a[200:203], v12 offset:37888
    s_add_u32 s6, s6, 4096
    s_add_u32 s7, s7, 4096
    buffer_load_dwordx4 a[96:99], v8, s[28:31], s6 offen offset:0 sc1
    v_mfma_f32_16x16x32_bf16 v[36:39], a[160:163], a[56:59], v[36:39]
    v_mfma_f32_16x16x32_bf16 v[64:67], a[160:163], a[60:63], v[64:67]
    ds_read_b128 a[204:207], v12 offset:38912
    v_mfma_f32_16x16x32_bf16 v[40:43], a[164:167], a[56:59], v[40:43]
    v_mfma_f32_16x16x32_bf16 v[68:71], a[164:167], a[60:63], v[68:71]
    ds_read_b128 a[160:163], v12 offset:39936
    buffer_load_dwordx4 a[100:103], v8, s[28:31], s7 offen offset:0 sc1
    v_mfma_f32_16x16x32_bf16 v[44:47], a[168:171], a[56:59], v[44:47]
    v_mfma_f32_16x16x32_bf16 v[72:75], a[168:171], a[60:63], v[72:75]
    ds_read_b128 a[164:167], v14 offset:1024
    v_mfma_f32_16x16x32_bf16 v[56:59], a[172:175], a[56:59], v[56:59]
    v_mfma_f32_16x16x32_bf16 v[84:87], a[172:175], a[60:63], v[84:87]
    ds_read_b128 a[168:171], v12 offset:40960
    s_waitcnt vmcnt(8) lgkmcnt(6)
    v_mfma_f32_16x16x32_bf16 v[32:35], a[176:179], a[64:67], v[32:35]
    v_mfma_f32_16x16x32_bf16 v[60:63], a[176:179], a[68:71], v[60:63]
    ds_read_b128 a[172:175], v12 offset:41984
    buffer_load_dwordx4 a[104:107], v8, s[28:31], s6 offen offset:1024 sc1
    v_mfma_f32_16x16x32_bf16 v[36:39], a[180:183], a[64:67], v[36:39]
    v_mfma_f32_16x16x32_bf16 v[64:67], a[180:183], a[68:71], v[64:67]
    ds_read_b128 a[176:179], v12 offset:43008
    v_mfma_f32_16x16x32_bf16 v[40:43], a[184:187], a[64:67], v[40:43]
    v_mfma_f32_16x16x32_bf16 v[68:71], a[184:187], a[68:71], v[68:71]
    ds_read_b128 a[180:183], v12 offset:44032
    buffer_load_dwordx4 a[108:111], v8, s[28:31], s7 offen offset:1024 sc1
    v_mfma_f32_16x16x32_bf16 v[44:47], a[188:191], a[64:67], v[44:47]
    v_mfma_f32_16x16x32_bf16 v[72:75], a[188:191], a[68:71], v[72:75]
    ds_read_b128 a[184:187], v14 offset:2048
    v_mfma_f32_16x16x32_bf16 v[56:59], a[192:195], a[64:67], v[56:59]
    v_mfma_f32_16x16x32_bf16 v[84:87], a[192:195], a[68:71], v[84:87]
    ds_read_b128 a[188:191], v12 offset:45056
    s_waitcnt vmcnt(8) lgkmcnt(6)
    v_mfma_f32_16x16x32_bf16 v[32:35], a[196:199], a[72:75], v[32:35]
    v_mfma_f32_16x16x32_bf16 v[60:63], a[196:199], a[76:79], v[60:63]
    ds_read_b128 a[192:195], v12 offset:46080
    buffer_load_dwordx4 a[112:115], v8, s[28:31], s6 offen offset:2048 sc1
    v_mfma_f32_16x16x32_bf16 v[36:39], a[200:203], a[72:75], v[36:39]
    v_mfma_f32_16x16x32_bf16 v[64:67], a[200:203], a[76:79], v[64:67]
    ds_read_b128 a[196:199], v12 offset:47104
    v_mfma_f32_16x16x32_bf16 v[40:43], a[204:207], a[72:75], v[40:43]
    v_mfma_f32_16x16x32_bf16 v[68:71], a[204:207], a[76:79], v[68:71]
    ds_read_b128 a[200:203], v12 offset:48128
    buffer_load_dwordx4 a[116:119], v8, s[28:31], s7 offen offset:2048 sc1
    v_mfma_f32_16x16x32_bf16 v[44:47], a[160:163], a[72:75], v[44:47]
    v_mfma_f32_16x16x32_bf16 v[72:75], a[160:163], a[76:79], v[72:75]
    ds_read_b128 a[204:207], v14 offset:3072
    v_mfma_f32_16x16x32_bf16 v[56:59], a[164:167], a[72:75], v[56:59]
    v_mfma_f32_16x16x32_bf16 v[84:87], a[164:167], a[76:79], v[84:87]
    ds_read_b128 a[160:163], v12 offset:49152
    s_waitcnt vmcnt(8) lgkmcnt(6)
    v_mfma_f32_16x16x32_bf16 v[32:35], a[168:171], a[80:83], v[32:35]
    v_mfma_f32_16x16x32_bf16 v[60:63], a[168:171], a[84:87], v[60:63]
    ds_read_b128 a[164:167], v12 offset:50176
    buffer_load_dwordx4 a[120:123], v8, s[28:31], s6 offen offset:3072 sc1
    v_mfma_f32_16x16x32_bf16 v[36:39], a[172:175], a[80:83], v[36:39]
    v_mfma_f32_16x16x32_bf16 v[64:67], a[172:175], a[84:87], v[64:67]
    ds_read_b128 a[168:171], v12 offset:51200
    v_mfma_f32_16x16x32_bf16 v[40:43], a[176:179], a[80:83], v[40:43]
    v_mfma_f32_16x16x32_bf16 v[68:71], a[176:179], a[84:87], v[68:71]
    ds_read_b128 a[172:175], v12 offset:52224
    buffer_load_dwordx4 a[124:127], v8, s[28:31], s7 offen offset:3072 sc1
    v_mfma_f32_16x16x32_bf16 v[44:47], a[180:183], a[80:83], v[44:47]
    v_mfma_f32_16x16x32_bf16 v[72:75], a[180:183], a[84:87], v[72:75]
    ds_read_b128 a[176:179], v14 offset:4096
    v_mfma_f32_16x16x32_bf16 v[56:59], a[184:187], a[80:83], v[56:59]
    v_mfma_f32_16x16x32_bf16 v[84:87], a[184:187], a[84:87], v[84:87]
    ds_read_b128 a[180:183], v12 offset:53248
    s_waitcnt vmcnt(8) lgkmcnt(6)
    v_mfma_f32_16x16x32_bf16 v[32:35], a[188:191], a[88:91], v[32:35]
    v_mfma_f32_16x16x32_bf16 v[60:63], a[188:191], a[92:95], v[60:63]
    ds_read_b128 a[184:187], v12 offset:54272
    s_add_u32 s6, s6, 4096
    s_add_u32 s7, s7, 4096
    buffer_load_dwordx4 a[128:131], v8, s[28:31], s6 offen offset:0 sc1
    v_mfma_f32_16x16x32_bf16 v[36:39], a[192:195], a[88:91], v[36:39]
    v_mfma_f32_16x16x32_bf16 v[64:67], a[192:195], a[92:95], v[64:67]
    ds_read_b128 a[188:191], v12 offset:55296
    v_mfma_f32_16x16x32_bf16 v[40:43], a[196:199], a[88:91], v[40:43]
    v_mfma_f32_16x16x32_bf16 v[68:71], a[196:199], a[92:95], v[68:71]
    ds_read_b128 a[192:195], v12 offset:56320
    buffer_load_dwordx4 a[132:135], v8, s[28:31], s7 offen offset:0 sc1
    v_mfma_f32_16x16x32_bf16 v[44:47], a[200:203], a[88:91], v[44:47]
    v_mfma_f32_16x16x32_bf16 v[72:75], a[200:203], a[92:95], v[72:75]
    ds_read_b128 a[196:199], v14 offset:5120
    v_mfma_f32_16x16x32_bf16 v[56:59], a[204:207], a[88:91], v[56:59]
    v_mfma_f32_16x16x32_bf16 v[84:87], a[204:207], a[92:95], v[84:87]
    ds_read_b128 a[200:203], v12 offset:57344
    s_waitcnt vmcnt(8) lgkmcnt(6)
    v_mfma_f32_16x16x32_bf16 v[32:35], a[160:163], a[96:99], v[32:35]
    v_mfma_f32_16x16x32_bf16 v[60:63], a[160:163], a[100:103], v[60:63]
    ds_read_b128 a[204:207], v12 offset:58368
    buffer_load_dwordx4 a[136:139], v8, s[28:31], s6 offen offset:1024 sc1
    v_mfma_f32_16x16x32_bf16 v[36:39], a[164:167], a[96:99], v[36:39]
    v_mfma_f32_16x16x32_bf16 v[64:67], a[164:167], a[100:103], v[64:67]
    ds_read_b128 a[160:163], v12 offset:59392
    v_mfma_f32_16x16x32_bf16 v[40:43], a[168:171], a[96:99], v[40:43]
    v_mfma_f32_16x16x32_bf16 v[68:71], a[168:171], a[100:103], v[68:71]
    ds_read_b128 a[164:167], v12 offset:60416
    buffer_load_dwordx4 a[140:143], v8, s[28:31], s7 offen offset:1024 sc1
    v_mfma_f32_16x16x32_bf16 v[44:47], a[172:175], a[96:99], v[44:47]
    v_mfma_f32_16x16x32_bf16 v[72:75], a[172:175], a[100:103], v[72:75]
    ds_read_b128 a[168:171], v14 offset:6144
    v_mfma_f32_16x16x32_bf16 v[56:59], a[176:179], a[96:99], v[56:59]
    v_mfma_f32_16x16x32_bf16 v[84:87], a[176:179], a[100:103], v[84:87]
    ds_read_b128 a[172:175], v12 offset:61440
    s_waitcnt vmcnt(8) lgkmcnt(6)
    v_mfma_f32_16x16x32_bf16 v[32:35], a[180:183], a[104:107], v[32:35]
    v_mfma_f32_16x16x32_bf16 v[60:63], a[180:183], a[108:111], v[60:63]
    ds_read_b128 a[176:179], v12 offset:62464
    buffer_load_dwordx4 a[144:147], v8, s[28:31], s6 offen offset:2048 sc1
    v_mfma_f32_16x16x32_bf16 v[36:39], a[184:187], a[104:107], v[36:39]
    v_mfma_f32_16x16x32_bf16 v[64:67], a[184:187], a[108:111], v[64:67]
    ds_read_b128 a[180:183], v12 offset:63488
    v_mfma_f32_16x16x32_bf16 v[40:43], a[188:191], a[104:107], v[40:43]
    v_mfma_f32_16x16x32_bf16 v[68:71], a[188:191], a[108:111], v[68:71]
    ds_read_b128 a[184:187], v12 offset:64512
    buffer_load_dwordx4 a[148:151], v8, s[28:31], s7 offen offset:2048 sc1
    v_mfma_f32_16x16x32_bf16 v[44:47], a[192:195], a[104:107], v[44:47]
    v_mfma_f32_16x16x32_bf16 v[72:75], a[192:195], a[108:111], v[72:75]
    ds_read_b128 a[188:191], v14 offset:7168
    v_mfma_f32_16x16x32_bf16 v[56:59], a[196:199], a[104:107], v[56:59]
    v_mfma_f32_16x16x32_bf16 v[84:87], a[196:199], a[108:111], v[84:87]
    ds_read_b128 a[192:195], v13 offset:0
    s_waitcnt vmcnt(8) lgkmcnt(6)
    v_mfma_f32_16x16x32_bf16 v[32:35], a[200:203], a[112:115], v[32:35]
    v_mfma_f32_16x16x32_bf16 v[60:63], a[200:203], a[116:119], v[60:63]
    ds_read_b128 a[196:199], v13 offset:1024
    buffer_load_dwordx4 a[152:155], v8, s[28:31], s6 offen offset:3072 sc1
    v_mfma_f32_16x16x32_bf16 v[36:39], a[204:207], a[112:115], v[36:39]
    v_mfma_f32_16x16x32_bf16 v[64:67], a[204:207], a[116:119], v[64:67]
    ds_read_b128 a[200:203], v13 offset:2048
    v_mfma_f32_16x16x32_bf16 v[40:43], a[160:163], a[112:115], v[40:43]
    v_mfma_f32_16x16x32_bf16 v[68:71], a[160:163], a[116:119], v[68:71]
    ds_read_b128 a[204:207], v13 offset:3072
    buffer_load_dwordx4 a[156:159], v8, s[28:31], s7 offen offset:3072 sc1
    v_mfma_f32_16x16x32_bf16 v[44:47], a[164:167], a[112:115], v[44:47]
    v_mfma_f32_16x16x32_bf16 v[72:75], a[164:167], a[116:119], v[72:75]
    ds_read_b128 a[160:163], v14 offset:8192
    v_mfma_f32_16x16x32_bf16 v[56:59], a[168:171], a[112:115], v[56:59]
    v_mfma_f32_16x16x32_bf16 v[84:87], a[168:171], a[116:119], v[84:87]
    ds_read_b128 a[164:167], v13 offset:4096
    s_waitcnt vmcnt(8) lgkmcnt(6)
    v_mfma_f32_16x16x32_bf16 v[32:35], a[172:175], a[120:123], v[32:35]
    v_mfma_f32_16x16x32_bf16 v[60:63], a[172:175], a[124:127], v[60:63]
    ds_read_b128 a[168:171], v13 offset:5120
    buffer_load_dwordx2 v[16:17], v228, s[28:31], s9 offen offset:0 sc1
    v_mfma_f32_16x16x32_bf16 v[36:39], a[176:179], a[120:123], v[36:39]
    v_mfma_f32_16x16x32_bf16 v[64:67], a[176:179], a[124:127], v[64:67]
    ds_read_b128 a[172:175], v13 offset:6144
    v_mfma_f32_16x16x32_bf16 v[40:43], a[180:183], a[120:123], v[40:43]
    v_mfma_f32_16x16x32_bf16 v[68:71], a[180:183], a[124:127], v[68:71]
    ds_read_b128 a[176:179], v13 offset:7168
    buffer_load_dwordx2 v[18:19], v228, s[28:31], s9 offen offset:128 sc1
    v_mfma_f32_16x16x32_bf16 v[44:47], a[184:187], a[120:123], v[44:47]
    v_mfma_f32_16x16x32_bf16 v[72:75], a[184:187], a[124:127], v[72:75]
    ds_read_b128 a[180:183], v14 offset:9216
    v_mfma_f32_16x16x32_bf16 v[56:59], a[188:191], a[120:123], v[56:59]
    v_mfma_f32_16x16x32_bf16 v[84:87], a[188:191], a[124:127], v[84:87]
    ds_read_b128 a[184:187], v13 offset:8192
    s_waitcnt vmcnt(8) lgkmcnt(6)
    v_mfma_f32_16x16x32_bf16 v[32:35], a[192:195], a[128:131], v[32:35]
    v_mfma_f32_16x16x32_bf16 v[60:63], a[192:195], a[132:135], v[60:63]
    ds_read_b128 a[188:191], v13 offset:9216
    buffer_load_dwordx2 v[20:21], v228, s[28:31], s9 offen offset:1024 sc1
    v_mfma_f32_16x16x32_bf16 v[36:39], a[196:199], a[128:131], v[36:39]
    v_mfma_f32_16x16x32_bf16 v[64:67], a[196:199], a[132:135], v[64:67]
    ds_read_b128 a[192:195], v13 offset:10240
    v_mfma_f32_16x16x32_bf16 v[40:43], a[200:203], a[128:131], v[40:43]
    v_mfma_f32_16x16x32_bf16 v[68:71], a[200:203], a[132:135], v[68:71]
    ds_read_b128 a[196:199], v13 offset:11264
    buffer_load_dwordx2 v[22:23], v228, s[28:31], s9 offen offset:1152 sc1
    v_mfma_f32_16x16x32_bf16 v[44:47], a[204:207], a[128:131], v[44:47]
    v_mfma_f32_16x16x32_bf16 v[72:75], a[204:207], a[132:135], v[72:75]
    ds_read_b128 a[200:203], v14 offset:10240
    v_mfma_f32_16x16x32_bf16 v[56:59], a[160:163], a[128:131], v[56:59]
    v_mfma_f32_16x16x32_bf16 v[84:87], a[160:163], a[132:135], v[84:87]
    ds_read_b128 a[204:207], v13 offset:12288
    s_waitcnt vmcnt(8) lgkmcnt(6)
    v_mfma_f32_16x16x32_bf16 v[32:35], a[164:167], a[136:139], v[32:35]
    v_mfma_f32_16x16x32_bf16 v[60:63], a[164:167], a[140:143], v[60:63]
    ds_read_b128 a[160:163], v13 offset:13312
    v_mfma_f32_16x16x32_bf16 v[36:39], a[168:171], a[136:139], v[36:39]
    v_mfma_f32_16x16x32_bf16 v[64:67], a[168:171], a[140:143], v[64:67]
    ds_read_b128 a[164:167], v13 offset:14336
    s_mul_i32 s25, s20, 3
    s_min_u32 s25, s25, 7
    s_lshl_b32 s25, s25, 10
    s_add_u32 s62, s25, 143360
    s_add_u32 s63, s25, s59
    s_add_u32 s63, s63, 0
    s_mov_b32 m0, s62
    buffer_load_dwordx4 v8, s[28:31], s63 offen offset:0 lds
    v_mfma_f32_16x16x32_bf16 v[40:43], a[172:175], a[136:139], v[40:43]
    v_mfma_f32_16x16x32_bf16 v[68:71], a[172:175], a[140:143], v[68:71]
    ds_read_b128 a[168:171], v13 offset:15360
    v_mfma_f32_16x16x32_bf16 v[44:47], a[176:179], a[136:139], v[44:47]
    v_mfma_f32_16x16x32_bf16 v[72:75], a[176:179], a[140:143], v[72:75]
    ds_read_b128 a[172:175], v14 offset:11264
    buffer_load_dwordx4 v8, s[28:31], s63 offen offset:1024 lds
    v_mfma_f32_16x16x32_bf16 v[56:59], a[180:183], a[136:139], v[56:59]
    v_mfma_f32_16x16x32_bf16 v[84:87], a[180:183], a[140:143], v[84:87]
    ds_read_b128 a[176:179], v13 offset:16384
    s_waitcnt vmcnt(8) lgkmcnt(6)
    v_mfma_f32_16x16x32_bf16 v[32:35], a[184:187], a[144:147], v[32:35]
    v_mfma_f32_16x16x32_bf16 v[60:63], a[184:187], a[148:151], v[60:63]
    ds_read_b128 a[180:183], v13 offset:17408
    v_mfma_f32_16x16x32_bf16 v[36:39], a[188:191], a[144:147], v[36:39]
    v_mfma_f32_16x16x32_bf16 v[64:67], a[188:191], a[148:151], v[64:67]
    ds_read_b128 a[184:187], v13 offset:18432
    buffer_load_dwordx4 v8, s[28:31], s63 offen offset:2048 lds
    v_mfma_f32_16x16x32_bf16 v[40:43], a[192:195], a[144:147], v[40:43]
    v_mfma_f32_16x16x32_bf16 v[68:71], a[192:195], a[148:151], v[68:71]
    ds_read_b128 a[188:191], v13 offset:19456
    v_mfma_f32_16x16x32_bf16 v[44:47], a[196:199], a[144:147], v[44:47]
    v_mfma_f32_16x16x32_bf16 v[72:75], a[196:199], a[148:151], v[72:75]
    ds_read_b128 a[192:195], v13 offset:20480
    v_mfma_f32_16x16x32_bf16 v[56:59], a[200:203], a[144:147], v[56:59]
    v_mfma_f32_16x16x32_bf16 v[84:87], a[200:203], a[148:151], v[84:87]
    ds_read_b128 a[196:199], v13 offset:21504
    s_waitcnt vmcnt(7) lgkmcnt(6)
    v_mfma_f32_16x16x32_bf16 v[32:35], a[204:207], a[152:155], v[32:35]
    v_mfma_f32_16x16x32_bf16 v[60:63], a[204:207], a[156:159], v[60:63]
    ds_read_b128 a[200:203], v13 offset:22528
    v_mfma_f32_16x16x32_bf16 v[36:39], a[160:163], a[152:155], v[36:39]
    v_mfma_f32_16x16x32_bf16 v[64:67], a[160:163], a[156:159], v[64:67]
    ds_read_b128 a[204:207], v13 offset:23552
    v_mfma_f32_16x16x32_bf16 v[40:43], a[164:167], a[152:155], v[40:43]
    v_mfma_f32_16x16x32_bf16 v[68:71], a[164:167], a[156:159], v[68:71]
    ds_read_b128 a[160:163], v13 offset:24576
    v_mfma_f32_16x16x32_bf16 v[44:47], a[168:171], a[152:155], v[44:47]
    v_mfma_f32_16x16x32_bf16 v[72:75], a[168:171], a[156:159], v[72:75]
    ds_read_b128 a[164:167], v13 offset:25600
    v_mfma_f32_16x16x32_bf16 v[56:59], a[172:175], a[152:155], v[56:59]
    v_mfma_f32_16x16x32_bf16 v[84:87], a[172:175], a[156:159], v[84:87]
    ds_read_b128 a[168:171], v13 offset:26624
    s_waitcnt lgkmcnt(7)
    v_mfma_f32_16x16x32_bf16 v[48:51], a[176:179], a[0:3], 0
    v_mfma_f32_16x16x32_bf16 v[76:79], a[176:179], a[4:7], 0
    ds_read_b128 a[172:175], v13 offset:27648
    v_mfma_f32_16x16x32_bf16 v[52:55], a[180:183], a[0:3], 0
    v_mfma_f32_16x16x32_bf16 v[80:83], a[180:183], a[4:7], 0
    ds_read_b128 a[176:179], v13 offset:28672
    v_mfma_f32_16x16x32_bf16 v[48:51], a[184:187], a[8:11], v[48:51]
    v_mfma_f32_16x16x32_bf16 v[76:79], a[184:187], a[12:15], v[76:79]
    ds_read_b128 a[180:183], v13 offset:29696
    v_mfma_f32_16x16x32_bf16 v[52:55], a[188:191], a[8:11], v[52:55]
    v_mfma_f32_16x16x32_bf16 v[80:83], a[188:191], a[12:15], v[80:83]
    ds_read_b128 a[184:187], v13 offset:30720
    s_barrier
    s_waitcnt lgkmcnt(7)
    v_mfma_f32_16x16x32_bf16 v[48:51], a[192:195], a[16:19], v[48:51]
    v_mfma_f32_16x16x32_bf16 v[76:79], a[192:195], a[20:23], v[76:79]
    ds_read_b128 a[188:191], v13 offset:31744
    s_mul_i32 s25, s20, 20
    s_lshl_b32 s25, s25, 10
    s_add_u32 s62, s25, 0
    s_add_u32 s63, s25, s59
    s_add_u32 s63, s63, 10240
    s_mov_b32 m0, s62
    buffer_load_dwordx4 v8, s[28:31], s63 offen offset:0 lds
    v_mfma_f32_16x16x32_bf16 v[52:55], a[196:199], a[16:19], v[52:55]
    v_mfma_f32_16x16x32_bf16 v[80:83], a[196:199], a[20:23], v[80:83]
    ds_read_b128 a[192:195], v13 offset:32768
    buffer_load_dwordx4 v8, s[28:31], s63 offen offset:1024 lds
    v_mfma_f32_16x16x32_bf16 v[48:51], a[200:203], a[24:27], v[48:51]
    v_mfma_f32_16x16x32_bf16 v[76:79], a[200:203], a[28:31], v[76:79]
    ds_read_b128 a[196:199], v13 offset:33792
    buffer_load_dwordx4 v8, s[28:31], s63 offen offset:2048 lds
    v_mfma_f32_16x16x32_bf16 v[52:55], a[204:207], a[24:27], v[52:55]
    v_mfma_f32_16x16x32_bf16 v[80:83], a[204:207], a[28:31], v[80:83]
    ds_read_b128 a[200:203], v13 offset:34816
    buffer_load_dwordx4 v8, s[28:31], s63 offen offset:3072 lds
    s_waitcnt lgkmcnt(7)
    v_mfma_f32_16x16x32_bf16 v[48:51], a[160:163], a[32:35], v[48:51]
    v_mfma_f32_16x16x32_bf16 v[76:79], a[160:163], a[36:39], v[76:79]
    ds_read_b128 a[204:207], v13 offset:35840
    s_add_u32 s62, s62, 4096
    s_add_u32 s63, s63, 4096
    s_mov_b32 m0, s62
    buffer_load_dwordx4 v8, s[28:31], s63 offen offset:0 lds
    v_mfma_f32_16x16x32_bf16 v[52:55], a[164:167], a[32:35], v[52:55]
    v_mfma_f32_16x16x32_bf16 v[80:83], a[164:167], a[36:39], v[80:83]
    ds_read_b128 a[160:163], v13 offset:36864
    buffer_load_dwordx4 v8, s[28:31], s63 offen offset:1024 lds
    v_mfma_f32_16x16x32_bf16 v[48:51], a[168:171], a[40:43], v[48:51]
    v_mfma_f32_16x16x32_bf16 v[76:79], a[168:171], a[44:47], v[76:79]
    ds_read_b128 a[164:167], v13 offset:37888
    buffer_load_dwordx4 v8, s[28:31], s63 offen offset:2048 lds
    v_mfma_f32_16x16x32_bf16 v[52:55], a[172:175], a[40:43], v[52:55]
    v_mfma_f32_16x16x32_bf16 v[80:83], a[172:175], a[44:47], v[80:83]
    ds_read_b128 a[168:171], v13 offset:38912
    buffer_load_dwordx4 v8, s[28:31], s63 offen offset:3072 lds
    s_waitcnt lgkmcnt(7)
    v_mfma_f32_16x16x32_bf16 v[48:51], a[176:179], a[48:51], v[48:51]
    v_mfma_f32_16x16x32_bf16 v[76:79], a[176:179], a[52:55], v[76:79]
    ds_read_b128 a[172:175], v13 offset:39936
    s_add_u32 s62, s62, 4096
    s_add_u32 s63, s63, 4096
    s_mov_b32 m0, s62
    buffer_load_dwordx4 v8, s[28:31], s63 offen offset:0 lds
    v_mfma_f32_16x16x32_bf16 v[52:55], a[180:183], a[48:51], v[52:55]
    v_mfma_f32_16x16x32_bf16 v[80:83], a[180:183], a[52:55], v[80:83]
    ds_read_b128 a[176:179], v13 offset:40960
    buffer_load_dwordx4 v8, s[28:31], s63 offen offset:1024 lds
    v_mfma_f32_16x16x32_bf16 v[48:51], a[184:187], a[56:59], v[48:51]
    v_mfma_f32_16x16x32_bf16 v[76:79], a[184:187], a[60:63], v[76:79]
    ds_read_b128 a[180:183], v13 offset:41984
    buffer_load_dwordx4 v8, s[28:31], s63 offen offset:2048 lds
    v_mfma_f32_16x16x32_bf16 v[52:55], a[188:191], a[56:59], v[52:55]
    v_mfma_f32_16x16x32_bf16 v[80:83], a[188:191], a[60:63], v[80:83]
    ds_read_b128 a[184:187], v13 offset:43008
    buffer_load_dwordx4 v8, s[28:31], s63 offen offset:3072 lds
    s_waitcnt lgkmcnt(7)
    v_mfma_f32_16x16x32_bf16 v[48:51], a[192:195], a[64:67], v[48:51]
    v_mfma_f32_16x16x32_bf16 v[76:79], a[192:195], a[68:71], v[76:79]
    ds_read_b128 a[188:191], v13 offset:44032
    s_add_u32 s62, s62, 4096
    s_add_u32 s63, s63, 4096
    s_mov_b32 m0, s62
    buffer_load_dwordx4 v8, s[28:31], s63 offen offset:0 lds
    v_mfma_f32_16x16x32_bf16 v[52:55], a[196:199], a[64:67], v[52:55]
    v_mfma_f32_16x16x32_bf16 v[80:83], a[196:199], a[68:71], v[80:83]
    ds_read_b128 a[192:195], v13 offset:45056
    buffer_load_dwordx4 v8, s[28:31], s63 offen offset:1024 lds
    v_mfma_f32_16x16x32_bf16 v[48:51], a[200:203], a[72:75], v[48:51]
    v_mfma_f32_16x16x32_bf16 v[76:79], a[200:203], a[76:79], v[76:79]
    ds_read_b128 a[196:199], v13 offset:46080
    buffer_load_dwordx4 v8, s[28:31], s63 offen offset:2048 lds
    v_mfma_f32_16x16x32_bf16 v[52:55], a[204:207], a[72:75], v[52:55]
    v_mfma_f32_16x16x32_bf16 v[80:83], a[204:207], a[76:79], v[80:83]
    ds_read_b128 a[200:203], v13 offset:47104
    buffer_load_dwordx4 v8, s[28:31], s63 offen offset:3072 lds
    s_waitcnt lgkmcnt(7)
    v_mfma_f32_16x16x32_bf16 v[48:51], a[160:163], a[80:83], v[48:51]
    v_mfma_f32_16x16x32_bf16 v[76:79], a[160:163], a[84:87], v[76:79]
    ds_read_b128 a[204:207], v13 offset:48128
    s_add_u32 s62, s62, 4096
    s_add_u32 s63, s63, 4096
    s_mov_b32 m0, s62
    buffer_load_dwordx4 v8, s[28:31], s63 offen offset:0 lds
    v_mfma_f32_16x16x32_bf16 v[52:55], a[164:167], a[80:83], v[52:55]
    v_mfma_f32_16x16x32_bf16 v[80:83], a[164:167], a[84:87], v[80:83]
    ds_read_b128 a[160:163], v13 offset:49152
    buffer_load_dwordx4 v8, s[28:31], s63 offen offset:1024 lds
    v_mfma_f32_16x16x32_bf16 v[48:51], a[168:171], a[88:91], v[48:51]
    v_mfma_f32_16x16x32_bf16 v[76:79], a[168:171], a[92:95], v[76:79]
    ds_read_b128 a[164:167], v13 offset:50176
    buffer_load_dwordx4 v8, s[28:31], s63 offen offset:2048 lds
    v_mfma_f32_16x16x32_bf16 v[52:55], a[172:175], a[88:91], v[52:55]
    v_mfma_f32_16x16x32_bf16 v[80:83], a[172:175], a[92:95], v[80:83]
    ds_read_b128 a[168:171], v13 offset:51200
    buffer_load_dwordx4 v8, s[28:31], s63 offen offset:3072 lds
    s_waitcnt lgkmcnt(7)
    v_mfma_f32_16x16x32_bf16 v[48:51], a[176:179], a[96:99], v[48:51]
    v_mfma_f32_16x16x32_bf16 v[76:79], a[176:179], a[100:103], v[76:79]
    ds_read_b128 a[172:175], v13 offset:52224
    s_mul_i32 s25, s20, 3
    s_min_u32 s25, s25, 7
    s_lshl_b32 s25, s25, 10
    s_add_u32 s62, s25, 153600
    s_add_u32 s63, s25, s59
    s_add_u32 s63, s63, 92160
    s_mov_b32 m0, s62
    buffer_load_dwordx4 v8, s[28:31], s63 offen offset:0 lds
    v_mfma_f32_16x16x32_bf16 v[52:55], a[180:183], a[96:99], v[52:55]
    v_mfma_f32_16x16x32_bf16 v[80:83], a[180:183], a[100:103], v[80:83]
    ds_read_b128 a[176:179], v13 offset:53248
    buffer_load_dwordx4 v8, s[28:31], s63 offen offset:1024 lds
    v_mfma_f32_16x16x32_bf16 v[48:51], a[184:187], a[104:107], v[48:51]
    v_mfma_f32_16x16x32_bf16 v[76:79], a[184:187], a[108:111], v[76:79]
    ds_read_b128 a[180:183], v13 offset:54272
    buffer_load_dwordx4 v8, s[28:31], s63 offen offset:2048 lds
    v_mfma_f32_16x16x32_bf16 v[52:55], a[188:191], a[104:107], v[52:55]
    v_mfma_f32_16x16x32_bf16 v[80:83], a[188:191], a[108:111], v[80:83]
    ds_read_b128 a[184:187], v13 offset:55296
    s_mul_i32 s25, s20, 5
    s_lshl_b32 s25, s25, 10
    s_add_u32 s62, s25, 122880
    s_add_u32 s63, s25, s59
    s_add_u32 s63, s63, 102400
    s_mov_b32 m0, s62
    buffer_load_dwordx4 v8, s[28:31], s63 offen offset:0 lds
    s_waitcnt lgkmcnt(7)
    v_mfma_f32_16x16x32_bf16 v[48:51], a[192:195], a[112:115], v[48:51]
    v_mfma_f32_16x16x32_bf16 v[76:79], a[192:195], a[116:119], v[76:79]
    ds_read_b128 a[188:191], v13 offset:56320
    buffer_load_dwordx4 v8, s[28:31], s63 offen offset:1024 lds
    v_mfma_f32_16x16x32_bf16 v[52:55], a[196:199], a[112:115], v[52:55]
    v_mfma_f32_16x16x32_bf16 v[80:83], a[196:199], a[116:119], v[80:83]
    buffer_load_dwordx4 v8, s[28:31], s63 offen offset:2048 lds
    v_mfma_f32_16x16x32_bf16 v[48:51], a[200:203], a[120:123], v[48:51]
    v_mfma_f32_16x16x32_bf16 v[76:79], a[200:203], a[124:127], v[76:79]
    buffer_load_dwordx4 v8, s[28:31], s63 offen offset:3072 lds
    v_mfma_f32_16x16x32_bf16 v[52:55], a[204:207], a[120:123], v[52:55]
    v_mfma_f32_16x16x32_bf16 v[80:83], a[204:207], a[124:127], v[80:83]
    s_add_u32 s62, s62, 4096
    s_add_u32 s63, s63, 4096
    s_mov_b32 m0, s62
    buffer_load_dwordx4 v8, s[28:31], s63 offen offset:0 lds
    s_waitcnt lgkmcnt(4)
    v_mfma_f32_16x16x32_bf16 v[48:51], a[160:163], a[128:131], v[48:51]
    v_mfma_f32_16x16x32_bf16 v[76:79], a[160:163], a[132:135], v[76:79]
    v_mfma_f32_16x16x32_bf16 v[52:55], a[164:167], a[128:131], v[52:55]
    v_mfma_f32_16x16x32_bf16 v[80:83], a[164:167], a[132:135], v[80:83]
    v_mfma_f32_16x16x32_bf16 v[48:51], a[168:171], a[136:139], v[48:51]
    v_mfma_f32_16x16x32_bf16 v[76:79], a[168:171], a[140:143], v[76:79]
    v_mfma_f32_16x16x32_bf16 v[52:55], a[172:175], a[136:139], v[52:55]
    v_mfma_f32_16x16x32_bf16 v[80:83], a[172:175], a[140:143], v[80:83]
    s_waitcnt lgkmcnt(0)
    v_mfma_f32_16x16x32_bf16 v[48:51], a[176:179], a[144:147], v[48:51]
    v_mfma_f32_16x16x32_bf16 v[76:79], a[176:179], a[148:151], v[76:79]
    v_mfma_f32_16x16x32_bf16 v[52:55], a[180:183], a[144:147], v[52:55]
    v_mfma_f32_16x16x32_bf16 v[80:83], a[180:183], a[148:151], v[80:83]
    v_mfma_f32_16x16x32_bf16 v[48:51], a[184:187], a[152:155], v[48:51]
    v_mfma_f32_16x16x32_bf16 v[76:79], a[184:187], a[156:159], v[76:79]
    v_mfma_f32_16x16x32_bf16 v[52:55], a[188:191], a[152:155], v[52:55]
    v_mfma_f32_16x16x32_bf16 v[80:83], a[188:191], a[156:159], v[80:83]
    s_barrier
    s_mul_i32 s26, s22, 5120
    s_add_u32 s55, s59, s26
    s_add_u32 s55, s55, 194560
    s_waitcnt vmcnt(31)
    v_add_f32 v16, v16, v18
    v_add_f32 v17, v17, v19
    v_add_f32 v20, v20, v22
    v_add_f32 v21, v21, v23
    s_nop 0
    v_mov_b32 v24, v16
    v_mov_b32 v25, v17
    v_mov_b32 v26, v20
    v_mov_b32 v27, v21
    s_nop 1
    v_permlane32_swap_b32 v24, v16
    v_permlane32_swap_b32 v25, v17
    v_permlane32_swap_b32 v26, v20
    v_permlane32_swap_b32 v27, v21
    s_mul_i32 s25, s20, 10
    s_lshl_b32 s25, s25, 10
    s_add_u32 s62, s25, 81920
    s_add_u32 s63, s25, s59
    s_add_u32 s63, s63, 122880
    s_mov_b32 m0, s62
    buffer_load_dwordx4 v8, s[28:31], s63 offen offset:0 lds
    s_nop 1
    v_add_f32 v16, v16, v24
    v_add_f32 v17, v17, v25
    v_add_f32 v20, v20, v26
    v_add_f32 v21, v21, v27
    v_mov_b32 v24, v16
    v_mov_b32 v25, v17
    v_mov_b32 v26, v20
    v_mov_b32 v27, v21
    s_nop 1
    v_permlane16_swap_b32 v24, v16
    v_permlane16_swap_b32 v25, v17
    v_permlane16_swap_b32 v26, v20
    v_permlane16_swap_b32 v27, v21
    s_nop 1
    v_add_f32 v16, v16, v24
    buffer_load_dwordx4 v8, s[28:31], s63 offen offset:1024 lds
    v_add_f32 v17, v17, v25
    v_add_f32 v20, v20, v26
    v_add_f32 v21, v21, v27
    v_mul_f32 v16, 0x3acccccd, v16
    v_mul_f32 v20, 0x3acccccd, v20
    v_mul_f32 v17, 0x3acccccd, v17
    v_mul_f32 v21, 0x3acccccd, v21
    v_fma_f32 v17, -v16, v16, v17
    v_fma_f32 v21, -v20, v20, v21
    v_max_f32 v17, 0, v17
    v_max_f32 v21, 0, v21
    v_cvt_pk_bf16_f32 v18, v16, v17
    v_cvt_pk_bf16_f32 v22, v20, v21
    v_lshlrev_b32 v16, 16, v18
    v_lshlrev_b32 v20, 16, v22
    v_and_b32 v17, 0xffff0000, v18
    v_and_b32 v21, 0xffff0000, v22
    v_add_f32 v17, 0x3727c5ac, v17
    v_add_f32 v21, 0x3727c5ac, v21
    buffer_load_dwordx4 v8, s[28:31], s63 offen offset:2048 lds
    v_cvt_pk_bf16_f32 v18, v17, v17
    v_cvt_pk_bf16_f32 v22, v21, v21
    v_lshlrev_b32 v17, 16, v18
    v_lshlrev_b32 v21, 16, v22
    v_sqrt_f32 v17, v17
    v_sqrt_f32 v21, v21
    s_nop 0
    s_nop 0
    v_cvt_pk_bf16_f32 v18, v17, v17
    v_cvt_pk_bf16_f32 v22, v21, v21
    v_lshlrev_b32 v17, 16, v18
    v_lshlrev_b32 v21, 16, v22
    v_rcp_f32 v17, v17
    v_rcp_f32 v21, v21
    s_nop 0
    s_nop 0
    v_mul_f32 v16, v16, v17
    buffer_load_dwordx4 v8, s[28:31], s63 offen offset:3072 lds
    v_mul_f32 v20, v20, v21
    v_sub_f32 v16, 0, v16
    v_sub_f32 v20, 0, v20
    v_mov_b32 v30, 0xbdd2d3e8
    v_mov_b32 v31, 0xc0135761
    v_pk_mul_f32 v[176:177], v[88:89], v[16:17] op_sel_hi:[1,0]
    v_pk_mul_f32 v[178:179], v[90:91], v[16:17] op_sel_hi:[1,0]
    v_pk_mul_f32 v[180:181], v[92:93], v[16:17] op_sel_hi:[1,0]
    v_pk_mul_f32 v[182:183], v[94:95], v[16:17] op_sel_hi:[1,0]
    v_pk_mul_f32 v[184:185], v[96:97], v[16:17] op_sel_hi:[1,0]
    v_pk_mul_f32 v[186:187], v[98:99], v[16:17] op_sel_hi:[1,0]
    v_pk_mul_f32 v[188:189], v[100:101], v[16:17] op_sel_hi:[1,0]
    v_pk_mul_f32 v[190:191], v[102:103], v[16:17] op_sel_hi:[1,0]
    v_pk_mul_f32 v[192:193], v[104:105], v[16:17] op_sel_hi:[1,0]
    v_pk_mul_f32 v[194:195], v[106:107], v[16:17] op_sel_hi:[1,0]
    v_pk_mul_f32 v[196:197], v[108:109], v[16:17] op_sel_hi:[1,0]
    v_pk_mul_f32 v[198:199], v[110:111], v[16:17] op_sel_hi:[1,0]
    v_pk_mul_f32 v[200:201], v[112:113], v[16:17] op_sel_hi:[1,0]
    v_pk_mul_f32 v[202:203], v[114:115], v[16:17] op_sel_hi:[1,0]
    s_add_u32 s62, s62, 4096
    s_add_u32 s63, s63, 4096
    s_mov_b32 m0, s62
    buffer_load_dwordx4 v8, s[28:31], s63 offen offset:0 lds
    v_pk_fma_f32 v[32:33], v[32:33], v[16:17], v[176:177] op_sel:[0,1,0] op_sel_hi:[1,1,1]
    v_pk_fma_f32 v[34:35], v[34:35], v[16:17], v[178:179] op_sel:[0,1,0] op_sel_hi:[1,1,1]
    v_pk_fma_f32 v[36:37], v[36:37], v[16:17], v[180:181] op_sel:[0,1,0] op_sel_hi:[1,1,1]
    v_pk_fma_f32 v[38:39], v[38:39], v[16:17], v[182:183] op_sel:[0,1,0] op_sel_hi:[1,1,1]
    v_pk_fma_f32 v[40:41], v[40:41], v[16:17], v[184:185] op_sel:[0,1,0] op_sel_hi:[1,1,1]
    v_pk_fma_f32 v[42:43], v[42:43], v[16:17], v[186:187] op_sel:[0,1,0] op_sel_hi:[1,1,1]
    v_pk_fma_f32 v[44:45], v[44:45], v[16:17], v[188:189] op_sel:[0,1,0] op_sel_hi:[1,1,1]
    v_pk_fma_f32 v[46:47], v[46:47], v[16:17], v[190:191] op_sel:[0,1,0] op_sel_hi:[1,1,1]
    v_pk_fma_f32 v[48:49], v[48:49], v[16:17], v[192:193] op_sel:[0,1,0] op_sel_hi:[1,1,1]
    v_pk_fma_f32 v[50:51], v[50:51], v[16:17], v[194:195] op_sel:[0,1,0] op_sel_hi:[1,1,1]
    v_pk_fma_f32 v[52:53], v[52:53], v[16:17], v[196:197] op_sel:[0,1,0] op_sel_hi:[1,1,1]
    v_pk_fma_f32 v[54:55], v[54:55], v[16:17], v[198:199] op_sel:[0,1,0] op_sel_hi:[1,1,1]
    v_pk_fma_f32 v[56:57], v[56:57], v[16:17], v[200:201] op_sel:[0,1,0] op_sel_hi:[1,1,1]
    v_pk_fma_f32 v[58:59], v[58:59], v[16:17], v[202:203] op_sel:[0,1,0] op_sel_hi:[1,1,1]
    v_pk_mul_f32 v[176:177], v[32:33], v[32:33]
    v_pk_mul_f32 v[178:179], v[34:35], v[34:35]
    v_pk_mul_f32 v[180:181], v[36:37], v[36:37]
    v_pk_mul_f32 v[182:183], v[38:39], v[38:39]
    v_pk_mul_f32 v[184:185], v[40:41], v[40:41]
    buffer_load_dwordx4 v8, s[28:31], s63 offen offset:1024 lds
    v_pk_mul_f32 v[186:187], v[42:43], v[42:43]
    v_pk_mul_f32 v[188:189], v[44:45], v[44:45]
    v_pk_mul_f32 v[190:191], v[46:47], v[46:47]
    v_pk_mul_f32 v[192:193], v[48:49], v[48:49]
    v_pk_mul_f32 v[194:195], v[50:51], v[50:51]
    v_pk_mul_f32 v[196:197], v[52:53], v[52:53]
    v_pk_mul_f32 v[198:199], v[54:55], v[54:55]
    v_pk_mul_f32 v[200:201], v[56:57], v[56:57]
    v_pk_mul_f32 v[202:203], v[58:59], v[58:59]
    v_pk_fma_f32 v[176:177], v[176:177], v[30:31], v[30:31] op_sel:[0,0,1] op_sel_hi:[1,0,1]
    v_pk_fma_f32 v[178:179], v[178:179], v[30:31], v[30:31] op_sel:[0,0,1] op_sel_hi:[1,0,1]
    v_pk_fma_f32 v[180:181], v[180:181], v[30:31], v[30:31] op_sel:[0,0,1] op_sel_hi:[1,0,1]
    v_pk_fma_f32 v[182:183], v[182:183], v[30:31], v[30:31] op_sel:[0,0,1] op_sel_hi:[1,0,1]
    v_pk_fma_f32 v[184:185], v[184:185], v[30:31], v[30:31] op_sel:[0,0,1] op_sel_hi:[1,0,1]
    v_pk_fma_f32 v[186:187], v[186:187], v[30:31], v[30:31] op_sel:[0,0,1] op_sel_hi:[1,0,1]
    v_pk_fma_f32 v[188:189], v[188:189], v[30:31], v[30:31] op_sel:[0,0,1] op_sel_hi:[1,0,1]
    v_pk_fma_f32 v[190:191], v[190:191], v[30:31], v[30:31] op_sel:[0,0,1] op_sel_hi:[1,0,1]
    v_pk_fma_f32 v[192:193], v[192:193], v[30:31], v[30:31] op_sel:[0,0,1] op_sel_hi:[1,0,1]
    v_pk_fma_f32 v[194:195], v[194:195], v[30:31], v[30:31] op_sel:[0,0,1] op_sel_hi:[1,0,1]
    buffer_load_dwordx4 v8, s[28:31], s63 offen offset:2048 lds
    v_pk_fma_f32 v[196:197], v[196:197], v[30:31], v[30:31] op_sel:[0,0,1] op_sel_hi:[1,0,1]
    v_pk_fma_f32 v[198:199], v[198:199], v[30:31], v[30:31] op_sel:[0,0,1] op_sel_hi:[1,0,1]
    v_pk_fma_f32 v[200:201], v[200:201], v[30:31], v[30:31] op_sel:[0,0,1] op_sel_hi:[1,0,1]
    v_pk_fma_f32 v[202:203], v[202:203], v[30:31], v[30:31] op_sel:[0,0,1] op_sel_hi:[1,0,1]
    v_pk_mul_f32 v[176:177], v[176:177], v[32:33]
    v_pk_mul_f32 v[178:179], v[178:179], v[34:35]
    v_pk_mul_f32 v[180:181], v[180:181], v[36:37]
    v_pk_mul_f32 v[182:183], v[182:183], v[38:39]
    v_pk_mul_f32 v[184:185], v[184:185], v[40:41]
    v_pk_mul_f32 v[186:187], v[186:187], v[42:43]
    v_pk_mul_f32 v[188:189], v[188:189], v[44:45]
    v_pk_mul_f32 v[190:191], v[190:191], v[46:47]
    v_pk_mul_f32 v[192:193], v[192:193], v[48:49]
    v_pk_mul_f32 v[194:195], v[194:195], v[50:51]
    v_pk_mul_f32 v[196:197], v[196:197], v[52:53]
    v_pk_mul_f32 v[198:199], v[198:199], v[54:55]
    v_pk_mul_f32 v[200:201], v[200:201], v[56:57]
    v_pk_mul_f32 v[202:203], v[202:203], v[58:59]
    v_exp_f32 v176, v176
    buffer_load_dwordx4 v8, s[28:31], s63 offen offset:3072 lds
    v_exp_f32 v177, v177
    v_exp_f32 v178, v178
    v_exp_f32 v179, v179
    v_exp_f32 v180, v180
    v_exp_f32 v181, v181
    v_exp_f32 v182, v182
    v_exp_f32 v183, v183
    v_exp_f32 v184, v184
    v_exp_f32 v185, v185
    v_exp_f32 v186, v186
    s_add_u32 s62, s62, 4096
    s_add_u32 s63, s63, 4096
    s_mov_b32 m0, s62
    buffer_load_dwordx4 v8, s[28:31], s63 offen offset:0 lds
    v_exp_f32 v187, v187
    v_exp_f32 v188, v188
    v_exp_f32 v189, v189
    v_exp_f32 v190, v190
    v_exp_f32 v191, v191
    v_exp_f32 v192, v192
    v_exp_f32 v193, v193
    v_exp_f32 v194, v194
    v_exp_f32 v195, v195
    v_exp_f32 v196, v196
    buffer_load_dwordx4 v8, s[28:31], s63 offen offset:1024 lds
    v_exp_f32 v197, v197
    v_exp_f32 v198, v198
    v_exp_f32 v199, v199
    v_exp_f32 v200, v200
    v_exp_f32 v201, v201
    v_exp_f32 v202, v202
    v_exp_f32 v203, v203
    v_pk_add_f32 v[176:177], v[176:177], 1.0 op_sel_hi:[1,0]
    v_pk_add_f32 v[178:179], v[178:179], 1.0 op_sel_hi:[1,0]
    v_pk_add_f32 v[180:181], v[180:181], 1.0 op_sel_hi:[1,0]
    v_pk_add_f32 v[182:183], v[182:183], 1.0 op_sel_hi:[1,0]
    v_pk_add_f32 v[184:185], v[184:185], 1.0 op_sel_hi:[1,0]
    buffer_load_dwordx4 a[96:99], v8, s[28:31], s55 offen offset:0
    v_pk_add_f32 v[186:187], v[186:187], 1.0 op_sel_hi:[1,0]
    v_pk_add_f32 v[188:189], v[188:189], 1.0 op_sel_hi:[1,0]
    v_pk_add_f32 v[190:191], v[190:191], 1.0 op_sel_hi:[1,0]
    v_pk_add_f32 v[192:193], v[192:193], 1.0 op_sel_hi:[1,0]
    v_pk_add_f32 v[194:195], v[194:195], 1.0 op_sel_hi:[1,0]
    v_pk_add_f32 v[196:197], v[196:197], 1.0 op_sel_hi:[1,0]
    v_pk_add_f32 v[198:199], v[198:199], 1.0 op_sel_hi:[1,0]
    v_pk_add_f32 v[200:201], v[200:201], 1.0 op_sel_hi:[1,0]
    v_pk_add_f32 v[202:203], v[202:203], 1.0 op_sel_hi:[1,0]
    v_rcp_f32 v176, v176
    v_rcp_f32 v177, v177
    v_rcp_f32 v178, v178
    v_rcp_f32 v179, v179
    v_rcp_f32 v180, v180
    buffer_load_dwordx4 a[100:103], v8, s[28:31], s55 offen offset:1024
    v_rcp_f32 v181, v181
    v_rcp_f32 v182, v182
    v_rcp_f32 v183, v183
    v_rcp_f32 v184, v184
    v_rcp_f32 v185, v185
    v_rcp_f32 v186, v186
    v_rcp_f32 v187, v187
    v_rcp_f32 v188, v188
    v_rcp_f32 v189, v189
    v_rcp_f32 v190, v190
    buffer_load_dwordx4 a[104:107], v8, s[28:31], s55 offen offset:2048
    v_rcp_f32 v191, v191
    v_rcp_f32 v192, v192
    v_rcp_f32 v193, v193
    v_rcp_f32 v194, v194
    v_rcp_f32 v195, v195
    v_rcp_f32 v196, v196
    v_rcp_f32 v197, v197
    v_rcp_f32 v198, v198
    v_rcp_f32 v199, v199
    v_rcp_f32 v200, v200
    buffer_load_dwordx4 a[108:111], v8, s[28:31], s55 offen offset:3072
    v_rcp_f32 v201, v201
    v_rcp_f32 v202, v202
    v_rcp_f32 v203, v203
    v_pk_mul_f32 v[32:33], v[32:33], v[176:177]
    v_pk_mul_f32 v[34:35], v[34:35], v[178:179]
    v_pk_mul_f32 v[36:37], v[36:37], v[180:181]
    v_pk_mul_f32 v[38:39], v[38:39], v[182:183]
    v_pk_mul_f32 v[40:41], v[40:41], v[184:185]
    v_pk_mul_f32 v[42:43], v[42:43], v[186:187]
    v_pk_mul_f32 v[44:45], v[44:45], v[188:189]
    v_pk_mul_f32 v[46:47], v[46:47], v[190:191]
    v_pk_mul_f32 v[48:49], v[48:49], v[192:193]
    v_pk_mul_f32 v[50:51], v[50:51], v[194:195]
    v_pk_mul_f32 v[52:53], v[52:53], v[196:197]
    v_pk_mul_f32 v[54:55], v[54:55], v[198:199]
    v_pk_mul_f32 v[56:57], v[56:57], v[200:201]
    s_add_u32 s55, s55, 4096
    buffer_load_dwordx4 a[112:115], v8, s[28:31], s55 offen offset:0
    s_add_u32 s55, s55, 6144
    v_pk_mul_f32 v[58:59], v[58:59], v[202:203]
    v_cvt_pk_bf16_f32 v144, v32, v33
    v_cvt_pk_bf16_f32 v145, v34, v35
    v_cvt_pk_bf16_f32 v146, v36, v37
    v_cvt_pk_bf16_f32 v147, v38, v39
    v_cvt_pk_bf16_f32 v148, v40, v41
    v_cvt_pk_bf16_f32 v149, v42, v43
    v_cvt_pk_bf16_f32 v150, v44, v45
    v_cvt_pk_bf16_f32 v151, v46, v47
    v_cvt_pk_bf16_f32 v152, v48, v49
    v_cvt_pk_bf16_f32 v153, v50, v51
    v_cvt_pk_bf16_f32 v154, v52, v53
    v_cvt_pk_bf16_f32 v155, v54, v55
    v_cvt_pk_bf16_f32 v156, v56, v57
    v_cvt_pk_bf16_f32 v157, v58, v59
    s_nop 1
    v_permlane16_swap_b32 v144, v146
    v_permlane16_swap_b32 v145, v147
    v_permlane16_swap_b32 v148, v150
    v_permlane16_swap_b32 v149, v151
    v_permlane16_swap_b32 v152, v154
    v_permlane16_swap_b32 v153, v155
    s_add_u32 s26, s13, 0
    s_add_u32 s27, s12, 0
    buffer_store_dwordx4 v[144:147], v226, s[28:31], s26 offen sc1
    buffer_store_dwordx2 v[156:157], v227, s[28:31], s27 offen sc1
    s_cmp_eq_u32 s52, 15
    s_cbranch_scc1 chain_kernel_j157
    buffer_store_dwordx4 v[148:151], v226, s[28:31], s26 offen offset:1024 sc1
    buffer_store_dwordx4 v[152:155], v226, s[28:31], s26 offen offset:2048 sc1
chain_kernel_j157:
    v_pk_mul_f32 v[176:177], v[88:89], v[20:21] op_sel_hi:[1,0]
    buffer_load_dwordx4 a[116:119], v8, s[28:31], s55 offen offset:0
    v_pk_mul_f32 v[178:179], v[90:91], v[20:21] op_sel_hi:[1,0]
    v_pk_mul_f32 v[180:181], v[92:93], v[20:21] op_sel_hi:[1,0]
    v_pk_mul_f32 v[182:183], v[94:95], v[20:21] op_sel_hi:[1,0]
    v_pk_mul_f32 v[184:185], v[96:97], v[20:21] op_sel_hi:[1,0]
    v_pk_mul_f32 v[186:187], v[98:99], v[20:21] op_sel_hi:[1,0]
    v_pk_mul_f32 v[188:189], v[100:101], v[20:21] op_sel_hi:[1,0]
    v_pk_mul_f32 v[190:191], v[102:103], v[20:21] op_sel_hi:[1,0]
    v_pk_mul_f32 v[192:193], v[104:105], v[20:21] op_sel_hi:[1,0]
    v_pk_mul_f32 v[194:195], v[106:107], v[20:21] op_sel_hi:[1,0]
    v_pk_mul_f32 v[196:197], v[108:109], v[20:21] op_sel_hi:[1,0]
    v_pk_mul_f32 v[198:199], v[110:111], v[20:21] op_sel_hi:[1,0]
    v_pk_mul_f32 v[200:201], v[112:113], v[20:21] op_sel_hi:[1,0]
    v_pk_mul_f32 v[202:203], v[114:115], v[20:21] op_sel_hi:[1,0]
    v_pk_fma_f32 v[60:61], v[60:61], v[20:21], v[176:177] op_sel:[0,1,0] op_sel_hi:[1,1,1]
    v_pk_fma_f32 v[62:63], v[62:63], v[20:21], v[178:179] op_sel:[0,1,0] op_sel_hi:[1,1,1]
    v_pk_fma_f32 v[64:65], v[64:65], v[20:21], v[180:181] op_sel:[0,1,0] op_sel_hi:[1,1,1]
    v_pk_fma_f32 v[66:67], v[66:67], v[20:21], v[182:183] op_sel:[0,1,0] op_sel_hi:[1,1,1]
    v_pk_fma_f32 v[68:69], v[68:69], v[20:21], v[184:185] op_sel:[0,1,0] op_sel_hi:[1,1,1]
    v_pk_fma_f32 v[70:71], v[70:71], v[20:21], v[186:187] op_sel:[0,1,0] op_sel_hi:[1,1,1]
    buffer_load_dwordx4 a[120:123], v8, s[28:31], s55 offen offset:1024
    v_pk_fma_f32 v[72:73], v[72:73], v[20:21], v[188:189] op_sel:[0,1,0] op_sel_hi:[1,1,1]
    v_pk_fma_f32 v[74:75], v[74:75], v[20:21], v[190:191] op_sel:[0,1,0] op_sel_hi:[1,1,1]
    v_pk_fma_f32 v[76:77], v[76:77], v[20:21], v[192:193] op_sel:[0,1,0] op_sel_hi:[1,1,1]
    v_pk_fma_f32 v[78:79], v[78:79], v[20:21], v[194:195] op_sel:[0,1,0] op_sel_hi:[1,1,1]
    v_pk_fma_f32 v[80:81], v[80:81], v[20:21], v[196:197] op_sel:[0,1,0] op_sel_hi:[1,1,1]
    v_pk_fma_f32 v[82:83], v[82:83], v[20:21], v[198:199] op_sel:[0,1,0] op_sel_hi:[1,1,1]
    v_pk_fma_f32 v[84:85], v[84:85], v[20:21], v[200:201] op_sel:[0,1,0] op_sel_hi:[1,1,1]
    v_pk_fma_f32 v[86:87], v[86:87], v[20:21], v[202:203] op_sel:[0,1,0] op_sel_hi:[1,1,1]
    v_pk_mul_f32 v[176:177], v[60:61], v[60:61]
    v_pk_mul_f32 v[178:179], v[62:63], v[62:63]
    v_pk_mul_f32 v[180:181], v[64:65], v[64:65]
    v_pk_mul_f32 v[182:183], v[66:67], v[66:67]
    v_pk_mul_f32 v[184:185], v[68:69], v[68:69]
    v_pk_mul_f32 v[186:187], v[70:71], v[70:71]
    v_pk_mul_f32 v[188:189], v[72:73], v[72:73]
    v_pk_mul_f32 v[190:191], v[74:75], v[74:75]
    v_pk_mul_f32 v[192:193], v[76:77], v[76:77]
    v_pk_mul_f32 v[194:195], v[78:79], v[78:79]
    v_pk_mul_f32 v[196:197], v[80:81], v[80:81]
    buffer_load_dwordx4 a[124:127], v8, s[28:31], s55 offen offset:2048
    v_pk_mul_f32 v[198:199], v[82:83], v[82:83]
    v_pk_mul_f32 v[200:201], v[84:85], v[84:85]
    v_pk_mul_f32 v[202:203], v[86:87], v[86:87]
    v_pk_fma_f32 v[176:177], v[176:177], v[30:31], v[30:31] op_sel:[0,0,1] op_sel_hi:[1,0,1]
    v_pk_fma_f32 v[178:179], v[178:179], v[30:31], v[30:31] op_sel:[0,0,1] op_sel_hi:[1,0,1]
    v_pk_fma_f32 v[180:181], v[180:181], v[30:31], v[30:31] op_sel:[0,0,1] op_sel_hi:[1,0,1]
    v_pk_fma_f32 v[182:183], v[182:183], v[30:31], v[30:31] op_sel:[0,0,1] op_sel_hi:[1,0,1]
    v_pk_fma_f32 v[184:185], v[184:185], v[30:31], v[30:31] op_sel:[0,0,1] op_sel_hi:[1,0,1]
    v_pk_fma_f32 v[186:187], v[186:187], v[30:31], v[30:31] op_sel:[0,0,1] op_sel_hi:[1,0,1]
    v_pk_fma_f32 v[188:189], v[188:189], v[30:31], v[30:31] op_sel:[0,0,1] op_sel_hi:[1,0,1]
    v_pk_fma_f32 v[190:191], v[190:191], v[30:31], v[30:31] op_sel:[0,0,1] op_sel_hi:[1,0,1]
    v_pk_fma_f32 v[192:193], v[192:193], v[30:31], v[30:31] op_sel:[0,0,1] op_sel_hi:[1,0,1]
    v_pk_fma_f32 v[194:195], v[194:195], v[30:31], v[30:31] op_sel:[0,0,1] op_sel_hi:[1,0,1]
    v_pk_fma_f32 v[196:197], v[196:197], v[30:31], v[30:31] op_sel:[0,0,1] op_sel_hi:[1,0,1]
    v_pk_fma_f32 v[198:199], v[198:199], v[30:31], v[30:31] op_sel:[0,0,1] op_sel_hi:[1,0,1]
    v_pk_fma_f32 v[200:201], v[200:201], v[30:31], v[30:31] op_sel:[0,0,1] op_sel_hi:[1,0,1]
    v_pk_fma_f32 v[202:203], v[202:203], v[30:31], v[30:31] op_sel:[0,0,1] op_sel_hi:[1,0,1]
    v_pk_mul_f32 v[176:177], v[176:177], v[60:61]
    v_pk_mul_f32 v[178:179], v[178:179], v[62:63]
    buffer_load_dwordx4 a[128:131], v8, s[28:31], s55 offen offset:3072
    v_pk_mul_f32 v[180:181], v[180:181], v[64:65]
    v_pk_mul_f32 v[182:183], v[182:183], v[66:67]
    v_pk_mul_f32 v[184:185], v[184:185], v[68:69]
    v_pk_mul_f32 v[186:187], v[186:187], v[70:71]
    v_pk_mul_f32 v[188:189], v[188:189], v[72:73]
    v_pk_mul_f32 v[190:191], v[190:191], v[74:75]
    v_pk_mul_f32 v[192:193], v[192:193], v[76:77]
    v_pk_mul_f32 v[194:195], v[194:195], v[78:79]
    v_pk_mul_f32 v[196:197], v[196:197], v[80:81]
    v_pk_mul_f32 v[198:199], v[198:199], v[82:83]
    v_pk_mul_f32 v[200:201], v[200:201], v[84:85]
    v_pk_mul_f32 v[202:203], v[202:203], v[86:87]
    v_exp_f32 v176, v176
    v_exp_f32 v177, v177
    v_exp_f32 v178, v178
    v_exp_f32 v179, v179
    s_add_u32 s55, s55, 4096
    buffer_load_dwordx4 a[132:135], v8, s[28:31], s55 offen offset:0
    s_add_u32 s55, s55, 6144
    v_exp_f32 v180, v180
    v_exp_f32 v181, v181
    v_exp_f32 v182, v182
    v_exp_f32 v183, v183
    v_exp_f32 v184, v184
    v_exp_f32 v185, v185
    v_exp_f32 v186, v186
    v_exp_f32 v187, v187
    v_exp_f32 v188, v188
    v_exp_f32 v189, v189
    buffer_load_dwordx4 a[136:139], v8, s[28:31], s55 offen offset:0
    v_exp_f32 v190, v190
    v_exp_f32 v191, v191
    v_exp_f32 v192, v192
    v_exp_f32 v193, v193
    v_exp_f32 v194, v194
    v_exp_f32 v195, v195
    v_exp_f32 v196, v196
    v_exp_f32 v197, v197
    v_exp_f32 v198, v198
    v_exp_f32 v199, v199
    buffer_load_dwordx4 a[140:143], v8, s[28:31], s55 offen offset:1024
    v_exp_f32 v200, v200
    v_exp_f32 v201, v201
    v_exp_f32 v202, v202
    v_exp_f32 v203, v203
    v_pk_add_f32 v[176:177], v[176:177], 1.0 op_sel_hi:[1,0]
    v_pk_add_f32 v[178:179], v[178:179], 1.0 op_sel_hi:[1,0]
    v_pk_add_f32 v[180:181], v[180:181], 1.0 op_sel_hi:[1,0]
    v_pk_add_f32 v[182:183], v[182:183], 1.0 op_sel_hi:[1,0]
    v_pk_add_f32 v[184:185], v[184:185], 1.0 op_sel_hi:[1,0]
    v_pk_add_f32 v[186:187], v[186:187], 1.0 op_sel_hi:[1,0]
    v_pk_add_f32 v[188:189], v[188:189], 1.0 op_sel_hi:[1,0]
    v_pk_add_f32 v[190:191], v[190:191], 1.0 op_sel_hi:[1,0]
    v_pk_add_f32 v[192:193], v[192:193], 1.0 op_sel_hi:[1,0]
    v_pk_add_f32 v[194:195], v[194:195], 1.0 op_sel_hi:[1,0]
    v_pk_add_f32 v[196:197], v[196:197], 1.0 op_sel_hi:[1,0]
    buffer_load_dwordx4 a[144:147], v8, s[28:31], s55 offen offset:2048
    v_pk_add_f32 v[198:199], v[198:199], 1.0 op_sel_hi:[1,0]
    v_pk_add_f32 v[200:201], v[200:201], 1.0 op_sel_hi:[1,0]
    v_pk_add_f32 v[202:203], v[202:203], 1.0 op_sel_hi:[1,0]
    v_rcp_f32 v176, v176
    v_rcp_f32 v177, v177
    v_rcp_f32 v178, v178
    v_rcp_f32 v179, v179
    v_rcp_f32 v180, v180
    v_rcp_f32 v181, v181
    v_rcp_f32 v182, v182
    v_rcp_f32 v183, v183
    buffer_load_dwordx4 a[148:151], v8, s[28:31], s55 offen offset:3072
    v_rcp_f32 v184, v184
    v_rcp_f32 v185, v185
    v_rcp_f32 v186, v186
    v_rcp_f32 v187, v187
    v_rcp_f32 v188, v188
    v_rcp_f32 v189, v189
    v_rcp_f32 v190, v190
    v_rcp_f32 v191, v191
    v_rcp_f32 v192, v192
    v_rcp_f32 v193, v193
    s_add_u32 s55, s55, 4096
    buffer_load_dwordx4 a[152:155], v8, s[28:31], s55 offen offset:0
    s_add_u32 s55, s55, 6144
    v_rcp_f32 v194, v194
    v_rcp_f32 v195, v195
    v_rcp_f32 v196, v196
    v_rcp_f32 v197, v197
    v_rcp_f32 v198, v198
    v_rcp_f32 v199, v199
    v_rcp_f32 v200, v200
    v_rcp_f32 v201, v201
    v_rcp_f32 v202, v202
    v_rcp_f32 v203, v203
    buffer_load_dwordx4 a[156:159], v8, s[28:31], s55 offen offset:0
    v_pk_mul_f32 v[60:61], v[60:61], v[176:177]
    v_pk_mul_f32 v[62:63], v[62:63], v[178:179]
    v_pk_mul_f32 v[64:65], v[64:65], v[180:181]
    v_pk_mul_f32 v[66:67], v[66:67], v[182:183]
    v_pk_mul_f32 v[68:69], v[68:69], v[184:185]
    v_pk_mul_f32 v[70:71], v[70:71], v[186:187]
    v_pk_mul_f32 v[72:73], v[72:73], v[188:189]
    v_pk_mul_f32 v[74:75], v[74:75], v[190:191]
    v_pk_mul_f32 v[76:77], v[76:77], v[192:193]
    v_pk_mul_f32 v[78:79], v[78:79], v[194:195]
    v_pk_mul_f32 v[80:81], v[80:81], v[196:197]
    v_pk_mul_f32 v[82:83], v[82:83], v[198:199]
    v_pk_mul_f32 v[84:85], v[84:85], v[200:201]
    v_pk_mul_f32 v[86:87], v[86:87], v[202:203]
    v_cvt_pk_bf16_f32 v160, v60, v61
    v_cvt_pk_bf16_f32 v161, v62, v63
    v_cvt_pk_bf16_f32 v162, v64, v65
    v_cvt_pk_bf16_f32 v163, v66, v67
    v_cvt_pk_bf16_f32 v164, v68, v69
    v_cvt_pk_bf16_f32 v165, v70, v71
    v_cvt_pk_bf16_f32 v166, v72, v73
    v_cvt_pk_bf16_f32 v167, v74, v75
    v_cvt_pk_bf16_f32 v168, v76, v77
    v_cvt_pk_bf16_f32 v169, v78, v79
    v_cvt_pk_bf16_f32 v170, v80, v81
    v_cvt_pk_bf16_f32 v171, v82, v83
    v_cvt_pk_bf16_f32 v172, v84, v85
    v_cvt_pk_bf16_f32 v173, v86, v87
    s_nop 1
    v_permlane16_swap_b32 v160, v162
    v_permlane16_swap_b32 v161, v163
    v_permlane16_swap_b32 v164, v166
    v_permlane16_swap_b32 v165, v167
    v_permlane16_swap_b32 v168, v170
    v_permlane16_swap_b32 v169, v171
    s_add_u32 s26, s13, 55296
    s_add_u32 s27, s12, 55296
    buffer_store_dwordx4 v[160:163], v226, s[28:31], s26 offen sc1
    buffer_store_dwordx2 v[172:173], v227, s[28:31], s27 offen sc1
    s_cmp_eq_u32 s52, 15
    s_cbranch_scc1 chain_kernel_j158
    buffer_store_dwordx4 v[164:167], v226, s[28:31], s26 offen offset:1024 sc1
    buffer_store_dwordx4 v[168:171], v226, s[28:31], s26 offen offset:2048 sc1
chain_kernel_j158:
    s_waitcnt vmcnt(0)
    v_mov_b32 v2, 1
    v_mov_b32 v7, 0
    s_mov_b64 exec, 1
    buffer_store_dword v2, v7, s[28:31], s15 offen sc1
    s_mov_b64 exec, -1
    buffer_load_dwordx4 a[160:163], v8, s[28:31], s55 offen offset:1024
    buffer_load_dwordx4 a[164:167], v8, s[28:31], s55 offen offset:2048
    buffer_load_dwordx4 a[168:171], v8, s[28:31], s55 offen offset:3072
    s_add_u32 s55, s55, 4096
    buffer_load_dwordx4 a[172:175], v8, s[28:31], s55 offen offset:0
    s_add_u32 s55, s55, 6144
    buffer_load_dwordx4 a[176:179], v8, s[28:31], s55 offen offset:0
    buffer_load_dwordx4 a[180:183], v8, s[28:31], s55 offen offset:1024
    buffer_load_dwordx4 a[184:187], v8, s[28:31], s55 offen offset:2048
    buffer_load_dwordx4 a[188:191], v8, s[28:31], s55 offen offset:3072
    s_add_u32 s55, s55, 4096
    buffer_load_dwordx4 a[192:195], v8, s[28:31], s55 offen offset:0
    s_add_u32 s55, s55, 6144
    buffer_load_dwordx4 a[196:199], v8, s[28:31], s55 offen offset:0
    buffer_load_dwordx4 a[200:203], v8, s[28:31], s55 offen offset:1024
    buffer_load_dwordx4 a[204:207], v8, s[28:31], s55 offen offset:2048
    buffer_load_dwordx4 a[208:211], v8, s[28:31], s55 offen offset:3072
    s_add_u32 s55, s55, 4096
    buffer_load_dwordx4 a[212:215], v8, s[28:31], s55 offen offset:0
    s_add_u32 s55, s55, 6144
    buffer_load_dwordx4 a[216:219], v8, s[28:31], s55 offen offset:0
    buffer_load_dwordx4 a[220:223], v8, s[28:31], s55 offen offset:1024
    buffer_load_dwordx4 a[224:227], v8, s[28:31], s55 offen offset:2048
    buffer_load_dwordx4 a[228:231], v8, s[28:31], s55 offen offset:3072
    s_add_u32 s55, s55, 4096
    buffer_load_dwordx4 a[232:235], v8, s[28:31], s55 offen offset:0
    s_add_u32 s55, s55, 6144
    buffer_load_dwordx4 a[236:239], v8, s[28:31], s55 offen offset:0
    buffer_load_dwordx4 a[240:243], v8, s[28:31], s55 offen offset:1024
    buffer_load_dwordx4 a[244:247], v8, s[28:31], s55 offen offset:2048
    buffer_load_dwordx4 a[248:251], v8, s[28:31], s55 offen offset:3072
    s_add_u32 s55, s55, 4096
    buffer_load_dwordx4 a[252:255], v8, s[28:31], s55 offen offset:0
    s_add_u32 s55, s55, 6144
    s_mul_i32 s26, s22, 5120
    v_add_u32 v12, s26, v8
    v_add_u32 v13, 0x10000, v12
    v_add_u32 v14, 0x20000, v12
    s_mov_b32 s47, 0
    s_mov_b64 exec, 511
chain_kernel_poll9:
    buffer_load_dword v2, v234, s[28:31], s48 offen sc1
    s_add_u32 s47, s47, 1
    s_waitcnt vmcnt(0)
    v_cmp_ne_u32 vcc, 1, v2
    s_cmp_ge_u32 s47, 20000
    s_cbranch_scc1 chain_kernel_polld10
    s_cbranch_vccnz chain_kernel_poll9
chain_kernel_polld10:
    s_mov_b64 exec, -1
    buffer_load_dwordx4 a[0:3], v8, s[28:31], s50 offen offset:0 sc1
    buffer_load_dwordx4 a[4:7], v8, s[28:31], s51 offen offset:0 sc1
    buffer_load_dwordx4 a[8:11], v8, s[28:31], s50 offen offset:1024 sc1
    buffer_load_dwordx4 a[12:15], v8, s[28:31], s51 offen offset:1024 sc1
    buffer_load_dwordx4 a[16:19], v8, s[28:31], s50 offen offset:2048 sc1
    buffer_load_dwordx4 a[20:23], v8, s[28:31], s51 offen offset:2048 sc1
    buffer_load_dwordx4 a[24:27], v8, s[28:31], s50 offen offset:3072 sc1
    buffer_load_dwordx4 a[28:31], v8, s[28:31], s51 offen offset:3072 sc1
    s_add_u32 s50, s50, 4096
    s_add_u32 s51, s51, 4096
    buffer_load_dwordx4 a[32:35], v8, s[28:31], s50 offen offset:0 sc1
    buffer_load_dwordx4 a[36:39], v8, s[28:31], s51 offen offset:0 sc1
    s_barrier
    ds_read_b128 v[176:179], v14 offset:12288
    ds_read_b128 v[180:183], v14 offset:13312
    ds_read_b128 v[184:187], v14 offset:14336
    ds_read_b128 v[188:191], v14 offset:15360
    ds_read_b128 v[192:195], v14 offset:16384
    ds_read_b128 v[196:199], v12 offset:0
    ds_read_b128 v[200:203], v12 offset:1024
    ds_read_b128 v[204:207], v12 offset:2048
    ds_read_b128 v[208:211], v12 offset:3072
    ds_read_b128 v[212:215], v12 offset:4096
    ds_read_b128 v[216:219], v12 offset:10240
    s_waitcnt vmcnt(8) lgkmcnt(6)
    v_mfma_f32_16x16x32_bf16 v[32:35], v[176:179], a[0:3], 0
    v_mfma_f32_16x16x32_bf16 v[52:55], v[176:179], a[4:7], 0
    ds_read_b128 v[220:223], v12 offset:11264
    buffer_load_dwordx4 a[40:43], v8, s[28:31], s50 offen offset:1024 sc1
    v_mfma_f32_16x16x32_bf16 v[36:39], v[180:183], a[0:3], 0
    v_mfma_f32_16x16x32_bf16 v[56:59], v[180:183], a[4:7], 0
    ds_read_b128 v[176:179], v12 offset:12288
    buffer_load_dwordx4 a[44:47], v8, s[28:31], s51 offen offset:1024 sc1
    v_mfma_f32_16x16x32_bf16 v[40:43], v[184:187], a[0:3], 0
    v_mfma_f32_16x16x32_bf16 v[60:63], v[184:187], a[4:7], 0
    ds_read_b128 v[180:183], v12 offset:13312
    buffer_load_dwordx4 a[48:51], v8, s[28:31], s50 offen offset:2048 sc1
    v_mfma_f32_16x16x32_bf16 v[44:47], v[188:191], a[0:3], 0
    v_mfma_f32_16x16x32_bf16 v[64:67], v[188:191], a[4:7], 0
    ds_read_b128 v[184:187], v12 offset:14336
    buffer_load_dwordx4 a[52:55], v8, s[28:31], s51 offen offset:2048 sc1
    v_mfma_f32_16x16x32_bf16 v[48:51], v[192:195], a[0:3], 0
    v_mfma_f32_16x16x32_bf16 v[68:71], v[192:195], a[4:7], 0
    ds_read_b128 v[188:191], v12 offset:20480
    buffer_load_dwordx4 a[56:59], v8, s[28:31], s50 offen offset:3072 sc1
    s_waitcnt vmcnt(11) lgkmcnt(6)
    v_mfma_f32_16x16x32_bf16 v[32:35], v[196:199], a[8:11], v[32:35]
    v_mfma_f32_16x16x32_bf16 v[52:55], v[196:199], a[12:15], v[52:55]
    ds_read_b128 v[192:195], v12 offset:21504
    buffer_load_dwordx4 a[60:63], v8, s[28:31], s51 offen offset:3072 sc1
    v_mfma_f32_16x16x32_bf16 v[36:39], v[200:203], a[8:11], v[36:39]
    v_mfma_f32_16x16x32_bf16 v[56:59], v[200:203], a[12:15], v[56:59]
    ds_read_b128 v[196:199], v12 offset:22528
    s_add_u32 s50, s50, 4096
    s_add_u32 s51, s51, 4096
    buffer_load_dwordx4 a[64:67], v8, s[28:31], s50 offen offset:0 sc1
    v_mfma_f32_16x16x32_bf16 v[40:43], v[204:207], a[8:11], v[40:43]
    v_mfma_f32_16x16x32_bf16 v[60:63], v[204:207], a[12:15], v[60:63]
    ds_read_b128 v[200:203], v12 offset:23552
    v_mfma_f32_16x16x32_bf16 v[44:47], v[208:211], a[8:11], v[44:47]
    v_mfma_f32_16x16x32_bf16 v[64:67], v[208:211], a[12:15], v[64:67]
    ds_read_b128 v[204:207], v12 offset:24576
    buffer_load_dwordx4 a[68:71], v8, s[28:31], s51 offen offset:0 sc1
    v_mfma_f32_16x16x32_bf16 v[48:51], v[212:215], a[8:11], v[48:51]
    v_mfma_f32_16x16x32_bf16 v[68:71], v[212:215], a[12:15], v[68:71]
    s_waitcnt lgkmcnt(5)
    s_barrier
    ds_read_b128 v[208:211], v12 offset:30720
    s_mul_i32 s25, s20, 3
    s_min_u32 s25, s25, 7
    s_lshl_b32 s25, s25, 10
    s_add_u32 s62, s25, 143360
    s_add_u32 s63, s25, s59
    s_add_u32 s63, s63, 163840
    s_mov_b32 m0, s62
    buffer_load_dwordx4 v8, s[28:31], s63 offen offset:0 lds
    s_waitcnt vmcnt(13) lgkmcnt(6)
    v_mfma_f32_16x16x32_bf16 v[32:35], v[216:219], a[16:19], v[32:35]
    v_mfma_f32_16x16x32_bf16 v[52:55], v[216:219], a[20:23], v[52:55]
    ds_read_b128 v[212:215], v12 offset:31744
    buffer_load_dwordx4 v8, s[28:31], s63 offen offset:1024 lds
    v_mfma_f32_16x16x32_bf16 v[36:39], v[220:223], a[16:19], v[36:39]
    v_mfma_f32_16x16x32_bf16 v[56:59], v[220:223], a[20:23], v[56:59]
    ds_read_b128 v[216:219], v12 offset:32768
    buffer_load_dwordx4 v8, s[28:31], s63 offen offset:2048 lds
    v_mfma_f32_16x16x32_bf16 v[40:43], v[176:179], a[16:19], v[40:43]
    v_mfma_f32_16x16x32_bf16 v[60:63], v[176:179], a[20:23], v[60:63]
    ds_read_b128 v[220:223], v12 offset:33792
    s_mul_i32 s25, s20, 5
    s_lshl_b32 s25, s25, 10
    s_add_u32 s62, s25, 0
    s_add_u32 s63, s25, s59
    s_add_u32 s63, s63, 174080
    s_mov_b32 m0, s62
    buffer_load_dwordx4 v8, s[28:31], s63 offen offset:0 lds
    v_mfma_f32_16x16x32_bf16 v[44:47], v[180:183], a[16:19], v[44:47]
    v_mfma_f32_16x16x32_bf16 v[64:67], v[180:183], a[20:23], v[64:67]
    ds_read_b128 v[176:179], v12 offset:34816
    buffer_load_dwordx4 v8, s[28:31], s63 offen offset:1024 lds
    v_mfma_f32_16x16x32_bf16 v[48:51], v[184:187], a[16:19], v[48:51]
    v_mfma_f32_16x16x32_bf16 v[68:71], v[184:187], a[20:23], v[68:71]
    ds_read_b128 v[180:183], v12 offset:40960
    buffer_load_dwordx4 v8, s[28:31], s63 offen offset:2048 lds
    s_waitcnt vmcnt(16) lgkmcnt(6)
    v_mfma_f32_16x16x32_bf16 v[32:35], v[188:191], a[24:27], v[32:35]
    v_mfma_f32_16x16x32_bf16 v[52:55], v[188:191], a[28:31], v[52:55]
    ds_read_b128 v[184:187], v12 offset:41984
    buffer_load_dwordx4 v8, s[28:31], s63 offen offset:3072 lds
    v_mfma_f32_16x16x32_bf16 v[36:39], v[192:195], a[24:27], v[36:39]
    v_mfma_f32_16x16x32_bf16 v[56:59], v[192:195], a[28:31], v[56:59]
    ds_read_b128 v[188:191], v12 offset:43008
    s_add_u32 s62, s62, 4096
    s_add_u32 s63, s63, 4096
    s_mov_b32 m0, s62
    buffer_load_dwordx4 v8, s[28:31], s63 offen offset:0 lds
    v_mfma_f32_16x16x32_bf16 v[40:43], v[196:199], a[24:27], v[40:43]
    v_mfma_f32_16x16x32_bf16 v[60:63], v[196:199], a[28:31], v[60:63]
    ds_read_b128 v[192:195], v12 offset:44032
    buffer_load_dwordx4 a[72:75], v8, s[28:31], s50 offen offset:1024 sc1
    v_mfma_f32_16x16x32_bf16 v[44:47], v[200:203], a[24:27], v[44:47]
    v_mfma_f32_16x16x32_bf16 v[64:67], v[200:203], a[28:31], v[64:67]
    ds_read_b128 v[196:199], v12 offset:45056
    buffer_load_dwordx4 a[76:79], v8, s[28:31], s51 offen offset:1024 sc1
    v_mfma_f32_16x16x32_bf16 v[48:51], v[204:207], a[24:27], v[48:51]
    v_mfma_f32_16x16x32_bf16 v[68:71], v[204:207], a[28:31], v[68:71]
    ds_read_b128 v[200:203], v12 offset:51200
    s_waitcnt vmcnt(18) lgkmcnt(6)
    v_mfma_f32_16x16x32_bf16 v[32:35], v[208:211], a[32:35], v[32:35]
    v_mfma_f32_16x16x32_bf16 v[52:55], v[208:211], a[36:39], v[52:55]
    ds_read_b128 v[204:207], v12 offset:52224
    buffer_load_dwordx4 a[80:83], v8, s[28:31], s50 offen offset:2048 sc1
    v_mfma_f32_16x16x32_bf16 v[36:39], v[212:215], a[32:35], v[36:39]
    v_mfma_f32_16x16x32_bf16 v[56:59], v[212:215], a[36:39], v[56:59]
    ds_read_b128 v[208:211], v12 offset:53248
    buffer_load_dwordx4 a[84:87], v8, s[28:31], s51 offen offset:2048 sc1
    v_mfma_f32_16x16x32_bf16 v[40:43], v[216:219], a[32:35], v[40:43]
    v_mfma_f32_16x16x32_bf16 v[60:63], v[216:219], a[36:39], v[60:63]
    ds_read_b128 v[212:215], v12 offset:54272
    buffer_load_dwordx4 a[88:91], v8, s[28:31], s50 offen offset:3072 sc1
    v_mfma_f32_16x16x32_bf16 v[44:47], v[220:223], a[32:35], v[44:47]
    v_mfma_f32_16x16x32_bf16 v[64:67], v[220:223], a[36:39], v[64:67]
    ds_read_b128 v[216:219], v12 offset:55296
    v_mfma_f32_16x16x32_bf16 v[48:51], v[176:179], a[32:35], v[48:51]
    v_mfma_f32_16x16x32_bf16 v[68:71], v[176:179], a[36:39], v[68:71]
    ds_read_b128 v[220:223], v12 offset:61440
    buffer_load_dwordx4 a[92:95], v8, s[28:31], s51 offen offset:3072 sc1
    s_waitcnt vmcnt(20) lgkmcnt(6)
    v_mfma_f32_16x16x32_bf16 v[32:35], v[180:183], a[40:43], v[32:35]
    v_mfma_f32_16x16x32_bf16 v[52:55], v[180:183], a[44:47], v[52:55]
    ds_read_b128 v[176:179], v12 offset:62464
    v_mfma_f32_16x16x32_bf16 v[36:39], v[184:187], a[40:43], v[36:39]
    v_mfma_f32_16x16x32_bf16 v[56:59], v[184:187], a[44:47], v[56:59]
    ds_read_b128 v[180:183], v12 offset:63488
    s_add_u32 s50, s50, 4096
    s_add_u32 s51, s51, 4096
    buffer_load_dwordx4 a[0:3], v8, s[28:31], s50 offen offset:0 sc1
    v_mfma_f32_16x16x32_bf16 v[40:43], v[188:191], a[40:43], v[40:43]
    v_mfma_f32_16x16x32_bf16 v[60:63], v[188:191], a[44:47], v[60:63]
    ds_read_b128 v[184:187], v12 offset:64512
    v_mfma_f32_16x16x32_bf16 v[44:47], v[192:195], a[40:43], v[44:47]
    v_mfma_f32_16x16x32_bf16 v[64:67], v[192:195], a[44:47], v[64:67]
    ds_read_b128 v[188:191], v13 offset:0
    buffer_load_dwordx4 a[4:7], v8, s[28:31], s51 offen offset:0 sc1
    v_mfma_f32_16x16x32_bf16 v[48:51], v[196:199], a[40:43], v[48:51]
    v_mfma_f32_16x16x32_bf16 v[68:71], v[196:199], a[44:47], v[68:71]
    ds_read_b128 v[192:195], v13 offset:6144
    s_waitcnt vmcnt(20) lgkmcnt(6)
    v_mfma_f32_16x16x32_bf16 v[32:35], v[200:203], a[48:51], v[32:35]
    v_mfma_f32_16x16x32_bf16 v[52:55], v[200:203], a[52:55], v[52:55]
    ds_read_b128 v[196:199], v13 offset:7168
    buffer_load_dwordx4 a[8:11], v8, s[28:31], s50 offen offset:1024 sc1
    v_mfma_f32_16x16x32_bf16 v[36:39], v[204:207], a[48:51], v[36:39]
    v_mfma_f32_16x16x32_bf16 v[56:59], v[204:207], a[52:55], v[56:59]
    ds_read_b128 v[200:203], v13 offset:8192
    v_mfma_f32_16x16x32_bf16 v[40:43], v[208:211], a[48:51], v[40:43]
    v_mfma_f32_16x16x32_bf16 v[60:63], v[208:211], a[52:55], v[60:63]
    ds_read_b128 v[204:207], v13 offset:9216
    buffer_load_dwordx4 a[12:15], v8, s[28:31], s51 offen offset:1024 sc1
    v_mfma_f32_16x16x32_bf16 v[44:47], v[212:215], a[48:51], v[44:47]
    v_mfma_f32_16x16x32_bf16 v[64:67], v[212:215], a[52:55], v[64:67]
    ds_read_b128 v[208:211], v13 offset:10240
    v_mfma_f32_16x16x32_bf16 v[48:51], v[216:219], a[48:51], v[48:51]
    v_mfma_f32_16x16x32_bf16 v[68:71], v[216:219], a[52:55], v[68:71]
    ds_read_b128 v[212:215], v14 offset:22528
    buffer_load_dwordx4 a[16:19], v8, s[28:31], s50 offen offset:2048 sc1
    s_waitcnt vmcnt(21) lgkmcnt(6)
    v_mfma_f32_16x16x32_bf16 v[32:35], v[220:223], a[56:59], v[32:35]
    v_mfma_f32_16x16x32_bf16 v[52:55], v[220:223], a[60:63], v[52:55]
    ds_read_b128 v[216:219], v14 offset:23552
    v_mfma_f32_16x16x32_bf16 v[36:39], v[176:179], a[56:59], v[36:39]
    v_mfma_f32_16x16x32_bf16 v[56:59], v[176:179], a[60:63], v[56:59]
    ds_read_b128 v[220:223], v14 offset:24576
    buffer_load_dwordx4 a[20:23], v8, s[28:31], s51 offen offset:2048 sc1
    v_mfma_f32_16x16x32_bf16 v[40:43], v[180:183], a[56:59], v[40:43]
    v_mfma_f32_16x16x32_bf16 v[60:63], v[180:183], a[60:63], v[60:63]
    ds_read_b128 v[176:179], v14 offset:25600
    v_mfma_f32_16x16x32_bf16 v[44:47], v[184:187], a[56:59], v[44:47]
    v_mfma_f32_16x16x32_bf16 v[64:67], v[184:187], a[60:63], v[64:67]
    ds_read_b128 v[180:183], v14 offset:26624
    buffer_load_dwordx4 a[24:27], v8, s[28:31], s50 offen offset:3072 sc1
    v_mfma_f32_16x16x32_bf16 v[48:51], v[188:191], a[56:59], v[48:51]
    v_mfma_f32_16x16x32_bf16 v[68:71], v[188:191], a[60:63], v[68:71]
    ds_read_b128 v[184:187], v13 offset:57344
    s_waitcnt vmcnt(21) lgkmcnt(6)
    v_mfma_f32_16x16x32_bf16 v[32:35], v[192:195], a[64:67], v[32:35]
    v_mfma_f32_16x16x32_bf16 v[52:55], v[192:195], a[68:71], v[52:55]
    ds_read_b128 v[188:191], v13 offset:58368
    buffer_load_dwordx4 a[28:31], v8, s[28:31], s51 offen offset:3072 sc1
    v_mfma_f32_16x16x32_bf16 v[36:39], v[196:199], a[64:67], v[36:39]
    v_mfma_f32_16x16x32_bf16 v[56:59], v[196:199], a[68:71], v[56:59]
    ds_read_b128 v[192:195], v13 offset:59392
    s_add_u32 s50, s50, 4096
    s_add_u32 s51, s51, 4096
    buffer_load_dwordx4 a[32:35], v8, s[28:31], s50 offen offset:0 sc1
    v_mfma_f32_16x16x32_bf16 v[40:43], v[200:203], a[64:67], v[40:43]
    v_mfma_f32_16x16x32_bf16 v[60:63], v[200:203], a[68:71], v[60:63]
    ds_read_b128 v[196:199], v13 offset:60416
    buffer_load_dwordx4 a[36:39], v8, s[28:31], s51 offen offset:0 sc1
    v_mfma_f32_16x16x32_bf16 v[44:47], v[204:207], a[64:67], v[44:47]
    v_mfma_f32_16x16x32_bf16 v[64:67], v[204:207], a[68:71], v[64:67]
    ds_read_b128 v[200:203], v13 offset:61440
    buffer_load_dwordx4 a[40:43], v8, s[28:31], s50 offen offset:1024 sc1
    v_mfma_f32_16x16x32_bf16 v[48:51], v[208:211], a[64:67], v[48:51]
    v_mfma_f32_16x16x32_bf16 v[68:71], v[208:211], a[68:71], v[68:71]
    ds_read_b128 v[204:207], v14 offset:2048
    buffer_load_dwordx4 a[44:47], v8, s[28:31], s51 offen offset:1024 sc1
    s_waitcnt vmcnt(16) lgkmcnt(6)
    v_mfma_f32_16x16x32_bf16 v[32:35], v[212:215], a[72:75], v[32:35]
    v_mfma_f32_16x16x32_bf16 v[52:55], v[212:215], a[76:79], v[52:55]
    ds_read_b128 v[208:211], v14 offset:3072
    s_add_u32 s26, s44, 13406208
    buffer_load_dwordx2 v[96:97], v230, s[28:31], s26 offen sc1
    v_mfma_f32_16x16x32_bf16 v[36:39], v[216:219], a[72:75], v[36:39]
    v_mfma_f32_16x16x32_bf16 v[56:59], v[216:219], a[76:79], v[56:59]
    ds_read_b128 v[212:215], v14 offset:4096
    s_mov_b32 s26, 5492736
    buffer_load_dwordx2 v[106:107], v235, s[28:31], s26 offen
    v_mfma_f32_16x16x32_bf16 v[40:43], v[220:223], a[72:75], v[40:43]
    v_mfma_f32_16x16x32_bf16 v[60:63], v[220:223], a[76:79], v[60:63]
    ds_read_b128 v[216:219], v14 offset:5120
    s_add_u32 s26, s44, 13406720
    buffer_load_dwordx2 v[98:99], v230, s[28:31], s26 offen sc1
    v_mfma_f32_16x16x32_bf16 v[44:47], v[176:179], a[72:75], v[44:47]
    v_mfma_f32_16x16x32_bf16 v[64:67], v[176:179], a[76:79], v[64:67]
    ds_read_b128 v[220:223], v14 offset:6144
    s_mov_b32 s26, 5492736
    buffer_load_dwordx2 v[108:109], v236, s[28:31], s26 offen
    v_mfma_f32_16x16x32_bf16 v[48:51], v[180:183], a[72:75], v[48:51]
    v_mfma_f32_16x16x32_bf16 v[68:71], v[180:183], a[76:79], v[68:71]
    ds_read_b128 v[176:179], v13 offset:16384
    s_add_u32 s26, s44, 13407232
    buffer_load_dwordx2 v[100:101], v230, s[28:31], s26 offen sc1
    s_waitcnt vmcnt(19) lgkmcnt(6)
    v_mfma_f32_16x16x32_bf16 v[32:35], v[184:187], a[80:83], v[32:35]
    v_mfma_f32_16x16x32_bf16 v[52:55], v[184:187], a[84:87], v[52:55]
    ds_read_b128 v[180:183], v13 offset:17408
    s_mov_b32 s26, 5492736
    buffer_load_dwordx2 v[110:111], v237, s[28:31], s26 offen
    v_mfma_f32_16x16x32_bf16 v[36:39], v[188:191], a[80:83], v[36:39]
    v_mfma_f32_16x16x32_bf16 v[56:59], v[188:191], a[84:87], v[56:59]
    ds_read_b128 v[184:187], v13 offset:18432
    s_add_u32 s26, s44, 13407744
    buffer_load_dwordx2 v[102:103], v230, s[28:31], s26 offen sc1
    v_mfma_f32_16x16x32_bf16 v[40:43], v[192:195], a[80:83], v[40:43]
    v_mfma_f32_16x16x32_bf16 v[60:63], v[192:195], a[84:87], v[60:63]
    ds_read_b128 v[188:191], v13 offset:19456
    s_mov_b32 s26, 5492736
    buffer_load_dwordx2 v[112:113], v238, s[28:31], s26 offen
    v_mfma_f32_16x16x32_bf16 v[44:47], v[196:199], a[80:83], v[44:47]
    v_mfma_f32_16x16x32_bf16 v[64:67], v[196:199], a[84:87], v[64:67]
    ds_read_b128 v[192:195], v13 offset:20480
    s_add_u32 s26, s45, 13406208
    buffer_load_dwordx2 v[104:105], v230, s[28:31], s26 offen sc1
    v_mfma_f32_16x16x32_bf16 v[48:51], v[200:203], a[80:83], v[48:51]
    v_mfma_f32_16x16x32_bf16 v[68:71], v[200:203], a[84:87], v[68:71]
    ds_read_b128 v[196:199], v13 offset:26624
    s_mov_b32 s26, 5492736
    buffer_load_dwordx2 v[114:115], v239, s[28:31], s26 offen
    s_waitcnt vmcnt(22) lgkmcnt(6)
    v_mfma_f32_16x16x32_bf16 v[32:35], v[204:207], a[88:91], v[32:35]
    v_mfma_f32_16x16x32_bf16 v[52:55], v[204:207], a[92:95], v[52:55]
    ds_read_b128 v[200:203], v13 offset:27648
    buffer_load_dwordx4 v[116:119], v233, s[28:31], s37 offen offset:0
    v_mfma_f32_16x16x32_bf16 v[36:39], v[208:211], a[88:91], v[36:39]
    v_mfma_f32_16x16x32_bf16 v[56:59], v[208:211], a[92:95], v[56:59]
    ds_read_b128 v[204:207], v13 offset:28672
    buffer_load_dwordx4 v[120:123], v233, s[28:31], s37 offen offset:64
    v_mfma_f32_16x16x32_bf16 v[40:43], v[212:215], a[88:91], v[40:43]
    v_mfma_f32_16x16x32_bf16 v[60:63], v[212:215], a[92:95], v[60:63]
    ds_read_b128 v[208:211], v13 offset:29696
    buffer_load_dwordx4 v[124:127], v233, s[28:31], s37 offen offset:128
    v_mfma_f32_16x16x32_bf16 v[44:47], v[216:219], a[88:91], v[44:47]
    v_mfma_f32_16x16x32_bf16 v[64:67], v[216:219], a[92:95], v[64:67]
    ds_read_b128 v[212:215], v13 offset:30720
    buffer_load_dwordx4 v[128:131], v233, s[28:31], s37 offen offset:192
    v_mfma_f32_16x16x32_bf16 v[48:51], v[220:223], a[88:91], v[48:51]
    v_mfma_f32_16x16x32_bf16 v[68:71], v[220:223], a[92:95], v[68:71]
    ds_read_b128 v[216:219], v13 offset:36864
    buffer_load_dwordx4 v[132:135], v233, s[28:31], s38 offen
    s_waitcnt vmcnt(25) lgkmcnt(6)
    v_mfma_f32_16x16x32_bf16 v[32:35], v[176:179], a[0:3], v[32:35]
    v_mfma_f32_16x16x32_bf16 v[52:55], v[176:179], a[4:7], v[52:55]
    ds_read_b128 v[220:223], v13 offset:37888
    buffer_load_dwordx4 a[48:51], v8, s[28:31], s50 offen offset:2048 sc1
    v_mfma_f32_16x16x32_bf16 v[36:39], v[180:183], a[0:3], v[36:39]
    v_mfma_f32_16x16x32_bf16 v[56:59], v[180:183], a[4:7], v[56:59]
    ds_read_b128 v[176:179], v13 offset:38912
    buffer_load_dwordx4 a[52:55], v8, s[28:31], s51 offen offset:2048 sc1
    v_mfma_f32_16x16x32_bf16 v[40:43], v[184:187], a[0:3], v[40:43]
    v_mfma_f32_16x16x32_bf16 v[60:63], v[184:187], a[4:7], v[60:63]
    ds_read_b128 v[180:183], v13 offset:39936
    buffer_load_dwordx4 a[56:59], v8, s[28:31], s50 offen offset:3072 sc1
    v_mfma_f32_16x16x32_bf16 v[44:47], v[188:191], a[0:3], v[44:47]
    v_mfma_f32_16x16x32_bf16 v[64:67], v[188:191], a[4:7], v[64:67]
    ds_read_b128 v[184:187], v13 offset:40960
    v_mfma_f32_16x16x32_bf16 v[48:51], v[192:195], a[0:3], v[48:51]
    v_mfma_f32_16x16x32_bf16 v[68:71], v[192:195], a[4:7], v[68:71]
    ds_read_b128 v[188:191], v13 offset:47104
    buffer_load_dwordx4 a[60:63], v8, s[28:31], s51 offen offset:3072 sc1
    s_waitcnt vmcnt(27) lgkmcnt(6)
    v_mfma_f32_16x16x32_bf16 v[32:35], v[196:199], a[8:11], v[32:35]
    v_mfma_f32_16x16x32_bf16 v[52:55], v[196:199], a[12:15], v[52:55]
    ds_read_b128 v[192:195], v13 offset:48128
    v_mfma_f32_16x16x32_bf16 v[36:39], v[200:203], a[8:11], v[36:39]
    v_mfma_f32_16x16x32_bf16 v[56:59], v[200:203], a[12:15], v[56:59]
    ds_read_b128 v[196:199], v13 offset:49152
    s_add_u32 s50, s50, 4096
    s_add_u32 s51, s51, 4096
    buffer_load_dwordx4 a[64:67], v8, s[28:31], s50 offen offset:0 sc1
    v_mfma_f32_16x16x32_bf16 v[40:43], v[204:207], a[8:11], v[40:43]
    v_mfma_f32_16x16x32_bf16 v[60:63], v[204:207], a[12:15], v[60:63]
    ds_read_b128 v[200:203], v13 offset:50176
    v_mfma_f32_16x16x32_bf16 v[44:47], v[208:211], a[8:11], v[44:47]
    v_mfma_f32_16x16x32_bf16 v[64:67], v[208:211], a[12:15], v[64:67]
    ds_read_b128 v[204:207], v13 offset:51200
    buffer_load_dwordx4 a[68:71], v8, s[28:31], s51 offen offset:0 sc1
    v_mfma_f32_16x16x32_bf16 v[48:51], v[212:215], a[8:11], v[48:51]
    v_mfma_f32_16x16x32_bf16 v[68:71], v[212:215], a[12:15], v[68:71]
    s_barrier
    ds_read_b128 v[208:211], v14 offset:12288
    s_waitcnt vmcnt(27) lgkmcnt(6)
    v_mfma_f32_16x16x32_bf16 v[32:35], v[216:219], a[16:19], v[32:35]
    v_mfma_f32_16x16x32_bf16 v[52:55], v[216:219], a[20:23], v[52:55]
    ds_read_b128 v[212:215], v14 offset:13312
    buffer_load_dwordx4 a[72:75], v8, s[28:31], s50 offen offset:1024 sc1
    v_mfma_f32_16x16x32_bf16 v[36:39], v[220:223], a[16:19], v[36:39]
    v_mfma_f32_16x16x32_bf16 v[56:59], v[220:223], a[20:23], v[56:59]
    ds_read_b128 v[216:219], v14 offset:14336
    v_mfma_f32_16x16x32_bf16 v[40:43], v[176:179], a[16:19], v[40:43]
    v_mfma_f32_16x16x32_bf16 v[60:63], v[176:179], a[20:23], v[60:63]
    ds_read_b128 v[220:223], v14 offset:15360
    buffer_load_dwordx4 a[76:79], v8, s[28:31], s51 offen offset:1024 sc1
    v_mfma_f32_16x16x32_bf16 v[44:47], v[180:183], a[16:19], v[44:47]
    v_mfma_f32_16x16x32_bf16 v[64:67], v[180:183], a[20:23], v[64:67]
    ds_read_b128 v[176:179], v14 offset:16384
    v_mfma_f32_16x16x32_bf16 v[48:51], v[184:187], a[16:19], v[48:51]
    v_mfma_f32_16x16x32_bf16 v[68:71], v[184:187], a[20:23], v[68:71]
    ds_read_b128 v[180:183], v12 offset:0
    buffer_load_dwordx4 a[80:83], v8, s[28:31], s50 offen offset:2048 sc1
    s_waitcnt vmcnt(28) lgkmcnt(6)
    v_mfma_f32_16x16x32_bf16 v[32:35], v[188:191], a[24:27], v[32:35]
    v_mfma_f32_16x16x32_bf16 v[52:55], v[188:191], a[28:31], v[52:55]
    ds_read_b128 v[184:187], v12 offset:1024
    v_mfma_f32_16x16x32_bf16 v[36:39], v[192:195], a[24:27], v[36:39]
    v_mfma_f32_16x16x32_bf16 v[56:59], v[192:195], a[28:31], v[56:59]
    ds_read_b128 v[188:191], v12 offset:2048
    buffer_load_dwordx4 a[84:87], v8, s[28:31], s51 offen offset:2048 sc1
    v_mfma_f32_16x16x32_bf16 v[40:43], v[196:199], a[24:27], v[40:43]
    v_mfma_f32_16x16x32_bf16 v[60:63], v[196:199], a[28:31], v[60:63]
    ds_read_b128 v[192:195], v12 offset:3072
    v_mfma_f32_16x16x32_bf16 v[44:47], v[200:203], a[24:27], v[44:47]
    v_mfma_f32_16x16x32_bf16 v[64:67], v[200:203], a[28:31], v[64:67]
    ds_read_b128 v[196:199], v12 offset:4096
    buffer_load_dwordx4 a[88:91], v8, s[28:31], s50 offen offset:3072 sc1
    v_mfma_f32_16x16x32_bf16 v[48:51], v[204:207], a[24:27], v[48:51]
    v_mfma_f32_16x16x32_bf16 v[68:71], v[204:207], a[28:31], v[68:71]
    ds_read_b128 v[200:203], v12 offset:10240
    s_waitcnt vmcnt(28) lgkmcnt(6)
    v_mfma_f32_16x16x32_bf16 v[32:35], v[208:211], a[32:35], v[32:35]
    v_mfma_f32_16x16x32_bf16 v[52:55], v[208:211], a[36:39], v[52:55]
    ds_read_b128 v[204:207], v12 offset:11264
    buffer_load_dwordx4 a[92:95], v8, s[28:31], s51 offen offset:3072 sc1
    v_mfma_f32_16x16x32_bf16 v[36:39], v[212:215], a[32:35], v[36:39]
    v_mfma_f32_16x16x32_bf16 v[56:59], v[212:215], a[36:39], v[56:59]
    ds_read_b128 v[208:211], v12 offset:12288
    v_mfma_f32_16x16x32_bf16 v[40:43], v[216:219], a[32:35], v[40:43]
    v_mfma_f32_16x16x32_bf16 v[60:63], v[216:219], a[36:39], v[60:63]
    ds_read_b128 v[212:215], v12 offset:13312
    s_add_u32 s50, s50, 4096
    s_add_u32 s51, s51, 4096
    buffer_load_dwordx4 a[0:3], v8, s[28:31], s50 offen offset:0 sc1
    v_mfma_f32_16x16x32_bf16 v[44:47], v[220:223], a[32:35], v[44:47]
    v_mfma_f32_16x16x32_bf16 v[64:67], v[220:223], a[36:39], v[64:67]
    ds_read_b128 v[216:219], v12 offset:14336
    v_mfma_f32_16x16x32_bf16 v[48:51], v[176:179], a[32:35], v[48:51]
    v_mfma_f32_16x16x32_bf16 v[68:71], v[176:179], a[36:39], v[68:71]
    buffer_load_dwordx4 a[4:7], v8, s[28:31], s51 offen offset:0 sc1
    s_waitcnt vmcnt(29) lgkmcnt(5)
    v_mfma_f32_16x16x32_bf16 v[32:35], v[180:183], a[40:43], v[32:35]
    v_mfma_f32_16x16x32_bf16 v[52:55], v[180:183], a[44:47], v[52:55]
    v_mfma_f32_16x16x32_bf16 v[36:39], v[184:187], a[40:43], v[36:39]
    v_mfma_f32_16x16x32_bf16 v[56:59], v[184:187], a[44:47], v[56:59]
    buffer_load_dwordx4 a[8:11], v8, s[28:31], s50 offen offset:1024 sc1
    v_mfma_f32_16x16x32_bf16 v[40:43], v[188:191], a[40:43], v[40:43]
    v_mfma_f32_16x16x32_bf16 v[60:63], v[188:191], a[44:47], v[60:63]
    v_mfma_f32_16x16x32_bf16 v[44:47], v[192:195], a[40:43], v[44:47]
    v_mfma_f32_16x16x32_bf16 v[64:67], v[192:195], a[44:47], v[64:67]
    buffer_load_dwordx4 a[12:15], v8, s[28:31], s51 offen offset:1024 sc1
    v_mfma_f32_16x16x32_bf16 v[48:51], v[196:199], a[40:43], v[48:51]
    v_mfma_f32_16x16x32_bf16 v[68:71], v[196:199], a[44:47], v[68:71]
    s_waitcnt vmcnt(14) lgkmcnt(0)
    v_mfma_f32_16x16x32_bf16 v[32:35], v[200:203], a[48:51], v[32:35]
    v_mfma_f32_16x16x32_bf16 v[52:55], v[200:203], a[52:55], v[52:55]
    buffer_load_dwordx4 a[16:19], v8, s[28:31], s50 offen offset:2048 sc1
    v_mfma_f32_16x16x32_bf16 v[36:39], v[204:207], a[48:51], v[36:39]
    v_mfma_f32_16x16x32_bf16 v[56:59], v[204:207], a[52:55], v[56:59]
    v_mfma_f32_16x16x32_bf16 v[40:43], v[208:211], a[48:51], v[40:43]
    v_mfma_f32_16x16x32_bf16 v[60:63], v[208:211], a[52:55], v[60:63]
    buffer_load_dwordx4 a[20:23], v8, s[28:31], s51 offen offset:2048 sc1
    v_mfma_f32_16x16x32_bf16 v[44:47], v[212:215], a[48:51], v[44:47]
    v_mfma_f32_16x16x32_bf16 v[64:67], v[212:215], a[52:55], v[64:67]
    v_mfma_f32_16x16x32_bf16 v[48:51], v[216:219], a[48:51], v[48:51]
    v_mfma_f32_16x16x32_bf16 v[68:71], v[216:219], a[52:55], v[68:71]
    s_waitcnt vmcnt(14)
    v_mfma_f32_16x16x32_bf16 v[32:35], a[96:99], a[56:59], v[32:35]
    v_mfma_f32_16x16x32_bf16 v[52:55], a[96:99], a[60:63], v[52:55]
    v_mfma_f32_16x16x32_bf16 v[36:39], a[100:103], a[56:59], v[36:39]
    v_mfma_f32_16x16x32_bf16 v[56:59], a[100:103], a[60:63], v[56:59]
    v_mfma_f32_16x16x32_bf16 v[40:43], a[104:107], a[56:59], v[40:43]
    v_mfma_f32_16x16x32_bf16 v[60:63], a[104:107], a[60:63], v[60:63]
    v_mfma_f32_16x16x32_bf16 v[44:47], a[108:111], a[56:59], v[44:47]
    v_mfma_f32_16x16x32_bf16 v[64:67], a[108:111], a[60:63], v[64:67]
    v_mfma_f32_16x16x32_bf16 v[48:51], a[112:115], a[56:59], v[48:51]
    v_mfma_f32_16x16x32_bf16 v[68:71], a[112:115], a[60:63], v[68:71]
    s_waitcnt vmcnt(12)
    v_mfma_f32_16x16x32_bf16 v[32:35], a[116:119], a[64:67], v[32:35]
    v_mfma_f32_16x16x32_bf16 v[52:55], a[116:119], a[68:71], v[52:55]
    v_mfma_f32_16x16x32_bf16 v[36:39], a[120:123], a[64:67], v[36:39]
    v_mfma_f32_16x16x32_bf16 v[56:59], a[120:123], a[68:71], v[56:59]
    v_mfma_f32_16x16x32_bf16 v[40:43], a[124:127], a[64:67], v[40:43]
    v_mfma_f32_16x16x32_bf16 v[60:63], a[124:127], a[68:71], v[60:63]
    v_mfma_f32_16x16x32_bf16 v[44:47], a[128:131], a[64:67], v[44:47]
    v_mfma_f32_16x16x32_bf16 v[64:67], a[128:131], a[68:71], v[64:67]
    v_mfma_f32_16x16x32_bf16 v[48:51], a[132:135], a[64:67], v[48:51]
    v_mfma_f32_16x16x32_bf16 v[68:71], a[132:135], a[68:71], v[68:71]
    s_waitcnt vmcnt(10)
    v_mfma_f32_16x16x32_bf16 v[32:35], a[136:139], a[72:75], v[32:35]
    v_mfma_f32_16x16x32_bf16 v[52:55], a[136:139], a[76:79], v[52:55]
    v_mfma_f32_16x16x32_bf16 v[36:39], a[140:143], a[72:75], v[36:39]
    v_mfma_f32_16x16x32_bf16 v[56:59], a[140:143], a[76:79], v[56:59]
    v_mfma_f32_16x16x32_bf16 v[40:43], a[144:147], a[72:75], v[40:43]
    v_mfma_f32_16x16x32_bf16 v[60:63], a[144:147], a[76:79], v[60:63]
    v_mfma_f32_16x16x32_bf16 v[44:47], a[148:151], a[72:75], v[44:47]
    v_mfma_f32_16x16x32_bf16 v[64:67], a[148:151], a[76:79], v[64:67]
    v_mfma_f32_16x16x32_bf16 v[48:51], a[152:155], a[72:75], v[48:51]
    v_mfma_f32_16x16x32_bf16 v[68:71], a[152:155], a[76:79], v[68:71]
    s_waitcnt vmcnt(8)
    v_mfma_f32_16x16x32_bf16 v[32:35], a[156:159], a[80:83], v[32:35]
    v_mfma_f32_16x16x32_bf16 v[52:55], a[156:159], a[84:87], v[52:55]
    v_mfma_f32_16x16x32_bf16 v[36:39], a[160:163], a[80:83], v[36:39]
    v_mfma_f32_16x16x32_bf16 v[56:59], a[160:163], a[84:87], v[56:59]
    v_mfma_f32_16x16x32_bf16 v[40:43], a[164:167], a[80:83], v[40:43]
    v_mfma_f32_16x16x32_bf16 v[60:63], a[164:167], a[84:87], v[60:63]
    v_mfma_f32_16x16x32_bf16 v[44:47], a[168:171], a[80:83], v[44:47]
    v_mfma_f32_16x16x32_bf16 v[64:67], a[168:171], a[84:87], v[64:67]
    v_mfma_f32_16x16x32_bf16 v[48:51], a[172:175], a[80:83], v[48:51]
    v_mfma_f32_16x16x32_bf16 v[68:71], a[172:175], a[84:87], v[68:71]
    s_waitcnt vmcnt(6)
    v_mfma_f32_16x16x32_bf16 v[32:35], a[176:179], a[88:91], v[32:35]
    v_mfma_f32_16x16x32_bf16 v[52:55], a[176:179], a[92:95], v[52:55]
    v_mfma_f32_16x16x32_bf16 v[36:39], a[180:183], a[88:91], v[36:39]
    v_mfma_f32_16x16x32_bf16 v[56:59], a[180:183], a[92:95], v[56:59]
    v_mfma_f32_16x16x32_bf16 v[40:43], a[184:187], a[88:91], v[40:43]
    v_mfma_f32_16x16x32_bf16 v[60:63], a[184:187], a[92:95], v[60:63]
    v_mfma_f32_16x16x32_bf16 v[44:47], a[188:191], a[88:91], v[44:47]
    v_mfma_f32_16x16x32_bf16 v[64:67], a[188:191], a[92:95], v[64:67]
    v_mfma_f32_16x16x32_bf16 v[48:51], a[192:195], a[88:91], v[48:51]
    v_mfma_f32_16x16x32_bf16 v[68:71], a[192:195], a[92:95], v[68:71]
    s_waitcnt vmcnt(4)
    v_mfma_f32_16x16x32_bf16 v[32:35], a[196:199], a[0:3], v[32:35]
    v_mfma_f32_16x16x32_bf16 v[52:55], a[196:199], a[4:7], v[52:55]
    v_mfma_f32_16x16x32_bf16 v[36:39], a[200:203], a[0:3], v[36:39]
    v_mfma_f32_16x16x32_bf16 v[56:59], a[200:203], a[4:7], v[56:59]
    v_mfma_f32_16x16x32_bf16 v[40:43], a[204:207], a[0:3], v[40:43]
    v_mfma_f32_16x16x32_bf16 v[60:63], a[204:207], a[4:7], v[60:63]
    v_mfma_f32_16x16x32_bf16 v[44:47], a[208:211], a[0:3], v[44:47]
    v_mfma_f32_16x16x32_bf16 v[64:67], a[208:211], a[4:7], v[64:67]
    v_mfma_f32_16x16x32_bf16 v[48:51], a[212:215], a[0:3], v[48:51]
    v_mfma_f32_16x16x32_bf16 v[68:71], a[212:215], a[4:7], v[68:71]
    s_waitcnt vmcnt(2)
    v_mfma_f32_16x16x32_bf16 v[32:35], a[216:219], a[8:11], v[32:35]
    v_mfma_f32_16x16x32_bf16 v[52:55], a[216:219], a[12:15], v[52:55]
    v_mfma_f32_16x16x32_bf16 v[36:39], a[220:223], a[8:11], v[36:39]
    v_mfma_f32_16x16x32_bf16 v[56:59], a[220:223], a[12:15], v[56:59]
    v_mfma_f32_16x16x32_bf16 v[40:43], a[224:227], a[8:11], v[40:43]
    v_mfma_f32_16x16x32_bf16 v[60:63], a[224:227], a[12:15], v[60:63]
    v_mfma_f32_16x16x32_bf16 v[44:47], a[228:231], a[8:11], v[44:47]
    v_mfma_f32_16x16x32_bf16 v[64:67], a[228:231], a[12:15], v[64:67]
    v_mfma_f32_16x16x32_bf16 v[48:51], a[232:235], a[8:11], v[48:51]
    v_mfma_f32_16x16x32_bf16 v[68:71], a[232:235], a[12:15], v[68:71]
    s_waitcnt vmcnt(0)
    v_mfma_f32_16x16x32_bf16 v[32:35], a[236:239], a[16:19], v[32:35]
    v_mfma_f32_16x16x32_bf16 v[52:55], a[236:239], a[20:23], v[52:55]
    v_mfma_f32_16x16x32_bf16 v[36:39], a[240:243], a[16:19], v[36:39]
    v_mfma_f32_16x16x32_bf16 v[56:59], a[240:243], a[20:23], v[56:59]
    v_mfma_f32_16x16x32_bf16 v[40:43], a[244:247], a[16:19], v[40:43]
    v_mfma_f32_16x16x32_bf16 v[60:63], a[244:247], a[20:23], v[60:63]
    v_mfma_f32_16x16x32_bf16 v[44:47], a[248:251], a[16:19], v[44:47]
    v_mfma_f32_16x16x32_bf16 v[64:67], a[248:251], a[20:23], v[64:67]
    v_mfma_f32_16x16x32_bf16 v[48:51], a[252:255], a[16:19], v[48:51]
    v_mfma_f32_16x16x32_bf16 v[68:71], a[252:255], a[20:23], v[68:71]
    s_barrier
    s_nop 4
    ds_write_b128 v246, v[52:55] offset:0
    ds_write_b128 v246, v[56:59] offset:1024
    ds_write_b128 v246, v[60:63] offset:2048
    ds_write_b128 v246, v[64:67] offset:3072
    ds_write_b128 v246, v[68:71] offset:4096
    v_lshlrev_b32 v136, 16, v96
    v_and_b32 v137, 0xffff0000, v96
    v_lshlrev_b32 v138, 16, v97
    v_and_b32 v139, 0xffff0000, v97
    v_lshlrev_b32 v156, 16, v106
    v_and_b32 v157, 0xffff0000, v106
    v_lshlrev_b32 v158, 16, v107
    v_and_b32 v159, 0xffff0000, v107
    v_lshlrev_b32 v140, 16, v98
    v_and_b32 v141, 0xffff0000, v98
    v_lshlrev_b32 v142, 16, v99
    v_and_b32 v143, 0xffff0000, v99
    v_lshlrev_b32 v160, 16, v108
    v_and_b32 v161, 0xffff0000, v108
    v_lshlrev_b32 v162, 16, v109
    v_and_b32 v163, 0xffff0000, v109
    v_lshlrev_b32 v144, 16, v100
    v_and_b32 v145, 0xffff0000, v100
    v_lshlrev_b32 v146, 16, v101
    v_and_b32 v147, 0xffff0000, v101
    v_lshlrev_b32 v164, 16, v110
    v_and_b32 v165, 0xffff0000, v110
    v_lshlrev_b32 v166, 16, v111
    v_and_b32 v167, 0xffff0000, v111
    v_lshlrev_b32 v148, 16, v102
    v_and_b32 v149, 0xffff0000, v102
    v_lshlrev_b32 v150, 16, v103
    v_and_b32 v151, 0xffff0000, v103
    v_lshlrev_b32 v168, 16, v112
    v_and_b32 v169, 0xffff0000, v112
    v_lshlrev_b32 v170, 16, v113
    v_and_b32 v171, 0xffff0000, v113
    v_lshlrev_b32 v152, 16, v104
    v_and_b32 v153, 0xffff0000, v104
    v_lshlrev_b32 v154, 16, v105
    v_and_b32 v155, 0xffff0000, v105
    v_lshlrev_b32 v172, 16, v114
    v_and_b32 v173, 0xffff0000, v114
    v_lshlrev_b32 v174, 16, v115
    v_and_b32 v175, 0xffff0000, v115
    v_pk_add_f32 v[32:33], v[32:33], v[136:137]
    v_pk_add_f32 v[34:35], v[34:35], v[138:139]
    v_pk_add_f32 v[36:37], v[36:37], v[140:141]
    v_pk_add_f32 v[38:39], v[38:39], v[142:143]
    v_pk_add_f32 v[40:41], v[40:41], v[144:145]
    v_pk_add_f32 v[42:43], v[42:43], v[146:147]
    v_pk_add_f32 v[44:45], v[44:45], v[148:149]
    v_pk_add_f32 v[46:47], v[46:47], v[150:151]
    v_pk_add_f32 v[48:49], v[48:49], v[152:153]
    v_pk_add_f32 v[50:51], v[50:51], v[154:155]
    s_waitcnt lgkmcnt(0)
    s_barrier
    ds_read_b128 v[72:75], v247 offset:0
    ds_read_b128 v[76:79], v247 offset:1024
    ds_read_b128 v[80:83], v247 offset:2048
    ds_read_b128 v[84:87], v247 offset:3072
    ds_read_b128 v[88:91], v247 offset:4096
    s_waitcnt lgkmcnt(4)
    v_pk_add_f32 v[32:33], v[32:33], v[72:73]
    v_pk_add_f32 v[34:35], v[34:35], v[74:75]
    v_pk_fma_f32 v[32:33], v[32:33], v[116:117], v[156:157]
    v_pk_fma_f32 v[34:35], v[34:35], v[118:119], v[158:159]
    v_cvt_pk_bf16_f32 v180, v32, v33
    v_cvt_pk_bf16_f32 v181, v34, v35
    s_waitcnt lgkmcnt(3)
    v_pk_add_f32 v[36:37], v[36:37], v[76:77]
    v_pk_add_f32 v[38:39], v[38:39], v[78:79]
    v_pk_fma_f32 v[36:37], v[36:37], v[120:121], v[160:161]
    v_pk_fma_f32 v[38:39], v[38:39], v[122:123], v[162:163]
    v_cvt_pk_bf16_f32 v182, v36, v37
    v_cvt_pk_bf16_f32 v183, v38, v39
    s_waitcnt lgkmcnt(2)
    v_pk_add_f32 v[40:41], v[40:41], v[80:81]
    v_pk_add_f32 v[42:43], v[42:43], v[82:83]
    v_pk_fma_f32 v[40:41], v[40:41], v[124:125], v[164:165]
    v_pk_fma_f32 v[42:43], v[42:43], v[126:127], v[166:167]
    v_cvt_pk_bf16_f32 v184, v40, v41
    v_cvt_pk_bf16_f32 v185, v42, v43
    s_waitcnt lgkmcnt(1)
    v_pk_add_f32 v[44:45], v[44:45], v[84:85]
    v_pk_add_f32 v[46:47], v[46:47], v[86:87]
    v_pk_fma_f32 v[44:45], v[44:45], v[128:129], v[168:169]
    v_pk_fma_f32 v[46:47], v[46:47], v[130:131], v[170:171]
    v_cvt_pk_bf16_f32 v186, v44, v45
    v_cvt_pk_bf16_f32 v187, v46, v47
    s_waitcnt lgkmcnt(0)
    v_pk_add_f32 v[48:49], v[48:49], v[88:89]
    v_pk_add_f32 v[50:51], v[50:51], v[90:91]
    v_pk_fma_f32 v[48:49], v[48:49], v[132:133], v[172:173]
    v_pk_fma_f32 v[50:51], v[50:51], v[134:135], v[174:175]
    v_cvt_pk_bf16_f32 v188, v48, v49
    v_cvt_pk_bf16_f32 v189, v50, v51
    s_nop 1
    v_permlane16_swap_b32 v180, v182
    v_permlane16_swap_b32 v181, v183
    v_permlane16_swap_b32 v184, v186
    v_permlane16_swap_b32 v185, v187
    buffer_store_dwordx4 v[180:183], v231, s[32:35], s46 offen sc1
    buffer_store_dwordx4 v[184:187], v231, s[32:35], s46 offen offset:64 sc1
    buffer_store_dwordx2 v[188:189], v232, s[32:35], s49 offen sc1
    s_endpgm
chain_end:
    s_endpgm
.section .rodata,"a"
.p2align 6
.amdhsa_kernel k0_kernel
  .amdhsa_next_free_vgpr 128
  .amdhsa_next_free_sgpr 72
  .amdhsa_accum_offset 128
  .amdhsa_group_segment_fixed_size 0
  .amdhsa_kernarg_size 128
  .amdhsa_user_sgpr_count 2
  .amdhsa_user_sgpr_kernarg_segment_ptr 1
  .amdhsa_system_sgpr_workgroup_id_x 1
  .amdhsa_float_denorm_mode_32 3
.end_amdhsa_kernel
.p2align 6
.amdhsa_kernel k1_kernel
  .amdhsa_next_free_vgpr 288
  .amdhsa_next_free_sgpr 100
  .amdhsa_accum_offset 256
  .amdhsa_group_segment_fixed_size 0
  .amdhsa_kernarg_size 128
  .amdhsa_user_sgpr_count 2
  .amdhsa_user_sgpr_kernarg_segment_ptr 1
  .amdhsa_system_sgpr_workgroup_id_x 1
  .amdhsa_float_denorm_mode_32 3
.end_amdhsa_kernel
.p2align 6
.amdhsa_kernel chain_kernel
  .amdhsa_next_free_vgpr 512
  .amdhsa_next_free_sgpr 100
  .amdhsa_accum_offset 256
  .amdhsa_group_segment_fixed_size 0
  .amdhsa_kernarg_size 128
  .amdhsa_user_sgpr_count 2
  .amdhsa_user_sgpr_kernarg_segment_ptr 1
  .amdhsa_system_sgpr_workgroup_id_x 1
  .amdhsa_float_denorm_mode_32 3
.end_amdhsa_kernel
```

```asm
; @launch kernel=prep_kernel grid=(512,1,1) block=(512,1,1) lds=88064
; @launch kernel=chain_kernel grid=(256,1,1) block=(256,1,1) lds=163840
.amdgcn_target "amdgcn-amd-amdhsa--gfx950"
.text
.globl prep_kernel
.p2align 8
.type prep_kernel,@function
prep_kernel:
    s_cmp_ge_u32 s2, 512
    s_cbranch_scc1 prep_end
    s_load_dwordx4 s[4:7], s[0:1], 8
    s_load_dwordx2 s[8:9], s[0:1], 24
    s_load_dwordx2 s[10:11], s[0:1], 120
    s_load_dwordx8 s[12:19], s[0:1], 56
    s_load_dwordx2 s[60:61], s[0:1], 0
    s_load_dwordx2 s[62:63], s[0:1], 96
    s_load_dwordx2 s[52:53], s[0:1], 88
    s_load_dwordx2 s[54:55], s[0:1], 112
    s_load_dwordx4 s[56:59], s[0:1], 32
    s_memrealtime s[64:65]
    v_lshrrev_b32 v2, 6, v0
    v_and_b32 v1, 63, v0
    v_readfirstlane_b32 s20, v2
    s_waitcnt lgkmcnt(0)
    s_mov_b32 s28, s10
    s_mov_b32 s29, s11
    s_mov_b32 s30, 268435456
    s_mov_b32 s31, 0x00020000
    s_mov_b32 s48, s54
    s_mov_b32 s49, s55
    s_mov_b32 s50, 256
    s_mov_b32 s51, 0x00020000
    s_cmp_ge_u32 s2, 416
    s_cbranch_scc1 p_pack
    s_cmp_ge_u32 s2, 256
    s_cbranch_scc1 p_conv
    s_cmp_ge_u32 s2, 160
    s_cbranch_scc1 p_aux
    s_or_b32 s21, s2, s20
    s_cmp_lg_u32 s21, 0
    s_cbranch_scc1 prep_kernel_n01
    s_or_b32 s64, s64, 1
    v_mov_b32 v3, s64
    v_mov_b32 v4, 0
    s_mov_b64 exec, 1
    buffer_store_dword v3, v4, s[48:51], 0 offen sc1
    s_mov_b64 exec, -1
prep_kernel_n01:
    s_mov_b32 s45, s20
    s_mov_b32 s16, s4
    s_mov_b32 s17, s5
    s_mov_b32 s18, 2621440
    s_mov_b32 s19, 0x00020000
    s_mov_b32 s20, s6
    s_mov_b32 s21, s7
    s_mov_b32 s22, 2621440
    s_mov_b32 s23, 0x00020000
    s_mov_b32 s24, s8
    s_mov_b32 s25, s9
    s_mov_b32 s26, 5120
    s_mov_b32 s27, 0x00020000
    s_lshr_b32 s47, s45, 2
    s_lshl_b32 s46, s2, 1
    s_add_u32 s46, s46, s47
    v_and_b32 v0, 255, v0
    s_mul_i32 s32, s46, 52429
    s_lshr_b32 s32, s32, 19
    s_mul_i32 s33, s32, 10
    s_sub_u32 s33, s46, s33
    s_lshl_b32 s43, s47, 13
    v_and_b32 v1, 15, v0
    v_lshrrev_b32 v2, 4, v0
    s_lshl_b32 s34, s32, 6
    v_lshl_add_u32 v3, v2, 2, s34
    v_mul_u32_u24 v4, 1280, v3
    s_lshl_b32 s35, s33, 7
    v_lshl_add_u32 v5, v1, 3, s35
    v_add_u32 v4, v4, v5
    v_subrev_u32 v6, 3840, v4
    v_subrev_u32 v7, 2560, v4
    v_subrev_u32 v8, 1280, v4
    buffer_load_dwordx2 v[10:11], v6, s[16:19], 0 offen nt
    buffer_load_dwordx2 v[12:13], v7, s[16:19], 0 offen nt
    buffer_load_dwordx2 v[14:15], v8, s[16:19], 0 offen nt
    buffer_load_dwordx2 v[16:17], v4, s[16:19], 0 offen offset:0 nt
    buffer_load_dwordx2 v[18:19], v4, s[16:19], 0 offen offset:1280 nt
    buffer_load_dwordx2 v[20:21], v4, s[16:19], 0 offen offset:2560 nt
    buffer_load_dwordx2 v[22:23], v4, s[16:19], 0 offen offset:3840 nt
    v_lshlrev_b32 v100, 2, v5
    buffer_load_dwordx4 v[32:35], v100, s[24:27], 0 offen
    buffer_load_dwordx4 v[36:39], v100, s[24:27], 0 offen offset:16
    buffer_load_dwordx2 v[24:25], v4, s[20:23], 0 offen offset:0 nt
    buffer_load_dwordx2 v[26:27], v4, s[20:23], 0 offen offset:1280 nt
    buffer_load_dwordx2 v[28:29], v4, s[20:23], 0 offen offset:2560 nt
    buffer_load_dwordx2 v[30:31], v4, s[20:23], 0 offen offset:3840 nt
    v_lshlrev_b32 v100, 9, v1
    v_sub_u32 v101, 15, v2
    v_lshl_add_u32 v100, v101, 3, v100
    v_add_u32 v100, s43, v100
    v_lshrrev_b32 v101, 3, v0
    v_mul_u32_u24 v101, 4352, v101
    v_and_b32 v102, 7, v0
    v_lshl_add_u32 v103, v102, 4, v101
    v_lshlrev_b32 v104, 4, v0
    v_add_u32 v104, s43, v104
    s_mul_i32 s36, s33, 278528
    s_lshr_b32 s37, s32, 1
    s_mul_i32 s37, s37, 272
    s_add_u32 s36, s36, s37
    s_add_u32 s36, s36, 0
    s_and_b32 s37, s32, 1
    s_lshl_b32 s38, s37, 7
    s_sub_u32 s38, 128, s38
    s_add_u32 s38, s38, s36
    s_lshl_b32 s44, s33, 5
    s_add_u32 s44, s44, s32
    s_lshl_b32 s44, s44, 7
    s_add_u32 s44, s44, 29642752
    s_waitcnt vmcnt(4)
    v_mov_b32 v123, 0
    buffer_load_dword v122, v123, s[48:51], 0 offen sc1
    v_lshlrev_b32 v40, 16, v32
    v_and_b32 v44, 0xffff0000, v32
    v_lshlrev_b32 v48, 16, v33
    v_and_b32 v52, 0xffff0000, v33
    v_lshlrev_b32 v41, 16, v34
    v_and_b32 v45, 0xffff0000, v34
    v_lshlrev_b32 v49, 16, v35
    v_and_b32 v53, 0xffff0000, v35
    v_lshlrev_b32 v42, 16, v36
    v_and_b32 v46, 0xffff0000, v36
    v_lshlrev_b32 v50, 16, v37
    v_and_b32 v54, 0xffff0000, v37
    v_lshlrev_b32 v43, 16, v38
    v_and_b32 v47, 0xffff0000, v38
    v_lshlrev_b32 v51, 16, v39
    v_and_b32 v55, 0xffff0000, v39
    v_lshlrev_b32 v56, 16, v10
    v_and_b32 v57, 0xffff0000, v10
    v_lshlrev_b32 v58, 16, v11
    v_and_b32 v59, 0xffff0000, v11
    v_lshlrev_b32 v60, 16, v12
    v_and_b32 v61, 0xffff0000, v12
    v_lshlrev_b32 v62, 16, v13
    v_and_b32 v63, 0xffff0000, v13
    v_lshlrev_b32 v64, 16, v14
    v_and_b32 v65, 0xffff0000, v14
    v_lshlrev_b32 v66, 16, v15
    v_and_b32 v67, 0xffff0000, v15
    v_lshlrev_b32 v68, 16, v16
    v_and_b32 v69, 0xffff0000, v16
    v_lshlrev_b32 v70, 16, v17
    v_and_b32 v71, 0xffff0000, v17
    v_lshlrev_b32 v72, 16, v18
    v_and_b32 v73, 0xffff0000, v18
    v_lshlrev_b32 v74, 16, v19
    v_and_b32 v75, 0xffff0000, v19
    v_lshlrev_b32 v76, 16, v20
    v_and_b32 v77, 0xffff0000, v20
    v_lshlrev_b32 v78, 16, v21
    v_and_b32 v79, 0xffff0000, v21
    v_lshlrev_b32 v80, 16, v22
    v_and_b32 v81, 0xffff0000, v22
    v_lshlrev_b32 v82, 16, v23
    v_and_b32 v83, 0xffff0000, v23
    v_pk_mul_f32 v[84:85], v[56:57], v[52:53]
    v_pk_mul_f32 v[86:87], v[58:59], v[54:55]
    v_pk_mul_f32 v[88:89], v[60:61], v[52:53]
    v_pk_mul_f32 v[90:91], v[62:63], v[54:55]
    v_pk_mul_f32 v[92:93], v[64:65], v[52:53]
    v_pk_mul_f32 v[94:95], v[66:67], v[54:55]
    v_pk_mul_f32 v[96:97], v[68:69], v[52:53]
    v_pk_mul_f32 v[98:99], v[70:71], v[54:55]
    v_pk_fma_f32 v[84:85], v[60:61], v[48:49], v[84:85]
    v_pk_fma_f32 v[86:87], v[62:63], v[50:51], v[86:87]
    v_pk_fma_f32 v[88:89], v[64:65], v[48:49], v[88:89]
    v_pk_fma_f32 v[90:91], v[66:67], v[50:51], v[90:91]
    v_pk_fma_f32 v[92:93], v[68:69], v[48:49], v[92:93]
    v_pk_fma_f32 v[94:95], v[70:71], v[50:51], v[94:95]
    v_pk_fma_f32 v[96:97], v[72:73], v[48:49], v[96:97]
    v_pk_fma_f32 v[98:99], v[74:75], v[50:51], v[98:99]
    v_pk_fma_f32 v[84:85], v[64:65], v[44:45], v[84:85]
    v_pk_fma_f32 v[86:87], v[66:67], v[46:47], v[86:87]
    v_pk_fma_f32 v[88:89], v[68:69], v[44:45], v[88:89]
    v_pk_fma_f32 v[90:91], v[70:71], v[46:47], v[90:91]
    v_pk_fma_f32 v[92:93], v[72:73], v[44:45], v[92:93]
    v_pk_fma_f32 v[94:95], v[74:75], v[46:47], v[94:95]
    v_pk_fma_f32 v[96:97], v[76:77], v[44:45], v[96:97]
    v_pk_fma_f32 v[98:99], v[78:79], v[46:47], v[98:99]
    v_pk_fma_f32 v[84:85], v[68:69], v[40:41], v[84:85]
    v_pk_fma_f32 v[86:87], v[70:71], v[42:43], v[86:87]
    v_pk_fma_f32 v[88:89], v[72:73], v[40:41], v[88:89]
    v_pk_fma_f32 v[90:91], v[74:75], v[42:43], v[90:91]
    v_pk_fma_f32 v[92:93], v[76:77], v[40:41], v[92:93]
    v_pk_fma_f32 v[94:95], v[78:79], v[42:43], v[94:95]
    v_pk_fma_f32 v[96:97], v[80:81], v[40:41], v[96:97]
    v_pk_fma_f32 v[98:99], v[82:83], v[42:43], v[98:99]
    v_cvt_pk_bf16_f32 v56, v84, v85
    v_cvt_pk_bf16_f32 v57, v86, v87
    v_cvt_pk_bf16_f32 v58, v88, v89
    v_cvt_pk_bf16_f32 v59, v90, v91
    v_cvt_pk_bf16_f32 v60, v92, v93
    v_cvt_pk_bf16_f32 v61, v94, v95
    v_cvt_pk_bf16_f32 v62, v96, v97
    v_cvt_pk_bf16_f32 v63, v98, v99
    s_waitcnt vmcnt(1)
    v_lshlrev_b32 v84, 16, v56
    v_and_b32 v85, 0xffff0000, v56
    v_lshlrev_b32 v86, 16, v57
    v_and_b32 v87, 0xffff0000, v57
    v_lshlrev_b32 v88, 16, v58
    v_and_b32 v89, 0xffff0000, v58
    v_lshlrev_b32 v90, 16, v59
    v_and_b32 v91, 0xffff0000, v59
    v_lshlrev_b32 v92, 16, v60
    v_and_b32 v93, 0xffff0000, v60
    v_lshlrev_b32 v94, 16, v61
    v_and_b32 v95, 0xffff0000, v61
    v_lshlrev_b32 v96, 16, v62
    v_and_b32 v97, 0xffff0000, v62
    v_lshlrev_b32 v98, 16, v63
    v_and_b32 v99, 0xffff0000, v63
    v_lshlrev_b32 v64, 16, v24
    v_and_b32 v65, 0xffff0000, v24
    v_pk_mul_f32 v[84:85], v[84:85], v[64:65]
    v_lshlrev_b32 v66, 16, v25
    v_and_b32 v67, 0xffff0000, v25
    v_pk_mul_f32 v[86:87], v[86:87], v[66:67]
    v_lshlrev_b32 v68, 16, v26
    v_and_b32 v69, 0xffff0000, v26
    v_pk_mul_f32 v[88:89], v[88:89], v[68:69]
    v_lshlrev_b32 v70, 16, v27
    v_and_b32 v71, 0xffff0000, v27
    v_pk_mul_f32 v[90:91], v[90:91], v[70:71]
    v_lshlrev_b32 v64, 16, v28
    v_and_b32 v65, 0xffff0000, v28
    v_pk_mul_f32 v[92:93], v[92:93], v[64:65]
    v_lshlrev_b32 v66, 16, v29
    v_and_b32 v67, 0xffff0000, v29
    v_pk_mul_f32 v[94:95], v[94:95], v[66:67]
    v_lshlrev_b32 v68, 16, v30
    v_and_b32 v69, 0xffff0000, v30
    v_pk_mul_f32 v[96:97], v[96:97], v[68:69]
    v_lshlrev_b32 v70, 16, v31
    v_and_b32 v71, 0xffff0000, v31
    v_pk_mul_f32 v[98:99], v[98:99], v[70:71]
    v_cvt_pk_bf16_f32 v64, v96, v92
    v_cvt_pk_bf16_f32 v65, v88, v84
    v_cvt_pk_bf16_f32 v66, v97, v93
    v_cvt_pk_bf16_f32 v67, v89, v85
    v_cvt_pk_bf16_f32 v68, v98, v94
    v_cvt_pk_bf16_f32 v69, v90, v86
    v_cvt_pk_bf16_f32 v70, v99, v95
    v_cvt_pk_bf16_f32 v71, v91, v87
    ds_write_b64 v100, v[64:65] offset:0
    ds_write_b64 v100, v[66:67] offset:128
    ds_write_b64 v100, v[68:69] offset:256
    ds_write_b64 v100, v[70:71] offset:384
    s_waitcnt lgkmcnt(0)
    s_barrier
    ds_read_b128 v[10:13], v104 offset:0
    ds_read_b128 v[14:17], v104 offset:4096
    s_waitcnt lgkmcnt(1)
    buffer_store_dwordx4 v[10:13], v103, s[28:31], s38 offen sc1
    s_add_u32 s38, s38, 139264
    s_waitcnt lgkmcnt(0)
    buffer_store_dwordx4 v[14:17], v103, s[28:31], s38 offen sc1
    s_add_u32 s38, s38, 139264
    v_cmp_eq_u32 vcc, 0, v102
    s_and_saveexec_b64 s[66:67], vcc
    s_cmp_eq_u32 s37, 0
    s_cbranch_scc1 prep_kernel_L2
    s_cmp_eq_u32 s32, 31
    s_cbranch_scc1 prep_kernel_L3
    buffer_store_dwordx4 v[10:13], v101, s[28:31], s36 offen offset:528 sc1
    s_add_u32 s36, s36, 139264
    buffer_store_dwordx4 v[14:17], v101, s[28:31], s36 offen offset:528 sc1
    s_add_u32 s36, s36, 139264
    s_branch prep_kernel_L3
prep_kernel_L2:
    s_cmp_lg_u32 s32, 0
    s_cbranch_scc1 prep_kernel_L3
    v_mov_b32 v108, 0
    v_mov_b32 v109, 0
    v_mov_b32 v110, 0
    v_mov_b32 v111, 0
    buffer_store_dwordx4 v[108:111], v101, s[28:31], s36 offen offset:256 sc1
    s_add_u32 s36, s36, 139264
    buffer_store_dwordx4 v[108:111], v101, s[28:31], s36 offen offset:256 sc1
    s_add_u32 s36, s36, 139264
prep_kernel_L3:
    s_mov_b64 exec, -1
    s_waitcnt vmcnt(0)
    s_barrier
    s_and_b32 s45, s45, 3
    s_cmp_lg_u32 s45, 0
    s_cbranch_scc1 prep_end
    s_mov_b32 s47, 0
prep_kernel_nn4:
    v_readfirstlane_b32 s46, v122
    s_add_u32 s47, s47, 1
    s_cmp_lg_u32 s46, 0
    s_cbranch_scc1 prep_kernel_nd5
    s_cmp_ge_u32 s47, 20000
    s_cbranch_scc1 prep_kernel_nd5
    buffer_load_dword v122, v123, s[48:51], 0 offen sc1
    s_waitcnt vmcnt(0)
    s_branch prep_kernel_nn4
prep_kernel_nd5:
    v_mov_b32 v124, s46
    v_mov_b32 v125, 0
    s_mov_b64 exec, 1
    buffer_store_dword v124, v125, s[28:31], s44 offen sc1
    s_endpgm
prep_end:
    s_endpgm
p_aux:
    v_mov_b32 v251, 0
    buffer_load_dword v250, v251, s[48:51], 0 offen sc1
    s_sub_u32 s21, s2, 160
    s_cmp_ge_u32 s20, 6
    s_cbranch_scc1 prep_end
    s_cmp_ge_u32 s20, 3
    s_cbranch_scc1 p_misc
    s_cmp_eq_u32 s20, 0
    s_cbranch_scc1 p_st
    s_cmp_eq_u32 s20, 2
    s_cbranch_scc1 p_aux2
    s_add_u32 s21, s21, 96
    s_cmp_lt_u32 s21, 128
    s_cbranch_scc1 p_st
    s_sub_u32 s21, s21, 128
    s_branch p_mod
p_aux2:
    s_cmp_ge_u32 s21, 56
    s_cbranch_scc1 prep_end
    s_add_u32 s21, s21, 64
p_mod:
    s_lshr_b32 s32, s21, 2
    s_and_b32 s33, s21, 3
    v_lshrrev_b32 v4, 3, v1
    v_and_b32 v3, 7, v1
    s_mul_i32 s34, s33, 160
    v_add_u32 v4, s34, v4
    v_lshlrev_b32 v5, 1, v4
    v_mul_u32_u24 v6, 7680, v4
    s_lshl_b32 s36, s32, 7
    v_lshl_add_u32 v7, v3, 4, s36
    v_add_u32 v6, v6, v7
    s_mov_b32 s16, s52
    s_mov_b32 s17, s53
    s_mov_b32 s18, 1280
    s_mov_b32 s19, 0x00020000
    s_mov_b32 s24, s62
    s_mov_b32 s25, s63
    s_mov_b32 s26, 4915200
    s_mov_b32 s27, 0x00020000
    s_mul_i32 s35, s33, 320
    v_lshlrev_b32 v5, 3, v1
    buffer_load_dwordx2 v[30:31], v5, s[16:19], s35 offen
    s_mov_b32 s37, 0
    buffer_load_dwordx4 v[32:35], v6, s[24:27], s37 offen nt
    s_add_u32 s37, s37, 61440
    buffer_load_dwordx4 v[36:39], v6, s[24:27], s37 offen nt
    s_add_u32 s37, s37, 61440
    buffer_load_dwordx4 v[40:43], v6, s[24:27], s37 offen nt
    s_add_u32 s37, s37, 61440
    buffer_load_dwordx4 v[44:47], v6, s[24:27], s37 offen nt
    s_add_u32 s37, s37, 61440
    buffer_load_dwordx4 v[48:51], v6, s[24:27], s37 offen nt
    s_add_u32 s37, s37, 61440
    buffer_load_dwordx4 v[52:55], v6, s[24:27], s37 offen nt
    s_add_u32 s37, s37, 61440
    buffer_load_dwordx4 v[56:59], v6, s[24:27], s37 offen nt
    s_add_u32 s37, s37, 61440
    buffer_load_dwordx4 v[60:63], v6, s[24:27], s37 offen nt
    s_add_u32 s37, s37, 61440
    buffer_load_dwordx4 v[64:67], v6, s[24:27], s37 offen nt
    s_add_u32 s37, s37, 61440
    buffer_load_dwordx4 v[68:71], v6, s[24:27], s37 offen nt
    s_add_u32 s37, s37, 61440
    buffer_load_dwordx4 v[72:75], v6, s[24:27], s37 offen nt
    s_add_u32 s37, s37, 61440
    buffer_load_dwordx4 v[76:79], v6, s[24:27], s37 offen nt
    s_add_u32 s37, s37, 61440
    buffer_load_dwordx4 v[80:83], v6, s[24:27], s37 offen nt
    s_add_u32 s37, s37, 61440
    buffer_load_dwordx4 v[84:87], v6, s[24:27], s37 offen nt
    s_add_u32 s37, s37, 61440
    buffer_load_dwordx4 v[88:91], v6, s[24:27], s37 offen nt
    s_add_u32 s37, s37, 61440
    buffer_load_dwordx4 v[92:95], v6, s[24:27], s37 offen nt
    s_add_u32 s37, s37, 61440
    buffer_load_dwordx4 v[96:99], v6, s[24:27], s37 offen nt
    s_add_u32 s37, s37, 61440
    buffer_load_dwordx4 v[100:103], v6, s[24:27], s37 offen nt
    s_add_u32 s37, s37, 61440
    buffer_load_dwordx4 v[104:107], v6, s[24:27], s37 offen nt
    s_add_u32 s37, s37, 61440
    buffer_load_dwordx4 v[108:111], v6, s[24:27], s37 offen nt
    s_mul_i32 s35, s20, 13824
    v_lshlrev_b32 v5, 4, v1
    v_add_u32 v5, s35, v5
    v_lshrrev_b32 v29, 3, v1
    v_lshlrev_b32 v29, 2, v29
    v_add_u32 v29, s35, v29
    s_waitcnt vmcnt(20)
    v_lshlrev_b32 v8, 16, v30
    v_and_b32 v9, 0xffff0000, v30
    v_lshlrev_b32 v10, 16, v31
    v_and_b32 v11, 0xffff0000, v31
    v_mul_f32 v120, 0xbfb8aa3b, v8
    v_mul_f32 v121, 0xbfb8aa3b, v9
    v_mul_f32 v122, 0xbfb8aa3b, v10
    v_mul_f32 v123, 0xbfb8aa3b, v11
    v_exp_f32 v120, v120
    v_exp_f32 v121, v121
    v_exp_f32 v122, v122
    v_exp_f32 v123, v123
    v_add_f32 v120, 1.0, v120
    v_add_f32 v121, 1.0, v121
    v_add_f32 v122, 1.0, v122
    v_add_f32 v123, 1.0, v123
    v_rcp_f32 v120, v120
    v_rcp_f32 v121, v121
    v_rcp_f32 v122, v122
    v_rcp_f32 v123, v123
    s_nop 0
    v_mul_f32 v8, v8, v120
    v_mul_f32 v9, v9, v121
    v_mul_f32 v10, v10, v122
    v_mul_f32 v11, v11, v123
    v_cvt_pk_bf16_f32 v120, v8, v9
    v_lshlrev_b32 v8, 16, v120
    v_and_b32 v9, 0xffff0000, v120
    v_cvt_pk_bf16_f32 v120, v10, v11
    v_lshlrev_b32 v10, 16, v120
    v_and_b32 v11, 0xffff0000, v120
    ds_write_b128 v5, v[8:11]
    s_waitcnt lgkmcnt(0)
    ds_read_b32 v8, v29 offset:0
    ds_read_b32 v9, v29 offset:32
    ds_read_b32 v10, v29 offset:64
    ds_read_b32 v11, v29 offset:96
    ds_read_b32 v12, v29 offset:128
    ds_read_b32 v13, v29 offset:160
    ds_read_b32 v14, v29 offset:192
    ds_read_b32 v15, v29 offset:224
    ds_read_b32 v16, v29 offset:256
    ds_read_b32 v17, v29 offset:288
    ds_read_b32 v18, v29 offset:320
    ds_read_b32 v19, v29 offset:352
    ds_read_b32 v20, v29 offset:384
    ds_read_b32 v21, v29 offset:416
    ds_read_b32 v22, v29 offset:448
    ds_read_b32 v23, v29 offset:480
    ds_read_b32 v24, v29 offset:512
    ds_read_b32 v25, v29 offset:544
    ds_read_b32 v26, v29 offset:576
    ds_read_b32 v27, v29 offset:608
    s_waitcnt lgkmcnt(0)
    v_mov_b32 v112, 0
    v_mov_b32 v113, 0
    v_mov_b32 v114, 0
    v_mov_b32 v115, 0
    v_mov_b32 v116, 0
    v_mov_b32 v117, 0
    v_mov_b32 v118, 0
    v_mov_b32 v119, 0
    s_waitcnt vmcnt(19)
    v_lshlrev_b32 v120, 16, v32
    v_and_b32 v121, 0xffff0000, v32
    v_lshlrev_b32 v122, 16, v33
    v_and_b32 v123, 0xffff0000, v33
    v_lshlrev_b32 v124, 16, v34
    v_and_b32 v125, 0xffff0000, v34
    v_lshlrev_b32 v126, 16, v35
    v_and_b32 v127, 0xffff0000, v35
    v_pk_fma_f32 v[112:113], v[120:121], v[8:9], v[112:113] op_sel:[0,0,0] op_sel_hi:[1,0,1]
    v_pk_fma_f32 v[114:115], v[122:123], v[8:9], v[114:115] op_sel:[0,0,0] op_sel_hi:[1,0,1]
    v_pk_fma_f32 v[116:117], v[124:125], v[8:9], v[116:117] op_sel:[0,0,0] op_sel_hi:[1,0,1]
    v_pk_fma_f32 v[118:119], v[126:127], v[8:9], v[118:119] op_sel:[0,0,0] op_sel_hi:[1,0,1]
    s_waitcnt vmcnt(18)
    v_lshlrev_b32 v120, 16, v36
    v_and_b32 v121, 0xffff0000, v36
    v_lshlrev_b32 v122, 16, v37
    v_and_b32 v123, 0xffff0000, v37
    v_lshlrev_b32 v124, 16, v38
    v_and_b32 v125, 0xffff0000, v38
    v_lshlrev_b32 v126, 16, v39
    v_and_b32 v127, 0xffff0000, v39
    v_pk_fma_f32 v[112:113], v[120:121], v[8:9], v[112:113] op_sel:[0,1,0] op_sel_hi:[1,1,1]
    v_pk_fma_f32 v[114:115], v[122:123], v[8:9], v[114:115] op_sel:[0,1,0] op_sel_hi:[1,1,1]
    v_pk_fma_f32 v[116:117], v[124:125], v[8:9], v[116:117] op_sel:[0,1,0] op_sel_hi:[1,1,1]
    v_pk_fma_f32 v[118:119], v[126:127], v[8:9], v[118:119] op_sel:[0,1,0] op_sel_hi:[1,1,1]
    s_waitcnt vmcnt(17)
    v_lshlrev_b32 v120, 16, v40
    v_and_b32 v121, 0xffff0000, v40
    v_lshlrev_b32 v122, 16, v41
    v_and_b32 v123, 0xffff0000, v41
    v_lshlrev_b32 v124, 16, v42
    v_and_b32 v125, 0xffff0000, v42
    v_lshlrev_b32 v126, 16, v43
    v_and_b32 v127, 0xffff0000, v43
    v_pk_fma_f32 v[112:113], v[120:121], v[10:11], v[112:113] op_sel:[0,0,0] op_sel_hi:[1,0,1]
    v_pk_fma_f32 v[114:115], v[122:123], v[10:11], v[114:115] op_sel:[0,0,0] op_sel_hi:[1,0,1]
    v_pk_fma_f32 v[116:117], v[124:125], v[10:11], v[116:117] op_sel:[0,0,0] op_sel_hi:[1,0,1]
    v_pk_fma_f32 v[118:119], v[126:127], v[10:11], v[118:119] op_sel:[0,0,0] op_sel_hi:[1,0,1]
    s_waitcnt vmcnt(16)
    v_lshlrev_b32 v120, 16, v44
    v_and_b32 v121, 0xffff0000, v44
    v_lshlrev_b32 v122, 16, v45
    v_and_b32 v123, 0xffff0000, v45
    v_lshlrev_b32 v124, 16, v46
    v_and_b32 v125, 0xffff0000, v46
    v_lshlrev_b32 v126, 16, v47
    v_and_b32 v127, 0xffff0000, v47
    v_pk_fma_f32 v[112:113], v[120:121], v[10:11], v[112:113] op_sel:[0,1,0] op_sel_hi:[1,1,1]
    v_pk_fma_f32 v[114:115], v[122:123], v[10:11], v[114:115] op_sel:[0,1,0] op_sel_hi:[1,1,1]
    v_pk_fma_f32 v[116:117], v[124:125], v[10:11], v[116:117] op_sel:[0,1,0] op_sel_hi:[1,1,1]
    v_pk_fma_f32 v[118:119], v[126:127], v[10:11], v[118:119] op_sel:[0,1,0] op_sel_hi:[1,1,1]
    s_waitcnt vmcnt(15)
    v_lshlrev_b32 v120, 16, v48
    v_and_b32 v121, 0xffff0000, v48
    v_lshlrev_b32 v122, 16, v49
    v_and_b32 v123, 0xffff0000, v49
    v_lshlrev_b32 v124, 16, v50
    v_and_b32 v125, 0xffff0000, v50
    v_lshlrev_b32 v126, 16, v51
    v_and_b32 v127, 0xffff0000, v51
    v_pk_fma_f32 v[112:113], v[120:121], v[12:13], v[112:113] op_sel:[0,0,0] op_sel_hi:[1,0,1]
    v_pk_fma_f32 v[114:115], v[122:123], v[12:13], v[114:115] op_sel:[0,0,0] op_sel_hi:[1,0,1]
    v_pk_fma_f32 v[116:117], v[124:125], v[12:13], v[116:117] op_sel:[0,0,0] op_sel_hi:[1,0,1]
    v_pk_fma_f32 v[118:119], v[126:127], v[12:13], v[118:119] op_sel:[0,0,0] op_sel_hi:[1,0,1]
    s_waitcnt vmcnt(14)
    v_lshlrev_b32 v120, 16, v52
    v_and_b32 v121, 0xffff0000, v52
    v_lshlrev_b32 v122, 16, v53
    v_and_b32 v123, 0xffff0000, v53
    v_lshlrev_b32 v124, 16, v54
    v_and_b32 v125, 0xffff0000, v54
    v_lshlrev_b32 v126, 16, v55
    v_and_b32 v127, 0xffff0000, v55
    v_pk_fma_f32 v[112:113], v[120:121], v[12:13], v[112:113] op_sel:[0,1,0] op_sel_hi:[1,1,1]
    v_pk_fma_f32 v[114:115], v[122:123], v[12:13], v[114:115] op_sel:[0,1,0] op_sel_hi:[1,1,1]
    v_pk_fma_f32 v[116:117], v[124:125], v[12:13], v[116:117] op_sel:[0,1,0] op_sel_hi:[1,1,1]
    v_pk_fma_f32 v[118:119], v[126:127], v[12:13], v[118:119] op_sel:[0,1,0] op_sel_hi:[1,1,1]
    s_waitcnt vmcnt(13)
    v_lshlrev_b32 v120, 16, v56
    v_and_b32 v121, 0xffff0000, v56
    v_lshlrev_b32 v122, 16, v57
    v_and_b32 v123, 0xffff0000, v57
    v_lshlrev_b32 v124, 16, v58
    v_and_b32 v125, 0xffff0000, v58
    v_lshlrev_b32 v126, 16, v59
    v_and_b32 v127, 0xffff0000, v59
    v_pk_fma_f32 v[112:113], v[120:121], v[14:15], v[112:113] op_sel:[0,0,0] op_sel_hi:[1,0,1]
    v_pk_fma_f32 v[114:115], v[122:123], v[14:15], v[114:115] op_sel:[0,0,0] op_sel_hi:[1,0,1]
    v_pk_fma_f32 v[116:117], v[124:125], v[14:15], v[116:117] op_sel:[0,0,0] op_sel_hi:[1,0,1]
    v_pk_fma_f32 v[118:119], v[126:127], v[14:15], v[118:119] op_sel:[0,0,0] op_sel_hi:[1,0,1]
    s_waitcnt vmcnt(12)
    v_lshlrev_b32 v120, 16, v60
    v_and_b32 v121, 0xffff0000, v60
    v_lshlrev_b32 v122, 16, v61
    v_and_b32 v123, 0xffff0000, v61
    v_lshlrev_b32 v124, 16, v62
    v_and_b32 v125, 0xffff0000, v62
    v_lshlrev_b32 v126, 16, v63
    v_and_b32 v127, 0xffff0000, v63
    v_pk_fma_f32 v[112:113], v[120:121], v[14:15], v[112:113] op_sel:[0,1,0] op_sel_hi:[1,1,1]
    v_pk_fma_f32 v[114:115], v[122:123], v[14:15], v[114:115] op_sel:[0,1,0] op_sel_hi:[1,1,1]
    v_pk_fma_f32 v[116:117], v[124:125], v[14:15], v[116:117] op_sel:[0,1,0] op_sel_hi:[1,1,1]
    v_pk_fma_f32 v[118:119], v[126:127], v[14:15], v[118:119] op_sel:[0,1,0] op_sel_hi:[1,1,1]
    s_waitcnt vmcnt(11)
    v_lshlrev_b32 v120, 16, v64
    v_and_b32 v121, 0xffff0000, v64
    v_lshlrev_b32 v122, 16, v65
    v_and_b32 v123, 0xffff0000, v65
    v_lshlrev_b32 v124, 16, v66
    v_and_b32 v125, 0xffff0000, v66
    v_lshlrev_b32 v126, 16, v67
    v_and_b32 v127, 0xffff0000, v67
    v_pk_fma_f32 v[112:113], v[120:121], v[16:17], v[112:113] op_sel:[0,0,0] op_sel_hi:[1,0,1]
    v_pk_fma_f32 v[114:115], v[122:123], v[16:17], v[114:115] op_sel:[0,0,0] op_sel_hi:[1,0,1]
    v_pk_fma_f32 v[116:117], v[124:125], v[16:17], v[116:117] op_sel:[0,0,0] op_sel_hi:[1,0,1]
    v_pk_fma_f32 v[118:119], v[126:127], v[16:17], v[118:119] op_sel:[0,0,0] op_sel_hi:[1,0,1]
    s_waitcnt vmcnt(10)
    v_lshlrev_b32 v120, 16, v68
    v_and_b32 v121, 0xffff0000, v68
    v_lshlrev_b32 v122, 16, v69
    v_and_b32 v123, 0xffff0000, v69
    v_lshlrev_b32 v124, 16, v70
    v_and_b32 v125, 0xffff0000, v70
    v_lshlrev_b32 v126, 16, v71
    v_and_b32 v127, 0xffff0000, v71
    v_pk_fma_f32 v[112:113], v[120:121], v[16:17], v[112:113] op_sel:[0,1,0] op_sel_hi:[1,1,1]
    v_pk_fma_f32 v[114:115], v[122:123], v[16:17], v[114:115] op_sel:[0,1,0] op_sel_hi:[1,1,1]
    v_pk_fma_f32 v[116:117], v[124:125], v[16:17], v[116:117] op_sel:[0,1,0] op_sel_hi:[1,1,1]
    v_pk_fma_f32 v[118:119], v[126:127], v[16:17], v[118:119] op_sel:[0,1,0] op_sel_hi:[1,1,1]
    s_waitcnt vmcnt(9)
    v_lshlrev_b32 v120, 16, v72
    v_and_b32 v121, 0xffff0000, v72
    v_lshlrev_b32 v122, 16, v73
    v_and_b32 v123, 0xffff0000, v73
    v_lshlrev_b32 v124, 16, v74
    v_and_b32 v125, 0xffff0000, v74
    v_lshlrev_b32 v126, 16, v75
    v_and_b32 v127, 0xffff0000, v75
    v_pk_fma_f32 v[112:113], v[120:121], v[18:19], v[112:113] op_sel:[0,0,0] op_sel_hi:[1,0,1]
    v_pk_fma_f32 v[114:115], v[122:123], v[18:19], v[114:115] op_sel:[0,0,0] op_sel_hi:[1,0,1]
    v_pk_fma_f32 v[116:117], v[124:125], v[18:19], v[116:117] op_sel:[0,0,0] op_sel_hi:[1,0,1]
    v_pk_fma_f32 v[118:119], v[126:127], v[18:19], v[118:119] op_sel:[0,0,0] op_sel_hi:[1,0,1]
    s_waitcnt vmcnt(8)
    v_lshlrev_b32 v120, 16, v76
    v_and_b32 v121, 0xffff0000, v76
    v_lshlrev_b32 v122, 16, v77
    v_and_b32 v123, 0xffff0000, v77
    v_lshlrev_b32 v124, 16, v78
    v_and_b32 v125, 0xffff0000, v78
    v_lshlrev_b32 v126, 16, v79
    v_and_b32 v127, 0xffff0000, v79
    v_pk_fma_f32 v[112:113], v[120:121], v[18:19], v[112:113] op_sel:[0,1,0] op_sel_hi:[1,1,1]
    v_pk_fma_f32 v[114:115], v[122:123], v[18:19], v[114:115] op_sel:[0,1,0] op_sel_hi:[1,1,1]
    v_pk_fma_f32 v[116:117], v[124:125], v[18:19], v[116:117] op_sel:[0,1,0] op_sel_hi:[1,1,1]
    v_pk_fma_f32 v[118:119], v[126:127], v[18:19], v[118:119] op_sel:[0,1,0] op_sel_hi:[1,1,1]
    s_waitcnt vmcnt(7)
    v_lshlrev_b32 v120, 16, v80
    v_and_b32 v121, 0xffff0000, v80
    v_lshlrev_b32 v122, 16, v81
    v_and_b32 v123, 0xffff0000, v81
    v_lshlrev_b32 v124, 16, v82
    v_and_b32 v125, 0xffff0000, v82
    v_lshlrev_b32 v126, 16, v83
    v_and_b32 v127, 0xffff0000, v83
    v_pk_fma_f32 v[112:113], v[120:121], v[20:21], v[112:113] op_sel:[0,0,0] op_sel_hi:[1,0,1]
    v_pk_fma_f32 v[114:115], v[122:123], v[20:21], v[114:115] op_sel:[0,0,0] op_sel_hi:[1,0,1]
    v_pk_fma_f32 v[116:117], v[124:125], v[20:21], v[116:117] op_sel:[0,0,0] op_sel_hi:[1,0,1]
    v_pk_fma_f32 v[118:119], v[126:127], v[20:21], v[118:119] op_sel:[0,0,0] op_sel_hi:[1,0,1]
    s_waitcnt vmcnt(6)
    v_lshlrev_b32 v120, 16, v84
    v_and_b32 v121, 0xffff0000, v84
    v_lshlrev_b32 v122, 16, v85
    v_and_b32 v123, 0xffff0000, v85
    v_lshlrev_b32 v124, 16, v86
    v_and_b32 v125, 0xffff0000, v86
    v_lshlrev_b32 v126, 16, v87
    v_and_b32 v127, 0xffff0000, v87
    v_pk_fma_f32 v[112:113], v[120:121], v[20:21], v[112:113] op_sel:[0,1,0] op_sel_hi:[1,1,1]
    v_pk_fma_f32 v[114:115], v[122:123], v[20:21], v[114:115] op_sel:[0,1,0] op_sel_hi:[1,1,1]
    v_pk_fma_f32 v[116:117], v[124:125], v[20:21], v[116:117] op_sel:[0,1,0] op_sel_hi:[1,1,1]
    v_pk_fma_f32 v[118:119], v[126:127], v[20:21], v[118:119] op_sel:[0,1,0] op_sel_hi:[1,1,1]
    s_waitcnt vmcnt(5)
    v_lshlrev_b32 v120, 16, v88
    v_and_b32 v121, 0xffff0000, v88
    v_lshlrev_b32 v122, 16, v89
    v_and_b32 v123, 0xffff0000, v89
    v_lshlrev_b32 v124, 16, v90
    v_and_b32 v125, 0xffff0000, v90
    v_lshlrev_b32 v126, 16, v91
    v_and_b32 v127, 0xffff0000, v91
    v_pk_fma_f32 v[112:113], v[120:121], v[22:23], v[112:113] op_sel:[0,0,0] op_sel_hi:[1,0,1]
    v_pk_fma_f32 v[114:115], v[122:123], v[22:23], v[114:115] op_sel:[0,0,0] op_sel_hi:[1,0,1]
    v_pk_fma_f32 v[116:117], v[124:125], v[22:23], v[116:117] op_sel:[0,0,0] op_sel_hi:[1,0,1]
    v_pk_fma_f32 v[118:119], v[126:127], v[22:23], v[118:119] op_sel:[0,0,0] op_sel_hi:[1,0,1]
    s_waitcnt vmcnt(4)
    v_lshlrev_b32 v120, 16, v92
    v_and_b32 v121, 0xffff0000, v92
    v_lshlrev_b32 v122, 16, v93
    v_and_b32 v123, 0xffff0000, v93
    v_lshlrev_b32 v124, 16, v94
    v_and_b32 v125, 0xffff0000, v94
    v_lshlrev_b32 v126, 16, v95
    v_and_b32 v127, 0xffff0000, v95
    v_pk_fma_f32 v[112:113], v[120:121], v[22:23], v[112:113] op_sel:[0,1,0] op_sel_hi:[1,1,1]
    v_pk_fma_f32 v[114:115], v[122:123], v[22:23], v[114:115] op_sel:[0,1,0] op_sel_hi:[1,1,1]
    v_pk_fma_f32 v[116:117], v[124:125], v[22:23], v[116:117] op_sel:[0,1,0] op_sel_hi:[1,1,1]
    v_pk_fma_f32 v[118:119], v[126:127], v[22:23], v[118:119] op_sel:[0,1,0] op_sel_hi:[1,1,1]
    s_waitcnt vmcnt(3)
    v_lshlrev_b32 v120, 16, v96
    v_and_b32 v121, 0xffff0000, v96
    v_lshlrev_b32 v122, 16, v97
    v_and_b32 v123, 0xffff0000, v97
    v_lshlrev_b32 v124, 16, v98
    v_and_b32 v125, 0xffff0000, v98
    v_lshlrev_b32 v126, 16, v99
    v_and_b32 v127, 0xffff0000, v99
    v_pk_fma_f32 v[112:113], v[120:121], v[24:25], v[112:113] op_sel:[0,0,0] op_sel_hi:[1,0,1]
    v_pk_fma_f32 v[114:115], v[122:123], v[24:25], v[114:115] op_sel:[0,0,0] op_sel_hi:[1,0,1]
    v_pk_fma_f32 v[116:117], v[124:125], v[24:25], v[116:117] op_sel:[0,0,0] op_sel_hi:[1,0,1]
    v_pk_fma_f32 v[118:119], v[126:127], v[24:25], v[118:119] op_sel:[0,0,0] op_sel_hi:[1,0,1]
    s_waitcnt vmcnt(2)
    v_lshlrev_b32 v120, 16, v100
    v_and_b32 v121, 0xffff0000, v100
    v_lshlrev_b32 v122, 16, v101
    v_and_b32 v123, 0xffff0000, v101
    v_lshlrev_b32 v124, 16, v102
    v_and_b32 v125, 0xffff0000, v102
    v_lshlrev_b32 v126, 16, v103
    v_and_b32 v127, 0xffff0000, v103
    v_pk_fma_f32 v[112:113], v[120:121], v[24:25], v[112:113] op_sel:[0,1,0] op_sel_hi:[1,1,1]
    v_pk_fma_f32 v[114:115], v[122:123], v[24:25], v[114:115] op_sel:[0,1,0] op_sel_hi:[1,1,1]
    v_pk_fma_f32 v[116:117], v[124:125], v[24:25], v[116:117] op_sel:[0,1,0] op_sel_hi:[1,1,1]
    v_pk_fma_f32 v[118:119], v[126:127], v[24:25], v[118:119] op_sel:[0,1,0] op_sel_hi:[1,1,1]
    s_waitcnt vmcnt(1)
    v_lshlrev_b32 v120, 16, v104
    v_and_b32 v121, 0xffff0000, v104
    v_lshlrev_b32 v122, 16, v105
    v_and_b32 v123, 0xffff0000, v105
    v_lshlrev_b32 v124, 16, v106
    v_and_b32 v125, 0xffff0000, v106
    v_lshlrev_b32 v126, 16, v107
    v_and_b32 v127, 0xffff0000, v107
    v_pk_fma_f32 v[112:113], v[120:121], v[26:27], v[112:113] op_sel:[0,0,0] op_sel_hi:[1,0,1]
    v_pk_fma_f32 v[114:115], v[122:123], v[26:27], v[114:115] op_sel:[0,0,0] op_sel_hi:[1,0,1]
    v_pk_fma_f32 v[116:117], v[124:125], v[26:27], v[116:117] op_sel:[0,0,0] op_sel_hi:[1,0,1]
    v_pk_fma_f32 v[118:119], v[126:127], v[26:27], v[118:119] op_sel:[0,0,0] op_sel_hi:[1,0,1]
    s_waitcnt vmcnt(0)
    v_lshlrev_b32 v120, 16, v108
    v_and_b32 v121, 0xffff0000, v108
    v_lshlrev_b32 v122, 16, v109
    v_and_b32 v123, 0xffff0000, v109
    v_lshlrev_b32 v124, 16, v110
    v_and_b32 v125, 0xffff0000, v110
    v_lshlrev_b32 v126, 16, v111
    v_and_b32 v127, 0xffff0000, v111
    v_pk_fma_f32 v[112:113], v[120:121], v[26:27], v[112:113] op_sel:[0,1,0] op_sel_hi:[1,1,1]
    v_pk_fma_f32 v[114:115], v[122:123], v[26:27], v[114:115] op_sel:[0,1,0] op_sel_hi:[1,1,1]
    v_pk_fma_f32 v[116:117], v[124:125], v[26:27], v[116:117] op_sel:[0,1,0] op_sel_hi:[1,1,1]
    v_pk_fma_f32 v[118:119], v[126:127], v[26:27], v[118:119] op_sel:[0,1,0] op_sel_hi:[1,1,1]
    s_nop 1
    v_add_f32_dpp v112, v112, v112 row_ror:8 row_mask:0xf bank_mask:0xf
    v_add_f32_dpp v113, v113, v113 row_ror:8 row_mask:0xf bank_mask:0xf
    v_add_f32_dpp v114, v114, v114 row_ror:8 row_mask:0xf bank_mask:0xf
    v_add_f32_dpp v115, v115, v115 row_ror:8 row_mask:0xf bank_mask:0xf
    v_add_f32_dpp v116, v116, v116 row_ror:8 row_mask:0xf bank_mask:0xf
    v_add_f32_dpp v117, v117, v117 row_ror:8 row_mask:0xf bank_mask:0xf
    v_add_f32_dpp v118, v118, v118 row_ror:8 row_mask:0xf bank_mask:0xf
    v_add_f32_dpp v119, v119, v119 row_ror:8 row_mask:0xf bank_mask:0xf
    v_mov_b32 v120, v112
    v_mov_b32 v121, v113
    v_mov_b32 v122, v114
    v_mov_b32 v123, v115
    v_mov_b32 v124, v116
    v_mov_b32 v125, v117
    v_mov_b32 v126, v118
    v_mov_b32 v127, v119
    s_nop 1
    v_permlane32_swap_b32 v120, v112
    v_permlane32_swap_b32 v121, v113
    v_permlane32_swap_b32 v122, v114
    v_permlane32_swap_b32 v123, v115
    v_permlane32_swap_b32 v124, v116
    v_permlane32_swap_b32 v125, v117
    v_permlane32_swap_b32 v126, v118
    v_permlane32_swap_b32 v127, v119
    s_nop 1
    v_add_f32 v112, v112, v120
    v_add_f32 v113, v113, v121
    v_add_f32 v114, v114, v122
    v_add_f32 v115, v115, v123
    v_add_f32 v116, v116, v124
    v_add_f32 v117, v117, v125
    v_add_f32 v118, v118, v126
    v_add_f32 v119, v119, v127
    v_mov_b32 v120, v112
    v_mov_b32 v121, v113
    v_mov_b32 v122, v114
    v_mov_b32 v123, v115
    v_mov_b32 v124, v116
    v_mov_b32 v125, v117
    v_mov_b32 v126, v118
    v_mov_b32 v127, v119
    s_nop 1
    v_permlane16_swap_b32 v120, v112
    v_permlane16_swap_b32 v121, v113
    v_permlane16_swap_b32 v122, v114
    v_permlane16_swap_b32 v123, v115
    v_permlane16_swap_b32 v124, v116
    v_permlane16_swap_b32 v125, v117
    v_permlane16_swap_b32 v126, v118
    v_permlane16_swap_b32 v127, v119
    s_nop 1
    v_add_f32 v112, v112, v120
    v_add_f32 v113, v113, v121
    v_add_f32 v114, v114, v122
    v_add_f32 v115, v115, v123
    v_add_f32 v116, v116, v124
    v_add_f32 v117, v117, v125
    v_add_f32 v118, v118, v126
    v_add_f32 v119, v119, v127
    v_lshlrev_b32 v7, 5, v3
    s_mul_i32 s36, s33, 15360
    s_lshl_b32 s37, s32, 8
    s_add_u32 s37, s37, s36
    s_add_u32 s37, s37, 2793472
    s_lshl_b32 s44, s21, 7
    s_add_u32 s44, s44, 29700096
    s_mov_b64 exec, 0xff
    buffer_store_dwordx4 v[112:115], v7, s[28:31], s37 offen sc1
    buffer_store_dwordx4 v[116:119], v7, s[28:31], s37 offen offset:16 sc1
    s_mov_b64 exec, -1
    s_waitcnt vmcnt(0)
    s_mov_b32 s47, 0
prep_kernel_nn6:
    v_readfirstlane_b32 s46, v250
    s_add_u32 s47, s47, 1
    s_cmp_lg_u32 s46, 0
    s_cbranch_scc1 prep_kernel_nd7
    s_cmp_ge_u32 s47, 20000
    s_cbranch_scc1 prep_kernel_nd7
    buffer_load_dword v250, v251, s[48:51], 0 offen sc1
    s_waitcnt vmcnt(0)
    s_branch prep_kernel_nn6
prep_kernel_nd7:
    v_mov_b32 v132, s46
    v_mov_b32 v133, 0
    s_mov_b64 exec, 1
    buffer_store_dword v132, v133, s[28:31], s44 offen sc1
    s_endpgm
p_st:
    s_mov_b32 s16, s60
    s_mov_b32 s17, s61
    s_mov_b32 s18, 2621440
    s_mov_b32 s19, 0x00020000
    v_lshrrev_b32 v5, 3, v1
    v_and_b32 v6, 7, v1
    s_lshl_b32 s23, s21, 4
    v_add_u32 v7, s23, v5
    v_mul_u32_u24 v9, 1280, v7
    v_lshl_add_u32 v9, v6, 4, v9
    v_mov_b32 v20, 0x3f803f80
    s_mov_b32 s24, 0
    buffer_load_dwordx4 v[32:35], v9, s[16:19], s24 offen offset:0 nt
    buffer_load_dwordx4 v[36:39], v9, s[16:19], s24 offen offset:128 nt
    buffer_load_dwordx4 v[40:43], v9, s[16:19], s24 offen offset:256 nt
    buffer_load_dwordx4 v[44:47], v9, s[16:19], s24 offen offset:384 nt
    buffer_load_dwordx4 v[48:51], v9, s[16:19], s24 offen offset:512 nt
    buffer_load_dwordx4 v[52:55], v9, s[16:19], s24 offen offset:640 nt
    buffer_load_dwordx4 v[56:59], v9, s[16:19], s24 offen offset:768 nt
    buffer_load_dwordx4 v[60:63], v9, s[16:19], s24 offen offset:896 nt
    buffer_load_dwordx4 v[64:67], v9, s[16:19], s24 offen offset:1024 nt
    buffer_load_dwordx4 v[68:71], v9, s[16:19], s24 offen offset:1152 nt
    s_add_u32 s24, s24, 10240
    buffer_load_dwordx4 v[72:75], v9, s[16:19], s24 offen offset:0 nt
    buffer_load_dwordx4 v[76:79], v9, s[16:19], s24 offen offset:128 nt
    buffer_load_dwordx4 v[80:83], v9, s[16:19], s24 offen offset:256 nt
    buffer_load_dwordx4 v[84:87], v9, s[16:19], s24 offen offset:384 nt
    buffer_load_dwordx4 v[88:91], v9, s[16:19], s24 offen offset:512 nt
    buffer_load_dwordx4 v[92:95], v9, s[16:19], s24 offen offset:640 nt
    buffer_load_dwordx4 v[96:99], v9, s[16:19], s24 offen offset:768 nt
    buffer_load_dwordx4 v[100:103], v9, s[16:19], s24 offen offset:896 nt
    buffer_load_dwordx4 v[104:107], v9, s[16:19], s24 offen offset:1024 nt
    buffer_load_dwordx4 v[108:111], v9, s[16:19], s24 offen offset:1152 nt
    v_and_b32 v21, 1, v5
    v_lshl_add_u32 v21, v6, 1, v21
    v_lshlrev_b32 v21, 7, v21
    v_lshrrev_b32 v22, 1, v5
    v_xor_b32 v22, v22, v6
    v_lshl_add_u32 v21, v22, 4, v21
    v_xor_b32 v23, 64, v21
    s_mul_i32 s25, s21, 20480
    s_add_u32 s25, s25, 2854912
    v_mov_b32 v10, 0
    v_mov_b32 v11, 0
    v_mov_b32 v12, 0
    v_mov_b32 v13, 0
    s_waitcnt vmcnt(19)
    v_dot2_f32_bf16 v10, v32, v20, v10
    v_dot2_f32_bf16 v11, v32, v32, v11
    v_dot2_f32_bf16 v10, v33, v20, v10
    v_dot2_f32_bf16 v11, v33, v33, v11
    v_dot2_f32_bf16 v10, v34, v20, v10
    v_dot2_f32_bf16 v11, v34, v34, v11
    v_dot2_f32_bf16 v10, v35, v20, v10
    v_dot2_f32_bf16 v11, v35, v35, v11
    v_mov_b32 v120, v32
    v_mov_b32 v121, v33
    v_mov_b32 v122, v34
    v_mov_b32 v123, v35
    v_mov_b32_dpp v120, v34 row_ror:8 row_mask:0xf bank_mask:0xc
    v_mov_b32_dpp v121, v35 row_ror:8 row_mask:0xf bank_mask:0xc
    v_mov_b32_dpp v122, v32 row_ror:8 row_mask:0xf bank_mask:0x3
    v_mov_b32_dpp v123, v33 row_ror:8 row_mask:0xf bank_mask:0x3
    s_add_u32 s26, s25, 0
    buffer_store_dwordx4 v[120:123], v21, s[28:31], s26 offen sc1
    s_waitcnt vmcnt(19)
    v_dot2_f32_bf16 v10, v36, v20, v10
    v_dot2_f32_bf16 v11, v36, v36, v11
    v_dot2_f32_bf16 v10, v37, v20, v10
    v_dot2_f32_bf16 v11, v37, v37, v11
    v_dot2_f32_bf16 v10, v38, v20, v10
    v_dot2_f32_bf16 v11, v38, v38, v11
    v_dot2_f32_bf16 v10, v39, v20, v10
    v_dot2_f32_bf16 v11, v39, v39, v11
    v_mov_b32 v124, v36
    v_mov_b32 v125, v37
    v_mov_b32 v126, v38
    v_mov_b32 v127, v39
    v_mov_b32_dpp v124, v38 row_ror:8 row_mask:0xf bank_mask:0xc
    v_mov_b32_dpp v125, v39 row_ror:8 row_mask:0xf bank_mask:0xc
    v_mov_b32_dpp v126, v36 row_ror:8 row_mask:0xf bank_mask:0x3
    v_mov_b32_dpp v127, v37 row_ror:8 row_mask:0xf bank_mask:0x3
    s_add_u32 s26, s25, 2048
    buffer_store_dwordx4 v[124:127], v21, s[28:31], s26 offen sc1
    s_waitcnt vmcnt(19)
    v_dot2_f32_bf16 v10, v40, v20, v10
    v_dot2_f32_bf16 v11, v40, v40, v11
    v_dot2_f32_bf16 v10, v41, v20, v10
    v_dot2_f32_bf16 v11, v41, v41, v11
    v_dot2_f32_bf16 v10, v42, v20, v10
    v_dot2_f32_bf16 v11, v42, v42, v11
    v_dot2_f32_bf16 v10, v43, v20, v10
    v_dot2_f32_bf16 v11, v43, v43, v11
    v_mov_b32 v120, v40
    v_mov_b32 v121, v41
    v_mov_b32 v122, v42
    v_mov_b32 v123, v43
    v_mov_b32_dpp v120, v42 row_ror:8 row_mask:0xf bank_mask:0xc
    v_mov_b32_dpp v121, v43 row_ror:8 row_mask:0xf bank_mask:0xc
    v_mov_b32_dpp v122, v40 row_ror:8 row_mask:0xf bank_mask:0x3
    v_mov_b32_dpp v123, v41 row_ror:8 row_mask:0xf bank_mask:0x3
    s_add_u32 s26, s25, 4096
    buffer_store_dwordx4 v[120:123], v21, s[28:31], s26 offen sc1
    s_waitcnt vmcnt(19)
    v_dot2_f32_bf16 v10, v44, v20, v10
    v_dot2_f32_bf16 v11, v44, v44, v11
    v_dot2_f32_bf16 v10, v45, v20, v10
    v_dot2_f32_bf16 v11, v45, v45, v11
    v_dot2_f32_bf16 v10, v46, v20, v10
    v_dot2_f32_bf16 v11, v46, v46, v11
    v_dot2_f32_bf16 v10, v47, v20, v10
    v_dot2_f32_bf16 v11, v47, v47, v11
    v_mov_b32 v124, v44
    v_mov_b32 v125, v45
    v_mov_b32 v126, v46
    v_mov_b32 v127, v47
    v_mov_b32_dpp v124, v46 row_ror:8 row_mask:0xf bank_mask:0xc
    v_mov_b32_dpp v125, v47 row_ror:8 row_mask:0xf bank_mask:0xc
    v_mov_b32_dpp v126, v44 row_ror:8 row_mask:0xf bank_mask:0x3
    v_mov_b32_dpp v127, v45 row_ror:8 row_mask:0xf bank_mask:0x3
    s_add_u32 s26, s25, 6144
    buffer_store_dwordx4 v[124:127], v21, s[28:31], s26 offen sc1
    s_waitcnt vmcnt(19)
    v_dot2_f32_bf16 v10, v48, v20, v10
    v_dot2_f32_bf16 v11, v48, v48, v11
    v_dot2_f32_bf16 v10, v49, v20, v10
    v_dot2_f32_bf16 v11, v49, v49, v11
    v_dot2_f32_bf16 v10, v50, v20, v10
    v_dot2_f32_bf16 v11, v50, v50, v11
    v_dot2_f32_bf16 v10, v51, v20, v10
    v_dot2_f32_bf16 v11, v51, v51, v11
    v_mov_b32 v120, v48
    v_mov_b32 v121, v49
    v_mov_b32 v122, v50
    v_mov_b32 v123, v51
    v_mov_b32_dpp v120, v50 row_ror:8 row_mask:0xf bank_mask:0xc
    v_mov_b32_dpp v121, v51 row_ror:8 row_mask:0xf bank_mask:0xc
    v_mov_b32_dpp v122, v48 row_ror:8 row_mask:0xf bank_mask:0x3
    v_mov_b32_dpp v123, v49 row_ror:8 row_mask:0xf bank_mask:0x3
    s_add_u32 s26, s25, 8192
    buffer_store_dwordx4 v[120:123], v21, s[28:31], s26 offen sc1
    s_waitcnt vmcnt(19)
    v_dot2_f32_bf16 v10, v52, v20, v10
    v_dot2_f32_bf16 v11, v52, v52, v11
    v_dot2_f32_bf16 v10, v53, v20, v10
    v_dot2_f32_bf16 v11, v53, v53, v11
    v_dot2_f32_bf16 v10, v54, v20, v10
    v_dot2_f32_bf16 v11, v54, v54, v11
    v_dot2_f32_bf16 v10, v55, v20, v10
    v_dot2_f32_bf16 v11, v55, v55, v11
    v_mov_b32 v124, v52
    v_mov_b32 v125, v53
    v_mov_b32 v126, v54
    v_mov_b32 v127, v55
    v_mov_b32_dpp v124, v54 row_ror:8 row_mask:0xf bank_mask:0xc
    v_mov_b32_dpp v125, v55 row_ror:8 row_mask:0xf bank_mask:0xc
    v_mov_b32_dpp v126, v52 row_ror:8 row_mask:0xf bank_mask:0x3
    v_mov_b32_dpp v127, v53 row_ror:8 row_mask:0xf bank_mask:0x3
    s_add_u32 s26, s25, 10240
    buffer_store_dwordx4 v[124:127], v21, s[28:31], s26 offen sc1
    s_waitcnt vmcnt(19)
    v_dot2_f32_bf16 v10, v56, v20, v10
    v_dot2_f32_bf16 v11, v56, v56, v11
    v_dot2_f32_bf16 v10, v57, v20, v10
    v_dot2_f32_bf16 v11, v57, v57, v11
    v_dot2_f32_bf16 v10, v58, v20, v10
    v_dot2_f32_bf16 v11, v58, v58, v11
    v_dot2_f32_bf16 v10, v59, v20, v10
    v_dot2_f32_bf16 v11, v59, v59, v11
    v_mov_b32 v120, v56
    v_mov_b32 v121, v57
    v_mov_b32 v122, v58
    v_mov_b32 v123, v59
    v_mov_b32_dpp v120, v58 row_ror:8 row_mask:0xf bank_mask:0xc
    v_mov_b32_dpp v121, v59 row_ror:8 row_mask:0xf bank_mask:0xc
    v_mov_b32_dpp v122, v56 row_ror:8 row_mask:0xf bank_mask:0x3
    v_mov_b32_dpp v123, v57 row_ror:8 row_mask:0xf bank_mask:0x3
    s_add_u32 s26, s25, 12288
    buffer_store_dwordx4 v[120:123], v21, s[28:31], s26 offen sc1
    s_waitcnt vmcnt(19)
    v_dot2_f32_bf16 v10, v60, v20, v10
    v_dot2_f32_bf16 v11, v60, v60, v11
    v_dot2_f32_bf16 v10, v61, v20, v10
    v_dot2_f32_bf16 v11, v61, v61, v11
    v_dot2_f32_bf16 v10, v62, v20, v10
    v_dot2_f32_bf16 v11, v62, v62, v11
    v_dot2_f32_bf16 v10, v63, v20, v10
    v_dot2_f32_bf16 v11, v63, v63, v11
    v_mov_b32 v124, v60
    v_mov_b32 v125, v61
    v_mov_b32 v126, v62
    v_mov_b32 v127, v63
    v_mov_b32_dpp v124, v62 row_ror:8 row_mask:0xf bank_mask:0xc
    v_mov_b32_dpp v125, v63 row_ror:8 row_mask:0xf bank_mask:0xc
    v_mov_b32_dpp v126, v60 row_ror:8 row_mask:0xf bank_mask:0x3
    v_mov_b32_dpp v127, v61 row_ror:8 row_mask:0xf bank_mask:0x3
    s_add_u32 s26, s25, 14336
    buffer_store_dwordx4 v[124:127], v21, s[28:31], s26 offen sc1
    s_waitcnt vmcnt(19)
    v_dot2_f32_bf16 v10, v64, v20, v10
    v_dot2_f32_bf16 v11, v64, v64, v11
    v_dot2_f32_bf16 v10, v65, v20, v10
    v_dot2_f32_bf16 v11, v65, v65, v11
    v_dot2_f32_bf16 v10, v66, v20, v10
    v_dot2_f32_bf16 v11, v66, v66, v11
    v_dot2_f32_bf16 v10, v67, v20, v10
    v_dot2_f32_bf16 v11, v67, v67, v11
    v_mov_b32 v120, v64
    v_mov_b32 v121, v65
    v_mov_b32 v122, v66
    v_mov_b32 v123, v67
    v_mov_b32_dpp v120, v66 row_ror:8 row_mask:0xf bank_mask:0xc
    v_mov_b32_dpp v121, v67 row_ror:8 row_mask:0xf bank_mask:0xc
    v_mov_b32_dpp v122, v64 row_ror:8 row_mask:0xf bank_mask:0x3
    v_mov_b32_dpp v123, v65 row_ror:8 row_mask:0xf bank_mask:0x3
    s_add_u32 s26, s25, 16384
    buffer_store_dwordx4 v[120:123], v21, s[28:31], s26 offen sc1
    s_waitcnt vmcnt(19)
    v_dot2_f32_bf16 v10, v68, v20, v10
    v_dot2_f32_bf16 v11, v68, v68, v11
    v_dot2_f32_bf16 v10, v69, v20, v10
    v_dot2_f32_bf16 v11, v69, v69, v11
    v_dot2_f32_bf16 v10, v70, v20, v10
    v_dot2_f32_bf16 v11, v70, v70, v11
    v_dot2_f32_bf16 v10, v71, v20, v10
    v_dot2_f32_bf16 v11, v71, v71, v11
    v_mov_b32 v124, v68
    v_mov_b32 v125, v69
    v_mov_b32 v126, v70
    v_mov_b32 v127, v71
    v_mov_b32_dpp v124, v70 row_ror:8 row_mask:0xf bank_mask:0xc
    v_mov_b32_dpp v125, v71 row_ror:8 row_mask:0xf bank_mask:0xc
    v_mov_b32_dpp v126, v68 row_ror:8 row_mask:0xf bank_mask:0x3
    v_mov_b32_dpp v127, v69 row_ror:8 row_mask:0xf bank_mask:0x3
    s_add_u32 s26, s25, 18432
    buffer_store_dwordx4 v[124:127], v21, s[28:31], s26 offen sc1
    s_waitcnt vmcnt(19)
    v_dot2_f32_bf16 v12, v72, v20, v12
    v_dot2_f32_bf16 v13, v72, v72, v13
    v_dot2_f32_bf16 v12, v73, v20, v12
    v_dot2_f32_bf16 v13, v73, v73, v13
    v_dot2_f32_bf16 v12, v74, v20, v12
    v_dot2_f32_bf16 v13, v74, v74, v13
    v_dot2_f32_bf16 v12, v75, v20, v12
    v_dot2_f32_bf16 v13, v75, v75, v13
    v_mov_b32 v120, v72
    v_mov_b32 v121, v73
    v_mov_b32 v122, v74
    v_mov_b32 v123, v75
    v_mov_b32_dpp v120, v74 row_ror:8 row_mask:0xf bank_mask:0xc
    v_mov_b32_dpp v121, v75 row_ror:8 row_mask:0xf bank_mask:0xc
    v_mov_b32_dpp v122, v72 row_ror:8 row_mask:0xf bank_mask:0x3
    v_mov_b32_dpp v123, v73 row_ror:8 row_mask:0xf bank_mask:0x3
    s_add_u32 s26, s25, 0
    buffer_store_dwordx4 v[120:123], v23, s[28:31], s26 offen sc1
    s_waitcnt vmcnt(19)
    v_dot2_f32_bf16 v12, v76, v20, v12
    v_dot2_f32_bf16 v13, v76, v76, v13
    v_dot2_f32_bf16 v12, v77, v20, v12
    v_dot2_f32_bf16 v13, v77, v77, v13
    v_dot2_f32_bf16 v12, v78, v20, v12
    v_dot2_f32_bf16 v13, v78, v78, v13
    v_dot2_f32_bf16 v12, v79, v20, v12
    v_dot2_f32_bf16 v13, v79, v79, v13
    v_mov_b32 v124, v76
    v_mov_b32 v125, v77
    v_mov_b32 v126, v78
    v_mov_b32 v127, v79
    v_mov_b32_dpp v124, v78 row_ror:8 row_mask:0xf bank_mask:0xc
    v_mov_b32_dpp v125, v79 row_ror:8 row_mask:0xf bank_mask:0xc
    v_mov_b32_dpp v126, v76 row_ror:8 row_mask:0xf bank_mask:0x3
    v_mov_b32_dpp v127, v77 row_ror:8 row_mask:0xf bank_mask:0x3
    s_add_u32 s26, s25, 2048
    buffer_store_dwordx4 v[124:127], v23, s[28:31], s26 offen sc1
    s_waitcnt vmcnt(19)
    v_dot2_f32_bf16 v12, v80, v20, v12
    v_dot2_f32_bf16 v13, v80, v80, v13
    v_dot2_f32_bf16 v12, v81, v20, v12
    v_dot2_f32_bf16 v13, v81, v81, v13
    v_dot2_f32_bf16 v12, v82, v20, v12
    v_dot2_f32_bf16 v13, v82, v82, v13
    v_dot2_f32_bf16 v12, v83, v20, v12
    v_dot2_f32_bf16 v13, v83, v83, v13
    v_mov_b32 v120, v80
    v_mov_b32 v121, v81
    v_mov_b32 v122, v82
    v_mov_b32 v123, v83
    v_mov_b32_dpp v120, v82 row_ror:8 row_mask:0xf bank_mask:0xc
    v_mov_b32_dpp v121, v83 row_ror:8 row_mask:0xf bank_mask:0xc
    v_mov_b32_dpp v122, v80 row_ror:8 row_mask:0xf bank_mask:0x3
    v_mov_b32_dpp v123, v81 row_ror:8 row_mask:0xf bank_mask:0x3
    s_add_u32 s26, s25, 4096
    buffer_store_dwordx4 v[120:123], v23, s[28:31], s26 offen sc1
    s_waitcnt vmcnt(19)
    v_dot2_f32_bf16 v12, v84, v20, v12
    v_dot2_f32_bf16 v13, v84, v84, v13
    v_dot2_f32_bf16 v12, v85, v20, v12
    v_dot2_f32_bf16 v13, v85, v85, v13
    v_dot2_f32_bf16 v12, v86, v20, v12
    v_dot2_f32_bf16 v13, v86, v86, v13
    v_dot2_f32_bf16 v12, v87, v20, v12
    v_dot2_f32_bf16 v13, v87, v87, v13
    v_mov_b32 v124, v84
    v_mov_b32 v125, v85
    v_mov_b32 v126, v86
    v_mov_b32 v127, v87
    v_mov_b32_dpp v124, v86 row_ror:8 row_mask:0xf bank_mask:0xc
    v_mov_b32_dpp v125, v87 row_ror:8 row_mask:0xf bank_mask:0xc
    v_mov_b32_dpp v126, v84 row_ror:8 row_mask:0xf bank_mask:0x3
    v_mov_b32_dpp v127, v85 row_ror:8 row_mask:0xf bank_mask:0x3
    s_add_u32 s26, s25, 6144
    buffer_store_dwordx4 v[124:127], v23, s[28:31], s26 offen sc1
    s_waitcnt vmcnt(19)
    v_dot2_f32_bf16 v12, v88, v20, v12
    v_dot2_f32_bf16 v13, v88, v88, v13
    v_dot2_f32_bf16 v12, v89, v20, v12
    v_dot2_f32_bf16 v13, v89, v89, v13
    v_dot2_f32_bf16 v12, v90, v20, v12
    v_dot2_f32_bf16 v13, v90, v90, v13
    v_dot2_f32_bf16 v12, v91, v20, v12
    v_dot2_f32_bf16 v13, v91, v91, v13
    v_mov_b32 v120, v88
    v_mov_b32 v121, v89
    v_mov_b32 v122, v90
    v_mov_b32 v123, v91
    v_mov_b32_dpp v120, v90 row_ror:8 row_mask:0xf bank_mask:0xc
    v_mov_b32_dpp v121, v91 row_ror:8 row_mask:0xf bank_mask:0xc
    v_mov_b32_dpp v122, v88 row_ror:8 row_mask:0xf bank_mask:0x3
    v_mov_b32_dpp v123, v89 row_ror:8 row_mask:0xf bank_mask:0x3
    s_add_u32 s26, s25, 8192
    buffer_store_dwordx4 v[120:123], v23, s[28:31], s26 offen sc1
    s_waitcnt vmcnt(19)
    v_dot2_f32_bf16 v12, v92, v20, v12
    v_dot2_f32_bf16 v13, v92, v92, v13
    v_dot2_f32_bf16 v12, v93, v20, v12
    v_dot2_f32_bf16 v13, v93, v93, v13
    v_dot2_f32_bf16 v12, v94, v20, v12
    v_dot2_f32_bf16 v13, v94, v94, v13
    v_dot2_f32_bf16 v12, v95, v20, v12
    v_dot2_f32_bf16 v13, v95, v95, v13
    v_mov_b32 v124, v92
    v_mov_b32 v125, v93
    v_mov_b32 v126, v94
    v_mov_b32 v127, v95
    v_mov_b32_dpp v124, v94 row_ror:8 row_mask:0xf bank_mask:0xc
    v_mov_b32_dpp v125, v95 row_ror:8 row_mask:0xf bank_mask:0xc
    v_mov_b32_dpp v126, v92 row_ror:8 row_mask:0xf bank_mask:0x3
    v_mov_b32_dpp v127, v93 row_ror:8 row_mask:0xf bank_mask:0x3
    s_add_u32 s26, s25, 10240
    buffer_store_dwordx4 v[124:127], v23, s[28:31], s26 offen sc1
    s_waitcnt vmcnt(19)
    v_dot2_f32_bf16 v12, v96, v20, v12
    v_dot2_f32_bf16 v13, v96, v96, v13
    v_dot2_f32_bf16 v12, v97, v20, v12
    v_dot2_f32_bf16 v13, v97, v97, v13
    v_dot2_f32_bf16 v12, v98, v20, v12
    v_dot2_f32_bf16 v13, v98, v98, v13
    v_dot2_f32_bf16 v12, v99, v20, v12
    v_dot2_f32_bf16 v13, v99, v99, v13
    v_mov_b32 v120, v96
    v_mov_b32 v121, v97
    v_mov_b32 v122, v98
    v_mov_b32 v123, v99
    v_mov_b32_dpp v120, v98 row_ror:8 row_mask:0xf bank_mask:0xc
    v_mov_b32_dpp v121, v99 row_ror:8 row_mask:0xf bank_mask:0xc
    v_mov_b32_dpp v122, v96 row_ror:8 row_mask:0xf bank_mask:0x3
    v_mov_b32_dpp v123, v97 row_ror:8 row_mask:0xf bank_mask:0x3
    s_add_u32 s26, s25, 12288
    buffer_store_dwordx4 v[120:123], v23, s[28:31], s26 offen sc1
    s_waitcnt vmcnt(19)
    v_dot2_f32_bf16 v12, v100, v20, v12
    v_dot2_f32_bf16 v13, v100, v100, v13
    v_dot2_f32_bf16 v12, v101, v20, v12
    v_dot2_f32_bf16 v13, v101, v101, v13
    v_dot2_f32_bf16 v12, v102, v20, v12
    v_dot2_f32_bf16 v13, v102, v102, v13
    v_dot2_f32_bf16 v12, v103, v20, v12
    v_dot2_f32_bf16 v13, v103, v103, v13
    v_mov_b32 v124, v100
    v_mov_b32 v125, v101
    v_mov_b32 v126, v102
    v_mov_b32 v127, v103
    v_mov_b32_dpp v124, v102 row_ror:8 row_mask:0xf bank_mask:0xc
    v_mov_b32_dpp v125, v103 row_ror:8 row_mask:0xf bank_mask:0xc
    v_mov_b32_dpp v126, v100 row_ror:8 row_mask:0xf bank_mask:0x3
    v_mov_b32_dpp v127, v101 row_ror:8 row_mask:0xf bank_mask:0x3
    s_add_u32 s26, s25, 14336
    buffer_store_dwordx4 v[124:127], v23, s[28:31], s26 offen sc1
    s_waitcnt vmcnt(19)
    v_dot2_f32_bf16 v12, v104, v20, v12
    v_dot2_f32_bf16 v13, v104, v104, v13
    v_dot2_f32_bf16 v12, v105, v20, v12
    v_dot2_f32_bf16 v13, v105, v105, v13
    v_dot2_f32_bf16 v12, v106, v20, v12
    v_dot2_f32_bf16 v13, v106, v106, v13
    v_dot2_f32_bf16 v12, v107, v20, v12
    v_dot2_f32_bf16 v13, v107, v107, v13
    v_mov_b32 v120, v104
    v_mov_b32 v121, v105
    v_mov_b32 v122, v106
    v_mov_b32 v123, v107
    v_mov_b32_dpp v120, v106 row_ror:8 row_mask:0xf bank_mask:0xc
    v_mov_b32_dpp v121, v107 row_ror:8 row_mask:0xf bank_mask:0xc
    v_mov_b32_dpp v122, v104 row_ror:8 row_mask:0xf bank_mask:0x3
    v_mov_b32_dpp v123, v105 row_ror:8 row_mask:0xf bank_mask:0x3
    s_add_u32 s26, s25, 16384
    buffer_store_dwordx4 v[120:123], v23, s[28:31], s26 offen sc1
    s_waitcnt vmcnt(19)
    v_dot2_f32_bf16 v12, v108, v20, v12
    v_dot2_f32_bf16 v13, v108, v108, v13
    v_dot2_f32_bf16 v12, v109, v20, v12
    v_dot2_f32_bf16 v13, v109, v109, v13
    v_dot2_f32_bf16 v12, v110, v20, v12
    v_dot2_f32_bf16 v13, v110, v110, v13
    v_dot2_f32_bf16 v12, v111, v20, v12
    v_dot2_f32_bf16 v13, v111, v111, v13
    v_mov_b32 v124, v108
    v_mov_b32 v125, v109
    v_mov_b32 v126, v110
    v_mov_b32 v127, v111
    v_mov_b32_dpp v124, v110 row_ror:8 row_mask:0xf bank_mask:0xc
    v_mov_b32_dpp v125, v111 row_ror:8 row_mask:0xf bank_mask:0xc
    v_mov_b32_dpp v126, v108 row_ror:8 row_mask:0xf bank_mask:0x3
    v_mov_b32_dpp v127, v109 row_ror:8 row_mask:0xf bank_mask:0x3
    s_add_u32 s26, s25, 18432
    buffer_store_dwordx4 v[124:127], v23, s[28:31], s26 offen sc1
    s_nop 2
    v_add_f32_dpp v10, v10, v10 quad_perm:[1,0,3,2] row_mask:0xf bank_mask:0xf
    v_add_f32_dpp v11, v11, v11 quad_perm:[1,0,3,2] row_mask:0xf bank_mask:0xf
    v_add_f32_dpp v12, v12, v12 quad_perm:[1,0,3,2] row_mask:0xf bank_mask:0xf
    v_add_f32_dpp v13, v13, v13 quad_perm:[1,0,3,2] row_mask:0xf bank_mask:0xf
    v_add_f32_dpp v10, v10, v10 quad_perm:[2,3,0,1] row_mask:0xf bank_mask:0xf
    v_add_f32_dpp v11, v11, v11 quad_perm:[2,3,0,1] row_mask:0xf bank_mask:0xf
    v_add_f32_dpp v12, v12, v12 quad_perm:[2,3,0,1] row_mask:0xf bank_mask:0xf
    v_add_f32_dpp v13, v13, v13 quad_perm:[2,3,0,1] row_mask:0xf bank_mask:0xf
    v_add_f32_dpp v10, v10, v10 row_half_mirror row_mask:0xf bank_mask:0xf
    v_add_f32_dpp v11, v11, v11 row_half_mirror row_mask:0xf bank_mask:0xf
    v_add_f32_dpp v12, v12, v12 row_half_mirror row_mask:0xf bank_mask:0xf
    v_add_f32_dpp v13, v13, v13 row_half_mirror row_mask:0xf bank_mask:0xf
    v_mul_f32 v10, 0x3acccccd, v10
    v_mul_f32 v12, 0x3acccccd, v12
    v_mul_f32 v11, 0x3acccccd, v11
    v_mul_f32 v13, 0x3acccccd, v13
    v_fma_f32 v11, -v10, v10, v11
    v_fma_f32 v13, -v12, v12, v13
    v_max_f32 v11, 0, v11
    v_max_f32 v13, 0, v13
    v_cvt_pk_bf16_f32 v24, v10, v11
    v_cvt_pk_bf16_f32 v25, v12, v13
    v_lshlrev_b32 v10, 16, v24
    v_lshlrev_b32 v12, 16, v25
    v_and_b32 v11, 0xffff0000, v24
    v_and_b32 v13, 0xffff0000, v25
    v_add_f32 v11, 0x3727c5ac, v11
    v_add_f32 v13, 0x3727c5ac, v13
    v_cvt_pk_bf16_f32 v24, v11, v11
    v_cvt_pk_bf16_f32 v25, v13, v13
    v_lshlrev_b32 v11, 16, v24
    v_lshlrev_b32 v13, 16, v25
    v_sqrt_f32 v11, v11
    v_sqrt_f32 v13, v13
    s_nop 0
    s_nop 0
    v_cvt_pk_bf16_f32 v24, v11, v11
    v_cvt_pk_bf16_f32 v25, v13, v13
    v_lshlrev_b32 v11, 16, v24
    v_lshlrev_b32 v13, 16, v25
    v_rcp_f32 v11, v11
    v_rcp_f32 v13, v13
    s_nop 0
    s_nop 0
    v_mul_f32 v10, v10, v11
    v_mul_f32 v12, v12, v13
    v_sub_f32 v10, 0, v10
    v_sub_f32 v12, 0, v12
    v_lshlrev_b32 v7, 3, v7
    v_cmp_eq_u32 vcc, 0, v6
    s_lshl_b32 s44, s21, 7
    s_add_u32 s44, s44, 29683712
    s_mov_b32 s23, 5476352
    s_and_saveexec_b64 s[66:67], vcc
    buffer_store_dwordx2 v[10:11], v7, s[28:31], s23 offen offset:0 sc1
    buffer_store_dwordx2 v[12:13], v7, s[28:31], s23 offen offset:64 sc1
    s_mov_b64 exec, -1
    s_waitcnt vmcnt(0)
    s_mov_b32 s47, 0
prep_kernel_nn8:
    v_readfirstlane_b32 s46, v250
    s_add_u32 s47, s47, 1
    s_cmp_lg_u32 s46, 0
    s_cbranch_scc1 prep_kernel_nd9
    s_cmp_ge_u32 s47, 20000
    s_cbranch_scc1 prep_kernel_nd9
    buffer_load_dword v250, v251, s[48:51], 0 offen sc1
    s_waitcnt vmcnt(0)
    s_branch prep_kernel_nn8
prep_kernel_nd9:
    v_mov_b32 v30, s46
    v_mov_b32 v31, 0
    s_mov_b64 exec, 1
    buffer_store_dword v30, v31, s[28:31], s44 offen sc1
    s_endpgm
p_misc:
    s_sub_u32 s24, s20, 3
    s_mul_i32 s23, s24, 96
    s_add_u32 s23, s23, s21
    s_cmp_ge_u32 s23, 256
    s_cbranch_scc1 prep_end
    s_mul_i32 s22, s24, 12
    s_lshr_b32 s25, s21, 3
    s_add_u32 s22, s22, s25
    v_lshlrev_b32 v1, 4, v1
    v_mov_b32 v60, 0
    v_mov_b32 v61, 0
    v_mov_b32 v62, 0
    v_mov_b32 v63, 0
    s_lshl_b32 s24, s23, 10
    s_add_u32 s25, s24, 29380608
    s_add_u32 s26, s24, 10784768
    s_add_u32 s27, s24, 13365248
    s_cmp_ge_u32 s23, 20
    s_cselect_b32 s26, s27, s26
    s_cmp_ge_u32 s23, 256
    s_cbranch_scc1 prep_kernel_nz10
    buffer_store_dwordx4 v[60:63], v1, s[28:31], s25 offen sc1
prep_kernel_nz10:
    s_cmp_ge_u32 s23, 40
    s_cbranch_scc1 prep_kernel_nz11
    buffer_store_dwordx4 v[60:63], v1, s[28:31], s26 offen sc1
prep_kernel_nz11:
    s_getpc_b64 s[24:25]
p_pcref:
    s_sub_u32 s24, s24, p_pcref-prep_kernel
    s_subb_u32 s25, s25, 0
    s_lshl_b32 s23, s22, 11
    s_add_u32 s26, s23, 0
    s_min_u32 s26, s26, (chain_end-prep_kernel-1020)&0xfffffff0
    v_add_u32 v64, s26, v1
    v_mov_b32 v5, s25
    v_add_co_u32 v4, vcc, s24, v64
    v_addc_co_u32 v5, vcc, 0, v5, vcc
    global_load_dwordx4 v[72:75], v[4:5], off
    s_add_u32 s26, s23, 1024
    s_min_u32 s26, s26, (chain_end-prep_kernel-1020)&0xfffffff0
    v_add_u32 v64, s26, v1
    v_mov_b32 v5, s25
    v_add_co_u32 v4, vcc, s24, v64
    v_addc_co_u32 v5, vcc, 0, v5, vcc
    global_load_dwordx4 v[76:79], v[4:5], off
    s_waitcnt vmcnt(0)
    s_endpgm
p_conv:
    s_cmp_ge_u32 s20, 4
    s_cbranch_scc1 prep_end
    s_setprio 3
    s_and_b32 s21, s2, 7
    s_mul_i32 s21, s21, 20
    s_sub_u32 s2, s2, 256
    s_lshr_b32 s2, s2, 3
    s_add_u32 s2, s2, s21
    s_mov_b32 s24, s56
    s_mov_b32 s25, s57
    s_mov_b32 s26, 2621440
    s_mov_b32 s27, 0x00020000
    s_lshl_b32 s21, s2, 3
    s_add_u32 s22, s58, s21
    s_addc_u32 s23, s59, 0
    s_load_dwordx2 s[32:33], s[22:23], 0
    s_lshl_b32 s21, s2, 2
    s_add_u32 s21, s21, s20
    s_mul_i32 s34, s20, 13824
    v_lshlrev_b32 v3, 4, v1
    s_lshl_b32 s35, s21, 12
    s_add_u32 s36, s34, 256
    s_mov_b32 m0, s36
    s_mul_i32 s37, s21, 4352
    s_add_u32 s37, s37, 0
    buffer_load_dwordx4 v3, s[24:27], s35 offen offset:0 nt lds
    buffer_load_dwordx4 v3, s[24:27], s35 offen offset:1024 nt lds
    buffer_load_dwordx4 v3, s[24:27], s35 offen offset:2048 nt lds
    buffer_load_dwordx4 v3, s[24:27], s35 offen offset:3072 nt lds
    s_add_u32 s36, s34, 9728
    s_mov_b32 m0, s36
    s_add_u32 s40, s35, 8
    v_mov_b32 v16, 0
    buffer_load_dwordx4 v3, s[24:27], s40 offen offset:0 lds
    buffer_load_dwordx4 v3, s[24:27], s40 offen offset:1024 lds
    buffer_load_dwordx4 v3, s[24:27], s40 offen offset:2048 lds
    buffer_load_dwordx4 v3, s[24:27], s40 offen offset:3072 lds
    buffer_load_dwordx2 v[252:253], v16, s[24:27], s35 offen
    v_lshrrev_b32 v4, 3, v0
    v_mul_u32_u24 v4, 20480, v4
    s_lshr_b32 s38, s2, 1
    s_and_b32 s38, s38, 7
    v_and_b32 v5, 7, v0
    v_xor_b32 v5, s38, v5
    v_lshl_add_u32 v4, v5, 4, v4
    s_lshl_b32 s38, s2, 7
    v_mov_b32 v16, 0
    buffer_load_dword v17, v16, s[48:51], 0 offen sc1
    s_waitcnt vmcnt(0)
    s_mov_b32 s47, 0
prep_kernel_nn12:
    v_readfirstlane_b32 s46, v17
    s_add_u32 s47, s47, 1
    s_cmp_lg_u32 s46, 0
    s_cbranch_scc1 prep_kernel_nd13
    s_cmp_ge_u32 s47, 20000
    s_cbranch_scc1 prep_kernel_nd13
    buffer_load_dword v17, v16, s[48:51], 0 offen sc1
    s_waitcnt vmcnt(0)
    s_branch prep_kernel_nn12
prep_kernel_nd13:
    s_lshr_b32 s40, s2, 4
    s_lshl_b32 s40, s40, 12
    s_add_u32 s40, s40, 29642752
    v_lshlrev_b32 v16, 7, v1
    s_cmp_lg_u32 s20, 0
    s_cbranch_scc1 prep_kernel_w014
    s_mov_b32 s47, 0
    s_mov_b32 exec_lo, -1
    s_mov_b32 exec_hi, 0
prep_kernel_pl15:
    buffer_load_dword v17, v16, s[28:31], s40 offen sc1
    s_add_u32 s47, s47, 1
    s_waitcnt vmcnt(0)
    v_cmp_ne_u32 vcc, s46, v17
    s_cmp_ge_u32 s47, 20000
    s_cbranch_scc1 prep_kernel_pd16
    s_cbranch_vccz prep_kernel_pd16
    s_sleep 8
    s_branch prep_kernel_pl15
prep_kernel_pd16:
    s_mov_b64 exec, -1
prep_kernel_w014:
    s_barrier
    s_add_u32 s36, s34, 4352
    s_mov_b32 m0, s36
    s_nop 0
    buffer_load_dwordx4 v3, s[28:31], s37 offen offset:0 sc1 lds
    buffer_load_dwordx4 v3, s[28:31], s37 offen offset:1024 sc1 lds
    buffer_load_dwordx4 v3, s[28:31], s37 offen offset:2048 sc1 lds
    buffer_load_dwordx4 v3, s[28:31], s37 offen offset:3072 sc1 lds
    s_add_u32 s36, s34, 8448
    s_mov_b32 m0, s36
    s_add_u32 s37, s37, 4096
    buffer_load_dwordx4 v3, s[28:31], s37 offen sc1 lds
    v_lshl_add_u32 v5, v1, 2, s34
    v_mov_b32 v6, 0
    ds_write_b32 v5, v6
    ds_write_b32 v5, v6 offset:9472
    v_and_b32 v7, 15, v1
    v_bfe_u32 v8, v1, 4, 1
    v_lshrrev_b32 v9, 5, v1
    v_mul_u32_u24 v10, 272, v7
    v_lshl_add_u32 v10, v9, 4, v10
    v_add_u32 v10, s34, v10
    v_add_u32 v10, 4356, v10
    v_lshlrev_b32 v11, 2, v8
    v_sub_u32 v10, v10, v11
    v_and_b32 v12, 7, v1
    v_mul_u32_u24 v13, 272, v12
    v_lshl_add_u32 v13, v9, 4, v13
    v_add_u32 v13, s34, v13
    v_add_u32 v13, 4356, v13
    v_sub_u32 v13, v13, v11
    v_bfe_u32 v11, v1, 3, 1
    v_lshlrev_b32 v11, 4, v11
    v_sub_u32 v11, 16, v11
    v_and_b32 v14, 31, v1
    v_lshlrev_b32 v14, 3, v14
    v_lshl_add_u32 v14, v9, 4, v14
    v_add_u32 v14, s34, v14
    v_and_b32 v17, 1, v1
    v_mul_u32_u24 v17, 9464, v17
    v_sub_u32 v17, 9472, v17
    v_add_u32 v14, v17, v14
    v_cmp_ne_u32 vcc, 0, v12
    v_mov_b32 v16, 0
    s_nop 1
    v_cndmask_b32 v15, v16, -1, vcc
    s_add_u32 s36, s34, 9720
    v_mov_b32 v17, s36
    s_waitcnt vmcnt(0) lgkmcnt(0)
    s_mov_b64 exec, 1
    ds_write_b64 v17, v[252:253]
    s_mov_b64 exec, -1
    s_waitcnt lgkmcnt(0)
    ds_read_b128 v[176:179], v14 offset:1792
    ds_read_b128 v[180:183], v14 offset:1824
    ds_read_b128 v[184:187], v14 offset:1856
    ds_read_b128 v[188:191], v14 offset:1888
    ds_read_b128 v[192:195], v14 offset:1920
    ds_read_b128 v[196:199], v14 offset:1952
    ds_read_b128 v[200:203], v14 offset:1984
    ds_read_b128 v[204:207], v14 offset:2016
    ds_read2_b32 v[64:65], v10 offset0:0 offset1:1
    ds_read2_b32 v[66:67], v10 offset0:2 offset1:3
    ds_read2_b32 v[68:69], v10 offset0:8 offset1:9
    ds_read2_b32 v[70:71], v10 offset0:10 offset1:11
    ds_read2_b32 v[72:73], v10 offset0:16 offset1:17
    ds_read2_b32 v[74:75], v10 offset0:18 offset1:19
    ds_read2_b32 v[76:77], v10 offset0:24 offset1:25
    ds_read2_b32 v[78:79], v10 offset0:26 offset1:27
    ds_read2_b32 v[80:81], v10 offset0:32 offset1:33
    ds_read2_b32 v[82:83], v10 offset0:34 offset1:35
    ds_read2_b32 v[84:85], v10 offset0:40 offset1:41
    ds_read2_b32 v[86:87], v10 offset0:42 offset1:43
    ds_read2_b32 v[88:89], v10 offset0:48 offset1:49
    ds_read2_b32 v[90:91], v10 offset0:50 offset1:51
    ds_read2_b32 v[92:93], v10 offset0:56 offset1:57
    ds_read2_b32 v[94:95], v10 offset0:58 offset1:59
    s_waitcnt lgkmcnt(0)
    v_mfma_f32_32x32x16_bf16 v[144:159], v[176:179], v[64:67], 0
    ds_read_b32 v16, v10 offset:16
    ds_read_b32 v17, v10 offset:48
    ds_read_b32 v18, v10 offset:80
    ds_read_b32 v19, v10 offset:112
    ds_read_b32 v20, v10 offset:144
    ds_read_b32 v21, v10 offset:176
    ds_read_b32 v22, v10 offset:208
    ds_read_b32 v23, v10 offset:240
    ds_read2_b32 v[96:97], v13 offset0:0 offset1:1
    ds_read2_b32 v[98:99], v13 offset0:2 offset1:3
    ds_read_b32 v24, v13 offset:16
    ds_read2_b32 v[100:101], v13 offset0:8 offset1:9
    ds_read2_b32 v[102:103], v13 offset0:10 offset1:11
    ds_read_b32 v25, v13 offset:48
    ds_read2_b32 v[104:105], v13 offset0:16 offset1:17
    ds_read2_b32 v[106:107], v13 offset0:18 offset1:19
    v_mfma_f32_32x32x16_bf16 v[144:159], v[180:183], v[68:71], v[144:159]
    ds_read_b32 v26, v13 offset:80
    ds_read2_b32 v[108:109], v13 offset0:24 offset1:25
    ds_read2_b32 v[110:111], v13 offset0:26 offset1:27
    ds_read_b32 v27, v13 offset:112
    ds_read2_b32 v[112:113], v13 offset0:32 offset1:33
    ds_read2_b32 v[114:115], v13 offset0:34 offset1:35
    ds_read_b32 v28, v13 offset:144
    ds_read2_b32 v[116:117], v13 offset0:40 offset1:41
    ds_read2_b32 v[118:119], v13 offset0:42 offset1:43
    ds_read_b32 v29, v13 offset:176
    ds_read2_b32 v[120:121], v13 offset0:48 offset1:49
    ds_read2_b32 v[122:123], v13 offset0:50 offset1:51
    ds_read_b32 v30, v13 offset:208
    ds_read2_b32 v[124:125], v13 offset0:56 offset1:57
    ds_read2_b32 v[126:127], v13 offset0:58 offset1:59
    ds_read_b32 v31, v13 offset:240
    v_mfma_f32_32x32x16_bf16 v[144:159], v[184:187], v[72:75], v[144:159]
    s_waitcnt lgkmcnt(15)
    s_waitcnt lgkmcnt(0)
    v_alignbit_b32 v32, v65, v64, 16
    v_alignbit_b32 v33, v66, v65, 16
    v_alignbit_b32 v34, v67, v66, 16
    v_alignbit_b32 v35, v16, v67, 16
    v_mfma_f32_32x32x16_bf16 v[144:159], v[188:191], v[76:79], v[144:159]
    v_alignbit_b32 v36, v69, v68, 16
    v_alignbit_b32 v37, v70, v69, 16
    v_alignbit_b32 v38, v71, v70, 16
    v_alignbit_b32 v39, v17, v71, 16
    v_alignbit_b32 v40, v73, v72, 16
    v_alignbit_b32 v41, v74, v73, 16
    v_mfma_f32_32x32x16_bf16 v[144:159], v[192:195], v[80:83], v[144:159]
    v_alignbit_b32 v42, v75, v74, 16
    v_alignbit_b32 v43, v18, v75, 16
    v_alignbit_b32 v44, v77, v76, 16
    v_alignbit_b32 v45, v78, v77, 16
    v_alignbit_b32 v46, v79, v78, 16
    v_alignbit_b32 v47, v19, v79, 16
    v_mfma_f32_32x32x16_bf16 v[144:159], v[196:199], v[84:87], v[144:159]
    v_alignbit_b32 v48, v81, v80, 16
    v_alignbit_b32 v49, v82, v81, 16
    v_alignbit_b32 v50, v83, v82, 16
    v_alignbit_b32 v51, v20, v83, 16
    v_alignbit_b32 v52, v85, v84, 16
    v_alignbit_b32 v53, v86, v85, 16
    v_mfma_f32_32x32x16_bf16 v[144:159], v[200:203], v[88:91], v[144:159]
    v_alignbit_b32 v54, v87, v86, 16
    v_alignbit_b32 v55, v21, v87, 16
    v_alignbit_b32 v56, v89, v88, 16
    v_alignbit_b32 v57, v90, v89, 16
    v_alignbit_b32 v58, v91, v90, 16
    v_alignbit_b32 v59, v22, v91, 16
    v_mfma_f32_32x32x16_bf16 v[144:159], v[204:207], v[92:95], v[144:159]
    v_alignbit_b32 v60, v93, v92, 16
    v_alignbit_b32 v61, v94, v93, 16
    v_alignbit_b32 v62, v95, v94, 16
    v_alignbit_b32 v63, v23, v95, 16
    s_nop 0
    v_mfma_f32_32x32x16_bf16 v[128:143], v[176:179], v[32:35], 0
    ds_read_b128 v[208:211], v14 offset:3840
    s_nop 3
    v_mfma_f32_32x32x16_bf16 v[128:143], v[180:183], v[36:39], v[128:143]
    ds_read_b128 v[212:215], v14 offset:3872
    s_nop 3
    v_mfma_f32_32x32x16_bf16 v[128:143], v[184:187], v[40:43], v[128:143]
    ds_read_b128 v[216:219], v14 offset:3904
    v_alignbit_b32 v96, v97, v96, v11
    v_alignbit_b32 v97, v98, v97, v11
    v_alignbit_b32 v98, v99, v98, v11
    v_alignbit_b32 v99, v24, v99, v11
    v_alignbit_b32 v100, v101, v100, v11
    v_alignbit_b32 v101, v102, v101, v11
    v_alignbit_b32 v102, v103, v102, v11
    v_alignbit_b32 v103, v25, v103, v11
    v_alignbit_b32 v104, v105, v104, v11
    v_mfma_f32_32x32x16_bf16 v[128:143], v[188:191], v[44:47], v[128:143]
    ds_read_b128 v[220:223], v14 offset:3936
    v_alignbit_b32 v105, v106, v105, v11
    v_alignbit_b32 v106, v107, v106, v11
    v_alignbit_b32 v107, v26, v107, v11
    v_alignbit_b32 v108, v109, v108, v11
    v_alignbit_b32 v109, v110, v109, v11
    v_alignbit_b32 v110, v111, v110, v11
    v_alignbit_b32 v111, v27, v111, v11
    v_mov_b32_dpp v144, v144 row_shr:1 row_mask:0xf bank_mask:0xf bound_ctrl:0
    v_mfma_f32_32x32x16_bf16 v[128:143], v[192:195], v[48:51], v[128:143]
    ds_read_b128 v[224:227], v14 offset:3968
    v_mov_b32_dpp v145, v145 row_shr:1 row_mask:0xf bank_mask:0xf bound_ctrl:0
    v_mov_b32_dpp v146, v146 row_shr:1 row_mask:0xf bank_mask:0xf bound_ctrl:0
    v_mov_b32_dpp v147, v147 row_shr:1 row_mask:0xf bank_mask:0xf bound_ctrl:0
    v_mov_b32_dpp v148, v148 row_shr:1 row_mask:0xf bank_mask:0xf bound_ctrl:0
    v_mov_b32_dpp v149, v149 row_shr:1 row_mask:0xf bank_mask:0xf bound_ctrl:0
    v_mov_b32_dpp v150, v150 row_shr:1 row_mask:0xf bank_mask:0xf bound_ctrl:0
    v_mov_b32_dpp v151, v151 row_shr:1 row_mask:0xf bank_mask:0xf bound_ctrl:0
    v_mov_b32_dpp v152, v152 row_shr:1 row_mask:0xf bank_mask:0xf bound_ctrl:0
    v_mfma_f32_32x32x16_bf16 v[128:143], v[196:199], v[52:55], v[128:143]
    ds_read_b128 v[228:231], v14 offset:4000
    v_mov_b32_dpp v153, v153 row_shr:1 row_mask:0xf bank_mask:0xf bound_ctrl:0
    v_mov_b32_dpp v154, v154 row_shr:1 row_mask:0xf bank_mask:0xf bound_ctrl:0
    v_mov_b32_dpp v155, v155 row_shr:1 row_mask:0xf bank_mask:0xf bound_ctrl:0
    v_mov_b32_dpp v156, v156 row_shr:1 row_mask:0xf bank_mask:0xf bound_ctrl:0
    v_mov_b32_dpp v157, v157 row_shr:1 row_mask:0xf bank_mask:0xf bound_ctrl:0
    v_mov_b32_dpp v158, v158 row_shr:1 row_mask:0xf bank_mask:0xf bound_ctrl:0
    v_mov_b32_dpp v159, v159 row_shr:1 row_mask:0xf bank_mask:0xf bound_ctrl:0
    v_alignbit_b32 v112, v113, v112, v11
    v_mfma_f32_32x32x16_bf16 v[128:143], v[200:203], v[56:59], v[128:143]
    ds_read_b128 v[232:235], v14 offset:4032
    v_alignbit_b32 v113, v114, v113, v11
    v_alignbit_b32 v114, v115, v114, v11
    v_alignbit_b32 v115, v28, v115, v11
    v_alignbit_b32 v116, v117, v116, v11
    v_alignbit_b32 v117, v118, v117, v11
    v_alignbit_b32 v118, v119, v118, v11
    v_alignbit_b32 v119, v29, v119, v11
    v_alignbit_b32 v120, v121, v120, v11
    v_mfma_f32_32x32x16_bf16 v[128:143], v[204:207], v[60:63], v[128:143]
    ds_read_b128 v[236:239], v14 offset:4064
    v_alignbit_b32 v121, v122, v121, v11
    v_alignbit_b32 v122, v123, v122, v11
    v_alignbit_b32 v123, v30, v123, v11
    v_alignbit_b32 v124, v125, v124, v11
    v_alignbit_b32 v125, v126, v125, v11
    v_alignbit_b32 v126, v127, v126, v11
    v_alignbit_b32 v127, v31, v127, v11
    s_nop 0
    s_waitcnt lgkmcnt(0)
    v_mfma_f32_32x32x16_bf16 v[160:175], v[208:211], v[96:99], 0
    ds_read_b128 v[176:179], v14 offset:1536
    ds_read_b128 v[180:183], v14 offset:1568
    s_nop 2
    v_mfma_f32_32x32x16_bf16 v[160:175], v[212:215], v[100:103], v[160:175]
    ds_read_b128 v[184:187], v14 offset:1600
    ds_read_b128 v[188:191], v14 offset:1632
    s_nop 2
    v_mfma_f32_32x32x16_bf16 v[160:175], v[216:219], v[104:107], v[160:175]
    ds_read_b128 v[192:195], v14 offset:1664
    ds_read_b128 v[196:199], v14 offset:1696
    v_mov_b32_dpp v128, v128 row_shr:1 row_mask:0xf bank_mask:0xf bound_ctrl:0
    v_mov_b32_dpp v129, v129 row_shr:1 row_mask:0xf bank_mask:0xf bound_ctrl:0
    v_mov_b32_dpp v130, v130 row_shr:1 row_mask:0xf bank_mask:0xf bound_ctrl:0
    v_mfma_f32_32x32x16_bf16 v[160:175], v[220:223], v[108:111], v[160:175]
    ds_read_b128 v[200:203], v14 offset:1728
    v_mov_b32_dpp v131, v131 row_shr:1 row_mask:0xf bank_mask:0xf bound_ctrl:0
    v_mov_b32_dpp v132, v132 row_shr:1 row_mask:0xf bank_mask:0xf bound_ctrl:0
    v_mov_b32_dpp v133, v133 row_shr:1 row_mask:0xf bank_mask:0xf bound_ctrl:0
    v_mfma_f32_32x32x16_bf16 v[160:175], v[224:227], v[112:115], v[160:175]
    ds_read_b128 v[204:207], v14 offset:1760
    v_mov_b32_dpp v134, v134 row_shr:1 row_mask:0xf bank_mask:0xf bound_ctrl:0
    v_mov_b32_dpp v135, v135 row_shr:1 row_mask:0xf bank_mask:0xf bound_ctrl:0
    v_mov_b32_dpp v136, v136 row_shr:1 row_mask:0xf bank_mask:0xf bound_ctrl:0
    v_mfma_f32_32x32x16_bf16 v[160:175], v[228:231], v[116:119], v[160:175]
    v_mov_b32_dpp v137, v137 row_shr:1 row_mask:0xf bank_mask:0xf bound_ctrl:0
    v_mov_b32_dpp v138, v138 row_shr:1 row_mask:0xf bank_mask:0xf bound_ctrl:0
    v_mov_b32_dpp v139, v139 row_shr:1 row_mask:0xf bank_mask:0xf bound_ctrl:0
    v_mfma_f32_32x32x16_bf16 v[160:175], v[232:235], v[120:123], v[160:175]
    v_mov_b32_dpp v140, v140 row_shr:1 row_mask:0xf bank_mask:0xf bound_ctrl:0
    v_mov_b32_dpp v141, v141 row_shr:1 row_mask:0xf bank_mask:0xf bound_ctrl:0
    v_mfma_f32_32x32x16_bf16 v[160:175], v[236:239], v[124:127], v[160:175]
    v_mov_b32_dpp v142, v142 row_shr:1 row_mask:0xf bank_mask:0xf bound_ctrl:0
    v_mov_b32_dpp v143, v143 row_shr:1 row_mask:0xf bank_mask:0xf bound_ctrl:0
    s_waitcnt lgkmcnt(0)
    v_mfma_f32_32x32x16_bf16 v[144:159], v[176:179], v[64:67], v[144:159]
    ds_read_b128 v[208:211], v14 offset:3584
    s_nop 3
    v_mfma_f32_32x32x16_bf16 v[144:159], v[180:183], v[68:71], v[144:159]
    ds_read_b128 v[212:215], v14 offset:3616
    s_nop 3
    v_mfma_f32_32x32x16_bf16 v[144:159], v[184:187], v[72:75], v[144:159]
    ds_read_b128 v[216:219], v14 offset:3648
    v_and_b32_dpp v160, v160, v15 row_shr:1 row_mask:0xf bank_mask:0xf bound_ctrl:0
    v_and_b32_dpp v161, v161, v15 row_shr:1 row_mask:0xf bank_mask:0xf bound_ctrl:0
    v_and_b32_dpp v162, v162, v15 row_shr:1 row_mask:0xf bank_mask:0xf bound_ctrl:0
    v_mfma_f32_32x32x16_bf16 v[144:159], v[188:191], v[76:79], v[144:159]
    ds_read_b128 v[220:223], v14 offset:3680
    v_and_b32_dpp v163, v163, v15 row_shr:1 row_mask:0xf bank_mask:0xf bound_ctrl:0
    v_and_b32_dpp v164, v164, v15 row_shr:1 row_mask:0xf bank_mask:0xf bound_ctrl:0
    v_and_b32_dpp v165, v165, v15 row_shr:1 row_mask:0xf bank_mask:0xf bound_ctrl:0
    v_mfma_f32_32x32x16_bf16 v[144:159], v[192:195], v[80:83], v[144:159]
    ds_read_b128 v[224:227], v14 offset:3712
    v_and_b32_dpp v166, v166, v15 row_shr:1 row_mask:0xf bank_mask:0xf bound_ctrl:0
    v_and_b32_dpp v167, v167, v15 row_shr:1 row_mask:0xf bank_mask:0xf bound_ctrl:0
    v_and_b32_dpp v168, v168, v15 row_shr:1 row_mask:0xf bank_mask:0xf bound_ctrl:0
    v_mfma_f32_32x32x16_bf16 v[144:159], v[196:199], v[84:87], v[144:159]
    ds_read_b128 v[228:231], v14 offset:3744
    v_and_b32_dpp v169, v169, v15 row_shr:1 row_mask:0xf bank_mask:0xf bound_ctrl:0
    v_and_b32_dpp v170, v170, v15 row_shr:1 row_mask:0xf bank_mask:0xf bound_ctrl:0
    v_and_b32_dpp v171, v171, v15 row_shr:1 row_mask:0xf bank_mask:0xf bound_ctrl:0
    v_mfma_f32_32x32x16_bf16 v[144:159], v[200:203], v[88:91], v[144:159]
    ds_read_b128 v[232:235], v14 offset:3776
    v_and_b32_dpp v172, v172, v15 row_shr:1 row_mask:0xf bank_mask:0xf bound_ctrl:0
    v_and_b32_dpp v173, v173, v15 row_shr:1 row_mask:0xf bank_mask:0xf bound_ctrl:0
    v_mfma_f32_32x32x16_bf16 v[144:159], v[204:207], v[92:95], v[144:159]
    ds_read_b128 v[236:239], v14 offset:3808
    v_and_b32_dpp v174, v174, v15 row_shr:1 row_mask:0xf bank_mask:0xf bound_ctrl:0
    v_and_b32_dpp v175, v175, v15 row_shr:1 row_mask:0xf bank_mask:0xf bound_ctrl:0
    v_mfma_f32_32x32x16_bf16 v[128:143], v[176:179], v[32:35], v[128:143]
    s_nop 4
    v_mfma_f32_32x32x16_bf16 v[128:143], v[180:183], v[36:39], v[128:143]
    s_nop 4
    v_mfma_f32_32x32x16_bf16 v[128:143], v[184:187], v[40:43], v[128:143]
    v_mov_b32_dpp v144, v144 row_shr:1 row_mask:0xf bank_mask:0xf bound_ctrl:0
    v_mov_b32_dpp v145, v145 row_shr:1 row_mask:0xf bank_mask:0xf bound_ctrl:0
    v_mov_b32_dpp v146, v146 row_shr:1 row_mask:0xf bank_mask:0xf bound_ctrl:0
    v_mfma_f32_32x32x16_bf16 v[128:143], v[188:191], v[44:47], v[128:143]
    v_mov_b32_dpp v147, v147 row_shr:1 row_mask:0xf bank_mask:0xf bound_ctrl:0
    v_mov_b32_dpp v148, v148 row_shr:1 row_mask:0xf bank_mask:0xf bound_ctrl:0
    v_mov_b32_dpp v149, v149 row_shr:1 row_mask:0xf bank_mask:0xf bound_ctrl:0
    v_mfma_f32_32x32x16_bf16 v[128:143], v[192:195], v[48:51], v[128:143]
    v_mov_b32_dpp v150, v150 row_shr:1 row_mask:0xf bank_mask:0xf bound_ctrl:0
    v_mov_b32_dpp v151, v151 row_shr:1 row_mask:0xf bank_mask:0xf bound_ctrl:0
    v_mov_b32_dpp v152, v152 row_shr:1 row_mask:0xf bank_mask:0xf bound_ctrl:0
    v_mfma_f32_32x32x16_bf16 v[128:143], v[196:199], v[52:55], v[128:143]
    v_mov_b32_dpp v153, v153 row_shr:1 row_mask:0xf bank_mask:0xf bound_ctrl:0
    v_mov_b32_dpp v154, v154 row_shr:1 row_mask:0xf bank_mask:0xf bound_ctrl:0
    v_mov_b32_dpp v155, v155 row_shr:1 row_mask:0xf bank_mask:0xf bound_ctrl:0
    v_mfma_f32_32x32x16_bf16 v[128:143], v[200:203], v[56:59], v[128:143]
    v_mov_b32_dpp v156, v156 row_shr:1 row_mask:0xf bank_mask:0xf bound_ctrl:0
    v_mov_b32_dpp v157, v157 row_shr:1 row_mask:0xf bank_mask:0xf bound_ctrl:0
    v_mfma_f32_32x32x16_bf16 v[128:143], v[204:207], v[60:63], v[128:143]
    v_mov_b32_dpp v158, v158 row_shr:1 row_mask:0xf bank_mask:0xf bound_ctrl:0
    v_mov_b32_dpp v159, v159 row_shr:1 row_mask:0xf bank_mask:0xf bound_ctrl:0
    s_waitcnt lgkmcnt(0)
    v_mfma_f32_32x32x16_bf16 v[160:175], v[208:211], v[96:99], v[160:175]
    ds_read_b128 v[176:179], v14 offset:1280
    ds_read_b128 v[180:183], v14 offset:1312
    s_nop 2
    v_mfma_f32_32x32x16_bf16 v[160:175], v[212:215], v[100:103], v[160:175]
    ds_read_b128 v[184:187], v14 offset:1344
    ds_read_b128 v[188:191], v14 offset:1376
    s_nop 2
    v_mfma_f32_32x32x16_bf16 v[160:175], v[216:219], v[104:107], v[160:175]
    ds_read_b128 v[192:195], v14 offset:1408
    ds_read_b128 v[196:199], v14 offset:1440
    v_mov_b32_dpp v128, v128 row_shr:1 row_mask:0xf bank_mask:0xf bound_ctrl:0
    v_mov_b32_dpp v129, v129 row_shr:1 row_mask:0xf bank_mask:0xf bound_ctrl:0
    v_mov_b32_dpp v130, v130 row_shr:1 row_mask:0xf bank_mask:0xf bound_ctrl:0
    v_mfma_f32_32x32x16_bf16 v[160:175], v[220:223], v[108:111], v[160:175]
    ds_read_b128 v[200:203], v14 offset:1472
    v_mov_b32_dpp v131, v131 row_shr:1 row_mask:0xf bank_mask:0xf bound_ctrl:0
    v_mov_b32_dpp v132, v132 row_shr:1 row_mask:0xf bank_mask:0xf bound_ctrl:0
    v_mov_b32_dpp v133, v133 row_shr:1 row_mask:0xf bank_mask:0xf bound_ctrl:0
    v_mfma_f32_32x32x16_bf16 v[160:175], v[224:227], v[112:115], v[160:175]
    ds_read_b128 v[204:207], v14 offset:1504
    v_mov_b32_dpp v134, v134 row_shr:1 row_mask:0xf bank_mask:0xf bound_ctrl:0
    v_mov_b32_dpp v135, v135 row_shr:1 row_mask:0xf bank_mask:0xf bound_ctrl:0
    v_mov_b32_dpp v136, v136 row_shr:1 row_mask:0xf bank_mask:0xf bound_ctrl:0
    v_mfma_f32_32x32x16_bf16 v[160:175], v[228:231], v[116:119], v[160:175]
    v_mov_b32_dpp v137, v137 row_shr:1 row_mask:0xf bank_mask:0xf bound_ctrl:0
    v_mov_b32_dpp v138, v138 row_shr:1 row_mask:0xf bank_mask:0xf bound_ctrl:0
    v_mov_b32_dpp v139, v139 row_shr:1 row_mask:0xf bank_mask:0xf bound_ctrl:0
    v_mfma_f32_32x32x16_bf16 v[160:175], v[232:235], v[120:123], v[160:175]
    v_mov_b32_dpp v140, v140 row_shr:1 row_mask:0xf bank_mask:0xf bound_ctrl:0
    v_mov_b32_dpp v141, v141 row_shr:1 row_mask:0xf bank_mask:0xf bound_ctrl:0
    v_mfma_f32_32x32x16_bf16 v[160:175], v[236:239], v[124:127], v[160:175]
    v_mov_b32_dpp v142, v142 row_shr:1 row_mask:0xf bank_mask:0xf bound_ctrl:0
    v_mov_b32_dpp v143, v143 row_shr:1 row_mask:0xf bank_mask:0xf bound_ctrl:0
    s_waitcnt lgkmcnt(0)
    v_mfma_f32_32x32x16_bf16 v[144:159], v[176:179], v[64:67], v[144:159]
    ds_read_b128 v[208:211], v14 offset:3328
    s_nop 3
    v_mfma_f32_32x32x16_bf16 v[144:159], v[180:183], v[68:71], v[144:159]
    ds_read_b128 v[212:215], v14 offset:3360
    s_nop 3
    v_mfma_f32_32x32x16_bf16 v[144:159], v[184:187], v[72:75], v[144:159]
    ds_read_b128 v[216:219], v14 offset:3392
    v_and_b32_dpp v160, v160, v15 row_shr:1 row_mask:0xf bank_mask:0xf bound_ctrl:0
    v_and_b32_dpp v161, v161, v15 row_shr:1 row_mask:0xf bank_mask:0xf bound_ctrl:0
    v_and_b32_dpp v162, v162, v15 row_shr:1 row_mask:0xf bank_mask:0xf bound_ctrl:0
    v_mfma_f32_32x32x16_bf16 v[144:159], v[188:191], v[76:79], v[144:159]
    ds_read_b128 v[220:223], v14 offset:3424
    v_and_b32_dpp v163, v163, v15 row_shr:1 row_mask:0xf bank_mask:0xf bound_ctrl:0
    v_and_b32_dpp v164, v164, v15 row_shr:1 row_mask:0xf bank_mask:0xf bound_ctrl:0
    v_and_b32_dpp v165, v165, v15 row_shr:1 row_mask:0xf bank_mask:0xf bound_ctrl:0
    v_mfma_f32_32x32x16_bf16 v[144:159], v[192:195], v[80:83], v[144:159]
    ds_read_b128 v[224:227], v14 offset:3456
    v_and_b32_dpp v166, v166, v15 row_shr:1 row_mask:0xf bank_mask:0xf bound_ctrl:0
    v_and_b32_dpp v167, v167, v15 row_shr:1 row_mask:0xf bank_mask:0xf bound_ctrl:0
    v_and_b32_dpp v168, v168, v15 row_shr:1 row_mask:0xf bank_mask:0xf bound_ctrl:0
    v_mfma_f32_32x32x16_bf16 v[144:159], v[196:199], v[84:87], v[144:159]
    ds_read_b128 v[228:231], v14 offset:3488
    v_and_b32_dpp v169, v169, v15 row_shr:1 row_mask:0xf bank_mask:0xf bound_ctrl:0
    v_and_b32_dpp v170, v170, v15 row_shr:1 row_mask:0xf bank_mask:0xf bound_ctrl:0
    v_and_b32_dpp v171, v171, v15 row_shr:1 row_mask:0xf bank_mask:0xf bound_ctrl:0
    v_mfma_f32_32x32x16_bf16 v[144:159], v[200:203], v[88:91], v[144:159]
    ds_read_b128 v[232:235], v14 offset:3520
    v_and_b32_dpp v172, v172, v15 row_shr:1 row_mask:0xf bank_mask:0xf bound_ctrl:0
    v_and_b32_dpp v173, v173, v15 row_shr:1 row_mask:0xf bank_mask:0xf bound_ctrl:0
    v_mfma_f32_32x32x16_bf16 v[144:159], v[204:207], v[92:95], v[144:159]
    ds_read_b128 v[236:239], v14 offset:3552
    v_and_b32_dpp v174, v174, v15 row_shr:1 row_mask:0xf bank_mask:0xf bound_ctrl:0
    v_and_b32_dpp v175, v175, v15 row_shr:1 row_mask:0xf bank_mask:0xf bound_ctrl:0
    v_mfma_f32_32x32x16_bf16 v[128:143], v[176:179], v[32:35], v[128:143]
    s_nop 4
    v_mfma_f32_32x32x16_bf16 v[128:143], v[180:183], v[36:39], v[128:143]
    s_nop 4
    v_mfma_f32_32x32x16_bf16 v[128:143], v[184:187], v[40:43], v[128:143]
    v_mov_b32_dpp v144, v144 row_shr:1 row_mask:0xf bank_mask:0xf bound_ctrl:0
    v_mov_b32_dpp v145, v145 row_shr:1 row_mask:0xf bank_mask:0xf bound_ctrl:0
    v_mov_b32_dpp v146, v146 row_shr:1 row_mask:0xf bank_mask:0xf bound_ctrl:0
    v_mfma_f32_32x32x16_bf16 v[128:143], v[188:191], v[44:47], v[128:143]
    v_mov_b32_dpp v147, v147 row_shr:1 row_mask:0xf bank_mask:0xf bound_ctrl:0
    v_mov_b32_dpp v148, v148 row_shr:1 row_mask:0xf bank_mask:0xf bound_ctrl:0
    v_mov_b32_dpp v149, v149 row_shr:1 row_mask:0xf bank_mask:0xf bound_ctrl:0
    v_mfma_f32_32x32x16_bf16 v[128:143], v[192:195], v[48:51], v[128:143]
    v_mov_b32_dpp v150, v150 row_shr:1 row_mask:0xf bank_mask:0xf bound_ctrl:0
    v_mov_b32_dpp v151, v151 row_shr:1 row_mask:0xf bank_mask:0xf bound_ctrl:0
    v_mov_b32_dpp v152, v152 row_shr:1 row_mask:0xf bank_mask:0xf bound_ctrl:0
    v_mfma_f32_32x32x16_bf16 v[128:143], v[196:199], v[52:55], v[128:143]
    v_mov_b32_dpp v153, v153 row_shr:1 row_mask:0xf bank_mask:0xf bound_ctrl:0
    v_mov_b32_dpp v154, v154 row_shr:1 row_mask:0xf bank_mask:0xf bound_ctrl:0
    v_mov_b32_dpp v155, v155 row_shr:1 row_mask:0xf bank_mask:0xf bound_ctrl:0
    v_mfma_f32_32x32x16_bf16 v[128:143], v[200:203], v[56:59], v[128:143]
    v_mov_b32_dpp v156, v156 row_shr:1 row_mask:0xf bank_mask:0xf bound_ctrl:0
    v_mov_b32_dpp v157, v157 row_shr:1 row_mask:0xf bank_mask:0xf bound_ctrl:0
    v_mfma_f32_32x32x16_bf16 v[128:143], v[204:207], v[60:63], v[128:143]
    v_mov_b32_dpp v158, v158 row_shr:1 row_mask:0xf bank_mask:0xf bound_ctrl:0
    v_mov_b32_dpp v159, v159 row_shr:1 row_mask:0xf bank_mask:0xf bound_ctrl:0
    s_waitcnt lgkmcnt(0)
    v_mfma_f32_32x32x16_bf16 v[160:175], v[208:211], v[96:99], v[160:175]
    ds_read_b128 v[176:179], v14 offset:1024
    ds_read_b128 v[180:183], v14 offset:1056
    s_nop 2
    v_mfma_f32_32x32x16_bf16 v[160:175], v[212:215], v[100:103], v[160:175]
    ds_read_b128 v[184:187], v14 offset:1088
    ds_read_b128 v[188:191], v14 offset:1120
    s_nop 2
    v_mfma_f32_32x32x16_bf16 v[160:175], v[216:219], v[104:107], v[160:175]
    ds_read_b128 v[192:195], v14 offset:1152
    ds_read_b128 v[196:199], v14 offset:1184
    v_mov_b32_dpp v128, v128 row_shr:1 row_mask:0xf bank_mask:0xf bound_ctrl:0
    v_mov_b32_dpp v129, v129 row_shr:1 row_mask:0xf bank_mask:0xf bound_ctrl:0
    v_mov_b32_dpp v130, v130 row_shr:1 row_mask:0xf bank_mask:0xf bound_ctrl:0
    v_mfma_f32_32x32x16_bf16 v[160:175], v[220:223], v[108:111], v[160:175]
    ds_read_b128 v[200:203], v14 offset:1216
    v_mov_b32_dpp v131, v131 row_shr:1 row_mask:0xf bank_mask:0xf bound_ctrl:0
    v_mov_b32_dpp v132, v132 row_shr:1 row_mask:0xf bank_mask:0xf bound_ctrl:0
    v_mov_b32_dpp v133, v133 row_shr:1 row_mask:0xf bank_mask:0xf bound_ctrl:0
    v_mfma_f32_32x32x16_bf16 v[160:175], v[224:227], v[112:115], v[160:175]
    ds_read_b128 v[204:207], v14 offset:1248
    v_mov_b32_dpp v134, v134 row_shr:1 row_mask:0xf bank_mask:0xf bound_ctrl:0
    v_mov_b32_dpp v135, v135 row_shr:1 row_mask:0xf bank_mask:0xf bound_ctrl:0
    v_mov_b32_dpp v136, v136 row_shr:1 row_mask:0xf bank_mask:0xf bound_ctrl:0
    v_mfma_f32_32x32x16_bf16 v[160:175], v[228:231], v[116:119], v[160:175]
    v_mov_b32_dpp v137, v137 row_shr:1 row_mask:0xf bank_mask:0xf bound_ctrl:0
    v_mov_b32_dpp v138, v138 row_shr:1 row_mask:0xf bank_mask:0xf bound_ctrl:0
    v_mov_b32_dpp v139, v139 row_shr:1 row_mask:0xf bank_mask:0xf bound_ctrl:0
    v_mfma_f32_32x32x16_bf16 v[160:175], v[232:235], v[120:123], v[160:175]
    v_mov_b32_dpp v140, v140 row_shr:1 row_mask:0xf bank_mask:0xf bound_ctrl:0
    v_mov_b32_dpp v141, v141 row_shr:1 row_mask:0xf bank_mask:0xf bound_ctrl:0
    v_mfma_f32_32x32x16_bf16 v[160:175], v[236:239], v[124:127], v[160:175]
    v_mov_b32_dpp v142, v142 row_shr:1 row_mask:0xf bank_mask:0xf bound_ctrl:0
    v_mov_b32_dpp v143, v143 row_shr:1 row_mask:0xf bank_mask:0xf bound_ctrl:0
    s_waitcnt lgkmcnt(0)
    v_mfma_f32_32x32x16_bf16 v[144:159], v[176:179], v[64:67], v[144:159]
    ds_read_b128 v[208:211], v14 offset:3072
    s_nop 3
    v_mfma_f32_32x32x16_bf16 v[144:159], v[180:183], v[68:71], v[144:159]
    ds_read_b128 v[212:215], v14 offset:3104
    s_nop 3
    v_mfma_f32_32x32x16_bf16 v[144:159], v[184:187], v[72:75], v[144:159]
    ds_read_b128 v[216:219], v14 offset:3136
    v_and_b32_dpp v160, v160, v15 row_shr:1 row_mask:0xf bank_mask:0xf bound_ctrl:0
    v_and_b32_dpp v161, v161, v15 row_shr:1 row_mask:0xf bank_mask:0xf bound_ctrl:0
    v_and_b32_dpp v162, v162, v15 row_shr:1 row_mask:0xf bank_mask:0xf bound_ctrl:0
    v_mfma_f32_32x32x16_bf16 v[144:159], v[188:191], v[76:79], v[144:159]
    ds_read_b128 v[220:223], v14 offset:3168
    v_and_b32_dpp v163, v163, v15 row_shr:1 row_mask:0xf bank_mask:0xf bound_ctrl:0
    v_and_b32_dpp v164, v164, v15 row_shr:1 row_mask:0xf bank_mask:0xf bound_ctrl:0
    v_and_b32_dpp v165, v165, v15 row_shr:1 row_mask:0xf bank_mask:0xf bound_ctrl:0
    v_mfma_f32_32x32x16_bf16 v[144:159], v[192:195], v[80:83], v[144:159]
    ds_read_b128 v[224:227], v14 offset:3200
    v_and_b32_dpp v166, v166, v15 row_shr:1 row_mask:0xf bank_mask:0xf bound_ctrl:0
    v_and_b32_dpp v167, v167, v15 row_shr:1 row_mask:0xf bank_mask:0xf bound_ctrl:0
    v_and_b32_dpp v168, v168, v15 row_shr:1 row_mask:0xf bank_mask:0xf bound_ctrl:0
    v_mfma_f32_32x32x16_bf16 v[144:159], v[196:199], v[84:87], v[144:159]
    ds_read_b128 v[228:231], v14 offset:3232
    v_and_b32_dpp v169, v169, v15 row_shr:1 row_mask:0xf bank_mask:0xf bound_ctrl:0
    v_and_b32_dpp v170, v170, v15 row_shr:1 row_mask:0xf bank_mask:0xf bound_ctrl:0
    v_and_b32_dpp v171, v171, v15 row_shr:1 row_mask:0xf bank_mask:0xf bound_ctrl:0
    v_mfma_f32_32x32x16_bf16 v[144:159], v[200:203], v[88:91], v[144:159]
    ds_read_b128 v[232:235], v14 offset:3264
    v_and_b32_dpp v172, v172, v15 row_shr:1 row_mask:0xf bank_mask:0xf bound_ctrl:0
    v_and_b32_dpp v173, v173, v15 row_shr:1 row_mask:0xf bank_mask:0xf bound_ctrl:0
    v_mfma_f32_32x32x16_bf16 v[144:159], v[204:207], v[92:95], v[144:159]
    ds_read_b128 v[236:239], v14 offset:3296
    v_and_b32_dpp v174, v174, v15 row_shr:1 row_mask:0xf bank_mask:0xf bound_ctrl:0
    v_and_b32_dpp v175, v175, v15 row_shr:1 row_mask:0xf bank_mask:0xf bound_ctrl:0
    v_mfma_f32_32x32x16_bf16 v[128:143], v[176:179], v[32:35], v[128:143]
    s_nop 4
    v_mfma_f32_32x32x16_bf16 v[128:143], v[180:183], v[36:39], v[128:143]
    s_nop 4
    v_mfma_f32_32x32x16_bf16 v[128:143], v[184:187], v[40:43], v[128:143]
    v_mov_b32_dpp v144, v144 row_shr:1 row_mask:0xf bank_mask:0xf bound_ctrl:0
    v_mov_b32_dpp v145, v145 row_shr:1 row_mask:0xf bank_mask:0xf bound_ctrl:0
    v_mov_b32_dpp v146, v146 row_shr:1 row_mask:0xf bank_mask:0xf bound_ctrl:0
    v_mfma_f32_32x32x16_bf16 v[128:143], v[188:191], v[44:47], v[128:143]
    v_mov_b32_dpp v147, v147 row_shr:1 row_mask:0xf bank_mask:0xf bound_ctrl:0
    v_mov_b32_dpp v148, v148 row_shr:1 row_mask:0xf bank_mask:0xf bound_ctrl:0
    v_mov_b32_dpp v149, v149 row_shr:1 row_mask:0xf bank_mask:0xf bound_ctrl:0
    v_mfma_f32_32x32x16_bf16 v[128:143], v[192:195], v[48:51], v[128:143]
    v_mov_b32_dpp v150, v150 row_shr:1 row_mask:0xf bank_mask:0xf bound_ctrl:0
    v_mov_b32_dpp v151, v151 row_shr:1 row_mask:0xf bank_mask:0xf bound_ctrl:0
    v_mov_b32_dpp v152, v152 row_shr:1 row_mask:0xf bank_mask:0xf bound_ctrl:0
    v_mfma_f32_32x32x16_bf16 v[128:143], v[196:199], v[52:55], v[128:143]
    v_mov_b32_dpp v153, v153 row_shr:1 row_mask:0xf bank_mask:0xf bound_ctrl:0
    v_mov_b32_dpp v154, v154 row_shr:1 row_mask:0xf bank_mask:0xf bound_ctrl:0
    v_mov_b32_dpp v155, v155 row_shr:1 row_mask:0xf bank_mask:0xf bound_ctrl:0
    v_mfma_f32_32x32x16_bf16 v[128:143], v[200:203], v[56:59], v[128:143]
    v_mov_b32_dpp v156, v156 row_shr:1 row_mask:0xf bank_mask:0xf bound_ctrl:0
    v_mov_b32_dpp v157, v157 row_shr:1 row_mask:0xf bank_mask:0xf bound_ctrl:0
    v_mfma_f32_32x32x16_bf16 v[128:143], v[204:207], v[60:63], v[128:143]
    v_mov_b32_dpp v158, v158 row_shr:1 row_mask:0xf bank_mask:0xf bound_ctrl:0
    v_mov_b32_dpp v159, v159 row_shr:1 row_mask:0xf bank_mask:0xf bound_ctrl:0
    s_waitcnt lgkmcnt(0)
    v_mfma_f32_32x32x16_bf16 v[160:175], v[208:211], v[96:99], v[160:175]
    ds_read_b128 v[176:179], v14 offset:768
    ds_read_b128 v[180:183], v14 offset:800
    s_nop 2
    v_mfma_f32_32x32x16_bf16 v[160:175], v[212:215], v[100:103], v[160:175]
    ds_read_b128 v[184:187], v14 offset:832
    ds_read_b128 v[188:191], v14 offset:864
    s_nop 2
    v_mfma_f32_32x32x16_bf16 v[160:175], v[216:219], v[104:107], v[160:175]
    ds_read_b128 v[192:195], v14 offset:896
    ds_read_b128 v[196:199], v14 offset:928
    v_mov_b32_dpp v128, v128 row_shr:1 row_mask:0xf bank_mask:0xf bound_ctrl:0
    v_mov_b32_dpp v129, v129 row_shr:1 row_mask:0xf bank_mask:0xf bound_ctrl:0
    v_mov_b32_dpp v130, v130 row_shr:1 row_mask:0xf bank_mask:0xf bound_ctrl:0
    v_mfma_f32_32x32x16_bf16 v[160:175], v[220:223], v[108:111], v[160:175]
    ds_read_b128 v[200:203], v14 offset:960
    v_mov_b32_dpp v131, v131 row_shr:1 row_mask:0xf bank_mask:0xf bound_ctrl:0
    v_mov_b32_dpp v132, v132 row_shr:1 row_mask:0xf bank_mask:0xf bound_ctrl:0
    v_mov_b32_dpp v133, v133 row_shr:1 row_mask:0xf bank_mask:0xf bound_ctrl:0
    v_mfma_f32_32x32x16_bf16 v[160:175], v[224:227], v[112:115], v[160:175]
    ds_read_b128 v[204:207], v14 offset:992
    v_mov_b32_dpp v134, v134 row_shr:1 row_mask:0xf bank_mask:0xf bound_ctrl:0
    v_mov_b32_dpp v135, v135 row_shr:1 row_mask:0xf bank_mask:0xf bound_ctrl:0
    v_mov_b32_dpp v136, v136 row_shr:1 row_mask:0xf bank_mask:0xf bound_ctrl:0
    v_mfma_f32_32x32x16_bf16 v[160:175], v[228:231], v[116:119], v[160:175]
    v_mov_b32_dpp v137, v137 row_shr:1 row_mask:0xf bank_mask:0xf bound_ctrl:0
    v_mov_b32_dpp v138, v138 row_shr:1 row_mask:0xf bank_mask:0xf bound_ctrl:0
    v_mov_b32_dpp v139, v139 row_shr:1 row_mask:0xf bank_mask:0xf bound_ctrl:0
    v_mfma_f32_32x32x16_bf16 v[160:175], v[232:235], v[120:123], v[160:175]
    v_mov_b32_dpp v140, v140 row_shr:1 row_mask:0xf bank_mask:0xf bound_ctrl:0
    v_mov_b32_dpp v141, v141 row_shr:1 row_mask:0xf bank_mask:0xf bound_ctrl:0
    v_mfma_f32_32x32x16_bf16 v[160:175], v[236:239], v[124:127], v[160:175]
    v_mov_b32_dpp v142, v142 row_shr:1 row_mask:0xf bank_mask:0xf bound_ctrl:0
    v_mov_b32_dpp v143, v143 row_shr:1 row_mask:0xf bank_mask:0xf bound_ctrl:0
    s_waitcnt lgkmcnt(0)
    v_mfma_f32_32x32x16_bf16 v[144:159], v[176:179], v[64:67], v[144:159]
    ds_read_b128 v[208:211], v14 offset:2816
    s_nop 3
    v_mfma_f32_32x32x16_bf16 v[144:159], v[180:183], v[68:71], v[144:159]
    ds_read_b128 v[212:215], v14 offset:2848
    s_nop 3
    v_mfma_f32_32x32x16_bf16 v[144:159], v[184:187], v[72:75], v[144:159]
    ds_read_b128 v[216:219], v14 offset:2880
    v_and_b32_dpp v160, v160, v15 row_shr:1 row_mask:0xf bank_mask:0xf bound_ctrl:0
    v_and_b32_dpp v161, v161, v15 row_shr:1 row_mask:0xf bank_mask:0xf bound_ctrl:0
    v_and_b32_dpp v162, v162, v15 row_shr:1 row_mask:0xf bank_mask:0xf bound_ctrl:0
    v_mfma_f32_32x32x16_bf16 v[144:159], v[188:191], v[76:79], v[144:159]
    ds_read_b128 v[220:223], v14 offset:2912
    v_and_b32_dpp v163, v163, v15 row_shr:1 row_mask:0xf bank_mask:0xf bound_ctrl:0
    v_and_b32_dpp v164, v164, v15 row_shr:1 row_mask:0xf bank_mask:0xf bound_ctrl:0
    v_and_b32_dpp v165, v165, v15 row_shr:1 row_mask:0xf bank_mask:0xf bound_ctrl:0
    v_mfma_f32_32x32x16_bf16 v[144:159], v[192:195], v[80:83], v[144:159]
    ds_read_b128 v[224:227], v14 offset:2944
    v_and_b32_dpp v166, v166, v15 row_shr:1 row_mask:0xf bank_mask:0xf bound_ctrl:0
    v_and_b32_dpp v167, v167, v15 row_shr:1 row_mask:0xf bank_mask:0xf bound_ctrl:0
    v_and_b32_dpp v168, v168, v15 row_shr:1 row_mask:0xf bank_mask:0xf bound_ctrl:0
    v_mfma_f32_32x32x16_bf16 v[144:159], v[196:199], v[84:87], v[144:159]
    ds_read_b128 v[228:231], v14 offset:2976
    v_and_b32_dpp v169, v169, v15 row_shr:1 row_mask:0xf bank_mask:0xf bound_ctrl:0
    v_and_b32_dpp v170, v170, v15 row_shr:1 row_mask:0xf bank_mask:0xf bound_ctrl:0
    v_and_b32_dpp v171, v171, v15 row_shr:1 row_mask:0xf bank_mask:0xf bound_ctrl:0
    v_mfma_f32_32x32x16_bf16 v[144:159], v[200:203], v[88:91], v[144:159]
    ds_read_b128 v[232:235], v14 offset:3008
    v_and_b32_dpp v172, v172, v15 row_shr:1 row_mask:0xf bank_mask:0xf bound_ctrl:0
    v_and_b32_dpp v173, v173, v15 row_shr:1 row_mask:0xf bank_mask:0xf bound_ctrl:0
    v_mfma_f32_32x32x16_bf16 v[144:159], v[204:207], v[92:95], v[144:159]
    ds_read_b128 v[236:239], v14 offset:3040
    v_and_b32_dpp v174, v174, v15 row_shr:1 row_mask:0xf bank_mask:0xf bound_ctrl:0
    v_and_b32_dpp v175, v175, v15 row_shr:1 row_mask:0xf bank_mask:0xf bound_ctrl:0
    v_mfma_f32_32x32x16_bf16 v[128:143], v[176:179], v[32:35], v[128:143]
    s_nop 4
    v_mfma_f32_32x32x16_bf16 v[128:143], v[180:183], v[36:39], v[128:143]
    s_nop 4
    v_mfma_f32_32x32x16_bf16 v[128:143], v[184:187], v[40:43], v[128:143]
    v_mov_b32_dpp v144, v144 row_shr:1 row_mask:0xf bank_mask:0xf bound_ctrl:0
    v_mov_b32_dpp v145, v145 row_shr:1 row_mask:0xf bank_mask:0xf bound_ctrl:0
    v_mov_b32_dpp v146, v146 row_shr:1 row_mask:0xf bank_mask:0xf bound_ctrl:0
    v_mfma_f32_32x32x16_bf16 v[128:143], v[188:191], v[44:47], v[128:143]
    v_mov_b32_dpp v147, v147 row_shr:1 row_mask:0xf bank_mask:0xf bound_ctrl:0
    v_mov_b32_dpp v148, v148 row_shr:1 row_mask:0xf bank_mask:0xf bound_ctrl:0
    v_mov_b32_dpp v149, v149 row_shr:1 row_mask:0xf bank_mask:0xf bound_ctrl:0
    v_mfma_f32_32x32x16_bf16 v[128:143], v[192:195], v[48:51], v[128:143]
    v_mov_b32_dpp v150, v150 row_shr:1 row_mask:0xf bank_mask:0xf bound_ctrl:0
    v_mov_b32_dpp v151, v151 row_shr:1 row_mask:0xf bank_mask:0xf bound_ctrl:0
    v_mov_b32_dpp v152, v152 row_shr:1 row_mask:0xf bank_mask:0xf bound_ctrl:0
    v_mfma_f32_32x32x16_bf16 v[128:143], v[196:199], v[52:55], v[128:143]
    v_mov_b32_dpp v153, v153 row_shr:1 row_mask:0xf bank_mask:0xf bound_ctrl:0
    v_mov_b32_dpp v154, v154 row_shr:1 row_mask:0xf bank_mask:0xf bound_ctrl:0
    v_mov_b32_dpp v155, v155 row_shr:1 row_mask:0xf bank_mask:0xf bound_ctrl:0
    v_mfma_f32_32x32x16_bf16 v[128:143], v[200:203], v[56:59], v[128:143]
    v_mov_b32_dpp v156, v156 row_shr:1 row_mask:0xf bank_mask:0xf bound_ctrl:0
    v_mov_b32_dpp v157, v157 row_shr:1 row_mask:0xf bank_mask:0xf bound_ctrl:0
    v_mfma_f32_32x32x16_bf16 v[128:143], v[204:207], v[60:63], v[128:143]
    v_mov_b32_dpp v158, v158 row_shr:1 row_mask:0xf bank_mask:0xf bound_ctrl:0
    v_mov_b32_dpp v159, v159 row_shr:1 row_mask:0xf bank_mask:0xf bound_ctrl:0
    s_waitcnt lgkmcnt(0)
    v_mfma_f32_32x32x16_bf16 v[160:175], v[208:211], v[96:99], v[160:175]
    ds_read_b128 v[176:179], v14 offset:512
    ds_read_b128 v[180:183], v14 offset:544
    s_nop 2
    v_mfma_f32_32x32x16_bf16 v[160:175], v[212:215], v[100:103], v[160:175]
    ds_read_b128 v[184:187], v14 offset:576
    ds_read_b128 v[188:191], v14 offset:608
    s_nop 2
    v_mfma_f32_32x32x16_bf16 v[160:175], v[216:219], v[104:107], v[160:175]
    ds_read_b128 v[192:195], v14 offset:640
    ds_read_b128 v[196:199], v14 offset:672
    v_mov_b32_dpp v128, v128 row_shr:1 row_mask:0xf bank_mask:0xf bound_ctrl:0
    v_mov_b32_dpp v129, v129 row_shr:1 row_mask:0xf bank_mask:0xf bound_ctrl:0
    v_mov_b32_dpp v130, v130 row_shr:1 row_mask:0xf bank_mask:0xf bound_ctrl:0
    v_mfma_f32_32x32x16_bf16 v[160:175], v[220:223], v[108:111], v[160:175]
    ds_read_b128 v[200:203], v14 offset:704
    v_mov_b32_dpp v131, v131 row_shr:1 row_mask:0xf bank_mask:0xf bound_ctrl:0
    v_mov_b32_dpp v132, v132 row_shr:1 row_mask:0xf bank_mask:0xf bound_ctrl:0
    v_mov_b32_dpp v133, v133 row_shr:1 row_mask:0xf bank_mask:0xf bound_ctrl:0
    v_mfma_f32_32x32x16_bf16 v[160:175], v[224:227], v[112:115], v[160:175]
    ds_read_b128 v[204:207], v14 offset:736
    v_mov_b32_dpp v134, v134 row_shr:1 row_mask:0xf bank_mask:0xf bound_ctrl:0
    v_mov_b32_dpp v135, v135 row_shr:1 row_mask:0xf bank_mask:0xf bound_ctrl:0
    v_mov_b32_dpp v136, v136 row_shr:1 row_mask:0xf bank_mask:0xf bound_ctrl:0
    v_mfma_f32_32x32x16_bf16 v[160:175], v[228:231], v[116:119], v[160:175]
    v_mov_b32_dpp v137, v137 row_shr:1 row_mask:0xf bank_mask:0xf bound_ctrl:0
    v_mov_b32_dpp v138, v138 row_shr:1 row_mask:0xf bank_mask:0xf bound_ctrl:0
    v_mov_b32_dpp v139, v139 row_shr:1 row_mask:0xf bank_mask:0xf bound_ctrl:0
    v_mfma_f32_32x32x16_bf16 v[160:175], v[232:235], v[120:123], v[160:175]
    v_mov_b32_dpp v140, v140 row_shr:1 row_mask:0xf bank_mask:0xf bound_ctrl:0
    v_mov_b32_dpp v141, v141 row_shr:1 row_mask:0xf bank_mask:0xf bound_ctrl:0
    v_mfma_f32_32x32x16_bf16 v[160:175], v[236:239], v[124:127], v[160:175]
    v_mov_b32_dpp v142, v142 row_shr:1 row_mask:0xf bank_mask:0xf bound_ctrl:0
    v_mov_b32_dpp v143, v143 row_shr:1 row_mask:0xf bank_mask:0xf bound_ctrl:0
    s_lshr_b32 s40, s2, 4
    s_lshl_b32 s40, s40, 9
    s_add_u32 s40, s40, 29700096
    s_mov_b32 s41, 29683712
    v_lshrrev_b32 v16, 2, v1
    v_mul_u32_u24 v16, 5120, v16
    v_and_b32 v17, 3, v1
    v_lshl_add_u32 v16, v17, 7, v16
    v_lshlrev_b32 v18, 7, v1
    v_mov_b32 v17, s46
    s_add_u32 s42, s41, 8192
    buffer_load_dword v19, v18, s[28:31], s41 offen sc1
    buffer_load_dword v28, v18, s[28:31], s42 offen sc1
    s_mov_b64 exec, 0xfff
    buffer_load_dword v17, v16, s[28:31], s40 offen sc1
    s_mov_b64 exec, -1
    s_waitcnt lgkmcnt(0)
    v_mfma_f32_32x32x16_bf16 v[144:159], v[176:179], v[64:67], v[144:159]
    ds_read_b128 v[208:211], v14 offset:2560
    s_nop 3
    v_mfma_f32_32x32x16_bf16 v[144:159], v[180:183], v[68:71], v[144:159]
    ds_read_b128 v[212:215], v14 offset:2592
    s_nop 3
    v_mfma_f32_32x32x16_bf16 v[144:159], v[184:187], v[72:75], v[144:159]
    ds_read_b128 v[216:219], v14 offset:2624
    v_and_b32_dpp v160, v160, v15 row_shr:1 row_mask:0xf bank_mask:0xf bound_ctrl:0
    v_and_b32_dpp v161, v161, v15 row_shr:1 row_mask:0xf bank_mask:0xf bound_ctrl:0
    v_and_b32_dpp v162, v162, v15 row_shr:1 row_mask:0xf bank_mask:0xf bound_ctrl:0
    v_mfma_f32_32x32x16_bf16 v[144:159], v[188:191], v[76:79], v[144:159]
    ds_read_b128 v[220:223], v14 offset:2656
    v_and_b32_dpp v163, v163, v15 row_shr:1 row_mask:0xf bank_mask:0xf bound_ctrl:0
    v_and_b32_dpp v164, v164, v15 row_shr:1 row_mask:0xf bank_mask:0xf bound_ctrl:0
    v_and_b32_dpp v165, v165, v15 row_shr:1 row_mask:0xf bank_mask:0xf bound_ctrl:0
    v_mfma_f32_32x32x16_bf16 v[144:159], v[192:195], v[80:83], v[144:159]
    ds_read_b128 v[224:227], v14 offset:2688
    v_and_b32_dpp v166, v166, v15 row_shr:1 row_mask:0xf bank_mask:0xf bound_ctrl:0
    v_and_b32_dpp v167, v167, v15 row_shr:1 row_mask:0xf bank_mask:0xf bound_ctrl:0
    v_and_b32_dpp v168, v168, v15 row_shr:1 row_mask:0xf bank_mask:0xf bound_ctrl:0
    v_mfma_f32_32x32x16_bf16 v[144:159], v[196:199], v[84:87], v[144:159]
    ds_read_b128 v[228:231], v14 offset:2720
    v_and_b32_dpp v169, v169, v15 row_shr:1 row_mask:0xf bank_mask:0xf bound_ctrl:0
    v_and_b32_dpp v170, v170, v15 row_shr:1 row_mask:0xf bank_mask:0xf bound_ctrl:0
    v_and_b32_dpp v171, v171, v15 row_shr:1 row_mask:0xf bank_mask:0xf bound_ctrl:0
    v_mfma_f32_32x32x16_bf16 v[144:159], v[200:203], v[88:91], v[144:159]
    ds_read_b128 v[232:235], v14 offset:2752
    v_and_b32_dpp v172, v172, v15 row_shr:1 row_mask:0xf bank_mask:0xf bound_ctrl:0
    v_and_b32_dpp v173, v173, v15 row_shr:1 row_mask:0xf bank_mask:0xf bound_ctrl:0
    v_mfma_f32_32x32x16_bf16 v[144:159], v[204:207], v[92:95], v[144:159]
    ds_read_b128 v[236:239], v14 offset:2784
    v_and_b32_dpp v174, v174, v15 row_shr:1 row_mask:0xf bank_mask:0xf bound_ctrl:0
    v_and_b32_dpp v175, v175, v15 row_shr:1 row_mask:0xf bank_mask:0xf bound_ctrl:0
    v_mfma_f32_32x32x16_bf16 v[128:143], v[176:179], v[32:35], v[128:143]
    s_nop 4
    v_mfma_f32_32x32x16_bf16 v[128:143], v[180:183], v[36:39], v[128:143]
    s_nop 4
    v_mfma_f32_32x32x16_bf16 v[128:143], v[184:187], v[40:43], v[128:143]
    v_mov_b32_dpp v144, v144 row_shr:1 row_mask:0xf bank_mask:0xf bound_ctrl:0
    v_mov_b32_dpp v145, v145 row_shr:1 row_mask:0xf bank_mask:0xf bound_ctrl:0
    v_mov_b32_dpp v146, v146 row_shr:1 row_mask:0xf bank_mask:0xf bound_ctrl:0
    v_mfma_f32_32x32x16_bf16 v[128:143], v[188:191], v[44:47], v[128:143]
    v_mov_b32_dpp v147, v147 row_shr:1 row_mask:0xf bank_mask:0xf bound_ctrl:0
    v_mov_b32_dpp v148, v148 row_shr:1 row_mask:0xf bank_mask:0xf bound_ctrl:0
    v_mov_b32_dpp v149, v149 row_shr:1 row_mask:0xf bank_mask:0xf bound_ctrl:0
    v_mfma_f32_32x32x16_bf16 v[128:143], v[192:195], v[48:51], v[128:143]
    v_mov_b32_dpp v150, v150 row_shr:1 row_mask:0xf bank_mask:0xf bound_ctrl:0
    v_mov_b32_dpp v151, v151 row_shr:1 row_mask:0xf bank_mask:0xf bound_ctrl:0
    v_mov_b32_dpp v152, v152 row_shr:1 row_mask:0xf bank_mask:0xf bound_ctrl:0
    v_mfma_f32_32x32x16_bf16 v[128:143], v[196:199], v[52:55], v[128:143]
    v_mov_b32_dpp v153, v153 row_shr:1 row_mask:0xf bank_mask:0xf bound_ctrl:0
    v_mov_b32_dpp v154, v154 row_shr:1 row_mask:0xf bank_mask:0xf bound_ctrl:0
    v_mov_b32_dpp v155, v155 row_shr:1 row_mask:0xf bank_mask:0xf bound_ctrl:0
    v_mfma_f32_32x32x16_bf16 v[128:143], v[200:203], v[56:59], v[128:143]
    v_mov_b32_dpp v156, v156 row_shr:1 row_mask:0xf bank_mask:0xf bound_ctrl:0
    v_mov_b32_dpp v157, v157 row_shr:1 row_mask:0xf bank_mask:0xf bound_ctrl:0
    v_mfma_f32_32x32x16_bf16 v[128:143], v[204:207], v[60:63], v[128:143]
    v_mov_b32_dpp v158, v158 row_shr:1 row_mask:0xf bank_mask:0xf bound_ctrl:0
    v_mov_b32_dpp v159, v159 row_shr:1 row_mask:0xf bank_mask:0xf bound_ctrl:0
    s_waitcnt lgkmcnt(0)
    v_mfma_f32_32x32x16_bf16 v[160:175], v[208:211], v[96:99], v[160:175]
    ds_read_b128 v[176:179], v14 offset:256
    ds_read_b128 v[180:183], v14 offset:288
    s_nop 2
    v_mfma_f32_32x32x16_bf16 v[160:175], v[212:215], v[100:103], v[160:175]
    ds_read_b128 v[184:187], v14 offset:320
    ds_read_b128 v[188:191], v14 offset:352
    s_nop 2
    v_mfma_f32_32x32x16_bf16 v[160:175], v[216:219], v[104:107], v[160:175]
    ds_read_b128 v[192:195], v14 offset:384
    ds_read_b128 v[196:199], v14 offset:416
    v_mov_b32_dpp v128, v128 row_shr:1 row_mask:0xf bank_mask:0xf bound_ctrl:0
    v_mov_b32_dpp v129, v129 row_shr:1 row_mask:0xf bank_mask:0xf bound_ctrl:0
    v_mov_b32_dpp v130, v130 row_shr:1 row_mask:0xf bank_mask:0xf bound_ctrl:0
    v_mfma_f32_32x32x16_bf16 v[160:175], v[220:223], v[108:111], v[160:175]
    ds_read_b128 v[200:203], v14 offset:448
    v_mov_b32_dpp v131, v131 row_shr:1 row_mask:0xf bank_mask:0xf bound_ctrl:0
    v_mov_b32_dpp v132, v132 row_shr:1 row_mask:0xf bank_mask:0xf bound_ctrl:0
    v_mov_b32_dpp v133, v133 row_shr:1 row_mask:0xf bank_mask:0xf bound_ctrl:0
    v_mfma_f32_32x32x16_bf16 v[160:175], v[224:227], v[112:115], v[160:175]
    ds_read_b128 v[204:207], v14 offset:480
    v_mov_b32_dpp v134, v134 row_shr:1 row_mask:0xf bank_mask:0xf bound_ctrl:0
    v_mov_b32_dpp v135, v135 row_shr:1 row_mask:0xf bank_mask:0xf bound_ctrl:0
    v_mov_b32_dpp v136, v136 row_shr:1 row_mask:0xf bank_mask:0xf bound_ctrl:0
    v_mfma_f32_32x32x16_bf16 v[160:175], v[228:231], v[116:119], v[160:175]
    v_mov_b32_dpp v137, v137 row_shr:1 row_mask:0xf bank_mask:0xf bound_ctrl:0
    v_mov_b32_dpp v138, v138 row_shr:1 row_mask:0xf bank_mask:0xf bound_ctrl:0
    v_mov_b32_dpp v139, v139 row_shr:1 row_mask:0xf bank_mask:0xf bound_ctrl:0
    v_mfma_f32_32x32x16_bf16 v[160:175], v[232:235], v[120:123], v[160:175]
    v_mov_b32_dpp v140, v140 row_shr:1 row_mask:0xf bank_mask:0xf bound_ctrl:0
    v_mov_b32_dpp v141, v141 row_shr:1 row_mask:0xf bank_mask:0xf bound_ctrl:0
    v_mfma_f32_32x32x16_bf16 v[160:175], v[236:239], v[124:127], v[160:175]
    v_mov_b32_dpp v142, v142 row_shr:1 row_mask:0xf bank_mask:0xf bound_ctrl:0
    v_mov_b32_dpp v143, v143 row_shr:1 row_mask:0xf bank_mask:0xf bound_ctrl:0
    s_mov_b32 s47, 0
prep_kernel_mp17:
    s_waitcnt vmcnt(0)
    v_cmp_ne_u32 vcc, s46, v17
    v_cmp_ne_u32 s[66:67], s46, v19
    v_cmp_ne_u32 s[68:69], s46, v28
    s_add_u32 s47, s47, 1
    s_nop 2
    s_or_b64 vcc, vcc, s[66:67]
    s_or_b64 vcc, vcc, s[68:69]
    s_cmp_ge_u32 s47, 20000
    s_cbranch_scc1 prep_kernel_md18
    s_cbranch_vccz prep_kernel_md18
    buffer_load_dword v19, v18, s[28:31], s41 offen sc1
    buffer_load_dword v28, v18, s[28:31], s42 offen sc1
    s_mov_b64 exec, 0xfff
    buffer_load_dword v17, v16, s[28:31], s40 offen sc1
    s_mov_b64 exec, -1
    s_branch prep_kernel_mp17
prep_kernel_md18:
    s_lshl_b32 s40, s2, 4
    s_add_u32 s40, s40, 2793472
    v_lshrrev_b32 v16, 2, v1
    v_mul_u32_u24 v16, 2560, v16
    v_and_b32 v17, 3, v1
    v_mul_u32_u24 v17, 15360, v17
    v_add_u32 v16, v16, v17
    v_lshlrev_b32 v18, 4, v1
    s_mov_b64 exec, 0xfff
    buffer_load_dwordx4 v[20:23], v16, s[28:31], s40 offen sc1
    s_mov_b64 exec, -1
    s_lshl_b32 s39, s20, 10
    s_add_u32 m0, s39, 71680
    s_add_u32 s39, s39, 5476352
    buffer_load_dwordx4 v18, s[28:31], s39 offen sc1 lds
    s_lshl_b32 s39, s20, 10
    s_add_u32 m0, s39, 55296
    s_add_u32 s39, s38, 2854912
    buffer_load_dwordx4 v4, s[28:31], s39 offen sc1 lds
    s_lshl_b32 s39, s20, 10
    s_add_u32 m0, s39, 75776
    s_add_u32 s39, s39, 5480448
    buffer_load_dwordx4 v18, s[28:31], s39 offen sc1 lds
    s_lshl_b32 s39, s20, 10
    s_add_u32 m0, s39, 59392
    s_add_u32 s39, s38, 3510272
    buffer_load_dwordx4 v4, s[28:31], s39 offen sc1 lds
    s_lshl_b32 s39, s20, 10
    s_add_u32 m0, s39, 79872
    s_add_u32 s39, s39, 5484544
    buffer_load_dwordx4 v18, s[28:31], s39 offen sc1 lds
    s_lshl_b32 s39, s20, 10
    s_add_u32 m0, s39, 63488
    s_add_u32 s39, s38, 4165632
    buffer_load_dwordx4 v4, s[28:31], s39 offen sc1 lds
    s_lshl_b32 s39, s20, 10
    s_add_u32 m0, s39, 83968
    s_add_u32 s39, s39, 5488640
    buffer_load_dwordx4 v18, s[28:31], s39 offen sc1 lds
    s_lshl_b32 s39, s20, 10
    s_add_u32 m0, s39, 67584
    s_add_u32 s39, s38, 4820992
    buffer_load_dwordx4 v4, s[28:31], s39 offen sc1 lds
    s_waitcnt lgkmcnt(0)
    v_mfma_f32_32x32x16_bf16 v[144:159], v[176:179], v[64:67], v[144:159]
    ds_read_b128 v[208:211], v14 offset:2304
    s_nop 3
    v_mfma_f32_32x32x16_bf16 v[144:159], v[180:183], v[68:71], v[144:159]
    ds_read_b128 v[212:215], v14 offset:2336
    s_nop 3
    v_mfma_f32_32x32x16_bf16 v[144:159], v[184:187], v[72:75], v[144:159]
    ds_read_b128 v[216:219], v14 offset:2368
    v_and_b32_dpp v160, v160, v15 row_shr:1 row_mask:0xf bank_mask:0xf bound_ctrl:0
    v_and_b32_dpp v161, v161, v15 row_shr:1 row_mask:0xf bank_mask:0xf bound_ctrl:0
    v_and_b32_dpp v162, v162, v15 row_shr:1 row_mask:0xf bank_mask:0xf bound_ctrl:0
    v_mfma_f32_32x32x16_bf16 v[144:159], v[188:191], v[76:79], v[144:159]
    ds_read_b128 v[220:223], v14 offset:2400
    v_and_b32_dpp v163, v163, v15 row_shr:1 row_mask:0xf bank_mask:0xf bound_ctrl:0
    v_and_b32_dpp v164, v164, v15 row_shr:1 row_mask:0xf bank_mask:0xf bound_ctrl:0
    v_and_b32_dpp v165, v165, v15 row_shr:1 row_mask:0xf bank_mask:0xf bound_ctrl:0
    v_mfma_f32_32x32x16_bf16 v[144:159], v[192:195], v[80:83], v[144:159]
    ds_read_b128 v[224:227], v14 offset:2432
    v_and_b32_dpp v166, v166, v15 row_shr:1 row_mask:0xf bank_mask:0xf bound_ctrl:0
    v_and_b32_dpp v167, v167, v15 row_shr:1 row_mask:0xf bank_mask:0xf bound_ctrl:0
    v_and_b32_dpp v168, v168, v15 row_shr:1 row_mask:0xf bank_mask:0xf bound_ctrl:0
    v_mfma_f32_32x32x16_bf16 v[144:159], v[196:199], v[84:87], v[144:159]
    ds_read_b128 v[228:231], v14 offset:2464
    v_and_b32_dpp v169, v169, v15 row_shr:1 row_mask:0xf bank_mask:0xf bound_ctrl:0
    v_and_b32_dpp v170, v170, v15 row_shr:1 row_mask:0xf bank_mask:0xf bound_ctrl:0
    v_and_b32_dpp v171, v171, v15 row_shr:1 row_mask:0xf bank_mask:0xf bound_ctrl:0
    v_mfma_f32_32x32x16_bf16 v[144:159], v[200:203], v[88:91], v[144:159]
    ds_read_b128 v[232:235], v14 offset:2496
    v_and_b32_dpp v172, v172, v15 row_shr:1 row_mask:0xf bank_mask:0xf bound_ctrl:0
    v_and_b32_dpp v173, v173, v15 row_shr:1 row_mask:0xf bank_mask:0xf bound_ctrl:0
    v_mfma_f32_32x32x16_bf16 v[144:159], v[204:207], v[92:95], v[144:159]
    ds_read_b128 v[236:239], v14 offset:2528
    v_and_b32_dpp v174, v174, v15 row_shr:1 row_mask:0xf bank_mask:0xf bound_ctrl:0
    v_and_b32_dpp v175, v175, v15 row_shr:1 row_mask:0xf bank_mask:0xf bound_ctrl:0
    v_mfma_f32_32x32x16_bf16 v[128:143], v[176:179], v[32:35], v[128:143]
    s_nop 4
    v_mfma_f32_32x32x16_bf16 v[128:143], v[180:183], v[36:39], v[128:143]
    s_nop 4
    v_mfma_f32_32x32x16_bf16 v[128:143], v[184:187], v[40:43], v[128:143]
    v_mov_b32_dpp v144, v144 row_shr:1 row_mask:0xf bank_mask:0xf bound_ctrl:0
    v_mov_b32_dpp v145, v145 row_shr:1 row_mask:0xf bank_mask:0xf bound_ctrl:0
    v_mov_b32_dpp v146, v146 row_shr:1 row_mask:0xf bank_mask:0xf bound_ctrl:0
    v_mfma_f32_32x32x16_bf16 v[128:143], v[188:191], v[44:47], v[128:143]
    v_mov_b32_dpp v147, v147 row_shr:1 row_mask:0xf bank_mask:0xf bound_ctrl:0
    v_mov_b32_dpp v148, v148 row_shr:1 row_mask:0xf bank_mask:0xf bound_ctrl:0
    v_mov_b32_dpp v149, v149 row_shr:1 row_mask:0xf bank_mask:0xf bound_ctrl:0
    v_mfma_f32_32x32x16_bf16 v[128:143], v[192:195], v[48:51], v[128:143]
    v_mov_b32_dpp v150, v150 row_shr:1 row_mask:0xf bank_mask:0xf bound_ctrl:0
    v_mov_b32_dpp v151, v151 row_shr:1 row_mask:0xf bank_mask:0xf bound_ctrl:0
    v_mov_b32_dpp v152, v152 row_shr:1 row_mask:0xf bank_mask:0xf bound_ctrl:0
    v_mfma_f32_32x32x16_bf16 v[128:143], v[196:199], v[52:55], v[128:143]
    v_mov_b32_dpp v153, v153 row_shr:1 row_mask:0xf bank_mask:0xf bound_ctrl:0
    v_mov_b32_dpp v154, v154 row_shr:1 row_mask:0xf bank_mask:0xf bound_ctrl:0
    v_mov_b32_dpp v155, v155 row_shr:1 row_mask:0xf bank_mask:0xf bound_ctrl:0
    v_mfma_f32_32x32x16_bf16 v[128:143], v[200:203], v[56:59], v[128:143]
    v_mov_b32_dpp v156, v156 row_shr:1 row_mask:0xf bank_mask:0xf bound_ctrl:0
    v_mov_b32_dpp v157, v157 row_shr:1 row_mask:0xf bank_mask:0xf bound_ctrl:0
    v_mfma_f32_32x32x16_bf16 v[128:143], v[204:207], v[60:63], v[128:143]
    v_mov_b32_dpp v158, v158 row_shr:1 row_mask:0xf bank_mask:0xf bound_ctrl:0
    v_mov_b32_dpp v159, v159 row_shr:1 row_mask:0xf bank_mask:0xf bound_ctrl:0
    s_waitcnt lgkmcnt(0)
    v_mfma_f32_32x32x16_bf16 v[160:175], v[208:211], v[96:99], v[160:175]
    ds_read_b128 v[176:179], v14 offset:0
    ds_read_b128 v[180:183], v14 offset:32
    s_nop 2
    v_mfma_f32_32x32x16_bf16 v[160:175], v[212:215], v[100:103], v[160:175]
    ds_read_b128 v[184:187], v14 offset:64
    ds_read_b128 v[188:191], v14 offset:96
    s_nop 2
    v_mfma_f32_32x32x16_bf16 v[160:175], v[216:219], v[104:107], v[160:175]
    ds_read_b128 v[192:195], v14 offset:128
    ds_read_b128 v[196:199], v14 offset:160
    v_mov_b32_dpp v128, v128 row_shr:1 row_mask:0xf bank_mask:0xf bound_ctrl:0
    v_mov_b32_dpp v129, v129 row_shr:1 row_mask:0xf bank_mask:0xf bound_ctrl:0
    v_mov_b32_dpp v130, v130 row_shr:1 row_mask:0xf bank_mask:0xf bound_ctrl:0
    v_mfma_f32_32x32x16_bf16 v[160:175], v[220:223], v[108:111], v[160:175]
    ds_read_b128 v[200:203], v14 offset:192
    v_mov_b32_dpp v131, v131 row_shr:1 row_mask:0xf bank_mask:0xf bound_ctrl:0
    v_mov_b32_dpp v132, v132 row_shr:1 row_mask:0xf bank_mask:0xf bound_ctrl:0
    v_mov_b32_dpp v133, v133 row_shr:1 row_mask:0xf bank_mask:0xf bound_ctrl:0
    v_mfma_f32_32x32x16_bf16 v[160:175], v[224:227], v[112:115], v[160:175]
    ds_read_b128 v[204:207], v14 offset:224
    v_mov_b32_dpp v134, v134 row_shr:1 row_mask:0xf bank_mask:0xf bound_ctrl:0
    v_mov_b32_dpp v135, v135 row_shr:1 row_mask:0xf bank_mask:0xf bound_ctrl:0
    v_mov_b32_dpp v136, v136 row_shr:1 row_mask:0xf bank_mask:0xf bound_ctrl:0
    v_mfma_f32_32x32x16_bf16 v[160:175], v[228:231], v[116:119], v[160:175]
    v_mov_b32_dpp v137, v137 row_shr:1 row_mask:0xf bank_mask:0xf bound_ctrl:0
    v_mov_b32_dpp v138, v138 row_shr:1 row_mask:0xf bank_mask:0xf bound_ctrl:0
    v_mov_b32_dpp v139, v139 row_shr:1 row_mask:0xf bank_mask:0xf bound_ctrl:0
    v_mfma_f32_32x32x16_bf16 v[160:175], v[232:235], v[120:123], v[160:175]
    v_mov_b32_dpp v140, v140 row_shr:1 row_mask:0xf bank_mask:0xf bound_ctrl:0
    v_mov_b32_dpp v141, v141 row_shr:1 row_mask:0xf bank_mask:0xf bound_ctrl:0
    v_mfma_f32_32x32x16_bf16 v[160:175], v[236:239], v[124:127], v[160:175]
    v_mov_b32_dpp v142, v142 row_shr:1 row_mask:0xf bank_mask:0xf bound_ctrl:0
    v_mov_b32_dpp v143, v143 row_shr:1 row_mask:0xf bank_mask:0xf bound_ctrl:0
    s_waitcnt lgkmcnt(0)
    v_mfma_f32_32x32x16_bf16 v[144:159], v[176:179], v[64:67], v[144:159]
    ds_read_b128 v[208:211], v14 offset:2048
    s_nop 3
    v_mfma_f32_32x32x16_bf16 v[144:159], v[180:183], v[68:71], v[144:159]
    ds_read_b128 v[212:215], v14 offset:2080
    s_nop 3
    v_mfma_f32_32x32x16_bf16 v[144:159], v[184:187], v[72:75], v[144:159]
    ds_read_b128 v[216:219], v14 offset:2112
    v_and_b32_dpp v160, v160, v15 row_shr:1 row_mask:0xf bank_mask:0xf bound_ctrl:0
    v_and_b32_dpp v161, v161, v15 row_shr:1 row_mask:0xf bank_mask:0xf bound_ctrl:0
    v_and_b32_dpp v162, v162, v15 row_shr:1 row_mask:0xf bank_mask:0xf bound_ctrl:0
    v_mfma_f32_32x32x16_bf16 v[144:159], v[188:191], v[76:79], v[144:159]
    ds_read_b128 v[220:223], v14 offset:2144
    v_and_b32_dpp v163, v163, v15 row_shr:1 row_mask:0xf bank_mask:0xf bound_ctrl:0
    v_and_b32_dpp v164, v164, v15 row_shr:1 row_mask:0xf bank_mask:0xf bound_ctrl:0
    v_and_b32_dpp v165, v165, v15 row_shr:1 row_mask:0xf bank_mask:0xf bound_ctrl:0
    v_mfma_f32_32x32x16_bf16 v[144:159], v[192:195], v[80:83], v[144:159]
    ds_read_b128 v[224:227], v14 offset:2176
    v_and_b32_dpp v166, v166, v15 row_shr:1 row_mask:0xf bank_mask:0xf bound_ctrl:0
    v_and_b32_dpp v167, v167, v15 row_shr:1 row_mask:0xf bank_mask:0xf bound_ctrl:0
    v_and_b32_dpp v168, v168, v15 row_shr:1 row_mask:0xf bank_mask:0xf bound_ctrl:0
    v_mfma_f32_32x32x16_bf16 v[144:159], v[196:199], v[84:87], v[144:159]
    ds_read_b128 v[228:231], v14 offset:2208
    v_and_b32_dpp v169, v169, v15 row_shr:1 row_mask:0xf bank_mask:0xf bound_ctrl:0
    v_and_b32_dpp v170, v170, v15 row_shr:1 row_mask:0xf bank_mask:0xf bound_ctrl:0
    v_and_b32_dpp v171, v171, v15 row_shr:1 row_mask:0xf bank_mask:0xf bound_ctrl:0
    v_mfma_f32_32x32x16_bf16 v[144:159], v[200:203], v[88:91], v[144:159]
    ds_read_b128 v[232:235], v14 offset:2240
    v_and_b32_dpp v172, v172, v15 row_shr:1 row_mask:0xf bank_mask:0xf bound_ctrl:0
    v_and_b32_dpp v173, v173, v15 row_shr:1 row_mask:0xf bank_mask:0xf bound_ctrl:0
    v_mfma_f32_32x32x16_bf16 v[144:159], v[204:207], v[92:95], v[144:159]
    ds_read_b128 v[236:239], v14 offset:2272
    v_and_b32_dpp v174, v174, v15 row_shr:1 row_mask:0xf bank_mask:0xf bound_ctrl:0
    v_and_b32_dpp v175, v175, v15 row_shr:1 row_mask:0xf bank_mask:0xf bound_ctrl:0
    v_mfma_f32_32x32x16_bf16 v[128:143], v[176:179], v[32:35], v[128:143]
    v_mfma_f32_32x32x16_bf16 v[128:143], v[180:183], v[36:39], v[128:143]
    v_mfma_f32_32x32x16_bf16 v[128:143], v[184:187], v[40:43], v[128:143]
    v_mfma_f32_32x32x16_bf16 v[128:143], v[188:191], v[44:47], v[128:143]
    v_mfma_f32_32x32x16_bf16 v[128:143], v[192:195], v[48:51], v[128:143]
    v_mfma_f32_32x32x16_bf16 v[128:143], v[196:199], v[52:55], v[128:143]
    v_mfma_f32_32x32x16_bf16 v[128:143], v[200:203], v[56:59], v[128:143]
    v_mfma_f32_32x32x16_bf16 v[128:143], v[204:207], v[60:63], v[128:143]
    s_waitcnt lgkmcnt(0)
    v_mfma_f32_32x32x16_bf16 v[160:175], v[208:211], v[96:99], v[160:175]
    v_mfma_f32_32x32x16_bf16 v[160:175], v[212:215], v[100:103], v[160:175]
    v_mfma_f32_32x32x16_bf16 v[160:175], v[216:219], v[104:107], v[160:175]
    v_mfma_f32_32x32x16_bf16 v[160:175], v[220:223], v[108:111], v[160:175]
    v_mfma_f32_32x32x16_bf16 v[160:175], v[224:227], v[112:115], v[160:175]
    v_mfma_f32_32x32x16_bf16 v[160:175], v[228:231], v[116:119], v[160:175]
    v_mfma_f32_32x32x16_bf16 v[160:175], v[232:235], v[120:123], v[160:175]
    v_mfma_f32_32x32x16_bf16 v[160:175], v[236:239], v[124:127], v[160:175]
    s_nop 11
    v_add_f32_dpp v128, v160, v128 row_shr:8 row_mask:0xf bank_mask:0xf bound_ctrl:0
    v_add_f32_dpp v129, v161, v129 row_shr:8 row_mask:0xf bank_mask:0xf bound_ctrl:0
    v_add_f32_dpp v130, v162, v130 row_shr:8 row_mask:0xf bank_mask:0xf bound_ctrl:0
    v_add_f32_dpp v131, v163, v131 row_shr:8 row_mask:0xf bank_mask:0xf bound_ctrl:0
    v_add_f32_dpp v132, v164, v132 row_shr:8 row_mask:0xf bank_mask:0xf bound_ctrl:0
    v_add_f32_dpp v133, v165, v133 row_shr:8 row_mask:0xf bank_mask:0xf bound_ctrl:0
    v_add_f32_dpp v134, v166, v134 row_shr:8 row_mask:0xf bank_mask:0xf bound_ctrl:0
    v_add_f32_dpp v135, v167, v135 row_shr:8 row_mask:0xf bank_mask:0xf bound_ctrl:0
    v_add_f32_dpp v136, v168, v136 row_shr:8 row_mask:0xf bank_mask:0xf bound_ctrl:0
    v_add_f32_dpp v137, v169, v137 row_shr:8 row_mask:0xf bank_mask:0xf bound_ctrl:0
    v_add_f32_dpp v138, v170, v138 row_shr:8 row_mask:0xf bank_mask:0xf bound_ctrl:0
    v_add_f32_dpp v139, v171, v139 row_shr:8 row_mask:0xf bank_mask:0xf bound_ctrl:0
    v_add_f32_dpp v140, v172, v140 row_shr:8 row_mask:0xf bank_mask:0xf bound_ctrl:0
    v_add_f32_dpp v141, v173, v141 row_shr:8 row_mask:0xf bank_mask:0xf bound_ctrl:0
    v_add_f32_dpp v142, v174, v142 row_shr:8 row_mask:0xf bank_mask:0xf bound_ctrl:0
    v_add_f32_dpp v143, v175, v143 row_shr:8 row_mask:0xf bank_mask:0xf bound_ctrl:0
    s_mov_b32 s42, 0xff00ff00
    s_mov_b32 s43, 0xff00ff00
    s_mov_b64 exec, s[42:43]
    v_add_f32 v144, v160, v144
    v_add_f32 v145, v161, v145
    v_add_f32 v146, v162, v146
    v_add_f32 v147, v163, v147
    v_add_f32 v148, v164, v148
    v_add_f32 v149, v165, v149
    v_add_f32 v150, v166, v150
    v_add_f32 v151, v167, v151
    v_add_f32 v152, v168, v152
    v_add_f32 v153, v169, v153
    v_add_f32 v154, v170, v154
    v_add_f32 v155, v171, v155
    v_add_f32 v156, v172, v156
    v_add_f32 v157, v173, v157
    v_add_f32 v158, v174, v158
    v_add_f32 v159, v175, v159
    s_mov_b64 exec, -1
    v_mul_u32_u24 v16, 264, v7
    v_lshl_add_u32 v16, v9, 5, v16
    v_lshl_add_u32 v16, v8, 2, v16
    v_add_u32 v16, s34, v16
    v_cvt_pk_bf16_f32 v32, v128, v144
    v_cvt_pk_bf16_f32 v33, v129, v145
    v_cvt_pk_bf16_f32 v34, v130, v146
    v_cvt_pk_bf16_f32 v35, v131, v147
    v_cvt_pk_bf16_f32 v36, v132, v148
    v_cvt_pk_bf16_f32 v37, v133, v149
    v_cvt_pk_bf16_f32 v38, v134, v150
    v_cvt_pk_bf16_f32 v39, v135, v151
    v_cvt_pk_bf16_f32 v40, v136, v152
    v_cvt_pk_bf16_f32 v41, v137, v153
    v_cvt_pk_bf16_f32 v42, v138, v154
    v_cvt_pk_bf16_f32 v43, v139, v155
    v_cvt_pk_bf16_f32 v44, v140, v156
    v_cvt_pk_bf16_f32 v45, v141, v157
    v_cvt_pk_bf16_f32 v46, v142, v158
    v_cvt_pk_bf16_f32 v47, v143, v159
    ds_write_b32 v16, v32 offset:0
    ds_write_b32 v16, v33 offset:8
    ds_write_b32 v16, v34 offset:16
    ds_write_b32 v16, v35 offset:24
    ds_write_b32 v16, v36 offset:64
    ds_write_b32 v16, v37 offset:72
    ds_write_b32 v16, v38 offset:80
    ds_write_b32 v16, v39 offset:88
    ds_write_b32 v16, v40 offset:128
    ds_write_b32 v16, v41 offset:136
    ds_write_b32 v16, v42 offset:144
    ds_write_b32 v16, v43 offset:152
    ds_write_b32 v16, v44 offset:192
    ds_write_b32 v16, v45 offset:200
    ds_write_b32 v16, v46 offset:208
    ds_write_b32 v16, v47 offset:216
    s_lshl_b32 s44, s32, 16
    s_and_b32 s45, s32, 0xffff0000
    s_lshl_b32 s46, s33, 16
    s_and_b32 s47, s33, 0xffff0000
    v_mul_u32_u24 v17, 264, v2
    v_lshl_add_u32 v17, v1, 2, v17
    s_waitcnt lgkmcnt(0)
    s_barrier
    v_mul_u32_u24 v19, 272, v2
    v_lshlrev_b32 v18, 2, v1
    v_sub_u32 v19, v19, v18
    v_add_u32 v19, 4604, v19
    ds_read_b32 v48, v17 offset:0
    ds_read_b32 v49, v17 offset:13824
    ds_read_b32 v50, v17 offset:27648
    ds_read_b32 v51, v17 offset:41472
    ds_read_b32 v52, v17 offset:1056
    ds_read_b32 v53, v17 offset:14880
    ds_read_b32 v54, v17 offset:28704
    ds_read_b32 v55, v17 offset:42528
    ds_read_b32 v56, v17 offset:2112
    ds_read_b32 v57, v17 offset:15936
    ds_read_b32 v58, v17 offset:29760
    ds_read_b32 v59, v17 offset:43584
    ds_read_b32 v60, v17 offset:3168
    ds_read_b32 v61, v17 offset:16992
    ds_read_b32 v62, v17 offset:30816
    ds_read_b32 v63, v17 offset:44640
    s_waitcnt lgkmcnt(0)
    ds_read_b32 v224, v19 offset:0
    ds_read_b32 v225, v19 offset:13824
    ds_read_b32 v226, v19 offset:27648
    ds_read_b32 v227, v19 offset:41472
    ds_read_b32 v228, v19 offset:1088
    ds_read_b32 v229, v19 offset:14912
    ds_read_b32 v230, v19 offset:28736
    ds_read_b32 v231, v19 offset:42560
    ds_read_b32 v232, v19 offset:2176
    ds_read_b32 v233, v19 offset:16000
    ds_read_b32 v234, v19 offset:29824
    ds_read_b32 v235, v19 offset:43648
    ds_read_b32 v236, v19 offset:3264
    ds_read_b32 v237, v19 offset:17088
    ds_read_b32 v238, v19 offset:30912
    ds_read_b32 v239, v19 offset:44736
    v_mov_b32 v28, s44
    v_mov_b32 v29, s45
    v_mov_b32 v30, s46
    v_mov_b32 v31, s47
    s_waitcnt vmcnt(0)
    v_lshlrev_b32 v18, 4, v0
    v_add_u32 v18, 55296, v18
    s_waitcnt lgkmcnt(0)
    ds_read_b128 v[176:179], v18 offset:0
    ds_read_b128 v[144:147], v18 offset:16384
    ds_read_b128 v[180:183], v18 offset:4096
    ds_read_b128 v[148:151], v18 offset:20480
    ds_read_b128 v[184:187], v18 offset:8192
    ds_read_b128 v[152:155], v18 offset:24576
    ds_read_b128 v[188:191], v18 offset:12288
    ds_read_b128 v[156:159], v18 offset:28672
    s_nop 1
    v_add_f32_dpp v20, v20, v20 quad_perm:[1,0,3,2] row_mask:0xf bank_mask:0xf
    v_add_f32_dpp v21, v21, v21 quad_perm:[1,0,3,2] row_mask:0xf bank_mask:0xf
    v_add_f32_dpp v22, v22, v22 quad_perm:[1,0,3,2] row_mask:0xf bank_mask:0xf
    v_add_f32_dpp v23, v23, v23 quad_perm:[1,0,3,2] row_mask:0xf bank_mask:0xf
    s_nop 1
    v_add_f32_dpp v20, v20, v20 quad_perm:[2,3,0,1] row_mask:0xf bank_mask:0xf
    v_add_f32_dpp v21, v21, v21 quad_perm:[2,3,0,1] row_mask:0xf bank_mask:0xf
    v_add_f32_dpp v22, v22, v22 quad_perm:[2,3,0,1] row_mask:0xf bank_mask:0xf
    v_add_f32_dpp v23, v23, v23 quad_perm:[2,3,0,1] row_mask:0xf bank_mask:0xf
    s_nop 1
    v_cvt_pk_bf16_f32 v24, v20, v21
    v_lshlrev_b32 v20, 16, v24
    v_and_b32 v21, 0xffff0000, v24
    v_cvt_pk_bf16_f32 v24, v22, v23
    v_lshlrev_b32 v22, 16, v24
    v_and_b32 v23, 0xffff0000, v24
    v_add_f32 v24, 1.0, v20
    v_add_f32 v25, 1.0, v21
    v_add_f32 v26, 1.0, v22
    v_add_f32 v27, 1.0, v23
    v_cvt_pk_bf16_f32 v10, v24, v25
    v_lshlrev_b32 v24, 16, v10
    v_and_b32 v25, 0xffff0000, v10
    v_cvt_pk_bf16_f32 v10, v26, v27
    v_lshlrev_b32 v26, 16, v10
    v_and_b32 v27, 0xffff0000, v10
    s_nop 1
    v_readlane_b32 s68, v20, 0
    v_readlane_b32 s72, v24, 4
    v_readlane_b32 s76, v20, 8
    v_readlane_b32 s69, v21, 0
    v_readlane_b32 s73, v25, 4
    v_readlane_b32 s77, v21, 8
    v_readlane_b32 s70, v22, 0
    v_readlane_b32 s74, v26, 4
    v_readlane_b32 s78, v22, 8
    v_readlane_b32 s71, v23, 0
    v_readlane_b32 s75, v27, 4
    v_readlane_b32 s79, v23, 8
    s_nop 1
    v_mov_b32 v10, s76
    v_mov_b32 v11, s77
    v_mov_b32 v12, s78
    v_mov_b32 v13, s79
    v_mul_f32 v160, s72, v10
    v_mul_f32 v164, s68, v10
    v_mul_f32 v161, s73, v11
    v_mul_f32 v165, s69, v11
    v_mul_f32 v162, s74, v12
    v_mul_f32 v166, s70, v12
    v_mul_f32 v163, s75, v13
    v_mul_f32 v167, s71, v13
    s_waitcnt lgkmcnt(0)
    v_lshlrev_b32 v68, 16, v224
    v_and_b32 v64, 0xffff0000, v224
    v_lshlrev_b32 v69, 16, v225
    v_and_b32 v65, 0xffff0000, v225
    v_lshlrev_b32 v70, 16, v226
    v_and_b32 v66, 0xffff0000, v226
    v_lshlrev_b32 v71, 16, v227
    v_and_b32 v67, 0xffff0000, v227
    v_lshlrev_b32 v74, 16, v48
    v_and_b32 v78, 0xffff0000, v48
    v_lshlrev_b32 v75, 16, v49
    v_and_b32 v79, 0xffff0000, v49
    v_lshlrev_b32 v76, 16, v50
    v_and_b32 v80, 0xffff0000, v50
    v_lshlrev_b32 v77, 16, v51
    v_and_b32 v81, 0xffff0000, v51
    v_lshlrev_b32 v112, 16, v176
    v_and_b32 v113, 0xffff0000, v176
    v_lshlrev_b32 v114, 16, v177
    v_and_b32 v115, 0xffff0000, v177
    v_lshlrev_b32 v116, 16, v178
    v_and_b32 v117, 0xffff0000, v178
    v_lshlrev_b32 v118, 16, v179
    v_and_b32 v119, 0xffff0000, v179
    v_pk_fma_f32 v[64:65], v[64:65], v[28:29], v[74:75]
    v_pk_fma_f32 v[66:67], v[66:67], v[30:31], v[76:77]
    v_pk_fma_f32 v[68:69], v[68:69], v[28:29], v[78:79]
    v_pk_fma_f32 v[70:71], v[70:71], v[30:31], v[80:81]
    v_pk_fma_f32 v[120:121], v[112:113], v[144:145], v[144:145] op_sel:[0,1,0] op_sel_hi:[1,1,0]
    v_pk_fma_f32 v[122:123], v[114:115], v[144:145], v[144:145] op_sel:[0,1,0] op_sel_hi:[1,1,0]
    v_pk_fma_f32 v[124:125], v[116:117], v[146:147], v[146:147] op_sel:[0,1,0] op_sel_hi:[1,1,0]
    v_pk_fma_f32 v[126:127], v[118:119], v[146:147], v[146:147] op_sel:[0,1,0] op_sel_hi:[1,1,0]
    v_pk_fma_f32 v[120:121], v[120:121], v[160:161], v[164:165]
    v_pk_fma_f32 v[122:123], v[122:123], v[162:163], v[166:167]
    v_pk_fma_f32 v[124:125], v[124:125], v[160:161], v[164:165]
    v_pk_fma_f32 v[126:127], v[126:127], v[162:163], v[166:167]
    v_pk_fma_f32 v[64:65], v[64:65], v[120:121], v[112:113]
    v_pk_fma_f32 v[66:67], v[66:67], v[122:123], v[114:115]
    v_pk_fma_f32 v[68:69], v[68:69], v[124:125], v[116:117]
    v_pk_fma_f32 v[70:71], v[70:71], v[126:127], v[118:119]
    v_cvt_pk_bf16_f32 v96, v64, v65
    v_cvt_pk_bf16_f32 v97, v66, v67
    v_cvt_pk_bf16_f32 v98, v68, v69
    v_cvt_pk_bf16_f32 v99, v70, v71
    v_lshlrev_b32 v68, 16, v228
    v_and_b32 v64, 0xffff0000, v228
    v_lshlrev_b32 v69, 16, v229
    v_and_b32 v65, 0xffff0000, v229
    v_lshlrev_b32 v70, 16, v230
    v_and_b32 v66, 0xffff0000, v230
    v_lshlrev_b32 v71, 16, v231
    v_and_b32 v67, 0xffff0000, v231
    v_lshlrev_b32 v74, 16, v52
    v_and_b32 v78, 0xffff0000, v52
    v_lshlrev_b32 v75, 16, v53
    v_and_b32 v79, 0xffff0000, v53
    v_lshlrev_b32 v76, 16, v54
    v_and_b32 v80, 0xffff0000, v54
    v_lshlrev_b32 v77, 16, v55
    v_and_b32 v81, 0xffff0000, v55
    v_lshlrev_b32 v112, 16, v180
    v_and_b32 v113, 0xffff0000, v180
    v_lshlrev_b32 v114, 16, v181
    v_and_b32 v115, 0xffff0000, v181
    v_lshlrev_b32 v116, 16, v182
    v_and_b32 v117, 0xffff0000, v182
    v_lshlrev_b32 v118, 16, v183
    v_and_b32 v119, 0xffff0000, v183
    v_pk_fma_f32 v[64:65], v[64:65], v[28:29], v[74:75]
    v_pk_fma_f32 v[66:67], v[66:67], v[30:31], v[76:77]
    v_pk_fma_f32 v[68:69], v[68:69], v[28:29], v[78:79]
    v_pk_fma_f32 v[70:71], v[70:71], v[30:31], v[80:81]
    v_pk_fma_f32 v[120:121], v[112:113], v[148:149], v[148:149] op_sel:[0,1,0] op_sel_hi:[1,1,0]
    v_pk_fma_f32 v[122:123], v[114:115], v[148:149], v[148:149] op_sel:[0,1,0] op_sel_hi:[1,1,0]
    v_pk_fma_f32 v[124:125], v[116:117], v[150:151], v[150:151] op_sel:[0,1,0] op_sel_hi:[1,1,0]
    v_pk_fma_f32 v[126:127], v[118:119], v[150:151], v[150:151] op_sel:[0,1,0] op_sel_hi:[1,1,0]
    v_pk_fma_f32 v[120:121], v[120:121], v[160:161], v[164:165]
    v_pk_fma_f32 v[122:123], v[122:123], v[162:163], v[166:167]
    v_pk_fma_f32 v[124:125], v[124:125], v[160:161], v[164:165]
    v_pk_fma_f32 v[126:127], v[126:127], v[162:163], v[166:167]
    v_pk_fma_f32 v[64:65], v[64:65], v[120:121], v[112:113]
    v_pk_fma_f32 v[66:67], v[66:67], v[122:123], v[114:115]
    v_pk_fma_f32 v[68:69], v[68:69], v[124:125], v[116:117]
    v_pk_fma_f32 v[70:71], v[70:71], v[126:127], v[118:119]
    v_cvt_pk_bf16_f32 v100, v64, v65
    v_cvt_pk_bf16_f32 v101, v66, v67
    v_cvt_pk_bf16_f32 v102, v68, v69
    v_cvt_pk_bf16_f32 v103, v70, v71
    v_lshlrev_b32 v68, 16, v232
    v_and_b32 v64, 0xffff0000, v232
    v_lshlrev_b32 v69, 16, v233
    v_and_b32 v65, 0xffff0000, v233
    v_lshlrev_b32 v70, 16, v234
    v_and_b32 v66, 0xffff0000, v234
    v_lshlrev_b32 v71, 16, v235
    v_and_b32 v67, 0xffff0000, v235
    v_lshlrev_b32 v74, 16, v56
    v_and_b32 v78, 0xffff0000, v56
    v_lshlrev_b32 v75, 16, v57
    v_and_b32 v79, 0xffff0000, v57
    v_lshlrev_b32 v76, 16, v58
    v_and_b32 v80, 0xffff0000, v58
    v_lshlrev_b32 v77, 16, v59
    v_and_b32 v81, 0xffff0000, v59
    v_lshlrev_b32 v112, 16, v184
    v_and_b32 v113, 0xffff0000, v184
    v_lshlrev_b32 v114, 16, v185
    v_and_b32 v115, 0xffff0000, v185
    v_lshlrev_b32 v116, 16, v186
    v_and_b32 v117, 0xffff0000, v186
    v_lshlrev_b32 v118, 16, v187
    v_and_b32 v119, 0xffff0000, v187
    v_pk_fma_f32 v[64:65], v[64:65], v[28:29], v[74:75]
    v_pk_fma_f32 v[66:67], v[66:67], v[30:31], v[76:77]
    v_pk_fma_f32 v[68:69], v[68:69], v[28:29], v[78:79]
    v_pk_fma_f32 v[70:71], v[70:71], v[30:31], v[80:81]
    v_pk_fma_f32 v[120:121], v[112:113], v[152:153], v[152:153] op_sel:[0,1,0] op_sel_hi:[1,1,0]
    v_pk_fma_f32 v[122:123], v[114:115], v[152:153], v[152:153] op_sel:[0,1,0] op_sel_hi:[1,1,0]
    v_pk_fma_f32 v[124:125], v[116:117], v[154:155], v[154:155] op_sel:[0,1,0] op_sel_hi:[1,1,0]
    v_pk_fma_f32 v[126:127], v[118:119], v[154:155], v[154:155] op_sel:[0,1,0] op_sel_hi:[1,1,0]
    v_pk_fma_f32 v[120:121], v[120:121], v[160:161], v[164:165]
    v_pk_fma_f32 v[122:123], v[122:123], v[162:163], v[166:167]
    v_pk_fma_f32 v[124:125], v[124:125], v[160:161], v[164:165]
    v_pk_fma_f32 v[126:127], v[126:127], v[162:163], v[166:167]
    v_pk_fma_f32 v[64:65], v[64:65], v[120:121], v[112:113]
    v_pk_fma_f32 v[66:67], v[66:67], v[122:123], v[114:115]
    v_pk_fma_f32 v[68:69], v[68:69], v[124:125], v[116:117]
    v_pk_fma_f32 v[70:71], v[70:71], v[126:127], v[118:119]
    v_cvt_pk_bf16_f32 v104, v64, v65
    v_cvt_pk_bf16_f32 v105, v66, v67
    v_cvt_pk_bf16_f32 v106, v68, v69
    v_cvt_pk_bf16_f32 v107, v70, v71
    v_lshlrev_b32 v68, 16, v236
    v_and_b32 v64, 0xffff0000, v236
    v_lshlrev_b32 v69, 16, v237
    v_and_b32 v65, 0xffff0000, v237
    v_lshlrev_b32 v70, 16, v238
    v_and_b32 v66, 0xffff0000, v238
    v_lshlrev_b32 v71, 16, v239
    v_and_b32 v67, 0xffff0000, v239
    v_lshlrev_b32 v74, 16, v60
    v_and_b32 v78, 0xffff0000, v60
    v_lshlrev_b32 v75, 16, v61
    v_and_b32 v79, 0xffff0000, v61
    v_lshlrev_b32 v76, 16, v62
    v_and_b32 v80, 0xffff0000, v62
    v_lshlrev_b32 v77, 16, v63
    v_and_b32 v81, 0xffff0000, v63
    v_lshlrev_b32 v112, 16, v188
    v_and_b32 v113, 0xffff0000, v188
    v_lshlrev_b32 v114, 16, v189
    v_and_b32 v115, 0xffff0000, v189
    v_lshlrev_b32 v116, 16, v190
    v_and_b32 v117, 0xffff0000, v190
    v_lshlrev_b32 v118, 16, v191
    v_and_b32 v119, 0xffff0000, v191
    v_pk_fma_f32 v[64:65], v[64:65], v[28:29], v[74:75]
    v_pk_fma_f32 v[66:67], v[66:67], v[30:31], v[76:77]
    v_pk_fma_f32 v[68:69], v[68:69], v[28:29], v[78:79]
    v_pk_fma_f32 v[70:71], v[70:71], v[30:31], v[80:81]
    v_pk_fma_f32 v[120:121], v[112:113], v[156:157], v[156:157] op_sel:[0,1,0] op_sel_hi:[1,1,0]
    v_pk_fma_f32 v[122:123], v[114:115], v[156:157], v[156:157] op_sel:[0,1,0] op_sel_hi:[1,1,0]
    v_pk_fma_f32 v[124:125], v[116:117], v[158:159], v[158:159] op_sel:[0,1,0] op_sel_hi:[1,1,0]
    v_pk_fma_f32 v[126:127], v[118:119], v[158:159], v[158:159] op_sel:[0,1,0] op_sel_hi:[1,1,0]
    v_pk_fma_f32 v[120:121], v[120:121], v[160:161], v[164:165]
    v_pk_fma_f32 v[122:123], v[122:123], v[162:163], v[166:167]
    v_pk_fma_f32 v[124:125], v[124:125], v[160:161], v[164:165]
    v_pk_fma_f32 v[126:127], v[126:127], v[162:163], v[166:167]
    v_pk_fma_f32 v[64:65], v[64:65], v[120:121], v[112:113]
    v_pk_fma_f32 v[66:67], v[66:67], v[122:123], v[114:115]
    v_pk_fma_f32 v[68:69], v[68:69], v[124:125], v[116:117]
    v_pk_fma_f32 v[70:71], v[70:71], v[126:127], v[118:119]
    v_cvt_pk_bf16_f32 v108, v64, v65
    v_cvt_pk_bf16_f32 v109, v66, v67
    v_cvt_pk_bf16_f32 v110, v68, v69
    v_cvt_pk_bf16_f32 v111, v70, v71
    s_add_u32 s39, s38, 5492736
    buffer_store_dwordx4 v[96:99], v4, s[28:31], s39 offen sc1
    s_add_u32 s39, s39, 655360
    buffer_store_dwordx4 v[100:103], v4, s[28:31], s39 offen sc1
    s_add_u32 s39, s39, 655360
    buffer_store_dwordx4 v[104:107], v4, s[28:31], s39 offen sc1
    s_add_u32 s39, s39, 655360
    buffer_store_dwordx4 v[108:111], v4, s[28:31], s39 offen sc1
    s_add_u32 s39, s39, 655360
    s_waitcnt vmcnt(0)
    s_endpgm
p_pack:
    s_sub_u32 s21, s2, 416
    s_mul_i32 s34, s20, 13824
    s_cmp_ge_u32 s20, 4
    s_cbranch_scc1 prep_end
    s_cmp_eq_u32 s20, 0
    s_cbranch_scc1 k1_pack
    s_cmp_eq_u32 s20, 1
    s_cbranch_scc0 p_pk2
    s_cmp_lt_u32 s21, 58
    s_cbranch_scc0 p_pk1
    s_add_u32 s21, s21, 96
    s_branch k1_pack
p_pk1:
    s_sub_u32 s21, s21, 58
    s_cmp_ge_u32 s21, 30
    s_cbranch_scc1 prep_end
    s_branch p_fin
p_pk2:
    s_sub_u32 s22, s20, 2
    s_mul_i32 s22, s22, 96
    s_add_u32 s21, s21, s22
    s_cmp_ge_u32 s21, 120
    s_cbranch_scc1 prep_end
    s_add_u32 s21, s21, 120
    v_mov_b32 v251, 0
    buffer_load_dword v250, v251, s[48:51], 0 offen sc1
    s_branch p_mod
p_fin:
    s_add_u32 s21, s21, 30
    v_mov_b32 v16, 0
    buffer_load_dword v17, v16, s[48:51], 0 offen sc1
    s_waitcnt vmcnt(0)
    s_mov_b32 s47, 0
prep_kernel_nn19:
    v_readfirstlane_b32 s46, v17
    s_add_u32 s47, s47, 1
    s_cmp_lg_u32 s46, 0
    s_cbranch_scc1 prep_kernel_nd20
    s_cmp_ge_u32 s47, 20000
    s_cbranch_scc1 prep_kernel_nd20
    buffer_load_dword v17, v16, s[48:51], 0 offen sc1
    s_waitcnt vmcnt(0)
    s_branch prep_kernel_nn19
prep_kernel_nd20:
    s_lshl_b32 s40, s21, 9
    s_add_u32 s40, s40, 29700096
    v_lshlrev_b32 v16, 7, v1
    s_mov_b32 s47, 0
    s_mov_b64 exec, 15
prep_kernel_pl21:
    buffer_load_dword v17, v16, s[28:31], s40 offen sc1
    s_add_u32 s47, s47, 1
    s_waitcnt vmcnt(0)
    v_cmp_ne_u32 vcc, s46, v17
    s_cmp_ge_u32 s47, 20000
    s_cbranch_scc1 prep_kernel_pd22
    s_cbranch_vccz prep_kernel_pd22
    s_sleep 8
    s_branch prep_kernel_pl21
prep_kernel_pd22:
    s_mov_b64 exec, -1
    v_lshlrev_b32 v7, 2, v1
    s_lshl_b32 s22, s21, 8
    s_add_u32 s23, s22, 2793472
    buffer_load_dword v10, v7, s[28:31], s23 offen sc1
    s_add_u32 s23, s23, 15360
    buffer_load_dword v11, v7, s[28:31], s23 offen sc1
    s_add_u32 s23, s23, 15360
    buffer_load_dword v12, v7, s[28:31], s23 offen sc1
    s_add_u32 s23, s23, 15360
    buffer_load_dword v13, v7, s[28:31], s23 offen sc1
    s_waitcnt vmcnt(0)
    v_add_f32 v10, v10, v11
    v_add_f32 v12, v12, v13
    s_nop 0
    v_add_f32 v10, v10, v12
    s_nop 0
    v_cvt_pk_bf16_f32 v10, v10, v10
    s_nop 0
    v_lshlrev_b32 v10, 16, v10
    s_sub_u32 s24, s21, 10
    s_cmp_lt_u32 s24, 10
    s_cbranch_scc1 prep_kernel_f123
    s_sub_u32 s24, s21, 40
    s_cmp_lt_u32 s24, 10
    s_cbranch_scc0 prep_kernel_f224
prep_kernel_f123:
    v_add_f32 v10, 1.0, v10
    s_nop 0
    v_cvt_pk_bf16_f32 v10, v10, v10
    s_nop 0
    v_lshlrev_b32 v10, 16, v10
prep_kernel_f224:
    s_add_u32 s22, s22, 8114176
    buffer_store_dword v10, v7, s[28:31], s22 offen sc1
    s_endpgm
k1_pack:
    v_lshrrev_b32 v3, 3, v1
    v_and_b32 v4, 7, v1
    v_mul_u32_u24 v5, 144, v3
    v_lshl_add_u32 v5, v4, 4, v5
    v_add_u32 v5, s34, v5
    v_and_b32 v6, 15, v1
    v_lshrrev_b32 v7, 4, v1
    v_lshrrev_b32 v8, 2, v6
    v_lshl_add_u32 v8, v7, 3, v8
    v_mul_u32_u24 v8, 144, v8
    v_and_b32 v9, 3, v6
    v_lshl_add_u32 v8, v9, 3, v8
    v_add_u32 v8, s34, v8
    v_lshlrev_b32 v9, 4, v1
    s_cmp_lt_u32 s21, 20
    s_cbranch_scc1 prep_kernel_pk25
    s_cmp_lt_u32 s21, 40
    s_cbranch_scc1 prep_kernel_pk26
    s_cmp_lt_u32 s21, 94
    s_cbranch_scc1 prep_kernel_pk27
    s_branch prep_kernel_pk28
prep_kernel_pk25:
    s_mov_b32 s24, s12
    s_mov_b32 s25, s13
    s_mov_b32 s26, 819200
    s_mov_b32 s27, 0x00020000
    s_sub_u32 s32, s21, 0
    s_mul_i32 s33, s32, 52429
    s_lshr_b32 s33, s33, 19
    s_mul_i32 s35, s33, 10
    s_sub_u32 s35, s32, s35
    v_mul_u32_u24 v10, 1280, v3
    v_lshl_add_u32 v10, v4, 4, v10
    s_mul_i32 s36, s33, 409600
    s_lshl_b32 s37, s35, 7
    s_add_u32 s36, s36, s37
    buffer_load_dwordx4 v[32:35], v10, s[24:27], s36 offen nt
    s_add_u32 s36, s36, 10240
    buffer_load_dwordx4 v[36:39], v10, s[24:27], s36 offen nt
    s_add_u32 s36, s36, 10240
    buffer_load_dwordx4 v[40:43], v10, s[24:27], s36 offen nt
    s_add_u32 s36, s36, 10240
    buffer_load_dwordx4 v[44:47], v10, s[24:27], s36 offen nt
    s_add_u32 s36, s36, 10240
    buffer_load_dwordx4 v[48:51], v10, s[24:27], s36 offen nt
    s_add_u32 s36, s36, 10240
    buffer_load_dwordx4 v[52:55], v10, s[24:27], s36 offen nt
    s_add_u32 s36, s36, 10240
    buffer_load_dwordx4 v[56:59], v10, s[24:27], s36 offen nt
    s_add_u32 s36, s36, 10240
    buffer_load_dwordx4 v[60:63], v10, s[24:27], s36 offen nt
    s_add_u32 s36, s36, 10240
    buffer_load_dwordx4 v[64:67], v10, s[24:27], s36 offen nt
    s_add_u32 s36, s36, 10240
    buffer_load_dwordx4 v[68:71], v10, s[24:27], s36 offen nt
    s_add_u32 s36, s36, 10240
    buffer_load_dwordx4 v[72:75], v10, s[24:27], s36 offen nt
    s_add_u32 s36, s36, 10240
    buffer_load_dwordx4 v[76:79], v10, s[24:27], s36 offen nt
    s_add_u32 s36, s36, 10240
    buffer_load_dwordx4 v[80:83], v10, s[24:27], s36 offen nt
    s_add_u32 s36, s36, 10240
    buffer_load_dwordx4 v[84:87], v10, s[24:27], s36 offen nt
    s_add_u32 s36, s36, 10240
    buffer_load_dwordx4 v[88:91], v10, s[24:27], s36 offen nt
    s_add_u32 s36, s36, 10240
    buffer_load_dwordx4 v[92:95], v10, s[24:27], s36 offen nt
    s_add_u32 s36, s36, 10240
    buffer_load_dwordx4 v[96:99], v10, s[24:27], s36 offen nt
    s_add_u32 s36, s36, 10240
    buffer_load_dwordx4 v[100:103], v10, s[24:27], s36 offen nt
    s_add_u32 s36, s36, 10240
    buffer_load_dwordx4 v[104:107], v10, s[24:27], s36 offen nt
    s_add_u32 s36, s36, 10240
    buffer_load_dwordx4 v[108:111], v10, s[24:27], s36 offen nt
    s_add_u32 s36, s36, 10240
    buffer_load_dwordx4 v[112:115], v10, s[24:27], s36 offen nt
    s_add_u32 s36, s36, 10240
    buffer_load_dwordx4 v[116:119], v10, s[24:27], s36 offen nt
    s_add_u32 s36, s36, 10240
    buffer_load_dwordx4 v[120:123], v10, s[24:27], s36 offen nt
    s_add_u32 s36, s36, 10240
    buffer_load_dwordx4 v[124:127], v10, s[24:27], s36 offen nt
    s_add_u32 s36, s36, 10240
    buffer_load_dwordx4 v[128:131], v10, s[24:27], s36 offen nt
    s_add_u32 s36, s36, 10240
    buffer_load_dwordx4 v[132:135], v10, s[24:27], s36 offen nt
    s_add_u32 s36, s36, 10240
    buffer_load_dwordx4 v[136:139], v10, s[24:27], s36 offen nt
    s_add_u32 s36, s36, 10240
    buffer_load_dwordx4 v[140:143], v10, s[24:27], s36 offen nt
    s_add_u32 s36, s36, 10240
    buffer_load_dwordx4 v[144:147], v10, s[24:27], s36 offen nt
    s_add_u32 s36, s36, 10240
    buffer_load_dwordx4 v[148:151], v10, s[24:27], s36 offen nt
    s_add_u32 s36, s36, 10240
    buffer_load_dwordx4 v[152:155], v10, s[24:27], s36 offen nt
    s_add_u32 s36, s36, 10240
    buffer_load_dwordx4 v[156:159], v10, s[24:27], s36 offen nt
    s_add_u32 s36, s36, 10240
    buffer_load_dwordx4 v[160:163], v10, s[24:27], s36 offen nt
    s_add_u32 s36, s36, 10240
    buffer_load_dwordx4 v[164:167], v10, s[24:27], s36 offen nt
    s_add_u32 s36, s36, 10240
    buffer_load_dwordx4 v[168:171], v10, s[24:27], s36 offen nt
    s_add_u32 s36, s36, 10240
    buffer_load_dwordx4 v[172:175], v10, s[24:27], s36 offen nt
    s_add_u32 s36, s36, 10240
    buffer_load_dwordx4 v[176:179], v10, s[24:27], s36 offen nt
    s_add_u32 s36, s36, 10240
    buffer_load_dwordx4 v[180:183], v10, s[24:27], s36 offen nt
    s_add_u32 s36, s36, 10240
    buffer_load_dwordx4 v[184:187], v10, s[24:27], s36 offen nt
    s_add_u32 s36, s36, 10240
    buffer_load_dwordx4 v[188:191], v10, s[24:27], s36 offen nt
    s_lshl_b32 s36, s35, 2
    s_add_u32 s36, s36, 0
    s_mul_i32 s38, s36, 6554
    s_lshr_b32 s38, s38, 16
    s_mul_i32 s39, s38, 10
    s_sub_u32 s39, s36, s39
    s_cmp_ge_u32 s39, 5
    s_cselect_b32 s40, 1, 0
    s_sub_u32 s41, s39, 6
    s_cmp_eq_u32 s39, 5
    s_cselect_b32 s41, 4, s41
    s_cmp_eq_u32 s40, 1
    s_cselect_b32 s39, s41, s39
    s_mul_i32 s37, s38, 200
    s_mul_i32 s40, s40, 100
    s_add_u32 s37, s37, s40
    s_mul_i32 s40, s33, 50
    s_add_u32 s37, s37, s40
    s_add_u32 s37, s37, s39
    s_lshl_b32 s37, s37, 10
    s_add_u32 s44, s37, 23236608
    s_movk_i32 s48, 5120
    s_lshl_b32 s36, s35, 2
    s_add_u32 s36, s36, 1
    s_mul_i32 s38, s36, 6554
    s_lshr_b32 s38, s38, 16
    s_mul_i32 s39, s38, 10
    s_sub_u32 s39, s36, s39
    s_cmp_ge_u32 s39, 5
    s_cselect_b32 s40, 1, 0
    s_sub_u32 s41, s39, 6
    s_cmp_eq_u32 s39, 5
    s_cselect_b32 s41, 4, s41
    s_cmp_eq_u32 s40, 1
    s_cselect_b32 s39, s41, s39
    s_mul_i32 s37, s38, 200
    s_mul_i32 s40, s40, 100
    s_add_u32 s37, s37, s40
    s_mul_i32 s40, s33, 50
    s_add_u32 s37, s37, s40
    s_add_u32 s37, s37, s39
    s_lshl_b32 s37, s37, 10
    s_add_u32 s45, s37, 23236608
    s_movk_i32 s49, 5120
    s_lshl_b32 s36, s35, 2
    s_add_u32 s36, s36, 2
    s_mul_i32 s38, s36, 6554
    s_lshr_b32 s38, s38, 16
    s_mul_i32 s39, s38, 10
    s_sub_u32 s39, s36, s39
    s_cmp_ge_u32 s39, 5
    s_cselect_b32 s40, 1, 0
    s_sub_u32 s41, s39, 6
    s_cmp_eq_u32 s39, 5
    s_cselect_b32 s41, 4, s41
    s_cmp_eq_u32 s40, 1
    s_cselect_b32 s39, s41, s39
    s_mul_i32 s37, s38, 200
    s_mul_i32 s40, s40, 100
    s_add_u32 s37, s37, s40
    s_mul_i32 s40, s33, 50
    s_add_u32 s37, s37, s40
    s_add_u32 s37, s37, s39
    s_lshl_b32 s37, s37, 10
    s_add_u32 s46, s37, 23236608
    s_movk_i32 s50, 5120
    s_lshl_b32 s36, s35, 2
    s_add_u32 s36, s36, 3
    s_mul_i32 s38, s36, 6554
    s_lshr_b32 s38, s38, 16
    s_mul_i32 s39, s38, 10
    s_sub_u32 s39, s36, s39
    s_cmp_ge_u32 s39, 5
    s_cselect_b32 s40, 1, 0
    s_sub_u32 s41, s39, 6
    s_cmp_eq_u32 s39, 5
    s_cselect_b32 s41, 4, s41
    s_cmp_eq_u32 s40, 1
    s_cselect_b32 s39, s41, s39
    s_mul_i32 s37, s38, 200
    s_mul_i32 s40, s40, 100
    s_add_u32 s37, s37, s40
    s_mul_i32 s40, s33, 50
    s_add_u32 s37, s37, s40
    s_add_u32 s37, s37, s39
    s_lshl_b32 s37, s37, 10
    s_add_u32 s47, s37, 23236608
    s_movk_i32 s51, 5120
    v_mov_b32 v12, 0
    v_mov_b32 v13, 0
    v_mov_b32 v14, 0
    v_mov_b32 v15, 0
    v_mov_b32 v16, 0x3f803f80
    s_waitcnt vmcnt(36)
    ds_write_b128 v5, v[32:35] offset:0
    ds_write_b128 v5, v[36:39] offset:1152
    ds_write_b128 v5, v[40:43] offset:2304
    ds_write_b128 v5, v[44:47] offset:3456
    s_waitcnt lgkmcnt(0)
    ds_read_b64_tr_b16 v[200:201], v8 offset:0
    ds_read_b64_tr_b16 v[202:203], v8 offset:576
    ds_read_b64_tr_b16 v[204:205], v8 offset:32
    ds_read_b64_tr_b16 v[206:207], v8 offset:608
    ds_read_b64_tr_b16 v[208:209], v8 offset:64
    ds_read_b64_tr_b16 v[210:211], v8 offset:640
    ds_read_b64_tr_b16 v[212:213], v8 offset:96
    ds_read_b64_tr_b16 v[214:215], v8 offset:672
    s_waitcnt vmcnt(32)
    ds_write_b128 v5, v[48:51] offset:4608
    ds_write_b128 v5, v[52:55] offset:5760
    ds_write_b128 v5, v[56:59] offset:6912
    ds_write_b128 v5, v[60:63] offset:8064
    s_waitcnt lgkmcnt(4)
    buffer_store_dwordx4 v[200:203], v9, s[28:31], s44 offen sc1
    s_add_u32 s44, s44, s48
    v_dot2_f32_bf16 v12, v200, v16, v12
    v_dot2_f32_bf16 v12, v201, v16, v12
    v_dot2_f32_bf16 v12, v202, v16, v12
    v_dot2_f32_bf16 v12, v203, v16, v12
    buffer_store_dwordx4 v[204:207], v9, s[28:31], s45 offen sc1
    s_add_u32 s45, s45, s49
    v_dot2_f32_bf16 v13, v204, v16, v13
    v_dot2_f32_bf16 v13, v205, v16, v13
    v_dot2_f32_bf16 v13, v206, v16, v13
    v_dot2_f32_bf16 v13, v207, v16, v13
    buffer_store_dwordx4 v[208:211], v9, s[28:31], s46 offen sc1
    s_add_u32 s46, s46, s50
    v_dot2_f32_bf16 v14, v208, v16, v14
    v_dot2_f32_bf16 v14, v209, v16, v14
    v_dot2_f32_bf16 v14, v210, v16, v14
    v_dot2_f32_bf16 v14, v211, v16, v14
    buffer_store_dwordx4 v[212:215], v9, s[28:31], s47 offen sc1
    s_add_u32 s47, s47, s51
    v_dot2_f32_bf16 v15, v212, v16, v15
    v_dot2_f32_bf16 v15, v213, v16, v15
    v_dot2_f32_bf16 v15, v214, v16, v15
    v_dot2_f32_bf16 v15, v215, v16, v15
    s_waitcnt lgkmcnt(0)
    ds_read_b64_tr_b16 v[216:217], v8 offset:4608
    ds_read_b64_tr_b16 v[218:219], v8 offset:5184
    ds_read_b64_tr_b16 v[220:221], v8 offset:4640
    ds_read_b64_tr_b16 v[222:223], v8 offset:5216
    ds_read_b64_tr_b16 v[224:225], v8 offset:4672
    ds_read_b64_tr_b16 v[226:227], v8 offset:5248
    ds_read_b64_tr_b16 v[228:229], v8 offset:4704
    ds_read_b64_tr_b16 v[230:231], v8 offset:5280
    s_waitcnt vmcnt(32)
    ds_write_b128 v5, v[64:67] offset:0
    ds_write_b128 v5, v[68:71] offset:1152
    ds_write_b128 v5, v[72:75] offset:2304
    ds_write_b128 v5, v[76:79] offset:3456
    s_waitcnt lgkmcnt(4)
    buffer_store_dwordx4 v[216:219], v9, s[28:31], s44 offen sc1
    s_add_u32 s44, s44, s48
    v_dot2_f32_bf16 v12, v216, v16, v12
    v_dot2_f32_bf16 v12, v217, v16, v12
    v_dot2_f32_bf16 v12, v218, v16, v12
    v_dot2_f32_bf16 v12, v219, v16, v12
    buffer_store_dwordx4 v[220:223], v9, s[28:31], s45 offen sc1
    s_add_u32 s45, s45, s49
    v_dot2_f32_bf16 v13, v220, v16, v13
    v_dot2_f32_bf16 v13, v221, v16, v13
    v_dot2_f32_bf16 v13, v222, v16, v13
    v_dot2_f32_bf16 v13, v223, v16, v13
    buffer_store_dwordx4 v[224:227], v9, s[28:31], s46 offen sc1
    s_add_u32 s46, s46, s50
    v_dot2_f32_bf16 v14, v224, v16, v14
    v_dot2_f32_bf16 v14, v225, v16, v14
    v_dot2_f32_bf16 v14, v226, v16, v14
    v_dot2_f32_bf16 v14, v227, v16, v14
    buffer_store_dwordx4 v[228:231], v9, s[28:31], s47 offen sc1
    s_add_u32 s47, s47, s51
    v_dot2_f32_bf16 v15, v228, v16, v15
    v_dot2_f32_bf16 v15, v229, v16, v15
    v_dot2_f32_bf16 v15, v230, v16, v15
    v_dot2_f32_bf16 v15, v231, v16, v15
    s_waitcnt lgkmcnt(0)
    ds_read_b64_tr_b16 v[200:201], v8 offset:0
    ds_read_b64_tr_b16 v[202:203], v8 offset:576
    ds_read_b64_tr_b16 v[204:205], v8 offset:32
    ds_read_b64_tr_b16 v[206:207], v8 offset:608
    ds_read_b64_tr_b16 v[208:209], v8 offset:64
    ds_read_b64_tr_b16 v[210:211], v8 offset:640
    ds_read_b64_tr_b16 v[212:213], v8 offset:96
    ds_read_b64_tr_b16 v[214:215], v8 offset:672
    s_waitcnt vmcnt(32)
    ds_write_b128 v5, v[80:83] offset:4608
    ds_write_b128 v5, v[84:87] offset:5760
    ds_write_b128 v5, v[88:91] offset:6912
    ds_write_b128 v5, v[92:95] offset:8064
    s_waitcnt lgkmcnt(4)
    buffer_store_dwordx4 v[200:203], v9, s[28:31], s44 offen sc1
    s_add_u32 s44, s44, s48
    v_dot2_f32_bf16 v12, v200, v16, v12
    v_dot2_f32_bf16 v12, v201, v16, v12
    v_dot2_f32_bf16 v12, v202, v16, v12
    v_dot2_f32_bf16 v12, v203, v16, v12
    buffer_store_dwordx4 v[204:207], v9, s[28:31], s45 offen sc1
    s_add_u32 s45, s45, s49
    v_dot2_f32_bf16 v13, v204, v16, v13
    v_dot2_f32_bf16 v13, v205, v16, v13
    v_dot2_f32_bf16 v13, v206, v16, v13
    v_dot2_f32_bf16 v13, v207, v16, v13
    buffer_store_dwordx4 v[208:211], v9, s[28:31], s46 offen sc1
    s_add_u32 s46, s46, s50
    v_dot2_f32_bf16 v14, v208, v16, v14
    v_dot2_f32_bf16 v14, v209, v16, v14
    v_dot2_f32_bf16 v14, v210, v16, v14
    v_dot2_f32_bf16 v14, v211, v16, v14
    buffer_store_dwordx4 v[212:215], v9, s[28:31], s47 offen sc1
    s_add_u32 s47, s47, s51
    v_dot2_f32_bf16 v15, v212, v16, v15
    v_dot2_f32_bf16 v15, v213, v16, v15
    v_dot2_f32_bf16 v15, v214, v16, v15
    v_dot2_f32_bf16 v15, v215, v16, v15
    s_waitcnt lgkmcnt(0)
    ds_read_b64_tr_b16 v[216:217], v8 offset:4608
    ds_read_b64_tr_b16 v[218:219], v8 offset:5184
    ds_read_b64_tr_b16 v[220:221], v8 offset:4640
    ds_read_b64_tr_b16 v[222:223], v8 offset:5216
    ds_read_b64_tr_b16 v[224:225], v8 offset:4672
    ds_read_b64_tr_b16 v[226:227], v8 offset:5248
    ds_read_b64_tr_b16 v[228:229], v8 offset:4704
    ds_read_b64_tr_b16 v[230:231], v8 offset:5280
    s_waitcnt vmcnt(32)
    ds_write_b128 v5, v[96:99] offset:0
    ds_write_b128 v5, v[100:103] offset:1152
    ds_write_b128 v5, v[104:107] offset:2304
    ds_write_b128 v5, v[108:111] offset:3456
    s_waitcnt lgkmcnt(4)
    buffer_store_dwordx4 v[216:219], v9, s[28:31], s44 offen sc1
    s_add_u32 s44, s44, s48
    v_dot2_f32_bf16 v12, v216, v16, v12
    v_dot2_f32_bf16 v12, v217, v16, v12
    v_dot2_f32_bf16 v12, v218, v16, v12
    v_dot2_f32_bf16 v12, v219, v16, v12
    buffer_store_dwordx4 v[220:223], v9, s[28:31], s45 offen sc1
    s_add_u32 s45, s45, s49
    v_dot2_f32_bf16 v13, v220, v16, v13
    v_dot2_f32_bf16 v13, v221, v16, v13
    v_dot2_f32_bf16 v13, v222, v16, v13
    v_dot2_f32_bf16 v13, v223, v16, v13
    buffer_store_dwordx4 v[224:227], v9, s[28:31], s46 offen sc1
    s_add_u32 s46, s46, s50
    v_dot2_f32_bf16 v14, v224, v16, v14
    v_dot2_f32_bf16 v14, v225, v16, v14
    v_dot2_f32_bf16 v14, v226, v16, v14
    v_dot2_f32_bf16 v14, v227, v16, v14
    buffer_store_dwordx4 v[228:231], v9, s[28:31], s47 offen sc1
    s_add_u32 s47, s47, s51
    v_dot2_f32_bf16 v15, v228, v16, v15
    v_dot2_f32_bf16 v15, v229, v16, v15
    v_dot2_f32_bf16 v15, v230, v16, v15
    v_dot2_f32_bf16 v15, v231, v16, v15
    s_waitcnt lgkmcnt(0)
    ds_read_b64_tr_b16 v[200:201], v8 offset:0
    ds_read_b64_tr_b16 v[202:203], v8 offset:576
    ds_read_b64_tr_b16 v[204:205], v8 offset:32
    ds_read_b64_tr_b16 v[206:207], v8 offset:608
    ds_read_b64_tr_b16 v[208:209], v8 offset:64
    ds_read_b64_tr_b16 v[210:211], v8 offset:640
    ds_read_b64_tr_b16 v[212:213], v8 offset:96
    ds_read_b64_tr_b16 v[214:215], v8 offset:672
    s_waitcnt vmcnt(32)
    ds_write_b128 v5, v[112:115] offset:4608
    ds_write_b128 v5, v[116:119] offset:5760
    ds_write_b128 v5, v[120:123] offset:6912
    ds_write_b128 v5, v[124:127] offset:8064
    s_waitcnt lgkmcnt(4)
    buffer_store_dwordx4 v[200:203], v9, s[28:31], s44 offen sc1
    s_add_u32 s44, s44, s48
    v_dot2_f32_bf16 v12, v200, v16, v12
    v_dot2_f32_bf16 v12, v201, v16, v12
    v_dot2_f32_bf16 v12, v202, v16, v12
    v_dot2_f32_bf16 v12, v203, v16, v12
    buffer_store_dwordx4 v[204:207], v9, s[28:31], s45 offen sc1
    s_add_u32 s45, s45, s49
    v_dot2_f32_bf16 v13, v204, v16, v13
    v_dot2_f32_bf16 v13, v205, v16, v13
    v_dot2_f32_bf16 v13, v206, v16, v13
    v_dot2_f32_bf16 v13, v207, v16, v13
    buffer_store_dwordx4 v[208:211], v9, s[28:31], s46 offen sc1
    s_add_u32 s46, s46, s50
    v_dot2_f32_bf16 v14, v208, v16, v14
    v_dot2_f32_bf16 v14, v209, v16, v14
    v_dot2_f32_bf16 v14, v210, v16, v14
    v_dot2_f32_bf16 v14, v211, v16, v14
    buffer_store_dwordx4 v[212:215], v9, s[28:31], s47 offen sc1
    s_add_u32 s47, s47, s51
    v_dot2_f32_bf16 v15, v212, v16, v15
    v_dot2_f32_bf16 v15, v213, v16, v15
    v_dot2_f32_bf16 v15, v214, v16, v15
    v_dot2_f32_bf16 v15, v215, v16, v15
    s_waitcnt lgkmcnt(0)
    ds_read_b64_tr_b16 v[216:217], v8 offset:4608
    ds_read_b64_tr_b16 v[218:219], v8 offset:5184
    ds_read_b64_tr_b16 v[220:221], v8 offset:4640
    ds_read_b64_tr_b16 v[222:223], v8 offset:5216
    ds_read_b64_tr_b16 v[224:225], v8 offset:4672
    ds_read_b64_tr_b16 v[226:227], v8 offset:5248
    ds_read_b64_tr_b16 v[228:229], v8 offset:4704
    ds_read_b64_tr_b16 v[230:231], v8 offset:5280
    s_waitcnt vmcnt(32)
    ds_write_b128 v5, v[128:131] offset:0
    ds_write_b128 v5, v[132:135] offset:1152
    ds_write_b128 v5, v[136:139] offset:2304
    ds_write_b128 v5, v[140:143] offset:3456
    s_waitcnt lgkmcnt(4)
    buffer_store_dwordx4 v[216:219], v9, s[28:31], s44 offen sc1
    s_add_u32 s44, s44, s48
    v_dot2_f32_bf16 v12, v216, v16, v12
    v_dot2_f32_bf16 v12, v217, v16, v12
    v_dot2_f32_bf16 v12, v218, v16, v12
    v_dot2_f32_bf16 v12, v219, v16, v12
    buffer_store_dwordx4 v[220:223], v9, s[28:31], s45 offen sc1
    s_add_u32 s45, s45, s49
    v_dot2_f32_bf16 v13, v220, v16, v13
    v_dot2_f32_bf16 v13, v221, v16, v13
    v_dot2_f32_bf16 v13, v222, v16, v13
    v_dot2_f32_bf16 v13, v223, v16, v13
    buffer_store_dwordx4 v[224:227], v9, s[28:31], s46 offen sc1
    s_add_u32 s46, s46, s50
    v_dot2_f32_bf16 v14, v224, v16, v14
    v_dot2_f32_bf16 v14, v225, v16, v14
    v_dot2_f32_bf16 v14, v226, v16, v14
    v_dot2_f32_bf16 v14, v227, v16, v14
    buffer_store_dwordx4 v[228:231], v9, s[28:31], s47 offen sc1
    s_add_u32 s47, s47, s51
    v_dot2_f32_bf16 v15, v228, v16, v15
    v_dot2_f32_bf16 v15, v229, v16, v15
    v_dot2_f32_bf16 v15, v230, v16, v15
    v_dot2_f32_bf16 v15, v231, v16, v15
    s_waitcnt lgkmcnt(0)
    ds_read_b64_tr_b16 v[200:201], v8 offset:0
    ds_read_b64_tr_b16 v[202:203], v8 offset:576
    ds_read_b64_tr_b16 v[204:205], v8 offset:32
    ds_read_b64_tr_b16 v[206:207], v8 offset:608
    ds_read_b64_tr_b16 v[208:209], v8 offset:64
    ds_read_b64_tr_b16 v[210:211], v8 offset:640
    ds_read_b64_tr_b16 v[212:213], v8 offset:96
    ds_read_b64_tr_b16 v[214:215], v8 offset:672
    s_waitcnt vmcnt(32)
    ds_write_b128 v5, v[144:147] offset:4608
    ds_write_b128 v5, v[148:151] offset:5760
    ds_write_b128 v5, v[152:155] offset:6912
    ds_write_b128 v5, v[156:159] offset:8064
    s_waitcnt lgkmcnt(4)
    buffer_store_dwordx4 v[200:203], v9, s[28:31], s44 offen sc1
    s_add_u32 s44, s44, s48
    v_dot2_f32_bf16 v12, v200, v16, v12
    v_dot2_f32_bf16 v12, v201, v16, v12
    v_dot2_f32_bf16 v12, v202, v16, v12
    v_dot2_f32_bf16 v12, v203, v16, v12
    buffer_store_dwordx4 v[204:207], v9, s[28:31], s45 offen sc1
    s_add_u32 s45, s45, s49
    v_dot2_f32_bf16 v13, v204, v16, v13
    v_dot2_f32_bf16 v13, v205, v16, v13
    v_dot2_f32_bf16 v13, v206, v16, v13
    v_dot2_f32_bf16 v13, v207, v16, v13
    buffer_store_dwordx4 v[208:211], v9, s[28:31], s46 offen sc1
    s_add_u32 s46, s46, s50
    v_dot2_f32_bf16 v14, v208, v16, v14
    v_dot2_f32_bf16 v14, v209, v16, v14
    v_dot2_f32_bf16 v14, v210, v16, v14
    v_dot2_f32_bf16 v14, v211, v16, v14
    buffer_store_dwordx4 v[212:215], v9, s[28:31], s47 offen sc1
    s_add_u32 s47, s47, s51
    v_dot2_f32_bf16 v15, v212, v16, v15
    v_dot2_f32_bf16 v15, v213, v16, v15
    v_dot2_f32_bf16 v15, v214, v16, v15
    v_dot2_f32_bf16 v15, v215, v16, v15
    s_waitcnt lgkmcnt(0)
    ds_read_b64_tr_b16 v[216:217], v8 offset:4608
    ds_read_b64_tr_b16 v[218:219], v8 offset:5184
    ds_read_b64_tr_b16 v[220:221], v8 offset:4640
    ds_read_b64_tr_b16 v[222:223], v8 offset:5216
    ds_read_b64_tr_b16 v[224:225], v8 offset:4672
    ds_read_b64_tr_b16 v[226:227], v8 offset:5248
    ds_read_b64_tr_b16 v[228:229], v8 offset:4704
    ds_read_b64_tr_b16 v[230:231], v8 offset:5280
    s_waitcnt vmcnt(32)
    ds_write_b128 v5, v[160:163] offset:0
    ds_write_b128 v5, v[164:167] offset:1152
    ds_write_b128 v5, v[168:171] offset:2304
    ds_write_b128 v5, v[172:175] offset:3456
    s_waitcnt lgkmcnt(4)
    buffer_store_dwordx4 v[216:219], v9, s[28:31], s44 offen sc1
    s_add_u32 s44, s44, s48
    v_dot2_f32_bf16 v12, v216, v16, v12
    v_dot2_f32_bf16 v12, v217, v16, v12
    v_dot2_f32_bf16 v12, v218, v16, v12
    v_dot2_f32_bf16 v12, v219, v16, v12
    buffer_store_dwordx4 v[220:223], v9, s[28:31], s45 offen sc1
    s_add_u32 s45, s45, s49
    v_dot2_f32_bf16 v13, v220, v16, v13
    v_dot2_f32_bf16 v13, v221, v16, v13
    v_dot2_f32_bf16 v13, v222, v16, v13
    v_dot2_f32_bf16 v13, v223, v16, v13
    buffer_store_dwordx4 v[224:227], v9, s[28:31], s46 offen sc1
    s_add_u32 s46, s46, s50
    v_dot2_f32_bf16 v14, v224, v16, v14
    v_dot2_f32_bf16 v14, v225, v16, v14
    v_dot2_f32_bf16 v14, v226, v16, v14
    v_dot2_f32_bf16 v14, v227, v16, v14
    buffer_store_dwordx4 v[228:231], v9, s[28:31], s47 offen sc1
    s_add_u32 s47, s47, s51
    v_dot2_f32_bf16 v15, v228, v16, v15
    v_dot2_f32_bf16 v15, v229, v16, v15
    v_dot2_f32_bf16 v15, v230, v16, v15
    v_dot2_f32_bf16 v15, v231, v16, v15
    s_waitcnt lgkmcnt(0)
    ds_read_b64_tr_b16 v[200:201], v8 offset:0
    ds_read_b64_tr_b16 v[202:203], v8 offset:576
    ds_read_b64_tr_b16 v[204:205], v8 offset:32
    ds_read_b64_tr_b16 v[206:207], v8 offset:608
    ds_read_b64_tr_b16 v[208:209], v8 offset:64
    ds_read_b64_tr_b16 v[210:211], v8 offset:640
    ds_read_b64_tr_b16 v[212:213], v8 offset:96
    ds_read_b64_tr_b16 v[214:215], v8 offset:672
    s_waitcnt vmcnt(32)
    ds_write_b128 v5, v[176:179] offset:4608
    ds_write_b128 v5, v[180:183] offset:5760
    ds_write_b128 v5, v[184:187] offset:6912
    ds_write_b128 v5, v[188:191] offset:8064
    s_waitcnt lgkmcnt(4)
    buffer_store_dwordx4 v[200:203], v9, s[28:31], s44 offen sc1
    s_add_u32 s44, s44, s48
    v_dot2_f32_bf16 v12, v200, v16, v12
    v_dot2_f32_bf16 v12, v201, v16, v12
    v_dot2_f32_bf16 v12, v202, v16, v12
    v_dot2_f32_bf16 v12, v203, v16, v12
    buffer_store_dwordx4 v[204:207], v9, s[28:31], s45 offen sc1
    s_add_u32 s45, s45, s49
    v_dot2_f32_bf16 v13, v204, v16, v13
    v_dot2_f32_bf16 v13, v205, v16, v13
    v_dot2_f32_bf16 v13, v206, v16, v13
    v_dot2_f32_bf16 v13, v207, v16, v13
    buffer_store_dwordx4 v[208:211], v9, s[28:31], s46 offen sc1
    s_add_u32 s46, s46, s50
    v_dot2_f32_bf16 v14, v208, v16, v14
    v_dot2_f32_bf16 v14, v209, v16, v14
    v_dot2_f32_bf16 v14, v210, v16, v14
    v_dot2_f32_bf16 v14, v211, v16, v14
    buffer_store_dwordx4 v[212:215], v9, s[28:31], s47 offen sc1
    s_add_u32 s47, s47, s51
    v_dot2_f32_bf16 v15, v212, v16, v15
    v_dot2_f32_bf16 v15, v213, v16, v15
    v_dot2_f32_bf16 v15, v214, v16, v15
    v_dot2_f32_bf16 v15, v215, v16, v15
    s_waitcnt lgkmcnt(0)
    ds_read_b64_tr_b16 v[216:217], v8 offset:4608
    ds_read_b64_tr_b16 v[218:219], v8 offset:5184
    ds_read_b64_tr_b16 v[220:221], v8 offset:4640
    ds_read_b64_tr_b16 v[222:223], v8 offset:5216
    ds_read_b64_tr_b16 v[224:225], v8 offset:4672
    ds_read_b64_tr_b16 v[226:227], v8 offset:5248
    ds_read_b64_tr_b16 v[228:229], v8 offset:4704
    ds_read_b64_tr_b16 v[230:231], v8 offset:5280
    s_waitcnt lgkmcnt(0)
    buffer_store_dwordx4 v[216:219], v9, s[28:31], s44 offen sc1
    s_add_u32 s44, s44, s48
    v_dot2_f32_bf16 v12, v216, v16, v12
    v_dot2_f32_bf16 v12, v217, v16, v12
    v_dot2_f32_bf16 v12, v218, v16, v12
    v_dot2_f32_bf16 v12, v219, v16, v12
    buffer_store_dwordx4 v[220:223], v9, s[28:31], s45 offen sc1
    s_add_u32 s45, s45, s49
    v_dot2_f32_bf16 v13, v220, v16, v13
    v_dot2_f32_bf16 v13, v221, v16, v13
    v_dot2_f32_bf16 v13, v222, v16, v13
    v_dot2_f32_bf16 v13, v223, v16, v13
    buffer_store_dwordx4 v[224:227], v9, s[28:31], s46 offen sc1
    s_add_u32 s46, s46, s50
    v_dot2_f32_bf16 v14, v224, v16, v14
    v_dot2_f32_bf16 v14, v225, v16, v14
    v_dot2_f32_bf16 v14, v226, v16, v14
    v_dot2_f32_bf16 v14, v227, v16, v14
    buffer_store_dwordx4 v[228:231], v9, s[28:31], s47 offen sc1
    s_add_u32 s47, s47, s51
    v_dot2_f32_bf16 v15, v228, v16, v15
    v_dot2_f32_bf16 v15, v229, v16, v15
    v_dot2_f32_bf16 v15, v230, v16, v15
    v_dot2_f32_bf16 v15, v231, v16, v15
    s_nop 2
    v_mov_b32 v20, v12
    v_mov_b32 v21, v13
    v_mov_b32 v22, v14
    v_mov_b32 v23, v15
    s_nop 1
    v_permlane32_swap_b32 v20, v12
    v_permlane32_swap_b32 v21, v13
    v_permlane32_swap_b32 v22, v14
    v_permlane32_swap_b32 v23, v15
    s_nop 1
    v_add_f32 v12, v12, v20
    v_add_f32 v13, v13, v21
    v_add_f32 v14, v14, v22
    v_add_f32 v15, v15, v23
    v_mov_b32 v20, v12
    v_mov_b32 v21, v13
    v_mov_b32 v22, v14
    v_mov_b32 v23, v15
    s_nop 1
    v_permlane16_swap_b32 v20, v12
    v_permlane16_swap_b32 v21, v13
    v_permlane16_swap_b32 v22, v14
    v_permlane16_swap_b32 v23, v15
    s_nop 1
    v_add_f32 v12, v12, v20
    v_add_f32 v13, v13, v21
    v_add_f32 v14, v14, v22
    v_add_f32 v15, v15, v23
    s_mul_i32 s38, s33, 7168
    s_lshl_b32 s39, s35, 8
    s_add_u32 s38, s38, s39
    s_add_u32 s38, s38, 8146944
    v_lshlrev_b32 v17, 2, v1
    s_mov_b64 exec, 0xffff
    buffer_store_dword v12, v17, s[28:31], s38 offen offset:0 sc1
    buffer_store_dword v13, v17, s[28:31], s38 offen offset:64 sc1
    buffer_store_dword v14, v17, s[28:31], s38 offen offset:128 sc1
    buffer_store_dword v15, v17, s[28:31], s38 offen offset:192 sc1
    s_endpgm
prep_kernel_pk26:
    s_mov_b32 s24, s14
    s_mov_b32 s25, s15
    s_mov_b32 s26, 819200
    s_mov_b32 s27, 0x00020000
    s_sub_u32 s32, s21, 20
    s_mul_i32 s33, s32, 52429
    s_lshr_b32 s33, s33, 19
    s_mul_i32 s35, s33, 10
    s_sub_u32 s35, s32, s35
    v_mul_u32_u24 v10, 1280, v3
    v_lshl_add_u32 v10, v4, 4, v10
    s_mul_i32 s36, s33, 409600
    s_lshl_b32 s37, s35, 7
    s_add_u32 s36, s36, s37
    buffer_load_dwordx4 v[32:35], v10, s[24:27], s36 offen nt
    s_add_u32 s36, s36, 10240
    buffer_load_dwordx4 v[36:39], v10, s[24:27], s36 offen nt
    s_add_u32 s36, s36, 10240
    buffer_load_dwordx4 v[40:43], v10, s[24:27], s36 offen nt
    s_add_u32 s36, s36, 10240
    buffer_load_dwordx4 v[44:47], v10, s[24:27], s36 offen nt
    s_add_u32 s36, s36, 10240
    buffer_load_dwordx4 v[48:51], v10, s[24:27], s36 offen nt
    s_add_u32 s36, s36, 10240
    buffer_load_dwordx4 v[52:55], v10, s[24:27], s36 offen nt
    s_add_u32 s36, s36, 10240
    buffer_load_dwordx4 v[56:59], v10, s[24:27], s36 offen nt
    s_add_u32 s36, s36, 10240
    buffer_load_dwordx4 v[60:63], v10, s[24:27], s36 offen nt
    s_add_u32 s36, s36, 10240
    buffer_load_dwordx4 v[64:67], v10, s[24:27], s36 offen nt
    s_add_u32 s36, s36, 10240
    buffer_load_dwordx4 v[68:71], v10, s[24:27], s36 offen nt
    s_add_u32 s36, s36, 10240
    buffer_load_dwordx4 v[72:75], v10, s[24:27], s36 offen nt
    s_add_u32 s36, s36, 10240
    buffer_load_dwordx4 v[76:79], v10, s[24:27], s36 offen nt
    s_add_u32 s36, s36, 10240
    buffer_load_dwordx4 v[80:83], v10, s[24:27], s36 offen nt
    s_add_u32 s36, s36, 10240
    buffer_load_dwordx4 v[84:87], v10, s[24:27], s36 offen nt
    s_add_u32 s36, s36, 10240
    buffer_load_dwordx4 v[88:91], v10, s[24:27], s36 offen nt
    s_add_u32 s36, s36, 10240
    buffer_load_dwordx4 v[92:95], v10, s[24:27], s36 offen nt
    s_add_u32 s36, s36, 10240
    buffer_load_dwordx4 v[96:99], v10, s[24:27], s36 offen nt
    s_add_u32 s36, s36, 10240
    buffer_load_dwordx4 v[100:103], v10, s[24:27], s36 offen nt
    s_add_u32 s36, s36, 10240
    buffer_load_dwordx4 v[104:107], v10, s[24:27], s36 offen nt
    s_add_u32 s36, s36, 10240
    buffer_load_dwordx4 v[108:111], v10, s[24:27], s36 offen nt
    s_add_u32 s36, s36, 10240
    buffer_load_dwordx4 v[112:115], v10, s[24:27], s36 offen nt
    s_add_u32 s36, s36, 10240
    buffer_load_dwordx4 v[116:119], v10, s[24:27], s36 offen nt
    s_add_u32 s36, s36, 10240
    buffer_load_dwordx4 v[120:123], v10, s[24:27], s36 offen nt
    s_add_u32 s36, s36, 10240
    buffer_load_dwordx4 v[124:127], v10, s[24:27], s36 offen nt
    s_add_u32 s36, s36, 10240
    buffer_load_dwordx4 v[128:131], v10, s[24:27], s36 offen nt
    s_add_u32 s36, s36, 10240
    buffer_load_dwordx4 v[132:135], v10, s[24:27], s36 offen nt
    s_add_u32 s36, s36, 10240
    buffer_load_dwordx4 v[136:139], v10, s[24:27], s36 offen nt
    s_add_u32 s36, s36, 10240
    buffer_load_dwordx4 v[140:143], v10, s[24:27], s36 offen nt
    s_add_u32 s36, s36, 10240
    buffer_load_dwordx4 v[144:147], v10, s[24:27], s36 offen nt
    s_add_u32 s36, s36, 10240
    buffer_load_dwordx4 v[148:151], v10, s[24:27], s36 offen nt
    s_add_u32 s36, s36, 10240
    buffer_load_dwordx4 v[152:155], v10, s[24:27], s36 offen nt
    s_add_u32 s36, s36, 10240
    buffer_load_dwordx4 v[156:159], v10, s[24:27], s36 offen nt
    s_add_u32 s36, s36, 10240
    buffer_load_dwordx4 v[160:163], v10, s[24:27], s36 offen nt
    s_add_u32 s36, s36, 10240
    buffer_load_dwordx4 v[164:167], v10, s[24:27], s36 offen nt
    s_add_u32 s36, s36, 10240
    buffer_load_dwordx4 v[168:171], v10, s[24:27], s36 offen nt
    s_add_u32 s36, s36, 10240
    buffer_load_dwordx4 v[172:175], v10, s[24:27], s36 offen nt
    s_add_u32 s36, s36, 10240
    buffer_load_dwordx4 v[176:179], v10, s[24:27], s36 offen nt
    s_add_u32 s36, s36, 10240
    buffer_load_dwordx4 v[180:183], v10, s[24:27], s36 offen nt
    s_add_u32 s36, s36, 10240
    buffer_load_dwordx4 v[184:187], v10, s[24:27], s36 offen nt
    s_add_u32 s36, s36, 10240
    buffer_load_dwordx4 v[188:191], v10, s[24:27], s36 offen nt
    s_lshl_b32 s36, s35, 2
    s_add_u32 s36, s36, 0
    s_mul_i32 s38, s36, 6554
    s_lshr_b32 s38, s38, 16
    s_mul_i32 s39, s38, 10
    s_sub_u32 s39, s36, s39
    s_cmp_ge_u32 s39, 5
    s_cselect_b32 s40, 1, 0
    s_sub_u32 s41, s39, 6
    s_cmp_eq_u32 s39, 5
    s_cselect_b32 s41, 4, s41
    s_cmp_eq_u32 s40, 1
    s_cselect_b32 s39, s41, s39
    s_mul_i32 s37, s38, 200
    s_mul_i32 s40, s40, 100
    s_add_u32 s37, s37, s40
    s_mul_i32 s40, s33, 50
    s_add_u32 s37, s37, s40
    s_add_u32 s37, s37, s39
    s_lshl_b32 s37, s37, 10
    s_add_u32 s44, s37, 24055808
    s_movk_i32 s48, 5120
    s_lshl_b32 s36, s35, 2
    s_add_u32 s36, s36, 1
    s_mul_i32 s38, s36, 6554
    s_lshr_b32 s38, s38, 16
    s_mul_i32 s39, s38, 10
    s_sub_u32 s39, s36, s39
    s_cmp_ge_u32 s39, 5
    s_cselect_b32 s40, 1, 0
    s_sub_u32 s41, s39, 6
    s_cmp_eq_u32 s39, 5
    s_cselect_b32 s41, 4, s41
    s_cmp_eq_u32 s40, 1
    s_cselect_b32 s39, s41, s39
    s_mul_i32 s37, s38, 200
    s_mul_i32 s40, s40, 100
    s_add_u32 s37, s37, s40
    s_mul_i32 s40, s33, 50
    s_add_u32 s37, s37, s40
    s_add_u32 s37, s37, s39
    s_lshl_b32 s37, s37, 10
    s_add_u32 s45, s37, 24055808
    s_movk_i32 s49, 5120
    s_lshl_b32 s36, s35, 2
    s_add_u32 s36, s36, 2
    s_mul_i32 s38, s36, 6554
    s_lshr_b32 s38, s38, 16
    s_mul_i32 s39, s38, 10
    s_sub_u32 s39, s36, s39
    s_cmp_ge_u32 s39, 5
    s_cselect_b32 s40, 1, 0
    s_sub_u32 s41, s39, 6
    s_cmp_eq_u32 s39, 5
    s_cselect_b32 s41, 4, s41
    s_cmp_eq_u32 s40, 1
    s_cselect_b32 s39, s41, s39
    s_mul_i32 s37, s38, 200
    s_mul_i32 s40, s40, 100
    s_add_u32 s37, s37, s40
    s_mul_i32 s40, s33, 50
    s_add_u32 s37, s37, s40
    s_add_u32 s37, s37, s39
    s_lshl_b32 s37, s37, 10
    s_add_u32 s46, s37, 24055808
    s_movk_i32 s50, 5120
    s_lshl_b32 s36, s35, 2
    s_add_u32 s36, s36, 3
    s_mul_i32 s38, s36, 6554
    s_lshr_b32 s38, s38, 16
    s_mul_i32 s39, s38, 10
    s_sub_u32 s39, s36, s39
    s_cmp_ge_u32 s39, 5
    s_cselect_b32 s40, 1, 0
    s_sub_u32 s41, s39, 6
    s_cmp_eq_u32 s39, 5
    s_cselect_b32 s41, 4, s41
    s_cmp_eq_u32 s40, 1
    s_cselect_b32 s39, s41, s39
    s_mul_i32 s37, s38, 200
    s_mul_i32 s40, s40, 100
    s_add_u32 s37, s37, s40
    s_mul_i32 s40, s33, 50
    s_add_u32 s37, s37, s40
    s_add_u32 s37, s37, s39
    s_lshl_b32 s37, s37, 10
    s_add_u32 s47, s37, 24055808
    s_movk_i32 s51, 5120
    s_waitcnt vmcnt(36)
    ds_write_b128 v5, v[32:35] offset:0
    ds_write_b128 v5, v[36:39] offset:1152
    ds_write_b128 v5, v[40:43] offset:2304
    ds_write_b128 v5, v[44:47] offset:3456
    s_waitcnt lgkmcnt(0)
    ds_read_b64_tr_b16 v[200:201], v8 offset:0
    ds_read_b64_tr_b16 v[202:203], v8 offset:576
    ds_read_b64_tr_b16 v[204:205], v8 offset:32
    ds_read_b64_tr_b16 v[206:207], v8 offset:608
    ds_read_b64_tr_b16 v[208:209], v8 offset:64
    ds_read_b64_tr_b16 v[210:211], v8 offset:640
    ds_read_b64_tr_b16 v[212:213], v8 offset:96
    ds_read_b64_tr_b16 v[214:215], v8 offset:672
    s_waitcnt vmcnt(32)
    ds_write_b128 v5, v[48:51] offset:4608
    ds_write_b128 v5, v[52:55] offset:5760
    ds_write_b128 v5, v[56:59] offset:6912
    ds_write_b128 v5, v[60:63] offset:8064
    s_waitcnt lgkmcnt(4)
    buffer_store_dwordx4 v[200:203], v9, s[28:31], s44 offen sc1
    s_add_u32 s44, s44, s48
    buffer_store_dwordx4 v[204:207], v9, s[28:31], s45 offen sc1
    s_add_u32 s45, s45, s49
    buffer_store_dwordx4 v[208:211], v9, s[28:31], s46 offen sc1
    s_add_u32 s46, s46, s50
    buffer_store_dwordx4 v[212:215], v9, s[28:31], s47 offen sc1
    s_add_u32 s47, s47, s51
    s_waitcnt lgkmcnt(0)
    ds_read_b64_tr_b16 v[216:217], v8 offset:4608
    ds_read_b64_tr_b16 v[218:219], v8 offset:5184
    ds_read_b64_tr_b16 v[220:221], v8 offset:4640
    ds_read_b64_tr_b16 v[222:223], v8 offset:5216
    ds_read_b64_tr_b16 v[224:225], v8 offset:4672
    ds_read_b64_tr_b16 v[226:227], v8 offset:5248
    ds_read_b64_tr_b16 v[228:229], v8 offset:4704
    ds_read_b64_tr_b16 v[230:231], v8 offset:5280
    s_waitcnt vmcnt(32)
    ds_write_b128 v5, v[64:67] offset:0
    ds_write_b128 v5, v[68:71] offset:1152
    ds_write_b128 v5, v[72:75] offset:2304
    ds_write_b128 v5, v[76:79] offset:3456
    s_waitcnt lgkmcnt(4)
    buffer_store_dwordx4 v[216:219], v9, s[28:31], s44 offen sc1
    s_add_u32 s44, s44, s48
    buffer_store_dwordx4 v[220:223], v9, s[28:31], s45 offen sc1
    s_add_u32 s45, s45, s49
    buffer_store_dwordx4 v[224:227], v9, s[28:31], s46 offen sc1
    s_add_u32 s46, s46, s50
    buffer_store_dwordx4 v[228:231], v9, s[28:31], s47 offen sc1
    s_add_u32 s47, s47, s51
    s_waitcnt lgkmcnt(0)
    ds_read_b64_tr_b16 v[200:201], v8 offset:0
    ds_read_b64_tr_b16 v[202:203], v8 offset:576
    ds_read_b64_tr_b16 v[204:205], v8 offset:32
    ds_read_b64_tr_b16 v[206:207], v8 offset:608
    ds_read_b64_tr_b16 v[208:209], v8 offset:64
    ds_read_b64_tr_b16 v[210:211], v8 offset:640
    ds_read_b64_tr_b16 v[212:213], v8 offset:96
    ds_read_b64_tr_b16 v[214:215], v8 offset:672
    s_waitcnt vmcnt(32)
    ds_write_b128 v5, v[80:83] offset:4608
    ds_write_b128 v5, v[84:87] offset:5760
    ds_write_b128 v5, v[88:91] offset:6912
    ds_write_b128 v5, v[92:95] offset:8064
    s_waitcnt lgkmcnt(4)
    buffer_store_dwordx4 v[200:203], v9, s[28:31], s44 offen sc1
    s_add_u32 s44, s44, s48
    buffer_store_dwordx4 v[204:207], v9, s[28:31], s45 offen sc1
    s_add_u32 s45, s45, s49
    buffer_store_dwordx4 v[208:211], v9, s[28:31], s46 offen sc1
    s_add_u32 s46, s46, s50
    buffer_store_dwordx4 v[212:215], v9, s[28:31], s47 offen sc1
    s_add_u32 s47, s47, s51
    s_waitcnt lgkmcnt(0)
    ds_read_b64_tr_b16 v[216:217], v8 offset:4608
    ds_read_b64_tr_b16 v[218:219], v8 offset:5184
    ds_read_b64_tr_b16 v[220:221], v8 offset:4640
    ds_read_b64_tr_b16 v[222:223], v8 offset:5216
    ds_read_b64_tr_b16 v[224:225], v8 offset:4672
    ds_read_b64_tr_b16 v[226:227], v8 offset:5248
    ds_read_b64_tr_b16 v[228:229], v8 offset:4704
    ds_read_b64_tr_b16 v[230:231], v8 offset:5280
    s_waitcnt vmcnt(32)
    ds_write_b128 v5, v[96:99] offset:0
    ds_write_b128 v5, v[100:103] offset:1152
    ds_write_b128 v5, v[104:107] offset:2304
    ds_write_b128 v5, v[108:111] offset:3456
    s_waitcnt lgkmcnt(4)
    buffer_store_dwordx4 v[216:219], v9, s[28:31], s44 offen sc1
    s_add_u32 s44, s44, s48
    buffer_store_dwordx4 v[220:223], v9, s[28:31], s45 offen sc1
    s_add_u32 s45, s45, s49
    buffer_store_dwordx4 v[224:227], v9, s[28:31], s46 offen sc1
    s_add_u32 s46, s46, s50
    buffer_store_dwordx4 v[228:231], v9, s[28:31], s47 offen sc1
    s_add_u32 s47, s47, s51
    s_waitcnt lgkmcnt(0)
    ds_read_b64_tr_b16 v[200:201], v8 offset:0
    ds_read_b64_tr_b16 v[202:203], v8 offset:576
    ds_read_b64_tr_b16 v[204:205], v8 offset:32
    ds_read_b64_tr_b16 v[206:207], v8 offset:608
    ds_read_b64_tr_b16 v[208:209], v8 offset:64
    ds_read_b64_tr_b16 v[210:211], v8 offset:640
    ds_read_b64_tr_b16 v[212:213], v8 offset:96
    ds_read_b64_tr_b16 v[214:215], v8 offset:672
    s_waitcnt vmcnt(32)
    ds_write_b128 v5, v[112:115] offset:4608
    ds_write_b128 v5, v[116:119] offset:5760
    ds_write_b128 v5, v[120:123] offset:6912
    ds_write_b128 v5, v[124:127] offset:8064
    s_waitcnt lgkmcnt(4)
    buffer_store_dwordx4 v[200:203], v9, s[28:31], s44 offen sc1
    s_add_u32 s44, s44, s48
    buffer_store_dwordx4 v[204:207], v9, s[28:31], s45 offen sc1
    s_add_u32 s45, s45, s49
    buffer_store_dwordx4 v[208:211], v9, s[28:31], s46 offen sc1
    s_add_u32 s46, s46, s50
    buffer_store_dwordx4 v[212:215], v9, s[28:31], s47 offen sc1
    s_add_u32 s47, s47, s51
    s_waitcnt lgkmcnt(0)
    ds_read_b64_tr_b16 v[216:217], v8 offset:4608
    ds_read_b64_tr_b16 v[218:219], v8 offset:5184
    ds_read_b64_tr_b16 v[220:221], v8 offset:4640
    ds_read_b64_tr_b16 v[222:223], v8 offset:5216
    ds_read_b64_tr_b16 v[224:225], v8 offset:4672
    ds_read_b64_tr_b16 v[226:227], v8 offset:5248
    ds_read_b64_tr_b16 v[228:229], v8 offset:4704
    ds_read_b64_tr_b16 v[230:231], v8 offset:5280
    s_waitcnt vmcnt(32)
    ds_write_b128 v5, v[128:131] offset:0
    ds_write_b128 v5, v[132:135] offset:1152
    ds_write_b128 v5, v[136:139] offset:2304
    ds_write_b128 v5, v[140:143] offset:3456
    s_waitcnt lgkmcnt(4)
    buffer_store_dwordx4 v[216:219], v9, s[28:31], s44 offen sc1
    s_add_u32 s44, s44, s48
    buffer_store_dwordx4 v[220:223], v9, s[28:31], s45 offen sc1
    s_add_u32 s45, s45, s49
    buffer_store_dwordx4 v[224:227], v9, s[28:31], s46 offen sc1
    s_add_u32 s46, s46, s50
    buffer_store_dwordx4 v[228:231], v9, s[28:31], s47 offen sc1
    s_add_u32 s47, s47, s51
    s_waitcnt lgkmcnt(0)
    ds_read_b64_tr_b16 v[200:201], v8 offset:0
    ds_read_b64_tr_b16 v[202:203], v8 offset:576
    ds_read_b64_tr_b16 v[204:205], v8 offset:32
    ds_read_b64_tr_b16 v[206:207], v8 offset:608
    ds_read_b64_tr_b16 v[208:209], v8 offset:64
    ds_read_b64_tr_b16 v[210:211], v8 offset:640
    ds_read_b64_tr_b16 v[212:213], v8 offset:96
    ds_read_b64_tr_b16 v[214:215], v8 offset:672
    s_waitcnt vmcnt(32)
    ds_write_b128 v5, v[144:147] offset:4608
    ds_write_b128 v5, v[148:151] offset:5760
    ds_write_b128 v5, v[152:155] offset:6912
    ds_write_b128 v5, v[156:159] offset:8064
    s_waitcnt lgkmcnt(4)
    buffer_store_dwordx4 v[200:203], v9, s[28:31], s44 offen sc1
    s_add_u32 s44, s44, s48
    buffer_store_dwordx4 v[204:207], v9, s[28:31], s45 offen sc1
    s_add_u32 s45, s45, s49
    buffer_store_dwordx4 v[208:211], v9, s[28:31], s46 offen sc1
    s_add_u32 s46, s46, s50
    buffer_store_dwordx4 v[212:215], v9, s[28:31], s47 offen sc1
    s_add_u32 s47, s47, s51
    s_waitcnt lgkmcnt(0)
    ds_read_b64_tr_b16 v[216:217], v8 offset:4608
    ds_read_b64_tr_b16 v[218:219], v8 offset:5184
    ds_read_b64_tr_b16 v[220:221], v8 offset:4640
    ds_read_b64_tr_b16 v[222:223], v8 offset:5216
    ds_read_b64_tr_b16 v[224:225], v8 offset:4672
    ds_read_b64_tr_b16 v[226:227], v8 offset:5248
    ds_read_b64_tr_b16 v[228:229], v8 offset:4704
    ds_read_b64_tr_b16 v[230:231], v8 offset:5280
    s_waitcnt vmcnt(32)
    ds_write_b128 v5, v[160:163] offset:0
    ds_write_b128 v5, v[164:167] offset:1152
    ds_write_b128 v5, v[168:171] offset:2304
    ds_write_b128 v5, v[172:175] offset:3456
    s_waitcnt lgkmcnt(4)
    buffer_store_dwordx4 v[216:219], v9, s[28:31], s44 offen sc1
    s_add_u32 s44, s44, s48
    buffer_store_dwordx4 v[220:223], v9, s[28:31], s45 offen sc1
    s_add_u32 s45, s45, s49
    buffer_store_dwordx4 v[224:227], v9, s[28:31], s46 offen sc1
    s_add_u32 s46, s46, s50
    buffer_store_dwordx4 v[228:231], v9, s[28:31], s47 offen sc1
    s_add_u32 s47, s47, s51
    s_waitcnt lgkmcnt(0)
    ds_read_b64_tr_b16 v[200:201], v8 offset:0
    ds_read_b64_tr_b16 v[202:203], v8 offset:576
    ds_read_b64_tr_b16 v[204:205], v8 offset:32
    ds_read_b64_tr_b16 v[206:207], v8 offset:608
    ds_read_b64_tr_b16 v[208:209], v8 offset:64
    ds_read_b64_tr_b16 v[210:211], v8 offset:640
    ds_read_b64_tr_b16 v[212:213], v8 offset:96
    ds_read_b64_tr_b16 v[214:215], v8 offset:672
    s_waitcnt vmcnt(32)
    ds_write_b128 v5, v[176:179] offset:4608
    ds_write_b128 v5, v[180:183] offset:5760
    ds_write_b128 v5, v[184:187] offset:6912
    ds_write_b128 v5, v[188:191] offset:8064
    s_waitcnt lgkmcnt(4)
    buffer_store_dwordx4 v[200:203], v9, s[28:31], s44 offen sc1
    s_add_u32 s44, s44, s48
    buffer_store_dwordx4 v[204:207], v9, s[28:31], s45 offen sc1
    s_add_u32 s45, s45, s49
    buffer_store_dwordx4 v[208:211], v9, s[28:31], s46 offen sc1
    s_add_u32 s46, s46, s50
    buffer_store_dwordx4 v[212:215], v9, s[28:31], s47 offen sc1
    s_add_u32 s47, s47, s51
    s_waitcnt lgkmcnt(0)
    ds_read_b64_tr_b16 v[216:217], v8 offset:4608
    ds_read_b64_tr_b16 v[218:219], v8 offset:5184
    ds_read_b64_tr_b16 v[220:221], v8 offset:4640
    ds_read_b64_tr_b16 v[222:223], v8 offset:5216
    ds_read_b64_tr_b16 v[224:225], v8 offset:4672
    ds_read_b64_tr_b16 v[226:227], v8 offset:5248
    ds_read_b64_tr_b16 v[228:229], v8 offset:4704
    ds_read_b64_tr_b16 v[230:231], v8 offset:5280
    s_waitcnt lgkmcnt(0)
    buffer_store_dwordx4 v[216:219], v9, s[28:31], s44 offen sc1
    s_add_u32 s44, s44, s48
    buffer_store_dwordx4 v[220:223], v9, s[28:31], s45 offen sc1
    s_add_u32 s45, s45, s49
    buffer_store_dwordx4 v[224:227], v9, s[28:31], s46 offen sc1
    s_add_u32 s46, s46, s50
    buffer_store_dwordx4 v[228:231], v9, s[28:31], s47 offen sc1
    s_add_u32 s47, s47, s51
    s_endpgm
prep_kernel_pk27:
    s_mov_b32 s24, s16
    s_mov_b32 s25, s17
    s_mov_b32 s26, 2211840
    s_mov_b32 s27, 0x00020000
    s_sub_u32 s32, s21, 40
    s_mul_i32 s33, s32, 2428
    s_lshr_b32 s33, s33, 16
    s_mul_i32 s35, s33, 27
    s_sub_u32 s35, s32, s35
    v_mul_u32_u24 v10, 3456, v3
    v_lshl_add_u32 v10, v4, 4, v10
    s_mul_i32 s36, s33, 1105920
    s_lshl_b32 s37, s35, 7
    s_add_u32 s36, s36, s37
    buffer_load_dwordx4 v[32:35], v10, s[24:27], s36 offen nt
    s_add_u32 s36, s36, 27648
    buffer_load_dwordx4 v[36:39], v10, s[24:27], s36 offen nt
    s_add_u32 s36, s36, 27648
    buffer_load_dwordx4 v[40:43], v10, s[24:27], s36 offen nt
    s_add_u32 s36, s36, 27648
    buffer_load_dwordx4 v[44:47], v10, s[24:27], s36 offen nt
    s_add_u32 s36, s36, 27648
    buffer_load_dwordx4 v[48:51], v10, s[24:27], s36 offen nt
    s_add_u32 s36, s36, 27648
    buffer_load_dwordx4 v[52:55], v10, s[24:27], s36 offen nt
    s_add_u32 s36, s36, 27648
    buffer_load_dwordx4 v[56:59], v10, s[24:27], s36 offen nt
    s_add_u32 s36, s36, 27648
    buffer_load_dwordx4 v[60:63], v10, s[24:27], s36 offen nt
    s_add_u32 s36, s36, 27648
    buffer_load_dwordx4 v[64:67], v10, s[24:27], s36 offen nt
    s_add_u32 s36, s36, 27648
    buffer_load_dwordx4 v[68:71], v10, s[24:27], s36 offen nt
    s_add_u32 s36, s36, 27648
    buffer_load_dwordx4 v[72:75], v10, s[24:27], s36 offen nt
    s_add_u32 s36, s36, 27648
    buffer_load_dwordx4 v[76:79], v10, s[24:27], s36 offen nt
    s_add_u32 s36, s36, 27648
    buffer_load_dwordx4 v[80:83], v10, s[24:27], s36 offen nt
    s_add_u32 s36, s36, 27648
    buffer_load_dwordx4 v[84:87], v10, s[24:27], s36 offen nt
    s_add_u32 s36, s36, 27648
    buffer_load_dwordx4 v[88:91], v10, s[24:27], s36 offen nt
    s_add_u32 s36, s36, 27648
    buffer_load_dwordx4 v[92:95], v10, s[24:27], s36 offen nt
    s_add_u32 s36, s36, 27648
    buffer_load_dwordx4 v[96:99], v10, s[24:27], s36 offen nt
    s_add_u32 s36, s36, 27648
    buffer_load_dwordx4 v[100:103], v10, s[24:27], s36 offen nt
    s_add_u32 s36, s36, 27648
    buffer_load_dwordx4 v[104:107], v10, s[24:27], s36 offen nt
    s_add_u32 s36, s36, 27648
    buffer_load_dwordx4 v[108:111], v10, s[24:27], s36 offen nt
    s_add_u32 s36, s36, 27648
    buffer_load_dwordx4 v[112:115], v10, s[24:27], s36 offen nt
    s_add_u32 s36, s36, 27648
    buffer_load_dwordx4 v[116:119], v10, s[24:27], s36 offen nt
    s_add_u32 s36, s36, 27648
    buffer_load_dwordx4 v[120:123], v10, s[24:27], s36 offen nt
    s_add_u32 s36, s36, 27648
    buffer_load_dwordx4 v[124:127], v10, s[24:27], s36 offen nt
    s_add_u32 s36, s36, 27648
    buffer_load_dwordx4 v[128:131], v10, s[24:27], s36 offen nt
    s_add_u32 s36, s36, 27648
    buffer_load_dwordx4 v[132:135], v10, s[24:27], s36 offen nt
    s_add_u32 s36, s36, 27648
    buffer_load_dwordx4 v[136:139], v10, s[24:27], s36 offen nt
    s_add_u32 s36, s36, 27648
    buffer_load_dwordx4 v[140:143], v10, s[24:27], s36 offen nt
    s_add_u32 s36, s36, 27648
    buffer_load_dwordx4 v[144:147], v10, s[24:27], s36 offen nt
    s_add_u32 s36, s36, 27648
    buffer_load_dwordx4 v[148:151], v10, s[24:27], s36 offen nt
    s_add_u32 s36, s36, 27648
    buffer_load_dwordx4 v[152:155], v10, s[24:27], s36 offen nt
    s_add_u32 s36, s36, 27648
    buffer_load_dwordx4 v[156:159], v10, s[24:27], s36 offen nt
    s_add_u32 s36, s36, 27648
    buffer_load_dwordx4 v[160:163], v10, s[24:27], s36 offen nt
    s_add_u32 s36, s36, 27648
    buffer_load_dwordx4 v[164:167], v10, s[24:27], s36 offen nt
    s_add_u32 s36, s36, 27648
    buffer_load_dwordx4 v[168:171], v10, s[24:27], s36 offen nt
    s_add_u32 s36, s36, 27648
    buffer_load_dwordx4 v[172:175], v10, s[24:27], s36 offen nt
    s_add_u32 s36, s36, 27648
    buffer_load_dwordx4 v[176:179], v10, s[24:27], s36 offen nt
    s_add_u32 s36, s36, 27648
    buffer_load_dwordx4 v[180:183], v10, s[24:27], s36 offen nt
    s_add_u32 s36, s36, 27648
    buffer_load_dwordx4 v[184:187], v10, s[24:27], s36 offen nt
    s_add_u32 s36, s36, 27648
    buffer_load_dwordx4 v[188:191], v10, s[24:27], s36 offen nt
    s_lshl_b32 s36, s35, 2
    s_add_u32 s36, s36, 0
    s_mul_i32 s38, s36, 9363
    s_lshr_b32 s38, s38, 16
    s_mul_i32 s39, s38, 7
    s_sub_u32 s39, s36, s39
    s_sub_u32 s41, s39, 1
    s_cmp_eq_u32 s39, 0
    s_cselect_b32 s41, 6, s41
    s_and_b32 s40, s38, 1
    s_cmp_eq_u32 s40, 1
    s_cselect_b32 s39, s41, s39
    s_mov_b32 s41, 4
    s_mov_b32 s40, s39
    s_cmp_ge_u32 s39, 4
    s_cselect_b32 s41, 2, s41
    s_add_u32 s42, s39, 76
    s_cmp_ge_u32 s39, 4
    s_cselect_b32 s40, s42, s40
    s_cmp_eq_u32 s39, 6
    s_cselect_b32 s41, 1, s41
    s_cselect_b32 s40, 120, s40
    s_mul_i32 s42, s33, 10
    s_mul_i32 s42, s42, s41
    s_add_u32 s40, s40, s42
    s_mul_i32 s37, s38, 140
    s_add_u32 s37, s37, s40
    s_lshl_b32 s37, s37, 10
    s_add_u32 s44, s37, 24875008
    s_lshl_b32 s48, s41, 10
    s_lshl_b32 s36, s35, 2
    s_add_u32 s36, s36, 1
    s_mul_i32 s38, s36, 9363
    s_lshr_b32 s38, s38, 16
    s_mul_i32 s39, s38, 7
    s_sub_u32 s39, s36, s39
    s_sub_u32 s41, s39, 1
    s_cmp_eq_u32 s39, 0
    s_cselect_b32 s41, 6, s41
    s_and_b32 s40, s38, 1
    s_cmp_eq_u32 s40, 1
    s_cselect_b32 s39, s41, s39
    s_mov_b32 s41, 4
    s_mov_b32 s40, s39
    s_cmp_ge_u32 s39, 4
    s_cselect_b32 s41, 2, s41
    s_add_u32 s42, s39, 76
    s_cmp_ge_u32 s39, 4
    s_cselect_b32 s40, s42, s40
    s_cmp_eq_u32 s39, 6
    s_cselect_b32 s41, 1, s41
    s_cselect_b32 s40, 120, s40
    s_mul_i32 s42, s33, 10
    s_mul_i32 s42, s42, s41
    s_add_u32 s40, s40, s42
    s_mul_i32 s37, s38, 140
    s_add_u32 s37, s37, s40
    s_lshl_b32 s37, s37, 10
    s_add_u32 s45, s37, 24875008
    s_lshl_b32 s49, s41, 10
    s_lshl_b32 s36, s35, 2
    s_add_u32 s36, s36, 2
    s_mul_i32 s38, s36, 9363
    s_lshr_b32 s38, s38, 16
    s_mul_i32 s39, s38, 7
    s_sub_u32 s39, s36, s39
    s_sub_u32 s41, s39, 1
    s_cmp_eq_u32 s39, 0
    s_cselect_b32 s41, 6, s41
    s_and_b32 s40, s38, 1
    s_cmp_eq_u32 s40, 1
    s_cselect_b32 s39, s41, s39
    s_mov_b32 s41, 4
    s_mov_b32 s40, s39
    s_cmp_ge_u32 s39, 4
    s_cselect_b32 s41, 2, s41
    s_add_u32 s42, s39, 76
    s_cmp_ge_u32 s39, 4
    s_cselect_b32 s40, s42, s40
    s_cmp_eq_u32 s39, 6
    s_cselect_b32 s41, 1, s41
    s_cselect_b32 s40, 120, s40
    s_mul_i32 s42, s33, 10
    s_mul_i32 s42, s42, s41
    s_add_u32 s40, s40, s42
    s_mul_i32 s37, s38, 140
    s_add_u32 s37, s37, s40
    s_lshl_b32 s37, s37, 10
    s_add_u32 s46, s37, 24875008
    s_lshl_b32 s50, s41, 10
    s_lshl_b32 s36, s35, 2
    s_add_u32 s36, s36, 3
    s_mul_i32 s38, s36, 9363
    s_lshr_b32 s38, s38, 16
    s_mul_i32 s39, s38, 7
    s_sub_u32 s39, s36, s39
    s_sub_u32 s41, s39, 1
    s_cmp_eq_u32 s39, 0
    s_cselect_b32 s41, 6, s41
    s_and_b32 s40, s38, 1
    s_cmp_eq_u32 s40, 1
    s_cselect_b32 s39, s41, s39
    s_mov_b32 s41, 4
    s_mov_b32 s40, s39
    s_cmp_ge_u32 s39, 4
    s_cselect_b32 s41, 2, s41
    s_add_u32 s42, s39, 76
    s_cmp_ge_u32 s39, 4
    s_cselect_b32 s40, s42, s40
    s_cmp_eq_u32 s39, 6
    s_cselect_b32 s41, 1, s41
    s_cselect_b32 s40, 120, s40
    s_mul_i32 s42, s33, 10
    s_mul_i32 s42, s42, s41
    s_add_u32 s40, s40, s42
    s_mul_i32 s37, s38, 140
    s_add_u32 s37, s37, s40
    s_lshl_b32 s37, s37, 10
    s_add_u32 s47, s37, 24875008
    s_lshl_b32 s51, s41, 10
    v_mov_b32 v12, 0
    v_mov_b32 v13, 0
    v_mov_b32 v14, 0
    v_mov_b32 v15, 0
    v_mov_b32 v16, 0x3f803f80
    s_waitcnt vmcnt(36)
    ds_write_b128 v5, v[32:35] offset:0
    ds_write_b128 v5, v[36:39] offset:1152
    ds_write_b128 v5, v[40:43] offset:2304
    ds_write_b128 v5, v[44:47] offset:3456
    s_waitcnt lgkmcnt(0)
    ds_read_b64_tr_b16 v[200:201], v8 offset:0
    ds_read_b64_tr_b16 v[202:203], v8 offset:576
    ds_read_b64_tr_b16 v[204:205], v8 offset:32
    ds_read_b64_tr_b16 v[206:207], v8 offset:608
    ds_read_b64_tr_b16 v[208:209], v8 offset:64
    ds_read_b64_tr_b16 v[210:211], v8 offset:640
    ds_read_b64_tr_b16 v[212:213], v8 offset:96
    ds_read_b64_tr_b16 v[214:215], v8 offset:672
    s_waitcnt vmcnt(32)
    ds_write_b128 v5, v[48:51] offset:4608
    ds_write_b128 v5, v[52:55] offset:5760
    ds_write_b128 v5, v[56:59] offset:6912
    ds_write_b128 v5, v[60:63] offset:8064
    s_waitcnt lgkmcnt(4)
    buffer_store_dwordx4 v[200:203], v9, s[28:31], s44 offen sc1
    s_add_u32 s44, s44, s48
    v_dot2_f32_bf16 v12, v200, v16, v12
    v_dot2_f32_bf16 v12, v201, v16, v12
    v_dot2_f32_bf16 v12, v202, v16, v12
    v_dot2_f32_bf16 v12, v203, v16, v12
    buffer_store_dwordx4 v[204:207], v9, s[28:31], s45 offen sc1
    s_add_u32 s45, s45, s49
    v_dot2_f32_bf16 v13, v204, v16, v13
    v_dot2_f32_bf16 v13, v205, v16, v13
    v_dot2_f32_bf16 v13, v206, v16, v13
    v_dot2_f32_bf16 v13, v207, v16, v13
    buffer_store_dwordx4 v[208:211], v9, s[28:31], s46 offen sc1
    s_add_u32 s46, s46, s50
    v_dot2_f32_bf16 v14, v208, v16, v14
    v_dot2_f32_bf16 v14, v209, v16, v14
    v_dot2_f32_bf16 v14, v210, v16, v14
    v_dot2_f32_bf16 v14, v211, v16, v14
    buffer_store_dwordx4 v[212:215], v9, s[28:31], s47 offen sc1
    s_add_u32 s47, s47, s51
    v_dot2_f32_bf16 v15, v212, v16, v15
    v_dot2_f32_bf16 v15, v213, v16, v15
    v_dot2_f32_bf16 v15, v214, v16, v15
    v_dot2_f32_bf16 v15, v215, v16, v15
    s_waitcnt lgkmcnt(0)
    ds_read_b64_tr_b16 v[216:217], v8 offset:4608
    ds_read_b64_tr_b16 v[218:219], v8 offset:5184
    ds_read_b64_tr_b16 v[220:221], v8 offset:4640
    ds_read_b64_tr_b16 v[222:223], v8 offset:5216
    ds_read_b64_tr_b16 v[224:225], v8 offset:4672
    ds_read_b64_tr_b16 v[226:227], v8 offset:5248
    ds_read_b64_tr_b16 v[228:229], v8 offset:4704
    ds_read_b64_tr_b16 v[230:231], v8 offset:5280
    s_waitcnt vmcnt(32)
    ds_write_b128 v5, v[64:67] offset:0
    ds_write_b128 v5, v[68:71] offset:1152
    ds_write_b128 v5, v[72:75] offset:2304
    ds_write_b128 v5, v[76:79] offset:3456
    s_waitcnt lgkmcnt(4)
    buffer_store_dwordx4 v[216:219], v9, s[28:31], s44 offen sc1
    s_add_u32 s44, s44, s48
    v_dot2_f32_bf16 v12, v216, v16, v12
    v_dot2_f32_bf16 v12, v217, v16, v12
    v_dot2_f32_bf16 v12, v218, v16, v12
    v_dot2_f32_bf16 v12, v219, v16, v12
    buffer_store_dwordx4 v[220:223], v9, s[28:31], s45 offen sc1
    s_add_u32 s45, s45, s49
    v_dot2_f32_bf16 v13, v220, v16, v13
    v_dot2_f32_bf16 v13, v221, v16, v13
    v_dot2_f32_bf16 v13, v222, v16, v13
    v_dot2_f32_bf16 v13, v223, v16, v13
    buffer_store_dwordx4 v[224:227], v9, s[28:31], s46 offen sc1
    s_add_u32 s46, s46, s50
    v_dot2_f32_bf16 v14, v224, v16, v14
    v_dot2_f32_bf16 v14, v225, v16, v14
    v_dot2_f32_bf16 v14, v226, v16, v14
    v_dot2_f32_bf16 v14, v227, v16, v14
    buffer_store_dwordx4 v[228:231], v9, s[28:31], s47 offen sc1
    s_add_u32 s47, s47, s51
    v_dot2_f32_bf16 v15, v228, v16, v15
    v_dot2_f32_bf16 v15, v229, v16, v15
    v_dot2_f32_bf16 v15, v230, v16, v15
    v_dot2_f32_bf16 v15, v231, v16, v15
    s_waitcnt lgkmcnt(0)
    ds_read_b64_tr_b16 v[200:201], v8 offset:0
    ds_read_b64_tr_b16 v[202:203], v8 offset:576
    ds_read_b64_tr_b16 v[204:205], v8 offset:32
    ds_read_b64_tr_b16 v[206:207], v8 offset:608
    ds_read_b64_tr_b16 v[208:209], v8 offset:64
    ds_read_b64_tr_b16 v[210:211], v8 offset:640
    ds_read_b64_tr_b16 v[212:213], v8 offset:96
    ds_read_b64_tr_b16 v[214:215], v8 offset:672
    s_waitcnt vmcnt(32)
    ds_write_b128 v5, v[80:83] offset:4608
    ds_write_b128 v5, v[84:87] offset:5760
    ds_write_b128 v5, v[88:91] offset:6912
    ds_write_b128 v5, v[92:95] offset:8064
    s_waitcnt lgkmcnt(4)
    buffer_store_dwordx4 v[200:203], v9, s[28:31], s44 offen sc1
    s_add_u32 s44, s44, s48
    v_dot2_f32_bf16 v12, v200, v16, v12
    v_dot2_f32_bf16 v12, v201, v16, v12
    v_dot2_f32_bf16 v12, v202, v16, v12
    v_dot2_f32_bf16 v12, v203, v16, v12
    buffer_store_dwordx4 v[204:207], v9, s[28:31], s45 offen sc1
    s_add_u32 s45, s45, s49
    v_dot2_f32_bf16 v13, v204, v16, v13
    v_dot2_f32_bf16 v13, v205, v16, v13
    v_dot2_f32_bf16 v13, v206, v16, v13
    v_dot2_f32_bf16 v13, v207, v16, v13
    buffer_store_dwordx4 v[208:211], v9, s[28:31], s46 offen sc1
    s_add_u32 s46, s46, s50
    v_dot2_f32_bf16 v14, v208, v16, v14
    v_dot2_f32_bf16 v14, v209, v16, v14
    v_dot2_f32_bf16 v14, v210, v16, v14
    v_dot2_f32_bf16 v14, v211, v16, v14
    buffer_store_dwordx4 v[212:215], v9, s[28:31], s47 offen sc1
    s_add_u32 s47, s47, s51
    v_dot2_f32_bf16 v15, v212, v16, v15
    v_dot2_f32_bf16 v15, v213, v16, v15
    v_dot2_f32_bf16 v15, v214, v16, v15
    v_dot2_f32_bf16 v15, v215, v16, v15
    s_waitcnt lgkmcnt(0)
    ds_read_b64_tr_b16 v[216:217], v8 offset:4608
    ds_read_b64_tr_b16 v[218:219], v8 offset:5184
    ds_read_b64_tr_b16 v[220:221], v8 offset:4640
    ds_read_b64_tr_b16 v[222:223], v8 offset:5216
    ds_read_b64_tr_b16 v[224:225], v8 offset:4672
    ds_read_b64_tr_b16 v[226:227], v8 offset:5248
    ds_read_b64_tr_b16 v[228:229], v8 offset:4704
    ds_read_b64_tr_b16 v[230:231], v8 offset:5280
    s_waitcnt vmcnt(32)
    ds_write_b128 v5, v[96:99] offset:0
    ds_write_b128 v5, v[100:103] offset:1152
    ds_write_b128 v5, v[104:107] offset:2304
    ds_write_b128 v5, v[108:111] offset:3456
    s_waitcnt lgkmcnt(4)
    buffer_store_dwordx4 v[216:219], v9, s[28:31], s44 offen sc1
    s_add_u32 s44, s44, s48
    v_dot2_f32_bf16 v12, v216, v16, v12
    v_dot2_f32_bf16 v12, v217, v16, v12
    v_dot2_f32_bf16 v12, v218, v16, v12
    v_dot2_f32_bf16 v12, v219, v16, v12
    buffer_store_dwordx4 v[220:223], v9, s[28:31], s45 offen sc1
    s_add_u32 s45, s45, s49
    v_dot2_f32_bf16 v13, v220, v16, v13
    v_dot2_f32_bf16 v13, v221, v16, v13
    v_dot2_f32_bf16 v13, v222, v16, v13
    v_dot2_f32_bf16 v13, v223, v16, v13
    buffer_store_dwordx4 v[224:227], v9, s[28:31], s46 offen sc1
    s_add_u32 s46, s46, s50
    v_dot2_f32_bf16 v14, v224, v16, v14
    v_dot2_f32_bf16 v14, v225, v16, v14
    v_dot2_f32_bf16 v14, v226, v16, v14
    v_dot2_f32_bf16 v14, v227, v16, v14
    buffer_store_dwordx4 v[228:231], v9, s[28:31], s47 offen sc1
    s_add_u32 s47, s47, s51
    v_dot2_f32_bf16 v15, v228, v16, v15
    v_dot2_f32_bf16 v15, v229, v16, v15
    v_dot2_f32_bf16 v15, v230, v16, v15
    v_dot2_f32_bf16 v15, v231, v16, v15
    s_waitcnt lgkmcnt(0)
    ds_read_b64_tr_b16 v[200:201], v8 offset:0
    ds_read_b64_tr_b16 v[202:203], v8 offset:576
    ds_read_b64_tr_b16 v[204:205], v8 offset:32
    ds_read_b64_tr_b16 v[206:207], v8 offset:608
    ds_read_b64_tr_b16 v[208:209], v8 offset:64
    ds_read_b64_tr_b16 v[210:211], v8 offset:640
    ds_read_b64_tr_b16 v[212:213], v8 offset:96
    ds_read_b64_tr_b16 v[214:215], v8 offset:672
    s_waitcnt vmcnt(32)
    ds_write_b128 v5, v[112:115] offset:4608
    ds_write_b128 v5, v[116:119] offset:5760
    ds_write_b128 v5, v[120:123] offset:6912
    ds_write_b128 v5, v[124:127] offset:8064
    s_waitcnt lgkmcnt(4)
    buffer_store_dwordx4 v[200:203], v9, s[28:31], s44 offen sc1
    s_add_u32 s44, s44, s48
    v_dot2_f32_bf16 v12, v200, v16, v12
    v_dot2_f32_bf16 v12, v201, v16, v12
    v_dot2_f32_bf16 v12, v202, v16, v12
    v_dot2_f32_bf16 v12, v203, v16, v12
    buffer_store_dwordx4 v[204:207], v9, s[28:31], s45 offen sc1
    s_add_u32 s45, s45, s49
    v_dot2_f32_bf16 v13, v204, v16, v13
    v_dot2_f32_bf16 v13, v205, v16, v13
    v_dot2_f32_bf16 v13, v206, v16, v13
    v_dot2_f32_bf16 v13, v207, v16, v13
    buffer_store_dwordx4 v[208:211], v9, s[28:31], s46 offen sc1
    s_add_u32 s46, s46, s50
    v_dot2_f32_bf16 v14, v208, v16, v14
    v_dot2_f32_bf16 v14, v209, v16, v14
    v_dot2_f32_bf16 v14, v210, v16, v14
    v_dot2_f32_bf16 v14, v211, v16, v14
    buffer_store_dwordx4 v[212:215], v9, s[28:31], s47 offen sc1
    s_add_u32 s47, s47, s51
    v_dot2_f32_bf16 v15, v212, v16, v15
    v_dot2_f32_bf16 v15, v213, v16, v15
    v_dot2_f32_bf16 v15, v214, v16, v15
    v_dot2_f32_bf16 v15, v215, v16, v15
    s_waitcnt lgkmcnt(0)
    ds_read_b64_tr_b16 v[216:217], v8 offset:4608
    ds_read_b64_tr_b16 v[218:219], v8 offset:5184
    ds_read_b64_tr_b16 v[220:221], v8 offset:4640
    ds_read_b64_tr_b16 v[222:223], v8 offset:5216
    ds_read_b64_tr_b16 v[224:225], v8 offset:4672
    ds_read_b64_tr_b16 v[226:227], v8 offset:5248
    ds_read_b64_tr_b16 v[228:229], v8 offset:4704
    ds_read_b64_tr_b16 v[230:231], v8 offset:5280
    s_waitcnt vmcnt(32)
    ds_write_b128 v5, v[128:131] offset:0
    ds_write_b128 v5, v[132:135] offset:1152
    ds_write_b128 v5, v[136:139] offset:2304
    ds_write_b128 v5, v[140:143] offset:3456
    s_waitcnt lgkmcnt(4)
    buffer_store_dwordx4 v[216:219], v9, s[28:31], s44 offen sc1
    s_add_u32 s44, s44, s48
    v_dot2_f32_bf16 v12, v216, v16, v12
    v_dot2_f32_bf16 v12, v217, v16, v12
    v_dot2_f32_bf16 v12, v218, v16, v12
    v_dot2_f32_bf16 v12, v219, v16, v12
    buffer_store_dwordx4 v[220:223], v9, s[28:31], s45 offen sc1
    s_add_u32 s45, s45, s49
    v_dot2_f32_bf16 v13, v220, v16, v13
    v_dot2_f32_bf16 v13, v221, v16, v13
    v_dot2_f32_bf16 v13, v222, v16, v13
    v_dot2_f32_bf16 v13, v223, v16, v13
    buffer_store_dwordx4 v[224:227], v9, s[28:31], s46 offen sc1
    s_add_u32 s46, s46, s50
    v_dot2_f32_bf16 v14, v224, v16, v14
    v_dot2_f32_bf16 v14, v225, v16, v14
    v_dot2_f32_bf16 v14, v226, v16, v14
    v_dot2_f32_bf16 v14, v227, v16, v14
    buffer_store_dwordx4 v[228:231], v9, s[28:31], s47 offen sc1
    s_add_u32 s47, s47, s51
    v_dot2_f32_bf16 v15, v228, v16, v15
    v_dot2_f32_bf16 v15, v229, v16, v15
    v_dot2_f32_bf16 v15, v230, v16, v15
    v_dot2_f32_bf16 v15, v231, v16, v15
    s_waitcnt lgkmcnt(0)
    ds_read_b64_tr_b16 v[200:201], v8 offset:0
    ds_read_b64_tr_b16 v[202:203], v8 offset:576
    ds_read_b64_tr_b16 v[204:205], v8 offset:32
    ds_read_b64_tr_b16 v[206:207], v8 offset:608
    ds_read_b64_tr_b16 v[208:209], v8 offset:64
    ds_read_b64_tr_b16 v[210:211], v8 offset:640
    ds_read_b64_tr_b16 v[212:213], v8 offset:96
    ds_read_b64_tr_b16 v[214:215], v8 offset:672
    s_waitcnt vmcnt(32)
    ds_write_b128 v5, v[144:147] offset:4608
    ds_write_b128 v5, v[148:151] offset:5760
    ds_write_b128 v5, v[152:155] offset:6912
    ds_write_b128 v5, v[156:159] offset:8064
    s_waitcnt lgkmcnt(4)
    buffer_store_dwordx4 v[200:203], v9, s[28:31], s44 offen sc1
    s_add_u32 s44, s44, s48
    v_dot2_f32_bf16 v12, v200, v16, v12
    v_dot2_f32_bf16 v12, v201, v16, v12
    v_dot2_f32_bf16 v12, v202, v16, v12
    v_dot2_f32_bf16 v12, v203, v16, v12
    buffer_store_dwordx4 v[204:207], v9, s[28:31], s45 offen sc1
    s_add_u32 s45, s45, s49
    v_dot2_f32_bf16 v13, v204, v16, v13
    v_dot2_f32_bf16 v13, v205, v16, v13
    v_dot2_f32_bf16 v13, v206, v16, v13
    v_dot2_f32_bf16 v13, v207, v16, v13
    buffer_store_dwordx4 v[208:211], v9, s[28:31], s46 offen sc1
    s_add_u32 s46, s46, s50
    v_dot2_f32_bf16 v14, v208, v16, v14
    v_dot2_f32_bf16 v14, v209, v16, v14
    v_dot2_f32_bf16 v14, v210, v16, v14
    v_dot2_f32_bf16 v14, v211, v16, v14
    buffer_store_dwordx4 v[212:215], v9, s[28:31], s47 offen sc1
    s_add_u32 s47, s47, s51
    v_dot2_f32_bf16 v15, v212, v16, v15
    v_dot2_f32_bf16 v15, v213, v16, v15
    v_dot2_f32_bf16 v15, v214, v16, v15
    v_dot2_f32_bf16 v15, v215, v16, v15
    s_waitcnt lgkmcnt(0)
    ds_read_b64_tr_b16 v[216:217], v8 offset:4608
    ds_read_b64_tr_b16 v[218:219], v8 offset:5184
    ds_read_b64_tr_b16 v[220:221], v8 offset:4640
    ds_read_b64_tr_b16 v[222:223], v8 offset:5216
    ds_read_b64_tr_b16 v[224:225], v8 offset:4672
    ds_read_b64_tr_b16 v[226:227], v8 offset:5248
    ds_read_b64_tr_b16 v[228:229], v8 offset:4704
    ds_read_b64_tr_b16 v[230:231], v8 offset:5280
    s_waitcnt vmcnt(32)
    ds_write_b128 v5, v[160:163] offset:0
    ds_write_b128 v5, v[164:167] offset:1152
    ds_write_b128 v5, v[168:171] offset:2304
    ds_write_b128 v5, v[172:175] offset:3456
    s_waitcnt lgkmcnt(4)
    buffer_store_dwordx4 v[216:219], v9, s[28:31], s44 offen sc1
    s_add_u32 s44, s44, s48
    v_dot2_f32_bf16 v12, v216, v16, v12
    v_dot2_f32_bf16 v12, v217, v16, v12
    v_dot2_f32_bf16 v12, v218, v16, v12
    v_dot2_f32_bf16 v12, v219, v16, v12
    buffer_store_dwordx4 v[220:223], v9, s[28:31], s45 offen sc1
    s_add_u32 s45, s45, s49
    v_dot2_f32_bf16 v13, v220, v16, v13
    v_dot2_f32_bf16 v13, v221, v16, v13
    v_dot2_f32_bf16 v13, v222, v16, v13
    v_dot2_f32_bf16 v13, v223, v16, v13
    buffer_store_dwordx4 v[224:227], v9, s[28:31], s46 offen sc1
    s_add_u32 s46, s46, s50
    v_dot2_f32_bf16 v14, v224, v16, v14
    v_dot2_f32_bf16 v14, v225, v16, v14
    v_dot2_f32_bf16 v14, v226, v16, v14
    v_dot2_f32_bf16 v14, v227, v16, v14
    buffer_store_dwordx4 v[228:231], v9, s[28:31], s47 offen sc1
    s_add_u32 s47, s47, s51
    v_dot2_f32_bf16 v15, v228, v16, v15
    v_dot2_f32_bf16 v15, v229, v16, v15
    v_dot2_f32_bf16 v15, v230, v16, v15
    v_dot2_f32_bf16 v15, v231, v16, v15
    s_waitcnt lgkmcnt(0)
    ds_read_b64_tr_b16 v[200:201], v8 offset:0
    ds_read_b64_tr_b16 v[202:203], v8 offset:576
    ds_read_b64_tr_b16 v[204:205], v8 offset:32
    ds_read_b64_tr_b16 v[206:207], v8 offset:608
    ds_read_b64_tr_b16 v[208:209], v8 offset:64
    ds_read_b64_tr_b16 v[210:211], v8 offset:640
    ds_read_b64_tr_b16 v[212:213], v8 offset:96
    ds_read_b64_tr_b16 v[214:215], v8 offset:672
    s_waitcnt vmcnt(32)
    ds_write_b128 v5, v[176:179] offset:4608
    ds_write_b128 v5, v[180:183] offset:5760
    ds_write_b128 v5, v[184:187] offset:6912
    ds_write_b128 v5, v[188:191] offset:8064
    s_waitcnt lgkmcnt(4)
    buffer_store_dwordx4 v[200:203], v9, s[28:31], s44 offen sc1
    s_add_u32 s44, s44, s48
    v_dot2_f32_bf16 v12, v200, v16, v12
    v_dot2_f32_bf16 v12, v201, v16, v12
    v_dot2_f32_bf16 v12, v202, v16, v12
    v_dot2_f32_bf16 v12, v203, v16, v12
    buffer_store_dwordx4 v[204:207], v9, s[28:31], s45 offen sc1
    s_add_u32 s45, s45, s49
    v_dot2_f32_bf16 v13, v204, v16, v13
    v_dot2_f32_bf16 v13, v205, v16, v13
    v_dot2_f32_bf16 v13, v206, v16, v13
    v_dot2_f32_bf16 v13, v207, v16, v13
    buffer_store_dwordx4 v[208:211], v9, s[28:31], s46 offen sc1
    s_add_u32 s46, s46, s50
    v_dot2_f32_bf16 v14, v208, v16, v14
    v_dot2_f32_bf16 v14, v209, v16, v14
    v_dot2_f32_bf16 v14, v210, v16, v14
    v_dot2_f32_bf16 v14, v211, v16, v14
    buffer_store_dwordx4 v[212:215], v9, s[28:31], s47 offen sc1
    s_add_u32 s47, s47, s51
    v_dot2_f32_bf16 v15, v212, v16, v15
    v_dot2_f32_bf16 v15, v213, v16, v15
    v_dot2_f32_bf16 v15, v214, v16, v15
    v_dot2_f32_bf16 v15, v215, v16, v15
    s_waitcnt lgkmcnt(0)
    ds_read_b64_tr_b16 v[216:217], v8 offset:4608
    ds_read_b64_tr_b16 v[218:219], v8 offset:5184
    ds_read_b64_tr_b16 v[220:221], v8 offset:4640
    ds_read_b64_tr_b16 v[222:223], v8 offset:5216
    ds_read_b64_tr_b16 v[224:225], v8 offset:4672
    ds_read_b64_tr_b16 v[226:227], v8 offset:5248
    ds_read_b64_tr_b16 v[228:229], v8 offset:4704
    ds_read_b64_tr_b16 v[230:231], v8 offset:5280
    s_waitcnt lgkmcnt(0)
    buffer_store_dwordx4 v[216:219], v9, s[28:31], s44 offen sc1
    s_add_u32 s44, s44, s48
    v_dot2_f32_bf16 v12, v216, v16, v12
    v_dot2_f32_bf16 v12, v217, v16, v12
    v_dot2_f32_bf16 v12, v218, v16, v12
    v_dot2_f32_bf16 v12, v219, v16, v12
    buffer_store_dwordx4 v[220:223], v9, s[28:31], s45 offen sc1
    s_add_u32 s45, s45, s49
    v_dot2_f32_bf16 v13, v220, v16, v13
    v_dot2_f32_bf16 v13, v221, v16, v13
    v_dot2_f32_bf16 v13, v222, v16, v13
    v_dot2_f32_bf16 v13, v223, v16, v13
    buffer_store_dwordx4 v[224:227], v9, s[28:31], s46 offen sc1
    s_add_u32 s46, s46, s50
    v_dot2_f32_bf16 v14, v224, v16, v14
    v_dot2_f32_bf16 v14, v225, v16, v14
    v_dot2_f32_bf16 v14, v226, v16, v14
    v_dot2_f32_bf16 v14, v227, v16, v14
    buffer_store_dwordx4 v[228:231], v9, s[28:31], s47 offen sc1
    s_add_u32 s47, s47, s51
    v_dot2_f32_bf16 v15, v228, v16, v15
    v_dot2_f32_bf16 v15, v229, v16, v15
    v_dot2_f32_bf16 v15, v230, v16, v15
    v_dot2_f32_bf16 v15, v231, v16, v15
    s_nop 2
    v_mov_b32 v20, v12
    v_mov_b32 v21, v13
    v_mov_b32 v22, v14
    v_mov_b32 v23, v15
    s_nop 1
    v_permlane32_swap_b32 v20, v12
    v_permlane32_swap_b32 v21, v13
    v_permlane32_swap_b32 v22, v14
    v_permlane32_swap_b32 v23, v15
    s_nop 1
    v_add_f32 v12, v12, v20
    v_add_f32 v13, v13, v21
    v_add_f32 v14, v14, v22
    v_add_f32 v15, v15, v23
    v_mov_b32 v20, v12
    v_mov_b32 v21, v13
    v_mov_b32 v22, v14
    v_mov_b32 v23, v15
    s_nop 1
    v_permlane16_swap_b32 v20, v12
    v_permlane16_swap_b32 v21, v13
    v_permlane16_swap_b32 v22, v14
    v_permlane16_swap_b32 v23, v15
    s_nop 1
    v_add_f32 v12, v12, v20
    v_add_f32 v13, v13, v21
    v_add_f32 v14, v14, v22
    v_add_f32 v15, v15, v23
    s_mul_i32 s38, s33, 7168
    s_lshl_b32 s39, s35, 8
    s_add_u32 s38, s38, s39
    s_add_u32 s38, s38, 8130560
    v_lshlrev_b32 v17, 2, v1
    s_mov_b64 exec, 0xffff
    buffer_store_dword v12, v17, s[28:31], s38 offen offset:0 sc1
    buffer_store_dword v13, v17, s[28:31], s38 offen offset:64 sc1
    buffer_store_dword v14, v17, s[28:31], s38 offen offset:128 sc1
    buffer_store_dword v15, v17, s[28:31], s38 offen offset:192 sc1
    s_endpgm
prep_kernel_pk28:
    s_mov_b32 s24, s18
    s_mov_b32 s25, s19
    s_mov_b32 s26, 2211840
    s_mov_b32 s27, 0x00020000
    s_sub_u32 s32, s21, 94
    s_mul_i32 s33, s32, 52429
    s_lshr_b32 s33, s33, 19
    s_mul_i32 s35, s33, 10
    s_sub_u32 s35, s32, s35
    v_mul_u32_u24 v10, 1280, v3
    v_lshl_add_u32 v10, v4, 4, v10
    s_mul_i32 s36, s33, 368640
    s_lshl_b32 s37, s35, 7
    s_add_u32 s36, s36, s37
    buffer_load_dwordx4 v[32:35], v10, s[24:27], s36 offen nt
    s_add_u32 s36, s36, 10240
    buffer_load_dwordx4 v[36:39], v10, s[24:27], s36 offen nt
    s_add_u32 s36, s36, 10240
    buffer_load_dwordx4 v[40:43], v10, s[24:27], s36 offen nt
    s_add_u32 s36, s36, 10240
    buffer_load_dwordx4 v[44:47], v10, s[24:27], s36 offen nt
    s_add_u32 s36, s36, 10240
    buffer_load_dwordx4 v[48:51], v10, s[24:27], s36 offen nt
    s_add_u32 s36, s36, 10240
    buffer_load_dwordx4 v[52:55], v10, s[24:27], s36 offen nt
    s_add_u32 s36, s36, 10240
    buffer_load_dwordx4 v[56:59], v10, s[24:27], s36 offen nt
    s_add_u32 s36, s36, 10240
    buffer_load_dwordx4 v[60:63], v10, s[24:27], s36 offen nt
    s_add_u32 s36, s36, 10240
    buffer_load_dwordx4 v[64:67], v10, s[24:27], s36 offen nt
    s_add_u32 s36, s36, 10240
    buffer_load_dwordx4 v[68:71], v10, s[24:27], s36 offen nt
    s_add_u32 s36, s36, 10240
    buffer_load_dwordx4 v[72:75], v10, s[24:27], s36 offen nt
    s_add_u32 s36, s36, 10240
    buffer_load_dwordx4 v[76:79], v10, s[24:27], s36 offen nt
    s_add_u32 s36, s36, 10240
    buffer_load_dwordx4 v[80:83], v10, s[24:27], s36 offen nt
    s_add_u32 s36, s36, 10240
    buffer_load_dwordx4 v[84:87], v10, s[24:27], s36 offen nt
    s_add_u32 s36, s36, 10240
    buffer_load_dwordx4 v[88:91], v10, s[24:27], s36 offen nt
    s_add_u32 s36, s36, 10240
    buffer_load_dwordx4 v[92:95], v10, s[24:27], s36 offen nt
    s_add_u32 s36, s36, 10240
    buffer_load_dwordx4 v[96:99], v10, s[24:27], s36 offen nt
    s_add_u32 s36, s36, 10240
    buffer_load_dwordx4 v[100:103], v10, s[24:27], s36 offen nt
    s_add_u32 s36, s36, 10240
    buffer_load_dwordx4 v[104:107], v10, s[24:27], s36 offen nt
    s_add_u32 s36, s36, 10240
    buffer_load_dwordx4 v[108:111], v10, s[24:27], s36 offen nt
    s_add_u32 s36, s36, 10240
    buffer_load_dwordx4 v[112:115], v10, s[24:27], s36 offen nt
    s_add_u32 s36, s36, 10240
    buffer_load_dwordx4 v[116:119], v10, s[24:27], s36 offen nt
    s_add_u32 s36, s36, 10240
    buffer_load_dwordx4 v[120:123], v10, s[24:27], s36 offen nt
    s_add_u32 s36, s36, 10240
    buffer_load_dwordx4 v[124:127], v10, s[24:27], s36 offen nt
    s_add_u32 s36, s36, 10240
    buffer_load_dwordx4 v[128:131], v10, s[24:27], s36 offen nt
    s_add_u32 s36, s36, 10240
    buffer_load_dwordx4 v[132:135], v10, s[24:27], s36 offen nt
    s_add_u32 s36, s36, 10240
    buffer_load_dwordx4 v[136:139], v10, s[24:27], s36 offen nt
    s_add_u32 s36, s36, 10240
    buffer_load_dwordx4 v[140:143], v10, s[24:27], s36 offen nt
    s_add_u32 s36, s36, 10240
    buffer_load_dwordx4 v[144:147], v10, s[24:27], s36 offen nt
    s_add_u32 s36, s36, 10240
    buffer_load_dwordx4 v[148:151], v10, s[24:27], s36 offen nt
    s_add_u32 s36, s36, 10240
    buffer_load_dwordx4 v[152:155], v10, s[24:27], s36 offen nt
    s_add_u32 s36, s36, 10240
    buffer_load_dwordx4 v[156:159], v10, s[24:27], s36 offen nt
    s_add_u32 s36, s36, 10240
    buffer_load_dwordx4 v[160:163], v10, s[24:27], s36 offen nt
    s_add_u32 s36, s36, 10240
    buffer_load_dwordx4 v[164:167], v10, s[24:27], s36 offen nt
    s_add_u32 s36, s36, 10240
    buffer_load_dwordx4 v[168:171], v10, s[24:27], s36 offen nt
    s_add_u32 s36, s36, 10240
    buffer_load_dwordx4 v[172:175], v10, s[24:27], s36 offen nt
    s_lshl_b32 s36, s35, 2
    s_add_u32 s36, s36, 0
    s_mul_i32 s38, s36, 13108
    s_lshr_b32 s38, s38, 16
    s_mul_i32 s39, s38, 5
    s_sub_u32 s39, s36, s39
    s_sub_u32 s41, s39, 1
    s_cmp_eq_u32 s39, 0
    s_cselect_b32 s41, 4, s41
    s_and_b32 s40, s38, 1
    s_cmp_eq_u32 s40, 1
    s_cselect_b32 s39, s41, s39
    s_mul_i32 s40, s33, 21846
    s_lshr_b32 s40, s40, 16
    s_mul_i32 s41, s40, 3
    s_sub_u32 s41, s33, s41
    s_mul_i32 s37, s38, 270
    s_mul_i32 s41, s41, 90
    s_add_u32 s37, s37, s41
    s_mul_i32 s40, s40, 5
    s_add_u32 s37, s37, s40
    s_add_u32 s37, s37, s39
    s_lshl_b32 s37, s37, 10
    s_add_u32 s44, s37, 27168768
    s_movk_i32 s48, 10240
    s_lshl_b32 s36, s35, 2
    s_add_u32 s36, s36, 1
    s_mul_i32 s38, s36, 13108
    s_lshr_b32 s38, s38, 16
    s_mul_i32 s39, s38, 5
    s_sub_u32 s39, s36, s39
    s_sub_u32 s41, s39, 1
    s_cmp_eq_u32 s39, 0
    s_cselect_b32 s41, 4, s41
    s_and_b32 s40, s38, 1
    s_cmp_eq_u32 s40, 1
    s_cselect_b32 s39, s41, s39
    s_mul_i32 s40, s33, 21846
    s_lshr_b32 s40, s40, 16
    s_mul_i32 s41, s40, 3
    s_sub_u32 s41, s33, s41
    s_mul_i32 s37, s38, 270
    s_mul_i32 s41, s41, 90
    s_add_u32 s37, s37, s41
    s_mul_i32 s40, s40, 5
    s_add_u32 s37, s37, s40
    s_add_u32 s37, s37, s39
    s_lshl_b32 s37, s37, 10
    s_add_u32 s45, s37, 27168768
    s_movk_i32 s49, 10240
    s_lshl_b32 s36, s35, 2
    s_add_u32 s36, s36, 2
    s_mul_i32 s38, s36, 13108
    s_lshr_b32 s38, s38, 16
    s_mul_i32 s39, s38, 5
    s_sub_u32 s39, s36, s39
    s_sub_u32 s41, s39, 1
    s_cmp_eq_u32 s39, 0
    s_cselect_b32 s41, 4, s41
    s_and_b32 s40, s38, 1
    s_cmp_eq_u32 s40, 1
    s_cselect_b32 s39, s41, s39
    s_mul_i32 s40, s33, 21846
    s_lshr_b32 s40, s40, 16
    s_mul_i32 s41, s40, 3
    s_sub_u32 s41, s33, s41
    s_mul_i32 s37, s38, 270
    s_mul_i32 s41, s41, 90
    s_add_u32 s37, s37, s41
    s_mul_i32 s40, s40, 5
    s_add_u32 s37, s37, s40
    s_add_u32 s37, s37, s39
    s_lshl_b32 s37, s37, 10
    s_add_u32 s46, s37, 27168768
    s_movk_i32 s50, 10240
    s_lshl_b32 s36, s35, 2
    s_add_u32 s36, s36, 3
    s_mul_i32 s38, s36, 13108
    s_lshr_b32 s38, s38, 16
    s_mul_i32 s39, s38, 5
    s_sub_u32 s39, s36, s39
    s_sub_u32 s41, s39, 1
    s_cmp_eq_u32 s39, 0
    s_cselect_b32 s41, 4, s41
    s_and_b32 s40, s38, 1
    s_cmp_eq_u32 s40, 1
    s_cselect_b32 s39, s41, s39
    s_mul_i32 s40, s33, 21846
    s_lshr_b32 s40, s40, 16
    s_mul_i32 s41, s40, 3
    s_sub_u32 s41, s33, s41
    s_mul_i32 s37, s38, 270
    s_mul_i32 s41, s41, 90
    s_add_u32 s37, s37, s41
    s_mul_i32 s40, s40, 5
    s_add_u32 s37, s37, s40
    s_add_u32 s37, s37, s39
    s_lshl_b32 s37, s37, 10
    s_add_u32 s47, s37, 27168768
    s_movk_i32 s51, 10240
    s_waitcnt vmcnt(32)
    ds_write_b128 v5, v[32:35] offset:0
    ds_write_b128 v5, v[36:39] offset:1152
    ds_write_b128 v5, v[40:43] offset:2304
    ds_write_b128 v5, v[44:47] offset:3456
    s_waitcnt lgkmcnt(0)
    ds_read_b64_tr_b16 v[200:201], v8 offset:0
    ds_read_b64_tr_b16 v[202:203], v8 offset:576
    ds_read_b64_tr_b16 v[204:205], v8 offset:32
    ds_read_b64_tr_b16 v[206:207], v8 offset:608
    ds_read_b64_tr_b16 v[208:209], v8 offset:64
    ds_read_b64_tr_b16 v[210:211], v8 offset:640
    ds_read_b64_tr_b16 v[212:213], v8 offset:96
    ds_read_b64_tr_b16 v[214:215], v8 offset:672
    s_waitcnt vmcnt(28)
    ds_write_b128 v5, v[48:51] offset:4608
    ds_write_b128 v5, v[52:55] offset:5760
    ds_write_b128 v5, v[56:59] offset:6912
    ds_write_b128 v5, v[60:63] offset:8064
    s_waitcnt lgkmcnt(4)
    buffer_store_dwordx4 v[200:203], v9, s[28:31], s44 offen sc1
    s_add_u32 s44, s44, s48
    buffer_store_dwordx4 v[204:207], v9, s[28:31], s45 offen sc1
    s_add_u32 s45, s45, s49
    buffer_store_dwordx4 v[208:211], v9, s[28:31], s46 offen sc1
    s_add_u32 s46, s46, s50
    buffer_store_dwordx4 v[212:215], v9, s[28:31], s47 offen sc1
    s_add_u32 s47, s47, s51
    s_waitcnt lgkmcnt(0)
    ds_read_b64_tr_b16 v[216:217], v8 offset:4608
    ds_read_b64_tr_b16 v[218:219], v8 offset:5184
    ds_read_b64_tr_b16 v[220:221], v8 offset:4640
    ds_read_b64_tr_b16 v[222:223], v8 offset:5216
    ds_read_b64_tr_b16 v[224:225], v8 offset:4672
    ds_read_b64_tr_b16 v[226:227], v8 offset:5248
    ds_read_b64_tr_b16 v[228:229], v8 offset:4704
    ds_read_b64_tr_b16 v[230:231], v8 offset:5280
    s_waitcnt vmcnt(28)
    ds_write_b128 v5, v[64:67] offset:0
    ds_write_b128 v5, v[68:71] offset:1152
    ds_write_b128 v5, v[72:75] offset:2304
    ds_write_b128 v5, v[76:79] offset:3456
    s_waitcnt lgkmcnt(4)
    buffer_store_dwordx4 v[216:219], v9, s[28:31], s44 offen sc1
    s_add_u32 s44, s44, s48
    buffer_store_dwordx4 v[220:223], v9, s[28:31], s45 offen sc1
    s_add_u32 s45, s45, s49
    buffer_store_dwordx4 v[224:227], v9, s[28:31], s46 offen sc1
    s_add_u32 s46, s46, s50
    buffer_store_dwordx4 v[228:231], v9, s[28:31], s47 offen sc1
    s_add_u32 s47, s47, s51
    s_waitcnt lgkmcnt(0)
    ds_read_b64_tr_b16 v[200:201], v8 offset:0
    ds_read_b64_tr_b16 v[202:203], v8 offset:576
    ds_read_b64_tr_b16 v[204:205], v8 offset:32
    ds_read_b64_tr_b16 v[206:207], v8 offset:608
    ds_read_b64_tr_b16 v[208:209], v8 offset:64
    ds_read_b64_tr_b16 v[210:211], v8 offset:640
    ds_read_b64_tr_b16 v[212:213], v8 offset:96
    ds_read_b64_tr_b16 v[214:215], v8 offset:672
    s_waitcnt vmcnt(28)
    ds_write_b128 v5, v[80:83] offset:4608
    ds_write_b128 v5, v[84:87] offset:5760
    ds_write_b128 v5, v[88:91] offset:6912
    ds_write_b128 v5, v[92:95] offset:8064
    s_waitcnt lgkmcnt(4)
    buffer_store_dwordx4 v[200:203], v9, s[28:31], s44 offen sc1
    s_add_u32 s44, s44, s48
    buffer_store_dwordx4 v[204:207], v9, s[28:31], s45 offen sc1
    s_add_u32 s45, s45, s49
    buffer_store_dwordx4 v[208:211], v9, s[28:31], s46 offen sc1
    s_add_u32 s46, s46, s50
    buffer_store_dwordx4 v[212:215], v9, s[28:31], s47 offen sc1
    s_add_u32 s47, s47, s51
    s_waitcnt lgkmcnt(0)
    ds_read_b64_tr_b16 v[216:217], v8 offset:4608
    ds_read_b64_tr_b16 v[218:219], v8 offset:5184
    ds_read_b64_tr_b16 v[220:221], v8 offset:4640
    ds_read_b64_tr_b16 v[222:223], v8 offset:5216
    ds_read_b64_tr_b16 v[224:225], v8 offset:4672
    ds_read_b64_tr_b16 v[226:227], v8 offset:5248
    ds_read_b64_tr_b16 v[228:229], v8 offset:4704
    ds_read_b64_tr_b16 v[230:231], v8 offset:5280
    s_waitcnt vmcnt(28)
    ds_write_b128 v5, v[96:99] offset:0
    ds_write_b128 v5, v[100:103] offset:1152
    ds_write_b128 v5, v[104:107] offset:2304
    ds_write_b128 v5, v[108:111] offset:3456
    s_waitcnt lgkmcnt(4)
    buffer_store_dwordx4 v[216:219], v9, s[28:31], s44 offen sc1
    s_add_u32 s44, s44, s48
    buffer_store_dwordx4 v[220:223], v9, s[28:31], s45 offen sc1
    s_add_u32 s45, s45, s49
    buffer_store_dwordx4 v[224:227], v9, s[28:31], s46 offen sc1
    s_add_u32 s46, s46, s50
    buffer_store_dwordx4 v[228:231], v9, s[28:31], s47 offen sc1
    s_add_u32 s47, s47, s51
    s_waitcnt lgkmcnt(0)
    ds_read_b64_tr_b16 v[200:201], v8 offset:0
    ds_read_b64_tr_b16 v[202:203], v8 offset:576
    ds_read_b64_tr_b16 v[204:205], v8 offset:32
    ds_read_b64_tr_b16 v[206:207], v8 offset:608
    ds_read_b64_tr_b16 v[208:209], v8 offset:64
    ds_read_b64_tr_b16 v[210:211], v8 offset:640
    ds_read_b64_tr_b16 v[212:213], v8 offset:96
    ds_read_b64_tr_b16 v[214:215], v8 offset:672
    s_waitcnt vmcnt(28)
    ds_write_b128 v5, v[112:115] offset:4608
    ds_write_b128 v5, v[116:119] offset:5760
    ds_write_b128 v5, v[120:123] offset:6912
    ds_write_b128 v5, v[124:127] offset:8064
    s_waitcnt lgkmcnt(4)
    buffer_store_dwordx4 v[200:203], v9, s[28:31], s44 offen sc1
    s_add_u32 s44, s44, s48
    buffer_store_dwordx4 v[204:207], v9, s[28:31], s45 offen sc1
    s_add_u32 s45, s45, s49
    buffer_store_dwordx4 v[208:211], v9, s[28:31], s46 offen sc1
    s_add_u32 s46, s46, s50
    buffer_store_dwordx4 v[212:215], v9, s[28:31], s47 offen sc1
    s_add_u32 s47, s47, s51
    s_waitcnt lgkmcnt(0)
    ds_read_b64_tr_b16 v[216:217], v8 offset:4608
    ds_read_b64_tr_b16 v[218:219], v8 offset:5184
    ds_read_b64_tr_b16 v[220:221], v8 offset:4640
    ds_read_b64_tr_b16 v[222:223], v8 offset:5216
    ds_read_b64_tr_b16 v[224:225], v8 offset:4672
    ds_read_b64_tr_b16 v[226:227], v8 offset:5248
    ds_read_b64_tr_b16 v[228:229], v8 offset:4704
    ds_read_b64_tr_b16 v[230:231], v8 offset:5280
    s_waitcnt vmcnt(28)
    ds_write_b128 v5, v[128:131] offset:0
    ds_write_b128 v5, v[132:135] offset:1152
    ds_write_b128 v5, v[136:139] offset:2304
    ds_write_b128 v5, v[140:143] offset:3456
    s_waitcnt lgkmcnt(4)
    buffer_store_dwordx4 v[216:219], v9, s[28:31], s44 offen sc1
    s_add_u32 s44, s44, s48
    buffer_store_dwordx4 v[220:223], v9, s[28:31], s45 offen sc1
    s_add_u32 s45, s45, s49
    buffer_store_dwordx4 v[224:227], v9, s[28:31], s46 offen sc1
    s_add_u32 s46, s46, s50
    buffer_store_dwordx4 v[228:231], v9, s[28:31], s47 offen sc1
    s_add_u32 s47, s47, s51
    s_waitcnt lgkmcnt(0)
    ds_read_b64_tr_b16 v[200:201], v8 offset:0
    ds_read_b64_tr_b16 v[202:203], v8 offset:576
    ds_read_b64_tr_b16 v[204:205], v8 offset:32
    ds_read_b64_tr_b16 v[206:207], v8 offset:608
    ds_read_b64_tr_b16 v[208:209], v8 offset:64
    ds_read_b64_tr_b16 v[210:211], v8 offset:640
    ds_read_b64_tr_b16 v[212:213], v8 offset:96
    ds_read_b64_tr_b16 v[214:215], v8 offset:672
    s_waitcnt vmcnt(28)
    ds_write_b128 v5, v[144:147] offset:4608
    ds_write_b128 v5, v[148:151] offset:5760
    ds_write_b128 v5, v[152:155] offset:6912
    ds_write_b128 v5, v[156:159] offset:8064
    s_waitcnt lgkmcnt(4)
    buffer_store_dwordx4 v[200:203], v9, s[28:31], s44 offen sc1
    s_add_u32 s44, s44, s48
    buffer_store_dwordx4 v[204:207], v9, s[28:31], s45 offen sc1
    s_add_u32 s45, s45, s49
    buffer_store_dwordx4 v[208:211], v9, s[28:31], s46 offen sc1
    s_add_u32 s46, s46, s50
    buffer_store_dwordx4 v[212:215], v9, s[28:31], s47 offen sc1
    s_add_u32 s47, s47, s51
    s_waitcnt lgkmcnt(0)
    ds_read_b64_tr_b16 v[216:217], v8 offset:4608
    ds_read_b64_tr_b16 v[218:219], v8 offset:5184
    ds_read_b64_tr_b16 v[220:221], v8 offset:4640
    ds_read_b64_tr_b16 v[222:223], v8 offset:5216
    ds_read_b64_tr_b16 v[224:225], v8 offset:4672
    ds_read_b64_tr_b16 v[226:227], v8 offset:5248
    ds_read_b64_tr_b16 v[228:229], v8 offset:4704
    ds_read_b64_tr_b16 v[230:231], v8 offset:5280
    s_waitcnt vmcnt(28)
    ds_write_b128 v5, v[160:163] offset:0
    ds_write_b128 v5, v[164:167] offset:1152
    ds_write_b128 v5, v[168:171] offset:2304
    ds_write_b128 v5, v[172:175] offset:3456
    s_waitcnt lgkmcnt(4)
    buffer_store_dwordx4 v[216:219], v9, s[28:31], s44 offen sc1
    s_add_u32 s44, s44, s48
    buffer_store_dwordx4 v[220:223], v9, s[28:31], s45 offen sc1
    s_add_u32 s45, s45, s49
    buffer_store_dwordx4 v[224:227], v9, s[28:31], s46 offen sc1
    s_add_u32 s46, s46, s50
    buffer_store_dwordx4 v[228:231], v9, s[28:31], s47 offen sc1
    s_add_u32 s47, s47, s51
    s_waitcnt lgkmcnt(0)
    ds_read_b64_tr_b16 v[200:201], v8 offset:0
    ds_read_b64_tr_b16 v[202:203], v8 offset:576
    ds_read_b64_tr_b16 v[204:205], v8 offset:32
    ds_read_b64_tr_b16 v[206:207], v8 offset:608
    ds_read_b64_tr_b16 v[208:209], v8 offset:64
    ds_read_b64_tr_b16 v[210:211], v8 offset:640
    ds_read_b64_tr_b16 v[212:213], v8 offset:96
    ds_read_b64_tr_b16 v[214:215], v8 offset:672
    s_waitcnt lgkmcnt(0)
    buffer_store_dwordx4 v[200:203], v9, s[28:31], s44 offen sc1
    s_add_u32 s44, s44, s48
    buffer_store_dwordx4 v[204:207], v9, s[28:31], s45 offen sc1
    s_add_u32 s45, s45, s49
    buffer_store_dwordx4 v[208:211], v9, s[28:31], s46 offen sc1
    s_add_u32 s46, s46, s50
    buffer_store_dwordx4 v[212:215], v9, s[28:31], s47 offen sc1
    s_add_u32 s47, s47, s51
    s_endpgm
.globl chain_kernel
.p2align 8
.type chain_kernel,@function
chain_kernel:
    s_cmp_ge_u32 s2, 256
    s_cbranch_scc1 chain_end
    s_load_dwordx2 s[4:5], s[0:1], 0
    s_load_dwordx2 s[6:7], s[0:1], 104
    s_load_dwordx2 s[10:11], s[0:1], 120
    v_lshrrev_b32 v2, 6, v0
    v_and_b32 v1, 63, v0
    v_readfirstlane_b32 s20, v2
    s_and_b32 s25, s2, 7
    s_lshr_b32 s26, s2, 3
    s_lshl_b32 s23, s25, 3
    s_lshr_b32 s27, s26, 2
    s_add_u32 s23, s23, s27
    s_and_b32 s24, s26, 3
    s_and_b32 s21, s20, 1
    s_lshr_b32 s22, s20, 1
    v_lshrrev_b32 v3, 4, v1
    v_and_b32 v4, 15, v1
    v_lshlrev_b32 v8, 4, v1
    s_waitcnt lgkmcnt(0)
    s_mov_b32 s28, s10
    s_mov_b32 s29, s11
    s_mov_b32 s30, 268435456
    s_mov_b32 s31, 0x00020000
    s_mul_i32 s25, s20, 10240
    s_add_u32 s10, s25, 0
    s_mul_i32 s11, s23, 40960
    s_add_u32 s11, s11, s25
    s_add_u32 s11, s11, 5492736
    s_lshl_b32 s12, s20, 10
    s_add_u32 s13, s12, 8121856
    s_add_u32 s12, s12, 130560
    s_lshl_b32 s14, s21, 10
    s_add_u32 s14, s14, 139264
    s_mul_i32 s15, s21, 7168
    s_mul_i32 s25, s24, 640
    s_add_u32 s15, s15, s25
    s_add_u32 s15, s15, 8146944
    s_mov_b32 m0, s10
    s_add_u32 s10, s10, 4096
    buffer_load_dwordx4 v8, s[28:31], s11 offen offset:0 lds
    buffer_load_dwordx4 v8, s[28:31], s11 offen offset:1024 lds
    buffer_load_dwordx4 v8, s[28:31], s11 offen offset:2048 lds
    buffer_load_dwordx4 v8, s[28:31], s11 offen offset:3072 lds
    s_add_u32 s11, s11, 4096
    s_mov_b32 m0, s10
    s_add_u32 s10, s10, 4096
    buffer_load_dwordx4 v8, s[28:31], s11 offen offset:0 lds
    buffer_load_dwordx4 v8, s[28:31], s11 offen offset:1024 lds
    buffer_load_dwordx4 v8, s[28:31], s11 offen offset:2048 lds
    buffer_load_dwordx4 v8, s[28:31], s11 offen offset:3072 lds
    s_add_u32 s11, s11, 4096
    s_mov_b32 m0, s10
    s_add_u32 s10, s10, 4096
    buffer_load_dwordx4 v8, s[28:31], s11 offen offset:0 lds
    buffer_load_dwordx4 v8, s[28:31], s11 offen offset:1024 lds
    s_mov_b32 m0, s12
    s_nop 0
    buffer_load_dwordx4 v8, s[28:31], s13 offen lds
    s_mov_b32 m0, 134656
    s_mov_b32 s13, 8125952
    buffer_load_dwordx4 v8, s[28:31], s13 offen lds
    s_mov_b32 m0, s14
    s_nop 0
    buffer_load_dwordx4 v8, s[28:31], s15 offen lds
    s_mov_b32 s32, s6
    s_mov_b32 s33, s7
    s_mov_b32 s34, 2621440
    s_mov_b32 s35, 0x00020000
    s_mul_i32 s36, s24, 200
    s_mul_i32 s37, s21, 100
    s_add_u32 s36, s36, s37
    s_mul_i32 s37, s22, 50
    s_add_u32 s36, s36, s37
    s_lshl_b32 s36, s36, 10
    s_add_u32 s37, s36, 24055808
    s_add_u32 s36, s36, 23236608
    v_lshrrev_b32 v2, 1, v3
    s_lshl_b32 s26, s21, 2
    v_add_u32 v2, s26, v2
    v_and_b32 v7, 7, v4
    buffer_load_dwordx4 a[0:3], v8, s[28:31], s36 offen offset:0
    v_xor_b32 v2, v2, v7
    v_lshlrev_b32 v2, 4, v2
    v_lshl_add_u32 v226, v4, 8, v2
    v_and_b32 v2, 1, v3
    v_lshl_add_u32 v226, v2, 3, v226
    s_mul_i32 s26, s22, 20480
    s_add_u32 s27, s26, 0
    v_add_u32 v226, s27, v226
    v_lshlrev_b32 v227, 5, v4
    v_add_u32 v227, 122880, v227
    s_lshl_b32 s27, s21, 3
    v_add_u32 v2, s27, v3
    v_xor_b32 v2, v2, v7
    v_lshlrev_b32 v2, 4, v2
    v_and_b32 v7, 3, v4
    v_lshl_add_u32 v2, v7, 8, v2
    v_lshrrev_b32 v7, 2, v4
    buffer_load_dwordx4 a[4:7], v8, s[28:31], s36 offen offset:1024
    v_lshl_add_u32 v2, v7, 10, v2
    s_add_u32 s27, s26, 40960
    v_add_u32 v228, s27, v2
    v_xor_b32 v2, v4, v3
    v_lshlrev_b32 v2, 4, v2
    v_lshl_add_u32 v2, v3, 8, v2
    v_xor_b32 v7, 64, v2
    s_mul_i32 s26, s22, 30720
    s_add_u32 s26, s26, 40960
    s_mul_i32 s27, s22, 10240
    s_sub_u32 s27, 61440, s27
    v_add_u32 v229, s26, v2
    v_add_u32 v230, s26, v7
    v_add_u32 v231, s27, v2
    v_add_u32 v232, s27, v7
    v_lshlrev_b32 v2, 4, v3
    s_mul_i32 s26, s21, 384
    buffer_load_dwordx4 a[8:11], v8, s[28:31], s36 offen offset:2048
    s_add_u32 s26, s26, 139264
    v_add_u32 v233, s26, v2
    s_mul_i32 s26, s21, 64
    s_add_u32 s26, s26, 139520
    v_add_u32 v234, s26, v2
    s_lshl_b32 s26, s22, 7
    s_add_u32 s26, s26, 138240
    v_lshl_add_u32 v235, v4, 3, s26
    s_mul_i32 s39, s24, 5
    s_mul_i32 s40, s21, 3
    s_add_u32 s40, s40, s39
    s_add_u32 s41, s39, 2
    v_lshrrev_b32 v12, 1, v3
    v_and_b32 v13, 1, v3
    v_lshlrev_b32 v13, 3, v13
    s_add_u32 s26, s40, 0
    buffer_load_dwordx4 a[12:15], v8, s[28:31], s36 offen offset:3072
    v_add_u32 v14, 0, v12
    s_and_b32 s27, s26, 1
    s_lshl_b32 s27, s27, 2
    v_add_u32 v15, s27, v14
    v_xor_b32 v15, v15, v4
    v_lshlrev_b32 v15, 4, v15
    v_lshl_add_u32 v15, v14, 8, v15
    v_add_u32 v15, v15, v13
    s_mul_i32 s27, s22, 20
    s_add_u32 s27, s27, s26
    s_lshl_b32 s27, s27, 10
    s_add_u32 s27, s27, 40960
    v_add_u32 v236, s27, v15
    s_add_u32 s26, s40, 0
    v_add_u32 v14, 2, v12
    s_and_b32 s27, s26, 1
    s_lshl_b32 s27, s27, 2
    s_add_u32 s36, s36, 4096
    buffer_load_dwordx4 a[16:19], v8, s[28:31], s36 offen offset:0
    v_add_u32 v15, s27, v14
    v_xor_b32 v15, v15, v4
    v_lshlrev_b32 v15, 4, v15
    v_lshl_add_u32 v15, v14, 8, v15
    v_add_u32 v15, v15, v13
    s_mul_i32 s27, s22, 20
    s_add_u32 s27, s27, s26
    s_lshl_b32 s27, s27, 10
    s_add_u32 s27, s27, 40960
    v_add_u32 v237, s27, v15
    s_add_u32 s26, s40, 1
    v_add_u32 v14, 0, v12
    s_and_b32 s27, s26, 1
    s_lshl_b32 s27, s27, 2
    v_add_u32 v15, s27, v14
    v_xor_b32 v15, v15, v4
    v_lshlrev_b32 v15, 4, v15
    buffer_load_dwordx4 a[20:23], v8, s[28:31], s36 offen offset:1024
    v_lshl_add_u32 v15, v14, 8, v15
    v_add_u32 v15, v15, v13
    s_mul_i32 s27, s22, 20
    s_add_u32 s27, s27, s26
    s_lshl_b32 s27, s27, 10
    s_add_u32 s27, s27, 40960
    v_add_u32 v238, s27, v15
    s_add_u32 s26, s40, 1
    v_add_u32 v14, 2, v12
    s_and_b32 s27, s26, 1
    s_lshl_b32 s27, s27, 2
    v_add_u32 v15, s27, v14
    v_xor_b32 v15, v15, v4
    v_lshlrev_b32 v15, 4, v15
    v_lshl_add_u32 v15, v14, 8, v15
    v_add_u32 v15, v15, v13
    s_mul_i32 s27, s22, 20
    buffer_load_dwordx4 a[24:27], v8, s[28:31], s36 offen offset:2048
    s_add_u32 s27, s27, s26
    s_lshl_b32 s27, s27, 10
    s_add_u32 s27, s27, 40960
    v_add_u32 v239, s27, v15
    s_mov_b32 s26, s41
    s_lshl_b32 s27, s21, 1
    v_add_u32 v14, s27, v12
    s_and_b32 s27, s26, 1
    s_lshl_b32 s27, s27, 2
    v_add_u32 v15, s27, v14
    v_xor_b32 v15, v15, v4
    v_lshlrev_b32 v15, 4, v15
    v_lshl_add_u32 v15, v14, 8, v15
    v_add_u32 v15, v15, v13
    s_mul_i32 s27, s22, 20
    s_add_u32 s27, s27, s26
    s_lshl_b32 s27, s27, 10
    buffer_load_dwordx4 a[28:31], v8, s[28:31], s36 offen offset:3072
    s_add_u32 s27, s27, 40960
    v_add_u32 v240, s27, v15
    s_lshr_b32 s26, s24, 1
    s_add_u32 s26, s26, 1
    s_sub_u32 s27, 0, s26
    s_and_b32 s42, s24, 1
    s_cmp_eq_u32 s42, 1
    s_cselect_b32 s42, s27, s26
    s_lshl_b32 s43, s23, 5
    s_lshl_b32 s26, s22, 4
    s_add_u32 s43, s43, s26
    v_add_u32 v241, s43, v4
    v_add_u32 v241, s42, v241
    s_movk_i32 s27, 2048
    v_cmp_gt_u32 s[60:61], s27, v241
    v_lshrrev_b32 v242, 4, v241
    s_add_u32 s36, s36, 4096
    buffer_load_dwordx4 a[32:35], v8, s[28:31], s36 offen offset:0
    v_and_b32 v241, 15, v241
    s_mov_b32 s27, 20480
    v_mul_lo_u32 v242, v242, s27
    v_lshl_add_u32 v242, v241, 4, v242
    v_and_b32 v241, 1, v3
    v_lshlrev_b32 v241, 9, v241
    v_lshrrev_b32 v2, 1, v3
    v_lshl_add_u32 v241, v2, 8, v241
    v_add_u32 v241, v241, v242
    s_lshl_b32 s27, s21, 9
    v_lshl_add_u32 v242, v2, 8, v242
    v_add_u32 v242, s27, v242
    v_and_b32 v2, 1, v3
    v_lshl_add_u32 v242, v2, 3, v242
    v_add_u32 v243, s43, v4
    v_lshrrev_b32 v244, 4, v243
    v_and_b32 v243, 15, v243
    buffer_load_dwordx4 a[36:39], v8, s[28:31], s36 offen offset:1024
    s_mov_b32 s27, 20480
    v_mul_lo_u32 v244, v244, s27
    v_lshl_add_u32 v244, v243, 4, v244
    v_and_b32 v243, 1, v3
    v_lshlrev_b32 v243, 9, v243
    v_lshrrev_b32 v2, 1, v3
    v_lshl_add_u32 v243, v2, 8, v243
    v_add_u32 v243, v243, v244
    s_lshl_b32 s27, s21, 9
    v_lshl_add_u32 v244, v2, 8, v244
    v_add_u32 v244, s27, v244
    v_and_b32 v2, 1, v3
    v_lshl_add_u32 v244, v2, 3, v244
    s_lshl_b32 s44, s40, 10
    s_add_u32 s38, s44, 13406208
    s_add_u32 s44, s44, 10784768
    s_lshl_b32 s45, s41, 10
    buffer_load_dwordx4 a[40:43], v8, s[28:31], s36 offen offset:2048
    s_add_u32 s39, s45, 13406208
    s_add_u32 s45, s45, 10784768
    s_lshl_b32 s46, s23, 2
    s_add_u32 s46, s46, s24
    s_lshl_b32 s46, s46, 7
    s_add_u32 s49, s46, 29413376
    s_add_u32 s46, s46, 29380608
    v_add_u32 v7, 1, v1
    v_lshrrev_b32 v7, 1, v7
    v_add_u32 v7, s23, v7
    v_subrev_u32 v7, 1, v7
    v_max_i32 v7, 0, v7
    v_min_i32 v7, 63, v7
    v_lshrrev_b32 v2, 1, v1
    s_lshl_b32 s26, s22, 1
    v_add_u32 v2, s26, v2
    v_lshl_add_u32 v7, v7, 2, v2
    buffer_load_dwordx4 a[44:47], v8, s[28:31], s36 offen offset:3072
    v_lshlrev_b32 v245, 7, v7
    s_lshl_b32 s26, s23, 1
    s_add_u32 s27, s26, s22
    s_mul_i32 s27, s27, 20
    s_mul_i32 s3, s22, 10
    s_add_u32 s27, s27, s3
    s_lshl_b32 s27, s27, 10
    s_add_u32 s50, s27, 10784768
    s_add_u32 s27, s26, 1
    s_sub_u32 s27, s27, s22
    s_mul_i32 s27, s27, 20
    s_add_u32 s27, s27, s3
    s_lshl_b32 s27, s27, 10
    s_add_u32 s51, s27, 10784768
    s_mul_i32 s26, s20, 5120
    s_add_u32 s26, s26, 143360
    s_add_u32 s36, s36, 4096
    buffer_load_dwordx4 a[48:51], v8, s[28:31], s36 offen offset:0
    v_add_u32 v246, s26, v8
    s_xor_b32 s27, s20, 2
    s_mul_i32 s27, s27, 5120
    s_add_u32 s27, s27, 143360
    v_add_u32 v247, s27, v8
    s_lshr_b32 s26, s2, 3
    s_and_b32 s3, s2, 7
    s_and_b32 s4, s3, 1
    s_lshr_b32 s3, s3, 1
    s_and_b32 s52, s26, 7
    s_lshl_b32 s27, s4, 3
    s_add_u32 s52, s52, s27
    s_lshr_b32 s27, s26, 3
    s_lshl_b32 s53, s3, 2
    s_add_u32 s53, s53, s27
    s_and_b32 s57, s26, 3
    buffer_load_dwordx4 a[52:55], v8, s[28:31], s36 offen offset:1024
    s_lshl_b32 s27, s4, 2
    s_add_u32 s57, s57, s27
    s_lshr_b32 s27, s26, 2
    s_lshl_b32 s58, s3, 3
    s_add_u32 s58, s58, s27
    s_and_b32 s57, s26, 7
    s_lshr_b32 s27, s26, 3
    s_and_b32 s58, s2, 7
    s_lshl_b32 s58, s58, 2
    s_add_u32 s58, s58, s27
    s_mul_i32 s54, s52, 143360
    s_add_u32 s54, s54, 24875008
    s_mul_i32 s59, s57, 276480
    s_add_u32 s59, s59, 27168768
    v_mov_b32 v224, 0x3f803f80
    v_mov_b32 v216, 0
    buffer_load_dwordx4 a[56:59], v8, s[28:31], s36 offen offset:2048
    v_mov_b32 v217, 0
    v_mov_b32 v220, 0
    v_mov_b32 v221, 0
    v_mov_b32 v218, 0
    v_mov_b32 v219, 0
    v_mov_b32 v222, 0
    v_mov_b32 v223, 0
    buffer_load_dwordx4 a[60:63], v8, s[28:31], s36 offen offset:3072
    s_add_u32 s36, s36, 4096
    buffer_load_dwordx4 a[64:67], v8, s[28:31], s36 offen offset:0
    s_waitcnt vmcnt(17)
    s_barrier
    buffer_load_dwordx4 a[68:71], v8, s[28:31], s36 offen offset:1024
    v_xor_b32 v12, 32, v226
    ds_read_b64 v[32:33], v226 offset:0
    ds_read_b64 v[34:35], v226 offset:128
    ds_read_b64 v[36:37], v12 offset:0
    ds_read_b64 v[38:39], v12 offset:128
    ds_read_b64 v[40:41], v226 offset:4096
    ds_read_b64 v[42:43], v226 offset:4224
    buffer_load_dwordx4 a[72:75], v8, s[28:31], s36 offen offset:2048
    s_waitcnt lgkmcnt(4)
    v_dot2_f32_bf16 v220, v32, v224, v220
    v_lshlrev_b32 v72, 16, v32
    v_dot2_f32_bf16 v221, v32, v32, v221
    v_and_b32 v73, 0xffff0000, v32
    v_dot2_f32_bf16 v220, v33, v224, v220
    ds_read_b64 v[44:45], v12 offset:4096
    v_lshlrev_b32 v74, 16, v33
    v_dot2_f32_bf16 v221, v33, v33, v221
    v_and_b32 v75, 0xffff0000, v33
    v_dot2_f32_bf16 v220, v34, v224, v220
    ds_read_b64 v[46:47], v12 offset:4224
    v_lshlrev_b32 v76, 16, v34
    buffer_load_dwordx4 a[76:79], v8, s[28:31], s36 offen offset:3072
    v_dot2_f32_bf16 v221, v34, v34, v221
    v_and_b32 v77, 0xffff0000, v34
    v_dot2_f32_bf16 v220, v35, v224, v220
    v_lshlrev_b32 v78, 16, v35
    v_dot2_f32_bf16 v221, v35, v35, v221
    v_and_b32 v79, 0xffff0000, v35
    s_waitcnt lgkmcnt(4)
    v_dot2_f32_bf16 v222, v36, v224, v222
    v_lshlrev_b32 v80, 16, v36
    v_dot2_f32_bf16 v223, v36, v36, v223
    v_and_b32 v81, 0xffff0000, v36
    v_dot2_f32_bf16 v222, v37, v224, v222
    ds_read_b64 v[48:49], v226 offset:8192
    v_lshlrev_b32 v82, 16, v37
    v_dot2_f32_bf16 v223, v37, v37, v223
    s_add_u32 s36, s36, 4096
    buffer_load_dwordx4 a[80:83], v8, s[28:31], s36 offen offset:0
    v_and_b32 v83, 0xffff0000, v37
    v_dot2_f32_bf16 v222, v38, v224, v222
    ds_read_b64 v[50:51], v226 offset:8320
    v_lshlrev_b32 v84, 16, v38
    v_dot2_f32_bf16 v223, v38, v38, v223
    v_and_b32 v85, 0xffff0000, v38
    v_dot2_f32_bf16 v222, v39, v224, v222
    v_lshlrev_b32 v86, 16, v39
    v_dot2_f32_bf16 v223, v39, v39, v223
    v_and_b32 v87, 0xffff0000, v39
    s_waitcnt lgkmcnt(4)
    v_dot2_f32_bf16 v220, v40, v224, v220
    v_lshlrev_b32 v88, 16, v40
    v_dot2_f32_bf16 v221, v40, v40, v221
    v_and_b32 v89, 0xffff0000, v40
    buffer_load_dwordx4 a[84:87], v8, s[28:31], s36 offen offset:1024
    v_dot2_f32_bf16 v220, v41, v224, v220
    ds_read_b64 v[52:53], v12 offset:8192
    v_lshlrev_b32 v90, 16, v41
    v_dot2_f32_bf16 v221, v41, v41, v221
    v_and_b32 v91, 0xffff0000, v41
    v_dot2_f32_bf16 v220, v42, v224, v220
    ds_read_b64 v[54:55], v12 offset:8320
    v_lshlrev_b32 v92, 16, v42
    v_dot2_f32_bf16 v221, v42, v42, v221
    v_and_b32 v93, 0xffff0000, v42
    v_dot2_f32_bf16 v220, v43, v224, v220
    v_lshlrev_b32 v94, 16, v43
    v_dot2_f32_bf16 v221, v43, v43, v221
    buffer_load_dwordx4 a[88:91], v8, s[28:31], s36 offen offset:2048
    v_and_b32 v95, 0xffff0000, v43
    s_waitcnt lgkmcnt(4)
    v_dot2_f32_bf16 v222, v44, v224, v222
    v_lshlrev_b32 v96, 16, v44
    v_dot2_f32_bf16 v223, v44, v44, v223
    v_and_b32 v97, 0xffff0000, v44
    v_dot2_f32_bf16 v222, v45, v224, v222
    ds_read_b64 v[56:57], v226 offset:12288
    v_lshlrev_b32 v98, 16, v45
    v_dot2_f32_bf16 v223, v45, v45, v223
    v_and_b32 v99, 0xffff0000, v45
    v_dot2_f32_bf16 v222, v46, v224, v222
    ds_read_b64 v[58:59], v226 offset:12416
    buffer_load_dwordx4 a[92:95], v8, s[28:31], s36 offen offset:3072
    v_lshlrev_b32 v100, 16, v46
    v_dot2_f32_bf16 v223, v46, v46, v223
    v_and_b32 v101, 0xffff0000, v46
    v_dot2_f32_bf16 v222, v47, v224, v222
    v_lshlrev_b32 v102, 16, v47
    v_dot2_f32_bf16 v223, v47, v47, v223
    v_and_b32 v103, 0xffff0000, v47
    s_waitcnt lgkmcnt(4)
    v_dot2_f32_bf16 v220, v48, v224, v220
    v_lshlrev_b32 v104, 16, v48
    v_dot2_f32_bf16 v221, v48, v48, v221
    v_and_b32 v105, 0xffff0000, v48
    v_dot2_f32_bf16 v220, v49, v224, v220
    ds_read_b64 v[60:61], v12 offset:12288
    v_lshlrev_b32 v106, 16, v49
    s_add_u32 s36, s36, 4096
    buffer_load_dwordx4 a[96:99], v8, s[28:31], s36 offen offset:0
    v_dot2_f32_bf16 v221, v49, v49, v221
    v_and_b32 v107, 0xffff0000, v49
    v_dot2_f32_bf16 v220, v50, v224, v220
    ds_read_b64 v[62:63], v12 offset:12416
    v_lshlrev_b32 v108, 16, v50
    v_dot2_f32_bf16 v221, v50, v50, v221
    v_and_b32 v109, 0xffff0000, v50
    v_dot2_f32_bf16 v220, v51, v224, v220
    v_lshlrev_b32 v110, 16, v51
    v_dot2_f32_bf16 v221, v51, v51, v221
    v_and_b32 v111, 0xffff0000, v51
    s_waitcnt lgkmcnt(4)
    v_dot2_f32_bf16 v222, v52, v224, v222
    v_lshlrev_b32 v112, 16, v52
    v_dot2_f32_bf16 v223, v52, v52, v223
    buffer_load_dwordx4 a[100:103], v8, s[28:31], s36 offen offset:1024
    v_and_b32 v113, 0xffff0000, v52
    v_dot2_f32_bf16 v222, v53, v224, v222
    ds_read_b64 v[64:65], v226 offset:16384
    v_lshlrev_b32 v114, 16, v53
    v_dot2_f32_bf16 v223, v53, v53, v223
    v_and_b32 v115, 0xffff0000, v53
    v_dot2_f32_bf16 v222, v54, v224, v222
    ds_read_b64 v[66:67], v226 offset:16512
    v_lshlrev_b32 v116, 16, v54
    v_dot2_f32_bf16 v223, v54, v54, v223
    v_and_b32 v117, 0xffff0000, v54
    v_dot2_f32_bf16 v222, v55, v224, v222
    v_lshlrev_b32 v118, 16, v55
    buffer_load_dwordx4 a[104:107], v8, s[28:31], s36 offen offset:2048
    v_dot2_f32_bf16 v223, v55, v55, v223
    v_and_b32 v119, 0xffff0000, v55
    s_waitcnt lgkmcnt(4)
    v_dot2_f32_bf16 v220, v56, v224, v220
    v_lshlrev_b32 v120, 16, v56
    v_dot2_f32_bf16 v221, v56, v56, v221
    v_and_b32 v121, 0xffff0000, v56
    v_dot2_f32_bf16 v220, v57, v224, v220
    ds_read_b64 v[68:69], v12 offset:16384
    v_lshlrev_b32 v122, 16, v57
    v_dot2_f32_bf16 v221, v57, v57, v221
    v_and_b32 v123, 0xffff0000, v57
    v_dot2_f32_bf16 v220, v58, v224, v220
    ds_read_b64 v[70:71], v12 offset:16512
    buffer_load_dwordx4 a[108:111], v8, s[28:31], s36 offen offset:3072
    v_lshlrev_b32 v124, 16, v58
    v_dot2_f32_bf16 v221, v58, v58, v221
    v_and_b32 v125, 0xffff0000, v58
    v_dot2_f32_bf16 v220, v59, v224, v220
    v_lshlrev_b32 v126, 16, v59
    v_dot2_f32_bf16 v221, v59, v59, v221
    v_and_b32 v127, 0xffff0000, v59
    s_waitcnt lgkmcnt(4)
    v_dot2_f32_bf16 v222, v60, v224, v222
    v_lshlrev_b32 v128, 16, v60
    v_dot2_f32_bf16 v223, v60, v60, v223
    v_and_b32 v129, 0xffff0000, v60
    v_dot2_f32_bf16 v222, v61, v224, v222
    v_lshlrev_b32 v130, 16, v61
    v_dot2_f32_bf16 v223, v61, v61, v223
    v_and_b32 v131, 0xffff0000, v61
    v_dot2_f32_bf16 v222, v62, v224, v222
    s_add_u32 s36, s36, 4096
    buffer_load_dwordx4 a[112:115], v8, s[28:31], s36 offen offset:0
    v_lshlrev_b32 v132, 16, v62
    v_dot2_f32_bf16 v223, v62, v62, v223
    v_and_b32 v133, 0xffff0000, v62
    v_dot2_f32_bf16 v222, v63, v224, v222
    v_lshlrev_b32 v134, 16, v63
    v_dot2_f32_bf16 v223, v63, v63, v223
    v_and_b32 v135, 0xffff0000, v63
    s_waitcnt lgkmcnt(2)
    v_dot2_f32_bf16 v220, v64, v224, v220
    v_lshlrev_b32 v136, 16, v64
    v_dot2_f32_bf16 v221, v64, v64, v221
    v_and_b32 v137, 0xffff0000, v64
    v_dot2_f32_bf16 v220, v65, v224, v220
    v_lshlrev_b32 v138, 16, v65
    v_dot2_f32_bf16 v221, v65, v65, v221
    v_and_b32 v139, 0xffff0000, v65
    v_dot2_f32_bf16 v220, v66, v224, v220
    buffer_load_dwordx4 a[116:119], v8, s[28:31], s36 offen offset:1024
    v_lshlrev_b32 v140, 16, v66
    v_dot2_f32_bf16 v221, v66, v66, v221
    v_and_b32 v141, 0xffff0000, v66
    v_dot2_f32_bf16 v220, v67, v224, v220
    v_lshlrev_b32 v142, 16, v67
    v_dot2_f32_bf16 v221, v67, v67, v221
    v_and_b32 v143, 0xffff0000, v67
    s_waitcnt lgkmcnt(0)
    v_dot2_f32_bf16 v222, v68, v224, v222
    v_lshlrev_b32 v144, 16, v68
    v_dot2_f32_bf16 v223, v68, v68, v223
    v_and_b32 v145, 0xffff0000, v68
    v_dot2_f32_bf16 v222, v69, v224, v222
    v_lshlrev_b32 v146, 16, v69
    v_dot2_f32_bf16 v223, v69, v69, v223
    v_and_b32 v147, 0xffff0000, v69
    v_dot2_f32_bf16 v222, v70, v224, v222
    buffer_load_dwordx4 a[120:123], v8, s[28:31], s36 offen offset:2048
    v_lshlrev_b32 v148, 16, v70
    v_dot2_f32_bf16 v223, v70, v70, v223
    v_and_b32 v149, 0xffff0000, v70
    v_dot2_f32_bf16 v222, v71, v224, v222
    v_lshlrev_b32 v150, 16, v71
    v_dot2_f32_bf16 v223, v71, v71, v223
    v_and_b32 v151, 0xffff0000, v71
    s_nop 2
    s_nop 1
    v_add_f32_dpp v220, v220, v220 quad_perm:[1,0,3,2] row_mask:0xf bank_mask:0xf
    v_add_f32_dpp v221, v221, v221 quad_perm:[1,0,3,2] row_mask:0xf bank_mask:0xf
    v_add_f32_dpp v222, v222, v222 quad_perm:[1,0,3,2] row_mask:0xf bank_mask:0xf
    v_add_f32_dpp v223, v223, v223 quad_perm:[1,0,3,2] row_mask:0xf bank_mask:0xf
    v_add_f32_dpp v220, v220, v220 quad_perm:[2,3,0,1] row_mask:0xf bank_mask:0xf
    v_add_f32_dpp v221, v221, v221 quad_perm:[2,3,0,1] row_mask:0xf bank_mask:0xf
    v_add_f32_dpp v222, v222, v222 quad_perm:[2,3,0,1] row_mask:0xf bank_mask:0xf
    v_add_f32_dpp v223, v223, v223 quad_perm:[2,3,0,1] row_mask:0xf bank_mask:0xf
    buffer_load_dwordx4 a[124:127], v8, s[28:31], s36 offen offset:3072
    v_add_f32_dpp v220, v220, v220 row_half_mirror row_mask:0xf bank_mask:0xf
    v_add_f32_dpp v221, v221, v221 row_half_mirror row_mask:0xf bank_mask:0xf
    v_add_f32_dpp v222, v222, v222 row_half_mirror row_mask:0xf bank_mask:0xf
    v_add_f32_dpp v223, v223, v223 row_half_mirror row_mask:0xf bank_mask:0xf
    v_add_f32_dpp v220, v220, v220 row_mirror row_mask:0xf bank_mask:0xf
    v_add_f32_dpp v221, v221, v221 row_mirror row_mask:0xf bank_mask:0xf
    v_add_f32_dpp v222, v222, v222 row_mirror row_mask:0xf bank_mask:0xf
    v_add_f32_dpp v223, v223, v223 row_mirror row_mask:0xf bank_mask:0xf
    v_mul_f32 v220, 0x3acccccd, v220
    v_mul_f32 v222, 0x3acccccd, v222
    v_mul_f32 v221, 0x3acccccd, v221
    v_mul_f32 v223, 0x3acccccd, v223
    v_fma_f32 v221, -v220, v220, v221
    v_fma_f32 v223, -v222, v222, v223
    v_max_f32 v221, 0, v221
    v_max_f32 v223, 0, v223
    v_cvt_pk_bf16_f32 v192, v220, v221
    s_add_u32 s36, s36, 4096
    buffer_load_dwordx4 a[128:131], v8, s[28:31], s36 offen offset:0
    v_cvt_pk_bf16_f32 v193, v222, v223
    v_lshlrev_b32 v220, 16, v192
    v_lshlrev_b32 v222, 16, v193
    v_and_b32 v221, 0xffff0000, v192
    v_and_b32 v223, 0xffff0000, v193
    v_add_f32 v221, 0x3727c5ac, v221
    v_add_f32 v223, 0x3727c5ac, v223
    v_cvt_pk_bf16_f32 v192, v221, v221
    v_cvt_pk_bf16_f32 v193, v223, v223
    v_lshlrev_b32 v221, 16, v192
    v_lshlrev_b32 v223, 16, v193
    v_sqrt_f32 v221, v221
    v_sqrt_f32 v223, v223
    s_nop 0
    s_nop 0
    v_cvt_pk_bf16_f32 v192, v221, v221
    buffer_load_dwordx4 a[132:135], v8, s[28:31], s36 offen offset:1024
    v_cvt_pk_bf16_f32 v193, v223, v223
    v_lshlrev_b32 v221, 16, v192
    v_lshlrev_b32 v223, 16, v193
    v_rcp_f32 v221, v221
    v_rcp_f32 v223, v223
    s_nop 0
    s_nop 0
    v_mul_f32 v220, v220, v221
    v_mul_f32 v222, v222, v223
    v_sub_f32 v220, 0, v220
    v_sub_f32 v222, 0, v222
    v_mov_b32 v216, 0
    v_mov_b32 v217, 0
    v_mov_b32 v218, 0
    v_mov_b32 v219, 0
    buffer_load_dwordx4 a[136:139], v8, s[28:31], s36 offen offset:2048
    v_xor_b32 v12, 64, v228
    ds_read_b128 v[152:155], v227 offset:10240
    ds_read_b128 v[156:159], v227 offset:10256
    ds_read_b128 v[160:163], v227 offset:7680
    ds_read_b128 v[164:167], v227 offset:7696
    s_waitcnt lgkmcnt(0)
    v_pk_fma_f32 v[72:73], v[72:73], v[220:221], v[220:221] op_sel:[0,1,0] op_sel_hi:[1,1,0]
    v_pk_fma_f32 v[74:75], v[74:75], v[220:221], v[220:221] op_sel:[0,1,0] op_sel_hi:[1,1,0]
    v_pk_fma_f32 v[76:77], v[76:77], v[220:221], v[220:221] op_sel:[0,1,0] op_sel_hi:[1,1,0]
    buffer_load_dwordx4 a[140:143], v8, s[28:31], s36 offen offset:3072
    ds_read_b128 v[168:171], v227 offset:10752
    v_pk_fma_f32 v[78:79], v[78:79], v[220:221], v[220:221] op_sel:[0,1,0] op_sel_hi:[1,1,0]
    v_pk_fma_f32 v[72:73], v[72:73], v[152:153], v[160:161]
    v_pk_fma_f32 v[74:75], v[74:75], v[154:155], v[162:163]
    ds_read_b128 v[172:175], v227 offset:10768
    v_pk_fma_f32 v[76:77], v[76:77], v[156:157], v[164:165]
    v_pk_fma_f32 v[78:79], v[78:79], v[158:159], v[166:167]
    v_cvt_pk_bf16_f32 v32, v72, v73
    ds_read_b128 v[176:179], v227 offset:8192
    v_cvt_pk_bf16_f32 v33, v74, v75
    v_cvt_pk_bf16_f32 v34, v76, v77
    s_add_u32 s36, s36, 4096
    buffer_load_dwordx4 a[144:147], v8, s[28:31], s36 offen offset:0
    v_cvt_pk_bf16_f32 v35, v78, v79
    ds_read_b128 v[180:183], v227 offset:8208
    v_dot2_f32_bf16 v216, v32, v224, v216
    v_dot2_f32_bf16 v217, v32, v32, v217
    v_dot2_f32_bf16 v216, v33, v224, v216
    v_dot2_f32_bf16 v217, v33, v33, v217
    v_dot2_f32_bf16 v216, v34, v224, v216
    v_dot2_f32_bf16 v217, v34, v34, v217
    v_dot2_f32_bf16 v216, v35, v224, v216
    v_dot2_f32_bf16 v217, v35, v35, v217
    ds_write_b128 v228, v[32:35] offset:0
    buffer_load_dwordx4 a[148:151], v8, s[28:31], s36 offen offset:1024
    v_pk_fma_f32 v[80:81], v[80:81], v[222:223], v[222:223] op_sel:[0,1,0] op_sel_hi:[1,1,0]
    v_pk_fma_f32 v[82:83], v[82:83], v[222:223], v[222:223] op_sel:[0,1,0] op_sel_hi:[1,1,0]
    v_pk_fma_f32 v[84:85], v[84:85], v[222:223], v[222:223] op_sel:[0,1,0] op_sel_hi:[1,1,0]
    v_pk_fma_f32 v[86:87], v[86:87], v[222:223], v[222:223] op_sel:[0,1,0] op_sel_hi:[1,1,0]
    v_pk_fma_f32 v[80:81], v[80:81], v[152:153], v[160:161]
    v_pk_fma_f32 v[82:83], v[82:83], v[154:155], v[162:163]
    v_pk_fma_f32 v[84:85], v[84:85], v[156:157], v[164:165]
    v_pk_fma_f32 v[86:87], v[86:87], v[158:159], v[166:167]
    v_cvt_pk_bf16_f32 v36, v80, v81
    v_cvt_pk_bf16_f32 v37, v82, v83
    v_cvt_pk_bf16_f32 v38, v84, v85
    v_cvt_pk_bf16_f32 v39, v86, v87
    v_dot2_f32_bf16 v218, v36, v224, v218
    v_dot2_f32_bf16 v219, v36, v36, v219
    v_dot2_f32_bf16 v218, v37, v224, v218
    v_dot2_f32_bf16 v219, v37, v37, v219
    v_dot2_f32_bf16 v218, v38, v224, v218
    buffer_load_dwordx4 a[152:155], v8, s[28:31], s36 offen offset:2048
    v_dot2_f32_bf16 v219, v38, v38, v219
    v_dot2_f32_bf16 v218, v39, v224, v218
    v_dot2_f32_bf16 v219, v39, v39, v219
    ds_write_b128 v12, v[36:39] offset:0
    s_waitcnt lgkmcnt(1)
    v_pk_fma_f32 v[88:89], v[88:89], v[220:221], v[220:221] op_sel:[0,1,0] op_sel_hi:[1,1,0]
    v_pk_fma_f32 v[90:91], v[90:91], v[220:221], v[220:221] op_sel:[0,1,0] op_sel_hi:[1,1,0]
    v_pk_fma_f32 v[92:93], v[92:93], v[220:221], v[220:221] op_sel:[0,1,0] op_sel_hi:[1,1,0]
    ds_read_b128 v[152:155], v227 offset:11264
    buffer_load_dwordx4 a[156:159], v8, s[28:31], s36 offen offset:3072
    v_pk_fma_f32 v[94:95], v[94:95], v[220:221], v[220:221] op_sel:[0,1,0] op_sel_hi:[1,1,0]
    v_pk_fma_f32 v[88:89], v[88:89], v[168:169], v[176:177]
    v_pk_fma_f32 v[90:91], v[90:91], v[170:171], v[178:179]
    ds_read_b128 v[156:159], v227 offset:11280
    v_pk_fma_f32 v[92:93], v[92:93], v[172:173], v[180:181]
    v_pk_fma_f32 v[94:95], v[94:95], v[174:175], v[182:183]
    v_cvt_pk_bf16_f32 v40, v88, v89
    ds_read_b128 v[160:163], v227 offset:8704
    v_cvt_pk_bf16_f32 v41, v90, v91
    v_cvt_pk_bf16_f32 v42, v92, v93
    v_cvt_pk_bf16_f32 v43, v94, v95
    ds_read_b128 v[164:167], v227 offset:8720
    s_add_u32 s36, s36, 4096
    buffer_load_dwordx4 a[160:163], v8, s[28:31], s36 offen offset:0
    v_dot2_f32_bf16 v216, v40, v224, v216
    v_dot2_f32_bf16 v217, v40, v40, v217
    v_dot2_f32_bf16 v216, v41, v224, v216
    v_dot2_f32_bf16 v217, v41, v41, v217
    v_dot2_f32_bf16 v216, v42, v224, v216
    v_dot2_f32_bf16 v217, v42, v42, v217
    v_dot2_f32_bf16 v216, v43, v224, v216
    v_dot2_f32_bf16 v217, v43, v43, v217
    ds_write_b128 v228, v[40:43] offset:4096
    v_pk_fma_f32 v[96:97], v[96:97], v[222:223], v[222:223] op_sel:[0,1,0] op_sel_hi:[1,1,0]
    buffer_load_dwordx4 a[164:167], v8, s[28:31], s36 offen offset:1024
    v_pk_fma_f32 v[98:99], v[98:99], v[222:223], v[222:223] op_sel:[0,1,0] op_sel_hi:[1,1,0]
    v_pk_fma_f32 v[100:101], v[100:101], v[222:223], v[222:223] op_sel:[0,1,0] op_sel_hi:[1,1,0]
    v_pk_fma_f32 v[102:103], v[102:103], v[222:223], v[222:223] op_sel:[0,1,0] op_sel_hi:[1,1,0]
    v_pk_fma_f32 v[96:97], v[96:97], v[168:169], v[176:177]
    v_pk_fma_f32 v[98:99], v[98:99], v[170:171], v[178:179]
    v_pk_fma_f32 v[100:101], v[100:101], v[172:173], v[180:181]
    v_pk_fma_f32 v[102:103], v[102:103], v[174:175], v[182:183]
    v_cvt_pk_bf16_f32 v44, v96, v97
    v_cvt_pk_bf16_f32 v45, v98, v99
    v_cvt_pk_bf16_f32 v46, v100, v101
    v_cvt_pk_bf16_f32 v47, v102, v103
    v_dot2_f32_bf16 v218, v44, v224, v218
    v_dot2_f32_bf16 v219, v44, v44, v219
    v_dot2_f32_bf16 v218, v45, v224, v218
    v_dot2_f32_bf16 v219, v45, v45, v219
    v_dot2_f32_bf16 v218, v46, v224, v218
    v_dot2_f32_bf16 v219, v46, v46, v219
    buffer_load_dwordx4 a[168:171], v8, s[28:31], s36 offen offset:2048
    v_dot2_f32_bf16 v218, v47, v224, v218
    v_dot2_f32_bf16 v219, v47, v47, v219
    ds_write_b128 v12, v[44:47] offset:4096
    s_waitcnt lgkmcnt(1)
    v_pk_fma_f32 v[104:105], v[104:105], v[220:221], v[220:221] op_sel:[0,1,0] op_sel_hi:[1,1,0]
    v_pk_fma_f32 v[106:107], v[106:107], v[220:221], v[220:221] op_sel:[0,1,0] op_sel_hi:[1,1,0]
    v_pk_fma_f32 v[108:109], v[108:109], v[220:221], v[220:221] op_sel:[0,1,0] op_sel_hi:[1,1,0]
    ds_read_b128 v[168:171], v227 offset:11776
    buffer_load_dwordx4 a[172:175], v8, s[28:31], s36 offen offset:3072
    v_pk_fma_f32 v[110:111], v[110:111], v[220:221], v[220:221] op_sel:[0,1,0] op_sel_hi:[1,1,0]
    v_pk_fma_f32 v[104:105], v[104:105], v[152:153], v[160:161]
    v_pk_fma_f32 v[106:107], v[106:107], v[154:155], v[162:163]
    ds_read_b128 v[172:175], v227 offset:11792
    v_pk_fma_f32 v[108:109], v[108:109], v[156:157], v[164:165]
    v_pk_fma_f32 v[110:111], v[110:111], v[158:159], v[166:167]
    v_cvt_pk_bf16_f32 v48, v104, v105
    ds_read_b128 v[176:179], v227 offset:9216
    v_cvt_pk_bf16_f32 v49, v106, v107
    v_cvt_pk_bf16_f32 v50, v108, v109
    v_cvt_pk_bf16_f32 v51, v110, v111
    ds_read_b128 v[180:183], v227 offset:9232
    s_add_u32 s36, s36, 4096
    buffer_load_dwordx4 a[176:179], v8, s[28:31], s36 offen offset:0
    v_dot2_f32_bf16 v216, v48, v224, v216
    v_dot2_f32_bf16 v217, v48, v48, v217
    v_dot2_f32_bf16 v216, v49, v224, v216
    v_dot2_f32_bf16 v217, v49, v49, v217
    v_dot2_f32_bf16 v216, v50, v224, v216
    v_dot2_f32_bf16 v217, v50, v50, v217
    v_dot2_f32_bf16 v216, v51, v224, v216
    v_dot2_f32_bf16 v217, v51, v51, v217
    ds_write_b128 v228, v[48:51] offset:8192
    v_pk_fma_f32 v[112:113], v[112:113], v[222:223], v[222:223] op_sel:[0,1,0] op_sel_hi:[1,1,0]
    buffer_load_dwordx4 a[180:183], v8, s[28:31], s36 offen offset:1024
    v_pk_fma_f32 v[114:115], v[114:115], v[222:223], v[222:223] op_sel:[0,1,0] op_sel_hi:[1,1,0]
    v_pk_fma_f32 v[116:117], v[116:117], v[222:223], v[222:223] op_sel:[0,1,0] op_sel_hi:[1,1,0]
    v_pk_fma_f32 v[118:119], v[118:119], v[222:223], v[222:223] op_sel:[0,1,0] op_sel_hi:[1,1,0]
    v_pk_fma_f32 v[112:113], v[112:113], v[152:153], v[160:161]
    v_pk_fma_f32 v[114:115], v[114:115], v[154:155], v[162:163]
    v_pk_fma_f32 v[116:117], v[116:117], v[156:157], v[164:165]
    v_pk_fma_f32 v[118:119], v[118:119], v[158:159], v[166:167]
    v_cvt_pk_bf16_f32 v52, v112, v113
    v_cvt_pk_bf16_f32 v53, v114, v115
    v_cvt_pk_bf16_f32 v54, v116, v117
    v_cvt_pk_bf16_f32 v55, v118, v119
    v_dot2_f32_bf16 v218, v52, v224, v218
    v_dot2_f32_bf16 v219, v52, v52, v219
    v_dot2_f32_bf16 v218, v53, v224, v218
    v_dot2_f32_bf16 v219, v53, v53, v219
    v_dot2_f32_bf16 v218, v54, v224, v218
    v_dot2_f32_bf16 v219, v54, v54, v219
    buffer_load_dwordx4 a[184:187], v8, s[28:31], s36 offen offset:2048
    v_dot2_f32_bf16 v218, v55, v224, v218
    v_dot2_f32_bf16 v219, v55, v55, v219
    ds_write_b128 v12, v[52:55] offset:8192
    s_waitcnt lgkmcnt(1)
    v_pk_fma_f32 v[120:121], v[120:121], v[220:221], v[220:221] op_sel:[0,1,0] op_sel_hi:[1,1,0]
    v_pk_fma_f32 v[122:123], v[122:123], v[220:221], v[220:221] op_sel:[0,1,0] op_sel_hi:[1,1,0]
    v_pk_fma_f32 v[124:125], v[124:125], v[220:221], v[220:221] op_sel:[0,1,0] op_sel_hi:[1,1,0]
    ds_read_b128 v[152:155], v227 offset:12288
    buffer_load_dwordx4 a[188:191], v8, s[28:31], s36 offen offset:3072
    v_pk_fma_f32 v[126:127], v[126:127], v[220:221], v[220:221] op_sel:[0,1,0] op_sel_hi:[1,1,0]
    v_pk_fma_f32 v[120:121], v[120:121], v[168:169], v[176:177]
    v_pk_fma_f32 v[122:123], v[122:123], v[170:171], v[178:179]
    ds_read_b128 v[156:159], v227 offset:12304
    v_pk_fma_f32 v[124:125], v[124:125], v[172:173], v[180:181]
    v_pk_fma_f32 v[126:127], v[126:127], v[174:175], v[182:183]
    v_cvt_pk_bf16_f32 v56, v120, v121
    ds_read_b128 v[160:163], v227 offset:9728
    v_cvt_pk_bf16_f32 v57, v122, v123
    v_cvt_pk_bf16_f32 v58, v124, v125
    v_cvt_pk_bf16_f32 v59, v126, v127
    ds_read_b128 v[164:167], v227 offset:9744
    s_add_u32 s36, s36, 4096
    buffer_load_dwordx4 a[192:195], v8, s[28:31], s36 offen offset:0
    v_dot2_f32_bf16 v216, v56, v224, v216
    v_dot2_f32_bf16 v217, v56, v56, v217
    v_dot2_f32_bf16 v216, v57, v224, v216
    v_dot2_f32_bf16 v217, v57, v57, v217
    v_dot2_f32_bf16 v216, v58, v224, v216
    v_dot2_f32_bf16 v217, v58, v58, v217
    v_dot2_f32_bf16 v216, v59, v224, v216
    v_dot2_f32_bf16 v217, v59, v59, v217
    ds_write_b128 v228, v[56:59] offset:12288
    v_pk_fma_f32 v[128:129], v[128:129], v[222:223], v[222:223] op_sel:[0,1,0] op_sel_hi:[1,1,0]
    buffer_load_dwordx4 a[196:199], v8, s[28:31], s36 offen offset:1024
    v_pk_fma_f32 v[130:131], v[130:131], v[222:223], v[222:223] op_sel:[0,1,0] op_sel_hi:[1,1,0]
    v_pk_fma_f32 v[132:133], v[132:133], v[222:223], v[222:223] op_sel:[0,1,0] op_sel_hi:[1,1,0]
    v_pk_fma_f32 v[134:135], v[134:135], v[222:223], v[222:223] op_sel:[0,1,0] op_sel_hi:[1,1,0]
    v_pk_fma_f32 v[128:129], v[128:129], v[168:169], v[176:177]
    v_pk_fma_f32 v[130:131], v[130:131], v[170:171], v[178:179]
    v_pk_fma_f32 v[132:133], v[132:133], v[172:173], v[180:181]
    v_pk_fma_f32 v[134:135], v[134:135], v[174:175], v[182:183]
    v_cvt_pk_bf16_f32 v60, v128, v129
    v_cvt_pk_bf16_f32 v61, v130, v131
    v_cvt_pk_bf16_f32 v62, v132, v133
    v_cvt_pk_bf16_f32 v63, v134, v135
    v_dot2_f32_bf16 v218, v60, v224, v218
    v_dot2_f32_bf16 v219, v60, v60, v219
    v_dot2_f32_bf16 v218, v61, v224, v218
    v_dot2_f32_bf16 v219, v61, v61, v219
    v_dot2_f32_bf16 v218, v62, v224, v218
    v_dot2_f32_bf16 v219, v62, v62, v219
    buffer_load_dwordx4 a[200:203], v8, s[28:31], s37 offen offset:0
    v_dot2_f32_bf16 v218, v63, v224, v218
    v_dot2_f32_bf16 v219, v63, v63, v219
    ds_write_b128 v12, v[60:63] offset:12288
    s_waitcnt lgkmcnt(1)
    v_pk_fma_f32 v[136:137], v[136:137], v[220:221], v[220:221] op_sel:[0,1,0] op_sel_hi:[1,1,0]
    v_pk_fma_f32 v[138:139], v[138:139], v[220:221], v[220:221] op_sel:[0,1,0] op_sel_hi:[1,1,0]
    v_pk_fma_f32 v[140:141], v[140:141], v[220:221], v[220:221] op_sel:[0,1,0] op_sel_hi:[1,1,0]
    v_pk_fma_f32 v[142:143], v[142:143], v[220:221], v[220:221] op_sel:[0,1,0] op_sel_hi:[1,1,0]
    v_pk_fma_f32 v[136:137], v[136:137], v[152:153], v[160:161]
    v_pk_fma_f32 v[138:139], v[138:139], v[154:155], v[162:163]
    buffer_load_dwordx4 a[204:207], v8, s[28:31], s37 offen offset:1024
    v_pk_fma_f32 v[140:141], v[140:141], v[156:157], v[164:165]
    v_pk_fma_f32 v[142:143], v[142:143], v[158:159], v[166:167]
    v_cvt_pk_bf16_f32 v64, v136, v137
    v_cvt_pk_bf16_f32 v65, v138, v139
    v_cvt_pk_bf16_f32 v66, v140, v141
    v_cvt_pk_bf16_f32 v67, v142, v143
    v_dot2_f32_bf16 v216, v64, v224, v216
    v_dot2_f32_bf16 v217, v64, v64, v217
    v_dot2_f32_bf16 v216, v65, v224, v216
    v_dot2_f32_bf16 v217, v65, v65, v217
    v_dot2_f32_bf16 v216, v66, v224, v216
    v_dot2_f32_bf16 v217, v66, v66, v217
    v_dot2_f32_bf16 v216, v67, v224, v216
    v_dot2_f32_bf16 v217, v67, v67, v217
    ds_write_b128 v228, v[64:67] offset:16384
    buffer_load_dwordx4 a[208:211], v8, s[28:31], s37 offen offset:2048
    v_pk_fma_f32 v[144:145], v[144:145], v[222:223], v[222:223] op_sel:[0,1,0] op_sel_hi:[1,1,0]
    v_pk_fma_f32 v[146:147], v[146:147], v[222:223], v[222:223] op_sel:[0,1,0] op_sel_hi:[1,1,0]
    v_pk_fma_f32 v[148:149], v[148:149], v[222:223], v[222:223] op_sel:[0,1,0] op_sel_hi:[1,1,0]
    v_pk_fma_f32 v[150:151], v[150:151], v[222:223], v[222:223] op_sel:[0,1,0] op_sel_hi:[1,1,0]
    v_pk_fma_f32 v[144:145], v[144:145], v[152:153], v[160:161]
    v_pk_fma_f32 v[146:147], v[146:147], v[154:155], v[162:163]
    v_pk_fma_f32 v[148:149], v[148:149], v[156:157], v[164:165]
    v_pk_fma_f32 v[150:151], v[150:151], v[158:159], v[166:167]
    v_cvt_pk_bf16_f32 v68, v144, v145
    v_cvt_pk_bf16_f32 v69, v146, v147
    v_cvt_pk_bf16_f32 v70, v148, v149
    v_cvt_pk_bf16_f32 v71, v150, v151
    v_dot2_f32_bf16 v218, v68, v224, v218
    v_dot2_f32_bf16 v219, v68, v68, v219
    v_dot2_f32_bf16 v218, v69, v224, v218
    v_dot2_f32_bf16 v219, v69, v69, v219
    v_dot2_f32_bf16 v218, v70, v224, v218
    buffer_load_dwordx4 a[212:215], v8, s[28:31], s37 offen offset:3072
    v_dot2_f32_bf16 v219, v70, v70, v219
    v_dot2_f32_bf16 v218, v71, v224, v218
    v_dot2_f32_bf16 v219, v71, v71, v219
    ds_write_b128 v12, v[68:71] offset:16384
    s_waitcnt lgkmcnt(0)
    s_barrier
    ds_read_b128 v[72:75], v229 offset:0
    ds_read_b128 v[76:79], v231 offset:0
    s_add_u32 s37, s37, 4096
    buffer_load_dwordx4 a[216:219], v8, s[28:31], s37 offen offset:0
    s_waitcnt vmcnt(50) lgkmcnt(0)
    v_mfma_f32_16x16x32_bf16 v[32:35], a[0:3], v[72:75], 0
    v_mfma_f32_16x16x32_bf16 v[52:55], a[0:3], v[76:79], 0
    ds_read_b128 v[80:83], v230 offset:1024
    v_mfma_f32_16x16x32_bf16 v[36:39], a[4:7], v[72:75], 0
    v_mfma_f32_16x16x32_bf16 v[56:59], a[4:7], v[76:79], 0
    buffer_load_dwordx4 a[220:223], v8, s[28:31], s37 offen offset:1024
    ds_read_b128 v[84:87], v232 offset:1024
    v_mfma_f32_16x16x32_bf16 v[40:43], a[8:11], v[72:75], 0
    v_mfma_f32_16x16x32_bf16 v[60:63], a[8:11], v[76:79], 0
    ds_read_b128 v[112:115], v233 offset:0
    v_mfma_f32_16x16x32_bf16 v[44:47], a[12:15], v[72:75], 0
    buffer_load_dwordx4 a[224:227], v8, s[28:31], s37 offen offset:2048
    v_mfma_f32_16x16x32_bf16 v[64:67], a[12:15], v[76:79], 0
    ds_read_b128 v[132:135], v233 offset:1024
    v_mfma_f32_16x16x32_bf16 v[48:51], a[16:19], v[72:75], 0
    v_mfma_f32_16x16x32_bf16 v[68:71], a[16:19], v[76:79], 0
    s_waitcnt vmcnt(47) lgkmcnt(0)
    v_mfma_f32_16x16x32_bf16 v[32:35], a[20:23], v[80:83], v[32:35]
    buffer_load_dwordx4 a[228:231], v8, s[28:31], s37 offen offset:3072
    v_add_f32_dpp v216, v216, v216 quad_perm:[1,0,3,2] row_mask:0xf bank_mask:0xf
    v_mfma_f32_16x16x32_bf16 v[52:55], a[20:23], v[84:87], v[52:55]
    ds_read_b128 v[72:75], v229 offset:2048
    v_mfma_f32_16x16x32_bf16 v[36:39], a[24:27], v[80:83], v[36:39]
    v_add_f32_dpp v217, v217, v217 quad_perm:[1,0,3,2] row_mask:0xf bank_mask:0xf
    v_mfma_f32_16x16x32_bf16 v[56:59], a[24:27], v[84:87], v[56:59]
    ds_read_b128 v[76:79], v231 offset:2048
    s_add_u32 s37, s37, 4096
    buffer_load_dwordx4 a[232:235], v8, s[28:31], s37 offen offset:0
    v_mfma_f32_16x16x32_bf16 v[40:43], a[28:31], v[80:83], v[40:43]
    v_add_f32_dpp v218, v218, v218 quad_perm:[1,0,3,2] row_mask:0xf bank_mask:0xf
    v_mfma_f32_16x16x32_bf16 v[60:63], a[28:31], v[84:87], v[60:63]
    ds_read_b128 v[116:119], v233 offset:64
    v_mfma_f32_16x16x32_bf16 v[44:47], a[32:35], v[80:83], v[44:47]
    v_add_f32_dpp v219, v219, v219 quad_perm:[1,0,3,2] row_mask:0xf bank_mask:0xf
    v_mfma_f32_16x16x32_bf16 v[64:67], a[32:35], v[84:87], v[64:67]
    buffer_load_dwordx4 a[236:239], v8, s[28:31], s37 offen offset:1024
    ds_read_b128 v[136:139], v233 offset:1088
    v_mfma_f32_16x16x32_bf16 v[48:51], a[36:39], v[80:83], v[48:51]
    v_add_f32_dpp v216, v216, v216 quad_perm:[2,3,0,1] row_mask:0xf bank_mask:0xf
    v_mfma_f32_16x16x32_bf16 v[68:71], a[36:39], v[84:87], v[68:71]
    v_add_f32_dpp v217, v217, v217 quad_perm:[2,3,0,1] row_mask:0xf bank_mask:0xf
    s_waitcnt vmcnt(45) lgkmcnt(0)
    v_mfma_f32_16x16x32_bf16 v[32:35], a[40:43], v[72:75], v[32:35]
    buffer_load_dwordx4 a[240:243], v8, s[28:31], s37 offen offset:2048
    v_add_f32_dpp v218, v218, v218 quad_perm:[2,3,0,1] row_mask:0xf bank_mask:0xf
    v_mfma_f32_16x16x32_bf16 v[52:55], a[40:43], v[76:79], v[52:55]
    ds_read_b128 v[80:83], v230 offset:3072
    v_mfma_f32_16x16x32_bf16 v[36:39], a[44:47], v[72:75], v[36:39]
    v_add_f32_dpp v219, v219, v219 quad_perm:[2,3,0,1] row_mask:0xf bank_mask:0xf
    v_mfma_f32_16x16x32_bf16 v[56:59], a[44:47], v[76:79], v[56:59]
    ds_read_b128 v[84:87], v232 offset:3072
    buffer_load_dwordx4 a[244:247], v8, s[28:31], s37 offen offset:3072
    v_mfma_f32_16x16x32_bf16 v[40:43], a[48:51], v[72:75], v[40:43]
    v_add_f32_dpp v216, v216, v216 row_half_mirror row_mask:0xf bank_mask:0xf
    v_mfma_f32_16x16x32_bf16 v[60:63], a[48:51], v[76:79], v[60:63]
    ds_read_b128 v[120:123], v233 offset:128
    v_mfma_f32_16x16x32_bf16 v[44:47], a[52:55], v[72:75], v[44:47]
    v_add_f32_dpp v217, v217, v217 row_half_mirror row_mask:0xf bank_mask:0xf
    v_mfma_f32_16x16x32_bf16 v[64:67], a[52:55], v[76:79], v[64:67]
    s_add_u32 s37, s37, 4096
    buffer_load_dwordx4 a[248:251], v8, s[28:31], s37 offen offset:0
    ds_read_b128 v[140:143], v233 offset:1152
    v_mfma_f32_16x16x32_bf16 v[48:51], a[56:59], v[72:75], v[48:51]
    v_add_f32_dpp v218, v218, v218 row_half_mirror row_mask:0xf bank_mask:0xf
    v_mfma_f32_16x16x32_bf16 v[68:71], a[56:59], v[76:79], v[68:71]
    v_add_f32_dpp v219, v219, v219 row_half_mirror row_mask:0xf bank_mask:0xf
    s_waitcnt vmcnt(43) lgkmcnt(0)
    v_mfma_f32_16x16x32_bf16 v[32:35], a[60:63], v[80:83], v[32:35]
    buffer_load_dwordx4 a[252:255], v8, s[28:31], s37 offen offset:1024
    v_add_f32_dpp v216, v216, v216 row_mirror row_mask:0xf bank_mask:0xf
    v_mfma_f32_16x16x32_bf16 v[52:55], a[60:63], v[84:87], v[52:55]
    ds_read_b128 v[72:75], v229 offset:4096
    v_mfma_f32_16x16x32_bf16 v[36:39], a[64:67], v[80:83], v[36:39]
    v_add_f32_dpp v217, v217, v217 row_mirror row_mask:0xf bank_mask:0xf
    v_mfma_f32_16x16x32_bf16 v[56:59], a[64:67], v[84:87], v[56:59]
    ds_read_b128 v[76:79], v231 offset:4096
    buffer_load_dwordx4 a[0:3], v8, s[28:31], s37 offen offset:2048
    v_mfma_f32_16x16x32_bf16 v[40:43], a[68:71], v[80:83], v[40:43]
    v_add_f32_dpp v218, v218, v218 row_mirror row_mask:0xf bank_mask:0xf
    v_mfma_f32_16x16x32_bf16 v[60:63], a[68:71], v[84:87], v[60:63]
    ds_read_b128 v[124:127], v233 offset:192
    v_mfma_f32_16x16x32_bf16 v[44:47], a[72:75], v[80:83], v[44:47]
    v_add_f32_dpp v219, v219, v219 row_mirror row_mask:0xf bank_mask:0xf
    v_mfma_f32_16x16x32_bf16 v[64:67], a[72:75], v[84:87], v[64:67]
    buffer_load_dwordx4 a[4:7], v8, s[28:31], s37 offen offset:3072
    ds_read_b128 v[144:147], v233 offset:1216
    v_mfma_f32_16x16x32_bf16 v[48:51], a[76:79], v[80:83], v[48:51]
    v_mul_f32 v216, 0x3acccccd, v216
    v_mfma_f32_16x16x32_bf16 v[68:71], a[76:79], v[84:87], v[68:71]
    v_mul_f32 v218, 0x3acccccd, v218
    s_waitcnt vmcnt(41) lgkmcnt(0)
    v_mfma_f32_16x16x32_bf16 v[32:35], a[80:83], v[72:75], v[32:35]
    s_add_u32 s37, s37, 4096
    buffer_load_dwordx4 a[8:11], v8, s[28:31], s37 offen offset:0
    v_mul_f32 v217, 0x3acccccd, v217
    v_mfma_f32_16x16x32_bf16 v[52:55], a[80:83], v[76:79], v[52:55]
    ds_read_b128 v[80:83], v230 offset:5120
    v_mfma_f32_16x16x32_bf16 v[36:39], a[84:87], v[72:75], v[36:39]
    v_mul_f32 v219, 0x3acccccd, v219
    v_mfma_f32_16x16x32_bf16 v[56:59], a[84:87], v[76:79], v[56:59]
    ds_read_b128 v[84:87], v232 offset:5120
    buffer_load_dwordx4 a[12:15], v8, s[28:31], s37 offen offset:1024
    v_mfma_f32_16x16x32_bf16 v[40:43], a[88:91], v[72:75], v[40:43]
    v_fma_f32 v217, -v216, v216, v217
    v_mfma_f32_16x16x32_bf16 v[60:63], a[88:91], v[76:79], v[60:63]
    ds_read_b128 v[128:131], v234
    v_mfma_f32_16x16x32_bf16 v[44:47], a[92:95], v[72:75], v[44:47]
    v_fma_f32 v219, -v218, v218, v219
    v_mfma_f32_16x16x32_bf16 v[64:67], a[92:95], v[76:79], v[64:67]
    buffer_load_dwordx4 a[16:19], v8, s[28:31], s37 offen offset:2048
    ds_read_b128 v[148:151], v234 offset:1024
    v_mfma_f32_16x16x32_bf16 v[48:51], a[96:99], v[72:75], v[48:51]
    v_max_f32 v217, 0, v217
    v_mfma_f32_16x16x32_bf16 v[68:71], a[96:99], v[76:79], v[68:71]
    v_max_f32 v219, 0, v219
    s_waitcnt vmcnt(39) lgkmcnt(0)
    v_mfma_f32_16x16x32_bf16 v[32:35], a[100:103], v[80:83], v[32:35]
    buffer_load_dwordx4 a[20:23], v8, s[28:31], s37 offen offset:3072
    v_cvt_pk_bf16_f32 v192, v216, v217
    v_mfma_f32_16x16x32_bf16 v[52:55], a[100:103], v[84:87], v[52:55]
    ds_read_b128 v[72:75], v229 offset:6144
    v_mfma_f32_16x16x32_bf16 v[36:39], a[104:107], v[80:83], v[36:39]
    v_cvt_pk_bf16_f32 v193, v218, v219
    v_mfma_f32_16x16x32_bf16 v[56:59], a[104:107], v[84:87], v[56:59]
    ds_read_b128 v[76:79], v231 offset:6144
    s_add_u32 s37, s37, 4096
    buffer_load_dwordx4 a[24:27], v8, s[28:31], s37 offen offset:0
    v_mfma_f32_16x16x32_bf16 v[40:43], a[108:111], v[80:83], v[40:43]
    v_lshlrev_b32 v216, 16, v192
    v_mfma_f32_16x16x32_bf16 v[60:63], a[108:111], v[84:87], v[60:63]
    ds_read_b64 v[16:17], v236
    v_mfma_f32_16x16x32_bf16 v[44:47], a[112:115], v[80:83], v[44:47]
    v_lshlrev_b32 v218, 16, v193
    v_mfma_f32_16x16x32_bf16 v[64:67], a[112:115], v[84:87], v[64:67]
    buffer_load_dwordx4 a[28:31], v8, s[28:31], s37 offen offset:1024
    ds_read_b64 v[18:19], v237
    v_mfma_f32_16x16x32_bf16 v[48:51], a[116:119], v[80:83], v[48:51]
    v_and_b32 v217, 0xffff0000, v192
    v_mfma_f32_16x16x32_bf16 v[68:71], a[116:119], v[84:87], v[68:71]
    v_and_b32 v219, 0xffff0000, v193
    s_waitcnt vmcnt(37) lgkmcnt(0)
    v_mfma_f32_16x16x32_bf16 v[32:35], a[120:123], v[72:75], v[32:35]
    buffer_load_dwordx4 a[32:35], v8, s[28:31], s37 offen offset:2048
    v_add_f32 v217, 0x3727c5ac, v217
    v_mfma_f32_16x16x32_bf16 v[52:55], a[120:123], v[76:79], v[52:55]
    ds_read_b128 v[80:83], v230 offset:7168
    v_mfma_f32_16x16x32_bf16 v[36:39], a[124:127], v[72:75], v[36:39]
    v_add_f32 v219, 0x3727c5ac, v219
    v_mfma_f32_16x16x32_bf16 v[56:59], a[124:127], v[76:79], v[56:59]
    ds_read_b128 v[84:87], v232 offset:7168
    buffer_load_dwordx4 a[36:39], v8, s[28:31], s37 offen offset:3072
    v_mfma_f32_16x16x32_bf16 v[40:43], a[128:131], v[72:75], v[40:43]
    v_cvt_pk_bf16_f32 v192, v217, v217
    v_mfma_f32_16x16x32_bf16 v[60:63], a[128:131], v[76:79], v[60:63]
    ds_read_b64 v[20:21], v238
    v_mfma_f32_16x16x32_bf16 v[44:47], a[132:135], v[72:75], v[44:47]
    v_cvt_pk_bf16_f32 v193, v219, v219
    v_mfma_f32_16x16x32_bf16 v[64:67], a[132:135], v[76:79], v[64:67]
    s_add_u32 s37, s37, 4096
    buffer_load_dwordx4 a[40:43], v8, s[28:31], s37 offen offset:0
    ds_read_b64 v[22:23], v239
    v_mfma_f32_16x16x32_bf16 v[48:51], a[136:139], v[72:75], v[48:51]
    v_lshlrev_b32 v217, 16, v192
    v_mfma_f32_16x16x32_bf16 v[68:71], a[136:139], v[76:79], v[68:71]
    v_lshlrev_b32 v219, 16, v193
    s_waitcnt vmcnt(35) lgkmcnt(0)
    v_mfma_f32_16x16x32_bf16 v[32:35], a[140:143], v[80:83], v[32:35]
    buffer_load_dwordx4 a[44:47], v8, s[28:31], s37 offen offset:1024
    v_sqrt_f32 v217, v217
    v_mfma_f32_16x16x32_bf16 v[52:55], a[140:143], v[84:87], v[52:55]
    ds_read_b128 v[72:75], v229 offset:8192
    v_mfma_f32_16x16x32_bf16 v[36:39], a[144:147], v[80:83], v[36:39]
    v_sqrt_f32 v219, v219
    v_mfma_f32_16x16x32_bf16 v[56:59], a[144:147], v[84:87], v[56:59]
    buffer_load_dwordx4 a[48:51], v8, s[28:31], s37 offen offset:2048
    ds_read_b128 v[76:79], v231 offset:8192
    v_mfma_f32_16x16x32_bf16 v[40:43], a[148:151], v[80:83], v[40:43]
    v_cvt_pk_bf16_f32 v192, v217, v217
    v_mfma_f32_16x16x32_bf16 v[60:63], a[148:151], v[84:87], v[60:63]
    ds_read_b64 v[24:25], v240
    v_mfma_f32_16x16x32_bf16 v[44:47], a[152:155], v[80:83], v[44:47]
    buffer_load_dwordx4 a[52:55], v8, s[28:31], s37 offen offset:3072
    v_cvt_pk_bf16_f32 v193, v219, v219
    v_mfma_f32_16x16x32_bf16 v[64:67], a[152:155], v[84:87], v[64:67]
    v_lshlrev_b32 v217, 16, v192
    v_mfma_f32_16x16x32_bf16 v[48:51], a[156:159], v[80:83], v[48:51]
    v_lshlrev_b32 v219, 16, v193
    v_mfma_f32_16x16x32_bf16 v[68:71], a[156:159], v[84:87], v[68:71]
    v_rcp_f32 v217, v217
    s_waitcnt vmcnt(33) lgkmcnt(0)
    s_add_u32 s37, s37, 4096
    buffer_load_dwordx4 a[56:59], v8, s[28:31], s37 offen offset:0
    v_mfma_f32_16x16x32_bf16 v[32:35], a[160:163], v[72:75], v[32:35]
    v_rcp_f32 v219, v219
    v_mfma_f32_16x16x32_bf16 v[52:55], a[160:163], v[76:79], v[52:55]
    ds_read_b128 v[80:83], v230 offset:9216
    v_mfma_f32_16x16x32_bf16 v[36:39], a[164:167], v[72:75], v[36:39]
    v_mul_f32 v216, v216, v217
    buffer_load_dwordx4 a[60:63], v8, s[28:31], s37 offen offset:1024
    v_mfma_f32_16x16x32_bf16 v[56:59], a[164:167], v[76:79], v[56:59]
    ds_read_b128 v[84:87], v232 offset:9216
    v_mfma_f32_16x16x32_bf16 v[40:43], a[168:171], v[72:75], v[40:43]
    v_mul_f32 v218, v218, v219
    v_mfma_f32_16x16x32_bf16 v[60:63], a[168:171], v[76:79], v[60:63]
    v_sub_f32 v216, 0, v216
    v_mfma_f32_16x16x32_bf16 v[44:47], a[172:175], v[72:75], v[44:47]
    buffer_load_dwordx4 a[64:67], v8, s[28:31], s37 offen offset:2048
    v_sub_f32 v218, 0, v218
    v_mfma_f32_16x16x32_bf16 v[64:67], a[172:175], v[76:79], v[64:67]
    s_lshl_b32 s26, s20, 6
    v_mfma_f32_16x16x32_bf16 v[48:51], a[176:179], v[72:75], v[48:51]
    v_lshl_add_u32 v2, v3, 3, s26
    v_mfma_f32_16x16x32_bf16 v[68:71], a[176:179], v[76:79], v[68:71]
    v_add_u32 v2, 138240, v2
    s_waitcnt vmcnt(31) lgkmcnt(0)
    v_mfma_f32_16x16x32_bf16 v[32:35], a[180:183], v[80:83], v[32:35]
    buffer_load_dwordx4 a[68:71], v8, s[28:31], s37 offen offset:3072
    ds_write_b64 v2, v[216:217]
    v_mfma_f32_16x16x32_bf16 v[52:55], a[180:183], v[84:87], v[52:55]
    ds_write_b64 v2, v[218:219] offset:32
    s_add_u32 s37, s37, 4096
    buffer_load_dwordx4 a[72:75], v8, s[28:31], s37 offen offset:0
    v_mfma_f32_16x16x32_bf16 v[36:39], a[184:187], v[80:83], v[36:39]
    v_mfma_f32_16x16x32_bf16 v[56:59], a[184:187], v[84:87], v[56:59]
    v_mfma_f32_16x16x32_bf16 v[40:43], a[188:191], v[80:83], v[40:43]
    v_mfma_f32_16x16x32_bf16 v[60:63], a[188:191], v[84:87], v[60:63]
    v_mfma_f32_16x16x32_bf16 v[44:47], a[192:195], v[80:83], v[44:47]
    buffer_load_dwordx4 a[76:79], v8, s[28:31], s37 offen offset:1024
    v_mfma_f32_16x16x32_bf16 v[64:67], a[192:195], v[84:87], v[64:67]
    v_mfma_f32_16x16x32_bf16 v[48:51], a[196:199], v[80:83], v[48:51]
    v_mfma_f32_16x16x32_bf16 v[68:71], a[196:199], v[84:87], v[68:71]
    s_waitcnt lgkmcnt(0)
    s_nop 4
    ds_write_b128 v246, v[52:55] offset:0
    buffer_load_dwordx4 a[80:83], v8, s[28:31], s37 offen offset:2048
    ds_write_b128 v246, v[56:59] offset:1024
    ds_write_b128 v246, v[60:63] offset:2048
    buffer_load_dwordx4 a[84:87], v8, s[28:31], s37 offen offset:3072
    ds_write_b128 v246, v[64:67] offset:3072
    ds_write_b128 v246, v[68:71] offset:4096
    s_add_u32 s37, s37, 4096
    buffer_load_dwordx4 a[88:91], v8, s[28:31], s37 offen offset:0
    v_pk_add_f32 v[112:113], v[112:113], v[132:133]
    v_pk_add_f32 v[114:115], v[114:115], v[134:135]
    v_pk_add_f32 v[116:117], v[116:117], v[136:137]
    v_pk_add_f32 v[118:119], v[118:119], v[138:139]
    v_pk_add_f32 v[120:121], v[120:121], v[140:141]
    v_pk_add_f32 v[122:123], v[122:123], v[142:143]
    v_pk_add_f32 v[124:125], v[124:125], v[144:145]
    v_pk_add_f32 v[126:127], v[126:127], v[146:147]
    v_pk_add_f32 v[128:129], v[128:129], v[148:149]
    v_pk_add_f32 v[130:131], v[130:131], v[150:151]
    v_mov_b32 v30, 0xbdd2d3e8
    v_mov_b32 v31, 0xc0135761
    s_waitcnt lgkmcnt(0)
    s_barrier
    ds_read_b64 v[152:153], v235
    buffer_load_dwordx4 a[92:95], v8, s[28:31], s37 offen offset:1024
    ds_read_b128 v[88:91], v247 offset:0
    ds_read_b128 v[92:95], v247 offset:1024
    ds_read_b128 v[96:99], v247 offset:2048
    ds_read_b128 v[100:103], v247 offset:3072
    ds_read_b128 v[104:107], v247 offset:4096
    s_waitcnt lgkmcnt(5)
    v_pk_mul_f32 v[112:113], v[112:113], v[152:153] op_sel_hi:[1,0]
    buffer_load_dwordx4 a[96:99], v8, s[28:31], s37 offen offset:2048
    v_pk_mul_f32 v[114:115], v[114:115], v[152:153] op_sel_hi:[1,0]
    v_pk_mul_f32 v[116:117], v[116:117], v[152:153] op_sel_hi:[1,0]
    v_pk_mul_f32 v[118:119], v[118:119], v[152:153] op_sel_hi:[1,0]
    v_pk_mul_f32 v[120:121], v[120:121], v[152:153] op_sel_hi:[1,0]
    v_pk_mul_f32 v[122:123], v[122:123], v[152:153] op_sel_hi:[1,0]
    v_pk_mul_f32 v[124:125], v[124:125], v[152:153] op_sel_hi:[1,0]
    v_pk_mul_f32 v[126:127], v[126:127], v[152:153] op_sel_hi:[1,0]
    v_pk_mul_f32 v[128:129], v[128:129], v[152:153] op_sel_hi:[1,0]
    v_pk_mul_f32 v[130:131], v[130:131], v[152:153] op_sel_hi:[1,0]
    s_waitcnt lgkmcnt(4)
    v_pk_add_f32 v[32:33], v[32:33], v[88:89]
    v_pk_add_f32 v[34:35], v[34:35], v[90:91]
    s_waitcnt lgkmcnt(3)
    v_pk_add_f32 v[36:37], v[36:37], v[92:93]
    v_pk_add_f32 v[38:39], v[38:39], v[94:95]
    s_waitcnt lgkmcnt(2)
    v_pk_add_f32 v[40:41], v[40:41], v[96:97]
    buffer_load_dwordx4 a[100:103], v8, s[28:31], s37 offen offset:3072
    v_pk_add_f32 v[42:43], v[42:43], v[98:99]
    s_waitcnt lgkmcnt(1)
    v_pk_add_f32 v[44:45], v[44:45], v[100:101]
    v_pk_add_f32 v[46:47], v[46:47], v[102:103]
    s_waitcnt lgkmcnt(0)
    v_pk_add_f32 v[48:49], v[48:49], v[104:105]
    v_pk_add_f32 v[50:51], v[50:51], v[106:107]
    v_pk_fma_f32 v[32:33], v[32:33], v[152:153], v[112:113] op_sel:[0,1,0] op_sel_hi:[1,1,1]
    v_pk_fma_f32 v[34:35], v[34:35], v[152:153], v[114:115] op_sel:[0,1,0] op_sel_hi:[1,1,1]
    v_pk_fma_f32 v[36:37], v[36:37], v[152:153], v[116:117] op_sel:[0,1,0] op_sel_hi:[1,1,1]
    v_pk_fma_f32 v[38:39], v[38:39], v[152:153], v[118:119] op_sel:[0,1,0] op_sel_hi:[1,1,1]
    v_pk_fma_f32 v[40:41], v[40:41], v[152:153], v[120:121] op_sel:[0,1,0] op_sel_hi:[1,1,1]
    v_pk_fma_f32 v[42:43], v[42:43], v[152:153], v[122:123] op_sel:[0,1,0] op_sel_hi:[1,1,1]
    v_pk_fma_f32 v[44:45], v[44:45], v[152:153], v[124:125] op_sel:[0,1,0] op_sel_hi:[1,1,1]
    v_pk_fma_f32 v[46:47], v[46:47], v[152:153], v[126:127] op_sel:[0,1,0] op_sel_hi:[1,1,1]
    v_pk_fma_f32 v[48:49], v[48:49], v[152:153], v[128:129] op_sel:[0,1,0] op_sel_hi:[1,1,1]
    v_pk_fma_f32 v[50:51], v[50:51], v[152:153], v[130:131] op_sel:[0,1,0] op_sel_hi:[1,1,1]
    s_add_u32 s37, s37, 4096
    buffer_load_dwordx4 a[104:107], v8, s[28:31], s37 offen offset:0
    v_pk_mul_f32 v[192:193], v[32:33], v[32:33]
    v_pk_mul_f32 v[194:195], v[34:35], v[34:35]
    v_pk_mul_f32 v[196:197], v[36:37], v[36:37]
    v_pk_mul_f32 v[198:199], v[38:39], v[38:39]
    v_pk_mul_f32 v[200:201], v[40:41], v[40:41]
    v_pk_mul_f32 v[202:203], v[42:43], v[42:43]
    v_pk_mul_f32 v[204:205], v[44:45], v[44:45]
    v_pk_mul_f32 v[206:207], v[46:47], v[46:47]
    v_pk_mul_f32 v[208:209], v[48:49], v[48:49]
    v_pk_mul_f32 v[210:211], v[50:51], v[50:51]
    v_pk_fma_f32 v[192:193], v[192:193], v[30:31], v[30:31] op_sel:[0,0,1] op_sel_hi:[1,0,1]
    v_pk_fma_f32 v[194:195], v[194:195], v[30:31], v[30:31] op_sel:[0,0,1] op_sel_hi:[1,0,1]
    v_pk_fma_f32 v[196:197], v[196:197], v[30:31], v[30:31] op_sel:[0,0,1] op_sel_hi:[1,0,1]
    v_pk_fma_f32 v[198:199], v[198:199], v[30:31], v[30:31] op_sel:[0,0,1] op_sel_hi:[1,0,1]
    v_pk_fma_f32 v[200:201], v[200:201], v[30:31], v[30:31] op_sel:[0,0,1] op_sel_hi:[1,0,1]
    v_pk_fma_f32 v[202:203], v[202:203], v[30:31], v[30:31] op_sel:[0,0,1] op_sel_hi:[1,0,1]
    v_pk_fma_f32 v[204:205], v[204:205], v[30:31], v[30:31] op_sel:[0,0,1] op_sel_hi:[1,0,1]
    buffer_load_dwordx4 a[108:111], v8, s[28:31], s37 offen offset:1024
    v_pk_fma_f32 v[206:207], v[206:207], v[30:31], v[30:31] op_sel:[0,0,1] op_sel_hi:[1,0,1]
    v_pk_fma_f32 v[208:209], v[208:209], v[30:31], v[30:31] op_sel:[0,0,1] op_sel_hi:[1,0,1]
    v_pk_fma_f32 v[210:211], v[210:211], v[30:31], v[30:31] op_sel:[0,0,1] op_sel_hi:[1,0,1]
    v_pk_mul_f32 v[192:193], v[192:193], v[32:33]
    v_pk_mul_f32 v[194:195], v[194:195], v[34:35]
    v_pk_mul_f32 v[196:197], v[196:197], v[36:37]
    v_pk_mul_f32 v[198:199], v[198:199], v[38:39]
    v_pk_mul_f32 v[200:201], v[200:201], v[40:41]
    v_pk_mul_f32 v[202:203], v[202:203], v[42:43]
    v_pk_mul_f32 v[204:205], v[204:205], v[44:45]
    v_pk_mul_f32 v[206:207], v[206:207], v[46:47]
    v_pk_mul_f32 v[208:209], v[208:209], v[48:49]
    v_pk_mul_f32 v[210:211], v[210:211], v[50:51]
    v_exp_f32 v192, v192
    v_exp_f32 v193, v193
    buffer_load_dwordx4 a[112:115], v8, s[28:31], s37 offen offset:2048
    v_exp_f32 v194, v194
    v_exp_f32 v195, v195
    v_exp_f32 v196, v196
    v_exp_f32 v197, v197
    v_exp_f32 v198, v198
    v_exp_f32 v199, v199
    v_exp_f32 v200, v200
    v_exp_f32 v201, v201
    v_exp_f32 v202, v202
    buffer_load_dwordx4 a[116:119], v8, s[28:31], s37 offen offset:3072
    v_exp_f32 v203, v203
    v_exp_f32 v204, v204
    v_exp_f32 v205, v205
    v_exp_f32 v206, v206
    v_exp_f32 v207, v207
    v_exp_f32 v208, v208
    v_exp_f32 v209, v209
    v_exp_f32 v210, v210
    v_exp_f32 v211, v211
    s_add_u32 s37, s37, 4096
    buffer_load_dwordx4 a[120:123], v8, s[28:31], s37 offen offset:0
    v_pk_add_f32 v[192:193], v[192:193], 1.0 op_sel_hi:[1,0]
    v_pk_add_f32 v[194:195], v[194:195], 1.0 op_sel_hi:[1,0]
    v_pk_add_f32 v[196:197], v[196:197], 1.0 op_sel_hi:[1,0]
    v_pk_add_f32 v[198:199], v[198:199], 1.0 op_sel_hi:[1,0]
    v_pk_add_f32 v[200:201], v[200:201], 1.0 op_sel_hi:[1,0]
    v_pk_add_f32 v[202:203], v[202:203], 1.0 op_sel_hi:[1,0]
    v_pk_add_f32 v[204:205], v[204:205], 1.0 op_sel_hi:[1,0]
    v_pk_add_f32 v[206:207], v[206:207], 1.0 op_sel_hi:[1,0]
    v_pk_add_f32 v[208:209], v[208:209], 1.0 op_sel_hi:[1,0]
    v_pk_add_f32 v[210:211], v[210:211], 1.0 op_sel_hi:[1,0]
    v_rcp_f32 v192, v192
    v_rcp_f32 v193, v193
    v_rcp_f32 v194, v194
    v_rcp_f32 v195, v195
    buffer_load_dwordx4 a[124:127], v8, s[28:31], s37 offen offset:1024
    v_rcp_f32 v196, v196
    v_rcp_f32 v197, v197
    v_rcp_f32 v198, v198
    v_rcp_f32 v199, v199
    v_rcp_f32 v200, v200
    v_rcp_f32 v201, v201
    v_rcp_f32 v202, v202
    v_rcp_f32 v203, v203
    v_rcp_f32 v204, v204
    buffer_load_dwordx4 a[128:131], v8, s[28:31], s37 offen offset:2048
    v_rcp_f32 v205, v205
    v_rcp_f32 v206, v206
    v_rcp_f32 v207, v207
    v_rcp_f32 v208, v208
    v_rcp_f32 v209, v209
    v_rcp_f32 v210, v210
    v_rcp_f32 v211, v211
    v_pk_mul_f32 v[32:33], v[32:33], v[192:193]
    v_pk_mul_f32 v[34:35], v[34:35], v[194:195]
    v_pk_mul_f32 v[36:37], v[36:37], v[196:197]
    buffer_load_dwordx4 a[132:135], v8, s[28:31], s37 offen offset:3072
    v_pk_mul_f32 v[38:39], v[38:39], v[198:199]
    v_pk_mul_f32 v[40:41], v[40:41], v[200:201]
    v_pk_mul_f32 v[42:43], v[42:43], v[202:203]
    v_pk_mul_f32 v[44:45], v[44:45], v[204:205]
    v_pk_mul_f32 v[46:47], v[46:47], v[206:207]
    v_pk_mul_f32 v[48:49], v[48:49], v[208:209]
    v_pk_mul_f32 v[50:51], v[50:51], v[210:211]
    v_cvt_pk_bf16_f32 v180, v32, v33
    v_cvt_pk_bf16_f32 v181, v34, v35
    v_cvt_pk_bf16_f32 v182, v36, v37
    v_cvt_pk_bf16_f32 v183, v38, v39
    v_cvt_pk_bf16_f32 v184, v40, v41
    v_cvt_pk_bf16_f32 v185, v42, v43
    v_cvt_pk_bf16_f32 v186, v44, v45
    v_cvt_pk_bf16_f32 v187, v46, v47
    v_cvt_pk_bf16_f32 v188, v48, v49
    v_cvt_pk_bf16_f32 v189, v50, v51
    s_nop 1
    v_permlane16_swap_b32 v180, v182
    v_permlane16_swap_b32 v181, v183
    v_permlane16_swap_b32 v184, v186
    v_permlane16_swap_b32 v185, v187
    s_mov_b64 exec, s[60:61]
    buffer_store_dwordx4 v[180:183], v241, s[28:31], s44 offen sc1
    buffer_store_dwordx4 v[184:187], v241, s[28:31], s44 offen offset:1024 sc1
    buffer_store_dwordx2 v[188:189], v242, s[28:31], s45 offen sc1
    s_mov_b64 exec, -1
    s_waitcnt vmcnt(0)
    s_barrier
    s_cmp_lg_u32 s20, 0
    s_cbranch_scc1 chain_kernel_sig1
    v_mov_b32 v2, 1
    v_mov_b32 v7, 0
    s_mov_b64 exec, 1
    buffer_store_dword v2, v7, s[28:31], s46 offen sc1
    s_mov_b64 exec, -1
chain_kernel_sig1:
    s_add_u32 s37, s37, 4096
    buffer_load_dwordx4 a[136:139], v8, s[28:31], s37 offen offset:0
    buffer_load_dwordx4 a[140:143], v8, s[28:31], s37 offen offset:1024
    s_mul_i32 s25, s20, 10
    s_lshl_b32 s25, s25, 10
    s_add_u32 s62, s25, 0
    s_add_u32 s63, s25, s54
    s_add_u32 s63, s63, 0
    s_mov_b32 m0, s62
    buffer_load_dwordx4 v8, s[28:31], s63 offen offset:0 lds
    buffer_load_dwordx4 v8, s[28:31], s63 offen offset:1024 lds
    buffer_load_dwordx4 v8, s[28:31], s63 offen offset:2048 lds
    buffer_load_dwordx4 v8, s[28:31], s63 offen offset:3072 lds
    s_add_u32 s62, s62, 4096
    s_add_u32 s63, s63, 4096
    s_mov_b32 m0, s62
    buffer_load_dwordx4 v8, s[28:31], s63 offen offset:0 lds
    buffer_load_dwordx4 v8, s[28:31], s63 offen offset:1024 lds
    buffer_load_dwordx4 v8, s[28:31], s63 offen offset:2048 lds
    buffer_load_dwordx4 v8, s[28:31], s63 offen offset:3072 lds
    s_add_u32 s62, s62, 4096
    s_add_u32 s63, s63, 4096
    s_mov_b32 m0, s62
    buffer_load_dwordx4 v8, s[28:31], s63 offen offset:0 lds
    buffer_load_dwordx4 v8, s[28:31], s63 offen offset:1024 lds
    s_lshl_b32 s26, s53, 3
    s_lshl_b32 s27, s20, 1
    s_add_u32 s56, s26, s27
    s_mul_i32 s6, s56, 20480
    s_add_u32 s6, s6, 13406208
    s_add_u32 s7, s6, 20480
    s_lshl_b32 s26, s53, 2
    s_add_u32 s26, s26, s20
    s_lshl_b32 s26, s26, 9
    s_add_u32 s8, s26, 29413376
    v_lshlrev_b32 v228, 3, v4
    v_lshl_add_u32 v228, v3, 8, v228
    s_lshl_b32 s9, s56, 10
    s_add_u32 s9, s9, 23105536
    s_and_b32 s42, s52, 1
    s_mul_i32 s12, s52, 7
    s_add_u32 s13, s12, 1
    s_lshr_b32 s13, s13, 1
    s_add_u32 s26, s13, 3
    s_sub_u32 s27, s13, 1
    s_cmp_eq_u32 s42, 1
    s_cselect_b32 s12, s27, s26
    s_lshl_b32 s13, s13, 10
    s_add_u32 s13, s13, 16027648
    s_lshl_b32 s12, s12, 10
    s_add_u32 s12, s12, 16027648
    s_lshl_b32 s14, s56, 4
    s_lshl_b32 s15, s53, 4
    s_add_u32 s15, s15, s52
    s_lshl_b32 s15, s15, 2
    s_add_u32 s15, s15, s20
    s_lshl_b32 s15, s15, 7
    s_add_u32 s15, s15, 29446144
    s_lshr_b32 s26, s43, 4
    s_lshl_b32 s26, s26, 3
    s_lshl_b32 s27, s24, 1
    s_add_u32 s26, s26, s27
    s_add_u32 s26, s26, s21
    s_lshl_b32 s26, s26, 7
    s_add_u32 s19, s26, 23105536
    v_add_u32 v226, s14, v4
    v_lshrrev_b32 v227, 4, v226
    v_and_b32 v226, 15, v226
    s_mov_b32 s27, 55296
    v_mul_lo_u32 v227, v227, s27
    v_lshl_add_u32 v227, v226, 4, v227
    v_and_b32 v226, 1, v3
    v_lshlrev_b32 v226, 9, v226
    v_lshrrev_b32 v2, 1, v3
    v_lshl_add_u32 v226, v2, 8, v226
    v_add_u32 v226, v226, v227
    s_lshl_b32 s27, s42, 9
    v_lshl_add_u32 v227, v2, 8, v227
    v_add_u32 v227, s27, v227
    v_and_b32 v2, 1, v3
    v_lshl_add_u32 v227, v2, 3, v227
    s_mov_b32 s48, 29380608
    s_mov_b32 s47, 0
    s_mov_b64 exec, 15
chain_kernel_poll2:
    buffer_load_dword v2, v245, s[28:31], s48 offen sc1
    s_add_u32 s47, s47, 1
    s_waitcnt vmcnt(0)
    v_cmp_ne_u32 vcc, 1, v2
    s_cmp_ge_u32 s47, 20000
    s_cbranch_scc1 chain_kernel_polld3
    s_cbranch_vccnz chain_kernel_poll2
chain_kernel_polld3:
    s_mov_b64 exec, -1
    buffer_load_dwordx4 v[72:75], v8, s[28:31], s50 offen offset:0 sc1
    buffer_load_dwordx4 v[76:79], v8, s[28:31], s51 offen offset:0 sc1
    buffer_load_dwordx4 v[80:83], v8, s[28:31], s50 offen offset:1024 sc1
    buffer_load_dwordx4 v[84:87], v8, s[28:31], s51 offen offset:1024 sc1
    buffer_load_dwordx4 v[88:91], v8, s[28:31], s50 offen offset:2048 sc1
    buffer_load_dwordx4 v[92:95], v8, s[28:31], s51 offen offset:2048 sc1
    buffer_load_dwordx4 v[96:99], v8, s[28:31], s50 offen offset:3072 sc1
    buffer_load_dwordx4 v[100:103], v8, s[28:31], s51 offen offset:3072 sc1
    s_add_u32 s50, s50, 4096
    s_add_u32 s51, s51, 4096
    buffer_load_dwordx4 v[104:107], v8, s[28:31], s50 offen offset:0 sc1
    buffer_load_dwordx4 v[108:111], v8, s[28:31], s51 offen offset:0 sc1
    s_waitcnt vmcnt(8)
    v_mfma_f32_16x16x32_bf16 v[32:35], a[200:203], v[72:75], 0
    v_mfma_f32_16x16x32_bf16 v[52:55], a[200:203], v[76:79], 0
    buffer_load_dwordx4 v[112:115], v8, s[28:31], s50 offen offset:1024 sc1
    v_mfma_f32_16x16x32_bf16 v[36:39], a[204:207], v[72:75], 0
    v_mfma_f32_16x16x32_bf16 v[56:59], a[204:207], v[76:79], 0
    v_mfma_f32_16x16x32_bf16 v[40:43], a[208:211], v[72:75], 0
    v_mfma_f32_16x16x32_bf16 v[60:63], a[208:211], v[76:79], 0
    buffer_load_dwordx4 v[116:119], v8, s[28:31], s51 offen offset:1024 sc1
    v_mfma_f32_16x16x32_bf16 v[44:47], a[212:215], v[72:75], 0
    v_mfma_f32_16x16x32_bf16 v[64:67], a[212:215], v[76:79], 0
    v_mfma_f32_16x16x32_bf16 v[48:51], a[216:219], v[72:75], 0
    v_mfma_f32_16x16x32_bf16 v[68:71], a[216:219], v[76:79], 0
    s_waitcnt vmcnt(8)
    v_mfma_f32_16x16x32_bf16 v[32:35], a[220:223], v[80:83], v[32:35]
    v_mfma_f32_16x16x32_bf16 v[52:55], a[220:223], v[84:87], v[52:55]
    buffer_load_dwordx4 v[120:123], v8, s[28:31], s50 offen offset:2048 sc1
    v_mfma_f32_16x16x32_bf16 v[36:39], a[224:227], v[80:83], v[36:39]
    v_mfma_f32_16x16x32_bf16 v[56:59], a[224:227], v[84:87], v[56:59]
    v_mfma_f32_16x16x32_bf16 v[40:43], a[228:231], v[80:83], v[40:43]
    v_mfma_f32_16x16x32_bf16 v[60:63], a[228:231], v[84:87], v[60:63]
    buffer_load_dwordx4 v[124:127], v8, s[28:31], s51 offen offset:2048 sc1
    v_mfma_f32_16x16x32_bf16 v[44:47], a[232:235], v[80:83], v[44:47]
    v_mfma_f32_16x16x32_bf16 v[64:67], a[232:235], v[84:87], v[64:67]
    v_mfma_f32_16x16x32_bf16 v[48:51], a[236:239], v[80:83], v[48:51]
    v_mfma_f32_16x16x32_bf16 v[68:71], a[236:239], v[84:87], v[68:71]
    s_waitcnt vmcnt(8)
    v_mfma_f32_16x16x32_bf16 v[32:35], a[240:243], v[88:91], v[32:35]
    v_mfma_f32_16x16x32_bf16 v[52:55], a[240:243], v[92:95], v[52:55]
    buffer_load_dwordx4 v[128:131], v8, s[28:31], s50 offen offset:3072 sc1
    v_mfma_f32_16x16x32_bf16 v[36:39], a[244:247], v[88:91], v[36:39]
    v_mfma_f32_16x16x32_bf16 v[56:59], a[244:247], v[92:95], v[56:59]
    v_mfma_f32_16x16x32_bf16 v[40:43], a[248:251], v[88:91], v[40:43]
    v_mfma_f32_16x16x32_bf16 v[60:63], a[248:251], v[92:95], v[60:63]
    buffer_load_dwordx4 v[132:135], v8, s[28:31], s51 offen offset:3072 sc1
    v_mfma_f32_16x16x32_bf16 v[44:47], a[252:255], v[88:91], v[44:47]
    v_mfma_f32_16x16x32_bf16 v[64:67], a[252:255], v[92:95], v[64:67]
    v_mfma_f32_16x16x32_bf16 v[48:51], a[0:3], v[88:91], v[48:51]
    v_mfma_f32_16x16x32_bf16 v[68:71], a[0:3], v[92:95], v[68:71]
    s_waitcnt vmcnt(8)
    v_mfma_f32_16x16x32_bf16 v[32:35], a[4:7], v[96:99], v[32:35]
    v_mfma_f32_16x16x32_bf16 v[52:55], a[4:7], v[100:103], v[52:55]
    s_add_u32 s50, s50, 4096
    s_add_u32 s51, s51, 4096
    buffer_load_dwordx4 v[136:139], v8, s[28:31], s50 offen offset:0 sc1
    v_mfma_f32_16x16x32_bf16 v[36:39], a[8:11], v[96:99], v[36:39]
    v_mfma_f32_16x16x32_bf16 v[56:59], a[8:11], v[100:103], v[56:59]
    v_mfma_f32_16x16x32_bf16 v[40:43], a[12:15], v[96:99], v[40:43]
    v_mfma_f32_16x16x32_bf16 v[60:63], a[12:15], v[100:103], v[60:63]
    buffer_load_dwordx4 v[140:143], v8, s[28:31], s51 offen offset:0 sc1
    v_mfma_f32_16x16x32_bf16 v[44:47], a[16:19], v[96:99], v[44:47]
    v_mfma_f32_16x16x32_bf16 v[64:67], a[16:19], v[100:103], v[64:67]
    v_mfma_f32_16x16x32_bf16 v[48:51], a[20:23], v[96:99], v[48:51]
    v_mfma_f32_16x16x32_bf16 v[68:71], a[20:23], v[100:103], v[68:71]
    s_waitcnt vmcnt(8)
    v_mfma_f32_16x16x32_bf16 v[32:35], a[24:27], v[104:107], v[32:35]
    v_mfma_f32_16x16x32_bf16 v[52:55], a[24:27], v[108:111], v[52:55]
    buffer_load_dwordx4 v[144:147], v8, s[28:31], s50 offen offset:1024 sc1
    v_mfma_f32_16x16x32_bf16 v[36:39], a[28:31], v[104:107], v[36:39]
    v_mfma_f32_16x16x32_bf16 v[56:59], a[28:31], v[108:111], v[56:59]
    v_mfma_f32_16x16x32_bf16 v[40:43], a[32:35], v[104:107], v[40:43]
    v_mfma_f32_16x16x32_bf16 v[60:63], a[32:35], v[108:111], v[60:63]
    buffer_load_dwordx4 v[148:151], v8, s[28:31], s51 offen offset:1024 sc1
    v_mfma_f32_16x16x32_bf16 v[44:47], a[36:39], v[104:107], v[44:47]
    v_mfma_f32_16x16x32_bf16 v[64:67], a[36:39], v[108:111], v[64:67]
    s_mul_i32 s25, s20, 20
    s_lshl_b32 s25, s25, 10
    s_add_u32 s62, s25, 40960
    s_add_u32 s63, s25, s54
    s_add_u32 s63, s63, 40960
    s_mov_b32 m0, s62
    buffer_load_dwordx4 v8, s[28:31], s63 offen offset:0 lds
    v_mfma_f32_16x16x32_bf16 v[48:51], a[40:43], v[104:107], v[48:51]
    v_mfma_f32_16x16x32_bf16 v[68:71], a[40:43], v[108:111], v[68:71]
    s_waitcnt vmcnt(9)
    v_mfma_f32_16x16x32_bf16 v[32:35], a[44:47], v[112:115], v[32:35]
    v_mfma_f32_16x16x32_bf16 v[52:55], a[44:47], v[116:119], v[52:55]
    buffer_load_dwordx4 v8, s[28:31], s63 offen offset:1024 lds
    v_mfma_f32_16x16x32_bf16 v[36:39], a[48:51], v[112:115], v[36:39]
    v_mfma_f32_16x16x32_bf16 v[56:59], a[48:51], v[116:119], v[56:59]
    buffer_load_dwordx4 v8, s[28:31], s63 offen offset:2048 lds
    v_mfma_f32_16x16x32_bf16 v[40:43], a[52:55], v[112:115], v[40:43]
    v_mfma_f32_16x16x32_bf16 v[60:63], a[52:55], v[116:119], v[60:63]
    v_mfma_f32_16x16x32_bf16 v[44:47], a[56:59], v[112:115], v[44:47]
    v_mfma_f32_16x16x32_bf16 v[64:67], a[56:59], v[116:119], v[64:67]
    buffer_load_dwordx4 v8, s[28:31], s63 offen offset:3072 lds
    v_mfma_f32_16x16x32_bf16 v[48:51], a[60:63], v[112:115], v[48:51]
    v_mfma_f32_16x16x32_bf16 v[68:71], a[60:63], v[116:119], v[68:71]
    s_waitcnt vmcnt(10)
    v_mfma_f32_16x16x32_bf16 v[32:35], a[64:67], v[120:123], v[32:35]
    v_mfma_f32_16x16x32_bf16 v[52:55], a[64:67], v[124:127], v[52:55]
    s_add_u32 s62, s62, 4096
    s_add_u32 s63, s63, 4096
    s_mov_b32 m0, s62
    buffer_load_dwordx4 v8, s[28:31], s63 offen offset:0 lds
    v_mfma_f32_16x16x32_bf16 v[36:39], a[68:71], v[120:123], v[36:39]
    v_mfma_f32_16x16x32_bf16 v[56:59], a[68:71], v[124:127], v[56:59]
    buffer_load_dwordx4 v8, s[28:31], s63 offen offset:1024 lds
    v_mfma_f32_16x16x32_bf16 v[40:43], a[72:75], v[120:123], v[40:43]
    v_mfma_f32_16x16x32_bf16 v[60:63], a[72:75], v[124:127], v[60:63]
    v_mfma_f32_16x16x32_bf16 v[44:47], a[76:79], v[120:123], v[44:47]
    v_mfma_f32_16x16x32_bf16 v[64:67], a[76:79], v[124:127], v[64:67]
    buffer_load_dwordx4 v8, s[28:31], s63 offen offset:2048 lds
    v_mfma_f32_16x16x32_bf16 v[48:51], a[80:83], v[120:123], v[48:51]
    v_mfma_f32_16x16x32_bf16 v[68:71], a[80:83], v[124:127], v[68:71]
    s_waitcnt vmcnt(11)
    v_mfma_f32_16x16x32_bf16 v[32:35], a[84:87], v[128:131], v[32:35]
    v_mfma_f32_16x16x32_bf16 v[52:55], a[84:87], v[132:135], v[52:55]
    buffer_load_dwordx4 v8, s[28:31], s63 offen offset:3072 lds
    v_mfma_f32_16x16x32_bf16 v[36:39], a[88:91], v[128:131], v[36:39]
    v_mfma_f32_16x16x32_bf16 v[56:59], a[88:91], v[132:135], v[56:59]
    s_add_u32 s62, s62, 4096
    s_add_u32 s63, s63, 4096
    s_mov_b32 m0, s62
    buffer_load_dwordx4 v8, s[28:31], s63 offen offset:0 lds
    v_mfma_f32_16x16x32_bf16 v[40:43], a[92:95], v[128:131], v[40:43]
    v_mfma_f32_16x16x32_bf16 v[60:63], a[92:95], v[132:135], v[60:63]
    v_mfma_f32_16x16x32_bf16 v[44:47], a[96:99], v[128:131], v[44:47]
    v_mfma_f32_16x16x32_bf16 v[64:67], a[96:99], v[132:135], v[64:67]
    buffer_load_dwordx4 v8, s[28:31], s63 offen offset:1024 lds
    v_mfma_f32_16x16x32_bf16 v[48:51], a[100:103], v[128:131], v[48:51]
    v_mfma_f32_16x16x32_bf16 v[68:71], a[100:103], v[132:135], v[68:71]
    s_waitcnt vmcnt(12)
    v_mfma_f32_16x16x32_bf16 v[32:35], a[104:107], v[136:139], v[32:35]
    v_mfma_f32_16x16x32_bf16 v[52:55], a[104:107], v[140:143], v[52:55]
    buffer_load_dwordx4 v8, s[28:31], s63 offen offset:2048 lds
    v_mfma_f32_16x16x32_bf16 v[36:39], a[108:111], v[136:139], v[36:39]
    v_mfma_f32_16x16x32_bf16 v[56:59], a[108:111], v[140:143], v[56:59]
    buffer_load_dwordx4 v8, s[28:31], s63 offen offset:3072 lds
    v_mfma_f32_16x16x32_bf16 v[40:43], a[112:115], v[136:139], v[40:43]
    v_mfma_f32_16x16x32_bf16 v[60:63], a[112:115], v[140:143], v[60:63]
    v_mfma_f32_16x16x32_bf16 v[44:47], a[116:119], v[136:139], v[44:47]
    v_mfma_f32_16x16x32_bf16 v[64:67], a[116:119], v[140:143], v[64:67]
    s_add_u32 s62, s62, 4096
    s_add_u32 s63, s63, 4096
    s_mov_b32 m0, s62
    buffer_load_dwordx4 v8, s[28:31], s63 offen offset:0 lds
    v_mfma_f32_16x16x32_bf16 v[48:51], a[120:123], v[136:139], v[48:51]
    v_mfma_f32_16x16x32_bf16 v[68:71], a[120:123], v[140:143], v[68:71]
    s_waitcnt vmcnt(13)
    v_mfma_f32_16x16x32_bf16 v[32:35], a[124:127], v[144:147], v[32:35]
    v_mfma_f32_16x16x32_bf16 v[52:55], a[124:127], v[148:151], v[52:55]
    buffer_load_dwordx4 v8, s[28:31], s63 offen offset:1024 lds
    v_mfma_f32_16x16x32_bf16 v[36:39], a[128:131], v[144:147], v[36:39]
    v_mfma_f32_16x16x32_bf16 v[56:59], a[128:131], v[148:151], v[56:59]
    buffer_load_dwordx4 v8, s[28:31], s63 offen offset:2048 lds
    v_mfma_f32_16x16x32_bf16 v[40:43], a[132:135], v[144:147], v[40:43]
    v_mfma_f32_16x16x32_bf16 v[60:63], a[132:135], v[148:151], v[60:63]
    v_mfma_f32_16x16x32_bf16 v[44:47], a[136:139], v[144:147], v[44:47]
    v_mfma_f32_16x16x32_bf16 v[64:67], a[136:139], v[148:151], v[64:67]
    buffer_load_dwordx4 v8, s[28:31], s63 offen offset:3072 lds
    v_mfma_f32_16x16x32_bf16 v[48:51], a[140:143], v[144:147], v[48:51]
    v_mfma_f32_16x16x32_bf16 v[68:71], a[140:143], v[148:151], v[68:71]
    s_nop 4
    ds_write_b128 v246, v[52:55] offset:0
    ds_write_b128 v246, v[56:59] offset:1024
    ds_write_b128 v246, v[60:63] offset:2048
    ds_write_b128 v246, v[64:67] offset:3072
    ds_write_b128 v246, v[68:71] offset:4096
    v_lshlrev_b32 v112, 16, v16
    v_and_b32 v113, 0xffff0000, v16
    v_lshlrev_b32 v114, 16, v17
    v_and_b32 v115, 0xffff0000, v17
    v_lshlrev_b32 v116, 16, v18
    v_and_b32 v117, 0xffff0000, v18
    v_lshlrev_b32 v118, 16, v19
    v_and_b32 v119, 0xffff0000, v19
    v_lshlrev_b32 v120, 16, v20
    v_and_b32 v121, 0xffff0000, v20
    v_lshlrev_b32 v122, 16, v21
    v_and_b32 v123, 0xffff0000, v21
    v_lshlrev_b32 v124, 16, v22
    v_and_b32 v125, 0xffff0000, v22
    v_lshlrev_b32 v126, 16, v23
    v_and_b32 v127, 0xffff0000, v23
    v_lshlrev_b32 v128, 16, v24
    v_and_b32 v129, 0xffff0000, v24
    v_lshlrev_b32 v130, 16, v25
    v_and_b32 v131, 0xffff0000, v25
    v_pk_add_f32 v[32:33], v[32:33], v[112:113]
    v_pk_add_f32 v[34:35], v[34:35], v[114:115]
    v_pk_add_f32 v[36:37], v[36:37], v[116:117]
    v_pk_add_f32 v[38:39], v[38:39], v[118:119]
    v_pk_add_f32 v[40:41], v[40:41], v[120:121]
    v_pk_add_f32 v[42:43], v[42:43], v[122:123]
    v_pk_add_f32 v[44:45], v[44:45], v[124:125]
    v_pk_add_f32 v[46:47], v[46:47], v[126:127]
    v_pk_add_f32 v[48:49], v[48:49], v[128:129]
    v_pk_add_f32 v[50:51], v[50:51], v[130:131]
    v_mov_b32 v28, 0
    v_mov_b32 v29, 0
    s_add_u32 s62, s62, 4096
    s_add_u32 s63, s63, 4096
    s_mov_b32 m0, s62
    buffer_load_dwordx4 v8, s[28:31], s63 offen offset:0 lds
    buffer_load_dwordx4 v8, s[28:31], s63 offen offset:1024 lds
    buffer_load_dwordx4 v8, s[28:31], s63 offen offset:2048 lds
    buffer_load_dwordx4 v8, s[28:31], s63 offen offset:3072 lds
    s_mul_i32 s25, s20, 5
    s_lshl_b32 s25, s25, 10
    s_add_u32 s62, s25, 122880
    s_add_u32 s63, s25, s54
    s_add_u32 s63, s63, 122880
    s_mov_b32 m0, s62
    buffer_load_dwordx4 v8, s[28:31], s63 offen offset:0 lds
    buffer_load_dwordx4 v8, s[28:31], s63 offen offset:1024 lds
    buffer_load_dwordx4 v8, s[28:31], s63 offen offset:2048 lds
    buffer_load_dwordx4 v8, s[28:31], s63 offen offset:3072 lds
    s_add_u32 s62, s62, 4096
    s_add_u32 s63, s63, 4096
    s_mov_b32 m0, s62
    buffer_load_dwordx4 v8, s[28:31], s63 offen offset:0 lds
    s_waitcnt lgkmcnt(0)
    s_barrier
    ds_read_b128 v[88:91], v247 offset:0
    ds_read_b128 v[92:95], v247 offset:1024
    ds_read_b128 v[96:99], v247 offset:2048
    ds_read_b128 v[100:103], v247 offset:3072
    ds_read_b128 v[104:107], v247 offset:4096
    s_waitcnt lgkmcnt(4)
    v_pk_add_f32 v[32:33], v[32:33], v[88:89]
    v_pk_add_f32 v[34:35], v[34:35], v[90:91]
    v_cvt_pk_bf16_f32 v180, v32, v33
    v_cvt_pk_bf16_f32 v181, v34, v35
    s_waitcnt lgkmcnt(3)
    v_pk_add_f32 v[36:37], v[36:37], v[92:93]
    v_pk_add_f32 v[38:39], v[38:39], v[94:95]
    v_cvt_pk_bf16_f32 v182, v36, v37
    v_cvt_pk_bf16_f32 v183, v38, v39
    s_waitcnt lgkmcnt(2)
    v_pk_add_f32 v[40:41], v[40:41], v[96:97]
    v_pk_add_f32 v[42:43], v[42:43], v[98:99]
    v_cvt_pk_bf16_f32 v184, v40, v41
    v_cvt_pk_bf16_f32 v185, v42, v43
    s_waitcnt lgkmcnt(1)
    v_pk_add_f32 v[44:45], v[44:45], v[100:101]
    v_pk_add_f32 v[46:47], v[46:47], v[102:103]
    v_cvt_pk_bf16_f32 v186, v44, v45
    v_cvt_pk_bf16_f32 v187, v46, v47
    s_waitcnt lgkmcnt(0)
    v_pk_add_f32 v[48:49], v[48:49], v[104:105]
    v_pk_add_f32 v[50:51], v[50:51], v[106:107]
    v_cvt_pk_bf16_f32 v188, v48, v49
    v_cvt_pk_bf16_f32 v189, v50, v51
    v_dot2_f32_bf16 v28, v180, v224, v28
    v_dot2_f32_bf16 v29, v180, v180, v29
    v_dot2_f32_bf16 v28, v181, v224, v28
    v_dot2_f32_bf16 v29, v181, v181, v29
    v_dot2_f32_bf16 v28, v182, v224, v28
    v_dot2_f32_bf16 v29, v182, v182, v29
    v_dot2_f32_bf16 v28, v183, v224, v28
    v_dot2_f32_bf16 v29, v183, v183, v29
    v_dot2_f32_bf16 v28, v184, v224, v28
    v_dot2_f32_bf16 v29, v184, v184, v29
    v_dot2_f32_bf16 v28, v185, v224, v28
    v_dot2_f32_bf16 v29, v185, v185, v29
    v_dot2_f32_bf16 v28, v186, v224, v28
    v_dot2_f32_bf16 v29, v186, v186, v29
    v_dot2_f32_bf16 v28, v187, v224, v28
    v_dot2_f32_bf16 v29, v187, v187, v29
    v_dot2_f32_bf16 v28, v188, v224, v28
    v_dot2_f32_bf16 v29, v188, v188, v29
    v_dot2_f32_bf16 v28, v189, v224, v28
    v_dot2_f32_bf16 v29, v189, v189, v29
    s_nop 1
    v_permlane16_swap_b32 v180, v182
    v_permlane16_swap_b32 v181, v183
    v_permlane16_swap_b32 v184, v186
    v_permlane16_swap_b32 v185, v187
    buffer_store_dwordx4 v[180:183], v243, s[28:31], s38 offen sc1
    buffer_store_dwordx4 v[184:187], v243, s[28:31], s38 offen offset:1024 sc1
    buffer_store_dwordx2 v[188:189], v244, s[28:31], s39 offen sc1
    v_mov_b32 v160, v28
    v_mov_b32 v161, v29
    s_nop 1
    v_permlane32_swap_b32 v160, v28
    v_permlane32_swap_b32 v161, v29
    s_nop 1
    v_add_f32 v28, v28, v160
    v_add_f32 v29, v29, v161
    v_mov_b32 v160, v28
    v_mov_b32 v161, v29
    s_nop 1
    v_permlane16_swap_b32 v160, v28
    v_permlane16_swap_b32 v161, v29
    s_nop 1
    v_add_f32 v28, v28, v160
    v_add_f32 v29, v29, v161
    v_lshlrev_b32 v2, 3, v4
    s_mov_b64 exec, 0xffff
    buffer_store_dwordx2 v[28:29], v2, s[28:31], s19 offen sc1
    s_mov_b64 exec, -1
    s_waitcnt vmcnt(0)
    s_barrier
    s_cmp_lg_u32 s20, 0
    s_cbranch_scc1 chain_kernel_sig4
    v_mov_b32 v2, 1
    v_mov_b32 v7, 0
    s_mov_b64 exec, 1
    buffer_store_dword v2, v7, s[28:31], s49 offen sc1
    s_mov_b64 exec, -1
chain_kernel_sig4:
    v_and_b32 v2, 31, v1
    v_lshlrev_b32 v2, 4, v2
    v_lshrrev_b32 v7, 5, v1
    v_mul_u32_u24 v7, 7168, v7
    v_add_u32 v2, v2, v7
    s_mul_i32 s26, s52, 448
    s_add_u32 s26, s26, 8130560
    s_mov_b32 m0, 162816
    s_nop 0
    buffer_load_dwordx4 v2, s[28:31], s26 offen lds
    s_and_b32 s36, s57, 1
    s_lshl_b32 s43, s58, 6
    s_lshl_b32 s26, s21, 5
    s_add_u32 s43, s43, s26
    s_lshl_b32 s26, s22, 4
    s_add_u32 s43, s43, s26
    s_mul_i32 s40, s57, 5
    s_add_u32 s41, s40, 1
    s_lshr_b32 s41, s41, 1
    s_add_u32 s26, s41, 2
    s_sub_u32 s27, s41, 1
    s_cmp_eq_u32 s36, 1
    s_cselect_b32 s40, s27, s26
    s_lshl_b32 s44, s41, 10
    s_lshl_b32 s45, s40, 10
    s_lshl_b32 s26, s36, 9
    s_add_u32 s45, s45, s26
    s_lshr_b32 s26, s58, 1
    s_lshl_b32 s26, s26, 4
    s_mul_i32 s27, s22, 7
    s_add_u32 s26, s26, s27
    s_lshl_b32 s26, s26, 2
    s_and_b32 s27, s58, 1
    s_lshl_b32 s27, s27, 1
    s_add_u32 s26, s26, s27
    s_add_u32 s26, s26, s21
    s_lshl_b32 s26, s26, 7
    s_add_u32 s48, s26, 29446144
    v_lshlrev_b32 v234, 9, v1
    s_lshl_b32 s26, s58, 2
    s_lshl_b32 s27, s21, 1
    s_add_u32 s26, s26, s27
    s_add_u32 s27, s26, s22
    s_mul_i32 s27, s27, 54
    s_mul_i32 s39, s22, 27
    s_add_u32 s27, s27, s39
    s_lshl_b32 s27, s27, 10
    s_add_u32 s50, s27, 16027648
    s_add_u32 s27, s26, 1
    s_sub_u32 s27, s27, s22
    s_mul_i32 s27, s27, 54
    s_add_u32 s27, s27, s39
    s_lshl_b32 s27, s27, 10
    s_add_u32 s51, s27, 16027648
    v_add_u32 v9, s43, v4
    v_lshrrev_b32 v11, 4, v9
    v_and_b32 v10, 15, v9
    v_mul_u32_u24 v11, 20480, v11
    v_lshl_add_u32 v11, v10, 4, v11
    v_lshrrev_b32 v2, 1, v3
    v_lshl_add_u32 v11, v2, 8, v11
    v_and_b32 v7, 1, v3
    v_lshl_add_u32 v230, v7, 3, v11
    v_mul_u32_u24 v9, 1280, v9
    v_lshlrev_b32 v7, 5, v7
    v_lshl_add_u32 v7, v2, 4, v7
    v_add_u32 v231, v9, v7
    v_lshl_add_u32 v232, v3, 3, v9
    v_lshlrev_b32 v233, 4, v3
    v_add_u32 v9, s43, v4
    v_lshrrev_b32 v10, 4, v9
    v_mul_u32_u24 v10, 20480, v10
    v_and_b32 v11, 1, v9
    v_lshl_add_u32 v10, v11, 3, v10
    v_lshl_add_u32 v10, v3, 7, v10
    v_bfe_u32 v11, v9, 1, 3
    s_mul_i32 s26, s57, 20
    s_lshl_b32 s27, s36, 2
    s_add_u32 s27, s27, s26
    s_mul_i32 s3, s36, 16
    s_sub_u32 s3, 16, s3
    s_add_u32 s3, s3, s26
    s_add_u32 s4, s27, 0
    v_add_u32 v2, s4, v3
    v_bfe_u32 v2, v2, 1, 3
    v_xor_b32 v2, v2, v11
    v_lshl_add_u32 v2, v2, 4, v10
    s_lshl_b32 s4, s4, 7
    v_add_u32 v235, s4, v2
    s_add_u32 s4, s27, 4
    v_add_u32 v2, s4, v3
    v_bfe_u32 v2, v2, 1, 3
    v_xor_b32 v2, v2, v11
    v_lshl_add_u32 v2, v2, 4, v10
    s_lshl_b32 s4, s4, 7
    v_add_u32 v236, s4, v2
    s_add_u32 s4, s27, 8
    v_add_u32 v2, s4, v3
    v_bfe_u32 v2, v2, 1, 3
    v_xor_b32 v2, v2, v11
    v_lshl_add_u32 v2, v2, 4, v10
    s_lshl_b32 s4, s4, 7
    v_add_u32 v237, s4, v2
    s_add_u32 s4, s27, 12
    v_add_u32 v2, s4, v3
    v_bfe_u32 v2, v2, 1, 3
    v_xor_b32 v2, v2, v11
    v_lshl_add_u32 v2, v2, 4, v10
    s_lshl_b32 s4, s4, 7
    v_add_u32 v238, s4, v2
    s_mov_b32 s4, s3
    v_add_u32 v2, s4, v3
    v_bfe_u32 v2, v2, 1, 3
    v_xor_b32 v2, v2, v11
    v_lshl_add_u32 v2, v2, 4, v10
    s_lshl_b32 s4, s4, 7
    v_add_u32 v239, s4, v2
    s_mul_i32 s37, s57, 320
    s_add_u32 s37, s37, 8126976
    s_mul_i32 s26, s36, 256
    s_sub_u32 s26, 256, s26
    s_add_u32 s38, s37, s26
    s_lshl_b32 s26, s36, 6
    s_add_u32 s37, s37, s26
    s_mul_i32 s26, s57, 160
    s_lshl_b32 s27, s36, 5
    s_add_u32 s46, s26, s27
    s_mul_i32 s27, s36, 128
    s_sub_u32 s27, 128, s27
    s_add_u32 s49, s26, s27
    s_waitcnt vmcnt(0)
    s_lshl_b32 s26, s42, 6
    v_lshlrev_b32 v2, 4, v3
    v_add_u32 v7, 162816, v2
    v_add_u32 v2, s26, v7
    s_mul_i32 s26, s42, 384
    s_sub_u32 s26, 384, s26
    v_add_u32 v7, s26, v7
    ds_read_b128 v[88:91], v2 offset:0
    ds_read_b128 v[116:119], v2 offset:512
    ds_read_b128 v[92:95], v2 offset:64
    ds_read_b128 v[120:123], v2 offset:576
    ds_read_b128 v[96:99], v2 offset:128
    ds_read_b128 v[124:127], v2 offset:640
    ds_read_b128 v[100:103], v2 offset:192
    ds_read_b128 v[128:131], v2 offset:704
    ds_read_b128 v[104:107], v2 offset:256
    ds_read_b128 v[132:135], v2 offset:768
    ds_read_b128 v[108:111], v2 offset:320
    ds_read_b128 v[136:139], v2 offset:832
    ds_read_b128 v[112:115], v7
    ds_read_b128 v[140:143], v7 offset:512
    s_waitcnt lgkmcnt(0)
    v_pk_add_f32 v[88:89], v[88:89], v[116:117]
    v_pk_add_f32 v[90:91], v[90:91], v[118:119]
    v_pk_add_f32 v[92:93], v[92:93], v[120:121]
    v_pk_add_f32 v[94:95], v[94:95], v[122:123]
    v_pk_add_f32 v[96:97], v[96:97], v[124:125]
    v_pk_add_f32 v[98:99], v[98:99], v[126:127]
    v_pk_add_f32 v[100:101], v[100:101], v[128:129]
    v_pk_add_f32 v[102:103], v[102:103], v[130:131]
    v_pk_add_f32 v[104:105], v[104:105], v[132:133]
    v_pk_add_f32 v[106:107], v[106:107], v[134:135]
    v_pk_add_f32 v[108:109], v[108:109], v[136:137]
    v_pk_add_f32 v[110:111], v[110:111], v[138:139]
    v_pk_add_f32 v[112:113], v[112:113], v[140:141]
    v_pk_add_f32 v[114:115], v[114:115], v[142:143]
    v_mov_b32 v12, v8
    v_add_u32 v13, 0x10000, v8
    v_add_u32 v14, 0x20000, v8
    ds_read_b128 a[160:163], v12 offset:0
    ds_read_b128 a[164:167], v12 offset:1024
    ds_read_b128 a[168:171], v12 offset:2048
    ds_read_b128 a[172:175], v12 offset:3072
    ds_read_b128 a[176:179], v13 offset:57344
    ds_read_b128 a[180:183], v12 offset:4096
    ds_read_b128 a[184:187], v12 offset:5120
    ds_read_b128 a[188:191], v12 offset:6144
    ds_read_b128 a[192:195], v12 offset:7168
    ds_read_b128 a[196:199], v13 offset:58368
    ds_read_b128 a[200:203], v12 offset:8192
    v_lshlrev_b32 v7, 7, v1
    s_mov_b32 s47, 0
    s_mov_b64 exec, 15
chain_kernel_poll5:
    buffer_load_dword v2, v7, s[28:31], s8 offen sc1
    s_add_u32 s47, s47, 1
    s_waitcnt vmcnt(0)
    v_cmp_ne_u32 vcc, 1, v2
    s_cmp_ge_u32 s47, 20000
    s_cbranch_scc1 chain_kernel_polld6
    s_cbranch_vccnz chain_kernel_poll5
chain_kernel_polld6:
    s_mov_b64 exec, -1
    buffer_load_dwordx4 a[0:3], v8, s[28:31], s6 offen offset:0 sc1
    buffer_load_dwordx4 a[4:7], v8, s[28:31], s7 offen offset:0 sc1
    buffer_load_dwordx4 a[8:11], v8, s[28:31], s6 offen offset:1024 sc1
    buffer_load_dwordx4 a[12:15], v8, s[28:31], s7 offen offset:1024 sc1
    buffer_load_dwordx4 a[16:19], v8, s[28:31], s6 offen offset:2048 sc1
    buffer_load_dwordx4 a[20:23], v8, s[28:31], s7 offen offset:2048 sc1
    buffer_load_dwordx4 a[24:27], v8, s[28:31], s6 offen offset:3072 sc1
    buffer_load_dwordx4 a[28:31], v8, s[28:31], s7 offen offset:3072 sc1
    s_add_u32 s6, s6, 4096
    s_add_u32 s7, s7, 4096
    buffer_load_dwordx4 a[32:35], v8, s[28:31], s6 offen offset:0 sc1
    buffer_load_dwordx4 a[36:39], v8, s[28:31], s7 offen offset:0 sc1
    s_waitcnt vmcnt(8) lgkmcnt(6)
    v_mfma_f32_16x16x32_bf16 v[32:35], a[160:163], a[0:3], 0
    v_mfma_f32_16x16x32_bf16 v[60:63], a[160:163], a[4:7], 0
    ds_read_b128 a[204:207], v12 offset:9216
    buffer_load_dwordx4 a[40:43], v8, s[28:31], s6 offen offset:1024 sc1
    v_mfma_f32_16x16x32_bf16 v[36:39], a[164:167], a[0:3], 0
    v_mfma_f32_16x16x32_bf16 v[64:67], a[164:167], a[4:7], 0
    ds_read_b128 a[160:163], v12 offset:10240
    v_mfma_f32_16x16x32_bf16 v[40:43], a[168:171], a[0:3], 0
    v_mfma_f32_16x16x32_bf16 v[68:71], a[168:171], a[4:7], 0
    ds_read_b128 a[164:167], v12 offset:11264
    buffer_load_dwordx4 a[44:47], v8, s[28:31], s7 offen offset:1024 sc1
    v_mfma_f32_16x16x32_bf16 v[44:47], a[172:175], a[0:3], 0
    v_mfma_f32_16x16x32_bf16 v[72:75], a[172:175], a[4:7], 0
    ds_read_b128 a[168:171], v13 offset:59392
    v_mfma_f32_16x16x32_bf16 v[56:59], a[176:179], a[0:3], 0
    v_mfma_f32_16x16x32_bf16 v[84:87], a[176:179], a[4:7], 0
    ds_read_b128 a[172:175], v12 offset:12288
    s_waitcnt vmcnt(8) lgkmcnt(6)
    v_mfma_f32_16x16x32_bf16 v[32:35], a[180:183], a[8:11], v[32:35]
    v_mfma_f32_16x16x32_bf16 v[60:63], a[180:183], a[12:15], v[60:63]
    ds_read_b128 a[176:179], v12 offset:13312
    buffer_load_dwordx4 a[48:51], v8, s[28:31], s6 offen offset:2048 sc1
    v_mfma_f32_16x16x32_bf16 v[36:39], a[184:187], a[8:11], v[36:39]
    v_mfma_f32_16x16x32_bf16 v[64:67], a[184:187], a[12:15], v[64:67]
    ds_read_b128 a[180:183], v12 offset:14336
    v_mfma_f32_16x16x32_bf16 v[40:43], a[188:191], a[8:11], v[40:43]
    v_mfma_f32_16x16x32_bf16 v[68:71], a[188:191], a[12:15], v[68:71]
    ds_read_b128 a[184:187], v12 offset:15360
    buffer_load_dwordx4 a[52:55], v8, s[28:31], s7 offen offset:2048 sc1
    v_mfma_f32_16x16x32_bf16 v[44:47], a[192:195], a[8:11], v[44:47]
    v_mfma_f32_16x16x32_bf16 v[72:75], a[192:195], a[12:15], v[72:75]
    ds_read_b128 a[188:191], v13 offset:60416
    v_mfma_f32_16x16x32_bf16 v[56:59], a[196:199], a[8:11], v[56:59]
    v_mfma_f32_16x16x32_bf16 v[84:87], a[196:199], a[12:15], v[84:87]
    ds_read_b128 a[192:195], v12 offset:16384
    s_waitcnt vmcnt(8) lgkmcnt(6)
    v_mfma_f32_16x16x32_bf16 v[32:35], a[200:203], a[16:19], v[32:35]
    v_mfma_f32_16x16x32_bf16 v[60:63], a[200:203], a[20:23], v[60:63]
    ds_read_b128 a[196:199], v12 offset:17408
    buffer_load_dwordx4 a[56:59], v8, s[28:31], s6 offen offset:3072 sc1
    v_mfma_f32_16x16x32_bf16 v[36:39], a[204:207], a[16:19], v[36:39]
    v_mfma_f32_16x16x32_bf16 v[64:67], a[204:207], a[20:23], v[64:67]
    ds_read_b128 a[200:203], v12 offset:18432
    v_mfma_f32_16x16x32_bf16 v[40:43], a[160:163], a[16:19], v[40:43]
    v_mfma_f32_16x16x32_bf16 v[68:71], a[160:163], a[20:23], v[68:71]
    ds_read_b128 a[204:207], v12 offset:19456
    buffer_load_dwordx4 a[60:63], v8, s[28:31], s7 offen offset:3072 sc1
    v_mfma_f32_16x16x32_bf16 v[44:47], a[164:167], a[16:19], v[44:47]
    v_mfma_f32_16x16x32_bf16 v[72:75], a[164:167], a[20:23], v[72:75]
    ds_read_b128 a[160:163], v13 offset:61440
    v_mfma_f32_16x16x32_bf16 v[56:59], a[168:171], a[16:19], v[56:59]
    v_mfma_f32_16x16x32_bf16 v[84:87], a[168:171], a[20:23], v[84:87]
    ds_read_b128 a[164:167], v12 offset:20480
    s_waitcnt vmcnt(8) lgkmcnt(6)
    v_mfma_f32_16x16x32_bf16 v[32:35], a[172:175], a[24:27], v[32:35]
    v_mfma_f32_16x16x32_bf16 v[60:63], a[172:175], a[28:31], v[60:63]
    ds_read_b128 a[168:171], v12 offset:21504
    s_add_u32 s6, s6, 4096
    s_add_u32 s7, s7, 4096
    buffer_load_dwordx4 a[64:67], v8, s[28:31], s6 offen offset:0 sc1
    v_mfma_f32_16x16x32_bf16 v[36:39], a[176:179], a[24:27], v[36:39]
    v_mfma_f32_16x16x32_bf16 v[64:67], a[176:179], a[28:31], v[64:67]
    ds_read_b128 a[172:175], v12 offset:22528
    v_mfma_f32_16x16x32_bf16 v[40:43], a[180:183], a[24:27], v[40:43]
    v_mfma_f32_16x16x32_bf16 v[68:71], a[180:183], a[28:31], v[68:71]
    ds_read_b128 a[176:179], v12 offset:23552
    buffer_load_dwordx4 a[68:71], v8, s[28:31], s7 offen offset:0 sc1
    v_mfma_f32_16x16x32_bf16 v[44:47], a[184:187], a[24:27], v[44:47]
    v_mfma_f32_16x16x32_bf16 v[72:75], a[184:187], a[28:31], v[72:75]
    ds_read_b128 a[180:183], v13 offset:62464
    v_mfma_f32_16x16x32_bf16 v[56:59], a[188:191], a[24:27], v[56:59]
    v_mfma_f32_16x16x32_bf16 v[84:87], a[188:191], a[28:31], v[84:87]
    ds_read_b128 a[184:187], v12 offset:24576
    s_waitcnt vmcnt(8) lgkmcnt(6)
    v_mfma_f32_16x16x32_bf16 v[32:35], a[192:195], a[32:35], v[32:35]
    v_mfma_f32_16x16x32_bf16 v[60:63], a[192:195], a[36:39], v[60:63]
    ds_read_b128 a[188:191], v12 offset:25600
    buffer_load_dwordx4 a[72:75], v8, s[28:31], s6 offen offset:1024 sc1
    v_mfma_f32_16x16x32_bf16 v[36:39], a[196:199], a[32:35], v[36:39]
    v_mfma_f32_16x16x32_bf16 v[64:67], a[196:199], a[36:39], v[64:67]
    ds_read_b128 a[192:195], v12 offset:26624
    v_mfma_f32_16x16x32_bf16 v[40:43], a[200:203], a[32:35], v[40:43]
    v_mfma_f32_16x16x32_bf16 v[68:71], a[200:203], a[36:39], v[68:71]
    ds_read_b128 a[196:199], v12 offset:27648
    buffer_load_dwordx4 a[76:79], v8, s[28:31], s7 offen offset:1024 sc1
    v_mfma_f32_16x16x32_bf16 v[44:47], a[204:207], a[32:35], v[44:47]
    v_mfma_f32_16x16x32_bf16 v[72:75], a[204:207], a[36:39], v[72:75]
    ds_read_b128 a[200:203], v13 offset:63488
    v_mfma_f32_16x16x32_bf16 v[56:59], a[160:163], a[32:35], v[56:59]
    v_mfma_f32_16x16x32_bf16 v[84:87], a[160:163], a[36:39], v[84:87]
    ds_read_b128 a[204:207], v12 offset:28672
    s_waitcnt vmcnt(8) lgkmcnt(6)
    v_mfma_f32_16x16x32_bf16 v[32:35], a[164:167], a[40:43], v[32:35]
    v_mfma_f32_16x16x32_bf16 v[60:63], a[164:167], a[44:47], v[60:63]
    ds_read_b128 a[160:163], v12 offset:29696
    buffer_load_dwordx4 a[80:83], v8, s[28:31], s6 offen offset:2048 sc1
    v_mfma_f32_16x16x32_bf16 v[36:39], a[168:171], a[40:43], v[36:39]
    v_mfma_f32_16x16x32_bf16 v[64:67], a[168:171], a[44:47], v[64:67]
    ds_read_b128 a[164:167], v12 offset:30720
    v_mfma_f32_16x16x32_bf16 v[40:43], a[172:175], a[40:43], v[40:43]
    v_mfma_f32_16x16x32_bf16 v[68:71], a[172:175], a[44:47], v[68:71]
    ds_read_b128 a[168:171], v12 offset:31744
    buffer_load_dwordx4 a[84:87], v8, s[28:31], s7 offen offset:2048 sc1
    v_mfma_f32_16x16x32_bf16 v[44:47], a[176:179], a[40:43], v[44:47]
    v_mfma_f32_16x16x32_bf16 v[72:75], a[176:179], a[44:47], v[72:75]
    ds_read_b128 a[172:175], v13 offset:64512
    v_mfma_f32_16x16x32_bf16 v[56:59], a[180:183], a[40:43], v[56:59]
    v_mfma_f32_16x16x32_bf16 v[84:87], a[180:183], a[44:47], v[84:87]
    ds_read_b128 a[176:179], v12 offset:32768
    s_waitcnt vmcnt(8) lgkmcnt(6)
    v_mfma_f32_16x16x32_bf16 v[32:35], a[184:187], a[48:51], v[32:35]
    v_mfma_f32_16x16x32_bf16 v[60:63], a[184:187], a[52:55], v[60:63]
    ds_read_b128 a[180:183], v12 offset:33792
    buffer_load_dwordx4 a[88:91], v8, s[28:31], s6 offen offset:3072 sc1
    v_mfma_f32_16x16x32_bf16 v[36:39], a[188:191], a[48:51], v[36:39]
    v_mfma_f32_16x16x32_bf16 v[64:67], a[188:191], a[52:55], v[64:67]
    ds_read_b128 a[184:187], v12 offset:34816
    v_mfma_f32_16x16x32_bf16 v[40:43], a[192:195], a[48:51], v[40:43]
    v_mfma_f32_16x16x32_bf16 v[68:71], a[192:195], a[52:55], v[68:71]
    ds_read_b128 a[188:191], v12 offset:35840
    buffer_load_dwordx4 a[92:95], v8, s[28:31], s7 offen offset:3072 sc1
    v_mfma_f32_16x16x32_bf16 v[44:47], a[196:199], a[48:51], v[44:47]
    v_mfma_f32_16x16x32_bf16 v[72:75], a[196:199], a[52:55], v[72:75]
    ds_read_b128 a[192:195], v14 offset:0
    v_mfma_f32_16x16x32_bf16 v[56:59], a[200:203], a[48:51], v[56:59]
    v_mfma_f32_16x16x32_bf16 v[84:87], a[200:203], a[52:55], v[84:87]
    ds_read_b128 a[196:199], v12 offset:36864
    s_waitcnt vmcnt(8) lgkmcnt(6)
    v_mfma_f32_16x16x32_bf16 v[32:35], a[204:207], a[56:59], v[32:35]
    v_mfma_f32_16x16x32_bf16 v[60:63], a[204:207], a[60:63], v[60:63]
    ds_read_b128 a[200:203], v12 offset:37888
    s_add_u32 s6, s6, 4096
    s_add_u32 s7, s7, 4096
    buffer_load_dwordx4 a[96:99], v8, s[28:31], s6 offen offset:0 sc1
    v_mfma_f32_16x16x32_bf16 v[36:39], a[160:163], a[56:59], v[36:39]
    v_mfma_f32_16x16x32_bf16 v[64:67], a[160:163], a[60:63], v[64:67]
    ds_read_b128 a[204:207], v12 offset:38912
    v_mfma_f32_16x16x32_bf16 v[40:43], a[164:167], a[56:59], v[40:43]
    v_mfma_f32_16x16x32_bf16 v[68:71], a[164:167], a[60:63], v[68:71]
    ds_read_b128 a[160:163], v12 offset:39936
    buffer_load_dwordx4 a[100:103], v8, s[28:31], s7 offen offset:0 sc1
    v_mfma_f32_16x16x32_bf16 v[44:47], a[168:171], a[56:59], v[44:47]
    v_mfma_f32_16x16x32_bf16 v[72:75], a[168:171], a[60:63], v[72:75]
    ds_read_b128 a[164:167], v14 offset:1024
    v_mfma_f32_16x16x32_bf16 v[56:59], a[172:175], a[56:59], v[56:59]
    v_mfma_f32_16x16x32_bf16 v[84:87], a[172:175], a[60:63], v[84:87]
    ds_read_b128 a[168:171], v12 offset:40960
    s_waitcnt vmcnt(8) lgkmcnt(6)
    v_mfma_f32_16x16x32_bf16 v[32:35], a[176:179], a[64:67], v[32:35]
    v_mfma_f32_16x16x32_bf16 v[60:63], a[176:179], a[68:71], v[60:63]
    ds_read_b128 a[172:175], v12 offset:41984
    buffer_load_dwordx4 a[104:107], v8, s[28:31], s6 offen offset:1024 sc1
    v_mfma_f32_16x16x32_bf16 v[36:39], a[180:183], a[64:67], v[36:39]
    v_mfma_f32_16x16x32_bf16 v[64:67], a[180:183], a[68:71], v[64:67]
    ds_read_b128 a[176:179], v12 offset:43008
    v_mfma_f32_16x16x32_bf16 v[40:43], a[184:187], a[64:67], v[40:43]
    v_mfma_f32_16x16x32_bf16 v[68:71], a[184:187], a[68:71], v[68:71]
    ds_read_b128 a[180:183], v12 offset:44032
    buffer_load_dwordx4 a[108:111], v8, s[28:31], s7 offen offset:1024 sc1
    v_mfma_f32_16x16x32_bf16 v[44:47], a[188:191], a[64:67], v[44:47]
    v_mfma_f32_16x16x32_bf16 v[72:75], a[188:191], a[68:71], v[72:75]
    ds_read_b128 a[184:187], v14 offset:2048
    v_mfma_f32_16x16x32_bf16 v[56:59], a[192:195], a[64:67], v[56:59]
    v_mfma_f32_16x16x32_bf16 v[84:87], a[192:195], a[68:71], v[84:87]
    ds_read_b128 a[188:191], v12 offset:45056
    buffer_load_dwordx4 a[112:115], v8, s[28:31], s6 offen offset:2048 sc1
    s_waitcnt vmcnt(9) lgkmcnt(6)
    v_mfma_f32_16x16x32_bf16 v[32:35], a[196:199], a[72:75], v[32:35]
    v_mfma_f32_16x16x32_bf16 v[60:63], a[196:199], a[76:79], v[60:63]
    ds_read_b128 a[192:195], v12 offset:46080
    buffer_load_dwordx4 a[116:119], v8, s[28:31], s7 offen offset:2048 sc1
    v_mfma_f32_16x16x32_bf16 v[36:39], a[200:203], a[72:75], v[36:39]
    v_mfma_f32_16x16x32_bf16 v[64:67], a[200:203], a[76:79], v[64:67]
    ds_read_b128 a[196:199], v12 offset:47104
    v_mfma_f32_16x16x32_bf16 v[40:43], a[204:207], a[72:75], v[40:43]
    v_mfma_f32_16x16x32_bf16 v[68:71], a[204:207], a[76:79], v[68:71]
    ds_read_b128 a[200:203], v12 offset:48128
    buffer_load_dwordx4 a[120:123], v8, s[28:31], s6 offen offset:3072 sc1
    v_mfma_f32_16x16x32_bf16 v[44:47], a[160:163], a[72:75], v[44:47]
    v_mfma_f32_16x16x32_bf16 v[72:75], a[160:163], a[76:79], v[72:75]
    ds_read_b128 a[204:207], v14 offset:3072
    v_mfma_f32_16x16x32_bf16 v[56:59], a[164:167], a[72:75], v[56:59]
    v_mfma_f32_16x16x32_bf16 v[84:87], a[164:167], a[76:79], v[84:87]
    ds_read_b128 a[160:163], v12 offset:49152
    buffer_load_dwordx4 a[124:127], v8, s[28:31], s7 offen offset:3072 sc1
    s_waitcnt vmcnt(10) lgkmcnt(6)
    v_mfma_f32_16x16x32_bf16 v[32:35], a[168:171], a[80:83], v[32:35]
    v_mfma_f32_16x16x32_bf16 v[60:63], a[168:171], a[84:87], v[60:63]
    ds_read_b128 a[164:167], v12 offset:50176
    s_add_u32 s6, s6, 4096
    s_add_u32 s7, s7, 4096
    buffer_load_dwordx4 a[128:131], v8, s[28:31], s6 offen offset:0 sc1
    v_mfma_f32_16x16x32_bf16 v[36:39], a[172:175], a[80:83], v[36:39]
    v_mfma_f32_16x16x32_bf16 v[64:67], a[172:175], a[84:87], v[64:67]
    ds_read_b128 a[168:171], v12 offset:51200
    v_mfma_f32_16x16x32_bf16 v[40:43], a[176:179], a[80:83], v[40:43]
    v_mfma_f32_16x16x32_bf16 v[68:71], a[176:179], a[84:87], v[68:71]
    ds_read_b128 a[172:175], v12 offset:52224
    buffer_load_dwordx4 a[132:135], v8, s[28:31], s7 offen offset:0 sc1
    v_mfma_f32_16x16x32_bf16 v[44:47], a[180:183], a[80:83], v[44:47]
    v_mfma_f32_16x16x32_bf16 v[72:75], a[180:183], a[84:87], v[72:75]
    ds_read_b128 a[176:179], v14 offset:4096
    v_mfma_f32_16x16x32_bf16 v[56:59], a[184:187], a[80:83], v[56:59]
    v_mfma_f32_16x16x32_bf16 v[84:87], a[184:187], a[84:87], v[84:87]
    ds_read_b128 a[180:183], v12 offset:53248
    buffer_load_dwordx4 a[136:139], v8, s[28:31], s6 offen offset:1024 sc1
    s_waitcnt vmcnt(11) lgkmcnt(6)
    v_mfma_f32_16x16x32_bf16 v[32:35], a[188:191], a[88:91], v[32:35]
    v_mfma_f32_16x16x32_bf16 v[60:63], a[188:191], a[92:95], v[60:63]
    ds_read_b128 a[184:187], v12 offset:54272
    buffer_load_dwordx4 a[140:143], v8, s[28:31], s7 offen offset:1024 sc1
    v_mfma_f32_16x16x32_bf16 v[36:39], a[192:195], a[88:91], v[36:39]
    v_mfma_f32_16x16x32_bf16 v[64:67], a[192:195], a[92:95], v[64:67]
    ds_read_b128 a[188:191], v12 offset:55296
    v_mfma_f32_16x16x32_bf16 v[40:43], a[196:199], a[88:91], v[40:43]
    v_mfma_f32_16x16x32_bf16 v[68:71], a[196:199], a[92:95], v[68:71]
    ds_read_b128 a[192:195], v12 offset:56320
    buffer_load_dwordx4 a[144:147], v8, s[28:31], s6 offen offset:2048 sc1
    v_mfma_f32_16x16x32_bf16 v[44:47], a[200:203], a[88:91], v[44:47]
    v_mfma_f32_16x16x32_bf16 v[72:75], a[200:203], a[92:95], v[72:75]
    ds_read_b128 a[196:199], v14 offset:5120
    v_mfma_f32_16x16x32_bf16 v[56:59], a[204:207], a[88:91], v[56:59]
    v_mfma_f32_16x16x32_bf16 v[84:87], a[204:207], a[92:95], v[84:87]
    ds_read_b128 a[200:203], v12 offset:57344
    buffer_load_dwordx4 a[148:151], v8, s[28:31], s7 offen offset:2048 sc1
    s_waitcnt vmcnt(12) lgkmcnt(6)
    v_mfma_f32_16x16x32_bf16 v[32:35], a[160:163], a[96:99], v[32:35]
    v_mfma_f32_16x16x32_bf16 v[60:63], a[160:163], a[100:103], v[60:63]
    ds_read_b128 a[204:207], v12 offset:58368
    buffer_load_dwordx4 a[152:155], v8, s[28:31], s6 offen offset:3072 sc1
    v_mfma_f32_16x16x32_bf16 v[36:39], a[164:167], a[96:99], v[36:39]
    v_mfma_f32_16x16x32_bf16 v[64:67], a[164:167], a[100:103], v[64:67]
    ds_read_b128 a[160:163], v12 offset:59392
    v_mfma_f32_16x16x32_bf16 v[40:43], a[168:171], a[96:99], v[40:43]
    v_mfma_f32_16x16x32_bf16 v[68:71], a[168:171], a[100:103], v[68:71]
    ds_read_b128 a[164:167], v12 offset:60416
    buffer_load_dwordx4 a[156:159], v8, s[28:31], s7 offen offset:3072 sc1
    v_mfma_f32_16x16x32_bf16 v[44:47], a[172:175], a[96:99], v[44:47]
    v_mfma_f32_16x16x32_bf16 v[72:75], a[172:175], a[100:103], v[72:75]
    ds_read_b128 a[168:171], v14 offset:6144
    v_mfma_f32_16x16x32_bf16 v[56:59], a[176:179], a[96:99], v[56:59]
    v_mfma_f32_16x16x32_bf16 v[84:87], a[176:179], a[100:103], v[84:87]
    ds_read_b128 a[172:175], v12 offset:61440
    buffer_load_dwordx2 v[16:17], v228, s[28:31], s9 offen offset:0 sc1
    s_waitcnt vmcnt(13) lgkmcnt(6)
    v_mfma_f32_16x16x32_bf16 v[32:35], a[180:183], a[104:107], v[32:35]
    v_mfma_f32_16x16x32_bf16 v[60:63], a[180:183], a[108:111], v[60:63]
    ds_read_b128 a[176:179], v12 offset:62464
    buffer_load_dwordx2 v[18:19], v228, s[28:31], s9 offen offset:128 sc1
    v_mfma_f32_16x16x32_bf16 v[36:39], a[184:187], a[104:107], v[36:39]
    v_mfma_f32_16x16x32_bf16 v[64:67], a[184:187], a[108:111], v[64:67]
    ds_read_b128 a[180:183], v12 offset:63488
    v_mfma_f32_16x16x32_bf16 v[40:43], a[188:191], a[104:107], v[40:43]
    v_mfma_f32_16x16x32_bf16 v[68:71], a[188:191], a[108:111], v[68:71]
    ds_read_b128 a[184:187], v12 offset:64512
    buffer_load_dwordx2 v[20:21], v228, s[28:31], s9 offen offset:1024 sc1
    v_mfma_f32_16x16x32_bf16 v[44:47], a[192:195], a[104:107], v[44:47]
    v_mfma_f32_16x16x32_bf16 v[72:75], a[192:195], a[108:111], v[72:75]
    ds_read_b128 a[188:191], v14 offset:7168
    v_mfma_f32_16x16x32_bf16 v[56:59], a[196:199], a[104:107], v[56:59]
    v_mfma_f32_16x16x32_bf16 v[84:87], a[196:199], a[108:111], v[84:87]
    ds_read_b128 a[192:195], v13 offset:0
    buffer_load_dwordx2 v[22:23], v228, s[28:31], s9 offen offset:1152 sc1
    s_waitcnt vmcnt(14) lgkmcnt(6)
    v_mfma_f32_16x16x32_bf16 v[32:35], a[200:203], a[112:115], v[32:35]
    v_mfma_f32_16x16x32_bf16 v[60:63], a[200:203], a[116:119], v[60:63]
    ds_read_b128 a[196:199], v13 offset:1024
    s_mov_b32 s26, 5492736
    buffer_load_dwordx2 v[116:117], v235, s[28:31], s26 offen
    v_mfma_f32_16x16x32_bf16 v[36:39], a[204:207], a[112:115], v[36:39]
    v_mfma_f32_16x16x32_bf16 v[64:67], a[204:207], a[116:119], v[64:67]
    ds_read_b128 a[200:203], v13 offset:2048
    v_mfma_f32_16x16x32_bf16 v[40:43], a[160:163], a[112:115], v[40:43]
    v_mfma_f32_16x16x32_bf16 v[68:71], a[160:163], a[116:119], v[68:71]
    ds_read_b128 a[204:207], v13 offset:3072
    s_mov_b32 s26, 5492736
    buffer_load_dwordx2 v[118:119], v236, s[28:31], s26 offen
    v_mfma_f32_16x16x32_bf16 v[44:47], a[164:167], a[112:115], v[44:47]
    v_mfma_f32_16x16x32_bf16 v[72:75], a[164:167], a[116:119], v[72:75]
    ds_read_b128 a[160:163], v14 offset:8192
    v_mfma_f32_16x16x32_bf16 v[56:59], a[168:171], a[112:115], v[56:59]
    v_mfma_f32_16x16x32_bf16 v[84:87], a[168:171], a[116:119], v[84:87]
    ds_read_b128 a[164:167], v13 offset:4096
    s_mov_b32 s26, 5492736
    buffer_load_dwordx2 v[120:121], v237, s[28:31], s26 offen
    s_waitcnt vmcnt(15) lgkmcnt(6)
    v_mfma_f32_16x16x32_bf16 v[32:35], a[172:175], a[120:123], v[32:35]
    v_mfma_f32_16x16x32_bf16 v[60:63], a[172:175], a[124:127], v[60:63]
    ds_read_b128 a[168:171], v13 offset:5120
    s_mov_b32 s26, 5492736
    buffer_load_dwordx2 v[122:123], v238, s[28:31], s26 offen
    v_mfma_f32_16x16x32_bf16 v[36:39], a[176:179], a[120:123], v[36:39]
    v_mfma_f32_16x16x32_bf16 v[64:67], a[176:179], a[124:127], v[64:67]
    ds_read_b128 a[172:175], v13 offset:6144
    v_mfma_f32_16x16x32_bf16 v[40:43], a[180:183], a[120:123], v[40:43]
    v_mfma_f32_16x16x32_bf16 v[68:71], a[180:183], a[124:127], v[68:71]
    ds_read_b128 a[176:179], v13 offset:7168
    s_mov_b32 s26, 5492736
    buffer_load_dwordx2 v[124:125], v239, s[28:31], s26 offen
    v_mfma_f32_16x16x32_bf16 v[44:47], a[184:187], a[120:123], v[44:47]
    v_mfma_f32_16x16x32_bf16 v[72:75], a[184:187], a[124:127], v[72:75]
    ds_read_b128 a[180:183], v14 offset:9216
    v_mfma_f32_16x16x32_bf16 v[56:59], a[188:191], a[120:123], v[56:59]
    v_mfma_f32_16x16x32_bf16 v[84:87], a[188:191], a[124:127], v[84:87]
    ds_read_b128 a[184:187], v13 offset:8192
    buffer_load_dwordx4 v[204:207], v233, s[28:31], s37 offen offset:0
    s_waitcnt vmcnt(16) lgkmcnt(6)
    v_mfma_f32_16x16x32_bf16 v[32:35], a[192:195], a[128:131], v[32:35]
    v_mfma_f32_16x16x32_bf16 v[60:63], a[192:195], a[132:135], v[60:63]
    ds_read_b128 a[188:191], v13 offset:9216
    buffer_load_dwordx4 v[208:211], v233, s[28:31], s37 offen offset:64
    v_mfma_f32_16x16x32_bf16 v[36:39], a[196:199], a[128:131], v[36:39]
    v_mfma_f32_16x16x32_bf16 v[64:67], a[196:199], a[132:135], v[64:67]
    ds_read_b128 a[192:195], v13 offset:10240
    v_mfma_f32_16x16x32_bf16 v[40:43], a[200:203], a[128:131], v[40:43]
    v_mfma_f32_16x16x32_bf16 v[68:71], a[200:203], a[132:135], v[68:71]
    ds_read_b128 a[196:199], v13 offset:11264
    buffer_load_dwordx4 v[212:215], v233, s[28:31], s37 offen offset:128
    v_mfma_f32_16x16x32_bf16 v[44:47], a[204:207], a[128:131], v[44:47]
    v_mfma_f32_16x16x32_bf16 v[72:75], a[204:207], a[132:135], v[72:75]
    ds_read_b128 a[200:203], v14 offset:10240
    v_mfma_f32_16x16x32_bf16 v[56:59], a[160:163], a[128:131], v[56:59]
    v_mfma_f32_16x16x32_bf16 v[84:87], a[160:163], a[132:135], v[84:87]
    ds_read_b128 a[204:207], v13 offset:12288
    buffer_load_dwordx4 v[216:219], v233, s[28:31], s37 offen offset:192
    s_waitcnt vmcnt(17) lgkmcnt(6)
    v_mfma_f32_16x16x32_bf16 v[32:35], a[164:167], a[136:139], v[32:35]
    v_mfma_f32_16x16x32_bf16 v[60:63], a[164:167], a[140:143], v[60:63]
    ds_read_b128 a[160:163], v13 offset:13312
    buffer_load_dwordx4 v[220:223], v233, s[28:31], s38 offen
    v_mfma_f32_16x16x32_bf16 v[36:39], a[168:171], a[136:139], v[36:39]
    v_mfma_f32_16x16x32_bf16 v[64:67], a[168:171], a[140:143], v[64:67]
    ds_read_b128 a[164:167], v13 offset:14336
    s_mul_i32 s25, s20, 3
    s_min_u32 s25, s25, 7
    s_lshl_b32 s25, s25, 10
    s_add_u32 s62, s25, 143360
    s_add_u32 s63, s25, s59
    s_add_u32 s63, s63, 0
    s_mov_b32 m0, s62
    buffer_load_dwordx4 v8, s[28:31], s63 offen offset:0 lds
    v_mfma_f32_16x16x32_bf16 v[40:43], a[172:175], a[136:139], v[40:43]
    v_mfma_f32_16x16x32_bf16 v[68:71], a[172:175], a[140:143], v[68:71]
    ds_read_b128 a[168:171], v13 offset:15360
    v_mfma_f32_16x16x32_bf16 v[44:47], a[176:179], a[136:139], v[44:47]
    v_mfma_f32_16x16x32_bf16 v[72:75], a[176:179], a[140:143], v[72:75]
    ds_read_b128 a[172:175], v14 offset:11264
    buffer_load_dwordx4 v8, s[28:31], s63 offen offset:1024 lds
    v_mfma_f32_16x16x32_bf16 v[56:59], a[180:183], a[136:139], v[56:59]
    v_mfma_f32_16x16x32_bf16 v[84:87], a[180:183], a[140:143], v[84:87]
    ds_read_b128 a[176:179], v13 offset:16384
    s_waitcnt vmcnt(18) lgkmcnt(6)
    v_mfma_f32_16x16x32_bf16 v[32:35], a[184:187], a[144:147], v[32:35]
    v_mfma_f32_16x16x32_bf16 v[60:63], a[184:187], a[148:151], v[60:63]
    ds_read_b128 a[180:183], v13 offset:17408
    v_mfma_f32_16x16x32_bf16 v[36:39], a[188:191], a[144:147], v[36:39]
    v_mfma_f32_16x16x32_bf16 v[64:67], a[188:191], a[148:151], v[64:67]
    ds_read_b128 a[184:187], v13 offset:18432
    buffer_load_dwordx4 v8, s[28:31], s63 offen offset:2048 lds
    v_mfma_f32_16x16x32_bf16 v[40:43], a[192:195], a[144:147], v[40:43]
    v_mfma_f32_16x16x32_bf16 v[68:71], a[192:195], a[148:151], v[68:71]
    ds_read_b128 a[188:191], v13 offset:19456
    v_mfma_f32_16x16x32_bf16 v[44:47], a[196:199], a[144:147], v[44:47]
    v_mfma_f32_16x16x32_bf16 v[72:75], a[196:199], a[148:151], v[72:75]
    ds_read_b128 a[192:195], v13 offset:20480
    v_mfma_f32_16x16x32_bf16 v[56:59], a[200:203], a[144:147], v[56:59]
    v_mfma_f32_16x16x32_bf16 v[84:87], a[200:203], a[148:151], v[84:87]
    ds_read_b128 a[196:199], v13 offset:21504
    s_waitcnt vmcnt(17) lgkmcnt(6)
    v_mfma_f32_16x16x32_bf16 v[32:35], a[204:207], a[152:155], v[32:35]
    v_mfma_f32_16x16x32_bf16 v[60:63], a[204:207], a[156:159], v[60:63]
    ds_read_b128 a[200:203], v13 offset:22528
    v_mfma_f32_16x16x32_bf16 v[36:39], a[160:163], a[152:155], v[36:39]
    v_mfma_f32_16x16x32_bf16 v[64:67], a[160:163], a[156:159], v[64:67]
    ds_read_b128 a[204:207], v13 offset:23552
    v_mfma_f32_16x16x32_bf16 v[40:43], a[164:167], a[152:155], v[40:43]
    v_mfma_f32_16x16x32_bf16 v[68:71], a[164:167], a[156:159], v[68:71]
    ds_read_b128 a[160:163], v13 offset:24576
    v_mfma_f32_16x16x32_bf16 v[44:47], a[168:171], a[152:155], v[44:47]
    v_mfma_f32_16x16x32_bf16 v[72:75], a[168:171], a[156:159], v[72:75]
    ds_read_b128 a[164:167], v13 offset:25600
    v_mfma_f32_16x16x32_bf16 v[56:59], a[172:175], a[152:155], v[56:59]
    v_mfma_f32_16x16x32_bf16 v[84:87], a[172:175], a[156:159], v[84:87]
    ds_read_b128 a[168:171], v13 offset:26624
    s_waitcnt lgkmcnt(7)
    v_mfma_f32_16x16x32_bf16 v[48:51], a[176:179], a[0:3], 0
    v_mfma_f32_16x16x32_bf16 v[76:79], a[176:179], a[4:7], 0
    ds_read_b128 a[172:175], v13 offset:27648
    v_mfma_f32_16x16x32_bf16 v[52:55], a[180:183], a[0:3], 0
    v_mfma_f32_16x16x32_bf16 v[80:83], a[180:183], a[4:7], 0
    ds_read_b128 a[176:179], v13 offset:28672
    v_mfma_f32_16x16x32_bf16 v[48:51], a[184:187], a[8:11], v[48:51]
    v_mfma_f32_16x16x32_bf16 v[76:79], a[184:187], a[12:15], v[76:79]
    ds_read_b128 a[180:183], v13 offset:29696
    v_mfma_f32_16x16x32_bf16 v[52:55], a[188:191], a[8:11], v[52:55]
    v_mfma_f32_16x16x32_bf16 v[80:83], a[188:191], a[12:15], v[80:83]
    ds_read_b128 a[184:187], v13 offset:30720
    s_barrier
    s_waitcnt lgkmcnt(7)
    v_mfma_f32_16x16x32_bf16 v[48:51], a[192:195], a[16:19], v[48:51]
    v_mfma_f32_16x16x32_bf16 v[76:79], a[192:195], a[20:23], v[76:79]
    ds_read_b128 a[188:191], v13 offset:31744
    s_mul_i32 s25, s20, 20
    s_lshl_b32 s25, s25, 10
    s_add_u32 s62, s25, 0
    s_add_u32 s63, s25, s59
    s_add_u32 s63, s63, 10240
    s_mov_b32 m0, s62
    buffer_load_dwordx4 v8, s[28:31], s63 offen offset:0 lds
    v_mfma_f32_16x16x32_bf16 v[52:55], a[196:199], a[16:19], v[52:55]
    v_mfma_f32_16x16x32_bf16 v[80:83], a[196:199], a[20:23], v[80:83]
    ds_read_b128 a[192:195], v13 offset:32768
    buffer_load_dwordx4 v8, s[28:31], s63 offen offset:1024 lds
    v_mfma_f32_16x16x32_bf16 v[48:51], a[200:203], a[24:27], v[48:51]
    v_mfma_f32_16x16x32_bf16 v[76:79], a[200:203], a[28:31], v[76:79]
    ds_read_b128 a[196:199], v13 offset:33792
    buffer_load_dwordx4 v8, s[28:31], s63 offen offset:2048 lds
    v_mfma_f32_16x16x32_bf16 v[52:55], a[204:207], a[24:27], v[52:55]
    v_mfma_f32_16x16x32_bf16 v[80:83], a[204:207], a[28:31], v[80:83]
    ds_read_b128 a[200:203], v13 offset:34816
    buffer_load_dwordx4 v8, s[28:31], s63 offen offset:3072 lds
    s_waitcnt lgkmcnt(7)
    v_mfma_f32_16x16x32_bf16 v[48:51], a[160:163], a[32:35], v[48:51]
    v_mfma_f32_16x16x32_bf16 v[76:79], a[160:163], a[36:39], v[76:79]
    ds_read_b128 a[204:207], v13 offset:35840
    s_add_u32 s62, s62, 4096
    s_add_u32 s63, s63, 4096
    s_mov_b32 m0, s62
    buffer_load_dwordx4 v8, s[28:31], s63 offen offset:0 lds
    v_mfma_f32_16x16x32_bf16 v[52:55], a[164:167], a[32:35], v[52:55]
    v_mfma_f32_16x16x32_bf16 v[80:83], a[164:167], a[36:39], v[80:83]
    ds_read_b128 a[160:163], v13 offset:36864
    buffer_load_dwordx4 v8, s[28:31], s63 offen offset:1024 lds
    v_mfma_f32_16x16x32_bf16 v[48:51], a[168:171], a[40:43], v[48:51]
    v_mfma_f32_16x16x32_bf16 v[76:79], a[168:171], a[44:47], v[76:79]
    ds_read_b128 a[164:167], v13 offset:37888
    buffer_load_dwordx4 v8, s[28:31], s63 offen offset:2048 lds
    v_mfma_f32_16x16x32_bf16 v[52:55], a[172:175], a[40:43], v[52:55]
    v_mfma_f32_16x16x32_bf16 v[80:83], a[172:175], a[44:47], v[80:83]
    ds_read_b128 a[168:171], v13 offset:38912
    buffer_load_dwordx4 v8, s[28:31], s63 offen offset:3072 lds
    s_waitcnt lgkmcnt(7)
    v_mfma_f32_16x16x32_bf16 v[48:51], a[176:179], a[48:51], v[48:51]
    v_mfma_f32_16x16x32_bf16 v[76:79], a[176:179], a[52:55], v[76:79]
    ds_read_b128 a[172:175], v13 offset:39936
    s_add_u32 s62, s62, 4096
    s_add_u32 s63, s63, 4096
    s_mov_b32 m0, s62
    buffer_load_dwordx4 v8, s[28:31], s63 offen offset:0 lds
    v_mfma_f32_16x16x32_bf16 v[52:55], a[180:183], a[48:51], v[52:55]
    v_mfma_f32_16x16x32_bf16 v[80:83], a[180:183], a[52:55], v[80:83]
    ds_read_b128 a[176:179], v13 offset:40960
    buffer_load_dwordx4 v8, s[28:31], s63 offen offset:1024 lds
    v_mfma_f32_16x16x32_bf16 v[48:51], a[184:187], a[56:59], v[48:51]
    v_mfma_f32_16x16x32_bf16 v[76:79], a[184:187], a[60:63], v[76:79]
    ds_read_b128 a[180:183], v13 offset:41984
    buffer_load_dwordx4 v8, s[28:31], s63 offen offset:2048 lds
    v_mfma_f32_16x16x32_bf16 v[52:55], a[188:191], a[56:59], v[52:55]
    v_mfma_f32_16x16x32_bf16 v[80:83], a[188:191], a[60:63], v[80:83]
    ds_read_b128 a[184:187], v13 offset:43008
    buffer_load_dwordx4 v8, s[28:31], s63 offen offset:3072 lds
    s_waitcnt lgkmcnt(7)
    v_mfma_f32_16x16x32_bf16 v[48:51], a[192:195], a[64:67], v[48:51]
    v_mfma_f32_16x16x32_bf16 v[76:79], a[192:195], a[68:71], v[76:79]
    ds_read_b128 a[188:191], v13 offset:44032
    s_add_u32 s62, s62, 4096
    s_add_u32 s63, s63, 4096
    s_mov_b32 m0, s62
    buffer_load_dwordx4 v8, s[28:31], s63 offen offset:0 lds
    v_mfma_f32_16x16x32_bf16 v[52:55], a[196:199], a[64:67], v[52:55]
    v_mfma_f32_16x16x32_bf16 v[80:83], a[196:199], a[68:71], v[80:83]
    ds_read_b128 a[192:195], v13 offset:45056
    buffer_load_dwordx4 v8, s[28:31], s63 offen offset:1024 lds
    v_mfma_f32_16x16x32_bf16 v[48:51], a[200:203], a[72:75], v[48:51]
    v_mfma_f32_16x16x32_bf16 v[76:79], a[200:203], a[76:79], v[76:79]
    ds_read_b128 a[196:199], v13 offset:46080
    buffer_load_dwordx4 v8, s[28:31], s63 offen offset:2048 lds
    v_mfma_f32_16x16x32_bf16 v[52:55], a[204:207], a[72:75], v[52:55]
    v_mfma_f32_16x16x32_bf16 v[80:83], a[204:207], a[76:79], v[80:83]
    ds_read_b128 a[200:203], v13 offset:47104
    buffer_load_dwordx4 v8, s[28:31], s63 offen offset:3072 lds
    s_waitcnt lgkmcnt(7)
    v_mfma_f32_16x16x32_bf16 v[48:51], a[160:163], a[80:83], v[48:51]
    v_mfma_f32_16x16x32_bf16 v[76:79], a[160:163], a[84:87], v[76:79]
    ds_read_b128 a[204:207], v13 offset:48128
    s_add_u32 s62, s62, 4096
    s_add_u32 s63, s63, 4096
    s_mov_b32 m0, s62
    buffer_load_dwordx4 v8, s[28:31], s63 offen offset:0 lds
    v_mfma_f32_16x16x32_bf16 v[52:55], a[164:167], a[80:83], v[52:55]
    v_mfma_f32_16x16x32_bf16 v[80:83], a[164:167], a[84:87], v[80:83]
    ds_read_b128 a[160:163], v13 offset:49152
    buffer_load_dwordx4 v8, s[28:31], s63 offen offset:1024 lds
    v_mfma_f32_16x16x32_bf16 v[48:51], a[168:171], a[88:91], v[48:51]
    v_mfma_f32_16x16x32_bf16 v[76:79], a[168:171], a[92:95], v[76:79]
    ds_read_b128 a[164:167], v13 offset:50176
    buffer_load_dwordx4 v8, s[28:31], s63 offen offset:2048 lds
    v_mfma_f32_16x16x32_bf16 v[52:55], a[172:175], a[88:91], v[52:55]
    v_mfma_f32_16x16x32_bf16 v[80:83], a[172:175], a[92:95], v[80:83]
    ds_read_b128 a[168:171], v13 offset:51200
    buffer_load_dwordx4 v8, s[28:31], s63 offen offset:3072 lds
    s_waitcnt lgkmcnt(7)
    v_mfma_f32_16x16x32_bf16 v[48:51], a[176:179], a[96:99], v[48:51]
    v_mfma_f32_16x16x32_bf16 v[76:79], a[176:179], a[100:103], v[76:79]
    ds_read_b128 a[172:175], v13 offset:52224
    s_mul_i32 s25, s20, 3
    s_min_u32 s25, s25, 7
    s_lshl_b32 s25, s25, 10
    s_add_u32 s62, s25, 153600
    s_add_u32 s63, s25, s59
    s_add_u32 s63, s63, 92160
    s_mov_b32 m0, s62
    buffer_load_dwordx4 v8, s[28:31], s63 offen offset:0 lds
    v_mfma_f32_16x16x32_bf16 v[52:55], a[180:183], a[96:99], v[52:55]
    v_mfma_f32_16x16x32_bf16 v[80:83], a[180:183], a[100:103], v[80:83]
    ds_read_b128 a[176:179], v13 offset:53248
    buffer_load_dwordx4 v8, s[28:31], s63 offen offset:1024 lds
    v_mfma_f32_16x16x32_bf16 v[48:51], a[184:187], a[104:107], v[48:51]
    v_mfma_f32_16x16x32_bf16 v[76:79], a[184:187], a[108:111], v[76:79]
    ds_read_b128 a[180:183], v13 offset:54272
    buffer_load_dwordx4 v8, s[28:31], s63 offen offset:2048 lds
    v_mfma_f32_16x16x32_bf16 v[52:55], a[188:191], a[104:107], v[52:55]
    v_mfma_f32_16x16x32_bf16 v[80:83], a[188:191], a[108:111], v[80:83]
    ds_read_b128 a[184:187], v13 offset:55296
    s_mul_i32 s25, s20, 5
    s_lshl_b32 s25, s25, 10
    s_add_u32 s62, s25, 122880
    s_add_u32 s63, s25, s59
    s_add_u32 s63, s63, 102400
    s_mov_b32 m0, s62
    buffer_load_dwordx4 v8, s[28:31], s63 offen offset:0 lds
    s_waitcnt lgkmcnt(7)
    v_mfma_f32_16x16x32_bf16 v[48:51], a[192:195], a[112:115], v[48:51]
    v_mfma_f32_16x16x32_bf16 v[76:79], a[192:195], a[116:119], v[76:79]
    ds_read_b128 a[188:191], v13 offset:56320
    buffer_load_dwordx4 v8, s[28:31], s63 offen offset:1024 lds
    v_mfma_f32_16x16x32_bf16 v[52:55], a[196:199], a[112:115], v[52:55]
    v_mfma_f32_16x16x32_bf16 v[80:83], a[196:199], a[116:119], v[80:83]
    buffer_load_dwordx4 v8, s[28:31], s63 offen offset:2048 lds
    v_mfma_f32_16x16x32_bf16 v[48:51], a[200:203], a[120:123], v[48:51]
    v_mfma_f32_16x16x32_bf16 v[76:79], a[200:203], a[124:127], v[76:79]
    buffer_load_dwordx4 v8, s[28:31], s63 offen offset:3072 lds
    v_mfma_f32_16x16x32_bf16 v[52:55], a[204:207], a[120:123], v[52:55]
    v_mfma_f32_16x16x32_bf16 v[80:83], a[204:207], a[124:127], v[80:83]
    s_add_u32 s62, s62, 4096
    s_add_u32 s63, s63, 4096
    s_mov_b32 m0, s62
    buffer_load_dwordx4 v8, s[28:31], s63 offen offset:0 lds
    s_waitcnt lgkmcnt(4)
    v_mfma_f32_16x16x32_bf16 v[48:51], a[160:163], a[128:131], v[48:51]
    v_mfma_f32_16x16x32_bf16 v[76:79], a[160:163], a[132:135], v[76:79]
    v_mfma_f32_16x16x32_bf16 v[52:55], a[164:167], a[128:131], v[52:55]
    v_mfma_f32_16x16x32_bf16 v[80:83], a[164:167], a[132:135], v[80:83]
    v_mfma_f32_16x16x32_bf16 v[48:51], a[168:171], a[136:139], v[48:51]
    v_mfma_f32_16x16x32_bf16 v[76:79], a[168:171], a[140:143], v[76:79]
    v_mfma_f32_16x16x32_bf16 v[52:55], a[172:175], a[136:139], v[52:55]
    v_mfma_f32_16x16x32_bf16 v[80:83], a[172:175], a[140:143], v[80:83]
    s_waitcnt lgkmcnt(0)
    v_mfma_f32_16x16x32_bf16 v[48:51], a[176:179], a[144:147], v[48:51]
    v_mfma_f32_16x16x32_bf16 v[76:79], a[176:179], a[148:151], v[76:79]
    v_mfma_f32_16x16x32_bf16 v[52:55], a[180:183], a[144:147], v[52:55]
    v_mfma_f32_16x16x32_bf16 v[80:83], a[180:183], a[148:151], v[80:83]
    v_mfma_f32_16x16x32_bf16 v[48:51], a[184:187], a[152:155], v[48:51]
    v_mfma_f32_16x16x32_bf16 v[76:79], a[184:187], a[156:159], v[76:79]
    v_mfma_f32_16x16x32_bf16 v[52:55], a[188:191], a[152:155], v[52:55]
    v_mfma_f32_16x16x32_bf16 v[80:83], a[188:191], a[156:159], v[80:83]
    s_barrier
    s_mul_i32 s26, s22, 5120
    s_add_u32 s55, s59, s26
    s_add_u32 s55, s55, 194560
    s_waitcnt vmcnt(41)
    v_add_f32 v16, v16, v18
    v_add_f32 v17, v17, v19
    v_add_f32 v20, v20, v22
    v_add_f32 v21, v21, v23
    s_nop 0
    v_mov_b32 v24, v16
    v_mov_b32 v25, v17
    v_mov_b32 v26, v20
    v_mov_b32 v27, v21
    s_nop 1
    v_permlane32_swap_b32 v24, v16
    v_permlane32_swap_b32 v25, v17
    v_permlane32_swap_b32 v26, v20
    v_permlane32_swap_b32 v27, v21
    s_mul_i32 s25, s20, 10
    s_lshl_b32 s25, s25, 10
    s_add_u32 s62, s25, 81920
    s_add_u32 s63, s25, s59
    s_add_u32 s63, s63, 122880
    s_mov_b32 m0, s62
    buffer_load_dwordx4 v8, s[28:31], s63 offen offset:0 lds
    s_nop 1
    v_add_f32 v16, v16, v24
    v_add_f32 v17, v17, v25
    v_add_f32 v20, v20, v26
    v_add_f32 v21, v21, v27
    v_mov_b32 v24, v16
    v_mov_b32 v25, v17
    v_mov_b32 v26, v20
    v_mov_b32 v27, v21
    s_nop 1
    v_permlane16_swap_b32 v24, v16
    v_permlane16_swap_b32 v25, v17
    v_permlane16_swap_b32 v26, v20
    v_permlane16_swap_b32 v27, v21
    s_nop 1
    v_add_f32 v16, v16, v24
    buffer_load_dwordx4 v8, s[28:31], s63 offen offset:1024 lds
    v_add_f32 v17, v17, v25
    v_add_f32 v20, v20, v26
    v_add_f32 v21, v21, v27
    v_mul_f32 v16, 0x3acccccd, v16
    v_mul_f32 v20, 0x3acccccd, v20
    v_mul_f32 v17, 0x3acccccd, v17
    v_mul_f32 v21, 0x3acccccd, v21
    v_fma_f32 v17, -v16, v16, v17
    v_fma_f32 v21, -v20, v20, v21
    v_max_f32 v17, 0, v17
    v_max_f32 v21, 0, v21
    v_cvt_pk_bf16_f32 v18, v16, v17
    v_cvt_pk_bf16_f32 v22, v20, v21
    v_lshlrev_b32 v16, 16, v18
    v_lshlrev_b32 v20, 16, v22
    v_and_b32 v17, 0xffff0000, v18
    v_and_b32 v21, 0xffff0000, v22
    v_add_f32 v17, 0x3727c5ac, v17
    v_add_f32 v21, 0x3727c5ac, v21
    buffer_load_dwordx4 v8, s[28:31], s63 offen offset:2048 lds
    v_cvt_pk_bf16_f32 v18, v17, v17
    v_cvt_pk_bf16_f32 v22, v21, v21
    v_lshlrev_b32 v17, 16, v18
    v_lshlrev_b32 v21, 16, v22
    v_sqrt_f32 v17, v17
    v_sqrt_f32 v21, v21
    s_nop 0
    s_nop 0
    v_cvt_pk_bf16_f32 v18, v17, v17
    v_cvt_pk_bf16_f32 v22, v21, v21
    v_lshlrev_b32 v17, 16, v18
    v_lshlrev_b32 v21, 16, v22
    v_rcp_f32 v17, v17
    v_rcp_f32 v21, v21
    s_nop 0
    s_nop 0
    v_mul_f32 v16, v16, v17
    buffer_load_dwordx4 v8, s[28:31], s63 offen offset:3072 lds
    v_mul_f32 v20, v20, v21
    v_sub_f32 v16, 0, v16
    v_sub_f32 v20, 0, v20
    v_mov_b32 v30, 0xbdd2d3e8
    v_mov_b32 v31, 0xc0135761
    v_pk_mul_f32 v[176:177], v[88:89], v[16:17] op_sel_hi:[1,0]
    v_pk_mul_f32 v[178:179], v[90:91], v[16:17] op_sel_hi:[1,0]
    v_pk_mul_f32 v[180:181], v[92:93], v[16:17] op_sel_hi:[1,0]
    v_pk_mul_f32 v[182:183], v[94:95], v[16:17] op_sel_hi:[1,0]
    v_pk_mul_f32 v[184:185], v[96:97], v[16:17] op_sel_hi:[1,0]
    v_pk_mul_f32 v[186:187], v[98:99], v[16:17] op_sel_hi:[1,0]
    v_pk_mul_f32 v[188:189], v[100:101], v[16:17] op_sel_hi:[1,0]
    v_pk_mul_f32 v[190:191], v[102:103], v[16:17] op_sel_hi:[1,0]
    v_pk_mul_f32 v[192:193], v[104:105], v[16:17] op_sel_hi:[1,0]
    v_pk_mul_f32 v[194:195], v[106:107], v[16:17] op_sel_hi:[1,0]
    v_pk_mul_f32 v[196:197], v[108:109], v[16:17] op_sel_hi:[1,0]
    v_pk_mul_f32 v[198:199], v[110:111], v[16:17] op_sel_hi:[1,0]
    v_pk_mul_f32 v[200:201], v[112:113], v[16:17] op_sel_hi:[1,0]
    v_pk_mul_f32 v[202:203], v[114:115], v[16:17] op_sel_hi:[1,0]
    s_add_u32 s62, s62, 4096
    s_add_u32 s63, s63, 4096
    s_mov_b32 m0, s62
    buffer_load_dwordx4 v8, s[28:31], s63 offen offset:0 lds
    v_pk_fma_f32 v[32:33], v[32:33], v[16:17], v[176:177] op_sel:[0,1,0] op_sel_hi:[1,1,1]
    v_pk_fma_f32 v[34:35], v[34:35], v[16:17], v[178:179] op_sel:[0,1,0] op_sel_hi:[1,1,1]
    v_pk_fma_f32 v[36:37], v[36:37], v[16:17], v[180:181] op_sel:[0,1,0] op_sel_hi:[1,1,1]
    v_pk_fma_f32 v[38:39], v[38:39], v[16:17], v[182:183] op_sel:[0,1,0] op_sel_hi:[1,1,1]
    v_pk_fma_f32 v[40:41], v[40:41], v[16:17], v[184:185] op_sel:[0,1,0] op_sel_hi:[1,1,1]
    v_pk_fma_f32 v[42:43], v[42:43], v[16:17], v[186:187] op_sel:[0,1,0] op_sel_hi:[1,1,1]
    v_pk_fma_f32 v[44:45], v[44:45], v[16:17], v[188:189] op_sel:[0,1,0] op_sel_hi:[1,1,1]
    v_pk_fma_f32 v[46:47], v[46:47], v[16:17], v[190:191] op_sel:[0,1,0] op_sel_hi:[1,1,1]
    v_pk_fma_f32 v[48:49], v[48:49], v[16:17], v[192:193] op_sel:[0,1,0] op_sel_hi:[1,1,1]
    v_pk_fma_f32 v[50:51], v[50:51], v[16:17], v[194:195] op_sel:[0,1,0] op_sel_hi:[1,1,1]
    v_pk_fma_f32 v[52:53], v[52:53], v[16:17], v[196:197] op_sel:[0,1,0] op_sel_hi:[1,1,1]
    v_pk_fma_f32 v[54:55], v[54:55], v[16:17], v[198:199] op_sel:[0,1,0] op_sel_hi:[1,1,1]
    v_pk_fma_f32 v[56:57], v[56:57], v[16:17], v[200:201] op_sel:[0,1,0] op_sel_hi:[1,1,1]
    v_pk_fma_f32 v[58:59], v[58:59], v[16:17], v[202:203] op_sel:[0,1,0] op_sel_hi:[1,1,1]
    v_pk_mul_f32 v[176:177], v[32:33], v[32:33]
    v_pk_mul_f32 v[178:179], v[34:35], v[34:35]
    v_pk_mul_f32 v[180:181], v[36:37], v[36:37]
    v_pk_mul_f32 v[182:183], v[38:39], v[38:39]
    v_pk_mul_f32 v[184:185], v[40:41], v[40:41]
    buffer_load_dwordx4 v8, s[28:31], s63 offen offset:1024 lds
    v_pk_mul_f32 v[186:187], v[42:43], v[42:43]
    v_pk_mul_f32 v[188:189], v[44:45], v[44:45]
    v_pk_mul_f32 v[190:191], v[46:47], v[46:47]
    v_pk_mul_f32 v[192:193], v[48:49], v[48:49]
    v_pk_mul_f32 v[194:195], v[50:51], v[50:51]
    v_pk_mul_f32 v[196:197], v[52:53], v[52:53]
    v_pk_mul_f32 v[198:199], v[54:55], v[54:55]
    v_pk_mul_f32 v[200:201], v[56:57], v[56:57]
    v_pk_mul_f32 v[202:203], v[58:59], v[58:59]
    v_pk_fma_f32 v[176:177], v[176:177], v[30:31], v[30:31] op_sel:[0,0,1] op_sel_hi:[1,0,1]
    v_pk_fma_f32 v[178:179], v[178:179], v[30:31], v[30:31] op_sel:[0,0,1] op_sel_hi:[1,0,1]
    v_pk_fma_f32 v[180:181], v[180:181], v[30:31], v[30:31] op_sel:[0,0,1] op_sel_hi:[1,0,1]
    v_pk_fma_f32 v[182:183], v[182:183], v[30:31], v[30:31] op_sel:[0,0,1] op_sel_hi:[1,0,1]
    v_pk_fma_f32 v[184:185], v[184:185], v[30:31], v[30:31] op_sel:[0,0,1] op_sel_hi:[1,0,1]
    v_pk_fma_f32 v[186:187], v[186:187], v[30:31], v[30:31] op_sel:[0,0,1] op_sel_hi:[1,0,1]
    v_pk_fma_f32 v[188:189], v[188:189], v[30:31], v[30:31] op_sel:[0,0,1] op_sel_hi:[1,0,1]
    v_pk_fma_f32 v[190:191], v[190:191], v[30:31], v[30:31] op_sel:[0,0,1] op_sel_hi:[1,0,1]
    v_pk_fma_f32 v[192:193], v[192:193], v[30:31], v[30:31] op_sel:[0,0,1] op_sel_hi:[1,0,1]
    v_pk_fma_f32 v[194:195], v[194:195], v[30:31], v[30:31] op_sel:[0,0,1] op_sel_hi:[1,0,1]
    buffer_load_dwordx4 v8, s[28:31], s63 offen offset:2048 lds
    v_pk_fma_f32 v[196:197], v[196:197], v[30:31], v[30:31] op_sel:[0,0,1] op_sel_hi:[1,0,1]
    v_pk_fma_f32 v[198:199], v[198:199], v[30:31], v[30:31] op_sel:[0,0,1] op_sel_hi:[1,0,1]
    v_pk_fma_f32 v[200:201], v[200:201], v[30:31], v[30:31] op_sel:[0,0,1] op_sel_hi:[1,0,1]
    v_pk_fma_f32 v[202:203], v[202:203], v[30:31], v[30:31] op_sel:[0,0,1] op_sel_hi:[1,0,1]
    v_pk_mul_f32 v[176:177], v[176:177], v[32:33]
    v_pk_mul_f32 v[178:179], v[178:179], v[34:35]
    v_pk_mul_f32 v[180:181], v[180:181], v[36:37]
    v_pk_mul_f32 v[182:183], v[182:183], v[38:39]
    v_pk_mul_f32 v[184:185], v[184:185], v[40:41]
    v_pk_mul_f32 v[186:187], v[186:187], v[42:43]
    v_pk_mul_f32 v[188:189], v[188:189], v[44:45]
    v_pk_mul_f32 v[190:191], v[190:191], v[46:47]
    v_pk_mul_f32 v[192:193], v[192:193], v[48:49]
    v_pk_mul_f32 v[194:195], v[194:195], v[50:51]
    v_pk_mul_f32 v[196:197], v[196:197], v[52:53]
    v_pk_mul_f32 v[198:199], v[198:199], v[54:55]
    v_pk_mul_f32 v[200:201], v[200:201], v[56:57]
    v_pk_mul_f32 v[202:203], v[202:203], v[58:59]
    v_exp_f32 v176, v176
    buffer_load_dwordx4 v8, s[28:31], s63 offen offset:3072 lds
    v_exp_f32 v177, v177
    v_exp_f32 v178, v178
    v_exp_f32 v179, v179
    v_exp_f32 v180, v180
    v_exp_f32 v181, v181
    v_exp_f32 v182, v182
    v_exp_f32 v183, v183
    v_exp_f32 v184, v184
    v_exp_f32 v185, v185
    v_exp_f32 v186, v186
    s_add_u32 s62, s62, 4096
    s_add_u32 s63, s63, 4096
    s_mov_b32 m0, s62
    buffer_load_dwordx4 v8, s[28:31], s63 offen offset:0 lds
    v_exp_f32 v187, v187
    v_exp_f32 v188, v188
    v_exp_f32 v189, v189
    v_exp_f32 v190, v190
    v_exp_f32 v191, v191
    v_exp_f32 v192, v192
    v_exp_f32 v193, v193
    v_exp_f32 v194, v194
    v_exp_f32 v195, v195
    v_exp_f32 v196, v196
    buffer_load_dwordx4 v8, s[28:31], s63 offen offset:1024 lds
    v_exp_f32 v197, v197
    v_exp_f32 v198, v198
    v_exp_f32 v199, v199
    v_exp_f32 v200, v200
    v_exp_f32 v201, v201
    v_exp_f32 v202, v202
    v_exp_f32 v203, v203
    v_pk_add_f32 v[176:177], v[176:177], 1.0 op_sel_hi:[1,0]
    v_pk_add_f32 v[178:179], v[178:179], 1.0 op_sel_hi:[1,0]
    v_pk_add_f32 v[180:181], v[180:181], 1.0 op_sel_hi:[1,0]
    v_pk_add_f32 v[182:183], v[182:183], 1.0 op_sel_hi:[1,0]
    v_pk_add_f32 v[184:185], v[184:185], 1.0 op_sel_hi:[1,0]
    buffer_load_dwordx4 a[96:99], v8, s[28:31], s55 offen offset:0
    v_pk_add_f32 v[186:187], v[186:187], 1.0 op_sel_hi:[1,0]
    v_pk_add_f32 v[188:189], v[188:189], 1.0 op_sel_hi:[1,0]
    v_pk_add_f32 v[190:191], v[190:191], 1.0 op_sel_hi:[1,0]
    v_pk_add_f32 v[192:193], v[192:193], 1.0 op_sel_hi:[1,0]
    v_pk_add_f32 v[194:195], v[194:195], 1.0 op_sel_hi:[1,0]
    v_pk_add_f32 v[196:197], v[196:197], 1.0 op_sel_hi:[1,0]
    v_pk_add_f32 v[198:199], v[198:199], 1.0 op_sel_hi:[1,0]
    v_pk_add_f32 v[200:201], v[200:201], 1.0 op_sel_hi:[1,0]
    v_pk_add_f32 v[202:203], v[202:203], 1.0 op_sel_hi:[1,0]
    v_rcp_f32 v176, v176
    v_rcp_f32 v177, v177
    v_rcp_f32 v178, v178
    v_rcp_f32 v179, v179
    v_rcp_f32 v180, v180
    buffer_load_dwordx4 a[100:103], v8, s[28:31], s55 offen offset:1024
    v_rcp_f32 v181, v181
    v_rcp_f32 v182, v182
    v_rcp_f32 v183, v183
    v_rcp_f32 v184, v184
    v_rcp_f32 v185, v185
    v_rcp_f32 v186, v186
    v_rcp_f32 v187, v187
    v_rcp_f32 v188, v188
    v_rcp_f32 v189, v189
    v_rcp_f32 v190, v190
    buffer_load_dwordx4 a[104:107], v8, s[28:31], s55 offen offset:2048
    v_rcp_f32 v191, v191
    v_rcp_f32 v192, v192
    v_rcp_f32 v193, v193
    v_rcp_f32 v194, v194
    v_rcp_f32 v195, v195
    v_rcp_f32 v196, v196
    v_rcp_f32 v197, v197
    v_rcp_f32 v198, v198
    v_rcp_f32 v199, v199
    v_rcp_f32 v200, v200
    buffer_load_dwordx4 a[108:111], v8, s[28:31], s55 offen offset:3072
    v_rcp_f32 v201, v201
    v_rcp_f32 v202, v202
    v_rcp_f32 v203, v203
    v_pk_mul_f32 v[32:33], v[32:33], v[176:177]
    v_pk_mul_f32 v[34:35], v[34:35], v[178:179]
    v_pk_mul_f32 v[36:37], v[36:37], v[180:181]
    v_pk_mul_f32 v[38:39], v[38:39], v[182:183]
    v_pk_mul_f32 v[40:41], v[40:41], v[184:185]
    v_pk_mul_f32 v[42:43], v[42:43], v[186:187]
    v_pk_mul_f32 v[44:45], v[44:45], v[188:189]
    v_pk_mul_f32 v[46:47], v[46:47], v[190:191]
    v_pk_mul_f32 v[48:49], v[48:49], v[192:193]
    v_pk_mul_f32 v[50:51], v[50:51], v[194:195]
    v_pk_mul_f32 v[52:53], v[52:53], v[196:197]
    v_pk_mul_f32 v[54:55], v[54:55], v[198:199]
    v_pk_mul_f32 v[56:57], v[56:57], v[200:201]
    s_add_u32 s55, s55, 4096
    buffer_load_dwordx4 a[112:115], v8, s[28:31], s55 offen offset:0
    s_add_u32 s55, s55, 6144
    v_pk_mul_f32 v[58:59], v[58:59], v[202:203]
    v_cvt_pk_bf16_f32 v144, v32, v33
    v_cvt_pk_bf16_f32 v145, v34, v35
    v_cvt_pk_bf16_f32 v146, v36, v37
    v_cvt_pk_bf16_f32 v147, v38, v39
    v_cvt_pk_bf16_f32 v148, v40, v41
    v_cvt_pk_bf16_f32 v149, v42, v43
    v_cvt_pk_bf16_f32 v150, v44, v45
    v_cvt_pk_bf16_f32 v151, v46, v47
    v_cvt_pk_bf16_f32 v152, v48, v49
    v_cvt_pk_bf16_f32 v153, v50, v51
    v_cvt_pk_bf16_f32 v154, v52, v53
    v_cvt_pk_bf16_f32 v155, v54, v55
    v_cvt_pk_bf16_f32 v156, v56, v57
    v_cvt_pk_bf16_f32 v157, v58, v59
    s_nop 1
    v_permlane16_swap_b32 v144, v146
    v_permlane16_swap_b32 v145, v147
    v_permlane16_swap_b32 v148, v150
    v_permlane16_swap_b32 v149, v151
    v_permlane16_swap_b32 v152, v154
    v_permlane16_swap_b32 v153, v155
    s_add_u32 s26, s13, 0
    s_add_u32 s27, s12, 0
    buffer_store_dwordx4 v[144:147], v226, s[28:31], s26 offen sc1
    buffer_store_dwordx2 v[156:157], v227, s[28:31], s27 offen sc1
    s_cmp_eq_u32 s52, 15
    s_cbranch_scc1 chain_kernel_j157
    buffer_store_dwordx4 v[148:151], v226, s[28:31], s26 offen offset:1024 sc1
    buffer_store_dwordx4 v[152:155], v226, s[28:31], s26 offen offset:2048 sc1
chain_kernel_j157:
    v_pk_mul_f32 v[176:177], v[88:89], v[20:21] op_sel_hi:[1,0]
    buffer_load_dwordx4 a[116:119], v8, s[28:31], s55 offen offset:0
    v_pk_mul_f32 v[178:179], v[90:91], v[20:21] op_sel_hi:[1,0]
    v_pk_mul_f32 v[180:181], v[92:93], v[20:21] op_sel_hi:[1,0]
    v_pk_mul_f32 v[182:183], v[94:95], v[20:21] op_sel_hi:[1,0]
    v_pk_mul_f32 v[184:185], v[96:97], v[20:21] op_sel_hi:[1,0]
    v_pk_mul_f32 v[186:187], v[98:99], v[20:21] op_sel_hi:[1,0]
    v_pk_mul_f32 v[188:189], v[100:101], v[20:21] op_sel_hi:[1,0]
    v_pk_mul_f32 v[190:191], v[102:103], v[20:21] op_sel_hi:[1,0]
    v_pk_mul_f32 v[192:193], v[104:105], v[20:21] op_sel_hi:[1,0]
    v_pk_mul_f32 v[194:195], v[106:107], v[20:21] op_sel_hi:[1,0]
    v_pk_mul_f32 v[196:197], v[108:109], v[20:21] op_sel_hi:[1,0]
    v_pk_mul_f32 v[198:199], v[110:111], v[20:21] op_sel_hi:[1,0]
    v_pk_mul_f32 v[200:201], v[112:113], v[20:21] op_sel_hi:[1,0]
    v_pk_mul_f32 v[202:203], v[114:115], v[20:21] op_sel_hi:[1,0]
    v_pk_fma_f32 v[60:61], v[60:61], v[20:21], v[176:177] op_sel:[0,1,0] op_sel_hi:[1,1,1]
    v_pk_fma_f32 v[62:63], v[62:63], v[20:21], v[178:179] op_sel:[0,1,0] op_sel_hi:[1,1,1]
    v_pk_fma_f32 v[64:65], v[64:65], v[20:21], v[180:181] op_sel:[0,1,0] op_sel_hi:[1,1,1]
    v_pk_fma_f32 v[66:67], v[66:67], v[20:21], v[182:183] op_sel:[0,1,0] op_sel_hi:[1,1,1]
    v_pk_fma_f32 v[68:69], v[68:69], v[20:21], v[184:185] op_sel:[0,1,0] op_sel_hi:[1,1,1]
    v_pk_fma_f32 v[70:71], v[70:71], v[20:21], v[186:187] op_sel:[0,1,0] op_sel_hi:[1,1,1]
    buffer_load_dwordx4 a[120:123], v8, s[28:31], s55 offen offset:1024
    v_pk_fma_f32 v[72:73], v[72:73], v[20:21], v[188:189] op_sel:[0,1,0] op_sel_hi:[1,1,1]
    v_pk_fma_f32 v[74:75], v[74:75], v[20:21], v[190:191] op_sel:[0,1,0] op_sel_hi:[1,1,1]
    v_pk_fma_f32 v[76:77], v[76:77], v[20:21], v[192:193] op_sel:[0,1,0] op_sel_hi:[1,1,1]
    v_pk_fma_f32 v[78:79], v[78:79], v[20:21], v[194:195] op_sel:[0,1,0] op_sel_hi:[1,1,1]
    v_pk_fma_f32 v[80:81], v[80:81], v[20:21], v[196:197] op_sel:[0,1,0] op_sel_hi:[1,1,1]
    v_pk_fma_f32 v[82:83], v[82:83], v[20:21], v[198:199] op_sel:[0,1,0] op_sel_hi:[1,1,1]
    v_pk_fma_f32 v[84:85], v[84:85], v[20:21], v[200:201] op_sel:[0,1,0] op_sel_hi:[1,1,1]
    v_pk_fma_f32 v[86:87], v[86:87], v[20:21], v[202:203] op_sel:[0,1,0] op_sel_hi:[1,1,1]
    v_pk_mul_f32 v[176:177], v[60:61], v[60:61]
    v_pk_mul_f32 v[178:179], v[62:63], v[62:63]
    v_pk_mul_f32 v[180:181], v[64:65], v[64:65]
    v_pk_mul_f32 v[182:183], v[66:67], v[66:67]
    v_pk_mul_f32 v[184:185], v[68:69], v[68:69]
    v_pk_mul_f32 v[186:187], v[70:71], v[70:71]
    v_pk_mul_f32 v[188:189], v[72:73], v[72:73]
    v_pk_mul_f32 v[190:191], v[74:75], v[74:75]
    v_pk_mul_f32 v[192:193], v[76:77], v[76:77]
    v_pk_mul_f32 v[194:195], v[78:79], v[78:79]
    v_pk_mul_f32 v[196:197], v[80:81], v[80:81]
    buffer_load_dwordx4 a[124:127], v8, s[28:31], s55 offen offset:2048
    v_pk_mul_f32 v[198:199], v[82:83], v[82:83]
    v_pk_mul_f32 v[200:201], v[84:85], v[84:85]
    v_pk_mul_f32 v[202:203], v[86:87], v[86:87]
    v_pk_fma_f32 v[176:177], v[176:177], v[30:31], v[30:31] op_sel:[0,0,1] op_sel_hi:[1,0,1]
    v_pk_fma_f32 v[178:179], v[178:179], v[30:31], v[30:31] op_sel:[0,0,1] op_sel_hi:[1,0,1]
    v_pk_fma_f32 v[180:181], v[180:181], v[30:31], v[30:31] op_sel:[0,0,1] op_sel_hi:[1,0,1]
    v_pk_fma_f32 v[182:183], v[182:183], v[30:31], v[30:31] op_sel:[0,0,1] op_sel_hi:[1,0,1]
    v_pk_fma_f32 v[184:185], v[184:185], v[30:31], v[30:31] op_sel:[0,0,1] op_sel_hi:[1,0,1]
    v_pk_fma_f32 v[186:187], v[186:187], v[30:31], v[30:31] op_sel:[0,0,1] op_sel_hi:[1,0,1]
    v_pk_fma_f32 v[188:189], v[188:189], v[30:31], v[30:31] op_sel:[0,0,1] op_sel_hi:[1,0,1]
    v_pk_fma_f32 v[190:191], v[190:191], v[30:31], v[30:31] op_sel:[0,0,1] op_sel_hi:[1,0,1]
    v_pk_fma_f32 v[192:193], v[192:193], v[30:31], v[30:31] op_sel:[0,0,1] op_sel_hi:[1,0,1]
    v_pk_fma_f32 v[194:195], v[194:195], v[30:31], v[30:31] op_sel:[0,0,1] op_sel_hi:[1,0,1]
    v_pk_fma_f32 v[196:197], v[196:197], v[30:31], v[30:31] op_sel:[0,0,1] op_sel_hi:[1,0,1]
    v_pk_fma_f32 v[198:199], v[198:199], v[30:31], v[30:31] op_sel:[0,0,1] op_sel_hi:[1,0,1]
    v_pk_fma_f32 v[200:201], v[200:201], v[30:31], v[30:31] op_sel:[0,0,1] op_sel_hi:[1,0,1]
    v_pk_fma_f32 v[202:203], v[202:203], v[30:31], v[30:31] op_sel:[0,0,1] op_sel_hi:[1,0,1]
    v_pk_mul_f32 v[176:177], v[176:177], v[60:61]
    v_pk_mul_f32 v[178:179], v[178:179], v[62:63]
    buffer_load_dwordx4 a[128:131], v8, s[28:31], s55 offen offset:3072
    v_pk_mul_f32 v[180:181], v[180:181], v[64:65]
    v_pk_mul_f32 v[182:183], v[182:183], v[66:67]
    v_pk_mul_f32 v[184:185], v[184:185], v[68:69]
    v_pk_mul_f32 v[186:187], v[186:187], v[70:71]
    v_pk_mul_f32 v[188:189], v[188:189], v[72:73]
    v_pk_mul_f32 v[190:191], v[190:191], v[74:75]
    v_pk_mul_f32 v[192:193], v[192:193], v[76:77]
    v_pk_mul_f32 v[194:195], v[194:195], v[78:79]
    v_pk_mul_f32 v[196:197], v[196:197], v[80:81]
    v_pk_mul_f32 v[198:199], v[198:199], v[82:83]
    v_pk_mul_f32 v[200:201], v[200:201], v[84:85]
    v_pk_mul_f32 v[202:203], v[202:203], v[86:87]
    v_exp_f32 v176, v176
    v_exp_f32 v177, v177
    v_exp_f32 v178, v178
    v_exp_f32 v179, v179
    s_add_u32 s55, s55, 4096
    buffer_load_dwordx4 a[132:135], v8, s[28:31], s55 offen offset:0
    s_add_u32 s55, s55, 6144
    v_exp_f32 v180, v180
    v_exp_f32 v181, v181
    v_exp_f32 v182, v182
    v_exp_f32 v183, v183
    v_exp_f32 v184, v184
    v_exp_f32 v185, v185
    v_exp_f32 v186, v186
    v_exp_f32 v187, v187
    v_exp_f32 v188, v188
    v_exp_f32 v189, v189
    buffer_load_dwordx4 a[136:139], v8, s[28:31], s55 offen offset:0
    v_exp_f32 v190, v190
    v_exp_f32 v191, v191
    v_exp_f32 v192, v192
    v_exp_f32 v193, v193
    v_exp_f32 v194, v194
    v_exp_f32 v195, v195
    v_exp_f32 v196, v196
    v_exp_f32 v197, v197
    v_exp_f32 v198, v198
    v_exp_f32 v199, v199
    buffer_load_dwordx4 a[140:143], v8, s[28:31], s55 offen offset:1024
    v_exp_f32 v200, v200
    v_exp_f32 v201, v201
    v_exp_f32 v202, v202
    v_exp_f32 v203, v203
    v_pk_add_f32 v[176:177], v[176:177], 1.0 op_sel_hi:[1,0]
    v_pk_add_f32 v[178:179], v[178:179], 1.0 op_sel_hi:[1,0]
    v_pk_add_f32 v[180:181], v[180:181], 1.0 op_sel_hi:[1,0]
    v_pk_add_f32 v[182:183], v[182:183], 1.0 op_sel_hi:[1,0]
    v_pk_add_f32 v[184:185], v[184:185], 1.0 op_sel_hi:[1,0]
    v_pk_add_f32 v[186:187], v[186:187], 1.0 op_sel_hi:[1,0]
    v_pk_add_f32 v[188:189], v[188:189], 1.0 op_sel_hi:[1,0]
    v_pk_add_f32 v[190:191], v[190:191], 1.0 op_sel_hi:[1,0]
    v_pk_add_f32 v[192:193], v[192:193], 1.0 op_sel_hi:[1,0]
    v_pk_add_f32 v[194:195], v[194:195], 1.0 op_sel_hi:[1,0]
    v_pk_add_f32 v[196:197], v[196:197], 1.0 op_sel_hi:[1,0]
    buffer_load_dwordx4 a[144:147], v8, s[28:31], s55 offen offset:2048
    v_pk_add_f32 v[198:199], v[198:199], 1.0 op_sel_hi:[1,0]
    v_pk_add_f32 v[200:201], v[200:201], 1.0 op_sel_hi:[1,0]
    v_pk_add_f32 v[202:203], v[202:203], 1.0 op_sel_hi:[1,0]
    v_rcp_f32 v176, v176
    v_rcp_f32 v177, v177
    v_rcp_f32 v178, v178
    v_rcp_f32 v179, v179
    v_rcp_f32 v180, v180
    v_rcp_f32 v181, v181
    v_rcp_f32 v182, v182
    v_rcp_f32 v183, v183
    buffer_load_dwordx4 a[148:151], v8, s[28:31], s55 offen offset:3072
    v_rcp_f32 v184, v184
    v_rcp_f32 v185, v185
    v_rcp_f32 v186, v186
    v_rcp_f32 v187, v187
    v_rcp_f32 v188, v188
    v_rcp_f32 v189, v189
    v_rcp_f32 v190, v190
    v_rcp_f32 v191, v191
    v_rcp_f32 v192, v192
    v_rcp_f32 v193, v193
    s_add_u32 s55, s55, 4096
    buffer_load_dwordx4 a[152:155], v8, s[28:31], s55 offen offset:0
    s_add_u32 s55, s55, 6144
    v_rcp_f32 v194, v194
    v_rcp_f32 v195, v195
    v_rcp_f32 v196, v196
    v_rcp_f32 v197, v197
    v_rcp_f32 v198, v198
    v_rcp_f32 v199, v199
    v_rcp_f32 v200, v200
    v_rcp_f32 v201, v201
    v_rcp_f32 v202, v202
    v_rcp_f32 v203, v203
    buffer_load_dwordx4 a[156:159], v8, s[28:31], s55 offen offset:0
    v_pk_mul_f32 v[60:61], v[60:61], v[176:177]
    v_pk_mul_f32 v[62:63], v[62:63], v[178:179]
    v_pk_mul_f32 v[64:65], v[64:65], v[180:181]
    v_pk_mul_f32 v[66:67], v[66:67], v[182:183]
    v_pk_mul_f32 v[68:69], v[68:69], v[184:185]
    v_pk_mul_f32 v[70:71], v[70:71], v[186:187]
    v_pk_mul_f32 v[72:73], v[72:73], v[188:189]
    v_pk_mul_f32 v[74:75], v[74:75], v[190:191]
    v_pk_mul_f32 v[76:77], v[76:77], v[192:193]
    v_pk_mul_f32 v[78:79], v[78:79], v[194:195]
    v_pk_mul_f32 v[80:81], v[80:81], v[196:197]
    v_pk_mul_f32 v[82:83], v[82:83], v[198:199]
    v_pk_mul_f32 v[84:85], v[84:85], v[200:201]
    v_pk_mul_f32 v[86:87], v[86:87], v[202:203]
    v_cvt_pk_bf16_f32 v160, v60, v61
    v_cvt_pk_bf16_f32 v161, v62, v63
    v_cvt_pk_bf16_f32 v162, v64, v65
    v_cvt_pk_bf16_f32 v163, v66, v67
    v_cvt_pk_bf16_f32 v164, v68, v69
    v_cvt_pk_bf16_f32 v165, v70, v71
    v_cvt_pk_bf16_f32 v166, v72, v73
    v_cvt_pk_bf16_f32 v167, v74, v75
    v_cvt_pk_bf16_f32 v168, v76, v77
    v_cvt_pk_bf16_f32 v169, v78, v79
    v_cvt_pk_bf16_f32 v170, v80, v81
    v_cvt_pk_bf16_f32 v171, v82, v83
    v_cvt_pk_bf16_f32 v172, v84, v85
    v_cvt_pk_bf16_f32 v173, v86, v87
    s_nop 1
    v_permlane16_swap_b32 v160, v162
    v_permlane16_swap_b32 v161, v163
    v_permlane16_swap_b32 v164, v166
    v_permlane16_swap_b32 v165, v167
    v_permlane16_swap_b32 v168, v170
    v_permlane16_swap_b32 v169, v171
    s_add_u32 s26, s13, 55296
    s_add_u32 s27, s12, 55296
    buffer_store_dwordx4 v[160:163], v226, s[28:31], s26 offen sc1
    buffer_store_dwordx2 v[172:173], v227, s[28:31], s27 offen sc1
    s_cmp_eq_u32 s52, 15
    s_cbranch_scc1 chain_kernel_j158
    buffer_store_dwordx4 v[164:167], v226, s[28:31], s26 offen offset:1024 sc1
    buffer_store_dwordx4 v[168:171], v226, s[28:31], s26 offen offset:2048 sc1
chain_kernel_j158:
    s_waitcnt vmcnt(0)
    v_mov_b32 v2, 1
    v_mov_b32 v7, 0
    s_mov_b64 exec, 1
    buffer_store_dword v2, v7, s[28:31], s15 offen sc1
    s_mov_b64 exec, -1
    buffer_load_dwordx4 a[160:163], v8, s[28:31], s55 offen offset:1024
    buffer_load_dwordx4 a[164:167], v8, s[28:31], s55 offen offset:2048
    buffer_load_dwordx4 a[168:171], v8, s[28:31], s55 offen offset:3072
    s_add_u32 s55, s55, 4096
    buffer_load_dwordx4 a[172:175], v8, s[28:31], s55 offen offset:0
    s_add_u32 s55, s55, 6144
    buffer_load_dwordx4 a[176:179], v8, s[28:31], s55 offen offset:0
    buffer_load_dwordx4 a[180:183], v8, s[28:31], s55 offen offset:1024
    buffer_load_dwordx4 a[184:187], v8, s[28:31], s55 offen offset:2048
    buffer_load_dwordx4 a[188:191], v8, s[28:31], s55 offen offset:3072
    s_add_u32 s55, s55, 4096
    buffer_load_dwordx4 a[192:195], v8, s[28:31], s55 offen offset:0
    s_add_u32 s55, s55, 6144
    buffer_load_dwordx4 a[196:199], v8, s[28:31], s55 offen offset:0
    buffer_load_dwordx4 a[200:203], v8, s[28:31], s55 offen offset:1024
    buffer_load_dwordx4 a[204:207], v8, s[28:31], s55 offen offset:2048
    buffer_load_dwordx4 a[208:211], v8, s[28:31], s55 offen offset:3072
    s_add_u32 s55, s55, 4096
    buffer_load_dwordx4 a[212:215], v8, s[28:31], s55 offen offset:0
    s_add_u32 s55, s55, 6144
    buffer_load_dwordx4 a[216:219], v8, s[28:31], s55 offen offset:0
    buffer_load_dwordx4 a[220:223], v8, s[28:31], s55 offen offset:1024
    buffer_load_dwordx4 a[224:227], v8, s[28:31], s55 offen offset:2048
    buffer_load_dwordx4 a[228:231], v8, s[28:31], s55 offen offset:3072
    s_add_u32 s55, s55, 4096
    buffer_load_dwordx4 a[232:235], v8, s[28:31], s55 offen offset:0
    s_add_u32 s55, s55, 6144
    buffer_load_dwordx4 a[236:239], v8, s[28:31], s55 offen offset:0
    buffer_load_dwordx4 a[240:243], v8, s[28:31], s55 offen offset:1024
    buffer_load_dwordx4 a[244:247], v8, s[28:31], s55 offen offset:2048
    buffer_load_dwordx4 a[248:251], v8, s[28:31], s55 offen offset:3072
    s_add_u32 s55, s55, 4096
    buffer_load_dwordx4 a[252:255], v8, s[28:31], s55 offen offset:0
    s_add_u32 s55, s55, 6144
    s_mul_i32 s26, s22, 5120
    v_add_u32 v12, s26, v8
    v_add_u32 v13, 0x10000, v12
    v_add_u32 v14, 0x20000, v12
    s_mov_b32 s47, 0
    s_mov_b64 exec, 511
chain_kernel_poll9:
    buffer_load_dword v2, v234, s[28:31], s48 offen sc1
    s_add_u32 s47, s47, 1
    s_waitcnt vmcnt(0)
    v_cmp_ne_u32 vcc, 1, v2
    s_cmp_ge_u32 s47, 20000
    s_cbranch_scc1 chain_kernel_polld10
    s_cbranch_vccnz chain_kernel_poll9
chain_kernel_polld10:
    s_mov_b64 exec, -1
    buffer_load_dwordx4 a[0:3], v8, s[28:31], s50 offen offset:0 sc1
    buffer_load_dwordx4 a[4:7], v8, s[28:31], s51 offen offset:0 sc1
    buffer_load_dwordx4 a[8:11], v8, s[28:31], s50 offen offset:1024 sc1
    buffer_load_dwordx4 a[12:15], v8, s[28:31], s51 offen offset:1024 sc1
    buffer_load_dwordx4 a[16:19], v8, s[28:31], s50 offen offset:2048 sc1
    buffer_load_dwordx4 a[20:23], v8, s[28:31], s51 offen offset:2048 sc1
    buffer_load_dwordx4 a[24:27], v8, s[28:31], s50 offen offset:3072 sc1
    buffer_load_dwordx4 a[28:31], v8, s[28:31], s51 offen offset:3072 sc1
    s_add_u32 s50, s50, 4096
    s_add_u32 s51, s51, 4096
    buffer_load_dwordx4 a[32:35], v8, s[28:31], s50 offen offset:0 sc1
    buffer_load_dwordx4 a[36:39], v8, s[28:31], s51 offen offset:0 sc1
    s_barrier
    ds_read_b128 v[136:139], v14 offset:12288
    ds_read_b128 v[140:143], v14 offset:13312
    ds_read_b128 v[144:147], v14 offset:14336
    ds_read_b128 v[148:151], v14 offset:15360
    ds_read_b128 v[152:155], v14 offset:16384
    ds_read_b128 v[156:159], v12 offset:0
    ds_read_b128 v[160:163], v12 offset:1024
    ds_read_b128 v[164:167], v12 offset:2048
    ds_read_b128 v[168:171], v12 offset:3072
    ds_read_b128 v[172:175], v12 offset:4096
    ds_read_b128 v[176:179], v12 offset:10240
    s_waitcnt vmcnt(8) lgkmcnt(6)
    v_mfma_f32_16x16x32_bf16 v[32:35], v[136:139], a[0:3], 0
    v_mfma_f32_16x16x32_bf16 v[52:55], v[136:139], a[4:7], 0
    ds_read_b128 v[180:183], v12 offset:11264
    buffer_load_dwordx4 a[40:43], v8, s[28:31], s50 offen offset:1024 sc1
    v_mfma_f32_16x16x32_bf16 v[36:39], v[140:143], a[0:3], 0
    v_mfma_f32_16x16x32_bf16 v[56:59], v[140:143], a[4:7], 0
    ds_read_b128 v[136:139], v12 offset:12288
    buffer_load_dwordx4 a[44:47], v8, s[28:31], s51 offen offset:1024 sc1
    v_mfma_f32_16x16x32_bf16 v[40:43], v[144:147], a[0:3], 0
    v_mfma_f32_16x16x32_bf16 v[60:63], v[144:147], a[4:7], 0
    ds_read_b128 v[140:143], v12 offset:13312
    buffer_load_dwordx4 a[48:51], v8, s[28:31], s50 offen offset:2048 sc1
    v_mfma_f32_16x16x32_bf16 v[44:47], v[148:151], a[0:3], 0
    v_mfma_f32_16x16x32_bf16 v[64:67], v[148:151], a[4:7], 0
    ds_read_b128 v[144:147], v12 offset:14336
    buffer_load_dwordx4 a[52:55], v8, s[28:31], s51 offen offset:2048 sc1
    v_mfma_f32_16x16x32_bf16 v[48:51], v[152:155], a[0:3], 0
    v_mfma_f32_16x16x32_bf16 v[68:71], v[152:155], a[4:7], 0
    ds_read_b128 v[148:151], v12 offset:20480
    buffer_load_dwordx4 a[56:59], v8, s[28:31], s50 offen offset:3072 sc1
    s_waitcnt vmcnt(11) lgkmcnt(6)
    v_mfma_f32_16x16x32_bf16 v[32:35], v[156:159], a[8:11], v[32:35]
    v_mfma_f32_16x16x32_bf16 v[52:55], v[156:159], a[12:15], v[52:55]
    ds_read_b128 v[152:155], v12 offset:21504
    buffer_load_dwordx4 a[60:63], v8, s[28:31], s51 offen offset:3072 sc1
    v_mfma_f32_16x16x32_bf16 v[36:39], v[160:163], a[8:11], v[36:39]
    v_mfma_f32_16x16x32_bf16 v[56:59], v[160:163], a[12:15], v[56:59]
    ds_read_b128 v[156:159], v12 offset:22528
    s_add_u32 s50, s50, 4096
    s_add_u32 s51, s51, 4096
    buffer_load_dwordx4 a[64:67], v8, s[28:31], s50 offen offset:0 sc1
    v_mfma_f32_16x16x32_bf16 v[40:43], v[164:167], a[8:11], v[40:43]
    v_mfma_f32_16x16x32_bf16 v[60:63], v[164:167], a[12:15], v[60:63]
    ds_read_b128 v[160:163], v12 offset:23552
    v_mfma_f32_16x16x32_bf16 v[44:47], v[168:171], a[8:11], v[44:47]
    v_mfma_f32_16x16x32_bf16 v[64:67], v[168:171], a[12:15], v[64:67]
    ds_read_b128 v[164:167], v12 offset:24576
    buffer_load_dwordx4 a[68:71], v8, s[28:31], s51 offen offset:0 sc1
    v_mfma_f32_16x16x32_bf16 v[48:51], v[172:175], a[8:11], v[48:51]
    v_mfma_f32_16x16x32_bf16 v[68:71], v[172:175], a[12:15], v[68:71]
    s_waitcnt lgkmcnt(5)
    s_barrier
    ds_read_b128 v[168:171], v12 offset:30720
    s_mul_i32 s25, s20, 3
    s_min_u32 s25, s25, 7
    s_lshl_b32 s25, s25, 10
    s_add_u32 s62, s25, 143360
    s_add_u32 s63, s25, s59
    s_add_u32 s63, s63, 163840
    s_mov_b32 m0, s62
    buffer_load_dwordx4 v8, s[28:31], s63 offen offset:0 lds
    s_waitcnt vmcnt(13) lgkmcnt(6)
    v_mfma_f32_16x16x32_bf16 v[32:35], v[176:179], a[16:19], v[32:35]
    v_mfma_f32_16x16x32_bf16 v[52:55], v[176:179], a[20:23], v[52:55]
    ds_read_b128 v[172:175], v12 offset:31744
    buffer_load_dwordx4 v8, s[28:31], s63 offen offset:1024 lds
    v_mfma_f32_16x16x32_bf16 v[36:39], v[180:183], a[16:19], v[36:39]
    v_mfma_f32_16x16x32_bf16 v[56:59], v[180:183], a[20:23], v[56:59]
    ds_read_b128 v[176:179], v12 offset:32768
    buffer_load_dwordx4 v8, s[28:31], s63 offen offset:2048 lds
    v_mfma_f32_16x16x32_bf16 v[40:43], v[136:139], a[16:19], v[40:43]
    v_mfma_f32_16x16x32_bf16 v[60:63], v[136:139], a[20:23], v[60:63]
    ds_read_b128 v[180:183], v12 offset:33792
    s_mul_i32 s25, s20, 5
    s_lshl_b32 s25, s25, 10
    s_add_u32 s62, s25, 0
    s_add_u32 s63, s25, s59
    s_add_u32 s63, s63, 174080
    s_mov_b32 m0, s62
    buffer_load_dwordx4 v8, s[28:31], s63 offen offset:0 lds
    v_mfma_f32_16x16x32_bf16 v[44:47], v[140:143], a[16:19], v[44:47]
    v_mfma_f32_16x16x32_bf16 v[64:67], v[140:143], a[20:23], v[64:67]
    ds_read_b128 v[136:139], v12 offset:34816
    buffer_load_dwordx4 v8, s[28:31], s63 offen offset:1024 lds
    v_mfma_f32_16x16x32_bf16 v[48:51], v[144:147], a[16:19], v[48:51]
    v_mfma_f32_16x16x32_bf16 v[68:71], v[144:147], a[20:23], v[68:71]
    ds_read_b128 v[140:143], v12 offset:40960
    buffer_load_dwordx4 v8, s[28:31], s63 offen offset:2048 lds
    s_waitcnt vmcnt(16) lgkmcnt(6)
    v_mfma_f32_16x16x32_bf16 v[32:35], v[148:151], a[24:27], v[32:35]
    v_mfma_f32_16x16x32_bf16 v[52:55], v[148:151], a[28:31], v[52:55]
    ds_read_b128 v[144:147], v12 offset:41984
    buffer_load_dwordx4 v8, s[28:31], s63 offen offset:3072 lds
    v_mfma_f32_16x16x32_bf16 v[36:39], v[152:155], a[24:27], v[36:39]
    v_mfma_f32_16x16x32_bf16 v[56:59], v[152:155], a[28:31], v[56:59]
    ds_read_b128 v[148:151], v12 offset:43008
    s_add_u32 s62, s62, 4096
    s_add_u32 s63, s63, 4096
    s_mov_b32 m0, s62
    buffer_load_dwordx4 v8, s[28:31], s63 offen offset:0 lds
    v_mfma_f32_16x16x32_bf16 v[40:43], v[156:159], a[24:27], v[40:43]
    v_mfma_f32_16x16x32_bf16 v[60:63], v[156:159], a[28:31], v[60:63]
    ds_read_b128 v[152:155], v12 offset:44032
    buffer_load_dwordx4 a[72:75], v8, s[28:31], s50 offen offset:1024 sc1
    v_mfma_f32_16x16x32_bf16 v[44:47], v[160:163], a[24:27], v[44:47]
    v_mfma_f32_16x16x32_bf16 v[64:67], v[160:163], a[28:31], v[64:67]
    ds_read_b128 v[156:159], v12 offset:45056
    buffer_load_dwordx4 a[76:79], v8, s[28:31], s51 offen offset:1024 sc1
    v_mfma_f32_16x16x32_bf16 v[48:51], v[164:167], a[24:27], v[48:51]
    v_mfma_f32_16x16x32_bf16 v[68:71], v[164:167], a[28:31], v[68:71]
    ds_read_b128 v[160:163], v12 offset:51200
    s_waitcnt vmcnt(18) lgkmcnt(6)
    v_mfma_f32_16x16x32_bf16 v[32:35], v[168:171], a[32:35], v[32:35]
    v_mfma_f32_16x16x32_bf16 v[52:55], v[168:171], a[36:39], v[52:55]
    ds_read_b128 v[164:167], v12 offset:52224
    buffer_load_dwordx4 a[80:83], v8, s[28:31], s50 offen offset:2048 sc1
    v_mfma_f32_16x16x32_bf16 v[36:39], v[172:175], a[32:35], v[36:39]
    v_mfma_f32_16x16x32_bf16 v[56:59], v[172:175], a[36:39], v[56:59]
    ds_read_b128 v[168:171], v12 offset:53248
    buffer_load_dwordx4 a[84:87], v8, s[28:31], s51 offen offset:2048 sc1
    v_mfma_f32_16x16x32_bf16 v[40:43], v[176:179], a[32:35], v[40:43]
    v_mfma_f32_16x16x32_bf16 v[60:63], v[176:179], a[36:39], v[60:63]
    ds_read_b128 v[172:175], v12 offset:54272
    buffer_load_dwordx4 a[88:91], v8, s[28:31], s50 offen offset:3072 sc1
    v_mfma_f32_16x16x32_bf16 v[44:47], v[180:183], a[32:35], v[44:47]
    v_mfma_f32_16x16x32_bf16 v[64:67], v[180:183], a[36:39], v[64:67]
    ds_read_b128 v[176:179], v12 offset:55296
    v_mfma_f32_16x16x32_bf16 v[48:51], v[136:139], a[32:35], v[48:51]
    v_mfma_f32_16x16x32_bf16 v[68:71], v[136:139], a[36:39], v[68:71]
    ds_read_b128 v[180:183], v12 offset:61440
    buffer_load_dwordx4 a[92:95], v8, s[28:31], s51 offen offset:3072 sc1
    s_waitcnt vmcnt(20) lgkmcnt(6)
    v_mfma_f32_16x16x32_bf16 v[32:35], v[140:143], a[40:43], v[32:35]
    v_mfma_f32_16x16x32_bf16 v[52:55], v[140:143], a[44:47], v[52:55]
    ds_read_b128 v[136:139], v12 offset:62464
    v_mfma_f32_16x16x32_bf16 v[36:39], v[144:147], a[40:43], v[36:39]
    v_mfma_f32_16x16x32_bf16 v[56:59], v[144:147], a[44:47], v[56:59]
    ds_read_b128 v[140:143], v12 offset:63488
    s_add_u32 s50, s50, 4096
    s_add_u32 s51, s51, 4096
    buffer_load_dwordx4 a[0:3], v8, s[28:31], s50 offen offset:0 sc1
    v_mfma_f32_16x16x32_bf16 v[40:43], v[148:151], a[40:43], v[40:43]
    v_mfma_f32_16x16x32_bf16 v[60:63], v[148:151], a[44:47], v[60:63]
    ds_read_b128 v[144:147], v12 offset:64512
    v_mfma_f32_16x16x32_bf16 v[44:47], v[152:155], a[40:43], v[44:47]
    v_mfma_f32_16x16x32_bf16 v[64:67], v[152:155], a[44:47], v[64:67]
    ds_read_b128 v[148:151], v13 offset:0
    buffer_load_dwordx4 a[4:7], v8, s[28:31], s51 offen offset:0 sc1
    v_mfma_f32_16x16x32_bf16 v[48:51], v[156:159], a[40:43], v[48:51]
    v_mfma_f32_16x16x32_bf16 v[68:71], v[156:159], a[44:47], v[68:71]
    ds_read_b128 v[152:155], v13 offset:6144
    s_waitcnt vmcnt(20) lgkmcnt(6)
    v_mfma_f32_16x16x32_bf16 v[32:35], v[160:163], a[48:51], v[32:35]
    v_mfma_f32_16x16x32_bf16 v[52:55], v[160:163], a[52:55], v[52:55]
    ds_read_b128 v[156:159], v13 offset:7168
    buffer_load_dwordx4 a[8:11], v8, s[28:31], s50 offen offset:1024 sc1
    v_mfma_f32_16x16x32_bf16 v[36:39], v[164:167], a[48:51], v[36:39]
    v_mfma_f32_16x16x32_bf16 v[56:59], v[164:167], a[52:55], v[56:59]
    ds_read_b128 v[160:163], v13 offset:8192
    v_mfma_f32_16x16x32_bf16 v[40:43], v[168:171], a[48:51], v[40:43]
    v_mfma_f32_16x16x32_bf16 v[60:63], v[168:171], a[52:55], v[60:63]
    ds_read_b128 v[164:167], v13 offset:9216
    buffer_load_dwordx4 a[12:15], v8, s[28:31], s51 offen offset:1024 sc1
    v_mfma_f32_16x16x32_bf16 v[44:47], v[172:175], a[48:51], v[44:47]
    v_mfma_f32_16x16x32_bf16 v[64:67], v[172:175], a[52:55], v[64:67]
    ds_read_b128 v[168:171], v13 offset:10240
    v_mfma_f32_16x16x32_bf16 v[48:51], v[176:179], a[48:51], v[48:51]
    v_mfma_f32_16x16x32_bf16 v[68:71], v[176:179], a[52:55], v[68:71]
    ds_read_b128 v[172:175], v14 offset:22528
    buffer_load_dwordx4 a[16:19], v8, s[28:31], s50 offen offset:2048 sc1
    s_waitcnt vmcnt(21) lgkmcnt(6)
    v_mfma_f32_16x16x32_bf16 v[32:35], v[180:183], a[56:59], v[32:35]
    v_mfma_f32_16x16x32_bf16 v[52:55], v[180:183], a[60:63], v[52:55]
    ds_read_b128 v[176:179], v14 offset:23552
    v_mfma_f32_16x16x32_bf16 v[36:39], v[136:139], a[56:59], v[36:39]
    v_mfma_f32_16x16x32_bf16 v[56:59], v[136:139], a[60:63], v[56:59]
    ds_read_b128 v[180:183], v14 offset:24576
    buffer_load_dwordx4 a[20:23], v8, s[28:31], s51 offen offset:2048 sc1
    v_mfma_f32_16x16x32_bf16 v[40:43], v[140:143], a[56:59], v[40:43]
    v_mfma_f32_16x16x32_bf16 v[60:63], v[140:143], a[60:63], v[60:63]
    ds_read_b128 v[136:139], v14 offset:25600
    v_mfma_f32_16x16x32_bf16 v[44:47], v[144:147], a[56:59], v[44:47]
    v_mfma_f32_16x16x32_bf16 v[64:67], v[144:147], a[60:63], v[64:67]
    ds_read_b128 v[140:143], v14 offset:26624
    buffer_load_dwordx4 a[24:27], v8, s[28:31], s50 offen offset:3072 sc1
    v_mfma_f32_16x16x32_bf16 v[48:51], v[148:151], a[56:59], v[48:51]
    v_mfma_f32_16x16x32_bf16 v[68:71], v[148:151], a[60:63], v[68:71]
    ds_read_b128 v[144:147], v13 offset:57344
    s_waitcnt vmcnt(21) lgkmcnt(6)
    v_mfma_f32_16x16x32_bf16 v[32:35], v[152:155], a[64:67], v[32:35]
    v_mfma_f32_16x16x32_bf16 v[52:55], v[152:155], a[68:71], v[52:55]
    ds_read_b128 v[148:151], v13 offset:58368
    buffer_load_dwordx4 a[28:31], v8, s[28:31], s51 offen offset:3072 sc1
    v_mfma_f32_16x16x32_bf16 v[36:39], v[156:159], a[64:67], v[36:39]
    v_mfma_f32_16x16x32_bf16 v[56:59], v[156:159], a[68:71], v[56:59]
    ds_read_b128 v[152:155], v13 offset:59392
    s_add_u32 s50, s50, 4096
    s_add_u32 s51, s51, 4096
    buffer_load_dwordx4 a[32:35], v8, s[28:31], s50 offen offset:0 sc1
    v_mfma_f32_16x16x32_bf16 v[40:43], v[160:163], a[64:67], v[40:43]
    v_mfma_f32_16x16x32_bf16 v[60:63], v[160:163], a[68:71], v[60:63]
    ds_read_b128 v[156:159], v13 offset:60416
    buffer_load_dwordx4 a[36:39], v8, s[28:31], s51 offen offset:0 sc1
    v_mfma_f32_16x16x32_bf16 v[44:47], v[164:167], a[64:67], v[44:47]
    v_mfma_f32_16x16x32_bf16 v[64:67], v[164:167], a[68:71], v[64:67]
    ds_read_b128 v[160:163], v13 offset:61440
    buffer_load_dwordx4 a[40:43], v8, s[28:31], s50 offen offset:1024 sc1
    v_mfma_f32_16x16x32_bf16 v[48:51], v[168:171], a[64:67], v[48:51]
    v_mfma_f32_16x16x32_bf16 v[68:71], v[168:171], a[68:71], v[68:71]
    ds_read_b128 v[164:167], v14 offset:2048
    buffer_load_dwordx4 a[44:47], v8, s[28:31], s51 offen offset:1024 sc1
    s_waitcnt vmcnt(16) lgkmcnt(6)
    v_mfma_f32_16x16x32_bf16 v[32:35], v[172:175], a[72:75], v[32:35]
    v_mfma_f32_16x16x32_bf16 v[52:55], v[172:175], a[76:79], v[52:55]
    ds_read_b128 v[168:171], v14 offset:3072
    s_add_u32 s26, s44, 13406208
    buffer_load_dwordx2 v[96:97], v230, s[28:31], s26 offen sc1
    v_mfma_f32_16x16x32_bf16 v[36:39], v[176:179], a[72:75], v[36:39]
    v_mfma_f32_16x16x32_bf16 v[56:59], v[176:179], a[76:79], v[56:59]
    ds_read_b128 v[172:175], v14 offset:4096
    s_add_u32 s26, s44, 13406720
    buffer_load_dwordx2 v[98:99], v230, s[28:31], s26 offen sc1
    v_mfma_f32_16x16x32_bf16 v[40:43], v[180:183], a[72:75], v[40:43]
    v_mfma_f32_16x16x32_bf16 v[60:63], v[180:183], a[76:79], v[60:63]
    ds_read_b128 v[176:179], v14 offset:5120
    v_mfma_f32_16x16x32_bf16 v[44:47], v[136:139], a[72:75], v[44:47]
    v_mfma_f32_16x16x32_bf16 v[64:67], v[136:139], a[76:79], v[64:67]
    ds_read_b128 v[180:183], v14 offset:6144
    s_add_u32 s26, s44, 13407232
    buffer_load_dwordx2 v[100:101], v230, s[28:31], s26 offen sc1
    v_mfma_f32_16x16x32_bf16 v[48:51], v[140:143], a[72:75], v[48:51]
    v_mfma_f32_16x16x32_bf16 v[68:71], v[140:143], a[76:79], v[68:71]
    ds_read_b128 v[136:139], v13 offset:16384
    s_waitcnt vmcnt(17) lgkmcnt(6)
    v_mfma_f32_16x16x32_bf16 v[32:35], v[144:147], a[80:83], v[32:35]
    v_mfma_f32_16x16x32_bf16 v[52:55], v[144:147], a[84:87], v[52:55]
    ds_read_b128 v[140:143], v13 offset:17408
    s_add_u32 s26, s44, 13407744
    buffer_load_dwordx2 v[102:103], v230, s[28:31], s26 offen sc1
    v_mfma_f32_16x16x32_bf16 v[36:39], v[148:151], a[80:83], v[36:39]
    v_mfma_f32_16x16x32_bf16 v[56:59], v[148:151], a[84:87], v[56:59]
    ds_read_b128 v[144:147], v13 offset:18432
    v_mfma_f32_16x16x32_bf16 v[40:43], v[152:155], a[80:83], v[40:43]
    v_mfma_f32_16x16x32_bf16 v[60:63], v[152:155], a[84:87], v[60:63]
    ds_read_b128 v[148:151], v13 offset:19456
    s_add_u32 s26, s45, 13406208
    buffer_load_dwordx2 v[104:105], v230, s[28:31], s26 offen sc1
    v_mfma_f32_16x16x32_bf16 v[44:47], v[156:159], a[80:83], v[44:47]
    v_mfma_f32_16x16x32_bf16 v[64:67], v[156:159], a[84:87], v[64:67]
    ds_read_b128 v[152:155], v13 offset:20480
    v_mfma_f32_16x16x32_bf16 v[48:51], v[160:163], a[80:83], v[48:51]
    v_mfma_f32_16x16x32_bf16 v[68:71], v[160:163], a[84:87], v[68:71]
    ds_read_b128 v[156:159], v13 offset:26624
    buffer_load_dwordx4 a[48:51], v8, s[28:31], s50 offen offset:2048 sc1
    s_waitcnt vmcnt(18) lgkmcnt(6)
    v_mfma_f32_16x16x32_bf16 v[32:35], v[164:167], a[88:91], v[32:35]
    v_mfma_f32_16x16x32_bf16 v[52:55], v[164:167], a[92:95], v[52:55]
    ds_read_b128 v[160:163], v13 offset:27648
    v_mfma_f32_16x16x32_bf16 v[36:39], v[168:171], a[88:91], v[36:39]
    v_mfma_f32_16x16x32_bf16 v[56:59], v[168:171], a[92:95], v[56:59]
    ds_read_b128 v[164:167], v13 offset:28672
    buffer_load_dwordx4 a[52:55], v8, s[28:31], s51 offen offset:2048 sc1
    v_mfma_f32_16x16x32_bf16 v[40:43], v[172:175], a[88:91], v[40:43]
    v_mfma_f32_16x16x32_bf16 v[60:63], v[172:175], a[92:95], v[60:63]
    ds_read_b128 v[168:171], v13 offset:29696
    v_mfma_f32_16x16x32_bf16 v[44:47], v[176:179], a[88:91], v[44:47]
    v_mfma_f32_16x16x32_bf16 v[64:67], v[176:179], a[92:95], v[64:67]
    ds_read_b128 v[172:175], v13 offset:30720
    buffer_load_dwordx4 a[56:59], v8, s[28:31], s50 offen offset:3072 sc1
    v_mfma_f32_16x16x32_bf16 v[48:51], v[180:183], a[88:91], v[48:51]
    v_mfma_f32_16x16x32_bf16 v[68:71], v[180:183], a[92:95], v[68:71]
    ds_read_b128 v[176:179], v13 offset:36864
    s_waitcnt vmcnt(18) lgkmcnt(6)
    v_mfma_f32_16x16x32_bf16 v[32:35], v[136:139], a[0:3], v[32:35]
    v_mfma_f32_16x16x32_bf16 v[52:55], v[136:139], a[4:7], v[52:55]
    ds_read_b128 v[180:183], v13 offset:37888
    buffer_load_dwordx4 a[60:63], v8, s[28:31], s51 offen offset:3072 sc1
    v_mfma_f32_16x16x32_bf16 v[36:39], v[140:143], a[0:3], v[36:39]
    v_mfma_f32_16x16x32_bf16 v[56:59], v[140:143], a[4:7], v[56:59]
    ds_read_b128 v[136:139], v13 offset:38912
    v_mfma_f32_16x16x32_bf16 v[40:43], v[144:147], a[0:3], v[40:43]
    v_mfma_f32_16x16x32_bf16 v[60:63], v[144:147], a[4:7], v[60:63]
    ds_read_b128 v[140:143], v13 offset:39936
    s_add_u32 s50, s50, 4096
    s_add_u32 s51, s51, 4096
    buffer_load_dwordx4 a[64:67], v8, s[28:31], s50 offen offset:0 sc1
    v_mfma_f32_16x16x32_bf16 v[44:47], v[148:151], a[0:3], v[44:47]
    v_mfma_f32_16x16x32_bf16 v[64:67], v[148:151], a[4:7], v[64:67]
    ds_read_b128 v[144:147], v13 offset:40960
    v_mfma_f32_16x16x32_bf16 v[48:51], v[152:155], a[0:3], v[48:51]
    v_mfma_f32_16x16x32_bf16 v[68:71], v[152:155], a[4:7], v[68:71]
    ds_read_b128 v[148:151], v13 offset:47104
    buffer_load_dwordx4 a[68:71], v8, s[28:31], s51 offen offset:0 sc1
    s_waitcnt vmcnt(19) lgkmcnt(6)
    v_mfma_f32_16x16x32_bf16 v[32:35], v[156:159], a[8:11], v[32:35]
    v_mfma_f32_16x16x32_bf16 v[52:55], v[156:159], a[12:15], v[52:55]
    ds_read_b128 v[152:155], v13 offset:48128
    v_mfma_f32_16x16x32_bf16 v[36:39], v[160:163], a[8:11], v[36:39]
    v_mfma_f32_16x16x32_bf16 v[56:59], v[160:163], a[12:15], v[56:59]
    ds_read_b128 v[156:159], v13 offset:49152
    buffer_load_dwordx4 a[72:75], v8, s[28:31], s50 offen offset:1024 sc1
    v_mfma_f32_16x16x32_bf16 v[40:43], v[164:167], a[8:11], v[40:43]
    v_mfma_f32_16x16x32_bf16 v[60:63], v[164:167], a[12:15], v[60:63]
    ds_read_b128 v[160:163], v13 offset:50176
    v_mfma_f32_16x16x32_bf16 v[44:47], v[168:171], a[8:11], v[44:47]
    v_mfma_f32_16x16x32_bf16 v[64:67], v[168:171], a[12:15], v[64:67]
    ds_read_b128 v[164:167], v13 offset:51200
    buffer_load_dwordx4 a[76:79], v8, s[28:31], s51 offen offset:1024 sc1
    v_mfma_f32_16x16x32_bf16 v[48:51], v[172:175], a[8:11], v[48:51]
    v_mfma_f32_16x16x32_bf16 v[68:71], v[172:175], a[12:15], v[68:71]
    s_barrier
    ds_read_b128 v[168:171], v14 offset:12288
    s_waitcnt vmcnt(19) lgkmcnt(6)
    v_mfma_f32_16x16x32_bf16 v[32:35], v[176:179], a[16:19], v[32:35]
    v_mfma_f32_16x16x32_bf16 v[52:55], v[176:179], a[20:23], v[52:55]
    ds_read_b128 v[172:175], v14 offset:13312
    buffer_load_dwordx4 a[80:83], v8, s[28:31], s50 offen offset:2048 sc1
    v_mfma_f32_16x16x32_bf16 v[36:39], v[180:183], a[16:19], v[36:39]
    v_mfma_f32_16x16x32_bf16 v[56:59], v[180:183], a[20:23], v[56:59]
    ds_read_b128 v[176:179], v14 offset:14336
    v_mfma_f32_16x16x32_bf16 v[40:43], v[136:139], a[16:19], v[40:43]
    v_mfma_f32_16x16x32_bf16 v[60:63], v[136:139], a[20:23], v[60:63]
    ds_read_b128 v[180:183], v14 offset:15360
    buffer_load_dwordx4 a[84:87], v8, s[28:31], s51 offen offset:2048 sc1
    v_mfma_f32_16x16x32_bf16 v[44:47], v[140:143], a[16:19], v[44:47]
    v_mfma_f32_16x16x32_bf16 v[64:67], v[140:143], a[20:23], v[64:67]
    ds_read_b128 v[136:139], v14 offset:16384
    v_mfma_f32_16x16x32_bf16 v[48:51], v[144:147], a[16:19], v[48:51]
    v_mfma_f32_16x16x32_bf16 v[68:71], v[144:147], a[20:23], v[68:71]
    ds_read_b128 v[140:143], v12 offset:0
    buffer_load_dwordx4 a[88:91], v8, s[28:31], s50 offen offset:3072 sc1
    s_waitcnt vmcnt(20) lgkmcnt(6)
    v_mfma_f32_16x16x32_bf16 v[32:35], v[148:151], a[24:27], v[32:35]
    v_mfma_f32_16x16x32_bf16 v[52:55], v[148:151], a[28:31], v[52:55]
    ds_read_b128 v[144:147], v12 offset:1024
    v_mfma_f32_16x16x32_bf16 v[36:39], v[152:155], a[24:27], v[36:39]
    v_mfma_f32_16x16x32_bf16 v[56:59], v[152:155], a[28:31], v[56:59]
    ds_read_b128 v[148:151], v12 offset:2048
    buffer_load_dwordx4 a[92:95], v8, s[28:31], s51 offen offset:3072 sc1
    v_mfma_f32_16x16x32_bf16 v[40:43], v[156:159], a[24:27], v[40:43]
    v_mfma_f32_16x16x32_bf16 v[60:63], v[156:159], a[28:31], v[60:63]
    ds_read_b128 v[152:155], v12 offset:3072
    v_mfma_f32_16x16x32_bf16 v[44:47], v[160:163], a[24:27], v[44:47]
    v_mfma_f32_16x16x32_bf16 v[64:67], v[160:163], a[28:31], v[64:67]
    ds_read_b128 v[156:159], v12 offset:4096
    s_add_u32 s50, s50, 4096
    s_add_u32 s51, s51, 4096
    buffer_load_dwordx4 a[0:3], v8, s[28:31], s50 offen offset:0 sc1
    v_mfma_f32_16x16x32_bf16 v[48:51], v[164:167], a[24:27], v[48:51]
    v_mfma_f32_16x16x32_bf16 v[68:71], v[164:167], a[28:31], v[68:71]
    ds_read_b128 v[160:163], v12 offset:10240
    s_waitcnt vmcnt(20) lgkmcnt(6)
    v_mfma_f32_16x16x32_bf16 v[32:35], v[168:171], a[32:35], v[32:35]
    v_mfma_f32_16x16x32_bf16 v[52:55], v[168:171], a[36:39], v[52:55]
    ds_read_b128 v[164:167], v12 offset:11264
    buffer_load_dwordx4 a[4:7], v8, s[28:31], s51 offen offset:0 sc1
    v_mfma_f32_16x16x32_bf16 v[36:39], v[172:175], a[32:35], v[36:39]
    v_mfma_f32_16x16x32_bf16 v[56:59], v[172:175], a[36:39], v[56:59]
    ds_read_b128 v[168:171], v12 offset:12288
    v_mfma_f32_16x16x32_bf16 v[40:43], v[176:179], a[32:35], v[40:43]
    v_mfma_f32_16x16x32_bf16 v[60:63], v[176:179], a[36:39], v[60:63]
    ds_read_b128 v[172:175], v12 offset:13312
    buffer_load_dwordx4 a[8:11], v8, s[28:31], s50 offen offset:1024 sc1
    v_mfma_f32_16x16x32_bf16 v[44:47], v[180:183], a[32:35], v[44:47]
    v_mfma_f32_16x16x32_bf16 v[64:67], v[180:183], a[36:39], v[64:67]
    ds_read_b128 v[176:179], v12 offset:14336
    v_mfma_f32_16x16x32_bf16 v[48:51], v[136:139], a[32:35], v[48:51]
    v_mfma_f32_16x16x32_bf16 v[68:71], v[136:139], a[36:39], v[68:71]
    buffer_load_dwordx4 a[12:15], v8, s[28:31], s51 offen offset:1024 sc1
    s_waitcnt vmcnt(21) lgkmcnt(5)
    v_mfma_f32_16x16x32_bf16 v[32:35], v[140:143], a[40:43], v[32:35]
    v_mfma_f32_16x16x32_bf16 v[52:55], v[140:143], a[44:47], v[52:55]
    v_mfma_f32_16x16x32_bf16 v[36:39], v[144:147], a[40:43], v[36:39]
    v_mfma_f32_16x16x32_bf16 v[56:59], v[144:147], a[44:47], v[56:59]
    buffer_load_dwordx4 a[16:19], v8, s[28:31], s50 offen offset:2048 sc1
    v_mfma_f32_16x16x32_bf16 v[40:43], v[148:151], a[40:43], v[40:43]
    v_mfma_f32_16x16x32_bf16 v[60:63], v[148:151], a[44:47], v[60:63]
    v_mfma_f32_16x16x32_bf16 v[44:47], v[152:155], a[40:43], v[44:47]
    v_mfma_f32_16x16x32_bf16 v[64:67], v[152:155], a[44:47], v[64:67]
    buffer_load_dwordx4 a[20:23], v8, s[28:31], s51 offen offset:2048 sc1
    v_mfma_f32_16x16x32_bf16 v[48:51], v[156:159], a[40:43], v[48:51]
    v_mfma_f32_16x16x32_bf16 v[68:71], v[156:159], a[44:47], v[68:71]
    s_waitcnt vmcnt(16) lgkmcnt(0)
    v_mfma_f32_16x16x32_bf16 v[32:35], v[160:163], a[48:51], v[32:35]
    v_mfma_f32_16x16x32_bf16 v[52:55], v[160:163], a[52:55], v[52:55]
    v_mfma_f32_16x16x32_bf16 v[36:39], v[164:167], a[48:51], v[36:39]
    v_mfma_f32_16x16x32_bf16 v[56:59], v[164:167], a[52:55], v[56:59]
    v_mfma_f32_16x16x32_bf16 v[40:43], v[168:171], a[48:51], v[40:43]
    v_mfma_f32_16x16x32_bf16 v[60:63], v[168:171], a[52:55], v[60:63]
    v_mfma_f32_16x16x32_bf16 v[44:47], v[172:175], a[48:51], v[44:47]
    v_mfma_f32_16x16x32_bf16 v[64:67], v[172:175], a[52:55], v[64:67]
    v_mfma_f32_16x16x32_bf16 v[48:51], v[176:179], a[48:51], v[48:51]
    v_mfma_f32_16x16x32_bf16 v[68:71], v[176:179], a[52:55], v[68:71]
    s_waitcnt vmcnt(14)
    v_mfma_f32_16x16x32_bf16 v[32:35], a[96:99], a[56:59], v[32:35]
    v_mfma_f32_16x16x32_bf16 v[52:55], a[96:99], a[60:63], v[52:55]
    v_mfma_f32_16x16x32_bf16 v[36:39], a[100:103], a[56:59], v[36:39]
    v_mfma_f32_16x16x32_bf16 v[56:59], a[100:103], a[60:63], v[56:59]
    v_mfma_f32_16x16x32_bf16 v[40:43], a[104:107], a[56:59], v[40:43]
    v_mfma_f32_16x16x32_bf16 v[60:63], a[104:107], a[60:63], v[60:63]
    v_mfma_f32_16x16x32_bf16 v[44:47], a[108:111], a[56:59], v[44:47]
    v_mfma_f32_16x16x32_bf16 v[64:67], a[108:111], a[60:63], v[64:67]
    v_mfma_f32_16x16x32_bf16 v[48:51], a[112:115], a[56:59], v[48:51]
    v_mfma_f32_16x16x32_bf16 v[68:71], a[112:115], a[60:63], v[68:71]
    s_waitcnt vmcnt(12)
    v_mfma_f32_16x16x32_bf16 v[32:35], a[116:119], a[64:67], v[32:35]
    v_mfma_f32_16x16x32_bf16 v[52:55], a[116:119], a[68:71], v[52:55]
    v_mfma_f32_16x16x32_bf16 v[36:39], a[120:123], a[64:67], v[36:39]
    v_mfma_f32_16x16x32_bf16 v[56:59], a[120:123], a[68:71], v[56:59]
    v_mfma_f32_16x16x32_bf16 v[40:43], a[124:127], a[64:67], v[40:43]
    v_mfma_f32_16x16x32_bf16 v[60:63], a[124:127], a[68:71], v[60:63]
    v_mfma_f32_16x16x32_bf16 v[44:47], a[128:131], a[64:67], v[44:47]
    v_mfma_f32_16x16x32_bf16 v[64:67], a[128:131], a[68:71], v[64:67]
    v_mfma_f32_16x16x32_bf16 v[48:51], a[132:135], a[64:67], v[48:51]
    v_mfma_f32_16x16x32_bf16 v[68:71], a[132:135], a[68:71], v[68:71]
    s_waitcnt vmcnt(10)
    v_mfma_f32_16x16x32_bf16 v[32:35], a[136:139], a[72:75], v[32:35]
    v_mfma_f32_16x16x32_bf16 v[52:55], a[136:139], a[76:79], v[52:55]
    v_mfma_f32_16x16x32_bf16 v[36:39], a[140:143], a[72:75], v[36:39]
    v_mfma_f32_16x16x32_bf16 v[56:59], a[140:143], a[76:79], v[56:59]
    v_mfma_f32_16x16x32_bf16 v[40:43], a[144:147], a[72:75], v[40:43]
    v_mfma_f32_16x16x32_bf16 v[60:63], a[144:147], a[76:79], v[60:63]
    v_mfma_f32_16x16x32_bf16 v[44:47], a[148:151], a[72:75], v[44:47]
    v_mfma_f32_16x16x32_bf16 v[64:67], a[148:151], a[76:79], v[64:67]
    v_mfma_f32_16x16x32_bf16 v[48:51], a[152:155], a[72:75], v[48:51]
    v_mfma_f32_16x16x32_bf16 v[68:71], a[152:155], a[76:79], v[68:71]
    s_waitcnt vmcnt(8)
    v_mfma_f32_16x16x32_bf16 v[32:35], a[156:159], a[80:83], v[32:35]
    v_mfma_f32_16x16x32_bf16 v[52:55], a[156:159], a[84:87], v[52:55]
    v_mfma_f32_16x16x32_bf16 v[36:39], a[160:163], a[80:83], v[36:39]
    v_mfma_f32_16x16x32_bf16 v[56:59], a[160:163], a[84:87], v[56:59]
    v_mfma_f32_16x16x32_bf16 v[40:43], a[164:167], a[80:83], v[40:43]
    v_mfma_f32_16x16x32_bf16 v[60:63], a[164:167], a[84:87], v[60:63]
    v_mfma_f32_16x16x32_bf16 v[44:47], a[168:171], a[80:83], v[44:47]
    v_mfma_f32_16x16x32_bf16 v[64:67], a[168:171], a[84:87], v[64:67]
    v_mfma_f32_16x16x32_bf16 v[48:51], a[172:175], a[80:83], v[48:51]
    v_mfma_f32_16x16x32_bf16 v[68:71], a[172:175], a[84:87], v[68:71]
    s_waitcnt vmcnt(6)
    v_mfma_f32_16x16x32_bf16 v[32:35], a[176:179], a[88:91], v[32:35]
    v_mfma_f32_16x16x32_bf16 v[52:55], a[176:179], a[92:95], v[52:55]
    v_mfma_f32_16x16x32_bf16 v[36:39], a[180:183], a[88:91], v[36:39]
    v_mfma_f32_16x16x32_bf16 v[56:59], a[180:183], a[92:95], v[56:59]
    v_mfma_f32_16x16x32_bf16 v[40:43], a[184:187], a[88:91], v[40:43]
    v_mfma_f32_16x16x32_bf16 v[60:63], a[184:187], a[92:95], v[60:63]
    v_mfma_f32_16x16x32_bf16 v[44:47], a[188:191], a[88:91], v[44:47]
    v_mfma_f32_16x16x32_bf16 v[64:67], a[188:191], a[92:95], v[64:67]
    v_mfma_f32_16x16x32_bf16 v[48:51], a[192:195], a[88:91], v[48:51]
    v_mfma_f32_16x16x32_bf16 v[68:71], a[192:195], a[92:95], v[68:71]
    s_waitcnt vmcnt(4)
    v_mfma_f32_16x16x32_bf16 v[32:35], a[196:199], a[0:3], v[32:35]
    v_mfma_f32_16x16x32_bf16 v[52:55], a[196:199], a[4:7], v[52:55]
    v_mfma_f32_16x16x32_bf16 v[36:39], a[200:203], a[0:3], v[36:39]
    v_mfma_f32_16x16x32_bf16 v[56:59], a[200:203], a[4:7], v[56:59]
    v_mfma_f32_16x16x32_bf16 v[40:43], a[204:207], a[0:3], v[40:43]
    v_mfma_f32_16x16x32_bf16 v[60:63], a[204:207], a[4:7], v[60:63]
    v_mfma_f32_16x16x32_bf16 v[44:47], a[208:211], a[0:3], v[44:47]
    v_mfma_f32_16x16x32_bf16 v[64:67], a[208:211], a[4:7], v[64:67]
    v_mfma_f32_16x16x32_bf16 v[48:51], a[212:215], a[0:3], v[48:51]
    v_mfma_f32_16x16x32_bf16 v[68:71], a[212:215], a[4:7], v[68:71]
    s_waitcnt vmcnt(2)
    v_mfma_f32_16x16x32_bf16 v[32:35], a[216:219], a[8:11], v[32:35]
    v_mfma_f32_16x16x32_bf16 v[52:55], a[216:219], a[12:15], v[52:55]
    v_mfma_f32_16x16x32_bf16 v[36:39], a[220:223], a[8:11], v[36:39]
    v_mfma_f32_16x16x32_bf16 v[56:59], a[220:223], a[12:15], v[56:59]
    v_mfma_f32_16x16x32_bf16 v[40:43], a[224:227], a[8:11], v[40:43]
    v_mfma_f32_16x16x32_bf16 v[60:63], a[224:227], a[12:15], v[60:63]
    v_mfma_f32_16x16x32_bf16 v[44:47], a[228:231], a[8:11], v[44:47]
    v_mfma_f32_16x16x32_bf16 v[64:67], a[228:231], a[12:15], v[64:67]
    v_mfma_f32_16x16x32_bf16 v[48:51], a[232:235], a[8:11], v[48:51]
    v_mfma_f32_16x16x32_bf16 v[68:71], a[232:235], a[12:15], v[68:71]
    s_waitcnt vmcnt(0)
    v_mfma_f32_16x16x32_bf16 v[32:35], a[236:239], a[16:19], v[32:35]
    v_mfma_f32_16x16x32_bf16 v[52:55], a[236:239], a[20:23], v[52:55]
    v_mfma_f32_16x16x32_bf16 v[36:39], a[240:243], a[16:19], v[36:39]
    v_mfma_f32_16x16x32_bf16 v[56:59], a[240:243], a[20:23], v[56:59]
    v_mfma_f32_16x16x32_bf16 v[40:43], a[244:247], a[16:19], v[40:43]
    v_mfma_f32_16x16x32_bf16 v[60:63], a[244:247], a[20:23], v[60:63]
    v_mfma_f32_16x16x32_bf16 v[44:47], a[248:251], a[16:19], v[44:47]
    v_mfma_f32_16x16x32_bf16 v[64:67], a[248:251], a[20:23], v[64:67]
    v_mfma_f32_16x16x32_bf16 v[48:51], a[252:255], a[16:19], v[48:51]
    v_mfma_f32_16x16x32_bf16 v[68:71], a[252:255], a[20:23], v[68:71]
    s_barrier
    s_nop 4
    ds_write_b128 v246, v[52:55] offset:0
    ds_write_b128 v246, v[56:59] offset:1024
    ds_write_b128 v246, v[60:63] offset:2048
    ds_write_b128 v246, v[64:67] offset:3072
    ds_write_b128 v246, v[68:71] offset:4096
    v_lshlrev_b32 v136, 16, v96
    v_and_b32 v137, 0xffff0000, v96
    v_lshlrev_b32 v138, 16, v97
    v_and_b32 v139, 0xffff0000, v97
    v_lshlrev_b32 v156, 16, v116
    v_and_b32 v157, 0xffff0000, v116
    v_lshlrev_b32 v158, 16, v117
    v_and_b32 v159, 0xffff0000, v117
    v_lshlrev_b32 v140, 16, v98
    v_and_b32 v141, 0xffff0000, v98
    v_lshlrev_b32 v142, 16, v99
    v_and_b32 v143, 0xffff0000, v99
    v_lshlrev_b32 v160, 16, v118
    v_and_b32 v161, 0xffff0000, v118
    v_lshlrev_b32 v162, 16, v119
    v_and_b32 v163, 0xffff0000, v119
    v_lshlrev_b32 v144, 16, v100
    v_and_b32 v145, 0xffff0000, v100
    v_lshlrev_b32 v146, 16, v101
    v_and_b32 v147, 0xffff0000, v101
    v_lshlrev_b32 v164, 16, v120
    v_and_b32 v165, 0xffff0000, v120
    v_lshlrev_b32 v166, 16, v121
    v_and_b32 v167, 0xffff0000, v121
    v_lshlrev_b32 v148, 16, v102
    v_and_b32 v149, 0xffff0000, v102
    v_lshlrev_b32 v150, 16, v103
    v_and_b32 v151, 0xffff0000, v103
    v_lshlrev_b32 v168, 16, v122
    v_and_b32 v169, 0xffff0000, v122
    v_lshlrev_b32 v170, 16, v123
    v_and_b32 v171, 0xffff0000, v123
    v_lshlrev_b32 v152, 16, v104
    v_and_b32 v153, 0xffff0000, v104
    v_lshlrev_b32 v154, 16, v105
    v_and_b32 v155, 0xffff0000, v105
    v_lshlrev_b32 v172, 16, v124
    v_and_b32 v173, 0xffff0000, v124
    v_lshlrev_b32 v174, 16, v125
    v_and_b32 v175, 0xffff0000, v125
    v_pk_add_f32 v[32:33], v[32:33], v[136:137]
    v_pk_add_f32 v[34:35], v[34:35], v[138:139]
    v_pk_add_f32 v[36:37], v[36:37], v[140:141]
    v_pk_add_f32 v[38:39], v[38:39], v[142:143]
    v_pk_add_f32 v[40:41], v[40:41], v[144:145]
    v_pk_add_f32 v[42:43], v[42:43], v[146:147]
    v_pk_add_f32 v[44:45], v[44:45], v[148:149]
    v_pk_add_f32 v[46:47], v[46:47], v[150:151]
    v_pk_add_f32 v[48:49], v[48:49], v[152:153]
    v_pk_add_f32 v[50:51], v[50:51], v[154:155]
    s_waitcnt lgkmcnt(0)
    s_barrier
    ds_read_b128 v[72:75], v247 offset:0
    ds_read_b128 v[76:79], v247 offset:1024
    ds_read_b128 v[80:83], v247 offset:2048
    ds_read_b128 v[84:87], v247 offset:3072
    ds_read_b128 v[88:91], v247 offset:4096
    s_waitcnt lgkmcnt(4)
    v_pk_add_f32 v[32:33], v[32:33], v[72:73]
    v_pk_add_f32 v[34:35], v[34:35], v[74:75]
    v_pk_fma_f32 v[32:33], v[32:33], v[204:205], v[156:157]
    v_pk_fma_f32 v[34:35], v[34:35], v[206:207], v[158:159]
    v_cvt_pk_bf16_f32 v180, v32, v33
    v_cvt_pk_bf16_f32 v181, v34, v35
    s_waitcnt lgkmcnt(3)
    v_pk_add_f32 v[36:37], v[36:37], v[76:77]
    v_pk_add_f32 v[38:39], v[38:39], v[78:79]
    v_pk_fma_f32 v[36:37], v[36:37], v[208:209], v[160:161]
    v_pk_fma_f32 v[38:39], v[38:39], v[210:211], v[162:163]
    v_cvt_pk_bf16_f32 v182, v36, v37
    v_cvt_pk_bf16_f32 v183, v38, v39
    s_waitcnt lgkmcnt(2)
    v_pk_add_f32 v[40:41], v[40:41], v[80:81]
    v_pk_add_f32 v[42:43], v[42:43], v[82:83]
    v_pk_fma_f32 v[40:41], v[40:41], v[212:213], v[164:165]
    v_pk_fma_f32 v[42:43], v[42:43], v[214:215], v[166:167]
    v_cvt_pk_bf16_f32 v184, v40, v41
    v_cvt_pk_bf16_f32 v185, v42, v43
    s_waitcnt lgkmcnt(1)
    v_pk_add_f32 v[44:45], v[44:45], v[84:85]
    v_pk_add_f32 v[46:47], v[46:47], v[86:87]
    v_pk_fma_f32 v[44:45], v[44:45], v[216:217], v[168:169]
    v_pk_fma_f32 v[46:47], v[46:47], v[218:219], v[170:171]
    v_cvt_pk_bf16_f32 v186, v44, v45
    v_cvt_pk_bf16_f32 v187, v46, v47
    s_waitcnt lgkmcnt(0)
    v_pk_add_f32 v[48:49], v[48:49], v[88:89]
    v_pk_add_f32 v[50:51], v[50:51], v[90:91]
    v_pk_fma_f32 v[48:49], v[48:49], v[220:221], v[172:173]
    v_pk_fma_f32 v[50:51], v[50:51], v[222:223], v[174:175]
    v_cvt_pk_bf16_f32 v188, v48, v49
    v_cvt_pk_bf16_f32 v189, v50, v51
    s_nop 1
    v_permlane16_swap_b32 v180, v182
    v_permlane16_swap_b32 v181, v183
    v_permlane16_swap_b32 v184, v186
    v_permlane16_swap_b32 v185, v187
    buffer_store_dwordx4 v[180:183], v231, s[32:35], s46 offen sc1
    buffer_store_dwordx4 v[184:187], v231, s[32:35], s46 offen offset:64 sc1
    buffer_store_dwordx2 v[188:189], v232, s[32:35], s49 offen sc1
    s_endpgm
chain_end:
    s_endpgm
.section .rodata,"a"
.p2align 6
.amdhsa_kernel prep_kernel
  .amdhsa_next_free_vgpr 256
  .amdhsa_next_free_sgpr 100
  .amdhsa_accum_offset 256
  .amdhsa_group_segment_fixed_size 0
  .amdhsa_kernarg_size 128
  .amdhsa_user_sgpr_count 2
  .amdhsa_user_sgpr_kernarg_segment_ptr 1
  .amdhsa_system_sgpr_workgroup_id_x 1
  .amdhsa_float_denorm_mode_32 3
.end_amdhsa_kernel
.p2align 6
.amdhsa_kernel chain_kernel
  .amdhsa_next_free_vgpr 512
  .amdhsa_next_free_sgpr 100
  .amdhsa_accum_offset 256
  .amdhsa_group_segment_fixed_size 0
  .amdhsa_kernarg_size 128
  .amdhsa_user_sgpr_count 2
  .amdhsa_user_sgpr_kernarg_segment_ptr 1
  .amdhsa_system_sgpr_workgroup_id_x 1
  .amdhsa_float_denorm_mode_32 3
.end_amdhsa_kernel
```

```asm
; @launch kernel=prep_kernel grid=(512,1,1) block=(512,1,1) lds=88064
; @launch kernel=chain_kernel grid=(256,1,1) block=(256,1,1) lds=163840
.amdgcn_target "amdgcn-amd-amdhsa--gfx950"
.text
.globl prep_kernel
.p2align 8
.type prep_kernel,@function
prep_kernel:
    s_cmp_ge_u32 s2, 512
    s_cbranch_scc1 prep_end
    s_load_dwordx4 s[4:7], s[0:1], 8
    s_load_dwordx2 s[8:9], s[0:1], 24
    s_load_dwordx2 s[10:11], s[0:1], 120
    s_load_dwordx8 s[12:19], s[0:1], 56
    s_load_dwordx2 s[60:61], s[0:1], 0
    s_load_dwordx2 s[62:63], s[0:1], 96
    s_load_dwordx2 s[52:53], s[0:1], 88
    s_load_dwordx2 s[54:55], s[0:1], 112
    s_load_dwordx4 s[56:59], s[0:1], 32
    s_memrealtime s[64:65]
    v_lshrrev_b32 v2, 6, v0
    v_and_b32 v1, 63, v0
    v_readfirstlane_b32 s20, v2
    s_waitcnt lgkmcnt(0)
    s_mov_b32 s28, s10
    s_mov_b32 s29, s11
    s_mov_b32 s30, 268435456
    s_mov_b32 s31, 0x00020000
    s_mov_b32 s48, s54
    s_mov_b32 s49, s55
    s_mov_b32 s50, 256
    s_mov_b32 s51, 0x00020000
    s_cmp_ge_u32 s2, 416
    s_cbranch_scc1 p_pack
    s_cmp_ge_u32 s2, 256
    s_cbranch_scc1 p_conv
    s_cmp_ge_u32 s2, 160
    s_cbranch_scc1 p_aux
    s_or_b32 s21, s2, s20
    s_cmp_lg_u32 s21, 0
    s_cbranch_scc1 prep_kernel_n01
    s_or_b32 s64, s64, 1
    v_mov_b32 v3, s64
    v_mov_b32 v4, 0
    s_mov_b64 exec, 1
    buffer_store_dword v3, v4, s[48:51], 0 offen sc1
    s_mov_b64 exec, -1
prep_kernel_n01:
    s_mov_b32 s45, s20
    s_mov_b32 s16, s4
    s_mov_b32 s17, s5
    s_mov_b32 s18, 2621440
    s_mov_b32 s19, 0x00020000
    s_mov_b32 s20, s6
    s_mov_b32 s21, s7
    s_mov_b32 s22, 2621440
    s_mov_b32 s23, 0x00020000
    s_mov_b32 s24, s8
    s_mov_b32 s25, s9
    s_mov_b32 s26, 5120
    s_mov_b32 s27, 0x00020000
    s_lshr_b32 s47, s45, 2
    s_lshl_b32 s46, s2, 1
    s_add_u32 s46, s46, s47
    v_and_b32 v0, 255, v0
    s_mul_i32 s32, s46, 52429
    s_lshr_b32 s32, s32, 19
    s_mul_i32 s33, s32, 10
    s_sub_u32 s33, s46, s33
    s_lshl_b32 s43, s47, 13
    v_and_b32 v1, 15, v0
    v_lshrrev_b32 v2, 4, v0
    s_lshl_b32 s34, s32, 6
    v_lshl_add_u32 v3, v2, 2, s34
    v_mul_u32_u24 v4, 1280, v3
    s_lshl_b32 s35, s33, 7
    v_lshl_add_u32 v5, v1, 3, s35
    v_add_u32 v4, v4, v5
    v_subrev_u32 v6, 3840, v4
    v_subrev_u32 v7, 2560, v4
    v_subrev_u32 v8, 1280, v4
    buffer_load_dwordx2 v[10:11], v6, s[16:19], 0 offen nt
    buffer_load_dwordx2 v[12:13], v7, s[16:19], 0 offen nt
    buffer_load_dwordx2 v[14:15], v8, s[16:19], 0 offen nt
    buffer_load_dwordx2 v[16:17], v4, s[16:19], 0 offen offset:0 nt
    buffer_load_dwordx2 v[18:19], v4, s[16:19], 0 offen offset:1280 nt
    buffer_load_dwordx2 v[20:21], v4, s[16:19], 0 offen offset:2560 nt
    buffer_load_dwordx2 v[22:23], v4, s[16:19], 0 offen offset:3840 nt
    v_lshlrev_b32 v100, 2, v5
    buffer_load_dwordx4 v[32:35], v100, s[24:27], 0 offen
    buffer_load_dwordx4 v[36:39], v100, s[24:27], 0 offen offset:16
    buffer_load_dwordx2 v[24:25], v4, s[20:23], 0 offen offset:0 nt
    buffer_load_dwordx2 v[26:27], v4, s[20:23], 0 offen offset:1280 nt
    buffer_load_dwordx2 v[28:29], v4, s[20:23], 0 offen offset:2560 nt
    buffer_load_dwordx2 v[30:31], v4, s[20:23], 0 offen offset:3840 nt
    v_lshlrev_b32 v100, 9, v1
    v_sub_u32 v101, 15, v2
    v_lshl_add_u32 v100, v101, 3, v100
    v_add_u32 v100, s43, v100
    v_lshrrev_b32 v101, 3, v0
    v_mul_u32_u24 v101, 4352, v101
    v_and_b32 v102, 7, v0
    v_lshl_add_u32 v103, v102, 4, v101
    v_lshlrev_b32 v104, 4, v0
    v_add_u32 v104, s43, v104
    s_mul_i32 s36, s33, 278528
    s_lshr_b32 s37, s32, 1
    s_mul_i32 s37, s37, 272
    s_add_u32 s36, s36, s37
    s_add_u32 s36, s36, 0
    s_and_b32 s37, s32, 1
    s_lshl_b32 s38, s37, 7
    s_sub_u32 s38, 128, s38
    s_add_u32 s38, s38, s36
    s_lshl_b32 s44, s33, 5
    s_add_u32 s44, s44, s32
    s_lshl_b32 s44, s44, 7
    s_add_u32 s44, s44, 29642752
    s_waitcnt vmcnt(4)
    v_mov_b32 v123, 0
    buffer_load_dword v122, v123, s[48:51], 0 offen sc1
    v_lshlrev_b32 v40, 16, v32
    v_and_b32 v44, 0xffff0000, v32
    v_lshlrev_b32 v48, 16, v33
    v_and_b32 v52, 0xffff0000, v33
    v_lshlrev_b32 v41, 16, v34
    v_and_b32 v45, 0xffff0000, v34
    v_lshlrev_b32 v49, 16, v35
    v_and_b32 v53, 0xffff0000, v35
    v_lshlrev_b32 v42, 16, v36
    v_and_b32 v46, 0xffff0000, v36
    v_lshlrev_b32 v50, 16, v37
    v_and_b32 v54, 0xffff0000, v37
    v_lshlrev_b32 v43, 16, v38
    v_and_b32 v47, 0xffff0000, v38
    v_lshlrev_b32 v51, 16, v39
    v_and_b32 v55, 0xffff0000, v39
    v_lshlrev_b32 v56, 16, v10
    v_and_b32 v57, 0xffff0000, v10
    v_lshlrev_b32 v58, 16, v11
    v_and_b32 v59, 0xffff0000, v11
    v_lshlrev_b32 v60, 16, v12
    v_and_b32 v61, 0xffff0000, v12
    v_lshlrev_b32 v62, 16, v13
    v_and_b32 v63, 0xffff0000, v13
    v_lshlrev_b32 v64, 16, v14
    v_and_b32 v65, 0xffff0000, v14
    v_lshlrev_b32 v66, 16, v15
    v_and_b32 v67, 0xffff0000, v15
    v_lshlrev_b32 v68, 16, v16
    v_and_b32 v69, 0xffff0000, v16
    v_lshlrev_b32 v70, 16, v17
    v_and_b32 v71, 0xffff0000, v17
    v_lshlrev_b32 v72, 16, v18
    v_and_b32 v73, 0xffff0000, v18
    v_lshlrev_b32 v74, 16, v19
    v_and_b32 v75, 0xffff0000, v19
    v_lshlrev_b32 v76, 16, v20
    v_and_b32 v77, 0xffff0000, v20
    v_lshlrev_b32 v78, 16, v21
    v_and_b32 v79, 0xffff0000, v21
    v_lshlrev_b32 v80, 16, v22
    v_and_b32 v81, 0xffff0000, v22
    v_lshlrev_b32 v82, 16, v23
    v_and_b32 v83, 0xffff0000, v23
    v_pk_mul_f32 v[84:85], v[56:57], v[52:53]
    v_pk_mul_f32 v[86:87], v[58:59], v[54:55]
    v_pk_mul_f32 v[88:89], v[60:61], v[52:53]
    v_pk_mul_f32 v[90:91], v[62:63], v[54:55]
    v_pk_mul_f32 v[92:93], v[64:65], v[52:53]
    v_pk_mul_f32 v[94:95], v[66:67], v[54:55]
    v_pk_mul_f32 v[96:97], v[68:69], v[52:53]
    v_pk_mul_f32 v[98:99], v[70:71], v[54:55]
    v_pk_fma_f32 v[84:85], v[60:61], v[48:49], v[84:85]
    v_pk_fma_f32 v[86:87], v[62:63], v[50:51], v[86:87]
    v_pk_fma_f32 v[88:89], v[64:65], v[48:49], v[88:89]
    v_pk_fma_f32 v[90:91], v[66:67], v[50:51], v[90:91]
    v_pk_fma_f32 v[92:93], v[68:69], v[48:49], v[92:93]
    v_pk_fma_f32 v[94:95], v[70:71], v[50:51], v[94:95]
    v_pk_fma_f32 v[96:97], v[72:73], v[48:49], v[96:97]
    v_pk_fma_f32 v[98:99], v[74:75], v[50:51], v[98:99]
    v_pk_fma_f32 v[84:85], v[64:65], v[44:45], v[84:85]
    v_pk_fma_f32 v[86:87], v[66:67], v[46:47], v[86:87]
    v_pk_fma_f32 v[88:89], v[68:69], v[44:45], v[88:89]
    v_pk_fma_f32 v[90:91], v[70:71], v[46:47], v[90:91]
    v_pk_fma_f32 v[92:93], v[72:73], v[44:45], v[92:93]
    v_pk_fma_f32 v[94:95], v[74:75], v[46:47], v[94:95]
    v_pk_fma_f32 v[96:97], v[76:77], v[44:45], v[96:97]
    v_pk_fma_f32 v[98:99], v[78:79], v[46:47], v[98:99]
    v_pk_fma_f32 v[84:85], v[68:69], v[40:41], v[84:85]
    v_pk_fma_f32 v[86:87], v[70:71], v[42:43], v[86:87]
    v_pk_fma_f32 v[88:89], v[72:73], v[40:41], v[88:89]
    v_pk_fma_f32 v[90:91], v[74:75], v[42:43], v[90:91]
    v_pk_fma_f32 v[92:93], v[76:77], v[40:41], v[92:93]
    v_pk_fma_f32 v[94:95], v[78:79], v[42:43], v[94:95]
    v_pk_fma_f32 v[96:97], v[80:81], v[40:41], v[96:97]
    v_pk_fma_f32 v[98:99], v[82:83], v[42:43], v[98:99]
    v_cvt_pk_bf16_f32 v56, v84, v85
    v_cvt_pk_bf16_f32 v57, v86, v87
    v_cvt_pk_bf16_f32 v58, v88, v89
    v_cvt_pk_bf16_f32 v59, v90, v91
    v_cvt_pk_bf16_f32 v60, v92, v93
    v_cvt_pk_bf16_f32 v61, v94, v95
    v_cvt_pk_bf16_f32 v62, v96, v97
    v_cvt_pk_bf16_f32 v63, v98, v99
    s_waitcnt vmcnt(1)
    v_lshlrev_b32 v84, 16, v56
    v_and_b32 v85, 0xffff0000, v56
    v_lshlrev_b32 v86, 16, v57
    v_and_b32 v87, 0xffff0000, v57
    v_lshlrev_b32 v88, 16, v58
    v_and_b32 v89, 0xffff0000, v58
    v_lshlrev_b32 v90, 16, v59
    v_and_b32 v91, 0xffff0000, v59
    v_lshlrev_b32 v92, 16, v60
    v_and_b32 v93, 0xffff0000, v60
    v_lshlrev_b32 v94, 16, v61
    v_and_b32 v95, 0xffff0000, v61
    v_lshlrev_b32 v96, 16, v62
    v_and_b32 v97, 0xffff0000, v62
    v_lshlrev_b32 v98, 16, v63
    v_and_b32 v99, 0xffff0000, v63
    v_lshlrev_b32 v64, 16, v24
    v_and_b32 v65, 0xffff0000, v24
    v_pk_mul_f32 v[84:85], v[84:85], v[64:65]
    v_lshlrev_b32 v66, 16, v25
    v_and_b32 v67, 0xffff0000, v25
    v_pk_mul_f32 v[86:87], v[86:87], v[66:67]
    v_lshlrev_b32 v68, 16, v26
    v_and_b32 v69, 0xffff0000, v26
    v_pk_mul_f32 v[88:89], v[88:89], v[68:69]
    v_lshlrev_b32 v70, 16, v27
    v_and_b32 v71, 0xffff0000, v27
    v_pk_mul_f32 v[90:91], v[90:91], v[70:71]
    v_lshlrev_b32 v64, 16, v28
    v_and_b32 v65, 0xffff0000, v28
    v_pk_mul_f32 v[92:93], v[92:93], v[64:65]
    v_lshlrev_b32 v66, 16, v29
    v_and_b32 v67, 0xffff0000, v29
    v_pk_mul_f32 v[94:95], v[94:95], v[66:67]
    v_lshlrev_b32 v68, 16, v30
    v_and_b32 v69, 0xffff0000, v30
    v_pk_mul_f32 v[96:97], v[96:97], v[68:69]
    v_lshlrev_b32 v70, 16, v31
    v_and_b32 v71, 0xffff0000, v31
    v_pk_mul_f32 v[98:99], v[98:99], v[70:71]
    v_cvt_pk_bf16_f32 v64, v96, v92
    v_cvt_pk_bf16_f32 v65, v88, v84
    v_cvt_pk_bf16_f32 v66, v97, v93
    v_cvt_pk_bf16_f32 v67, v89, v85
    v_cvt_pk_bf16_f32 v68, v98, v94
    v_cvt_pk_bf16_f32 v69, v90, v86
    v_cvt_pk_bf16_f32 v70, v99, v95
    v_cvt_pk_bf16_f32 v71, v91, v87
    ds_write_b64 v100, v[64:65] offset:0
    ds_write_b64 v100, v[66:67] offset:128
    ds_write_b64 v100, v[68:69] offset:256
    ds_write_b64 v100, v[70:71] offset:384
    s_waitcnt lgkmcnt(0)
    s_barrier
    ds_read_b128 v[10:13], v104 offset:0
    ds_read_b128 v[14:17], v104 offset:4096
    s_waitcnt lgkmcnt(1)
    buffer_store_dwordx4 v[10:13], v103, s[28:31], s38 offen sc1
    s_add_u32 s38, s38, 139264
    s_waitcnt lgkmcnt(0)
    buffer_store_dwordx4 v[14:17], v103, s[28:31], s38 offen sc1
    s_add_u32 s38, s38, 139264
    v_cmp_eq_u32 vcc, 0, v102
    s_and_saveexec_b64 s[66:67], vcc
    s_cmp_eq_u32 s37, 0
    s_cbranch_scc1 prep_kernel_L2
    s_cmp_eq_u32 s32, 31
    s_cbranch_scc1 prep_kernel_L3
    buffer_store_dwordx4 v[10:13], v101, s[28:31], s36 offen offset:528 sc1
    s_add_u32 s36, s36, 139264
    buffer_store_dwordx4 v[14:17], v101, s[28:31], s36 offen offset:528 sc1
    s_add_u32 s36, s36, 139264
    s_branch prep_kernel_L3
prep_kernel_L2:
    s_cmp_lg_u32 s32, 0
    s_cbranch_scc1 prep_kernel_L3
    v_mov_b32 v108, 0
    v_mov_b32 v109, 0
    v_mov_b32 v110, 0
    v_mov_b32 v111, 0
    buffer_store_dwordx4 v[108:111], v101, s[28:31], s36 offen offset:256 sc1
    s_add_u32 s36, s36, 139264
    buffer_store_dwordx4 v[108:111], v101, s[28:31], s36 offen offset:256 sc1
    s_add_u32 s36, s36, 139264
prep_kernel_L3:
    s_mov_b64 exec, -1
    s_waitcnt vmcnt(0)
    s_barrier
    s_and_b32 s45, s45, 3
    s_cmp_lg_u32 s45, 0
    s_cbranch_scc1 prep_end
    s_mov_b32 s47, 0
prep_kernel_nn4:
    v_readfirstlane_b32 s46, v122
    s_add_u32 s47, s47, 1
    s_cmp_lg_u32 s46, 0
    s_cbranch_scc1 prep_kernel_nd5
    s_cmp_ge_u32 s47, 200000
    s_cbranch_scc1 prep_kernel_nd5
    buffer_load_dword v122, v123, s[48:51], 0 offen sc1
    s_waitcnt vmcnt(0)
    s_branch prep_kernel_nn4
prep_kernel_nd5:
    v_mov_b32 v124, s46
    v_mov_b32 v125, 0
    s_mov_b64 exec, 1
    buffer_store_dword v124, v125, s[28:31], s44 offen sc1
    s_endpgm
prep_end:
    s_endpgm
p_aux:
    v_mov_b32 v251, 0
    buffer_load_dword v250, v251, s[48:51], 0 offen sc1
    s_sub_u32 s21, s2, 160
    s_cmp_ge_u32 s20, 6
    s_cbranch_scc1 prep_end
    s_cmp_ge_u32 s20, 3
    s_cbranch_scc1 p_misc
    s_cmp_eq_u32 s20, 0
    s_cbranch_scc1 p_st
    s_cmp_eq_u32 s20, 2
    s_cbranch_scc1 p_aux2
    s_add_u32 s21, s21, 96
    s_cmp_lt_u32 s21, 128
    s_cbranch_scc1 p_st
    s_sub_u32 s21, s21, 128
    s_branch p_mod
p_aux2:
    s_cmp_ge_u32 s21, 56
    s_cbranch_scc1 prep_end
    s_add_u32 s21, s21, 64
p_mod:
    s_lshr_b32 s32, s21, 2
    s_and_b32 s33, s21, 3
    v_lshrrev_b32 v4, 3, v1
    v_and_b32 v3, 7, v1
    s_mul_i32 s34, s33, 160
    v_add_u32 v4, s34, v4
    v_lshlrev_b32 v5, 1, v4
    v_mul_u32_u24 v6, 7680, v4
    s_lshl_b32 s36, s32, 7
    v_lshl_add_u32 v7, v3, 4, s36
    v_add_u32 v6, v6, v7
    s_mov_b32 s16, s52
    s_mov_b32 s17, s53
    s_mov_b32 s18, 1280
    s_mov_b32 s19, 0x00020000
    s_mov_b32 s24, s62
    s_mov_b32 s25, s63
    s_mov_b32 s26, 4915200
    s_mov_b32 s27, 0x00020000
    s_mul_i32 s35, s33, 320
    v_lshlrev_b32 v5, 3, v1
    buffer_load_dwordx2 v[30:31], v5, s[16:19], s35 offen
    s_mov_b32 s37, 0
    buffer_load_dwordx4 v[32:35], v6, s[24:27], s37 offen nt
    s_add_u32 s37, s37, 61440
    buffer_load_dwordx4 v[36:39], v6, s[24:27], s37 offen nt
    s_add_u32 s37, s37, 61440
    buffer_load_dwordx4 v[40:43], v6, s[24:27], s37 offen nt
    s_add_u32 s37, s37, 61440
    buffer_load_dwordx4 v[44:47], v6, s[24:27], s37 offen nt
    s_add_u32 s37, s37, 61440
    buffer_load_dwordx4 v[48:51], v6, s[24:27], s37 offen nt
    s_add_u32 s37, s37, 61440
    buffer_load_dwordx4 v[52:55], v6, s[24:27], s37 offen nt
    s_add_u32 s37, s37, 61440
    buffer_load_dwordx4 v[56:59], v6, s[24:27], s37 offen nt
    s_add_u32 s37, s37, 61440
    buffer_load_dwordx4 v[60:63], v6, s[24:27], s37 offen nt
    s_add_u32 s37, s37, 61440
    buffer_load_dwordx4 v[64:67], v6, s[24:27], s37 offen nt
    s_add_u32 s37, s37, 61440
    buffer_load_dwordx4 v[68:71], v6, s[24:27], s37 offen nt
    s_add_u32 s37, s37, 61440
    buffer_load_dwordx4 v[72:75], v6, s[24:27], s37 offen nt
    s_add_u32 s37, s37, 61440
    buffer_load_dwordx4 v[76:79], v6, s[24:27], s37 offen nt
    s_add_u32 s37, s37, 61440
    buffer_load_dwordx4 v[80:83], v6, s[24:27], s37 offen nt
    s_add_u32 s37, s37, 61440
    buffer_load_dwordx4 v[84:87], v6, s[24:27], s37 offen nt
    s_add_u32 s37, s37, 61440
    buffer_load_dwordx4 v[88:91], v6, s[24:27], s37 offen nt
    s_add_u32 s37, s37, 61440
    buffer_load_dwordx4 v[92:95], v6, s[24:27], s37 offen nt
    s_add_u32 s37, s37, 61440
    buffer_load_dwordx4 v[96:99], v6, s[24:27], s37 offen nt
    s_add_u32 s37, s37, 61440
    buffer_load_dwordx4 v[100:103], v6, s[24:27], s37 offen nt
    s_add_u32 s37, s37, 61440
    buffer_load_dwordx4 v[104:107], v6, s[24:27], s37 offen nt
    s_add_u32 s37, s37, 61440
    buffer_load_dwordx4 v[108:111], v6, s[24:27], s37 offen nt
    s_mul_i32 s35, s20, 13824
    v_lshlrev_b32 v5, 4, v1
    v_add_u32 v5, s35, v5
    v_lshrrev_b32 v29, 3, v1
    v_lshlrev_b32 v29, 2, v29
    v_add_u32 v29, s35, v29
    s_waitcnt vmcnt(20)
    v_lshlrev_b32 v8, 16, v30
    v_and_b32 v9, 0xffff0000, v30
    v_lshlrev_b32 v10, 16, v31
    v_and_b32 v11, 0xffff0000, v31
    v_mul_f32 v120, 0xbfb8aa3b, v8
    v_mul_f32 v121, 0xbfb8aa3b, v9
    v_mul_f32 v122, 0xbfb8aa3b, v10
    v_mul_f32 v123, 0xbfb8aa3b, v11
    v_exp_f32 v120, v120
    v_exp_f32 v121, v121
    v_exp_f32 v122, v122
    v_exp_f32 v123, v123
    v_add_f32 v120, 1.0, v120
    v_add_f32 v121, 1.0, v121
    v_add_f32 v122, 1.0, v122
    v_add_f32 v123, 1.0, v123
    v_rcp_f32 v120, v120
    v_rcp_f32 v121, v121
    v_rcp_f32 v122, v122
    v_rcp_f32 v123, v123
    s_nop 0
    v_mul_f32 v8, v8, v120
    v_mul_f32 v9, v9, v121
    v_mul_f32 v10, v10, v122
    v_mul_f32 v11, v11, v123
    v_cvt_pk_bf16_f32 v120, v8, v9
    v_lshlrev_b32 v8, 16, v120
    v_and_b32 v9, 0xffff0000, v120
    v_cvt_pk_bf16_f32 v120, v10, v11
    v_lshlrev_b32 v10, 16, v120
    v_and_b32 v11, 0xffff0000, v120
    ds_write_b128 v5, v[8:11]
    s_waitcnt lgkmcnt(0)
    ds_read_b32 v8, v29 offset:0
    ds_read_b32 v9, v29 offset:32
    ds_read_b32 v10, v29 offset:64
    ds_read_b32 v11, v29 offset:96
    ds_read_b32 v12, v29 offset:128
    ds_read_b32 v13, v29 offset:160
    ds_read_b32 v14, v29 offset:192
    ds_read_b32 v15, v29 offset:224
    ds_read_b32 v16, v29 offset:256
    ds_read_b32 v17, v29 offset:288
    ds_read_b32 v18, v29 offset:320
    ds_read_b32 v19, v29 offset:352
    ds_read_b32 v20, v29 offset:384
    ds_read_b32 v21, v29 offset:416
    ds_read_b32 v22, v29 offset:448
    ds_read_b32 v23, v29 offset:480
    ds_read_b32 v24, v29 offset:512
    ds_read_b32 v25, v29 offset:544
    ds_read_b32 v26, v29 offset:576
    ds_read_b32 v27, v29 offset:608
    s_waitcnt lgkmcnt(0)
    v_mov_b32 v112, 0
    v_mov_b32 v113, 0
    v_mov_b32 v114, 0
    v_mov_b32 v115, 0
    v_mov_b32 v116, 0
    v_mov_b32 v117, 0
    v_mov_b32 v118, 0
    v_mov_b32 v119, 0
    s_waitcnt vmcnt(19)
    v_lshlrev_b32 v120, 16, v32
    v_and_b32 v121, 0xffff0000, v32
    v_lshlrev_b32 v122, 16, v33
    v_and_b32 v123, 0xffff0000, v33
    v_lshlrev_b32 v124, 16, v34
    v_and_b32 v125, 0xffff0000, v34
    v_lshlrev_b32 v126, 16, v35
    v_and_b32 v127, 0xffff0000, v35
    v_pk_fma_f32 v[112:113], v[120:121], v[8:9], v[112:113] op_sel:[0,0,0] op_sel_hi:[1,0,1]
    v_pk_fma_f32 v[114:115], v[122:123], v[8:9], v[114:115] op_sel:[0,0,0] op_sel_hi:[1,0,1]
    v_pk_fma_f32 v[116:117], v[124:125], v[8:9], v[116:117] op_sel:[0,0,0] op_sel_hi:[1,0,1]
    v_pk_fma_f32 v[118:119], v[126:127], v[8:9], v[118:119] op_sel:[0,0,0] op_sel_hi:[1,0,1]
    s_waitcnt vmcnt(18)
    v_lshlrev_b32 v120, 16, v36
    v_and_b32 v121, 0xffff0000, v36
    v_lshlrev_b32 v122, 16, v37
    v_and_b32 v123, 0xffff0000, v37
    v_lshlrev_b32 v124, 16, v38
    v_and_b32 v125, 0xffff0000, v38
    v_lshlrev_b32 v126, 16, v39
    v_and_b32 v127, 0xffff0000, v39
    v_pk_fma_f32 v[112:113], v[120:121], v[8:9], v[112:113] op_sel:[0,1,0] op_sel_hi:[1,1,1]
    v_pk_fma_f32 v[114:115], v[122:123], v[8:9], v[114:115] op_sel:[0,1,0] op_sel_hi:[1,1,1]
    v_pk_fma_f32 v[116:117], v[124:125], v[8:9], v[116:117] op_sel:[0,1,0] op_sel_hi:[1,1,1]
    v_pk_fma_f32 v[118:119], v[126:127], v[8:9], v[118:119] op_sel:[0,1,0] op_sel_hi:[1,1,1]
    s_waitcnt vmcnt(17)
    v_lshlrev_b32 v120, 16, v40
    v_and_b32 v121, 0xffff0000, v40
    v_lshlrev_b32 v122, 16, v41
    v_and_b32 v123, 0xffff0000, v41
    v_lshlrev_b32 v124, 16, v42
    v_and_b32 v125, 0xffff0000, v42
    v_lshlrev_b32 v126, 16, v43
    v_and_b32 v127, 0xffff0000, v43
    v_pk_fma_f32 v[112:113], v[120:121], v[10:11], v[112:113] op_sel:[0,0,0] op_sel_hi:[1,0,1]
    v_pk_fma_f32 v[114:115], v[122:123], v[10:11], v[114:115] op_sel:[0,0,0] op_sel_hi:[1,0,1]
    v_pk_fma_f32 v[116:117], v[124:125], v[10:11], v[116:117] op_sel:[0,0,0] op_sel_hi:[1,0,1]
    v_pk_fma_f32 v[118:119], v[126:127], v[10:11], v[118:119] op_sel:[0,0,0] op_sel_hi:[1,0,1]
    s_waitcnt vmcnt(16)
    v_lshlrev_b32 v120, 16, v44
    v_and_b32 v121, 0xffff0000, v44
    v_lshlrev_b32 v122, 16, v45
    v_and_b32 v123, 0xffff0000, v45
    v_lshlrev_b32 v124, 16, v46
    v_and_b32 v125, 0xffff0000, v46
    v_lshlrev_b32 v126, 16, v47
    v_and_b32 v127, 0xffff0000, v47
    v_pk_fma_f32 v[112:113], v[120:121], v[10:11], v[112:113] op_sel:[0,1,0] op_sel_hi:[1,1,1]
    v_pk_fma_f32 v[114:115], v[122:123], v[10:11], v[114:115] op_sel:[0,1,0] op_sel_hi:[1,1,1]
    v_pk_fma_f32 v[116:117], v[124:125], v[10:11], v[116:117] op_sel:[0,1,0] op_sel_hi:[1,1,1]
    v_pk_fma_f32 v[118:119], v[126:127], v[10:11], v[118:119] op_sel:[0,1,0] op_sel_hi:[1,1,1]
    s_waitcnt vmcnt(15)
    v_lshlrev_b32 v120, 16, v48
    v_and_b32 v121, 0xffff0000, v48
    v_lshlrev_b32 v122, 16, v49
    v_and_b32 v123, 0xffff0000, v49
    v_lshlrev_b32 v124, 16, v50
    v_and_b32 v125, 0xffff0000, v50
    v_lshlrev_b32 v126, 16, v51
    v_and_b32 v127, 0xffff0000, v51
    v_pk_fma_f32 v[112:113], v[120:121], v[12:13], v[112:113] op_sel:[0,0,0] op_sel_hi:[1,0,1]
    v_pk_fma_f32 v[114:115], v[122:123], v[12:13], v[114:115] op_sel:[0,0,0] op_sel_hi:[1,0,1]
    v_pk_fma_f32 v[116:117], v[124:125], v[12:13], v[116:117] op_sel:[0,0,0] op_sel_hi:[1,0,1]
    v_pk_fma_f32 v[118:119], v[126:127], v[12:13], v[118:119] op_sel:[0,0,0] op_sel_hi:[1,0,1]
    s_waitcnt vmcnt(14)
    v_lshlrev_b32 v120, 16, v52
    v_and_b32 v121, 0xffff0000, v52
    v_lshlrev_b32 v122, 16, v53
    v_and_b32 v123, 0xffff0000, v53
    v_lshlrev_b32 v124, 16, v54
    v_and_b32 v125, 0xffff0000, v54
    v_lshlrev_b32 v126, 16, v55
    v_and_b32 v127, 0xffff0000, v55
    v_pk_fma_f32 v[112:113], v[120:121], v[12:13], v[112:113] op_sel:[0,1,0] op_sel_hi:[1,1,1]
    v_pk_fma_f32 v[114:115], v[122:123], v[12:13], v[114:115] op_sel:[0,1,0] op_sel_hi:[1,1,1]
    v_pk_fma_f32 v[116:117], v[124:125], v[12:13], v[116:117] op_sel:[0,1,0] op_sel_hi:[1,1,1]
    v_pk_fma_f32 v[118:119], v[126:127], v[12:13], v[118:119] op_sel:[0,1,0] op_sel_hi:[1,1,1]
    s_waitcnt vmcnt(13)
    v_lshlrev_b32 v120, 16, v56
    v_and_b32 v121, 0xffff0000, v56
    v_lshlrev_b32 v122, 16, v57
    v_and_b32 v123, 0xffff0000, v57
    v_lshlrev_b32 v124, 16, v58
    v_and_b32 v125, 0xffff0000, v58
    v_lshlrev_b32 v126, 16, v59
    v_and_b32 v127, 0xffff0000, v59
    v_pk_fma_f32 v[112:113], v[120:121], v[14:15], v[112:113] op_sel:[0,0,0] op_sel_hi:[1,0,1]
    v_pk_fma_f32 v[114:115], v[122:123], v[14:15], v[114:115] op_sel:[0,0,0] op_sel_hi:[1,0,1]
    v_pk_fma_f32 v[116:117], v[124:125], v[14:15], v[116:117] op_sel:[0,0,0] op_sel_hi:[1,0,1]
    v_pk_fma_f32 v[118:119], v[126:127], v[14:15], v[118:119] op_sel:[0,0,0] op_sel_hi:[1,0,1]
    s_waitcnt vmcnt(12)
    v_lshlrev_b32 v120, 16, v60
    v_and_b32 v121, 0xffff0000, v60
    v_lshlrev_b32 v122, 16, v61
    v_and_b32 v123, 0xffff0000, v61
    v_lshlrev_b32 v124, 16, v62
    v_and_b32 v125, 0xffff0000, v62
    v_lshlrev_b32 v126, 16, v63
    v_and_b32 v127, 0xffff0000, v63
    v_pk_fma_f32 v[112:113], v[120:121], v[14:15], v[112:113] op_sel:[0,1,0] op_sel_hi:[1,1,1]
    v_pk_fma_f32 v[114:115], v[122:123], v[14:15], v[114:115] op_sel:[0,1,0] op_sel_hi:[1,1,1]
    v_pk_fma_f32 v[116:117], v[124:125], v[14:15], v[116:117] op_sel:[0,1,0] op_sel_hi:[1,1,1]
    v_pk_fma_f32 v[118:119], v[126:127], v[14:15], v[118:119] op_sel:[0,1,0] op_sel_hi:[1,1,1]
    s_waitcnt vmcnt(11)
    v_lshlrev_b32 v120, 16, v64
    v_and_b32 v121, 0xffff0000, v64
    v_lshlrev_b32 v122, 16, v65
    v_and_b32 v123, 0xffff0000, v65
    v_lshlrev_b32 v124, 16, v66
    v_and_b32 v125, 0xffff0000, v66
    v_lshlrev_b32 v126, 16, v67
    v_and_b32 v127, 0xffff0000, v67
    v_pk_fma_f32 v[112:113], v[120:121], v[16:17], v[112:113] op_sel:[0,0,0] op_sel_hi:[1,0,1]
    v_pk_fma_f32 v[114:115], v[122:123], v[16:17], v[114:115] op_sel:[0,0,0] op_sel_hi:[1,0,1]
    v_pk_fma_f32 v[116:117], v[124:125], v[16:17], v[116:117] op_sel:[0,0,0] op_sel_hi:[1,0,1]
    v_pk_fma_f32 v[118:119], v[126:127], v[16:17], v[118:119] op_sel:[0,0,0] op_sel_hi:[1,0,1]
    s_waitcnt vmcnt(10)
    v_lshlrev_b32 v120, 16, v68
    v_and_b32 v121, 0xffff0000, v68
    v_lshlrev_b32 v122, 16, v69
    v_and_b32 v123, 0xffff0000, v69
    v_lshlrev_b32 v124, 16, v70
    v_and_b32 v125, 0xffff0000, v70
    v_lshlrev_b32 v126, 16, v71
    v_and_b32 v127, 0xffff0000, v71
    v_pk_fma_f32 v[112:113], v[120:121], v[16:17], v[112:113] op_sel:[0,1,0] op_sel_hi:[1,1,1]
    v_pk_fma_f32 v[114:115], v[122:123], v[16:17], v[114:115] op_sel:[0,1,0] op_sel_hi:[1,1,1]
    v_pk_fma_f32 v[116:117], v[124:125], v[16:17], v[116:117] op_sel:[0,1,0] op_sel_hi:[1,1,1]
    v_pk_fma_f32 v[118:119], v[126:127], v[16:17], v[118:119] op_sel:[0,1,0] op_sel_hi:[1,1,1]
    s_waitcnt vmcnt(9)
    v_lshlrev_b32 v120, 16, v72
    v_and_b32 v121, 0xffff0000, v72
    v_lshlrev_b32 v122, 16, v73
    v_and_b32 v123, 0xffff0000, v73
    v_lshlrev_b32 v124, 16, v74
    v_and_b32 v125, 0xffff0000, v74
    v_lshlrev_b32 v126, 16, v75
    v_and_b32 v127, 0xffff0000, v75
    v_pk_fma_f32 v[112:113], v[120:121], v[18:19], v[112:113] op_sel:[0,0,0] op_sel_hi:[1,0,1]
    v_pk_fma_f32 v[114:115], v[122:123], v[18:19], v[114:115] op_sel:[0,0,0] op_sel_hi:[1,0,1]
    v_pk_fma_f32 v[116:117], v[124:125], v[18:19], v[116:117] op_sel:[0,0,0] op_sel_hi:[1,0,1]
    v_pk_fma_f32 v[118:119], v[126:127], v[18:19], v[118:119] op_sel:[0,0,0] op_sel_hi:[1,0,1]
    s_waitcnt vmcnt(8)
    v_lshlrev_b32 v120, 16, v76
    v_and_b32 v121, 0xffff0000, v76
    v_lshlrev_b32 v122, 16, v77
    v_and_b32 v123, 0xffff0000, v77
    v_lshlrev_b32 v124, 16, v78
    v_and_b32 v125, 0xffff0000, v78
    v_lshlrev_b32 v126, 16, v79
    v_and_b32 v127, 0xffff0000, v79
    v_pk_fma_f32 v[112:113], v[120:121], v[18:19], v[112:113] op_sel:[0,1,0] op_sel_hi:[1,1,1]
    v_pk_fma_f32 v[114:115], v[122:123], v[18:19], v[114:115] op_sel:[0,1,0] op_sel_hi:[1,1,1]
    v_pk_fma_f32 v[116:117], v[124:125], v[18:19], v[116:117] op_sel:[0,1,0] op_sel_hi:[1,1,1]
    v_pk_fma_f32 v[118:119], v[126:127], v[18:19], v[118:119] op_sel:[0,1,0] op_sel_hi:[1,1,1]
    s_waitcnt vmcnt(7)
    v_lshlrev_b32 v120, 16, v80
    v_and_b32 v121, 0xffff0000, v80
    v_lshlrev_b32 v122, 16, v81
    v_and_b32 v123, 0xffff0000, v81
    v_lshlrev_b32 v124, 16, v82
    v_and_b32 v125, 0xffff0000, v82
    v_lshlrev_b32 v126, 16, v83
    v_and_b32 v127, 0xffff0000, v83
    v_pk_fma_f32 v[112:113], v[120:121], v[20:21], v[112:113] op_sel:[0,0,0] op_sel_hi:[1,0,1]
    v_pk_fma_f32 v[114:115], v[122:123], v[20:21], v[114:115] op_sel:[0,0,0] op_sel_hi:[1,0,1]
    v_pk_fma_f32 v[116:117], v[124:125], v[20:21], v[116:117] op_sel:[0,0,0] op_sel_hi:[1,0,1]
    v_pk_fma_f32 v[118:119], v[126:127], v[20:21], v[118:119] op_sel:[0,0,0] op_sel_hi:[1,0,1]
    s_waitcnt vmcnt(6)
    v_lshlrev_b32 v120, 16, v84
    v_and_b32 v121, 0xffff0000, v84
    v_lshlrev_b32 v122, 16, v85
    v_and_b32 v123, 0xffff0000, v85
    v_lshlrev_b32 v124, 16, v86
    v_and_b32 v125, 0xffff0000, v86
    v_lshlrev_b32 v126, 16, v87
    v_and_b32 v127, 0xffff0000, v87
    v_pk_fma_f32 v[112:113], v[120:121], v[20:21], v[112:113] op_sel:[0,1,0] op_sel_hi:[1,1,1]
    v_pk_fma_f32 v[114:115], v[122:123], v[20:21], v[114:115] op_sel:[0,1,0] op_sel_hi:[1,1,1]
    v_pk_fma_f32 v[116:117], v[124:125], v[20:21], v[116:117] op_sel:[0,1,0] op_sel_hi:[1,1,1]
    v_pk_fma_f32 v[118:119], v[126:127], v[20:21], v[118:119] op_sel:[0,1,0] op_sel_hi:[1,1,1]
    s_waitcnt vmcnt(5)
    v_lshlrev_b32 v120, 16, v88
    v_and_b32 v121, 0xffff0000, v88
    v_lshlrev_b32 v122, 16, v89
    v_and_b32 v123, 0xffff0000, v89
    v_lshlrev_b32 v124, 16, v90
    v_and_b32 v125, 0xffff0000, v90
    v_lshlrev_b32 v126, 16, v91
    v_and_b32 v127, 0xffff0000, v91
    v_pk_fma_f32 v[112:113], v[120:121], v[22:23], v[112:113] op_sel:[0,0,0] op_sel_hi:[1,0,1]
    v_pk_fma_f32 v[114:115], v[122:123], v[22:23], v[114:115] op_sel:[0,0,0] op_sel_hi:[1,0,1]
    v_pk_fma_f32 v[116:117], v[124:125], v[22:23], v[116:117] op_sel:[0,0,0] op_sel_hi:[1,0,1]
    v_pk_fma_f32 v[118:119], v[126:127], v[22:23], v[118:119] op_sel:[0,0,0] op_sel_hi:[1,0,1]
    s_waitcnt vmcnt(4)
    v_lshlrev_b32 v120, 16, v92
    v_and_b32 v121, 0xffff0000, v92
    v_lshlrev_b32 v122, 16, v93
    v_and_b32 v123, 0xffff0000, v93
    v_lshlrev_b32 v124, 16, v94
    v_and_b32 v125, 0xffff0000, v94
    v_lshlrev_b32 v126, 16, v95
    v_and_b32 v127, 0xffff0000, v95
    v_pk_fma_f32 v[112:113], v[120:121], v[22:23], v[112:113] op_sel:[0,1,0] op_sel_hi:[1,1,1]
    v_pk_fma_f32 v[114:115], v[122:123], v[22:23], v[114:115] op_sel:[0,1,0] op_sel_hi:[1,1,1]
    v_pk_fma_f32 v[116:117], v[124:125], v[22:23], v[116:117] op_sel:[0,1,0] op_sel_hi:[1,1,1]
    v_pk_fma_f32 v[118:119], v[126:127], v[22:23], v[118:119] op_sel:[0,1,0] op_sel_hi:[1,1,1]
    s_waitcnt vmcnt(3)
    v_lshlrev_b32 v120, 16, v96
    v_and_b32 v121, 0xffff0000, v96
    v_lshlrev_b32 v122, 16, v97
    v_and_b32 v123, 0xffff0000, v97
    v_lshlrev_b32 v124, 16, v98
    v_and_b32 v125, 0xffff0000, v98
    v_lshlrev_b32 v126, 16, v99
    v_and_b32 v127, 0xffff0000, v99
    v_pk_fma_f32 v[112:113], v[120:121], v[24:25], v[112:113] op_sel:[0,0,0] op_sel_hi:[1,0,1]
    v_pk_fma_f32 v[114:115], v[122:123], v[24:25], v[114:115] op_sel:[0,0,0] op_sel_hi:[1,0,1]
    v_pk_fma_f32 v[116:117], v[124:125], v[24:25], v[116:117] op_sel:[0,0,0] op_sel_hi:[1,0,1]
    v_pk_fma_f32 v[118:119], v[126:127], v[24:25], v[118:119] op_sel:[0,0,0] op_sel_hi:[1,0,1]
    s_waitcnt vmcnt(2)
    v_lshlrev_b32 v120, 16, v100
    v_and_b32 v121, 0xffff0000, v100
    v_lshlrev_b32 v122, 16, v101
    v_and_b32 v123, 0xffff0000, v101
    v_lshlrev_b32 v124, 16, v102
    v_and_b32 v125, 0xffff0000, v102
    v_lshlrev_b32 v126, 16, v103
    v_and_b32 v127, 0xffff0000, v103
    v_pk_fma_f32 v[112:113], v[120:121], v[24:25], v[112:113] op_sel:[0,1,0] op_sel_hi:[1,1,1]
    v_pk_fma_f32 v[114:115], v[122:123], v[24:25], v[114:115] op_sel:[0,1,0] op_sel_hi:[1,1,1]
    v_pk_fma_f32 v[116:117], v[124:125], v[24:25], v[116:117] op_sel:[0,1,0] op_sel_hi:[1,1,1]
    v_pk_fma_f32 v[118:119], v[126:127], v[24:25], v[118:119] op_sel:[0,1,0] op_sel_hi:[1,1,1]
    s_waitcnt vmcnt(1)
    v_lshlrev_b32 v120, 16, v104
    v_and_b32 v121, 0xffff0000, v104
    v_lshlrev_b32 v122, 16, v105
    v_and_b32 v123, 0xffff0000, v105
    v_lshlrev_b32 v124, 16, v106
    v_and_b32 v125, 0xffff0000, v106
    v_lshlrev_b32 v126, 16, v107
    v_and_b32 v127, 0xffff0000, v107
    v_pk_fma_f32 v[112:113], v[120:121], v[26:27], v[112:113] op_sel:[0,0,0] op_sel_hi:[1,0,1]
    v_pk_fma_f32 v[114:115], v[122:123], v[26:27], v[114:115] op_sel:[0,0,0] op_sel_hi:[1,0,1]
    v_pk_fma_f32 v[116:117], v[124:125], v[26:27], v[116:117] op_sel:[0,0,0] op_sel_hi:[1,0,1]
    v_pk_fma_f32 v[118:119], v[126:127], v[26:27], v[118:119] op_sel:[0,0,0] op_sel_hi:[1,0,1]
    s_waitcnt vmcnt(0)
    v_lshlrev_b32 v120, 16, v108
    v_and_b32 v121, 0xffff0000, v108
    v_lshlrev_b32 v122, 16, v109
    v_and_b32 v123, 0xffff0000, v109
    v_lshlrev_b32 v124, 16, v110
    v_and_b32 v125, 0xffff0000, v110
    v_lshlrev_b32 v126, 16, v111
    v_and_b32 v127, 0xffff0000, v111
    v_pk_fma_f32 v[112:113], v[120:121], v[26:27], v[112:113] op_sel:[0,1,0] op_sel_hi:[1,1,1]
    v_pk_fma_f32 v[114:115], v[122:123], v[26:27], v[114:115] op_sel:[0,1,0] op_sel_hi:[1,1,1]
    v_pk_fma_f32 v[116:117], v[124:125], v[26:27], v[116:117] op_sel:[0,1,0] op_sel_hi:[1,1,1]
    v_pk_fma_f32 v[118:119], v[126:127], v[26:27], v[118:119] op_sel:[0,1,0] op_sel_hi:[1,1,1]
    s_nop 1
    v_add_f32_dpp v112, v112, v112 row_ror:8 row_mask:0xf bank_mask:0xf
    v_add_f32_dpp v113, v113, v113 row_ror:8 row_mask:0xf bank_mask:0xf
    v_add_f32_dpp v114, v114, v114 row_ror:8 row_mask:0xf bank_mask:0xf
    v_add_f32_dpp v115, v115, v115 row_ror:8 row_mask:0xf bank_mask:0xf
    v_add_f32_dpp v116, v116, v116 row_ror:8 row_mask:0xf bank_mask:0xf
    v_add_f32_dpp v117, v117, v117 row_ror:8 row_mask:0xf bank_mask:0xf
    v_add_f32_dpp v118, v118, v118 row_ror:8 row_mask:0xf bank_mask:0xf
    v_add_f32_dpp v119, v119, v119 row_ror:8 row_mask:0xf bank_mask:0xf
    v_mov_b32 v120, v112
    v_mov_b32 v121, v113
    v_mov_b32 v122, v114
    v_mov_b32 v123, v115
    v_mov_b32 v124, v116
    v_mov_b32 v125, v117
    v_mov_b32 v126, v118
    v_mov_b32 v127, v119
    s_nop 1
    v_permlane32_swap_b32 v120, v112
    v_permlane32_swap_b32 v121, v113
    v_permlane32_swap_b32 v122, v114
    v_permlane32_swap_b32 v123, v115
    v_permlane32_swap_b32 v124, v116
    v_permlane32_swap_b32 v125, v117
    v_permlane32_swap_b32 v126, v118
    v_permlane32_swap_b32 v127, v119
    s_nop 1
    v_add_f32 v112, v112, v120
    v_add_f32 v113, v113, v121
    v_add_f32 v114, v114, v122
    v_add_f32 v115, v115, v123
    v_add_f32 v116, v116, v124
    v_add_f32 v117, v117, v125
    v_add_f32 v118, v118, v126
    v_add_f32 v119, v119, v127
    v_mov_b32 v120, v112
    v_mov_b32 v121, v113
    v_mov_b32 v122, v114
    v_mov_b32 v123, v115
    v_mov_b32 v124, v116
    v_mov_b32 v125, v117
    v_mov_b32 v126, v118
    v_mov_b32 v127, v119
    s_nop 1
    v_permlane16_swap_b32 v120, v112
    v_permlane16_swap_b32 v121, v113
    v_permlane16_swap_b32 v122, v114
    v_permlane16_swap_b32 v123, v115
    v_permlane16_swap_b32 v124, v116
    v_permlane16_swap_b32 v125, v117
    v_permlane16_swap_b32 v126, v118
    v_permlane16_swap_b32 v127, v119
    s_nop 1
    v_add_f32 v112, v112, v120
    v_add_f32 v113, v113, v121
    v_add_f32 v114, v114, v122
    v_add_f32 v115, v115, v123
    v_add_f32 v116, v116, v124
    v_add_f32 v117, v117, v125
    v_add_f32 v118, v118, v126
    v_add_f32 v119, v119, v127
    v_lshlrev_b32 v7, 5, v3
    s_mul_i32 s36, s33, 15360
    s_lshl_b32 s37, s32, 8
    s_add_u32 s37, s37, s36
    s_add_u32 s37, s37, 2793472
    s_lshl_b32 s44, s21, 7
    s_add_u32 s44, s44, 29700096
    s_mov_b64 exec, 0xff
    buffer_store_dwordx4 v[112:115], v7, s[28:31], s37 offen sc1
    buffer_store_dwordx4 v[116:119], v7, s[28:31], s37 offen offset:16 sc1
    s_mov_b64 exec, -1
    s_waitcnt vmcnt(0)
    s_mov_b32 s47, 0
prep_kernel_nn6:
    v_readfirstlane_b32 s46, v250
    s_add_u32 s47, s47, 1
    s_cmp_lg_u32 s46, 0
    s_cbranch_scc1 prep_kernel_nd7
    s_cmp_ge_u32 s47, 200000
    s_cbranch_scc1 prep_kernel_nd7
    buffer_load_dword v250, v251, s[48:51], 0 offen sc1
    s_waitcnt vmcnt(0)
    s_branch prep_kernel_nn6
prep_kernel_nd7:
    v_mov_b32 v132, s46
    v_mov_b32 v133, 0
    s_mov_b64 exec, 1
    buffer_store_dword v132, v133, s[28:31], s44 offen sc1
    s_endpgm
p_st:
    s_mov_b32 s16, s60
    s_mov_b32 s17, s61
    s_mov_b32 s18, 2621440
    s_mov_b32 s19, 0x00020000
    v_lshrrev_b32 v5, 3, v1
    v_and_b32 v6, 7, v1
    s_lshl_b32 s23, s21, 4
    v_add_u32 v7, s23, v5
    v_mul_u32_u24 v9, 1280, v7
    v_lshl_add_u32 v9, v6, 4, v9
    v_mov_b32 v20, 0x3f803f80
    s_mov_b32 s24, 0
    buffer_load_dwordx4 v[32:35], v9, s[16:19], s24 offen offset:0 nt
    buffer_load_dwordx4 v[36:39], v9, s[16:19], s24 offen offset:128 nt
    buffer_load_dwordx4 v[40:43], v9, s[16:19], s24 offen offset:256 nt
    buffer_load_dwordx4 v[44:47], v9, s[16:19], s24 offen offset:384 nt
    buffer_load_dwordx4 v[48:51], v9, s[16:19], s24 offen offset:512 nt
    buffer_load_dwordx4 v[52:55], v9, s[16:19], s24 offen offset:640 nt
    buffer_load_dwordx4 v[56:59], v9, s[16:19], s24 offen offset:768 nt
    buffer_load_dwordx4 v[60:63], v9, s[16:19], s24 offen offset:896 nt
    buffer_load_dwordx4 v[64:67], v9, s[16:19], s24 offen offset:1024 nt
    buffer_load_dwordx4 v[68:71], v9, s[16:19], s24 offen offset:1152 nt
    s_add_u32 s24, s24, 10240
    buffer_load_dwordx4 v[72:75], v9, s[16:19], s24 offen offset:0 nt
    buffer_load_dwordx4 v[76:79], v9, s[16:19], s24 offen offset:128 nt
    buffer_load_dwordx4 v[80:83], v9, s[16:19], s24 offen offset:256 nt
    buffer_load_dwordx4 v[84:87], v9, s[16:19], s24 offen offset:384 nt
    buffer_load_dwordx4 v[88:91], v9, s[16:19], s24 offen offset:512 nt
    buffer_load_dwordx4 v[92:95], v9, s[16:19], s24 offen offset:640 nt
    buffer_load_dwordx4 v[96:99], v9, s[16:19], s24 offen offset:768 nt
    buffer_load_dwordx4 v[100:103], v9, s[16:19], s24 offen offset:896 nt
    buffer_load_dwordx4 v[104:107], v9, s[16:19], s24 offen offset:1024 nt
    buffer_load_dwordx4 v[108:111], v9, s[16:19], s24 offen offset:1152 nt
    v_and_b32 v21, 1, v5
    v_lshl_add_u32 v21, v6, 1, v21
    v_lshlrev_b32 v21, 7, v21
    v_lshrrev_b32 v22, 1, v5
    v_xor_b32 v22, v22, v6
    v_lshl_add_u32 v21, v22, 4, v21
    v_xor_b32 v23, 64, v21
    s_mul_i32 s25, s21, 20480
    s_add_u32 s25, s25, 2854912
    v_mov_b32 v10, 0
    v_mov_b32 v11, 0
    v_mov_b32 v12, 0
    v_mov_b32 v13, 0
    s_waitcnt vmcnt(19)
    v_dot2_f32_bf16 v10, v32, v20, v10
    v_dot2_f32_bf16 v11, v32, v32, v11
    v_dot2_f32_bf16 v10, v33, v20, v10
    v_dot2_f32_bf16 v11, v33, v33, v11
    v_dot2_f32_bf16 v10, v34, v20, v10
    v_dot2_f32_bf16 v11, v34, v34, v11
    v_dot2_f32_bf16 v10, v35, v20, v10
    v_dot2_f32_bf16 v11, v35, v35, v11
    v_mov_b32 v120, v32
    v_mov_b32 v121, v33
    v_mov_b32 v122, v34
    v_mov_b32 v123, v35
    v_mov_b32_dpp v120, v34 row_ror:8 row_mask:0xf bank_mask:0xc
    v_mov_b32_dpp v121, v35 row_ror:8 row_mask:0xf bank_mask:0xc
    v_mov_b32_dpp v122, v32 row_ror:8 row_mask:0xf bank_mask:0x3
    v_mov_b32_dpp v123, v33 row_ror:8 row_mask:0xf bank_mask:0x3
    s_add_u32 s26, s25, 0
    buffer_store_dwordx4 v[120:123], v21, s[28:31], s26 offen sc1
    s_waitcnt vmcnt(19)
    v_dot2_f32_bf16 v10, v36, v20, v10
    v_dot2_f32_bf16 v11, v36, v36, v11
    v_dot2_f32_bf16 v10, v37, v20, v10
    v_dot2_f32_bf16 v11, v37, v37, v11
    v_dot2_f32_bf16 v10, v38, v20, v10
    v_dot2_f32_bf16 v11, v38, v38, v11
    v_dot2_f32_bf16 v10, v39, v20, v10
    v_dot2_f32_bf16 v11, v39, v39, v11
    v_mov_b32 v124, v36
    v_mov_b32 v125, v37
    v_mov_b32 v126, v38
    v_mov_b32 v127, v39
    v_mov_b32_dpp v124, v38 row_ror:8 row_mask:0xf bank_mask:0xc
    v_mov_b32_dpp v125, v39 row_ror:8 row_mask:0xf bank_mask:0xc
    v_mov_b32_dpp v126, v36 row_ror:8 row_mask:0xf bank_mask:0x3
    v_mov_b32_dpp v127, v37 row_ror:8 row_mask:0xf bank_mask:0x3
    s_add_u32 s26, s25, 2048
    buffer_store_dwordx4 v[124:127], v21, s[28:31], s26 offen sc1
    s_waitcnt vmcnt(19)
    v_dot2_f32_bf16 v10, v40, v20, v10
    v_dot2_f32_bf16 v11, v40, v40, v11
    v_dot2_f32_bf16 v10, v41, v20, v10
    v_dot2_f32_bf16 v11, v41, v41, v11
    v_dot2_f32_bf16 v10, v42, v20, v10
    v_dot2_f32_bf16 v11, v42, v42, v11
    v_dot2_f32_bf16 v10, v43, v20, v10
    v_dot2_f32_bf16 v11, v43, v43, v11
    v_mov_b32 v120, v40
    v_mov_b32 v121, v41
    v_mov_b32 v122, v42
    v_mov_b32 v123, v43
    v_mov_b32_dpp v120, v42 row_ror:8 row_mask:0xf bank_mask:0xc
    v_mov_b32_dpp v121, v43 row_ror:8 row_mask:0xf bank_mask:0xc
    v_mov_b32_dpp v122, v40 row_ror:8 row_mask:0xf bank_mask:0x3
    v_mov_b32_dpp v123, v41 row_ror:8 row_mask:0xf bank_mask:0x3
    s_add_u32 s26, s25, 4096
    buffer_store_dwordx4 v[120:123], v21, s[28:31], s26 offen sc1
    s_waitcnt vmcnt(19)
    v_dot2_f32_bf16 v10, v44, v20, v10
    v_dot2_f32_bf16 v11, v44, v44, v11
    v_dot2_f32_bf16 v10, v45, v20, v10
    v_dot2_f32_bf16 v11, v45, v45, v11
    v_dot2_f32_bf16 v10, v46, v20, v10
    v_dot2_f32_bf16 v11, v46, v46, v11
    v_dot2_f32_bf16 v10, v47, v20, v10
    v_dot2_f32_bf16 v11, v47, v47, v11
    v_mov_b32 v124, v44
    v_mov_b32 v125, v45
    v_mov_b32 v126, v46
    v_mov_b32 v127, v47
    v_mov_b32_dpp v124, v46 row_ror:8 row_mask:0xf bank_mask:0xc
    v_mov_b32_dpp v125, v47 row_ror:8 row_mask:0xf bank_mask:0xc
    v_mov_b32_dpp v126, v44 row_ror:8 row_mask:0xf bank_mask:0x3
    v_mov_b32_dpp v127, v45 row_ror:8 row_mask:0xf bank_mask:0x3
    s_add_u32 s26, s25, 6144
    buffer_store_dwordx4 v[124:127], v21, s[28:31], s26 offen sc1
    s_waitcnt vmcnt(19)
    v_dot2_f32_bf16 v10, v48, v20, v10
    v_dot2_f32_bf16 v11, v48, v48, v11
    v_dot2_f32_bf16 v10, v49, v20, v10
    v_dot2_f32_bf16 v11, v49, v49, v11
    v_dot2_f32_bf16 v10, v50, v20, v10
    v_dot2_f32_bf16 v11, v50, v50, v11
    v_dot2_f32_bf16 v10, v51, v20, v10
    v_dot2_f32_bf16 v11, v51, v51, v11
    v_mov_b32 v120, v48
    v_mov_b32 v121, v49
    v_mov_b32 v122, v50
    v_mov_b32 v123, v51
    v_mov_b32_dpp v120, v50 row_ror:8 row_mask:0xf bank_mask:0xc
    v_mov_b32_dpp v121, v51 row_ror:8 row_mask:0xf bank_mask:0xc
    v_mov_b32_dpp v122, v48 row_ror:8 row_mask:0xf bank_mask:0x3
    v_mov_b32_dpp v123, v49 row_ror:8 row_mask:0xf bank_mask:0x3
    s_add_u32 s26, s25, 8192
    buffer_store_dwordx4 v[120:123], v21, s[28:31], s26 offen sc1
    s_waitcnt vmcnt(19)
    v_dot2_f32_bf16 v10, v52, v20, v10
    v_dot2_f32_bf16 v11, v52, v52, v11
    v_dot2_f32_bf16 v10, v53, v20, v10
    v_dot2_f32_bf16 v11, v53, v53, v11
    v_dot2_f32_bf16 v10, v54, v20, v10
    v_dot2_f32_bf16 v11, v54, v54, v11
    v_dot2_f32_bf16 v10, v55, v20, v10
    v_dot2_f32_bf16 v11, v55, v55, v11
    v_mov_b32 v124, v52
    v_mov_b32 v125, v53
    v_mov_b32 v126, v54
    v_mov_b32 v127, v55
    v_mov_b32_dpp v124, v54 row_ror:8 row_mask:0xf bank_mask:0xc
    v_mov_b32_dpp v125, v55 row_ror:8 row_mask:0xf bank_mask:0xc
    v_mov_b32_dpp v126, v52 row_ror:8 row_mask:0xf bank_mask:0x3
    v_mov_b32_dpp v127, v53 row_ror:8 row_mask:0xf bank_mask:0x3
    s_add_u32 s26, s25, 10240
    buffer_store_dwordx4 v[124:127], v21, s[28:31], s26 offen sc1
    s_waitcnt vmcnt(19)
    v_dot2_f32_bf16 v10, v56, v20, v10
    v_dot2_f32_bf16 v11, v56, v56, v11
    v_dot2_f32_bf16 v10, v57, v20, v10
    v_dot2_f32_bf16 v11, v57, v57, v11
    v_dot2_f32_bf16 v10, v58, v20, v10
    v_dot2_f32_bf16 v11, v58, v58, v11
    v_dot2_f32_bf16 v10, v59, v20, v10
    v_dot2_f32_bf16 v11, v59, v59, v11
    v_mov_b32 v120, v56
    v_mov_b32 v121, v57
    v_mov_b32 v122, v58
    v_mov_b32 v123, v59
    v_mov_b32_dpp v120, v58 row_ror:8 row_mask:0xf bank_mask:0xc
    v_mov_b32_dpp v121, v59 row_ror:8 row_mask:0xf bank_mask:0xc
    v_mov_b32_dpp v122, v56 row_ror:8 row_mask:0xf bank_mask:0x3
    v_mov_b32_dpp v123, v57 row_ror:8 row_mask:0xf bank_mask:0x3
    s_add_u32 s26, s25, 12288
    buffer_store_dwordx4 v[120:123], v21, s[28:31], s26 offen sc1
    s_waitcnt vmcnt(19)
    v_dot2_f32_bf16 v10, v60, v20, v10
    v_dot2_f32_bf16 v11, v60, v60, v11
    v_dot2_f32_bf16 v10, v61, v20, v10
    v_dot2_f32_bf16 v11, v61, v61, v11
    v_dot2_f32_bf16 v10, v62, v20, v10
    v_dot2_f32_bf16 v11, v62, v62, v11
    v_dot2_f32_bf16 v10, v63, v20, v10
    v_dot2_f32_bf16 v11, v63, v63, v11
    v_mov_b32 v124, v60
    v_mov_b32 v125, v61
    v_mov_b32 v126, v62
    v_mov_b32 v127, v63
    v_mov_b32_dpp v124, v62 row_ror:8 row_mask:0xf bank_mask:0xc
    v_mov_b32_dpp v125, v63 row_ror:8 row_mask:0xf bank_mask:0xc
    v_mov_b32_dpp v126, v60 row_ror:8 row_mask:0xf bank_mask:0x3
    v_mov_b32_dpp v127, v61 row_ror:8 row_mask:0xf bank_mask:0x3
    s_add_u32 s26, s25, 14336
    buffer_store_dwordx4 v[124:127], v21, s[28:31], s26 offen sc1
    s_waitcnt vmcnt(19)
    v_dot2_f32_bf16 v10, v64, v20, v10
    v_dot2_f32_bf16 v11, v64, v64, v11
    v_dot2_f32_bf16 v10, v65, v20, v10
    v_dot2_f32_bf16 v11, v65, v65, v11
    v_dot2_f32_bf16 v10, v66, v20, v10
    v_dot2_f32_bf16 v11, v66, v66, v11
    v_dot2_f32_bf16 v10, v67, v20, v10
    v_dot2_f32_bf16 v11, v67, v67, v11
    v_mov_b32 v120, v64
    v_mov_b32 v121, v65
    v_mov_b32 v122, v66
    v_mov_b32 v123, v67
    v_mov_b32_dpp v120, v66 row_ror:8 row_mask:0xf bank_mask:0xc
    v_mov_b32_dpp v121, v67 row_ror:8 row_mask:0xf bank_mask:0xc
    v_mov_b32_dpp v122, v64 row_ror:8 row_mask:0xf bank_mask:0x3
    v_mov_b32_dpp v123, v65 row_ror:8 row_mask:0xf bank_mask:0x3
    s_add_u32 s26, s25, 16384
    buffer_store_dwordx4 v[120:123], v21, s[28:31], s26 offen sc1
    s_waitcnt vmcnt(19)
    v_dot2_f32_bf16 v10, v68, v20, v10
    v_dot2_f32_bf16 v11, v68, v68, v11
    v_dot2_f32_bf16 v10, v69, v20, v10
    v_dot2_f32_bf16 v11, v69, v69, v11
    v_dot2_f32_bf16 v10, v70, v20, v10
    v_dot2_f32_bf16 v11, v70, v70, v11
    v_dot2_f32_bf16 v10, v71, v20, v10
    v_dot2_f32_bf16 v11, v71, v71, v11
    v_mov_b32 v124, v68
    v_mov_b32 v125, v69
    v_mov_b32 v126, v70
    v_mov_b32 v127, v71
    v_mov_b32_dpp v124, v70 row_ror:8 row_mask:0xf bank_mask:0xc
    v_mov_b32_dpp v125, v71 row_ror:8 row_mask:0xf bank_mask:0xc
    v_mov_b32_dpp v126, v68 row_ror:8 row_mask:0xf bank_mask:0x3
    v_mov_b32_dpp v127, v69 row_ror:8 row_mask:0xf bank_mask:0x3
    s_add_u32 s26, s25, 18432
    buffer_store_dwordx4 v[124:127], v21, s[28:31], s26 offen sc1
    s_waitcnt vmcnt(19)
    v_dot2_f32_bf16 v12, v72, v20, v12
    v_dot2_f32_bf16 v13, v72, v72, v13
    v_dot2_f32_bf16 v12, v73, v20, v12
    v_dot2_f32_bf16 v13, v73, v73, v13
    v_dot2_f32_bf16 v12, v74, v20, v12
    v_dot2_f32_bf16 v13, v74, v74, v13
    v_dot2_f32_bf16 v12, v75, v20, v12
    v_dot2_f32_bf16 v13, v75, v75, v13
    v_mov_b32 v120, v72
    v_mov_b32 v121, v73
    v_mov_b32 v122, v74
    v_mov_b32 v123, v75
    v_mov_b32_dpp v120, v74 row_ror:8 row_mask:0xf bank_mask:0xc
    v_mov_b32_dpp v121, v75 row_ror:8 row_mask:0xf bank_mask:0xc
    v_mov_b32_dpp v122, v72 row_ror:8 row_mask:0xf bank_mask:0x3
    v_mov_b32_dpp v123, v73 row_ror:8 row_mask:0xf bank_mask:0x3
    s_add_u32 s26, s25, 0
    buffer_store_dwordx4 v[120:123], v23, s[28:31], s26 offen sc1
    s_waitcnt vmcnt(19)
    v_dot2_f32_bf16 v12, v76, v20, v12
    v_dot2_f32_bf16 v13, v76, v76, v13
    v_dot2_f32_bf16 v12, v77, v20, v12
    v_dot2_f32_bf16 v13, v77, v77, v13
    v_dot2_f32_bf16 v12, v78, v20, v12
    v_dot2_f32_bf16 v13, v78, v78, v13
    v_dot2_f32_bf16 v12, v79, v20, v12
    v_dot2_f32_bf16 v13, v79, v79, v13
    v_mov_b32 v124, v76
    v_mov_b32 v125, v77
    v_mov_b32 v126, v78
    v_mov_b32 v127, v79
    v_mov_b32_dpp v124, v78 row_ror:8 row_mask:0xf bank_mask:0xc
    v_mov_b32_dpp v125, v79 row_ror:8 row_mask:0xf bank_mask:0xc
    v_mov_b32_dpp v126, v76 row_ror:8 row_mask:0xf bank_mask:0x3
    v_mov_b32_dpp v127, v77 row_ror:8 row_mask:0xf bank_mask:0x3
    s_add_u32 s26, s25, 2048
    buffer_store_dwordx4 v[124:127], v23, s[28:31], s26 offen sc1
    s_waitcnt vmcnt(19)
    v_dot2_f32_bf16 v12, v80, v20, v12
    v_dot2_f32_bf16 v13, v80, v80, v13
    v_dot2_f32_bf16 v12, v81, v20, v12
    v_dot2_f32_bf16 v13, v81, v81, v13
    v_dot2_f32_bf16 v12, v82, v20, v12
    v_dot2_f32_bf16 v13, v82, v82, v13
    v_dot2_f32_bf16 v12, v83, v20, v12
    v_dot2_f32_bf16 v13, v83, v83, v13
    v_mov_b32 v120, v80
    v_mov_b32 v121, v81
    v_mov_b32 v122, v82
    v_mov_b32 v123, v83
    v_mov_b32_dpp v120, v82 row_ror:8 row_mask:0xf bank_mask:0xc
    v_mov_b32_dpp v121, v83 row_ror:8 row_mask:0xf bank_mask:0xc
    v_mov_b32_dpp v122, v80 row_ror:8 row_mask:0xf bank_mask:0x3
    v_mov_b32_dpp v123, v81 row_ror:8 row_mask:0xf bank_mask:0x3
    s_add_u32 s26, s25, 4096
    buffer_store_dwordx4 v[120:123], v23, s[28:31], s26 offen sc1
    s_waitcnt vmcnt(19)
    v_dot2_f32_bf16 v12, v84, v20, v12
    v_dot2_f32_bf16 v13, v84, v84, v13
    v_dot2_f32_bf16 v12, v85, v20, v12
    v_dot2_f32_bf16 v13, v85, v85, v13
    v_dot2_f32_bf16 v12, v86, v20, v12
    v_dot2_f32_bf16 v13, v86, v86, v13
    v_dot2_f32_bf16 v12, v87, v20, v12
    v_dot2_f32_bf16 v13, v87, v87, v13
    v_mov_b32 v124, v84
    v_mov_b32 v125, v85
    v_mov_b32 v126, v86
    v_mov_b32 v127, v87
    v_mov_b32_dpp v124, v86 row_ror:8 row_mask:0xf bank_mask:0xc
    v_mov_b32_dpp v125, v87 row_ror:8 row_mask:0xf bank_mask:0xc
    v_mov_b32_dpp v126, v84 row_ror:8 row_mask:0xf bank_mask:0x3
    v_mov_b32_dpp v127, v85 row_ror:8 row_mask:0xf bank_mask:0x3
    s_add_u32 s26, s25, 6144
    buffer_store_dwordx4 v[124:127], v23, s[28:31], s26 offen sc1
    s_waitcnt vmcnt(19)
    v_dot2_f32_bf16 v12, v88, v20, v12
    v_dot2_f32_bf16 v13, v88, v88, v13
    v_dot2_f32_bf16 v12, v89, v20, v12
    v_dot2_f32_bf16 v13, v89, v89, v13
    v_dot2_f32_bf16 v12, v90, v20, v12
    v_dot2_f32_bf16 v13, v90, v90, v13
    v_dot2_f32_bf16 v12, v91, v20, v12
    v_dot2_f32_bf16 v13, v91, v91, v13
    v_mov_b32 v120, v88
    v_mov_b32 v121, v89
    v_mov_b32 v122, v90
    v_mov_b32 v123, v91
    v_mov_b32_dpp v120, v90 row_ror:8 row_mask:0xf bank_mask:0xc
    v_mov_b32_dpp v121, v91 row_ror:8 row_mask:0xf bank_mask:0xc
    v_mov_b32_dpp v122, v88 row_ror:8 row_mask:0xf bank_mask:0x3
    v_mov_b32_dpp v123, v89 row_ror:8 row_mask:0xf bank_mask:0x3
    s_add_u32 s26, s25, 8192
    buffer_store_dwordx4 v[120:123], v23, s[28:31], s26 offen sc1
    s_waitcnt vmcnt(19)
    v_dot2_f32_bf16 v12, v92, v20, v12
    v_dot2_f32_bf16 v13, v92, v92, v13
    v_dot2_f32_bf16 v12, v93, v20, v12
    v_dot2_f32_bf16 v13, v93, v93, v13
    v_dot2_f32_bf16 v12, v94, v20, v12
    v_dot2_f32_bf16 v13, v94, v94, v13
    v_dot2_f32_bf16 v12, v95, v20, v12
    v_dot2_f32_bf16 v13, v95, v95, v13
    v_mov_b32 v124, v92
    v_mov_b32 v125, v93
    v_mov_b32 v126, v94
    v_mov_b32 v127, v95
    v_mov_b32_dpp v124, v94 row_ror:8 row_mask:0xf bank_mask:0xc
    v_mov_b32_dpp v125, v95 row_ror:8 row_mask:0xf bank_mask:0xc
    v_mov_b32_dpp v126, v92 row_ror:8 row_mask:0xf bank_mask:0x3
    v_mov_b32_dpp v127, v93 row_ror:8 row_mask:0xf bank_mask:0x3
    s_add_u32 s26, s25, 10240
    buffer_store_dwordx4 v[124:127], v23, s[28:31], s26 offen sc1
    s_waitcnt vmcnt(19)
    v_dot2_f32_bf16 v12, v96, v20, v12
    v_dot2_f32_bf16 v13, v96, v96, v13
    v_dot2_f32_bf16 v12, v97, v20, v12
    v_dot2_f32_bf16 v13, v97, v97, v13
    v_dot2_f32_bf16 v12, v98, v20, v12
    v_dot2_f32_bf16 v13, v98, v98, v13
    v_dot2_f32_bf16 v12, v99, v20, v12
    v_dot2_f32_bf16 v13, v99, v99, v13
    v_mov_b32 v120, v96
    v_mov_b32 v121, v97
    v_mov_b32 v122, v98
    v_mov_b32 v123, v99
    v_mov_b32_dpp v120, v98 row_ror:8 row_mask:0xf bank_mask:0xc
    v_mov_b32_dpp v121, v99 row_ror:8 row_mask:0xf bank_mask:0xc
    v_mov_b32_dpp v122, v96 row_ror:8 row_mask:0xf bank_mask:0x3
    v_mov_b32_dpp v123, v97 row_ror:8 row_mask:0xf bank_mask:0x3
    s_add_u32 s26, s25, 12288
    buffer_store_dwordx4 v[120:123], v23, s[28:31], s26 offen sc1
    s_waitcnt vmcnt(19)
    v_dot2_f32_bf16 v12, v100, v20, v12
    v_dot2_f32_bf16 v13, v100, v100, v13
    v_dot2_f32_bf16 v12, v101, v20, v12
    v_dot2_f32_bf16 v13, v101, v101, v13
    v_dot2_f32_bf16 v12, v102, v20, v12
    v_dot2_f32_bf16 v13, v102, v102, v13
    v_dot2_f32_bf16 v12, v103, v20, v12
    v_dot2_f32_bf16 v13, v103, v103, v13
    v_mov_b32 v124, v100
    v_mov_b32 v125, v101
    v_mov_b32 v126, v102
    v_mov_b32 v127, v103
    v_mov_b32_dpp v124, v102 row_ror:8 row_mask:0xf bank_mask:0xc
    v_mov_b32_dpp v125, v103 row_ror:8 row_mask:0xf bank_mask:0xc
    v_mov_b32_dpp v126, v100 row_ror:8 row_mask:0xf bank_mask:0x3
    v_mov_b32_dpp v127, v101 row_ror:8 row_mask:0xf bank_mask:0x3
    s_add_u32 s26, s25, 14336
    buffer_store_dwordx4 v[124:127], v23, s[28:31], s26 offen sc1
    s_waitcnt vmcnt(19)
    v_dot2_f32_bf16 v12, v104, v20, v12
    v_dot2_f32_bf16 v13, v104, v104, v13
    v_dot2_f32_bf16 v12, v105, v20, v12
    v_dot2_f32_bf16 v13, v105, v105, v13
    v_dot2_f32_bf16 v12, v106, v20, v12
    v_dot2_f32_bf16 v13, v106, v106, v13
    v_dot2_f32_bf16 v12, v107, v20, v12
    v_dot2_f32_bf16 v13, v107, v107, v13
    v_mov_b32 v120, v104
    v_mov_b32 v121, v105
    v_mov_b32 v122, v106
    v_mov_b32 v123, v107
    v_mov_b32_dpp v120, v106 row_ror:8 row_mask:0xf bank_mask:0xc
    v_mov_b32_dpp v121, v107 row_ror:8 row_mask:0xf bank_mask:0xc
    v_mov_b32_dpp v122, v104 row_ror:8 row_mask:0xf bank_mask:0x3
    v_mov_b32_dpp v123, v105 row_ror:8 row_mask:0xf bank_mask:0x3
    s_add_u32 s26, s25, 16384
    buffer_store_dwordx4 v[120:123], v23, s[28:31], s26 offen sc1
    s_waitcnt vmcnt(19)
    v_dot2_f32_bf16 v12, v108, v20, v12
    v_dot2_f32_bf16 v13, v108, v108, v13
    v_dot2_f32_bf16 v12, v109, v20, v12
    v_dot2_f32_bf16 v13, v109, v109, v13
    v_dot2_f32_bf16 v12, v110, v20, v12
    v_dot2_f32_bf16 v13, v110, v110, v13
    v_dot2_f32_bf16 v12, v111, v20, v12
    v_dot2_f32_bf16 v13, v111, v111, v13
    v_mov_b32 v124, v108
    v_mov_b32 v125, v109
    v_mov_b32 v126, v110
    v_mov_b32 v127, v111
    v_mov_b32_dpp v124, v110 row_ror:8 row_mask:0xf bank_mask:0xc
    v_mov_b32_dpp v125, v111 row_ror:8 row_mask:0xf bank_mask:0xc
    v_mov_b32_dpp v126, v108 row_ror:8 row_mask:0xf bank_mask:0x3
    v_mov_b32_dpp v127, v109 row_ror:8 row_mask:0xf bank_mask:0x3
    s_add_u32 s26, s25, 18432
    buffer_store_dwordx4 v[124:127], v23, s[28:31], s26 offen sc1
    s_nop 2
    v_add_f32_dpp v10, v10, v10 quad_perm:[1,0,3,2] row_mask:0xf bank_mask:0xf
    v_add_f32_dpp v11, v11, v11 quad_perm:[1,0,3,2] row_mask:0xf bank_mask:0xf
    v_add_f32_dpp v12, v12, v12 quad_perm:[1,0,3,2] row_mask:0xf bank_mask:0xf
    v_add_f32_dpp v13, v13, v13 quad_perm:[1,0,3,2] row_mask:0xf bank_mask:0xf
    v_add_f32_dpp v10, v10, v10 quad_perm:[2,3,0,1] row_mask:0xf bank_mask:0xf
    v_add_f32_dpp v11, v11, v11 quad_perm:[2,3,0,1] row_mask:0xf bank_mask:0xf
    v_add_f32_dpp v12, v12, v12 quad_perm:[2,3,0,1] row_mask:0xf bank_mask:0xf
    v_add_f32_dpp v13, v13, v13 quad_perm:[2,3,0,1] row_mask:0xf bank_mask:0xf
    v_add_f32_dpp v10, v10, v10 row_half_mirror row_mask:0xf bank_mask:0xf
    v_add_f32_dpp v11, v11, v11 row_half_mirror row_mask:0xf bank_mask:0xf
    v_add_f32_dpp v12, v12, v12 row_half_mirror row_mask:0xf bank_mask:0xf
    v_add_f32_dpp v13, v13, v13 row_half_mirror row_mask:0xf bank_mask:0xf
    v_mul_f32 v10, 0x3acccccd, v10
    v_mul_f32 v12, 0x3acccccd, v12
    v_mul_f32 v11, 0x3acccccd, v11
    v_mul_f32 v13, 0x3acccccd, v13
    v_fma_f32 v11, -v10, v10, v11
    v_fma_f32 v13, -v12, v12, v13
    v_max_f32 v11, 0, v11
    v_max_f32 v13, 0, v13
    v_cvt_pk_bf16_f32 v24, v10, v11
    v_cvt_pk_bf16_f32 v25, v12, v13
    v_lshlrev_b32 v10, 16, v24
    v_lshlrev_b32 v12, 16, v25
    v_and_b32 v11, 0xffff0000, v24
    v_and_b32 v13, 0xffff0000, v25
    v_add_f32 v11, 0x3727c5ac, v11
    v_add_f32 v13, 0x3727c5ac, v13
    v_cvt_pk_bf16_f32 v24, v11, v11
    v_cvt_pk_bf16_f32 v25, v13, v13
    v_lshlrev_b32 v11, 16, v24
    v_lshlrev_b32 v13, 16, v25
    v_sqrt_f32 v11, v11
    v_sqrt_f32 v13, v13
    s_nop 0
    s_nop 0
    v_cvt_pk_bf16_f32 v24, v11, v11
    v_cvt_pk_bf16_f32 v25, v13, v13
    v_lshlrev_b32 v11, 16, v24
    v_lshlrev_b32 v13, 16, v25
    v_rcp_f32 v11, v11
    v_rcp_f32 v13, v13
    s_nop 0
    s_nop 0
    v_mul_f32 v10, v10, v11
    v_mul_f32 v12, v12, v13
    v_sub_f32 v10, 0, v10
    v_sub_f32 v12, 0, v12
    v_lshlrev_b32 v7, 3, v7
    v_cmp_eq_u32 vcc, 0, v6
    s_lshl_b32 s44, s21, 7
    s_add_u32 s44, s44, 29683712
    s_mov_b32 s23, 5476352
    s_and_saveexec_b64 s[66:67], vcc
    buffer_store_dwordx2 v[10:11], v7, s[28:31], s23 offen offset:0 sc1
    buffer_store_dwordx2 v[12:13], v7, s[28:31], s23 offen offset:64 sc1
    s_mov_b64 exec, -1
    s_waitcnt vmcnt(0)
    s_mov_b32 s47, 0
prep_kernel_nn8:
    v_readfirstlane_b32 s46, v250
    s_add_u32 s47, s47, 1
    s_cmp_lg_u32 s46, 0
    s_cbranch_scc1 prep_kernel_nd9
    s_cmp_ge_u32 s47, 200000
    s_cbranch_scc1 prep_kernel_nd9
    buffer_load_dword v250, v251, s[48:51], 0 offen sc1
    s_waitcnt vmcnt(0)
    s_branch prep_kernel_nn8
prep_kernel_nd9:
    v_mov_b32 v30, s46
    v_mov_b32 v31, 0
    s_mov_b64 exec, 1
    buffer_store_dword v30, v31, s[28:31], s44 offen sc1
    s_endpgm
p_misc:
    s_sub_u32 s24, s20, 3
    s_mul_i32 s23, s24, 96
    s_add_u32 s23, s23, s21
    s_cmp_ge_u32 s23, 256
    s_cbranch_scc1 prep_end
    s_mul_i32 s22, s24, 12
    s_lshr_b32 s25, s21, 3
    s_add_u32 s22, s22, s25
    v_lshlrev_b32 v1, 4, v1
    v_mov_b32 v60, 0
    v_mov_b32 v61, 0
    v_mov_b32 v62, 0
    v_mov_b32 v63, 0
    s_lshl_b32 s24, s23, 10
    s_add_u32 s25, s24, 29380608
    s_add_u32 s26, s24, 10784768
    s_add_u32 s27, s24, 13365248
    s_cmp_ge_u32 s23, 20
    s_cselect_b32 s26, s27, s26
    s_cmp_ge_u32 s23, 256
    s_cbranch_scc1 prep_kernel_nz10
    buffer_store_dwordx4 v[60:63], v1, s[28:31], s25 offen sc1
prep_kernel_nz10:
    s_cmp_ge_u32 s23, 40
    s_cbranch_scc1 prep_kernel_nz11
    buffer_store_dwordx4 v[60:63], v1, s[28:31], s26 offen sc1
prep_kernel_nz11:
    s_getpc_b64 s[24:25]
p_pcref:
    s_sub_u32 s24, s24, p_pcref-prep_kernel
    s_subb_u32 s25, s25, 0
    s_lshl_b32 s23, s22, 11
    s_add_u32 s26, s23, 0
    s_min_u32 s26, s26, (chain_end-prep_kernel-1020)&0xfffffff0
    v_add_u32 v64, s26, v1
    v_mov_b32 v5, s25
    v_add_co_u32 v4, vcc, s24, v64
    v_addc_co_u32 v5, vcc, 0, v5, vcc
    global_load_dwordx4 v[72:75], v[4:5], off
    s_add_u32 s26, s23, 1024
    s_min_u32 s26, s26, (chain_end-prep_kernel-1020)&0xfffffff0
    v_add_u32 v64, s26, v1
    v_mov_b32 v5, s25
    v_add_co_u32 v4, vcc, s24, v64
    v_addc_co_u32 v5, vcc, 0, v5, vcc
    global_load_dwordx4 v[76:79], v[4:5], off
    s_waitcnt vmcnt(0)
    s_endpgm
p_conv:
    s_cmp_ge_u32 s20, 4
    s_cbranch_scc1 prep_end
    s_setprio 3
    s_and_b32 s21, s2, 7
    s_mul_i32 s21, s21, 20
    s_sub_u32 s2, s2, 256
    s_lshr_b32 s2, s2, 3
    s_add_u32 s2, s2, s21
    s_mov_b32 s24, s56
    s_mov_b32 s25, s57
    s_mov_b32 s26, 2621440
    s_mov_b32 s27, 0x00020000
    s_lshl_b32 s21, s2, 3
    s_add_u32 s22, s58, s21
    s_addc_u32 s23, s59, 0
    s_load_dwordx2 s[32:33], s[22:23], 0
    s_lshl_b32 s21, s2, 2
    s_add_u32 s21, s21, s20
    s_mul_i32 s34, s20, 13824
    v_lshlrev_b32 v3, 4, v1
    s_lshl_b32 s35, s21, 12
    s_add_u32 s36, s34, 256
    s_mov_b32 m0, s36
    s_mul_i32 s37, s21, 4352
    s_add_u32 s37, s37, 0
    buffer_load_dwordx4 v3, s[24:27], s35 offen offset:0 nt lds
    buffer_load_dwordx4 v3, s[24:27], s35 offen offset:1024 nt lds
    buffer_load_dwordx4 v3, s[24:27], s35 offen offset:2048 nt lds
    buffer_load_dwordx4 v3, s[24:27], s35 offen offset:3072 nt lds
    s_add_u32 s36, s34, 9728
    s_mov_b32 m0, s36
    s_add_u32 s40, s35, 8
    v_mov_b32 v16, 0
    buffer_load_dwordx4 v3, s[24:27], s40 offen offset:0 lds
    buffer_load_dwordx4 v3, s[24:27], s40 offen offset:1024 lds
    buffer_load_dwordx4 v3, s[24:27], s40 offen offset:2048 lds
    buffer_load_dwordx4 v3, s[24:27], s40 offen offset:3072 lds
    buffer_load_dwordx2 v[252:253], v16, s[24:27], s35 offen
    v_lshrrev_b32 v4, 3, v0
    v_mul_u32_u24 v4, 20480, v4
    s_lshr_b32 s38, s2, 1
    s_and_b32 s38, s38, 7
    v_and_b32 v5, 7, v0
    v_xor_b32 v5, s38, v5
    v_lshl_add_u32 v4, v5, 4, v4
    s_lshl_b32 s38, s2, 7
    v_mov_b32 v16, 0
    buffer_load_dword v17, v16, s[48:51], 0 offen sc1
    s_waitcnt vmcnt(0)
    s_mov_b32 s47, 0
prep_kernel_nn12:
    v_readfirstlane_b32 s46, v17
    s_add_u32 s47, s47, 1
    s_cmp_lg_u32 s46, 0
    s_cbranch_scc1 prep_kernel_nd13
    s_cmp_ge_u32 s47, 200000
    s_cbranch_scc1 prep_kernel_nd13
    buffer_load_dword v17, v16, s[48:51], 0 offen sc1
    s_waitcnt vmcnt(0)
    s_branch prep_kernel_nn12
prep_kernel_nd13:
    s_lshr_b32 s40, s2, 4
    s_lshl_b32 s40, s40, 12
    s_add_u32 s40, s40, 29642752
    v_lshlrev_b32 v16, 7, v1
    s_cmp_lg_u32 s20, 0
    s_cbranch_scc1 prep_kernel_w014
    s_mov_b32 s47, 0
    s_mov_b32 exec_lo, -1
    s_mov_b32 exec_hi, 0
prep_kernel_pl15:
    buffer_load_dword v17, v16, s[28:31], s40 offen sc1
    s_add_u32 s47, s47, 1
    s_waitcnt vmcnt(0)
    v_cmp_ne_u32 vcc, s46, v17
    s_cmp_ge_u32 s47, 200000
    s_cbranch_scc1 prep_kernel_pd16
    s_cbranch_vccz prep_kernel_pd16
    s_sleep 8
    s_branch prep_kernel_pl15
prep_kernel_pd16:
    s_mov_b64 exec, -1
prep_kernel_w014:
    s_barrier
    s_add_u32 s36, s34, 4352
    s_mov_b32 m0, s36
    s_nop 0
    buffer_load_dwordx4 v3, s[28:31], s37 offen offset:0 sc1 lds
    buffer_load_dwordx4 v3, s[28:31], s37 offen offset:1024 sc1 lds
    buffer_load_dwordx4 v3, s[28:31], s37 offen offset:2048 sc1 lds
    buffer_load_dwordx4 v3, s[28:31], s37 offen offset:3072 sc1 lds
    s_add_u32 s36, s34, 8448
    s_mov_b32 m0, s36
    s_add_u32 s37, s37, 4096
    buffer_load_dwordx4 v3, s[28:31], s37 offen sc1 lds
    v_lshl_add_u32 v5, v1, 2, s34
    v_mov_b32 v6, 0
    ds_write_b32 v5, v6
    ds_write_b32 v5, v6 offset:9472
    v_and_b32 v7, 15, v1
    v_bfe_u32 v8, v1, 4, 1
    v_lshrrev_b32 v9, 5, v1
    v_mul_u32_u24 v10, 272, v7
    v_lshl_add_u32 v10, v9, 4, v10
    v_add_u32 v10, s34, v10
    v_add_u32 v10, 4356, v10
    v_lshlrev_b32 v11, 2, v8
    v_sub_u32 v10, v10, v11
    v_and_b32 v12, 7, v1
    v_mul_u32_u24 v13, 272, v12
    v_lshl_add_u32 v13, v9, 4, v13
    v_add_u32 v13, s34, v13
    v_add_u32 v13, 4356, v13
    v_sub_u32 v13, v13, v11
    v_bfe_u32 v11, v1, 3, 1
    v_lshlrev_b32 v11, 4, v11
    v_sub_u32 v11, 16, v11
    v_and_b32 v14, 31, v1
    v_lshlrev_b32 v14, 3, v14
    v_lshl_add_u32 v14, v9, 4, v14
    v_add_u32 v14, s34, v14
    v_and_b32 v17, 1, v1
    v_mul_u32_u24 v17, 9464, v17
    v_sub_u32 v17, 9472, v17
    v_add_u32 v14, v17, v14
    v_cmp_ne_u32 vcc, 0, v12
    v_mov_b32 v16, 0
    s_nop 1
    v_cndmask_b32 v15, v16, -1, vcc
    s_add_u32 s36, s34, 9720
    v_mov_b32 v17, s36
    s_waitcnt vmcnt(0) lgkmcnt(0)
    s_mov_b64 exec, 1
    ds_write_b64 v17, v[252:253]
    s_mov_b64 exec, -1
    s_waitcnt lgkmcnt(0)
    ds_read_b128 v[176:179], v14 offset:1792
    ds_read_b128 v[180:183], v14 offset:1824
    ds_read_b128 v[184:187], v14 offset:1856
    ds_read_b128 v[188:191], v14 offset:1888
    ds_read_b128 v[192:195], v14 offset:1920
    ds_read_b128 v[196:199], v14 offset:1952
    ds_read_b128 v[200:203], v14 offset:1984
    ds_read_b128 v[204:207], v14 offset:2016
    ds_read2_b32 v[64:65], v10 offset0:0 offset1:1
    ds_read2_b32 v[66:67], v10 offset0:2 offset1:3
    ds_read2_b32 v[68:69], v10 offset0:8 offset1:9
    ds_read2_b32 v[70:71], v10 offset0:10 offset1:11
    ds_read2_b32 v[72:73], v10 offset0:16 offset1:17
    ds_read2_b32 v[74:75], v10 offset0:18 offset1:19
    ds_read2_b32 v[76:77], v10 offset0:24 offset1:25
    ds_read2_b32 v[78:79], v10 offset0:26 offset1:27
    ds_read2_b32 v[80:81], v10 offset0:32 offset1:33
    ds_read2_b32 v[82:83], v10 offset0:34 offset1:35
    ds_read2_b32 v[84:85], v10 offset0:40 offset1:41
    ds_read2_b32 v[86:87], v10 offset0:42 offset1:43
    ds_read2_b32 v[88:89], v10 offset0:48 offset1:49
    ds_read2_b32 v[90:91], v10 offset0:50 offset1:51
    ds_read2_b32 v[92:93], v10 offset0:56 offset1:57
    ds_read2_b32 v[94:95], v10 offset0:58 offset1:59
    s_waitcnt lgkmcnt(0)
    v_mfma_f32_32x32x16_bf16 v[144:159], v[176:179], v[64:67], 0
    ds_read_b32 v16, v10 offset:16
    ds_read_b32 v17, v10 offset:48
    ds_read_b32 v18, v10 offset:80
    ds_read_b32 v19, v10 offset:112
    ds_read_b32 v20, v10 offset:144
    ds_read_b32 v21, v10 offset:176
    ds_read_b32 v22, v10 offset:208
    ds_read_b32 v23, v10 offset:240
    ds_read2_b32 v[96:97], v13 offset0:0 offset1:1
    ds_read2_b32 v[98:99], v13 offset0:2 offset1:3
    ds_read_b32 v24, v13 offset:16
    ds_read2_b32 v[100:101], v13 offset0:8 offset1:9
    ds_read2_b32 v[102:103], v13 offset0:10 offset1:11
    ds_read_b32 v25, v13 offset:48
    ds_read2_b32 v[104:105], v13 offset0:16 offset1:17
    ds_read2_b32 v[106:107], v13 offset0:18 offset1:19
    v_mfma_f32_32x32x16_bf16 v[144:159], v[180:183], v[68:71], v[144:159]
    ds_read_b32 v26, v13 offset:80
    ds_read2_b32 v[108:109], v13 offset0:24 offset1:25
    ds_read2_b32 v[110:111], v13 offset0:26 offset1:27
    ds_read_b32 v27, v13 offset:112
    ds_read2_b32 v[112:113], v13 offset0:32 offset1:33
    ds_read2_b32 v[114:115], v13 offset0:34 offset1:35
    ds_read_b32 v28, v13 offset:144
    ds_read2_b32 v[116:117], v13 offset0:40 offset1:41
    ds_read2_b32 v[118:119], v13 offset0:42 offset1:43
    ds_read_b32 v29, v13 offset:176
    ds_read2_b32 v[120:121], v13 offset0:48 offset1:49
    ds_read2_b32 v[122:123], v13 offset0:50 offset1:51
    ds_read_b32 v30, v13 offset:208
    ds_read2_b32 v[124:125], v13 offset0:56 offset1:57
    ds_read2_b32 v[126:127], v13 offset0:58 offset1:59
    ds_read_b32 v31, v13 offset:240
    v_mfma_f32_32x32x16_bf16 v[144:159], v[184:187], v[72:75], v[144:159]
    s_waitcnt lgkmcnt(15)
    s_waitcnt lgkmcnt(0)
    v_alignbit_b32 v32, v65, v64, 16
    v_alignbit_b32 v33, v66, v65, 16
    v_alignbit_b32 v34, v67, v66, 16
    v_alignbit_b32 v35, v16, v67, 16
    v_mfma_f32_32x32x16_bf16 v[144:159], v[188:191], v[76:79], v[144:159]
    v_alignbit_b32 v36, v69, v68, 16
    v_alignbit_b32 v37, v70, v69, 16
    v_alignbit_b32 v38, v71, v70, 16
    v_alignbit_b32 v39, v17, v71, 16
    v_alignbit_b32 v40, v73, v72, 16
    v_alignbit_b32 v41, v74, v73, 16
    v_mfma_f32_32x32x16_bf16 v[144:159], v[192:195], v[80:83], v[144:159]
    v_alignbit_b32 v42, v75, v74, 16
    v_alignbit_b32 v43, v18, v75, 16
    v_alignbit_b32 v44, v77, v76, 16
    v_alignbit_b32 v45, v78, v77, 16
    v_alignbit_b32 v46, v79, v78, 16
    v_alignbit_b32 v47, v19, v79, 16
    v_mfma_f32_32x32x16_bf16 v[144:159], v[196:199], v[84:87], v[144:159]
    v_alignbit_b32 v48, v81, v80, 16
    v_alignbit_b32 v49, v82, v81, 16
    v_alignbit_b32 v50, v83, v82, 16
    v_alignbit_b32 v51, v20, v83, 16
    v_alignbit_b32 v52, v85, v84, 16
    v_alignbit_b32 v53, v86, v85, 16
    v_mfma_f32_32x32x16_bf16 v[144:159], v[200:203], v[88:91], v[144:159]
    v_alignbit_b32 v54, v87, v86, 16
    v_alignbit_b32 v55, v21, v87, 16
    v_alignbit_b32 v56, v89, v88, 16
    v_alignbit_b32 v57, v90, v89, 16
    v_alignbit_b32 v58, v91, v90, 16
    v_alignbit_b32 v59, v22, v91, 16
    v_mfma_f32_32x32x16_bf16 v[144:159], v[204:207], v[92:95], v[144:159]
    v_alignbit_b32 v60, v93, v92, 16
    v_alignbit_b32 v61, v94, v93, 16
    v_alignbit_b32 v62, v95, v94, 16
    v_alignbit_b32 v63, v23, v95, 16
    s_nop 0
    v_mfma_f32_32x32x16_bf16 v[128:143], v[176:179], v[32:35], 0
    ds_read_b128 v[208:211], v14 offset:3840
    s_nop 3
    v_mfma_f32_32x32x16_bf16 v[128:143], v[180:183], v[36:39], v[128:143]
    ds_read_b128 v[212:215], v14 offset:3872
    s_nop 3
    v_mfma_f32_32x32x16_bf16 v[128:143], v[184:187], v[40:43], v[128:143]
    ds_read_b128 v[216:219], v14 offset:3904
    v_alignbit_b32 v96, v97, v96, v11
    v_alignbit_b32 v97, v98, v97, v11
    v_alignbit_b32 v98, v99, v98, v11
    v_alignbit_b32 v99, v24, v99, v11
    v_alignbit_b32 v100, v101, v100, v11
    v_alignbit_b32 v101, v102, v101, v11
    v_alignbit_b32 v102, v103, v102, v11
    v_alignbit_b32 v103, v25, v103, v11
    v_alignbit_b32 v104, v105, v104, v11
    v_mfma_f32_32x32x16_bf16 v[128:143], v[188:191], v[44:47], v[128:143]
    ds_read_b128 v[220:223], v14 offset:3936
    v_alignbit_b32 v105, v106, v105, v11
    v_alignbit_b32 v106, v107, v106, v11
    v_alignbit_b32 v107, v26, v107, v11
    v_alignbit_b32 v108, v109, v108, v11
    v_alignbit_b32 v109, v110, v109, v11
    v_alignbit_b32 v110, v111, v110, v11
    v_alignbit_b32 v111, v27, v111, v11
    v_mov_b32_dpp v144, v144 row_shr:1 row_mask:0xf bank_mask:0xf bound_ctrl:0
    v_mfma_f32_32x32x16_bf16 v[128:143], v[192:195], v[48:51], v[128:143]
    ds_read_b128 v[224:227], v14 offset:3968
    v_mov_b32_dpp v145, v145 row_shr:1 row_mask:0xf bank_mask:0xf bound_ctrl:0
    v_mov_b32_dpp v146, v146 row_shr:1 row_mask:0xf bank_mask:0xf bound_ctrl:0
    v_mov_b32_dpp v147, v147 row_shr:1 row_mask:0xf bank_mask:0xf bound_ctrl:0
    v_mov_b32_dpp v148, v148 row_shr:1 row_mask:0xf bank_mask:0xf bound_ctrl:0
    v_mov_b32_dpp v149, v149 row_shr:1 row_mask:0xf bank_mask:0xf bound_ctrl:0
    v_mov_b32_dpp v150, v150 row_shr:1 row_mask:0xf bank_mask:0xf bound_ctrl:0
    v_mov_b32_dpp v151, v151 row_shr:1 row_mask:0xf bank_mask:0xf bound_ctrl:0
    v_mov_b32_dpp v152, v152 row_shr:1 row_mask:0xf bank_mask:0xf bound_ctrl:0
    v_mfma_f32_32x32x16_bf16 v[128:143], v[196:199], v[52:55], v[128:143]
    ds_read_b128 v[228:231], v14 offset:4000
    v_mov_b32_dpp v153, v153 row_shr:1 row_mask:0xf bank_mask:0xf bound_ctrl:0
    v_mov_b32_dpp v154, v154 row_shr:1 row_mask:0xf bank_mask:0xf bound_ctrl:0
    v_mov_b32_dpp v155, v155 row_shr:1 row_mask:0xf bank_mask:0xf bound_ctrl:0
    v_mov_b32_dpp v156, v156 row_shr:1 row_mask:0xf bank_mask:0xf bound_ctrl:0
    v_mov_b32_dpp v157, v157 row_shr:1 row_mask:0xf bank_mask:0xf bound_ctrl:0
    v_mov_b32_dpp v158, v158 row_shr:1 row_mask:0xf bank_mask:0xf bound_ctrl:0
    v_mov_b32_dpp v159, v159 row_shr:1 row_mask:0xf bank_mask:0xf bound_ctrl:0
    v_alignbit_b32 v112, v113, v112, v11
    v_mfma_f32_32x32x16_bf16 v[128:143], v[200:203], v[56:59], v[128:143]
    ds_read_b128 v[232:235], v14 offset:4032
    v_alignbit_b32 v113, v114, v113, v11
    v_alignbit_b32 v114, v115, v114, v11
    v_alignbit_b32 v115, v28, v115, v11
    v_alignbit_b32 v116, v117, v116, v11
    v_alignbit_b32 v117, v118, v117, v11
    v_alignbit_b32 v118, v119, v118, v11
    v_alignbit_b32 v119, v29, v119, v11
    v_alignbit_b32 v120, v121, v120, v11
    v_mfma_f32_32x32x16_bf16 v[128:143], v[204:207], v[60:63], v[128:143]
    ds_read_b128 v[236:239], v14 offset:4064
    v_alignbit_b32 v121, v122, v121, v11
    v_alignbit_b32 v122, v123, v122, v11
    v_alignbit_b32 v123, v30, v123, v11
    v_alignbit_b32 v124, v125, v124, v11
    v_alignbit_b32 v125, v126, v125, v11
    v_alignbit_b32 v126, v127, v126, v11
    v_alignbit_b32 v127, v31, v127, v11
    s_nop 0
    s_waitcnt lgkmcnt(0)
    v_mfma_f32_32x32x16_bf16 v[160:175], v[208:211], v[96:99], 0
    ds_read_b128 v[176:179], v14 offset:1536
    ds_read_b128 v[180:183], v14 offset:1568
    s_nop 2
    v_mfma_f32_32x32x16_bf16 v[160:175], v[212:215], v[100:103], v[160:175]
    ds_read_b128 v[184:187], v14 offset:1600
    ds_read_b128 v[188:191], v14 offset:1632
    s_nop 2
    v_mfma_f32_32x32x16_bf16 v[160:175], v[216:219], v[104:107], v[160:175]
    ds_read_b128 v[192:195], v14 offset:1664
    ds_read_b128 v[196:199], v14 offset:1696
    v_mov_b32_dpp v128, v128 row_shr:1 row_mask:0xf bank_mask:0xf bound_ctrl:0
    v_mov_b32_dpp v129, v129 row_shr:1 row_mask:0xf bank_mask:0xf bound_ctrl:0
    v_mov_b32_dpp v130, v130 row_shr:1 row_mask:0xf bank_mask:0xf bound_ctrl:0
    v_mfma_f32_32x32x16_bf16 v[160:175], v[220:223], v[108:111], v[160:175]
    ds_read_b128 v[200:203], v14 offset:1728
    v_mov_b32_dpp v131, v131 row_shr:1 row_mask:0xf bank_mask:0xf bound_ctrl:0
    v_mov_b32_dpp v132, v132 row_shr:1 row_mask:0xf bank_mask:0xf bound_ctrl:0
    v_mov_b32_dpp v133, v133 row_shr:1 row_mask:0xf bank_mask:0xf bound_ctrl:0
    v_mfma_f32_32x32x16_bf16 v[160:175], v[224:227], v[112:115], v[160:175]
    ds_read_b128 v[204:207], v14 offset:1760
    v_mov_b32_dpp v134, v134 row_shr:1 row_mask:0xf bank_mask:0xf bound_ctrl:0
    v_mov_b32_dpp v135, v135 row_shr:1 row_mask:0xf bank_mask:0xf bound_ctrl:0
    v_mov_b32_dpp v136, v136 row_shr:1 row_mask:0xf bank_mask:0xf bound_ctrl:0
    v_mfma_f32_32x32x16_bf16 v[160:175], v[228:231], v[116:119], v[160:175]
    v_mov_b32_dpp v137, v137 row_shr:1 row_mask:0xf bank_mask:0xf bound_ctrl:0
    v_mov_b32_dpp v138, v138 row_shr:1 row_mask:0xf bank_mask:0xf bound_ctrl:0
    v_mov_b32_dpp v139, v139 row_shr:1 row_mask:0xf bank_mask:0xf bound_ctrl:0
    v_mfma_f32_32x32x16_bf16 v[160:175], v[232:235], v[120:123], v[160:175]
    v_mov_b32_dpp v140, v140 row_shr:1 row_mask:0xf bank_mask:0xf bound_ctrl:0
    v_mov_b32_dpp v141, v141 row_shr:1 row_mask:0xf bank_mask:0xf bound_ctrl:0
    v_mfma_f32_32x32x16_bf16 v[160:175], v[236:239], v[124:127], v[160:175]
    v_mov_b32_dpp v142, v142 row_shr:1 row_mask:0xf bank_mask:0xf bound_ctrl:0
    v_mov_b32_dpp v143, v143 row_shr:1 row_mask:0xf bank_mask:0xf bound_ctrl:0
    s_waitcnt lgkmcnt(0)
    v_mfma_f32_32x32x16_bf16 v[144:159], v[176:179], v[64:67], v[144:159]
    ds_read_b128 v[208:211], v14 offset:3584
    s_nop 3
    v_mfma_f32_32x32x16_bf16 v[144:159], v[180:183], v[68:71], v[144:159]
    ds_read_b128 v[212:215], v14 offset:3616
    s_nop 3
    v_mfma_f32_32x32x16_bf16 v[144:159], v[184:187], v[72:75], v[144:159]
    ds_read_b128 v[216:219], v14 offset:3648
    v_and_b32_dpp v160, v160, v15 row_shr:1 row_mask:0xf bank_mask:0xf bound_ctrl:0
    v_and_b32_dpp v161, v161, v15 row_shr:1 row_mask:0xf bank_mask:0xf bound_ctrl:0
    v_and_b32_dpp v162, v162, v15 row_shr:1 row_mask:0xf bank_mask:0xf bound_ctrl:0
    v_mfma_f32_32x32x16_bf16 v[144:159], v[188:191], v[76:79], v[144:159]
    ds_read_b128 v[220:223], v14 offset:3680
    v_and_b32_dpp v163, v163, v15 row_shr:1 row_mask:0xf bank_mask:0xf bound_ctrl:0
    v_and_b32_dpp v164, v164, v15 row_shr:1 row_mask:0xf bank_mask:0xf bound_ctrl:0
    v_and_b32_dpp v165, v165, v15 row_shr:1 row_mask:0xf bank_mask:0xf bound_ctrl:0
    v_mfma_f32_32x32x16_bf16 v[144:159], v[192:195], v[80:83], v[144:159]
    ds_read_b128 v[224:227], v14 offset:3712
    v_and_b32_dpp v166, v166, v15 row_shr:1 row_mask:0xf bank_mask:0xf bound_ctrl:0
    v_and_b32_dpp v167, v167, v15 row_shr:1 row_mask:0xf bank_mask:0xf bound_ctrl:0
    v_and_b32_dpp v168, v168, v15 row_shr:1 row_mask:0xf bank_mask:0xf bound_ctrl:0
    v_mfma_f32_32x32x16_bf16 v[144:159], v[196:199], v[84:87], v[144:159]
    ds_read_b128 v[228:231], v14 offset:3744
    v_and_b32_dpp v169, v169, v15 row_shr:1 row_mask:0xf bank_mask:0xf bound_ctrl:0
    v_and_b32_dpp v170, v170, v15 row_shr:1 row_mask:0xf bank_mask:0xf bound_ctrl:0
    v_and_b32_dpp v171, v171, v15 row_shr:1 row_mask:0xf bank_mask:0xf bound_ctrl:0
    v_mfma_f32_32x32x16_bf16 v[144:159], v[200:203], v[88:91], v[144:159]
    ds_read_b128 v[232:235], v14 offset:3776
    v_and_b32_dpp v172, v172, v15 row_shr:1 row_mask:0xf bank_mask:0xf bound_ctrl:0
    v_and_b32_dpp v173, v173, v15 row_shr:1 row_mask:0xf bank_mask:0xf bound_ctrl:0
    v_mfma_f32_32x32x16_bf16 v[144:159], v[204:207], v[92:95], v[144:159]
    ds_read_b128 v[236:239], v14 offset:3808
    v_and_b32_dpp v174, v174, v15 row_shr:1 row_mask:0xf bank_mask:0xf bound_ctrl:0
    v_and_b32_dpp v175, v175, v15 row_shr:1 row_mask:0xf bank_mask:0xf bound_ctrl:0
    v_mfma_f32_32x32x16_bf16 v[128:143], v[176:179], v[32:35], v[128:143]
    s_nop 4
    v_mfma_f32_32x32x16_bf16 v[128:143], v[180:183], v[36:39], v[128:143]
    s_nop 4
    v_mfma_f32_32x32x16_bf16 v[128:143], v[184:187], v[40:43], v[128:143]
    v_mov_b32_dpp v144, v144 row_shr:1 row_mask:0xf bank_mask:0xf bound_ctrl:0
    v_mov_b32_dpp v145, v145 row_shr:1 row_mask:0xf bank_mask:0xf bound_ctrl:0
    v_mov_b32_dpp v146, v146 row_shr:1 row_mask:0xf bank_mask:0xf bound_ctrl:0
    v_mfma_f32_32x32x16_bf16 v[128:143], v[188:191], v[44:47], v[128:143]
    v_mov_b32_dpp v147, v147 row_shr:1 row_mask:0xf bank_mask:0xf bound_ctrl:0
    v_mov_b32_dpp v148, v148 row_shr:1 row_mask:0xf bank_mask:0xf bound_ctrl:0
    v_mov_b32_dpp v149, v149 row_shr:1 row_mask:0xf bank_mask:0xf bound_ctrl:0
    v_mfma_f32_32x32x16_bf16 v[128:143], v[192:195], v[48:51], v[128:143]
    v_mov_b32_dpp v150, v150 row_shr:1 row_mask:0xf bank_mask:0xf bound_ctrl:0
    v_mov_b32_dpp v151, v151 row_shr:1 row_mask:0xf bank_mask:0xf bound_ctrl:0
    v_mov_b32_dpp v152, v152 row_shr:1 row_mask:0xf bank_mask:0xf bound_ctrl:0
    v_mfma_f32_32x32x16_bf16 v[128:143], v[196:199], v[52:55], v[128:143]
    v_mov_b32_dpp v153, v153 row_shr:1 row_mask:0xf bank_mask:0xf bound_ctrl:0
    v_mov_b32_dpp v154, v154 row_shr:1 row_mask:0xf bank_mask:0xf bound_ctrl:0
    v_mov_b32_dpp v155, v155 row_shr:1 row_mask:0xf bank_mask:0xf bound_ctrl:0
    v_mfma_f32_32x32x16_bf16 v[128:143], v[200:203], v[56:59], v[128:143]
    v_mov_b32_dpp v156, v156 row_shr:1 row_mask:0xf bank_mask:0xf bound_ctrl:0
    v_mov_b32_dpp v157, v157 row_shr:1 row_mask:0xf bank_mask:0xf bound_ctrl:0
    v_mfma_f32_32x32x16_bf16 v[128:143], v[204:207], v[60:63], v[128:143]
    v_mov_b32_dpp v158, v158 row_shr:1 row_mask:0xf bank_mask:0xf bound_ctrl:0
    v_mov_b32_dpp v159, v159 row_shr:1 row_mask:0xf bank_mask:0xf bound_ctrl:0
    s_waitcnt lgkmcnt(0)
    v_mfma_f32_32x32x16_bf16 v[160:175], v[208:211], v[96:99], v[160:175]
    ds_read_b128 v[176:179], v14 offset:1280
    ds_read_b128 v[180:183], v14 offset:1312
    s_nop 2
    v_mfma_f32_32x32x16_bf16 v[160:175], v[212:215], v[100:103], v[160:175]
    ds_read_b128 v[184:187], v14 offset:1344
    ds_read_b128 v[188:191], v14 offset:1376
    s_nop 2
    v_mfma_f32_32x32x16_bf16 v[160:175], v[216:219], v[104:107], v[160:175]
    ds_read_b128 v[192:195], v14 offset:1408
    ds_read_b128 v[196:199], v14 offset:1440
    v_mov_b32_dpp v128, v128 row_shr:1 row_mask:0xf bank_mask:0xf bound_ctrl:0
    v_mov_b32_dpp v129, v129 row_shr:1 row_mask:0xf bank_mask:0xf bound_ctrl:0
    v_mov_b32_dpp v130, v130 row_shr:1 row_mask:0xf bank_mask:0xf bound_ctrl:0
    v_mfma_f32_32x32x16_bf16 v[160:175], v[220:223], v[108:111], v[160:175]
    ds_read_b128 v[200:203], v14 offset:1472
    v_mov_b32_dpp v131, v131 row_shr:1 row_mask:0xf bank_mask:0xf bound_ctrl:0
    v_mov_b32_dpp v132, v132 row_shr:1 row_mask:0xf bank_mask:0xf bound_ctrl:0
    v_mov_b32_dpp v133, v133 row_shr:1 row_mask:0xf bank_mask:0xf bound_ctrl:0
    v_mfma_f32_32x32x16_bf16 v[160:175], v[224:227], v[112:115], v[160:175]
    ds_read_b128 v[204:207], v14 offset:1504
    v_mov_b32_dpp v134, v134 row_shr:1 row_mask:0xf bank_mask:0xf bound_ctrl:0
    v_mov_b32_dpp v135, v135 row_shr:1 row_mask:0xf bank_mask:0xf bound_ctrl:0
    v_mov_b32_dpp v136, v136 row_shr:1 row_mask:0xf bank_mask:0xf bound_ctrl:0
    v_mfma_f32_32x32x16_bf16 v[160:175], v[228:231], v[116:119], v[160:175]
    v_mov_b32_dpp v137, v137 row_shr:1 row_mask:0xf bank_mask:0xf bound_ctrl:0
    v_mov_b32_dpp v138, v138 row_shr:1 row_mask:0xf bank_mask:0xf bound_ctrl:0
    v_mov_b32_dpp v139, v139 row_shr:1 row_mask:0xf bank_mask:0xf bound_ctrl:0
    v_mfma_f32_32x32x16_bf16 v[160:175], v[232:235], v[120:123], v[160:175]
    v_mov_b32_dpp v140, v140 row_shr:1 row_mask:0xf bank_mask:0xf bound_ctrl:0
    v_mov_b32_dpp v141, v141 row_shr:1 row_mask:0xf bank_mask:0xf bound_ctrl:0
    v_mfma_f32_32x32x16_bf16 v[160:175], v[236:239], v[124:127], v[160:175]
    v_mov_b32_dpp v142, v142 row_shr:1 row_mask:0xf bank_mask:0xf bound_ctrl:0
    v_mov_b32_dpp v143, v143 row_shr:1 row_mask:0xf bank_mask:0xf bound_ctrl:0
    s_waitcnt lgkmcnt(0)
    v_mfma_f32_32x32x16_bf16 v[144:159], v[176:179], v[64:67], v[144:159]
    ds_read_b128 v[208:211], v14 offset:3328
    s_nop 3
    v_mfma_f32_32x32x16_bf16 v[144:159], v[180:183], v[68:71], v[144:159]
    ds_read_b128 v[212:215], v14 offset:3360
    s_nop 3
    v_mfma_f32_32x32x16_bf16 v[144:159], v[184:187], v[72:75], v[144:159]
    ds_read_b128 v[216:219], v14 offset:3392
    v_and_b32_dpp v160, v160, v15 row_shr:1 row_mask:0xf bank_mask:0xf bound_ctrl:0
    v_and_b32_dpp v161, v161, v15 row_shr:1 row_mask:0xf bank_mask:0xf bound_ctrl:0
    v_and_b32_dpp v162, v162, v15 row_shr:1 row_mask:0xf bank_mask:0xf bound_ctrl:0
    v_mfma_f32_32x32x16_bf16 v[144:159], v[188:191], v[76:79], v[144:159]
    ds_read_b128 v[220:223], v14 offset:3424
    v_and_b32_dpp v163, v163, v15 row_shr:1 row_mask:0xf bank_mask:0xf bound_ctrl:0
    v_and_b32_dpp v164, v164, v15 row_shr:1 row_mask:0xf bank_mask:0xf bound_ctrl:0
    v_and_b32_dpp v165, v165, v15 row_shr:1 row_mask:0xf bank_mask:0xf bound_ctrl:0
    v_mfma_f32_32x32x16_bf16 v[144:159], v[192:195], v[80:83], v[144:159]
    ds_read_b128 v[224:227], v14 offset:3456
    v_and_b32_dpp v166, v166, v15 row_shr:1 row_mask:0xf bank_mask:0xf bound_ctrl:0
    v_and_b32_dpp v167, v167, v15 row_shr:1 row_mask:0xf bank_mask:0xf bound_ctrl:0
    v_and_b32_dpp v168, v168, v15 row_shr:1 row_mask:0xf bank_mask:0xf bound_ctrl:0
    v_mfma_f32_32x32x16_bf16 v[144:159], v[196:199], v[84:87], v[144:159]
    ds_read_b128 v[228:231], v14 offset:3488
    v_and_b32_dpp v169, v169, v15 row_shr:1 row_mask:0xf bank_mask:0xf bound_ctrl:0
    v_and_b32_dpp v170, v170, v15 row_shr:1 row_mask:0xf bank_mask:0xf bound_ctrl:0
    v_and_b32_dpp v171, v171, v15 row_shr:1 row_mask:0xf bank_mask:0xf bound_ctrl:0
    v_mfma_f32_32x32x16_bf16 v[144:159], v[200:203], v[88:91], v[144:159]
    ds_read_b128 v[232:235], v14 offset:3520
    v_and_b32_dpp v172, v172, v15 row_shr:1 row_mask:0xf bank_mask:0xf bound_ctrl:0
    v_and_b32_dpp v173, v173, v15 row_shr:1 row_mask:0xf bank_mask:0xf bound_ctrl:0
    v_mfma_f32_32x32x16_bf16 v[144:159], v[204:207], v[92:95], v[144:159]
    ds_read_b128 v[236:239], v14 offset:3552
    v_and_b32_dpp v174, v174, v15 row_shr:1 row_mask:0xf bank_mask:0xf bound_ctrl:0
    v_and_b32_dpp v175, v175, v15 row_shr:1 row_mask:0xf bank_mask:0xf bound_ctrl:0
    v_mfma_f32_32x32x16_bf16 v[128:143], v[176:179], v[32:35], v[128:143]
    s_nop 4
    v_mfma_f32_32x32x16_bf16 v[128:143], v[180:183], v[36:39], v[128:143]
    s_nop 4
    v_mfma_f32_32x32x16_bf16 v[128:143], v[184:187], v[40:43], v[128:143]
    v_mov_b32_dpp v144, v144 row_shr:1 row_mask:0xf bank_mask:0xf bound_ctrl:0
    v_mov_b32_dpp v145, v145 row_shr:1 row_mask:0xf bank_mask:0xf bound_ctrl:0
    v_mov_b32_dpp v146, v146 row_shr:1 row_mask:0xf bank_mask:0xf bound_ctrl:0
    v_mfma_f32_32x32x16_bf16 v[128:143], v[188:191], v[44:47], v[128:143]
    v_mov_b32_dpp v147, v147 row_shr:1 row_mask:0xf bank_mask:0xf bound_ctrl:0
    v_mov_b32_dpp v148, v148 row_shr:1 row_mask:0xf bank_mask:0xf bound_ctrl:0
    v_mov_b32_dpp v149, v149 row_shr:1 row_mask:0xf bank_mask:0xf bound_ctrl:0
    v_mfma_f32_32x32x16_bf16 v[128:143], v[192:195], v[48:51], v[128:143]
    v_mov_b32_dpp v150, v150 row_shr:1 row_mask:0xf bank_mask:0xf bound_ctrl:0
    v_mov_b32_dpp v151, v151 row_shr:1 row_mask:0xf bank_mask:0xf bound_ctrl:0
    v_mov_b32_dpp v152, v152 row_shr:1 row_mask:0xf bank_mask:0xf bound_ctrl:0
    v_mfma_f32_32x32x16_bf16 v[128:143], v[196:199], v[52:55], v[128:143]
    v_mov_b32_dpp v153, v153 row_shr:1 row_mask:0xf bank_mask:0xf bound_ctrl:0
    v_mov_b32_dpp v154, v154 row_shr:1 row_mask:0xf bank_mask:0xf bound_ctrl:0
    v_mov_b32_dpp v155, v155 row_shr:1 row_mask:0xf bank_mask:0xf bound_ctrl:0
    v_mfma_f32_32x32x16_bf16 v[128:143], v[200:203], v[56:59], v[128:143]
    v_mov_b32_dpp v156, v156 row_shr:1 row_mask:0xf bank_mask:0xf bound_ctrl:0
    v_mov_b32_dpp v157, v157 row_shr:1 row_mask:0xf bank_mask:0xf bound_ctrl:0
    v_mfma_f32_32x32x16_bf16 v[128:143], v[204:207], v[60:63], v[128:143]
    v_mov_b32_dpp v158, v158 row_shr:1 row_mask:0xf bank_mask:0xf bound_ctrl:0
    v_mov_b32_dpp v159, v159 row_shr:1 row_mask:0xf bank_mask:0xf bound_ctrl:0
    s_waitcnt lgkmcnt(0)
    v_mfma_f32_32x32x16_bf16 v[160:175], v[208:211], v[96:99], v[160:175]
    ds_read_b128 v[176:179], v14 offset:1024
    ds_read_b128 v[180:183], v14 offset:1056
    s_nop 2
    v_mfma_f32_32x32x16_bf16 v[160:175], v[212:215], v[100:103], v[160:175]
    ds_read_b128 v[184:187], v14 offset:1088
    ds_read_b128 v[188:191], v14 offset:1120
    s_nop 2
    v_mfma_f32_32x32x16_bf16 v[160:175], v[216:219], v[104:107], v[160:175]
    ds_read_b128 v[192:195], v14 offset:1152
    ds_read_b128 v[196:199], v14 offset:1184
    v_mov_b32_dpp v128, v128 row_shr:1 row_mask:0xf bank_mask:0xf bound_ctrl:0
    v_mov_b32_dpp v129, v129 row_shr:1 row_mask:0xf bank_mask:0xf bound_ctrl:0
    v_mov_b32_dpp v130, v130 row_shr:1 row_mask:0xf bank_mask:0xf bound_ctrl:0
    v_mfma_f32_32x32x16_bf16 v[160:175], v[220:223], v[108:111], v[160:175]
    ds_read_b128 v[200:203], v14 offset:1216
    v_mov_b32_dpp v131, v131 row_shr:1 row_mask:0xf bank_mask:0xf bound_ctrl:0
    v_mov_b32_dpp v132, v132 row_shr:1 row_mask:0xf bank_mask:0xf bound_ctrl:0
    v_mov_b32_dpp v133, v133 row_shr:1 row_mask:0xf bank_mask:0xf bound_ctrl:0
    v_mfma_f32_32x32x16_bf16 v[160:175], v[224:227], v[112:115], v[160:175]
    ds_read_b128 v[204:207], v14 offset:1248
    v_mov_b32_dpp v134, v134 row_shr:1 row_mask:0xf bank_mask:0xf bound_ctrl:0
    v_mov_b32_dpp v135, v135 row_shr:1 row_mask:0xf bank_mask:0xf bound_ctrl:0
    v_mov_b32_dpp v136, v136 row_shr:1 row_mask:0xf bank_mask:0xf bound_ctrl:0
    v_mfma_f32_32x32x16_bf16 v[160:175], v[228:231], v[116:119], v[160:175]
    v_mov_b32_dpp v137, v137 row_shr:1 row_mask:0xf bank_mask:0xf bound_ctrl:0
    v_mov_b32_dpp v138, v138 row_shr:1 row_mask:0xf bank_mask:0xf bound_ctrl:0
    v_mov_b32_dpp v139, v139 row_shr:1 row_mask:0xf bank_mask:0xf bound_ctrl:0
    v_mfma_f32_32x32x16_bf16 v[160:175], v[232:235], v[120:123], v[160:175]
    v_mov_b32_dpp v140, v140 row_shr:1 row_mask:0xf bank_mask:0xf bound_ctrl:0
    v_mov_b32_dpp v141, v141 row_shr:1 row_mask:0xf bank_mask:0xf bound_ctrl:0
    v_mfma_f32_32x32x16_bf16 v[160:175], v[236:239], v[124:127], v[160:175]
    v_mov_b32_dpp v142, v142 row_shr:1 row_mask:0xf bank_mask:0xf bound_ctrl:0
    v_mov_b32_dpp v143, v143 row_shr:1 row_mask:0xf bank_mask:0xf bound_ctrl:0
    s_lshr_b32 s40, s2, 4
    s_lshl_b32 s40, s40, 9
    s_add_u32 s40, s40, 29700096
    s_mov_b32 s41, 29683712
    v_lshrrev_b32 v16, 2, v1
    v_mul_u32_u24 v16, 5120, v16
    v_and_b32 v17, 3, v1
    v_lshl_add_u32 v16, v17, 7, v16
    v_lshlrev_b32 v18, 7, v1
    v_mov_b32 v17, s46
    s_add_u32 s42, s41, 8192
    buffer_load_dword v19, v18, s[28:31], s41 offen sc1
    buffer_load_dword v28, v18, s[28:31], s42 offen sc1
    s_mov_b64 exec, 0xfff
    buffer_load_dword v17, v16, s[28:31], s40 offen sc1
    s_mov_b64 exec, -1
    s_waitcnt lgkmcnt(0)
    v_mfma_f32_32x32x16_bf16 v[144:159], v[176:179], v[64:67], v[144:159]
    ds_read_b128 v[208:211], v14 offset:3072
    s_nop 3
    v_mfma_f32_32x32x16_bf16 v[144:159], v[180:183], v[68:71], v[144:159]
    ds_read_b128 v[212:215], v14 offset:3104
    s_nop 3
    v_mfma_f32_32x32x16_bf16 v[144:159], v[184:187], v[72:75], v[144:159]
    ds_read_b128 v[216:219], v14 offset:3136
    v_and_b32_dpp v160, v160, v15 row_shr:1 row_mask:0xf bank_mask:0xf bound_ctrl:0
    v_and_b32_dpp v161, v161, v15 row_shr:1 row_mask:0xf bank_mask:0xf bound_ctrl:0
    v_and_b32_dpp v162, v162, v15 row_shr:1 row_mask:0xf bank_mask:0xf bound_ctrl:0
    v_mfma_f32_32x32x16_bf16 v[144:159], v[188:191], v[76:79], v[144:159]
    ds_read_b128 v[220:223], v14 offset:3168
    v_and_b32_dpp v163, v163, v15 row_shr:1 row_mask:0xf bank_mask:0xf bound_ctrl:0
    v_and_b32_dpp v164, v164, v15 row_shr:1 row_mask:0xf bank_mask:0xf bound_ctrl:0
    v_and_b32_dpp v165, v165, v15 row_shr:1 row_mask:0xf bank_mask:0xf bound_ctrl:0
    v_mfma_f32_32x32x16_bf16 v[144:159], v[192:195], v[80:83], v[144:159]
    ds_read_b128 v[224:227], v14 offset:3200
    v_and_b32_dpp v166, v166, v15 row_shr:1 row_mask:0xf bank_mask:0xf bound_ctrl:0
    v_and_b32_dpp v167, v167, v15 row_shr:1 row_mask:0xf bank_mask:0xf bound_ctrl:0
    v_and_b32_dpp v168, v168, v15 row_shr:1 row_mask:0xf bank_mask:0xf bound_ctrl:0
    v_mfma_f32_32x32x16_bf16 v[144:159], v[196:199], v[84:87], v[144:159]
    ds_read_b128 v[228:231], v14 offset:3232
    v_and_b32_dpp v169, v169, v15 row_shr:1 row_mask:0xf bank_mask:0xf bound_ctrl:0
    v_and_b32_dpp v170, v170, v15 row_shr:1 row_mask:0xf bank_mask:0xf bound_ctrl:0
    v_and_b32_dpp v171, v171, v15 row_shr:1 row_mask:0xf bank_mask:0xf bound_ctrl:0
    v_mfma_f32_32x32x16_bf16 v[144:159], v[200:203], v[88:91], v[144:159]
    ds_read_b128 v[232:235], v14 offset:3264
    v_and_b32_dpp v172, v172, v15 row_shr:1 row_mask:0xf bank_mask:0xf bound_ctrl:0
    v_and_b32_dpp v173, v173, v15 row_shr:1 row_mask:0xf bank_mask:0xf bound_ctrl:0
    v_mfma_f32_32x32x16_bf16 v[144:159], v[204:207], v[92:95], v[144:159]
    ds_read_b128 v[236:239], v14 offset:3296
    v_and_b32_dpp v174, v174, v15 row_shr:1 row_mask:0xf bank_mask:0xf bound_ctrl:0
    v_and_b32_dpp v175, v175, v15 row_shr:1 row_mask:0xf bank_mask:0xf bound_ctrl:0
    v_mfma_f32_32x32x16_bf16 v[128:143], v[176:179], v[32:35], v[128:143]
    s_nop 4
    v_mfma_f32_32x32x16_bf16 v[128:143], v[180:183], v[36:39], v[128:143]
    s_nop 4
    v_mfma_f32_32x32x16_bf16 v[128:143], v[184:187], v[40:43], v[128:143]
    v_mov_b32_dpp v144, v144 row_shr:1 row_mask:0xf bank_mask:0xf bound_ctrl:0
    v_mov_b32_dpp v145, v145 row_shr:1 row_mask:0xf bank_mask:0xf bound_ctrl:0
    v_mov_b32_dpp v146, v146 row_shr:1 row_mask:0xf bank_mask:0xf bound_ctrl:0
    v_mfma_f32_32x32x16_bf16 v[128:143], v[188:191], v[44:47], v[128:143]
    v_mov_b32_dpp v147, v147 row_shr:1 row_mask:0xf bank_mask:0xf bound_ctrl:0
    v_mov_b32_dpp v148, v148 row_shr:1 row_mask:0xf bank_mask:0xf bound_ctrl:0
    v_mov_b32_dpp v149, v149 row_shr:1 row_mask:0xf bank_mask:0xf bound_ctrl:0
    v_mfma_f32_32x32x16_bf16 v[128:143], v[192:195], v[48:51], v[128:143]
    v_mov_b32_dpp v150, v150 row_shr:1 row_mask:0xf bank_mask:0xf bound_ctrl:0
    v_mov_b32_dpp v151, v151 row_shr:1 row_mask:0xf bank_mask:0xf bound_ctrl:0
    v_mov_b32_dpp v152, v152 row_shr:1 row_mask:0xf bank_mask:0xf bound_ctrl:0
    v_mfma_f32_32x32x16_bf16 v[128:143], v[196:199], v[52:55], v[128:143]
    v_mov_b32_dpp v153, v153 row_shr:1 row_mask:0xf bank_mask:0xf bound_ctrl:0
    v_mov_b32_dpp v154, v154 row_shr:1 row_mask:0xf bank_mask:0xf bound_ctrl:0
    v_mov_b32_dpp v155, v155 row_shr:1 row_mask:0xf bank_mask:0xf bound_ctrl:0
    v_mfma_f32_32x32x16_bf16 v[128:143], v[200:203], v[56:59], v[128:143]
    v_mov_b32_dpp v156, v156 row_shr:1 row_mask:0xf bank_mask:0xf bound_ctrl:0
    v_mov_b32_dpp v157, v157 row_shr:1 row_mask:0xf bank_mask:0xf bound_ctrl:0
    v_mfma_f32_32x32x16_bf16 v[128:143], v[204:207], v[60:63], v[128:143]
    v_mov_b32_dpp v158, v158 row_shr:1 row_mask:0xf bank_mask:0xf bound_ctrl:0
    v_mov_b32_dpp v159, v159 row_shr:1 row_mask:0xf bank_mask:0xf bound_ctrl:0
    s_waitcnt lgkmcnt(0)
    v_mfma_f32_32x32x16_bf16 v[160:175], v[208:211], v[96:99], v[160:175]
    ds_read_b128 v[176:179], v14 offset:768
    ds_read_b128 v[180:183], v14 offset:800
    s_nop 2
    v_mfma_f32_32x32x16_bf16 v[160:175], v[212:215], v[100:103], v[160:175]
    ds_read_b128 v[184:187], v14 offset:832
    ds_read_b128 v[188:191], v14 offset:864
    s_nop 2
    v_mfma_f32_32x32x16_bf16 v[160:175], v[216:219], v[104:107], v[160:175]
    ds_read_b128 v[192:195], v14 offset:896
    ds_read_b128 v[196:199], v14 offset:928
    v_mov_b32_dpp v128, v128 row_shr:1 row_mask:0xf bank_mask:0xf bound_ctrl:0
    v_mov_b32_dpp v129, v129 row_shr:1 row_mask:0xf bank_mask:0xf bound_ctrl:0
    v_mov_b32_dpp v130, v130 row_shr:1 row_mask:0xf bank_mask:0xf bound_ctrl:0
    v_mfma_f32_32x32x16_bf16 v[160:175], v[220:223], v[108:111], v[160:175]
    ds_read_b128 v[200:203], v14 offset:960
    v_mov_b32_dpp v131, v131 row_shr:1 row_mask:0xf bank_mask:0xf bound_ctrl:0
    v_mov_b32_dpp v132, v132 row_shr:1 row_mask:0xf bank_mask:0xf bound_ctrl:0
    v_mov_b32_dpp v133, v133 row_shr:1 row_mask:0xf bank_mask:0xf bound_ctrl:0
    v_mfma_f32_32x32x16_bf16 v[160:175], v[224:227], v[112:115], v[160:175]
    ds_read_b128 v[204:207], v14 offset:992
    v_mov_b32_dpp v134, v134 row_shr:1 row_mask:0xf bank_mask:0xf bound_ctrl:0
    v_mov_b32_dpp v135, v135 row_shr:1 row_mask:0xf bank_mask:0xf bound_ctrl:0
    v_mov_b32_dpp v136, v136 row_shr:1 row_mask:0xf bank_mask:0xf bound_ctrl:0
    v_mfma_f32_32x32x16_bf16 v[160:175], v[228:231], v[116:119], v[160:175]
    v_mov_b32_dpp v137, v137 row_shr:1 row_mask:0xf bank_mask:0xf bound_ctrl:0
    v_mov_b32_dpp v138, v138 row_shr:1 row_mask:0xf bank_mask:0xf bound_ctrl:0
    v_mov_b32_dpp v139, v139 row_shr:1 row_mask:0xf bank_mask:0xf bound_ctrl:0
    v_mfma_f32_32x32x16_bf16 v[160:175], v[232:235], v[120:123], v[160:175]
    v_mov_b32_dpp v140, v140 row_shr:1 row_mask:0xf bank_mask:0xf bound_ctrl:0
    v_mov_b32_dpp v141, v141 row_shr:1 row_mask:0xf bank_mask:0xf bound_ctrl:0
    v_mfma_f32_32x32x16_bf16 v[160:175], v[236:239], v[124:127], v[160:175]
    v_mov_b32_dpp v142, v142 row_shr:1 row_mask:0xf bank_mask:0xf bound_ctrl:0
    v_mov_b32_dpp v143, v143 row_shr:1 row_mask:0xf bank_mask:0xf bound_ctrl:0
    s_mov_b32 s47, 0
prep_kernel_mp17:
    s_waitcnt vmcnt(0)
    v_cmp_ne_u32 vcc, s46, v17
    v_cmp_ne_u32 s[66:67], s46, v19
    v_cmp_ne_u32 s[68:69], s46, v28
    s_add_u32 s47, s47, 1
    s_nop 2
    s_or_b64 vcc, vcc, s[66:67]
    s_or_b64 vcc, vcc, s[68:69]
    s_cmp_ge_u32 s47, 200000
    s_cbranch_scc1 prep_kernel_md18
    s_cbranch_vccz prep_kernel_md18
    buffer_load_dword v19, v18, s[28:31], s41 offen sc1
    buffer_load_dword v28, v18, s[28:31], s42 offen sc1
    s_mov_b64 exec, 0xfff
    buffer_load_dword v17, v16, s[28:31], s40 offen sc1
    s_mov_b64 exec, -1
    s_branch prep_kernel_mp17
prep_kernel_md18:
    s_lshl_b32 s40, s2, 4
    s_add_u32 s40, s40, 2793472
    v_lshrrev_b32 v16, 2, v1
    v_mul_u32_u24 v16, 2560, v16
    v_and_b32 v17, 3, v1
    v_mul_u32_u24 v17, 15360, v17
    v_add_u32 v16, v16, v17
    v_lshlrev_b32 v18, 4, v1
    s_mov_b64 exec, 0xfff
    buffer_load_dwordx4 v[20:23], v16, s[28:31], s40 offen sc1
    s_mov_b64 exec, -1
    s_lshl_b32 s43, s20, 10
    s_waitcnt lgkmcnt(0)
    v_mfma_f32_32x32x16_bf16 v[144:159], v[176:179], v[64:67], v[144:159]
    ds_read_b128 v[208:211], v14 offset:2816
    s_nop 3
    v_mfma_f32_32x32x16_bf16 v[144:159], v[180:183], v[68:71], v[144:159]
    ds_read_b128 v[212:215], v14 offset:2848
    s_nop 3
    v_mfma_f32_32x32x16_bf16 v[144:159], v[184:187], v[72:75], v[144:159]
    ds_read_b128 v[216:219], v14 offset:2880
    v_and_b32_dpp v160, v160, v15 row_shr:1 row_mask:0xf bank_mask:0xf bound_ctrl:0
    v_and_b32_dpp v161, v161, v15 row_shr:1 row_mask:0xf bank_mask:0xf bound_ctrl:0
    v_and_b32_dpp v162, v162, v15 row_shr:1 row_mask:0xf bank_mask:0xf bound_ctrl:0
    v_mfma_f32_32x32x16_bf16 v[144:159], v[188:191], v[76:79], v[144:159]
    ds_read_b128 v[220:223], v14 offset:2912
    v_and_b32_dpp v163, v163, v15 row_shr:1 row_mask:0xf bank_mask:0xf bound_ctrl:0
    v_and_b32_dpp v164, v164, v15 row_shr:1 row_mask:0xf bank_mask:0xf bound_ctrl:0
    v_and_b32_dpp v165, v165, v15 row_shr:1 row_mask:0xf bank_mask:0xf bound_ctrl:0
    v_mfma_f32_32x32x16_bf16 v[144:159], v[192:195], v[80:83], v[144:159]
    ds_read_b128 v[224:227], v14 offset:2944
    v_and_b32_dpp v166, v166, v15 row_shr:1 row_mask:0xf bank_mask:0xf bound_ctrl:0
    v_and_b32_dpp v167, v167, v15 row_shr:1 row_mask:0xf bank_mask:0xf bound_ctrl:0
    v_and_b32_dpp v168, v168, v15 row_shr:1 row_mask:0xf bank_mask:0xf bound_ctrl:0
    v_mfma_f32_32x32x16_bf16 v[144:159], v[196:199], v[84:87], v[144:159]
    ds_read_b128 v[228:231], v14 offset:2976
    v_and_b32_dpp v169, v169, v15 row_shr:1 row_mask:0xf bank_mask:0xf bound_ctrl:0
    v_and_b32_dpp v170, v170, v15 row_shr:1 row_mask:0xf bank_mask:0xf bound_ctrl:0
    v_and_b32_dpp v171, v171, v15 row_shr:1 row_mask:0xf bank_mask:0xf bound_ctrl:0
    v_mfma_f32_32x32x16_bf16 v[144:159], v[200:203], v[88:91], v[144:159]
    ds_read_b128 v[232:235], v14 offset:3008
    v_and_b32_dpp v172, v172, v15 row_shr:1 row_mask:0xf bank_mask:0xf bound_ctrl:0
    v_and_b32_dpp v173, v173, v15 row_shr:1 row_mask:0xf bank_mask:0xf bound_ctrl:0
    v_mfma_f32_32x32x16_bf16 v[144:159], v[204:207], v[92:95], v[144:159]
    ds_read_b128 v[236:239], v14 offset:3040
    v_and_b32_dpp v174, v174, v15 row_shr:1 row_mask:0xf bank_mask:0xf bound_ctrl:0
    v_and_b32_dpp v175, v175, v15 row_shr:1 row_mask:0xf bank_mask:0xf bound_ctrl:0
    v_mfma_f32_32x32x16_bf16 v[128:143], v[176:179], v[32:35], v[128:143]
    s_add_u32 m0, s43, 71680
    s_add_u32 s39, s43, 5476352
    buffer_load_dwordx4 v18, s[28:31], s39 offen sc1 lds
    s_nop 3
    v_mfma_f32_32x32x16_bf16 v[128:143], v[180:183], v[36:39], v[128:143]
    s_add_u32 m0, s43, 55296
    s_add_u32 s39, s38, 2854912
    buffer_load_dwordx4 v4, s[28:31], s39 offen sc1 lds
    s_nop 3
    v_mfma_f32_32x32x16_bf16 v[128:143], v[184:187], v[40:43], v[128:143]
    v_mov_b32_dpp v144, v144 row_shr:1 row_mask:0xf bank_mask:0xf bound_ctrl:0
    v_mov_b32_dpp v145, v145 row_shr:1 row_mask:0xf bank_mask:0xf bound_ctrl:0
    v_mov_b32_dpp v146, v146 row_shr:1 row_mask:0xf bank_mask:0xf bound_ctrl:0
    v_mfma_f32_32x32x16_bf16 v[128:143], v[188:191], v[44:47], v[128:143]
    v_mov_b32_dpp v147, v147 row_shr:1 row_mask:0xf bank_mask:0xf bound_ctrl:0
    v_mov_b32_dpp v148, v148 row_shr:1 row_mask:0xf bank_mask:0xf bound_ctrl:0
    v_mov_b32_dpp v149, v149 row_shr:1 row_mask:0xf bank_mask:0xf bound_ctrl:0
    v_mfma_f32_32x32x16_bf16 v[128:143], v[192:195], v[48:51], v[128:143]
    v_mov_b32_dpp v150, v150 row_shr:1 row_mask:0xf bank_mask:0xf bound_ctrl:0
    v_mov_b32_dpp v151, v151 row_shr:1 row_mask:0xf bank_mask:0xf bound_ctrl:0
    v_mov_b32_dpp v152, v152 row_shr:1 row_mask:0xf bank_mask:0xf bound_ctrl:0
    v_mfma_f32_32x32x16_bf16 v[128:143], v[196:199], v[52:55], v[128:143]
    v_mov_b32_dpp v153, v153 row_shr:1 row_mask:0xf bank_mask:0xf bound_ctrl:0
    v_mov_b32_dpp v154, v154 row_shr:1 row_mask:0xf bank_mask:0xf bound_ctrl:0
    v_mov_b32_dpp v155, v155 row_shr:1 row_mask:0xf bank_mask:0xf bound_ctrl:0
    v_mfma_f32_32x32x16_bf16 v[128:143], v[200:203], v[56:59], v[128:143]
    v_mov_b32_dpp v156, v156 row_shr:1 row_mask:0xf bank_mask:0xf bound_ctrl:0
    v_mov_b32_dpp v157, v157 row_shr:1 row_mask:0xf bank_mask:0xf bound_ctrl:0
    v_mfma_f32_32x32x16_bf16 v[128:143], v[204:207], v[60:63], v[128:143]
    v_mov_b32_dpp v158, v158 row_shr:1 row_mask:0xf bank_mask:0xf bound_ctrl:0
    v_mov_b32_dpp v159, v159 row_shr:1 row_mask:0xf bank_mask:0xf bound_ctrl:0
    s_waitcnt lgkmcnt(0)
    v_mfma_f32_32x32x16_bf16 v[160:175], v[208:211], v[96:99], v[160:175]
    ds_read_b128 v[176:179], v14 offset:512
    ds_read_b128 v[180:183], v14 offset:544
    s_nop 2
    v_mfma_f32_32x32x16_bf16 v[160:175], v[212:215], v[100:103], v[160:175]
    ds_read_b128 v[184:187], v14 offset:576
    ds_read_b128 v[188:191], v14 offset:608
    s_nop 2
    v_mfma_f32_32x32x16_bf16 v[160:175], v[216:219], v[104:107], v[160:175]
    ds_read_b128 v[192:195], v14 offset:640
    v_mov_b32_dpp v128, v128 row_shr:1 row_mask:0xf bank_mask:0xf bound_ctrl:0
    v_mov_b32_dpp v129, v129 row_shr:1 row_mask:0xf bank_mask:0xf bound_ctrl:0
    v_mov_b32_dpp v130, v130 row_shr:1 row_mask:0xf bank_mask:0xf bound_ctrl:0
    v_mfma_f32_32x32x16_bf16 v[160:175], v[220:223], v[108:111], v[160:175]
    ds_read_b128 v[196:199], v14 offset:672
    v_mov_b32_dpp v131, v131 row_shr:1 row_mask:0xf bank_mask:0xf bound_ctrl:0
    v_mov_b32_dpp v132, v132 row_shr:1 row_mask:0xf bank_mask:0xf bound_ctrl:0
    v_mov_b32_dpp v133, v133 row_shr:1 row_mask:0xf bank_mask:0xf bound_ctrl:0
    v_mfma_f32_32x32x16_bf16 v[160:175], v[224:227], v[112:115], v[160:175]
    ds_read_b128 v[200:203], v14 offset:704
    v_mov_b32_dpp v134, v134 row_shr:1 row_mask:0xf bank_mask:0xf bound_ctrl:0
    v_mov_b32_dpp v135, v135 row_shr:1 row_mask:0xf bank_mask:0xf bound_ctrl:0
    v_mov_b32_dpp v136, v136 row_shr:1 row_mask:0xf bank_mask:0xf bound_ctrl:0
    v_mfma_f32_32x32x16_bf16 v[160:175], v[228:231], v[116:119], v[160:175]
    ds_read_b128 v[204:207], v14 offset:736
    v_mov_b32_dpp v137, v137 row_shr:1 row_mask:0xf bank_mask:0xf bound_ctrl:0
    v_mov_b32_dpp v138, v138 row_shr:1 row_mask:0xf bank_mask:0xf bound_ctrl:0
    v_mov_b32_dpp v139, v139 row_shr:1 row_mask:0xf bank_mask:0xf bound_ctrl:0
    v_mfma_f32_32x32x16_bf16 v[160:175], v[232:235], v[120:123], v[160:175]
    s_add_u32 m0, s43, 75776
    s_add_u32 s39, s43, 5480448
    buffer_load_dwordx4 v18, s[28:31], s39 offen sc1 lds
    v_mov_b32_dpp v140, v140 row_shr:1 row_mask:0xf bank_mask:0xf bound_ctrl:0
    v_mov_b32_dpp v141, v141 row_shr:1 row_mask:0xf bank_mask:0xf bound_ctrl:0
    v_mfma_f32_32x32x16_bf16 v[160:175], v[236:239], v[124:127], v[160:175]
    s_add_u32 m0, s43, 59392
    s_add_u32 s39, s38, 3510272
    buffer_load_dwordx4 v4, s[28:31], s39 offen sc1 lds
    v_mov_b32_dpp v142, v142 row_shr:1 row_mask:0xf bank_mask:0xf bound_ctrl:0
    v_mov_b32_dpp v143, v143 row_shr:1 row_mask:0xf bank_mask:0xf bound_ctrl:0
    s_waitcnt lgkmcnt(0)
    v_mfma_f32_32x32x16_bf16 v[144:159], v[176:179], v[64:67], v[144:159]
    ds_read_b128 v[208:211], v14 offset:2560
    s_nop 3
    v_mfma_f32_32x32x16_bf16 v[144:159], v[180:183], v[68:71], v[144:159]
    ds_read_b128 v[212:215], v14 offset:2592
    s_nop 3
    v_mfma_f32_32x32x16_bf16 v[144:159], v[184:187], v[72:75], v[144:159]
    ds_read_b128 v[216:219], v14 offset:2624
    v_and_b32_dpp v160, v160, v15 row_shr:1 row_mask:0xf bank_mask:0xf bound_ctrl:0
    v_and_b32_dpp v161, v161, v15 row_shr:1 row_mask:0xf bank_mask:0xf bound_ctrl:0
    v_and_b32_dpp v162, v162, v15 row_shr:1 row_mask:0xf bank_mask:0xf bound_ctrl:0
    v_mfma_f32_32x32x16_bf16 v[144:159], v[188:191], v[76:79], v[144:159]
    ds_read_b128 v[220:223], v14 offset:2656
    v_and_b32_dpp v163, v163, v15 row_shr:1 row_mask:0xf bank_mask:0xf bound_ctrl:0
    v_and_b32_dpp v164, v164, v15 row_shr:1 row_mask:0xf bank_mask:0xf bound_ctrl:0
    v_and_b32_dpp v165, v165, v15 row_shr:1 row_mask:0xf bank_mask:0xf bound_ctrl:0
    v_mfma_f32_32x32x16_bf16 v[144:159], v[192:195], v[80:83], v[144:159]
    ds_read_b128 v[224:227], v14 offset:2688
    v_and_b32_dpp v166, v166, v15 row_shr:1 row_mask:0xf bank_mask:0xf bound_ctrl:0
    v_and_b32_dpp v167, v167, v15 row_shr:1 row_mask:0xf bank_mask:0xf bound_ctrl:0
    v_and_b32_dpp v168, v168, v15 row_shr:1 row_mask:0xf bank_mask:0xf bound_ctrl:0
    v_mfma_f32_32x32x16_bf16 v[144:159], v[196:199], v[84:87], v[144:159]
    ds_read_b128 v[228:231], v14 offset:2720
    v_and_b32_dpp v169, v169, v15 row_shr:1 row_mask:0xf bank_mask:0xf bound_ctrl:0
    v_and_b32_dpp v170, v170, v15 row_shr:1 row_mask:0xf bank_mask:0xf bound_ctrl:0
    v_and_b32_dpp v171, v171, v15 row_shr:1 row_mask:0xf bank_mask:0xf bound_ctrl:0
    v_mfma_f32_32x32x16_bf16 v[144:159], v[200:203], v[88:91], v[144:159]
    ds_read_b128 v[232:235], v14 offset:2752
    v_and_b32_dpp v172, v172, v15 row_shr:1 row_mask:0xf bank_mask:0xf bound_ctrl:0
    v_and_b32_dpp v173, v173, v15 row_shr:1 row_mask:0xf bank_mask:0xf bound_ctrl:0
    v_mfma_f32_32x32x16_bf16 v[144:159], v[204:207], v[92:95], v[144:159]
    ds_read_b128 v[236:239], v14 offset:2784
    v_and_b32_dpp v174, v174, v15 row_shr:1 row_mask:0xf bank_mask:0xf bound_ctrl:0
    v_and_b32_dpp v175, v175, v15 row_shr:1 row_mask:0xf bank_mask:0xf bound_ctrl:0
    v_mfma_f32_32x32x16_bf16 v[128:143], v[176:179], v[32:35], v[128:143]
    s_add_u32 m0, s43, 79872
    s_add_u32 s39, s43, 5484544
    buffer_load_dwordx4 v18, s[28:31], s39 offen sc1 lds
    s_nop 3
    v_mfma_f32_32x32x16_bf16 v[128:143], v[180:183], v[36:39], v[128:143]
    s_add_u32 m0, s43, 63488
    s_add_u32 s39, s38, 4165632
    buffer_load_dwordx4 v4, s[28:31], s39 offen sc1 lds
    s_nop 3
    v_mfma_f32_32x32x16_bf16 v[128:143], v[184:187], v[40:43], v[128:143]
    v_mov_b32_dpp v144, v144 row_shr:1 row_mask:0xf bank_mask:0xf bound_ctrl:0
    v_mov_b32_dpp v145, v145 row_shr:1 row_mask:0xf bank_mask:0xf bound_ctrl:0
    v_mov_b32_dpp v146, v146 row_shr:1 row_mask:0xf bank_mask:0xf bound_ctrl:0
    v_mfma_f32_32x32x16_bf16 v[128:143], v[188:191], v[44:47], v[128:143]
    v_mov_b32_dpp v147, v147 row_shr:1 row_mask:0xf bank_mask:0xf bound_ctrl:0
    v_mov_b32_dpp v148, v148 row_shr:1 row_mask:0xf bank_mask:0xf bound_ctrl:0
    v_mov_b32_dpp v149, v149 row_shr:1 row_mask:0xf bank_mask:0xf bound_ctrl:0
    v_mfma_f32_32x32x16_bf16 v[128:143], v[192:195], v[48:51], v[128:143]
    v_mov_b32_dpp v150, v150 row_shr:1 row_mask:0xf bank_mask:0xf bound_ctrl:0
    v_mov_b32_dpp v151, v151 row_shr:1 row_mask:0xf bank_mask:0xf bound_ctrl:0
    v_mov_b32_dpp v152, v152 row_shr:1 row_mask:0xf bank_mask:0xf bound_ctrl:0
    v_mfma_f32_32x32x16_bf16 v[128:143], v[196:199], v[52:55], v[128:143]
    v_mov_b32_dpp v153, v153 row_shr:1 row_mask:0xf bank_mask:0xf bound_ctrl:0
    v_mov_b32_dpp v154, v154 row_shr:1 row_mask:0xf bank_mask:0xf bound_ctrl:0
    v_mov_b32_dpp v155, v155 row_shr:1 row_mask:0xf bank_mask:0xf bound_ctrl:0
    v_mfma_f32_32x32x16_bf16 v[128:143], v[200:203], v[56:59], v[128:143]
    v_mov_b32_dpp v156, v156 row_shr:1 row_mask:0xf bank_mask:0xf bound_ctrl:0
    v_mov_b32_dpp v157, v157 row_shr:1 row_mask:0xf bank_mask:0xf bound_ctrl:0
    v_mfma_f32_32x32x16_bf16 v[128:143], v[204:207], v[60:63], v[128:143]
    v_mov_b32_dpp v158, v158 row_shr:1 row_mask:0xf bank_mask:0xf bound_ctrl:0
    v_mov_b32_dpp v159, v159 row_shr:1 row_mask:0xf bank_mask:0xf bound_ctrl:0
    s_waitcnt lgkmcnt(0)
    v_mfma_f32_32x32x16_bf16 v[160:175], v[208:211], v[96:99], v[160:175]
    ds_read_b128 v[176:179], v14 offset:256
    ds_read_b128 v[180:183], v14 offset:288
    s_nop 2
    v_mfma_f32_32x32x16_bf16 v[160:175], v[212:215], v[100:103], v[160:175]
    ds_read_b128 v[184:187], v14 offset:320
    ds_read_b128 v[188:191], v14 offset:352
    s_nop 2
    v_mfma_f32_32x32x16_bf16 v[160:175], v[216:219], v[104:107], v[160:175]
    ds_read_b128 v[192:195], v14 offset:384
    v_mov_b32_dpp v128, v128 row_shr:1 row_mask:0xf bank_mask:0xf bound_ctrl:0
    v_mov_b32_dpp v129, v129 row_shr:1 row_mask:0xf bank_mask:0xf bound_ctrl:0
    v_mov_b32_dpp v130, v130 row_shr:1 row_mask:0xf bank_mask:0xf bound_ctrl:0
    v_mfma_f32_32x32x16_bf16 v[160:175], v[220:223], v[108:111], v[160:175]
    ds_read_b128 v[196:199], v14 offset:416
    v_mov_b32_dpp v131, v131 row_shr:1 row_mask:0xf bank_mask:0xf bound_ctrl:0
    v_mov_b32_dpp v132, v132 row_shr:1 row_mask:0xf bank_mask:0xf bound_ctrl:0
    v_mov_b32_dpp v133, v133 row_shr:1 row_mask:0xf bank_mask:0xf bound_ctrl:0
    v_mfma_f32_32x32x16_bf16 v[160:175], v[224:227], v[112:115], v[160:175]
    ds_read_b128 v[200:203], v14 offset:448
    v_mov_b32_dpp v134, v134 row_shr:1 row_mask:0xf bank_mask:0xf bound_ctrl:0
    v_mov_b32_dpp v135, v135 row_shr:1 row_mask:0xf bank_mask:0xf bound_ctrl:0
    v_mov_b32_dpp v136, v136 row_shr:1 row_mask:0xf bank_mask:0xf bound_ctrl:0
    v_mfma_f32_32x32x16_bf16 v[160:175], v[228:231], v[116:119], v[160:175]
    ds_read_b128 v[204:207], v14 offset:480
    v_mov_b32_dpp v137, v137 row_shr:1 row_mask:0xf bank_mask:0xf bound_ctrl:0
    v_mov_b32_dpp v138, v138 row_shr:1 row_mask:0xf bank_mask:0xf bound_ctrl:0
    v_mov_b32_dpp v139, v139 row_shr:1 row_mask:0xf bank_mask:0xf bound_ctrl:0
    v_mfma_f32_32x32x16_bf16 v[160:175], v[232:235], v[120:123], v[160:175]
    s_add_u32 m0, s43, 83968
    s_add_u32 s39, s43, 5488640
    buffer_load_dwordx4 v18, s[28:31], s39 offen sc1 lds
    v_mov_b32_dpp v140, v140 row_shr:1 row_mask:0xf bank_mask:0xf bound_ctrl:0
    v_mov_b32_dpp v141, v141 row_shr:1 row_mask:0xf bank_mask:0xf bound_ctrl:0
    v_mfma_f32_32x32x16_bf16 v[160:175], v[236:239], v[124:127], v[160:175]
    s_add_u32 m0, s43, 67584
    s_add_u32 s39, s38, 4820992
    buffer_load_dwordx4 v4, s[28:31], s39 offen sc1 lds
    v_mov_b32_dpp v142, v142 row_shr:1 row_mask:0xf bank_mask:0xf bound_ctrl:0
    v_mov_b32_dpp v143, v143 row_shr:1 row_mask:0xf bank_mask:0xf bound_ctrl:0
    s_waitcnt lgkmcnt(0)
    v_mfma_f32_32x32x16_bf16 v[144:159], v[176:179], v[64:67], v[144:159]
    ds_read_b128 v[208:211], v14 offset:2304
    s_nop 3
    v_mfma_f32_32x32x16_bf16 v[144:159], v[180:183], v[68:71], v[144:159]
    ds_read_b128 v[212:215], v14 offset:2336
    s_nop 3
    v_mfma_f32_32x32x16_bf16 v[144:159], v[184:187], v[72:75], v[144:159]
    ds_read_b128 v[216:219], v14 offset:2368
    v_and_b32_dpp v160, v160, v15 row_shr:1 row_mask:0xf bank_mask:0xf bound_ctrl:0
    v_and_b32_dpp v161, v161, v15 row_shr:1 row_mask:0xf bank_mask:0xf bound_ctrl:0
    v_and_b32_dpp v162, v162, v15 row_shr:1 row_mask:0xf bank_mask:0xf bound_ctrl:0
    v_mfma_f32_32x32x16_bf16 v[144:159], v[188:191], v[76:79], v[144:159]
    ds_read_b128 v[220:223], v14 offset:2400
    v_and_b32_dpp v163, v163, v15 row_shr:1 row_mask:0xf bank_mask:0xf bound_ctrl:0
    v_and_b32_dpp v164, v164, v15 row_shr:1 row_mask:0xf bank_mask:0xf bound_ctrl:0
    v_and_b32_dpp v165, v165, v15 row_shr:1 row_mask:0xf bank_mask:0xf bound_ctrl:0
    v_mfma_f32_32x32x16_bf16 v[144:159], v[192:195], v[80:83], v[144:159]
    ds_read_b128 v[224:227], v14 offset:2432
    v_and_b32_dpp v166, v166, v15 row_shr:1 row_mask:0xf bank_mask:0xf bound_ctrl:0
    v_and_b32_dpp v167, v167, v15 row_shr:1 row_mask:0xf bank_mask:0xf bound_ctrl:0
    v_and_b32_dpp v168, v168, v15 row_shr:1 row_mask:0xf bank_mask:0xf bound_ctrl:0
    v_mfma_f32_32x32x16_bf16 v[144:159], v[196:199], v[84:87], v[144:159]
    ds_read_b128 v[228:231], v14 offset:2464
    v_and_b32_dpp v169, v169, v15 row_shr:1 row_mask:0xf bank_mask:0xf bound_ctrl:0
    v_and_b32_dpp v170, v170, v15 row_shr:1 row_mask:0xf bank_mask:0xf bound_ctrl:0
    v_and_b32_dpp v171, v171, v15 row_shr:1 row_mask:0xf bank_mask:0xf bound_ctrl:0
    v_mfma_f32_32x32x16_bf16 v[144:159], v[200:203], v[88:91], v[144:159]
    ds_read_b128 v[232:235], v14 offset:2496
    v_and_b32_dpp v172, v172, v15 row_shr:1 row_mask:0xf bank_mask:0xf bound_ctrl:0
    v_and_b32_dpp v173, v173, v15 row_shr:1 row_mask:0xf bank_mask:0xf bound_ctrl:0
    v_mfma_f32_32x32x16_bf16 v[144:159], v[204:207], v[92:95], v[144:159]
    ds_read_b128 v[236:239], v14 offset:2528
    v_and_b32_dpp v174, v174, v15 row_shr:1 row_mask:0xf bank_mask:0xf bound_ctrl:0
    v_and_b32_dpp v175, v175, v15 row_shr:1 row_mask:0xf bank_mask:0xf bound_ctrl:0
    v_mfma_f32_32x32x16_bf16 v[128:143], v[176:179], v[32:35], v[128:143]
    s_nop 4
    v_mfma_f32_32x32x16_bf16 v[128:143], v[180:183], v[36:39], v[128:143]
    s_nop 4
    v_mfma_f32_32x32x16_bf16 v[128:143], v[184:187], v[40:43], v[128:143]
    v_mov_b32_dpp v144, v144 row_shr:1 row_mask:0xf bank_mask:0xf bound_ctrl:0
    v_mov_b32_dpp v145, v145 row_shr:1 row_mask:0xf bank_mask:0xf bound_ctrl:0
    v_mov_b32_dpp v146, v146 row_shr:1 row_mask:0xf bank_mask:0xf bound_ctrl:0
    v_mfma_f32_32x32x16_bf16 v[128:143], v[188:191], v[44:47], v[128:143]
    v_mov_b32_dpp v147, v147 row_shr:1 row_mask:0xf bank_mask:0xf bound_ctrl:0
    v_mov_b32_dpp v148, v148 row_shr:1 row_mask:0xf bank_mask:0xf bound_ctrl:0
    v_mov_b32_dpp v149, v149 row_shr:1 row_mask:0xf bank_mask:0xf bound_ctrl:0
    v_mfma_f32_32x32x16_bf16 v[128:143], v[192:195], v[48:51], v[128:143]
    v_mov_b32_dpp v150, v150 row_shr:1 row_mask:0xf bank_mask:0xf bound_ctrl:0
    v_mov_b32_dpp v151, v151 row_shr:1 row_mask:0xf bank_mask:0xf bound_ctrl:0
    v_mov_b32_dpp v152, v152 row_shr:1 row_mask:0xf bank_mask:0xf bound_ctrl:0
    v_mfma_f32_32x32x16_bf16 v[128:143], v[196:199], v[52:55], v[128:143]
    v_mov_b32_dpp v153, v153 row_shr:1 row_mask:0xf bank_mask:0xf bound_ctrl:0
    v_mov_b32_dpp v154, v154 row_shr:1 row_mask:0xf bank_mask:0xf bound_ctrl:0
    v_mov_b32_dpp v155, v155 row_shr:1 row_mask:0xf bank_mask:0xf bound_ctrl:0
    v_mfma_f32_32x32x16_bf16 v[128:143], v[200:203], v[56:59], v[128:143]
    v_mov_b32_dpp v156, v156 row_shr:1 row_mask:0xf bank_mask:0xf bound_ctrl:0
    v_mov_b32_dpp v157, v157 row_shr:1 row_mask:0xf bank_mask:0xf bound_ctrl:0
    v_mfma_f32_32x32x16_bf16 v[128:143], v[204:207], v[60:63], v[128:143]
    v_mov_b32_dpp v158, v158 row_shr:1 row_mask:0xf bank_mask:0xf bound_ctrl:0
    v_mov_b32_dpp v159, v159 row_shr:1 row_mask:0xf bank_mask:0xf bound_ctrl:0
    s_waitcnt lgkmcnt(0)
    v_mfma_f32_32x32x16_bf16 v[160:175], v[208:211], v[96:99], v[160:175]
    ds_read_b128 v[176:179], v14 offset:0
    ds_read_b128 v[180:183], v14 offset:32
    s_nop 2
    v_mfma_f32_32x32x16_bf16 v[160:175], v[212:215], v[100:103], v[160:175]
    ds_read_b128 v[184:187], v14 offset:64
    ds_read_b128 v[188:191], v14 offset:96
    s_nop 2
    v_mfma_f32_32x32x16_bf16 v[160:175], v[216:219], v[104:107], v[160:175]
    ds_read_b128 v[192:195], v14 offset:128
    ds_read_b128 v[196:199], v14 offset:160
    v_mov_b32_dpp v128, v128 row_shr:1 row_mask:0xf bank_mask:0xf bound_ctrl:0
    v_mov_b32_dpp v129, v129 row_shr:1 row_mask:0xf bank_mask:0xf bound_ctrl:0
    v_mov_b32_dpp v130, v130 row_shr:1 row_mask:0xf bank_mask:0xf bound_ctrl:0
    v_mfma_f32_32x32x16_bf16 v[160:175], v[220:223], v[108:111], v[160:175]
    ds_read_b128 v[200:203], v14 offset:192
    v_mov_b32_dpp v131, v131 row_shr:1 row_mask:0xf bank_mask:0xf bound_ctrl:0
    v_mov_b32_dpp v132, v132 row_shr:1 row_mask:0xf bank_mask:0xf bound_ctrl:0
    v_mov_b32_dpp v133, v133 row_shr:1 row_mask:0xf bank_mask:0xf bound_ctrl:0
    v_mfma_f32_32x32x16_bf16 v[160:175], v[224:227], v[112:115], v[160:175]
    ds_read_b128 v[204:207], v14 offset:224
    v_mov_b32_dpp v134, v134 row_shr:1 row_mask:0xf bank_mask:0xf bound_ctrl:0
    v_mov_b32_dpp v135, v135 row_shr:1 row_mask:0xf bank_mask:0xf bound_ctrl:0
    v_mov_b32_dpp v136, v136 row_shr:1 row_mask:0xf bank_mask:0xf bound_ctrl:0
    v_mfma_f32_32x32x16_bf16 v[160:175], v[228:231], v[116:119], v[160:175]
    v_mov_b32_dpp v137, v137 row_shr:1 row_mask:0xf bank_mask:0xf bound_ctrl:0
    v_mov_b32_dpp v138, v138 row_shr:1 row_mask:0xf bank_mask:0xf bound_ctrl:0
    v_mov_b32_dpp v139, v139 row_shr:1 row_mask:0xf bank_mask:0xf bound_ctrl:0
    v_mfma_f32_32x32x16_bf16 v[160:175], v[232:235], v[120:123], v[160:175]
    v_mov_b32_dpp v140, v140 row_shr:1 row_mask:0xf bank_mask:0xf bound_ctrl:0
    v_mov_b32_dpp v141, v141 row_shr:1 row_mask:0xf bank_mask:0xf bound_ctrl:0
    v_mfma_f32_32x32x16_bf16 v[160:175], v[236:239], v[124:127], v[160:175]
    v_mov_b32_dpp v142, v142 row_shr:1 row_mask:0xf bank_mask:0xf bound_ctrl:0
    v_mov_b32_dpp v143, v143 row_shr:1 row_mask:0xf bank_mask:0xf bound_ctrl:0
    s_waitcnt lgkmcnt(0)
    v_mfma_f32_32x32x16_bf16 v[144:159], v[176:179], v[64:67], v[144:159]
    ds_read_b128 v[208:211], v14 offset:2048
    s_nop 3
    v_mfma_f32_32x32x16_bf16 v[144:159], v[180:183], v[68:71], v[144:159]
    ds_read_b128 v[212:215], v14 offset:2080
    s_nop 3
    v_mfma_f32_32x32x16_bf16 v[144:159], v[184:187], v[72:75], v[144:159]
    ds_read_b128 v[216:219], v14 offset:2112
    v_and_b32_dpp v160, v160, v15 row_shr:1 row_mask:0xf bank_mask:0xf bound_ctrl:0
    v_and_b32_dpp v161, v161, v15 row_shr:1 row_mask:0xf bank_mask:0xf bound_ctrl:0
    v_and_b32_dpp v162, v162, v15 row_shr:1 row_mask:0xf bank_mask:0xf bound_ctrl:0
    v_mfma_f32_32x32x16_bf16 v[144:159], v[188:191], v[76:79], v[144:159]
    ds_read_b128 v[220:223], v14 offset:2144
    v_and_b32_dpp v163, v163, v15 row_shr:1 row_mask:0xf bank_mask:0xf bound_ctrl:0
    v_and_b32_dpp v164, v164, v15 row_shr:1 row_mask:0xf bank_mask:0xf bound_ctrl:0
    v_and_b32_dpp v165, v165, v15 row_shr:1 row_mask:0xf bank_mask:0xf bound_ctrl:0
    v_mfma_f32_32x32x16_bf16 v[144:159], v[192:195], v[80:83], v[144:159]
    ds_read_b128 v[224:227], v14 offset:2176
    v_and_b32_dpp v166, v166, v15 row_shr:1 row_mask:0xf bank_mask:0xf bound_ctrl:0
    v_and_b32_dpp v167, v167, v15 row_shr:1 row_mask:0xf bank_mask:0xf bound_ctrl:0
    v_and_b32_dpp v168, v168, v15 row_shr:1 row_mask:0xf bank_mask:0xf bound_ctrl:0
    v_mfma_f32_32x32x16_bf16 v[144:159], v[196:199], v[84:87], v[144:159]
    ds_read_b128 v[228:231], v14 offset:2208
    v_and_b32_dpp v169, v169, v15 row_shr:1 row_mask:0xf bank_mask:0xf bound_ctrl:0
    v_and_b32_dpp v170, v170, v15 row_shr:1 row_mask:0xf bank_mask:0xf bound_ctrl:0
    v_and_b32_dpp v171, v171, v15 row_shr:1 row_mask:0xf bank_mask:0xf bound_ctrl:0
    v_mfma_f32_32x32x16_bf16 v[144:159], v[200:203], v[88:91], v[144:159]
    ds_read_b128 v[232:235], v14 offset:2240
    v_and_b32_dpp v172, v172, v15 row_shr:1 row_mask:0xf bank_mask:0xf bound_ctrl:0
    v_and_b32_dpp v173, v173, v15 row_shr:1 row_mask:0xf bank_mask:0xf bound_ctrl:0
    v_mfma_f32_32x32x16_bf16 v[144:159], v[204:207], v[92:95], v[144:159]
    ds_read_b128 v[236:239], v14 offset:2272
    v_and_b32_dpp v174, v174, v15 row_shr:1 row_mask:0xf bank_mask:0xf bound_ctrl:0
    v_and_b32_dpp v175, v175, v15 row_shr:1 row_mask:0xf bank_mask:0xf bound_ctrl:0
    v_mfma_f32_32x32x16_bf16 v[128:143], v[176:179], v[32:35], v[128:143]
    v_mfma_f32_32x32x16_bf16 v[128:143], v[180:183], v[36:39], v[128:143]
    v_mfma_f32_32x32x16_bf16 v[128:143], v[184:187], v[40:43], v[128:143]
    v_mfma_f32_32x32x16_bf16 v[128:143], v[188:191], v[44:47], v[128:143]
    v_mfma_f32_32x32x16_bf16 v[128:143], v[192:195], v[48:51], v[128:143]
    v_mfma_f32_32x32x16_bf16 v[128:143], v[196:199], v[52:55], v[128:143]
    v_mfma_f32_32x32x16_bf16 v[128:143], v[200:203], v[56:59], v[128:143]
    v_mfma_f32_32x32x16_bf16 v[128:143], v[204:207], v[60:63], v[128:143]
    s_waitcnt lgkmcnt(0)
    v_mfma_f32_32x32x16_bf16 v[160:175], v[208:211], v[96:99], v[160:175]
    v_mfma_f32_32x32x16_bf16 v[160:175], v[212:215], v[100:103], v[160:175]
    v_mfma_f32_32x32x16_bf16 v[160:175], v[216:219], v[104:107], v[160:175]
    v_mfma_f32_32x32x16_bf16 v[160:175], v[220:223], v[108:111], v[160:175]
    v_mfma_f32_32x32x16_bf16 v[160:175], v[224:227], v[112:115], v[160:175]
    v_mfma_f32_32x32x16_bf16 v[160:175], v[228:231], v[116:119], v[160:175]
    v_mfma_f32_32x32x16_bf16 v[160:175], v[232:235], v[120:123], v[160:175]
    v_mfma_f32_32x32x16_bf16 v[160:175], v[236:239], v[124:127], v[160:175]
    s_nop 11
    v_add_f32_dpp v128, v160, v128 row_shr:8 row_mask:0xf bank_mask:0xf bound_ctrl:0
    v_add_f32_dpp v129, v161, v129 row_shr:8 row_mask:0xf bank_mask:0xf bound_ctrl:0
    v_add_f32_dpp v130, v162, v130 row_shr:8 row_mask:0xf bank_mask:0xf bound_ctrl:0
    v_add_f32_dpp v131, v163, v131 row_shr:8 row_mask:0xf bank_mask:0xf bound_ctrl:0
    v_add_f32_dpp v132, v164, v132 row_shr:8 row_mask:0xf bank_mask:0xf bound_ctrl:0
    v_add_f32_dpp v133, v165, v133 row_shr:8 row_mask:0xf bank_mask:0xf bound_ctrl:0
    v_add_f32_dpp v134, v166, v134 row_shr:8 row_mask:0xf bank_mask:0xf bound_ctrl:0
    v_add_f32_dpp v135, v167, v135 row_shr:8 row_mask:0xf bank_mask:0xf bound_ctrl:0
    v_add_f32_dpp v136, v168, v136 row_shr:8 row_mask:0xf bank_mask:0xf bound_ctrl:0
    v_add_f32_dpp v137, v169, v137 row_shr:8 row_mask:0xf bank_mask:0xf bound_ctrl:0
    v_add_f32_dpp v138, v170, v138 row_shr:8 row_mask:0xf bank_mask:0xf bound_ctrl:0
    v_add_f32_dpp v139, v171, v139 row_shr:8 row_mask:0xf bank_mask:0xf bound_ctrl:0
    v_add_f32_dpp v140, v172, v140 row_shr:8 row_mask:0xf bank_mask:0xf bound_ctrl:0
    v_add_f32_dpp v141, v173, v141 row_shr:8 row_mask:0xf bank_mask:0xf bound_ctrl:0
    v_add_f32_dpp v142, v174, v142 row_shr:8 row_mask:0xf bank_mask:0xf bound_ctrl:0
    v_add_f32_dpp v143, v175, v143 row_shr:8 row_mask:0xf bank_mask:0xf bound_ctrl:0
    s_mov_b32 s42, 0xff00ff00
    s_mov_b32 s43, 0xff00ff00
    s_mov_b64 exec, s[42:43]
    v_add_f32 v144, v160, v144
    v_add_f32 v145, v161, v145
    v_add_f32 v146, v162, v146
    v_add_f32 v147, v163, v147
    v_add_f32 v148, v164, v148
    v_add_f32 v149, v165, v149
    v_add_f32 v150, v166, v150
    v_add_f32 v151, v167, v151
    v_add_f32 v152, v168, v152
    v_add_f32 v153, v169, v153
    v_add_f32 v154, v170, v154
    v_add_f32 v155, v171, v155
    v_add_f32 v156, v172, v156
    v_add_f32 v157, v173, v157
    v_add_f32 v158, v174, v158
    v_add_f32 v159, v175, v159
    s_mov_b64 exec, -1
    v_mul_u32_u24 v16, 264, v7
    v_lshl_add_u32 v16, v9, 5, v16
    v_lshl_add_u32 v16, v8, 2, v16
    v_add_u32 v16, s34, v16
    v_cvt_pk_bf16_f32 v32, v128, v144
    v_cvt_pk_bf16_f32 v33, v129, v145
    v_cvt_pk_bf16_f32 v34, v130, v146
    v_cvt_pk_bf16_f32 v35, v131, v147
    v_cvt_pk_bf16_f32 v36, v132, v148
    v_cvt_pk_bf16_f32 v37, v133, v149
    v_cvt_pk_bf16_f32 v38, v134, v150
    v_cvt_pk_bf16_f32 v39, v135, v151
    v_cvt_pk_bf16_f32 v40, v136, v152
    v_cvt_pk_bf16_f32 v41, v137, v153
    v_cvt_pk_bf16_f32 v42, v138, v154
    v_cvt_pk_bf16_f32 v43, v139, v155
    v_cvt_pk_bf16_f32 v44, v140, v156
    v_cvt_pk_bf16_f32 v45, v141, v157
    v_cvt_pk_bf16_f32 v46, v142, v158
    v_cvt_pk_bf16_f32 v47, v143, v159
    ds_write_b32 v16, v32 offset:0
    ds_write_b32 v16, v33 offset:8
    ds_write_b32 v16, v34 offset:16
    ds_write_b32 v16, v35 offset:24
    ds_write_b32 v16, v36 offset:64
    ds_write_b32 v16, v37 offset:72
    ds_write_b32 v16, v38 offset:80
    ds_write_b32 v16, v39 offset:88
    ds_write_b32 v16, v40 offset:128
    ds_write_b32 v16, v41 offset:136
    ds_write_b32 v16, v42 offset:144
    ds_write_b32 v16, v43 offset:152
    ds_write_b32 v16, v44 offset:192
    ds_write_b32 v16, v45 offset:200
    ds_write_b32 v16, v46 offset:208
    ds_write_b32 v16, v47 offset:216
    s_lshl_b32 s44, s32, 16
    s_and_b32 s45, s32, 0xffff0000
    s_lshl_b32 s46, s33, 16
    s_and_b32 s47, s33, 0xffff0000
    v_mul_u32_u24 v17, 264, v2
    v_lshl_add_u32 v17, v1, 2, v17
    s_waitcnt lgkmcnt(0)
    s_barrier
    v_mul_u32_u24 v19, 272, v2
    v_lshlrev_b32 v18, 2, v1
    v_sub_u32 v19, v19, v18
    v_add_u32 v19, 4604, v19
    ds_read_b32 v48, v17 offset:0
    ds_read_b32 v49, v17 offset:13824
    ds_read_b32 v50, v17 offset:27648
    ds_read_b32 v51, v17 offset:41472
    ds_read_b32 v52, v17 offset:1056
    ds_read_b32 v53, v17 offset:14880
    ds_read_b32 v54, v17 offset:28704
    ds_read_b32 v55, v17 offset:42528
    ds_read_b32 v56, v17 offset:2112
    ds_read_b32 v57, v17 offset:15936
    ds_read_b32 v58, v17 offset:29760
    ds_read_b32 v59, v17 offset:43584
    ds_read_b32 v60, v17 offset:3168
    ds_read_b32 v61, v17 offset:16992
    ds_read_b32 v62, v17 offset:30816
    ds_read_b32 v63, v17 offset:44640
    s_waitcnt lgkmcnt(0)
    ds_read_b32 v224, v19 offset:0
    ds_read_b32 v225, v19 offset:13824
    ds_read_b32 v226, v19 offset:27648
    ds_read_b32 v227, v19 offset:41472
    ds_read_b32 v228, v19 offset:1088
    ds_read_b32 v229, v19 offset:14912
    ds_read_b32 v230, v19 offset:28736
    ds_read_b32 v231, v19 offset:42560
    ds_read_b32 v232, v19 offset:2176
    ds_read_b32 v233, v19 offset:16000
    ds_read_b32 v234, v19 offset:29824
    ds_read_b32 v235, v19 offset:43648
    ds_read_b32 v236, v19 offset:3264
    ds_read_b32 v237, v19 offset:17088
    ds_read_b32 v238, v19 offset:30912
    ds_read_b32 v239, v19 offset:44736
    v_mov_b32 v28, s44
    v_mov_b32 v29, s45
    v_mov_b32 v30, s46
    v_mov_b32 v31, s47
    s_waitcnt vmcnt(0)
    v_lshlrev_b32 v18, 4, v0
    v_add_u32 v18, 55296, v18
    s_waitcnt lgkmcnt(0)
    ds_read_b128 v[176:179], v18 offset:0
    ds_read_b128 v[144:147], v18 offset:16384
    ds_read_b128 v[180:183], v18 offset:4096
    ds_read_b128 v[148:151], v18 offset:20480
    ds_read_b128 v[184:187], v18 offset:8192
    ds_read_b128 v[152:155], v18 offset:24576
    ds_read_b128 v[188:191], v18 offset:12288
    ds_read_b128 v[156:159], v18 offset:28672
    s_nop 1
    v_add_f32_dpp v20, v20, v20 quad_perm:[1,0,3,2] row_mask:0xf bank_mask:0xf
    v_add_f32_dpp v21, v21, v21 quad_perm:[1,0,3,2] row_mask:0xf bank_mask:0xf
    v_add_f32_dpp v22, v22, v22 quad_perm:[1,0,3,2] row_mask:0xf bank_mask:0xf
    v_add_f32_dpp v23, v23, v23 quad_perm:[1,0,3,2] row_mask:0xf bank_mask:0xf
    s_nop 1
    v_add_f32_dpp v20, v20, v20 quad_perm:[2,3,0,1] row_mask:0xf bank_mask:0xf
    v_add_f32_dpp v21, v21, v21 quad_perm:[2,3,0,1] row_mask:0xf bank_mask:0xf
    v_add_f32_dpp v22, v22, v22 quad_perm:[2,3,0,1] row_mask:0xf bank_mask:0xf
    v_add_f32_dpp v23, v23, v23 quad_perm:[2,3,0,1] row_mask:0xf bank_mask:0xf
    s_nop 1
    v_cvt_pk_bf16_f32 v24, v20, v21
    v_lshlrev_b32 v20, 16, v24
    v_and_b32 v21, 0xffff0000, v24
    v_cvt_pk_bf16_f32 v24, v22, v23
    v_lshlrev_b32 v22, 16, v24
    v_and_b32 v23, 0xffff0000, v24
    v_add_f32 v24, 1.0, v20
    v_add_f32 v25, 1.0, v21
    v_add_f32 v26, 1.0, v22
    v_add_f32 v27, 1.0, v23
    v_cvt_pk_bf16_f32 v10, v24, v25
    v_lshlrev_b32 v24, 16, v10
    v_and_b32 v25, 0xffff0000, v10
    v_cvt_pk_bf16_f32 v10, v26, v27
    v_lshlrev_b32 v26, 16, v10
    v_and_b32 v27, 0xffff0000, v10
    s_nop 1
    v_readlane_b32 s68, v20, 0
    v_readlane_b32 s72, v24, 4
    v_readlane_b32 s76, v20, 8
    v_readlane_b32 s69, v21, 0
    v_readlane_b32 s73, v25, 4
    v_readlane_b32 s77, v21, 8
    v_readlane_b32 s70, v22, 0
    v_readlane_b32 s74, v26, 4
    v_readlane_b32 s78, v22, 8
    v_readlane_b32 s71, v23, 0
    v_readlane_b32 s75, v27, 4
    v_readlane_b32 s79, v23, 8
    s_nop 1
    v_mov_b32 v10, s76
    v_mov_b32 v11, s77
    v_mov_b32 v12, s78
    v_mov_b32 v13, s79
    v_mul_f32 v160, s72, v10
    v_mul_f32 v164, s68, v10
    v_mul_f32 v161, s73, v11
    v_mul_f32 v165, s69, v11
    v_mul_f32 v162, s74, v12
    v_mul_f32 v166, s70, v12
    v_mul_f32 v163, s75, v13
    v_mul_f32 v167, s71, v13
    s_waitcnt lgkmcnt(0)
    v_lshlrev_b32 v68, 16, v224
    v_and_b32 v64, 0xffff0000, v224
    v_lshlrev_b32 v69, 16, v225
    v_and_b32 v65, 0xffff0000, v225
    v_lshlrev_b32 v70, 16, v226
    v_and_b32 v66, 0xffff0000, v226
    v_lshlrev_b32 v71, 16, v227
    v_and_b32 v67, 0xffff0000, v227
    v_lshlrev_b32 v74, 16, v48
    v_and_b32 v78, 0xffff0000, v48
    v_lshlrev_b32 v75, 16, v49
    v_and_b32 v79, 0xffff0000, v49
    v_lshlrev_b32 v76, 16, v50
    v_and_b32 v80, 0xffff0000, v50
    v_lshlrev_b32 v77, 16, v51
    v_and_b32 v81, 0xffff0000, v51
    v_lshlrev_b32 v112, 16, v176
    v_and_b32 v113, 0xffff0000, v176
    v_lshlrev_b32 v114, 16, v177
    v_and_b32 v115, 0xffff0000, v177
    v_lshlrev_b32 v116, 16, v178
    v_and_b32 v117, 0xffff0000, v178
    v_lshlrev_b32 v118, 16, v179
    v_and_b32 v119, 0xffff0000, v179
    v_pk_fma_f32 v[64:65], v[64:65], v[28:29], v[74:75]
    v_pk_fma_f32 v[66:67], v[66:67], v[30:31], v[76:77]
    v_pk_fma_f32 v[68:69], v[68:69], v[28:29], v[78:79]
    v_pk_fma_f32 v[70:71], v[70:71], v[30:31], v[80:81]
    v_pk_fma_f32 v[120:121], v[112:113], v[144:145], v[144:145] op_sel:[0,1,0] op_sel_hi:[1,1,0]
    v_pk_fma_f32 v[122:123], v[114:115], v[144:145], v[144:145] op_sel:[0,1,0] op_sel_hi:[1,1,0]
    v_pk_fma_f32 v[124:125], v[116:117], v[146:147], v[146:147] op_sel:[0,1,0] op_sel_hi:[1,1,0]
    v_pk_fma_f32 v[126:127], v[118:119], v[146:147], v[146:147] op_sel:[0,1,0] op_sel_hi:[1,1,0]
    v_pk_fma_f32 v[120:121], v[120:121], v[160:161], v[164:165]
    v_pk_fma_f32 v[122:123], v[122:123], v[162:163], v[166:167]
    v_pk_fma_f32 v[124:125], v[124:125], v[160:161], v[164:165]
    v_pk_fma_f32 v[126:127], v[126:127], v[162:163], v[166:167]
    v_pk_fma_f32 v[64:65], v[64:65], v[120:121], v[112:113]
    v_pk_fma_f32 v[66:67], v[66:67], v[122:123], v[114:115]
    v_pk_fma_f32 v[68:69], v[68:69], v[124:125], v[116:117]
    v_pk_fma_f32 v[70:71], v[70:71], v[126:127], v[118:119]
    v_cvt_pk_bf16_f32 v96, v64, v65
    v_cvt_pk_bf16_f32 v97, v66, v67
    v_cvt_pk_bf16_f32 v98, v68, v69
    v_cvt_pk_bf16_f32 v99, v70, v71
    v_lshlrev_b32 v68, 16, v228
    v_and_b32 v64, 0xffff0000, v228
    v_lshlrev_b32 v69, 16, v229
    v_and_b32 v65, 0xffff0000, v229
    v_lshlrev_b32 v70, 16, v230
    v_and_b32 v66, 0xffff0000, v230
    v_lshlrev_b32 v71, 16, v231
    v_and_b32 v67, 0xffff0000, v231
    v_lshlrev_b32 v74, 16, v52
    v_and_b32 v78, 0xffff0000, v52
    v_lshlrev_b32 v75, 16, v53
    v_and_b32 v79, 0xffff0000, v53
    v_lshlrev_b32 v76, 16, v54
    v_and_b32 v80, 0xffff0000, v54
    v_lshlrev_b32 v77, 16, v55
    v_and_b32 v81, 0xffff0000, v55
    v_lshlrev_b32 v112, 16, v180
    v_and_b32 v113, 0xffff0000, v180
    v_lshlrev_b32 v114, 16, v181
    v_and_b32 v115, 0xffff0000, v181
    v_lshlrev_b32 v116, 16, v182
    v_and_b32 v117, 0xffff0000, v182
    v_lshlrev_b32 v118, 16, v183
    v_and_b32 v119, 0xffff0000, v183
    v_pk_fma_f32 v[64:65], v[64:65], v[28:29], v[74:75]
    v_pk_fma_f32 v[66:67], v[66:67], v[30:31], v[76:77]
    v_pk_fma_f32 v[68:69], v[68:69], v[28:29], v[78:79]
    v_pk_fma_f32 v[70:71], v[70:71], v[30:31], v[80:81]
    v_pk_fma_f32 v[120:121], v[112:113], v[148:149], v[148:149] op_sel:[0,1,0] op_sel_hi:[1,1,0]
    v_pk_fma_f32 v[122:123], v[114:115], v[148:149], v[148:149] op_sel:[0,1,0] op_sel_hi:[1,1,0]
    v_pk_fma_f32 v[124:125], v[116:117], v[150:151], v[150:151] op_sel:[0,1,0] op_sel_hi:[1,1,0]
    v_pk_fma_f32 v[126:127], v[118:119], v[150:151], v[150:151] op_sel:[0,1,0] op_sel_hi:[1,1,0]
    v_pk_fma_f32 v[120:121], v[120:121], v[160:161], v[164:165]
    v_pk_fma_f32 v[122:123], v[122:123], v[162:163], v[166:167]
    v_pk_fma_f32 v[124:125], v[124:125], v[160:161], v[164:165]
    v_pk_fma_f32 v[126:127], v[126:127], v[162:163], v[166:167]
    v_pk_fma_f32 v[64:65], v[64:65], v[120:121], v[112:113]
    v_pk_fma_f32 v[66:67], v[66:67], v[122:123], v[114:115]
    v_pk_fma_f32 v[68:69], v[68:69], v[124:125], v[116:117]
    v_pk_fma_f32 v[70:71], v[70:71], v[126:127], v[118:119]
    v_cvt_pk_bf16_f32 v100, v64, v65
    v_cvt_pk_bf16_f32 v101, v66, v67
    v_cvt_pk_bf16_f32 v102, v68, v69
    v_cvt_pk_bf16_f32 v103, v70, v71
    v_lshlrev_b32 v68, 16, v232
    v_and_b32 v64, 0xffff0000, v232
    v_lshlrev_b32 v69, 16, v233
    v_and_b32 v65, 0xffff0000, v233
    v_lshlrev_b32 v70, 16, v234
    v_and_b32 v66, 0xffff0000, v234
    v_lshlrev_b32 v71, 16, v235
    v_and_b32 v67, 0xffff0000, v235
    v_lshlrev_b32 v74, 16, v56
    v_and_b32 v78, 0xffff0000, v56
    v_lshlrev_b32 v75, 16, v57
    v_and_b32 v79, 0xffff0000, v57
    v_lshlrev_b32 v76, 16, v58
    v_and_b32 v80, 0xffff0000, v58
    v_lshlrev_b32 v77, 16, v59
    v_and_b32 v81, 0xffff0000, v59
    v_lshlrev_b32 v112, 16, v184
    v_and_b32 v113, 0xffff0000, v184
    v_lshlrev_b32 v114, 16, v185
    v_and_b32 v115, 0xffff0000, v185
    v_lshlrev_b32 v116, 16, v186
    v_and_b32 v117, 0xffff0000, v186
    v_lshlrev_b32 v118, 16, v187
    v_and_b32 v119, 0xffff0000, v187
    v_pk_fma_f32 v[64:65], v[64:65], v[28:29], v[74:75]
    v_pk_fma_f32 v[66:67], v[66:67], v[30:31], v[76:77]
    v_pk_fma_f32 v[68:69], v[68:69], v[28:29], v[78:79]
    v_pk_fma_f32 v[70:71], v[70:71], v[30:31], v[80:81]
    v_pk_fma_f32 v[120:121], v[112:113], v[152:153], v[152:153] op_sel:[0,1,0] op_sel_hi:[1,1,0]
    v_pk_fma_f32 v[122:123], v[114:115], v[152:153], v[152:153] op_sel:[0,1,0] op_sel_hi:[1,1,0]
    v_pk_fma_f32 v[124:125], v[116:117], v[154:155], v[154:155] op_sel:[0,1,0] op_sel_hi:[1,1,0]
    v_pk_fma_f32 v[126:127], v[118:119], v[154:155], v[154:155] op_sel:[0,1,0] op_sel_hi:[1,1,0]
    v_pk_fma_f32 v[120:121], v[120:121], v[160:161], v[164:165]
    v_pk_fma_f32 v[122:123], v[122:123], v[162:163], v[166:167]
    v_pk_fma_f32 v[124:125], v[124:125], v[160:161], v[164:165]
    v_pk_fma_f32 v[126:127], v[126:127], v[162:163], v[166:167]
    v_pk_fma_f32 v[64:65], v[64:65], v[120:121], v[112:113]
    v_pk_fma_f32 v[66:67], v[66:67], v[122:123], v[114:115]
    v_pk_fma_f32 v[68:69], v[68:69], v[124:125], v[116:117]
    v_pk_fma_f32 v[70:71], v[70:71], v[126:127], v[118:119]
    v_cvt_pk_bf16_f32 v104, v64, v65
    v_cvt_pk_bf16_f32 v105, v66, v67
    v_cvt_pk_bf16_f32 v106, v68, v69
    v_cvt_pk_bf16_f32 v107, v70, v71
    v_lshlrev_b32 v68, 16, v236
    v_and_b32 v64, 0xffff0000, v236
    v_lshlrev_b32 v69, 16, v237
    v_and_b32 v65, 0xffff0000, v237
    v_lshlrev_b32 v70, 16, v238
    v_and_b32 v66, 0xffff0000, v238
    v_lshlrev_b32 v71, 16, v239
    v_and_b32 v67, 0xffff0000, v239
    v_lshlrev_b32 v74, 16, v60
    v_and_b32 v78, 0xffff0000, v60
    v_lshlrev_b32 v75, 16, v61
    v_and_b32 v79, 0xffff0000, v61
    v_lshlrev_b32 v76, 16, v62
    v_and_b32 v80, 0xffff0000, v62
    v_lshlrev_b32 v77, 16, v63
    v_and_b32 v81, 0xffff0000, v63
    v_lshlrev_b32 v112, 16, v188
    v_and_b32 v113, 0xffff0000, v188
    v_lshlrev_b32 v114, 16, v189
    v_and_b32 v115, 0xffff0000, v189
    v_lshlrev_b32 v116, 16, v190
    v_and_b32 v117, 0xffff0000, v190
    v_lshlrev_b32 v118, 16, v191
    v_and_b32 v119, 0xffff0000, v191
    v_pk_fma_f32 v[64:65], v[64:65], v[28:29], v[74:75]
    v_pk_fma_f32 v[66:67], v[66:67], v[30:31], v[76:77]
    v_pk_fma_f32 v[68:69], v[68:69], v[28:29], v[78:79]
    v_pk_fma_f32 v[70:71], v[70:71], v[30:31], v[80:81]
    v_pk_fma_f32 v[120:121], v[112:113], v[156:157], v[156:157] op_sel:[0,1,0] op_sel_hi:[1,1,0]
    v_pk_fma_f32 v[122:123], v[114:115], v[156:157], v[156:157] op_sel:[0,1,0] op_sel_hi:[1,1,0]
    v_pk_fma_f32 v[124:125], v[116:117], v[158:159], v[158:159] op_sel:[0,1,0] op_sel_hi:[1,1,0]
    v_pk_fma_f32 v[126:127], v[118:119], v[158:159], v[158:159] op_sel:[0,1,0] op_sel_hi:[1,1,0]
    v_pk_fma_f32 v[120:121], v[120:121], v[160:161], v[164:165]
    v_pk_fma_f32 v[122:123], v[122:123], v[162:163], v[166:167]
    v_pk_fma_f32 v[124:125], v[124:125], v[160:161], v[164:165]
    v_pk_fma_f32 v[126:127], v[126:127], v[162:163], v[166:167]
    v_pk_fma_f32 v[64:65], v[64:65], v[120:121], v[112:113]
    v_pk_fma_f32 v[66:67], v[66:67], v[122:123], v[114:115]
    v_pk_fma_f32 v[68:69], v[68:69], v[124:125], v[116:117]
    v_pk_fma_f32 v[70:71], v[70:71], v[126:127], v[118:119]
    v_cvt_pk_bf16_f32 v108, v64, v65
    v_cvt_pk_bf16_f32 v109, v66, v67
    v_cvt_pk_bf16_f32 v110, v68, v69
    v_cvt_pk_bf16_f32 v111, v70, v71
    s_add_u32 s39, s38, 5492736
    buffer_store_dwordx4 v[96:99], v4, s[28:31], s39 offen sc1
    s_add_u32 s39, s39, 655360
    buffer_store_dwordx4 v[100:103], v4, s[28:31], s39 offen sc1
    s_add_u32 s39, s39, 655360
    buffer_store_dwordx4 v[104:107], v4, s[28:31], s39 offen sc1
    s_add_u32 s39, s39, 655360
    buffer_store_dwordx4 v[108:111], v4, s[28:31], s39 offen sc1
    s_add_u32 s39, s39, 655360
    s_waitcnt vmcnt(0)
    s_endpgm
p_pack:
    s_sub_u32 s21, s2, 416
    s_mul_i32 s34, s20, 13824
    s_cmp_ge_u32 s20, 4
    s_cbranch_scc1 prep_end
    s_cmp_eq_u32 s20, 0
    s_cbranch_scc1 k1_pack
    s_cmp_eq_u32 s20, 1
    s_cbranch_scc0 p_pk2
    s_cmp_lt_u32 s21, 58
    s_cbranch_scc0 p_pk1
    s_add_u32 s21, s21, 96
    s_branch k1_pack
p_pk1:
    s_sub_u32 s21, s21, 58
    s_cmp_ge_u32 s21, 30
    s_cbranch_scc1 prep_end
    s_branch p_fin
p_pk2:
    s_sub_u32 s22, s20, 2
    s_mul_i32 s22, s22, 96
    s_add_u32 s21, s21, s22
    s_cmp_ge_u32 s21, 120
    s_cbranch_scc1 prep_end
    s_add_u32 s21, s21, 120
    v_mov_b32 v251, 0
    buffer_load_dword v250, v251, s[48:51], 0 offen sc1
    s_branch p_mod
p_fin:
    s_add_u32 s21, s21, 30
    v_mov_b32 v16, 0
    buffer_load_dword v17, v16, s[48:51], 0 offen sc1
    s_waitcnt vmcnt(0)
    s_mov_b32 s47, 0
prep_kernel_nn19:
    v_readfirstlane_b32 s46, v17
    s_add_u32 s47, s47, 1
    s_cmp_lg_u32 s46, 0
    s_cbranch_scc1 prep_kernel_nd20
    s_cmp_ge_u32 s47, 200000
    s_cbranch_scc1 prep_kernel_nd20
    buffer_load_dword v17, v16, s[48:51], 0 offen sc1
    s_waitcnt vmcnt(0)
    s_branch prep_kernel_nn19
prep_kernel_nd20:
    s_lshl_b32 s40, s21, 9
    s_add_u32 s40, s40, 29700096
    v_lshlrev_b32 v16, 7, v1
    s_mov_b32 s47, 0
    s_mov_b64 exec, 15
prep_kernel_pl21:
    buffer_load_dword v17, v16, s[28:31], s40 offen sc1
    s_add_u32 s47, s47, 1
    s_waitcnt vmcnt(0)
    v_cmp_ne_u32 vcc, s46, v17
    s_cmp_ge_u32 s47, 200000
    s_cbranch_scc1 prep_kernel_pd22
    s_cbranch_vccz prep_kernel_pd22
    s_sleep 8
    s_branch prep_kernel_pl21
prep_kernel_pd22:
    s_mov_b64 exec, -1
    v_lshlrev_b32 v7, 2, v1
    s_lshl_b32 s22, s21, 8
    s_add_u32 s23, s22, 2793472
    buffer_load_dword v10, v7, s[28:31], s23 offen sc1
    s_add_u32 s23, s23, 15360
    buffer_load_dword v11, v7, s[28:31], s23 offen sc1
    s_add_u32 s23, s23, 15360
    buffer_load_dword v12, v7, s[28:31], s23 offen sc1
    s_add_u32 s23, s23, 15360
    buffer_load_dword v13, v7, s[28:31], s23 offen sc1
    s_waitcnt vmcnt(0)
    v_add_f32 v10, v10, v11
    v_add_f32 v12, v12, v13
    s_nop 0
    v_add_f32 v10, v10, v12
    s_nop 0
    v_cvt_pk_bf16_f32 v10, v10, v10
    s_nop 0
    v_lshlrev_b32 v10, 16, v10
    s_sub_u32 s24, s21, 10
    s_cmp_lt_u32 s24, 10
    s_cbranch_scc1 prep_kernel_f123
    s_sub_u32 s24, s21, 40
    s_cmp_lt_u32 s24, 10
    s_cbranch_scc0 prep_kernel_f224
prep_kernel_f123:
    v_add_f32 v10, 1.0, v10
    s_nop 0
    v_cvt_pk_bf16_f32 v10, v10, v10
    s_nop 0
    v_lshlrev_b32 v10, 16, v10
prep_kernel_f224:
    s_add_u32 s22, s22, 8114176
    buffer_store_dword v10, v7, s[28:31], s22 offen sc1
    s_endpgm
k1_pack:
    v_lshrrev_b32 v3, 3, v1
    v_and_b32 v4, 7, v1
    v_mul_u32_u24 v5, 144, v3
    v_lshl_add_u32 v5, v4, 4, v5
    v_add_u32 v5, s34, v5
    v_and_b32 v6, 15, v1
    v_lshrrev_b32 v7, 4, v1
    v_lshrrev_b32 v8, 2, v6
    v_lshl_add_u32 v8, v7, 3, v8
    v_mul_u32_u24 v8, 144, v8
    v_and_b32 v9, 3, v6
    v_lshl_add_u32 v8, v9, 3, v8
    v_add_u32 v8, s34, v8
    v_lshlrev_b32 v9, 4, v1
    s_cmp_lt_u32 s21, 20
    s_cbranch_scc1 prep_kernel_pk25
    s_cmp_lt_u32 s21, 40
    s_cbranch_scc1 prep_kernel_pk26
    s_cmp_lt_u32 s21, 94
    s_cbranch_scc1 prep_kernel_pk27
    s_branch prep_kernel_pk28
prep_kernel_pk25:
    s_mov_b32 s24, s12
    s_mov_b32 s25, s13
    s_mov_b32 s26, 819200
    s_mov_b32 s27, 0x00020000
    s_sub_u32 s32, s21, 0
    s_mul_i32 s33, s32, 52429
    s_lshr_b32 s33, s33, 19
    s_mul_i32 s35, s33, 10
    s_sub_u32 s35, s32, s35
    v_mul_u32_u24 v10, 1280, v3
    v_lshl_add_u32 v10, v4, 4, v10
    s_mul_i32 s36, s33, 409600
    s_lshl_b32 s37, s35, 7
    s_add_u32 s36, s36, s37
    buffer_load_dwordx4 v[32:35], v10, s[24:27], s36 offen nt
    s_add_u32 s36, s36, 10240
    buffer_load_dwordx4 v[36:39], v10, s[24:27], s36 offen nt
    s_add_u32 s36, s36, 10240
    buffer_load_dwordx4 v[40:43], v10, s[24:27], s36 offen nt
    s_add_u32 s36, s36, 10240
    buffer_load_dwordx4 v[44:47], v10, s[24:27], s36 offen nt
    s_add_u32 s36, s36, 10240
    buffer_load_dwordx4 v[48:51], v10, s[24:27], s36 offen nt
    s_add_u32 s36, s36, 10240
    buffer_load_dwordx4 v[52:55], v10, s[24:27], s36 offen nt
    s_add_u32 s36, s36, 10240
    buffer_load_dwordx4 v[56:59], v10, s[24:27], s36 offen nt
    s_add_u32 s36, s36, 10240
    buffer_load_dwordx4 v[60:63], v10, s[24:27], s36 offen nt
    s_add_u32 s36, s36, 10240
    buffer_load_dwordx4 v[64:67], v10, s[24:27], s36 offen nt
    s_add_u32 s36, s36, 10240
    buffer_load_dwordx4 v[68:71], v10, s[24:27], s36 offen nt
    s_add_u32 s36, s36, 10240
    buffer_load_dwordx4 v[72:75], v10, s[24:27], s36 offen nt
    s_add_u32 s36, s36, 10240
    buffer_load_dwordx4 v[76:79], v10, s[24:27], s36 offen nt
    s_add_u32 s36, s36, 10240
    buffer_load_dwordx4 v[80:83], v10, s[24:27], s36 offen nt
    s_add_u32 s36, s36, 10240
    buffer_load_dwordx4 v[84:87], v10, s[24:27], s36 offen nt
    s_add_u32 s36, s36, 10240
    buffer_load_dwordx4 v[88:91], v10, s[24:27], s36 offen nt
    s_add_u32 s36, s36, 10240
    buffer_load_dwordx4 v[92:95], v10, s[24:27], s36 offen nt
    s_add_u32 s36, s36, 10240
    buffer_load_dwordx4 v[96:99], v10, s[24:27], s36 offen nt
    s_add_u32 s36, s36, 10240
    buffer_load_dwordx4 v[100:103], v10, s[24:27], s36 offen nt
    s_add_u32 s36, s36, 10240
    buffer_load_dwordx4 v[104:107], v10, s[24:27], s36 offen nt
    s_add_u32 s36, s36, 10240
    buffer_load_dwordx4 v[108:111], v10, s[24:27], s36 offen nt
    s_add_u32 s36, s36, 10240
    buffer_load_dwordx4 v[112:115], v10, s[24:27], s36 offen nt
    s_add_u32 s36, s36, 10240
    buffer_load_dwordx4 v[116:119], v10, s[24:27], s36 offen nt
    s_add_u32 s36, s36, 10240
    buffer_load_dwordx4 v[120:123], v10, s[24:27], s36 offen nt
    s_add_u32 s36, s36, 10240
    buffer_load_dwordx4 v[124:127], v10, s[24:27], s36 offen nt
    s_add_u32 s36, s36, 10240
    buffer_load_dwordx4 v[128:131], v10, s[24:27], s36 offen nt
    s_add_u32 s36, s36, 10240
    buffer_load_dwordx4 v[132:135], v10, s[24:27], s36 offen nt
    s_add_u32 s36, s36, 10240
    buffer_load_dwordx4 v[136:139], v10, s[24:27], s36 offen nt
    s_add_u32 s36, s36, 10240
    buffer_load_dwordx4 v[140:143], v10, s[24:27], s36 offen nt
    s_add_u32 s36, s36, 10240
    buffer_load_dwordx4 v[144:147], v10, s[24:27], s36 offen nt
    s_add_u32 s36, s36, 10240
    buffer_load_dwordx4 v[148:151], v10, s[24:27], s36 offen nt
    s_add_u32 s36, s36, 10240
    buffer_load_dwordx4 v[152:155], v10, s[24:27], s36 offen nt
    s_add_u32 s36, s36, 10240
    buffer_load_dwordx4 v[156:159], v10, s[24:27], s36 offen nt
    s_add_u32 s36, s36, 10240
    buffer_load_dwordx4 v[160:163], v10, s[24:27], s36 offen nt
    s_add_u32 s36, s36, 10240
    buffer_load_dwordx4 v[164:167], v10, s[24:27], s36 offen nt
    s_add_u32 s36, s36, 10240
    buffer_load_dwordx4 v[168:171], v10, s[24:27], s36 offen nt
    s_add_u32 s36, s36, 10240
    buffer_load_dwordx4 v[172:175], v10, s[24:27], s36 offen nt
    s_add_u32 s36, s36, 10240
    buffer_load_dwordx4 v[176:179], v10, s[24:27], s36 offen nt
    s_add_u32 s36, s36, 10240
    buffer_load_dwordx4 v[180:183], v10, s[24:27], s36 offen nt
    s_add_u32 s36, s36, 10240
    buffer_load_dwordx4 v[184:187], v10, s[24:27], s36 offen nt
    s_add_u32 s36, s36, 10240
    buffer_load_dwordx4 v[188:191], v10, s[24:27], s36 offen nt
    s_lshl_b32 s36, s35, 2
    s_add_u32 s36, s36, 0
    s_mul_i32 s38, s36, 6554
    s_lshr_b32 s38, s38, 16
    s_mul_i32 s39, s38, 10
    s_sub_u32 s39, s36, s39
    s_cmp_ge_u32 s39, 5
    s_cselect_b32 s40, 1, 0
    s_sub_u32 s41, s39, 6
    s_cmp_eq_u32 s39, 5
    s_cselect_b32 s41, 4, s41
    s_cmp_eq_u32 s40, 1
    s_cselect_b32 s39, s41, s39
    s_mul_i32 s37, s38, 200
    s_mul_i32 s40, s40, 100
    s_add_u32 s37, s37, s40
    s_mul_i32 s40, s33, 50
    s_add_u32 s37, s37, s40
    s_add_u32 s37, s37, s39
    s_lshl_b32 s37, s37, 10
    s_add_u32 s44, s37, 23236608
    s_movk_i32 s48, 5120
    s_lshl_b32 s36, s35, 2
    s_add_u32 s36, s36, 1
    s_mul_i32 s38, s36, 6554
    s_lshr_b32 s38, s38, 16
    s_mul_i32 s39, s38, 10
    s_sub_u32 s39, s36, s39
    s_cmp_ge_u32 s39, 5
    s_cselect_b32 s40, 1, 0
    s_sub_u32 s41, s39, 6
    s_cmp_eq_u32 s39, 5
    s_cselect_b32 s41, 4, s41
    s_cmp_eq_u32 s40, 1
    s_cselect_b32 s39, s41, s39
    s_mul_i32 s37, s38, 200
    s_mul_i32 s40, s40, 100
    s_add_u32 s37, s37, s40
    s_mul_i32 s40, s33, 50
    s_add_u32 s37, s37, s40
    s_add_u32 s37, s37, s39
    s_lshl_b32 s37, s37, 10
    s_add_u32 s45, s37, 23236608
    s_movk_i32 s49, 5120
    s_lshl_b32 s36, s35, 2
    s_add_u32 s36, s36, 2
    s_mul_i32 s38, s36, 6554
    s_lshr_b32 s38, s38, 16
    s_mul_i32 s39, s38, 10
    s_sub_u32 s39, s36, s39
    s_cmp_ge_u32 s39, 5
    s_cselect_b32 s40, 1, 0
    s_sub_u32 s41, s39, 6
    s_cmp_eq_u32 s39, 5
    s_cselect_b32 s41, 4, s41
    s_cmp_eq_u32 s40, 1
    s_cselect_b32 s39, s41, s39
    s_mul_i32 s37, s38, 200
    s_mul_i32 s40, s40, 100
    s_add_u32 s37, s37, s40
    s_mul_i32 s40, s33, 50
    s_add_u32 s37, s37, s40
    s_add_u32 s37, s37, s39
    s_lshl_b32 s37, s37, 10
    s_add_u32 s46, s37, 23236608
    s_movk_i32 s50, 5120
    s_lshl_b32 s36, s35, 2
    s_add_u32 s36, s36, 3
    s_mul_i32 s38, s36, 6554
    s_lshr_b32 s38, s38, 16
    s_mul_i32 s39, s38, 10
    s_sub_u32 s39, s36, s39
    s_cmp_ge_u32 s39, 5
    s_cselect_b32 s40, 1, 0
    s_sub_u32 s41, s39, 6
    s_cmp_eq_u32 s39, 5
    s_cselect_b32 s41, 4, s41
    s_cmp_eq_u32 s40, 1
    s_cselect_b32 s39, s41, s39
    s_mul_i32 s37, s38, 200
    s_mul_i32 s40, s40, 100
    s_add_u32 s37, s37, s40
    s_mul_i32 s40, s33, 50
    s_add_u32 s37, s37, s40
    s_add_u32 s37, s37, s39
    s_lshl_b32 s37, s37, 10
    s_add_u32 s47, s37, 23236608
    s_movk_i32 s51, 5120
    v_mov_b32 v12, 0
    v_mov_b32 v13, 0
    v_mov_b32 v14, 0
    v_mov_b32 v15, 0
    v_mov_b32 v16, 0x3f803f80
    s_waitcnt vmcnt(36)
    ds_write_b128 v5, v[32:35] offset:0
    ds_write_b128 v5, v[36:39] offset:1152
    ds_write_b128 v5, v[40:43] offset:2304
    ds_write_b128 v5, v[44:47] offset:3456
    s_waitcnt lgkmcnt(0)
    ds_read_b64_tr_b16 v[200:201], v8 offset:0
    ds_read_b64_tr_b16 v[202:203], v8 offset:576
    ds_read_b64_tr_b16 v[204:205], v8 offset:32
    ds_read_b64_tr_b16 v[206:207], v8 offset:608
    ds_read_b64_tr_b16 v[208:209], v8 offset:64
    ds_read_b64_tr_b16 v[210:211], v8 offset:640
    ds_read_b64_tr_b16 v[212:213], v8 offset:96
    ds_read_b64_tr_b16 v[214:215], v8 offset:672
    s_waitcnt vmcnt(32)
    ds_write_b128 v5, v[48:51] offset:4608
    ds_write_b128 v5, v[52:55] offset:5760
    ds_write_b128 v5, v[56:59] offset:6912
    ds_write_b128 v5, v[60:63] offset:8064
    s_waitcnt lgkmcnt(4)
    buffer_store_dwordx4 v[200:203], v9, s[28:31], s44 offen sc1
    s_add_u32 s44, s44, s48
    v_dot2_f32_bf16 v12, v200, v16, v12
    v_dot2_f32_bf16 v12, v201, v16, v12
    v_dot2_f32_bf16 v12, v202, v16, v12
    v_dot2_f32_bf16 v12, v203, v16, v12
    buffer_store_dwordx4 v[204:207], v9, s[28:31], s45 offen sc1
    s_add_u32 s45, s45, s49
    v_dot2_f32_bf16 v13, v204, v16, v13
    v_dot2_f32_bf16 v13, v205, v16, v13
    v_dot2_f32_bf16 v13, v206, v16, v13
    v_dot2_f32_bf16 v13, v207, v16, v13
    buffer_store_dwordx4 v[208:211], v9, s[28:31], s46 offen sc1
    s_add_u32 s46, s46, s50
    v_dot2_f32_bf16 v14, v208, v16, v14
    v_dot2_f32_bf16 v14, v209, v16, v14
    v_dot2_f32_bf16 v14, v210, v16, v14
    v_dot2_f32_bf16 v14, v211, v16, v14
    buffer_store_dwordx4 v[212:215], v9, s[28:31], s47 offen sc1
    s_add_u32 s47, s47, s51
    v_dot2_f32_bf16 v15, v212, v16, v15
    v_dot2_f32_bf16 v15, v213, v16, v15
    v_dot2_f32_bf16 v15, v214, v16, v15
    v_dot2_f32_bf16 v15, v215, v16, v15
    s_waitcnt lgkmcnt(0)
    ds_read_b64_tr_b16 v[216:217], v8 offset:4608
    ds_read_b64_tr_b16 v[218:219], v8 offset:5184
    ds_read_b64_tr_b16 v[220:221], v8 offset:4640
    ds_read_b64_tr_b16 v[222:223], v8 offset:5216
    ds_read_b64_tr_b16 v[224:225], v8 offset:4672
    ds_read_b64_tr_b16 v[226:227], v8 offset:5248
    ds_read_b64_tr_b16 v[228:229], v8 offset:4704
    ds_read_b64_tr_b16 v[230:231], v8 offset:5280
    s_waitcnt vmcnt(32)
    ds_write_b128 v5, v[64:67] offset:0
    ds_write_b128 v5, v[68:71] offset:1152
    ds_write_b128 v5, v[72:75] offset:2304
    ds_write_b128 v5, v[76:79] offset:3456
    s_waitcnt lgkmcnt(4)
    buffer_store_dwordx4 v[216:219], v9, s[28:31], s44 offen sc1
    s_add_u32 s44, s44, s48
    v_dot2_f32_bf16 v12, v216, v16, v12
    v_dot2_f32_bf16 v12, v217, v16, v12
    v_dot2_f32_bf16 v12, v218, v16, v12
    v_dot2_f32_bf16 v12, v219, v16, v12
    buffer_store_dwordx4 v[220:223], v9, s[28:31], s45 offen sc1
    s_add_u32 s45, s45, s49
    v_dot2_f32_bf16 v13, v220, v16, v13
    v_dot2_f32_bf16 v13, v221, v16, v13
    v_dot2_f32_bf16 v13, v222, v16, v13
    v_dot2_f32_bf16 v13, v223, v16, v13
    buffer_store_dwordx4 v[224:227], v9, s[28:31], s46 offen sc1
    s_add_u32 s46, s46, s50
    v_dot2_f32_bf16 v14, v224, v16, v14
    v_dot2_f32_bf16 v14, v225, v16, v14
    v_dot2_f32_bf16 v14, v226, v16, v14
    v_dot2_f32_bf16 v14, v227, v16, v14
    buffer_store_dwordx4 v[228:231], v9, s[28:31], s47 offen sc1
    s_add_u32 s47, s47, s51
    v_dot2_f32_bf16 v15, v228, v16, v15
    v_dot2_f32_bf16 v15, v229, v16, v15
    v_dot2_f32_bf16 v15, v230, v16, v15
    v_dot2_f32_bf16 v15, v231, v16, v15
    s_waitcnt lgkmcnt(0)
    ds_read_b64_tr_b16 v[200:201], v8 offset:0
    ds_read_b64_tr_b16 v[202:203], v8 offset:576
    ds_read_b64_tr_b16 v[204:205], v8 offset:32
    ds_read_b64_tr_b16 v[206:207], v8 offset:608
    ds_read_b64_tr_b16 v[208:209], v8 offset:64
    ds_read_b64_tr_b16 v[210:211], v8 offset:640
    ds_read_b64_tr_b16 v[212:213], v8 offset:96
    ds_read_b64_tr_b16 v[214:215], v8 offset:672
    s_waitcnt vmcnt(32)
    ds_write_b128 v5, v[80:83] offset:4608
    ds_write_b128 v5, v[84:87] offset:5760
    ds_write_b128 v5, v[88:91] offset:6912
    ds_write_b128 v5, v[92:95] offset:8064
    s_waitcnt lgkmcnt(4)
    buffer_store_dwordx4 v[200:203], v9, s[28:31], s44 offen sc1
    s_add_u32 s44, s44, s48
    v_dot2_f32_bf16 v12, v200, v16, v12
    v_dot2_f32_bf16 v12, v201, v16, v12
    v_dot2_f32_bf16 v12, v202, v16, v12
    v_dot2_f32_bf16 v12, v203, v16, v12
    buffer_store_dwordx4 v[204:207], v9, s[28:31], s45 offen sc1
    s_add_u32 s45, s45, s49
    v_dot2_f32_bf16 v13, v204, v16, v13
    v_dot2_f32_bf16 v13, v205, v16, v13
    v_dot2_f32_bf16 v13, v206, v16, v13
    v_dot2_f32_bf16 v13, v207, v16, v13
    buffer_store_dwordx4 v[208:211], v9, s[28:31], s46 offen sc1
    s_add_u32 s46, s46, s50
    v_dot2_f32_bf16 v14, v208, v16, v14
    v_dot2_f32_bf16 v14, v209, v16, v14
    v_dot2_f32_bf16 v14, v210, v16, v14
    v_dot2_f32_bf16 v14, v211, v16, v14
    buffer_store_dwordx4 v[212:215], v9, s[28:31], s47 offen sc1
    s_add_u32 s47, s47, s51
    v_dot2_f32_bf16 v15, v212, v16, v15
    v_dot2_f32_bf16 v15, v213, v16, v15
    v_dot2_f32_bf16 v15, v214, v16, v15
    v_dot2_f32_bf16 v15, v215, v16, v15
    s_waitcnt lgkmcnt(0)
    ds_read_b64_tr_b16 v[216:217], v8 offset:4608
    ds_read_b64_tr_b16 v[218:219], v8 offset:5184
    ds_read_b64_tr_b16 v[220:221], v8 offset:4640
    ds_read_b64_tr_b16 v[222:223], v8 offset:5216
    ds_read_b64_tr_b16 v[224:225], v8 offset:4672
    ds_read_b64_tr_b16 v[226:227], v8 offset:5248
    ds_read_b64_tr_b16 v[228:229], v8 offset:4704
    ds_read_b64_tr_b16 v[230:231], v8 offset:5280
    s_waitcnt vmcnt(32)
    ds_write_b128 v5, v[96:99] offset:0
    ds_write_b128 v5, v[100:103] offset:1152
    ds_write_b128 v5, v[104:107] offset:2304
    ds_write_b128 v5, v[108:111] offset:3456
    s_waitcnt lgkmcnt(4)
    buffer_store_dwordx4 v[216:219], v9, s[28:31], s44 offen sc1
    s_add_u32 s44, s44, s48
    v_dot2_f32_bf16 v12, v216, v16, v12
    v_dot2_f32_bf16 v12, v217, v16, v12
    v_dot2_f32_bf16 v12, v218, v16, v12
    v_dot2_f32_bf16 v12, v219, v16, v12
    buffer_store_dwordx4 v[220:223], v9, s[28:31], s45 offen sc1
    s_add_u32 s45, s45, s49
    v_dot2_f32_bf16 v13, v220, v16, v13
    v_dot2_f32_bf16 v13, v221, v16, v13
    v_dot2_f32_bf16 v13, v222, v16, v13
    v_dot2_f32_bf16 v13, v223, v16, v13
    buffer_store_dwordx4 v[224:227], v9, s[28:31], s46 offen sc1
    s_add_u32 s46, s46, s50
    v_dot2_f32_bf16 v14, v224, v16, v14
    v_dot2_f32_bf16 v14, v225, v16, v14
    v_dot2_f32_bf16 v14, v226, v16, v14
    v_dot2_f32_bf16 v14, v227, v16, v14
    buffer_store_dwordx4 v[228:231], v9, s[28:31], s47 offen sc1
    s_add_u32 s47, s47, s51
    v_dot2_f32_bf16 v15, v228, v16, v15
    v_dot2_f32_bf16 v15, v229, v16, v15
    v_dot2_f32_bf16 v15, v230, v16, v15
    v_dot2_f32_bf16 v15, v231, v16, v15
    s_waitcnt lgkmcnt(0)
    ds_read_b64_tr_b16 v[200:201], v8 offset:0
    ds_read_b64_tr_b16 v[202:203], v8 offset:576
    ds_read_b64_tr_b16 v[204:205], v8 offset:32
    ds_read_b64_tr_b16 v[206:207], v8 offset:608
    ds_read_b64_tr_b16 v[208:209], v8 offset:64
    ds_read_b64_tr_b16 v[210:211], v8 offset:640
    ds_read_b64_tr_b16 v[212:213], v8 offset:96
    ds_read_b64_tr_b16 v[214:215], v8 offset:672
    s_waitcnt vmcnt(32)
    ds_write_b128 v5, v[112:115] offset:4608
    ds_write_b128 v5, v[116:119] offset:5760
    ds_write_b128 v5, v[120:123] offset:6912
    ds_write_b128 v5, v[124:127] offset:8064
    s_waitcnt lgkmcnt(4)
    buffer_store_dwordx4 v[200:203], v9, s[28:31], s44 offen sc1
    s_add_u32 s44, s44, s48
    v_dot2_f32_bf16 v12, v200, v16, v12
    v_dot2_f32_bf16 v12, v201, v16, v12
    v_dot2_f32_bf16 v12, v202, v16, v12
    v_dot2_f32_bf16 v12, v203, v16, v12
    buffer_store_dwordx4 v[204:207], v9, s[28:31], s45 offen sc1
    s_add_u32 s45, s45, s49
    v_dot2_f32_bf16 v13, v204, v16, v13
    v_dot2_f32_bf16 v13, v205, v16, v13
    v_dot2_f32_bf16 v13, v206, v16, v13
    v_dot2_f32_bf16 v13, v207, v16, v13
    buffer_store_dwordx4 v[208:211], v9, s[28:31], s46 offen sc1
    s_add_u32 s46, s46, s50
    v_dot2_f32_bf16 v14, v208, v16, v14
    v_dot2_f32_bf16 v14, v209, v16, v14
    v_dot2_f32_bf16 v14, v210, v16, v14
    v_dot2_f32_bf16 v14, v211, v16, v14
    buffer_store_dwordx4 v[212:215], v9, s[28:31], s47 offen sc1
    s_add_u32 s47, s47, s51
    v_dot2_f32_bf16 v15, v212, v16, v15
    v_dot2_f32_bf16 v15, v213, v16, v15
    v_dot2_f32_bf16 v15, v214, v16, v15
    v_dot2_f32_bf16 v15, v215, v16, v15
    s_waitcnt lgkmcnt(0)
    ds_read_b64_tr_b16 v[216:217], v8 offset:4608
    ds_read_b64_tr_b16 v[218:219], v8 offset:5184
    ds_read_b64_tr_b16 v[220:221], v8 offset:4640
    ds_read_b64_tr_b16 v[222:223], v8 offset:5216
    ds_read_b64_tr_b16 v[224:225], v8 offset:4672
    ds_read_b64_tr_b16 v[226:227], v8 offset:5248
    ds_read_b64_tr_b16 v[228:229], v8 offset:4704
    ds_read_b64_tr_b16 v[230:231], v8 offset:5280
    s_waitcnt vmcnt(32)
    ds_write_b128 v5, v[128:131] offset:0
    ds_write_b128 v5, v[132:135] offset:1152
    ds_write_b128 v5, v[136:139] offset:2304
    ds_write_b128 v5, v[140:143] offset:3456
    s_waitcnt lgkmcnt(4)
    buffer_store_dwordx4 v[216:219], v9, s[28:31], s44 offen sc1
    s_add_u32 s44, s44, s48
    v_dot2_f32_bf16 v12, v216, v16, v12
    v_dot2_f32_bf16 v12, v217, v16, v12
    v_dot2_f32_bf16 v12, v218, v16, v12
    v_dot2_f32_bf16 v12, v219, v16, v12
    buffer_store_dwordx4 v[220:223], v9, s[28:31], s45 offen sc1
    s_add_u32 s45, s45, s49
    v_dot2_f32_bf16 v13, v220, v16, v13
    v_dot2_f32_bf16 v13, v221, v16, v13
    v_dot2_f32_bf16 v13, v222, v16, v13
    v_dot2_f32_bf16 v13, v223, v16, v13
    buffer_store_dwordx4 v[224:227], v9, s[28:31], s46 offen sc1
    s_add_u32 s46, s46, s50
    v_dot2_f32_bf16 v14, v224, v16, v14
    v_dot2_f32_bf16 v14, v225, v16, v14
    v_dot2_f32_bf16 v14, v226, v16, v14
    v_dot2_f32_bf16 v14, v227, v16, v14
    buffer_store_dwordx4 v[228:231], v9, s[28:31], s47 offen sc1
    s_add_u32 s47, s47, s51
    v_dot2_f32_bf16 v15, v228, v16, v15
    v_dot2_f32_bf16 v15, v229, v16, v15
    v_dot2_f32_bf16 v15, v230, v16, v15
    v_dot2_f32_bf16 v15, v231, v16, v15
    s_waitcnt lgkmcnt(0)
    ds_read_b64_tr_b16 v[200:201], v8 offset:0
    ds_read_b64_tr_b16 v[202:203], v8 offset:576
    ds_read_b64_tr_b16 v[204:205], v8 offset:32
    ds_read_b64_tr_b16 v[206:207], v8 offset:608
    ds_read_b64_tr_b16 v[208:209], v8 offset:64
    ds_read_b64_tr_b16 v[210:211], v8 offset:640
    ds_read_b64_tr_b16 v[212:213], v8 offset:96
    ds_read_b64_tr_b16 v[214:215], v8 offset:672
    s_waitcnt vmcnt(32)
    ds_write_b128 v5, v[144:147] offset:4608
    ds_write_b128 v5, v[148:151] offset:5760
    ds_write_b128 v5, v[152:155] offset:6912
    ds_write_b128 v5, v[156:159] offset:8064
    s_waitcnt lgkmcnt(4)
    buffer_store_dwordx4 v[200:203], v9, s[28:31], s44 offen sc1
    s_add_u32 s44, s44, s48
    v_dot2_f32_bf16 v12, v200, v16, v12
    v_dot2_f32_bf16 v12, v201, v16, v12
    v_dot2_f32_bf16 v12, v202, v16, v12
    v_dot2_f32_bf16 v12, v203, v16, v12
    buffer_store_dwordx4 v[204:207], v9, s[28:31], s45 offen sc1
    s_add_u32 s45, s45, s49
    v_dot2_f32_bf16 v13, v204, v16, v13
    v_dot2_f32_bf16 v13, v205, v16, v13
    v_dot2_f32_bf16 v13, v206, v16, v13
    v_dot2_f32_bf16 v13, v207, v16, v13
    buffer_store_dwordx4 v[208:211], v9, s[28:31], s46 offen sc1
    s_add_u32 s46, s46, s50
    v_dot2_f32_bf16 v14, v208, v16, v14
    v_dot2_f32_bf16 v14, v209, v16, v14
    v_dot2_f32_bf16 v14, v210, v16, v14
    v_dot2_f32_bf16 v14, v211, v16, v14
    buffer_store_dwordx4 v[212:215], v9, s[28:31], s47 offen sc1
    s_add_u32 s47, s47, s51
    v_dot2_f32_bf16 v15, v212, v16, v15
    v_dot2_f32_bf16 v15, v213, v16, v15
    v_dot2_f32_bf16 v15, v214, v16, v15
    v_dot2_f32_bf16 v15, v215, v16, v15
    s_waitcnt lgkmcnt(0)
    ds_read_b64_tr_b16 v[216:217], v8 offset:4608
    ds_read_b64_tr_b16 v[218:219], v8 offset:5184
    ds_read_b64_tr_b16 v[220:221], v8 offset:4640
    ds_read_b64_tr_b16 v[222:223], v8 offset:5216
    ds_read_b64_tr_b16 v[224:225], v8 offset:4672
    ds_read_b64_tr_b16 v[226:227], v8 offset:5248
    ds_read_b64_tr_b16 v[228:229], v8 offset:4704
    ds_read_b64_tr_b16 v[230:231], v8 offset:5280
    s_waitcnt vmcnt(32)
    ds_write_b128 v5, v[160:163] offset:0
    ds_write_b128 v5, v[164:167] offset:1152
    ds_write_b128 v5, v[168:171] offset:2304
    ds_write_b128 v5, v[172:175] offset:3456
    s_waitcnt lgkmcnt(4)
    buffer_store_dwordx4 v[216:219], v9, s[28:31], s44 offen sc1
    s_add_u32 s44, s44, s48
    v_dot2_f32_bf16 v12, v216, v16, v12
    v_dot2_f32_bf16 v12, v217, v16, v12
    v_dot2_f32_bf16 v12, v218, v16, v12
    v_dot2_f32_bf16 v12, v219, v16, v12
    buffer_store_dwordx4 v[220:223], v9, s[28:31], s45 offen sc1
    s_add_u32 s45, s45, s49
    v_dot2_f32_bf16 v13, v220, v16, v13
    v_dot2_f32_bf16 v13, v221, v16, v13
    v_dot2_f32_bf16 v13, v222, v16, v13
    v_dot2_f32_bf16 v13, v223, v16, v13
    buffer_store_dwordx4 v[224:227], v9, s[28:31], s46 offen sc1
    s_add_u32 s46, s46, s50
    v_dot2_f32_bf16 v14, v224, v16, v14
    v_dot2_f32_bf16 v14, v225, v16, v14
    v_dot2_f32_bf16 v14, v226, v16, v14
    v_dot2_f32_bf16 v14, v227, v16, v14
    buffer_store_dwordx4 v[228:231], v9, s[28:31], s47 offen sc1
    s_add_u32 s47, s47, s51
    v_dot2_f32_bf16 v15, v228, v16, v15
    v_dot2_f32_bf16 v15, v229, v16, v15
    v_dot2_f32_bf16 v15, v230, v16, v15
    v_dot2_f32_bf16 v15, v231, v16, v15
    s_waitcnt lgkmcnt(0)
    ds_read_b64_tr_b16 v[200:201], v8 offset:0
    ds_read_b64_tr_b16 v[202:203], v8 offset:576
    ds_read_b64_tr_b16 v[204:205], v8 offset:32
    ds_read_b64_tr_b16 v[206:207], v8 offset:608
    ds_read_b64_tr_b16 v[208:209], v8 offset:64
    ds_read_b64_tr_b16 v[210:211], v8 offset:640
    ds_read_b64_tr_b16 v[212:213], v8 offset:96
    ds_read_b64_tr_b16 v[214:215], v8 offset:672
    s_waitcnt vmcnt(32)
    ds_write_b128 v5, v[176:179] offset:4608
    ds_write_b128 v5, v[180:183] offset:5760
    ds_write_b128 v5, v[184:187] offset:6912
    ds_write_b128 v5, v[188:191] offset:8064
    s_waitcnt lgkmcnt(4)
    buffer_store_dwordx4 v[200:203], v9, s[28:31], s44 offen sc1
    s_add_u32 s44, s44, s48
    v_dot2_f32_bf16 v12, v200, v16, v12
    v_dot2_f32_bf16 v12, v201, v16, v12
    v_dot2_f32_bf16 v12, v202, v16, v12
    v_dot2_f32_bf16 v12, v203, v16, v12
    buffer_store_dwordx4 v[204:207], v9, s[28:31], s45 offen sc1
    s_add_u32 s45, s45, s49
    v_dot2_f32_bf16 v13, v204, v16, v13
    v_dot2_f32_bf16 v13, v205, v16, v13
    v_dot2_f32_bf16 v13, v206, v16, v13
    v_dot2_f32_bf16 v13, v207, v16, v13
    buffer_store_dwordx4 v[208:211], v9, s[28:31], s46 offen sc1
    s_add_u32 s46, s46, s50
    v_dot2_f32_bf16 v14, v208, v16, v14
    v_dot2_f32_bf16 v14, v209, v16, v14
    v_dot2_f32_bf16 v14, v210, v16, v14
    v_dot2_f32_bf16 v14, v211, v16, v14
    buffer_store_dwordx4 v[212:215], v9, s[28:31], s47 offen sc1
    s_add_u32 s47, s47, s51
    v_dot2_f32_bf16 v15, v212, v16, v15
    v_dot2_f32_bf16 v15, v213, v16, v15
    v_dot2_f32_bf16 v15, v214, v16, v15
    v_dot2_f32_bf16 v15, v215, v16, v15
    s_waitcnt lgkmcnt(0)
    ds_read_b64_tr_b16 v[216:217], v8 offset:4608
    ds_read_b64_tr_b16 v[218:219], v8 offset:5184
    ds_read_b64_tr_b16 v[220:221], v8 offset:4640
    ds_read_b64_tr_b16 v[222:223], v8 offset:5216
    ds_read_b64_tr_b16 v[224:225], v8 offset:4672
    ds_read_b64_tr_b16 v[226:227], v8 offset:5248
    ds_read_b64_tr_b16 v[228:229], v8 offset:4704
    ds_read_b64_tr_b16 v[230:231], v8 offset:5280
    s_waitcnt lgkmcnt(0)
    buffer_store_dwordx4 v[216:219], v9, s[28:31], s44 offen sc1
    s_add_u32 s44, s44, s48
    v_dot2_f32_bf16 v12, v216, v16, v12
    v_dot2_f32_bf16 v12, v217, v16, v12
    v_dot2_f32_bf16 v12, v218, v16, v12
    v_dot2_f32_bf16 v12, v219, v16, v12
    buffer_store_dwordx4 v[220:223], v9, s[28:31], s45 offen sc1
    s_add_u32 s45, s45, s49
    v_dot2_f32_bf16 v13, v220, v16, v13
    v_dot2_f32_bf16 v13, v221, v16, v13
    v_dot2_f32_bf16 v13, v222, v16, v13
    v_dot2_f32_bf16 v13, v223, v16, v13
    buffer_store_dwordx4 v[224:227], v9, s[28:31], s46 offen sc1
    s_add_u32 s46, s46, s50
    v_dot2_f32_bf16 v14, v224, v16, v14
    v_dot2_f32_bf16 v14, v225, v16, v14
    v_dot2_f32_bf16 v14, v226, v16, v14
    v_dot2_f32_bf16 v14, v227, v16, v14
    buffer_store_dwordx4 v[228:231], v9, s[28:31], s47 offen sc1
    s_add_u32 s47, s47, s51
    v_dot2_f32_bf16 v15, v228, v16, v15
    v_dot2_f32_bf16 v15, v229, v16, v15
    v_dot2_f32_bf16 v15, v230, v16, v15
    v_dot2_f32_bf16 v15, v231, v16, v15
    s_nop 2
    v_mov_b32 v20, v12
    v_mov_b32 v21, v13
    v_mov_b32 v22, v14
    v_mov_b32 v23, v15
    s_nop 1
    v_permlane32_swap_b32 v20, v12
    v_permlane32_swap_b32 v21, v13
    v_permlane32_swap_b32 v22, v14
    v_permlane32_swap_b32 v23, v15
    s_nop 1
    v_add_f32 v12, v12, v20
    v_add_f32 v13, v13, v21
    v_add_f32 v14, v14, v22
    v_add_f32 v15, v15, v23
    v_mov_b32 v20, v12
    v_mov_b32 v21, v13
    v_mov_b32 v22, v14
    v_mov_b32 v23, v15
    s_nop 1
    v_permlane16_swap_b32 v20, v12
    v_permlane16_swap_b32 v21, v13
    v_permlane16_swap_b32 v22, v14
    v_permlane16_swap_b32 v23, v15
    s_nop 1
    v_add_f32 v12, v12, v20
    v_add_f32 v13, v13, v21
    v_add_f32 v14, v14, v22
    v_add_f32 v15, v15, v23
    s_mul_i32 s38, s33, 7168
    s_lshl_b32 s39, s35, 8
    s_add_u32 s38, s38, s39
    s_add_u32 s38, s38, 8146944
    v_lshlrev_b32 v17, 2, v1
    s_mov_b64 exec, 0xffff
    buffer_store_dword v12, v17, s[28:31], s38 offen offset:0 sc1
    buffer_store_dword v13, v17, s[28:31], s38 offen offset:64 sc1
    buffer_store_dword v14, v17, s[28:31], s38 offen offset:128 sc1
    buffer_store_dword v15, v17, s[28:31], s38 offen offset:192 sc1
    s_endpgm
prep_kernel_pk26:
    s_mov_b32 s24, s14
    s_mov_b32 s25, s15
    s_mov_b32 s26, 819200
    s_mov_b32 s27, 0x00020000
    s_sub_u32 s32, s21, 20
    s_mul_i32 s33, s32, 52429
    s_lshr_b32 s33, s33, 19
    s_mul_i32 s35, s33, 10
    s_sub_u32 s35, s32, s35
    v_mul_u32_u24 v10, 1280, v3
    v_lshl_add_u32 v10, v4, 4, v10
    s_mul_i32 s36, s33, 409600
    s_lshl_b32 s37, s35, 7
    s_add_u32 s36, s36, s37
    buffer_load_dwordx4 v[32:35], v10, s[24:27], s36 offen nt
    s_add_u32 s36, s36, 10240
    buffer_load_dwordx4 v[36:39], v10, s[24:27], s36 offen nt
    s_add_u32 s36, s36, 10240
    buffer_load_dwordx4 v[40:43], v10, s[24:27], s36 offen nt
    s_add_u32 s36, s36, 10240
    buffer_load_dwordx4 v[44:47], v10, s[24:27], s36 offen nt
    s_add_u32 s36, s36, 10240
    buffer_load_dwordx4 v[48:51], v10, s[24:27], s36 offen nt
    s_add_u32 s36, s36, 10240
    buffer_load_dwordx4 v[52:55], v10, s[24:27], s36 offen nt
    s_add_u32 s36, s36, 10240
    buffer_load_dwordx4 v[56:59], v10, s[24:27], s36 offen nt
    s_add_u32 s36, s36, 10240
    buffer_load_dwordx4 v[60:63], v10, s[24:27], s36 offen nt
    s_add_u32 s36, s36, 10240
    buffer_load_dwordx4 v[64:67], v10, s[24:27], s36 offen nt
    s_add_u32 s36, s36, 10240
    buffer_load_dwordx4 v[68:71], v10, s[24:27], s36 offen nt
    s_add_u32 s36, s36, 10240
    buffer_load_dwordx4 v[72:75], v10, s[24:27], s36 offen nt
    s_add_u32 s36, s36, 10240
    buffer_load_dwordx4 v[76:79], v10, s[24:27], s36 offen nt
    s_add_u32 s36, s36, 10240
    buffer_load_dwordx4 v[80:83], v10, s[24:27], s36 offen nt
    s_add_u32 s36, s36, 10240
    buffer_load_dwordx4 v[84:87], v10, s[24:27], s36 offen nt
    s_add_u32 s36, s36, 10240
    buffer_load_dwordx4 v[88:91], v10, s[24:27], s36 offen nt
    s_add_u32 s36, s36, 10240
    buffer_load_dwordx4 v[92:95], v10, s[24:27], s36 offen nt
    s_add_u32 s36, s36, 10240
    buffer_load_dwordx4 v[96:99], v10, s[24:27], s36 offen nt
    s_add_u32 s36, s36, 10240
    buffer_load_dwordx4 v[100:103], v10, s[24:27], s36 offen nt
    s_add_u32 s36, s36, 10240
    buffer_load_dwordx4 v[104:107], v10, s[24:27], s36 offen nt
    s_add_u32 s36, s36, 10240
    buffer_load_dwordx4 v[108:111], v10, s[24:27], s36 offen nt
    s_add_u32 s36, s36, 10240
    buffer_load_dwordx4 v[112:115], v10, s[24:27], s36 offen nt
    s_add_u32 s36, s36, 10240
    buffer_load_dwordx4 v[116:119], v10, s[24:27], s36 offen nt
    s_add_u32 s36, s36, 10240
    buffer_load_dwordx4 v[120:123], v10, s[24:27], s36 offen nt
    s_add_u32 s36, s36, 10240
    buffer_load_dwordx4 v[124:127], v10, s[24:27], s36 offen nt
    s_add_u32 s36, s36, 10240
    buffer_load_dwordx4 v[128:131], v10, s[24:27], s36 offen nt
    s_add_u32 s36, s36, 10240
    buffer_load_dwordx4 v[132:135], v10, s[24:27], s36 offen nt
    s_add_u32 s36, s36, 10240
    buffer_load_dwordx4 v[136:139], v10, s[24:27], s36 offen nt
    s_add_u32 s36, s36, 10240
    buffer_load_dwordx4 v[140:143], v10, s[24:27], s36 offen nt
    s_add_u32 s36, s36, 10240
    buffer_load_dwordx4 v[144:147], v10, s[24:27], s36 offen nt
    s_add_u32 s36, s36, 10240
    buffer_load_dwordx4 v[148:151], v10, s[24:27], s36 offen nt
    s_add_u32 s36, s36, 10240
    buffer_load_dwordx4 v[152:155], v10, s[24:27], s36 offen nt
    s_add_u32 s36, s36, 10240
    buffer_load_dwordx4 v[156:159], v10, s[24:27], s36 offen nt
    s_add_u32 s36, s36, 10240
    buffer_load_dwordx4 v[160:163], v10, s[24:27], s36 offen nt
    s_add_u32 s36, s36, 10240
    buffer_load_dwordx4 v[164:167], v10, s[24:27], s36 offen nt
    s_add_u32 s36, s36, 10240
    buffer_load_dwordx4 v[168:171], v10, s[24:27], s36 offen nt
    s_add_u32 s36, s36, 10240
    buffer_load_dwordx4 v[172:175], v10, s[24:27], s36 offen nt
    s_add_u32 s36, s36, 10240
    buffer_load_dwordx4 v[176:179], v10, s[24:27], s36 offen nt
    s_add_u32 s36, s36, 10240
    buffer_load_dwordx4 v[180:183], v10, s[24:27], s36 offen nt
    s_add_u32 s36, s36, 10240
    buffer_load_dwordx4 v[184:187], v10, s[24:27], s36 offen nt
    s_add_u32 s36, s36, 10240
    buffer_load_dwordx4 v[188:191], v10, s[24:27], s36 offen nt
    s_lshl_b32 s36, s35, 2
    s_add_u32 s36, s36, 0
    s_mul_i32 s38, s36, 6554
    s_lshr_b32 s38, s38, 16
    s_mul_i32 s39, s38, 10
    s_sub_u32 s39, s36, s39
    s_cmp_ge_u32 s39, 5
    s_cselect_b32 s40, 1, 0
    s_sub_u32 s41, s39, 6
    s_cmp_eq_u32 s39, 5
    s_cselect_b32 s41, 4, s41
    s_cmp_eq_u32 s40, 1
    s_cselect_b32 s39, s41, s39
    s_mul_i32 s37, s38, 200
    s_mul_i32 s40, s40, 100
    s_add_u32 s37, s37, s40
    s_mul_i32 s40, s33, 50
    s_add_u32 s37, s37, s40
    s_add_u32 s37, s37, s39
    s_lshl_b32 s37, s37, 10
    s_add_u32 s44, s37, 24055808
    s_movk_i32 s48, 5120
    s_lshl_b32 s36, s35, 2
    s_add_u32 s36, s36, 1
    s_mul_i32 s38, s36, 6554
    s_lshr_b32 s38, s38, 16
    s_mul_i32 s39, s38, 10
    s_sub_u32 s39, s36, s39
    s_cmp_ge_u32 s39, 5
    s_cselect_b32 s40, 1, 0
    s_sub_u32 s41, s39, 6
    s_cmp_eq_u32 s39, 5
    s_cselect_b32 s41, 4, s41
    s_cmp_eq_u32 s40, 1
    s_cselect_b32 s39, s41, s39
    s_mul_i32 s37, s38, 200
    s_mul_i32 s40, s40, 100
    s_add_u32 s37, s37, s40
    s_mul_i32 s40, s33, 50
    s_add_u32 s37, s37, s40
    s_add_u32 s37, s37, s39
    s_lshl_b32 s37, s37, 10
    s_add_u32 s45, s37, 24055808
    s_movk_i32 s49, 5120
    s_lshl_b32 s36, s35, 2
    s_add_u32 s36, s36, 2
    s_mul_i32 s38, s36, 6554
    s_lshr_b32 s38, s38, 16
    s_mul_i32 s39, s38, 10
    s_sub_u32 s39, s36, s39
    s_cmp_ge_u32 s39, 5
    s_cselect_b32 s40, 1, 0
    s_sub_u32 s41, s39, 6
    s_cmp_eq_u32 s39, 5
    s_cselect_b32 s41, 4, s41
    s_cmp_eq_u32 s40, 1
    s_cselect_b32 s39, s41, s39
    s_mul_i32 s37, s38, 200
    s_mul_i32 s40, s40, 100
    s_add_u32 s37, s37, s40
    s_mul_i32 s40, s33, 50
    s_add_u32 s37, s37, s40
    s_add_u32 s37, s37, s39
    s_lshl_b32 s37, s37, 10
    s_add_u32 s46, s37, 24055808
    s_movk_i32 s50, 5120
    s_lshl_b32 s36, s35, 2
    s_add_u32 s36, s36, 3
    s_mul_i32 s38, s36, 6554
    s_lshr_b32 s38, s38, 16
    s_mul_i32 s39, s38, 10
    s_sub_u32 s39, s36, s39
    s_cmp_ge_u32 s39, 5
    s_cselect_b32 s40, 1, 0
    s_sub_u32 s41, s39, 6
    s_cmp_eq_u32 s39, 5
    s_cselect_b32 s41, 4, s41
    s_cmp_eq_u32 s40, 1
    s_cselect_b32 s39, s41, s39
    s_mul_i32 s37, s38, 200
    s_mul_i32 s40, s40, 100
    s_add_u32 s37, s37, s40
    s_mul_i32 s40, s33, 50
    s_add_u32 s37, s37, s40
    s_add_u32 s37, s37, s39
    s_lshl_b32 s37, s37, 10
    s_add_u32 s47, s37, 24055808
    s_movk_i32 s51, 5120
    s_waitcnt vmcnt(36)
    ds_write_b128 v5, v[32:35] offset:0
    ds_write_b128 v5, v[36:39] offset:1152
    ds_write_b128 v5, v[40:43] offset:2304
    ds_write_b128 v5, v[44:47] offset:3456
    s_waitcnt lgkmcnt(0)
    ds_read_b64_tr_b16 v[200:201], v8 offset:0
    ds_read_b64_tr_b16 v[202:203], v8 offset:576
    ds_read_b64_tr_b16 v[204:205], v8 offset:32
    ds_read_b64_tr_b16 v[206:207], v8 offset:608
    ds_read_b64_tr_b16 v[208:209], v8 offset:64
    ds_read_b64_tr_b16 v[210:211], v8 offset:640
    ds_read_b64_tr_b16 v[212:213], v8 offset:96
    ds_read_b64_tr_b16 v[214:215], v8 offset:672
    s_waitcnt vmcnt(32)
    ds_write_b128 v5, v[48:51] offset:4608
    ds_write_b128 v5, v[52:55] offset:5760
    ds_write_b128 v5, v[56:59] offset:6912
    ds_write_b128 v5, v[60:63] offset:8064
    s_waitcnt lgkmcnt(4)
    buffer_store_dwordx4 v[200:203], v9, s[28:31], s44 offen sc1
    s_add_u32 s44, s44, s48
    buffer_store_dwordx4 v[204:207], v9, s[28:31], s45 offen sc1
    s_add_u32 s45, s45, s49
    buffer_store_dwordx4 v[208:211], v9, s[28:31], s46 offen sc1
    s_add_u32 s46, s46, s50
    buffer_store_dwordx4 v[212:215], v9, s[28:31], s47 offen sc1
    s_add_u32 s47, s47, s51
    s_waitcnt lgkmcnt(0)
    ds_read_b64_tr_b16 v[216:217], v8 offset:4608
    ds_read_b64_tr_b16 v[218:219], v8 offset:5184
    ds_read_b64_tr_b16 v[220:221], v8 offset:4640
    ds_read_b64_tr_b16 v[222:223], v8 offset:5216
    ds_read_b64_tr_b16 v[224:225], v8 offset:4672
    ds_read_b64_tr_b16 v[226:227], v8 offset:5248
    ds_read_b64_tr_b16 v[228:229], v8 offset:4704
    ds_read_b64_tr_b16 v[230:231], v8 offset:5280
    s_waitcnt vmcnt(32)
    ds_write_b128 v5, v[64:67] offset:0
    ds_write_b128 v5, v[68:71] offset:1152
    ds_write_b128 v5, v[72:75] offset:2304
    ds_write_b128 v5, v[76:79] offset:3456
    s_waitcnt lgkmcnt(4)
    buffer_store_dwordx4 v[216:219], v9, s[28:31], s44 offen sc1
    s_add_u32 s44, s44, s48
    buffer_store_dwordx4 v[220:223], v9, s[28:31], s45 offen sc1
    s_add_u32 s45, s45, s49
    buffer_store_dwordx4 v[224:227], v9, s[28:31], s46 offen sc1
    s_add_u32 s46, s46, s50
    buffer_store_dwordx4 v[228:231], v9, s[28:31], s47 offen sc1
    s_add_u32 s47, s47, s51
    s_waitcnt lgkmcnt(0)
    ds_read_b64_tr_b16 v[200:201], v8 offset:0
    ds_read_b64_tr_b16 v[202:203], v8 offset:576
    ds_read_b64_tr_b16 v[204:205], v8 offset:32
    ds_read_b64_tr_b16 v[206:207], v8 offset:608
    ds_read_b64_tr_b16 v[208:209], v8 offset:64
    ds_read_b64_tr_b16 v[210:211], v8 offset:640
    ds_read_b64_tr_b16 v[212:213], v8 offset:96
    ds_read_b64_tr_b16 v[214:215], v8 offset:672
    s_waitcnt vmcnt(32)
    ds_write_b128 v5, v[80:83] offset:4608
    ds_write_b128 v5, v[84:87] offset:5760
    ds_write_b128 v5, v[88:91] offset:6912
    ds_write_b128 v5, v[92:95] offset:8064
    s_waitcnt lgkmcnt(4)
    buffer_store_dwordx4 v[200:203], v9, s[28:31], s44 offen sc1
    s_add_u32 s44, s44, s48
    buffer_store_dwordx4 v[204:207], v9, s[28:31], s45 offen sc1
    s_add_u32 s45, s45, s49
    buffer_store_dwordx4 v[208:211], v9, s[28:31], s46 offen sc1
    s_add_u32 s46, s46, s50
    buffer_store_dwordx4 v[212:215], v9, s[28:31], s47 offen sc1
    s_add_u32 s47, s47, s51
    s_waitcnt lgkmcnt(0)
    ds_read_b64_tr_b16 v[216:217], v8 offset:4608
    ds_read_b64_tr_b16 v[218:219], v8 offset:5184
    ds_read_b64_tr_b16 v[220:221], v8 offset:4640
    ds_read_b64_tr_b16 v[222:223], v8 offset:5216
    ds_read_b64_tr_b16 v[224:225], v8 offset:4672
    ds_read_b64_tr_b16 v[226:227], v8 offset:5248
    ds_read_b64_tr_b16 v[228:229], v8 offset:4704
    ds_read_b64_tr_b16 v[230:231], v8 offset:5280
    s_waitcnt vmcnt(32)
    ds_write_b128 v5, v[96:99] offset:0
    ds_write_b128 v5, v[100:103] offset:1152
    ds_write_b128 v5, v[104:107] offset:2304
    ds_write_b128 v5, v[108:111] offset:3456
    s_waitcnt lgkmcnt(4)
    buffer_store_dwordx4 v[216:219], v9, s[28:31], s44 offen sc1
    s_add_u32 s44, s44, s48
    buffer_store_dwordx4 v[220:223], v9, s[28:31], s45 offen sc1
    s_add_u32 s45, s45, s49
    buffer_store_dwordx4 v[224:227], v9, s[28:31], s46 offen sc1
    s_add_u32 s46, s46, s50
    buffer_store_dwordx4 v[228:231], v9, s[28:31], s47 offen sc1
    s_add_u32 s47, s47, s51
    s_waitcnt lgkmcnt(0)
    ds_read_b64_tr_b16 v[200:201], v8 offset:0
    ds_read_b64_tr_b16 v[202:203], v8 offset:576
    ds_read_b64_tr_b16 v[204:205], v8 offset:32
    ds_read_b64_tr_b16 v[206:207], v8 offset:608
    ds_read_b64_tr_b16 v[208:209], v8 offset:64
    ds_read_b64_tr_b16 v[210:211], v8 offset:640
    ds_read_b64_tr_b16 v[212:213], v8 offset:96
    ds_read_b64_tr_b16 v[214:215], v8 offset:672
    s_waitcnt vmcnt(32)
    ds_write_b128 v5, v[112:115] offset:4608
    ds_write_b128 v5, v[116:119] offset:5760
    ds_write_b128 v5, v[120:123] offset:6912
    ds_write_b128 v5, v[124:127] offset:8064
    s_waitcnt lgkmcnt(4)
    buffer_store_dwordx4 v[200:203], v9, s[28:31], s44 offen sc1
    s_add_u32 s44, s44, s48
    buffer_store_dwordx4 v[204:207], v9, s[28:31], s45 offen sc1
    s_add_u32 s45, s45, s49
    buffer_store_dwordx4 v[208:211], v9, s[28:31], s46 offen sc1
    s_add_u32 s46, s46, s50
    buffer_store_dwordx4 v[212:215], v9, s[28:31], s47 offen sc1
    s_add_u32 s47, s47, s51
    s_waitcnt lgkmcnt(0)
    ds_read_b64_tr_b16 v[216:217], v8 offset:4608
    ds_read_b64_tr_b16 v[218:219], v8 offset:5184
    ds_read_b64_tr_b16 v[220:221], v8 offset:4640
    ds_read_b64_tr_b16 v[222:223], v8 offset:5216
    ds_read_b64_tr_b16 v[224:225], v8 offset:4672
    ds_read_b64_tr_b16 v[226:227], v8 offset:5248
    ds_read_b64_tr_b16 v[228:229], v8 offset:4704
    ds_read_b64_tr_b16 v[230:231], v8 offset:5280
    s_waitcnt vmcnt(32)
    ds_write_b128 v5, v[128:131] offset:0
    ds_write_b128 v5, v[132:135] offset:1152
    ds_write_b128 v5, v[136:139] offset:2304
    ds_write_b128 v5, v[140:143] offset:3456
    s_waitcnt lgkmcnt(4)
    buffer_store_dwordx4 v[216:219], v9, s[28:31], s44 offen sc1
    s_add_u32 s44, s44, s48
    buffer_store_dwordx4 v[220:223], v9, s[28:31], s45 offen sc1
    s_add_u32 s45, s45, s49
    buffer_store_dwordx4 v[224:227], v9, s[28:31], s46 offen sc1
    s_add_u32 s46, s46, s50
    buffer_store_dwordx4 v[228:231], v9, s[28:31], s47 offen sc1
    s_add_u32 s47, s47, s51
    s_waitcnt lgkmcnt(0)
    ds_read_b64_tr_b16 v[200:201], v8 offset:0
    ds_read_b64_tr_b16 v[202:203], v8 offset:576
    ds_read_b64_tr_b16 v[204:205], v8 offset:32
    ds_read_b64_tr_b16 v[206:207], v8 offset:608
    ds_read_b64_tr_b16 v[208:209], v8 offset:64
    ds_read_b64_tr_b16 v[210:211], v8 offset:640
    ds_read_b64_tr_b16 v[212:213], v8 offset:96
    ds_read_b64_tr_b16 v[214:215], v8 offset:672
    s_waitcnt vmcnt(32)
    ds_write_b128 v5, v[144:147] offset:4608
    ds_write_b128 v5, v[148:151] offset:5760
    ds_write_b128 v5, v[152:155] offset:6912
    ds_write_b128 v5, v[156:159] offset:8064
    s_waitcnt lgkmcnt(4)
    buffer_store_dwordx4 v[200:203], v9, s[28:31], s44 offen sc1
    s_add_u32 s44, s44, s48
    buffer_store_dwordx4 v[204:207], v9, s[28:31], s45 offen sc1
    s_add_u32 s45, s45, s49
    buffer_store_dwordx4 v[208:211], v9, s[28:31], s46 offen sc1
    s_add_u32 s46, s46, s50
    buffer_store_dwordx4 v[212:215], v9, s[28:31], s47 offen sc1
    s_add_u32 s47, s47, s51
    s_waitcnt lgkmcnt(0)
    ds_read_b64_tr_b16 v[216:217], v8 offset:4608
    ds_read_b64_tr_b16 v[218:219], v8 offset:5184
    ds_read_b64_tr_b16 v[220:221], v8 offset:4640
    ds_read_b64_tr_b16 v[222:223], v8 offset:5216
    ds_read_b64_tr_b16 v[224:225], v8 offset:4672
    ds_read_b64_tr_b16 v[226:227], v8 offset:5248
    ds_read_b64_tr_b16 v[228:229], v8 offset:4704
    ds_read_b64_tr_b16 v[230:231], v8 offset:5280
    s_waitcnt vmcnt(32)
    ds_write_b128 v5, v[160:163] offset:0
    ds_write_b128 v5, v[164:167] offset:1152
    ds_write_b128 v5, v[168:171] offset:2304
    ds_write_b128 v5, v[172:175] offset:3456
    s_waitcnt lgkmcnt(4)
    buffer_store_dwordx4 v[216:219], v9, s[28:31], s44 offen sc1
    s_add_u32 s44, s44, s48
    buffer_store_dwordx4 v[220:223], v9, s[28:31], s45 offen sc1
    s_add_u32 s45, s45, s49
    buffer_store_dwordx4 v[224:227], v9, s[28:31], s46 offen sc1
    s_add_u32 s46, s46, s50
    buffer_store_dwordx4 v[228:231], v9, s[28:31], s47 offen sc1
    s_add_u32 s47, s47, s51
    s_waitcnt lgkmcnt(0)
    ds_read_b64_tr_b16 v[200:201], v8 offset:0
    ds_read_b64_tr_b16 v[202:203], v8 offset:576
    ds_read_b64_tr_b16 v[204:205], v8 offset:32
    ds_read_b64_tr_b16 v[206:207], v8 offset:608
    ds_read_b64_tr_b16 v[208:209], v8 offset:64
    ds_read_b64_tr_b16 v[210:211], v8 offset:640
    ds_read_b64_tr_b16 v[212:213], v8 offset:96
    ds_read_b64_tr_b16 v[214:215], v8 offset:672
    s_waitcnt vmcnt(32)
    ds_write_b128 v5, v[176:179] offset:4608
    ds_write_b128 v5, v[180:183] offset:5760
    ds_write_b128 v5, v[184:187] offset:6912
    ds_write_b128 v5, v[188:191] offset:8064
    s_waitcnt lgkmcnt(4)
    buffer_store_dwordx4 v[200:203], v9, s[28:31], s44 offen sc1
    s_add_u32 s44, s44, s48
    buffer_store_dwordx4 v[204:207], v9, s[28:31], s45 offen sc1
    s_add_u32 s45, s45, s49
    buffer_store_dwordx4 v[208:211], v9, s[28:31], s46 offen sc1
    s_add_u32 s46, s46, s50
    buffer_store_dwordx4 v[212:215], v9, s[28:31], s47 offen sc1
    s_add_u32 s47, s47, s51
    s_waitcnt lgkmcnt(0)
    ds_read_b64_tr_b16 v[216:217], v8 offset:4608
    ds_read_b64_tr_b16 v[218:219], v8 offset:5184
    ds_read_b64_tr_b16 v[220:221], v8 offset:4640
    ds_read_b64_tr_b16 v[222:223], v8 offset:5216
    ds_read_b64_tr_b16 v[224:225], v8 offset:4672
    ds_read_b64_tr_b16 v[226:227], v8 offset:5248
    ds_read_b64_tr_b16 v[228:229], v8 offset:4704
    ds_read_b64_tr_b16 v[230:231], v8 offset:5280
    s_waitcnt lgkmcnt(0)
    buffer_store_dwordx4 v[216:219], v9, s[28:31], s44 offen sc1
    s_add_u32 s44, s44, s48
    buffer_store_dwordx4 v[220:223], v9, s[28:31], s45 offen sc1
    s_add_u32 s45, s45, s49
    buffer_store_dwordx4 v[224:227], v9, s[28:31], s46 offen sc1
    s_add_u32 s46, s46, s50
    buffer_store_dwordx4 v[228:231], v9, s[28:31], s47 offen sc1
    s_add_u32 s47, s47, s51
    s_endpgm
prep_kernel_pk27:
    s_mov_b32 s24, s16
    s_mov_b32 s25, s17
    s_mov_b32 s26, 2211840
    s_mov_b32 s27, 0x00020000
    s_sub_u32 s32, s21, 40
    s_mul_i32 s33, s32, 2428
    s_lshr_b32 s33, s33, 16
    s_mul_i32 s35, s33, 27
    s_sub_u32 s35, s32, s35
    v_mul_u32_u24 v10, 3456, v3
    v_lshl_add_u32 v10, v4, 4, v10
    s_mul_i32 s36, s33, 1105920
    s_lshl_b32 s37, s35, 7
    s_add_u32 s36, s36, s37
    buffer_load_dwordx4 v[32:35], v10, s[24:27], s36 offen nt
    s_add_u32 s36, s36, 27648
    buffer_load_dwordx4 v[36:39], v10, s[24:27], s36 offen nt
    s_add_u32 s36, s36, 27648
    buffer_load_dwordx4 v[40:43], v10, s[24:27], s36 offen nt
    s_add_u32 s36, s36, 27648
    buffer_load_dwordx4 v[44:47], v10, s[24:27], s36 offen nt
    s_add_u32 s36, s36, 27648
    buffer_load_dwordx4 v[48:51], v10, s[24:27], s36 offen nt
    s_add_u32 s36, s36, 27648
    buffer_load_dwordx4 v[52:55], v10, s[24:27], s36 offen nt
    s_add_u32 s36, s36, 27648
    buffer_load_dwordx4 v[56:59], v10, s[24:27], s36 offen nt
    s_add_u32 s36, s36, 27648
    buffer_load_dwordx4 v[60:63], v10, s[24:27], s36 offen nt
    s_add_u32 s36, s36, 27648
    buffer_load_dwordx4 v[64:67], v10, s[24:27], s36 offen nt
    s_add_u32 s36, s36, 27648
    buffer_load_dwordx4 v[68:71], v10, s[24:27], s36 offen nt
    s_add_u32 s36, s36, 27648
    buffer_load_dwordx4 v[72:75], v10, s[24:27], s36 offen nt
    s_add_u32 s36, s36, 27648
    buffer_load_dwordx4 v[76:79], v10, s[24:27], s36 offen nt
    s_add_u32 s36, s36, 27648
    buffer_load_dwordx4 v[80:83], v10, s[24:27], s36 offen nt
    s_add_u32 s36, s36, 27648
    buffer_load_dwordx4 v[84:87], v10, s[24:27], s36 offen nt
    s_add_u32 s36, s36, 27648
    buffer_load_dwordx4 v[88:91], v10, s[24:27], s36 offen nt
    s_add_u32 s36, s36, 27648
    buffer_load_dwordx4 v[92:95], v10, s[24:27], s36 offen nt
    s_add_u32 s36, s36, 27648
    buffer_load_dwordx4 v[96:99], v10, s[24:27], s36 offen nt
    s_add_u32 s36, s36, 27648
    buffer_load_dwordx4 v[100:103], v10, s[24:27], s36 offen nt
    s_add_u32 s36, s36, 27648
    buffer_load_dwordx4 v[104:107], v10, s[24:27], s36 offen nt
    s_add_u32 s36, s36, 27648
    buffer_load_dwordx4 v[108:111], v10, s[24:27], s36 offen nt
    s_add_u32 s36, s36, 27648
    buffer_load_dwordx4 v[112:115], v10, s[24:27], s36 offen nt
    s_add_u32 s36, s36, 27648
    buffer_load_dwordx4 v[116:119], v10, s[24:27], s36 offen nt
    s_add_u32 s36, s36, 27648
    buffer_load_dwordx4 v[120:123], v10, s[24:27], s36 offen nt
    s_add_u32 s36, s36, 27648
    buffer_load_dwordx4 v[124:127], v10, s[24:27], s36 offen nt
    s_add_u32 s36, s36, 27648
    buffer_load_dwordx4 v[128:131], v10, s[24:27], s36 offen nt
    s_add_u32 s36, s36, 27648
    buffer_load_dwordx4 v[132:135], v10, s[24:27], s36 offen nt
    s_add_u32 s36, s36, 27648
    buffer_load_dwordx4 v[136:139], v10, s[24:27], s36 offen nt
    s_add_u32 s36, s36, 27648
    buffer_load_dwordx4 v[140:143], v10, s[24:27], s36 offen nt
    s_add_u32 s36, s36, 27648
    buffer_load_dwordx4 v[144:147], v10, s[24:27], s36 offen nt
    s_add_u32 s36, s36, 27648
    buffer_load_dwordx4 v[148:151], v10, s[24:27], s36 offen nt
    s_add_u32 s36, s36, 27648
    buffer_load_dwordx4 v[152:155], v10, s[24:27], s36 offen nt
    s_add_u32 s36, s36, 27648
    buffer_load_dwordx4 v[156:159], v10, s[24:27], s36 offen nt
    s_add_u32 s36, s36, 27648
    buffer_load_dwordx4 v[160:163], v10, s[24:27], s36 offen nt
    s_add_u32 s36, s36, 27648
    buffer_load_dwordx4 v[164:167], v10, s[24:27], s36 offen nt
    s_add_u32 s36, s36, 27648
    buffer_load_dwordx4 v[168:171], v10, s[24:27], s36 offen nt
    s_add_u32 s36, s36, 27648
    buffer_load_dwordx4 v[172:175], v10, s[24:27], s36 offen nt
    s_add_u32 s36, s36, 27648
    buffer_load_dwordx4 v[176:179], v10, s[24:27], s36 offen nt
    s_add_u32 s36, s36, 27648
    buffer_load_dwordx4 v[180:183], v10, s[24:27], s36 offen nt
    s_add_u32 s36, s36, 27648
    buffer_load_dwordx4 v[184:187], v10, s[24:27], s36 offen nt
    s_add_u32 s36, s36, 27648
    buffer_load_dwordx4 v[188:191], v10, s[24:27], s36 offen nt
    s_lshl_b32 s36, s35, 2
    s_add_u32 s36, s36, 0
    s_mul_i32 s38, s36, 9363
    s_lshr_b32 s38, s38, 16
    s_mul_i32 s39, s38, 7
    s_sub_u32 s39, s36, s39
    s_sub_u32 s41, s39, 1
    s_cmp_eq_u32 s39, 0
    s_cselect_b32 s41, 6, s41
    s_and_b32 s40, s38, 1
    s_cmp_eq_u32 s40, 1
    s_cselect_b32 s39, s41, s39
    s_mov_b32 s41, 4
    s_mov_b32 s40, s39
    s_cmp_ge_u32 s39, 4
    s_cselect_b32 s41, 2, s41
    s_add_u32 s42, s39, 76
    s_cmp_ge_u32 s39, 4
    s_cselect_b32 s40, s42, s40
    s_cmp_eq_u32 s39, 6
    s_cselect_b32 s41, 1, s41
    s_cselect_b32 s40, 120, s40
    s_mul_i32 s42, s33, 10
    s_mul_i32 s42, s42, s41
    s_add_u32 s40, s40, s42
    s_mul_i32 s37, s38, 140
    s_add_u32 s37, s37, s40
    s_lshl_b32 s37, s37, 10
    s_add_u32 s44, s37, 24875008
    s_lshl_b32 s48, s41, 10
    s_lshl_b32 s36, s35, 2
    s_add_u32 s36, s36, 1
    s_mul_i32 s38, s36, 9363
    s_lshr_b32 s38, s38, 16
    s_mul_i32 s39, s38, 7
    s_sub_u32 s39, s36, s39
    s_sub_u32 s41, s39, 1
    s_cmp_eq_u32 s39, 0
    s_cselect_b32 s41, 6, s41
    s_and_b32 s40, s38, 1
    s_cmp_eq_u32 s40, 1
    s_cselect_b32 s39, s41, s39
    s_mov_b32 s41, 4
    s_mov_b32 s40, s39
    s_cmp_ge_u32 s39, 4
    s_cselect_b32 s41, 2, s41
    s_add_u32 s42, s39, 76
    s_cmp_ge_u32 s39, 4
    s_cselect_b32 s40, s42, s40
    s_cmp_eq_u32 s39, 6
    s_cselect_b32 s41, 1, s41
    s_cselect_b32 s40, 120, s40
    s_mul_i32 s42, s33, 10
    s_mul_i32 s42, s42, s41
    s_add_u32 s40, s40, s42
    s_mul_i32 s37, s38, 140
    s_add_u32 s37, s37, s40
    s_lshl_b32 s37, s37, 10
    s_add_u32 s45, s37, 24875008
    s_lshl_b32 s49, s41, 10
    s_lshl_b32 s36, s35, 2
    s_add_u32 s36, s36, 2
    s_mul_i32 s38, s36, 9363
    s_lshr_b32 s38, s38, 16
    s_mul_i32 s39, s38, 7
    s_sub_u32 s39, s36, s39
    s_sub_u32 s41, s39, 1
    s_cmp_eq_u32 s39, 0
    s_cselect_b32 s41, 6, s41
    s_and_b32 s40, s38, 1
    s_cmp_eq_u32 s40, 1
    s_cselect_b32 s39, s41, s39
    s_mov_b32 s41, 4
    s_mov_b32 s40, s39
    s_cmp_ge_u32 s39, 4
    s_cselect_b32 s41, 2, s41
    s_add_u32 s42, s39, 76
    s_cmp_ge_u32 s39, 4
    s_cselect_b32 s40, s42, s40
    s_cmp_eq_u32 s39, 6
    s_cselect_b32 s41, 1, s41
    s_cselect_b32 s40, 120, s40
    s_mul_i32 s42, s33, 10
    s_mul_i32 s42, s42, s41
    s_add_u32 s40, s40, s42
    s_mul_i32 s37, s38, 140
    s_add_u32 s37, s37, s40
    s_lshl_b32 s37, s37, 10
    s_add_u32 s46, s37, 24875008
    s_lshl_b32 s50, s41, 10
    s_lshl_b32 s36, s35, 2
    s_add_u32 s36, s36, 3
    s_mul_i32 s38, s36, 9363
    s_lshr_b32 s38, s38, 16
    s_mul_i32 s39, s38, 7
    s_sub_u32 s39, s36, s39
    s_sub_u32 s41, s39, 1
    s_cmp_eq_u32 s39, 0
    s_cselect_b32 s41, 6, s41
    s_and_b32 s40, s38, 1
    s_cmp_eq_u32 s40, 1
    s_cselect_b32 s39, s41, s39
    s_mov_b32 s41, 4
    s_mov_b32 s40, s39
    s_cmp_ge_u32 s39, 4
    s_cselect_b32 s41, 2, s41
    s_add_u32 s42, s39, 76
    s_cmp_ge_u32 s39, 4
    s_cselect_b32 s40, s42, s40
    s_cmp_eq_u32 s39, 6
    s_cselect_b32 s41, 1, s41
    s_cselect_b32 s40, 120, s40
    s_mul_i32 s42, s33, 10
    s_mul_i32 s42, s42, s41
    s_add_u32 s40, s40, s42
    s_mul_i32 s37, s38, 140
    s_add_u32 s37, s37, s40
    s_lshl_b32 s37, s37, 10
    s_add_u32 s47, s37, 24875008
    s_lshl_b32 s51, s41, 10
    v_mov_b32 v12, 0
    v_mov_b32 v13, 0
    v_mov_b32 v14, 0
    v_mov_b32 v15, 0
    v_mov_b32 v16, 0x3f803f80
    s_waitcnt vmcnt(36)
    ds_write_b128 v5, v[32:35] offset:0
    ds_write_b128 v5, v[36:39] offset:1152
    ds_write_b128 v5, v[40:43] offset:2304
    ds_write_b128 v5, v[44:47] offset:3456
    s_waitcnt lgkmcnt(0)
    ds_read_b64_tr_b16 v[200:201], v8 offset:0
    ds_read_b64_tr_b16 v[202:203], v8 offset:576
    ds_read_b64_tr_b16 v[204:205], v8 offset:32
    ds_read_b64_tr_b16 v[206:207], v8 offset:608
    ds_read_b64_tr_b16 v[208:209], v8 offset:64
    ds_read_b64_tr_b16 v[210:211], v8 offset:640
    ds_read_b64_tr_b16 v[212:213], v8 offset:96
    ds_read_b64_tr_b16 v[214:215], v8 offset:672
    s_waitcnt vmcnt(32)
    ds_write_b128 v5, v[48:51] offset:4608
    ds_write_b128 v5, v[52:55] offset:5760
    ds_write_b128 v5, v[56:59] offset:6912
    ds_write_b128 v5, v[60:63] offset:8064
    s_waitcnt lgkmcnt(4)
    buffer_store_dwordx4 v[200:203], v9, s[28:31], s44 offen sc1
    s_add_u32 s44, s44, s48
    v_dot2_f32_bf16 v12, v200, v16, v12
    v_dot2_f32_bf16 v12, v201, v16, v12
    v_dot2_f32_bf16 v12, v202, v16, v12
    v_dot2_f32_bf16 v12, v203, v16, v12
    buffer_store_dwordx4 v[204:207], v9, s[28:31], s45 offen sc1
    s_add_u32 s45, s45, s49
    v_dot2_f32_bf16 v13, v204, v16, v13
    v_dot2_f32_bf16 v13, v205, v16, v13
    v_dot2_f32_bf16 v13, v206, v16, v13
    v_dot2_f32_bf16 v13, v207, v16, v13
    buffer_store_dwordx4 v[208:211], v9, s[28:31], s46 offen sc1
    s_add_u32 s46, s46, s50
    v_dot2_f32_bf16 v14, v208, v16, v14
    v_dot2_f32_bf16 v14, v209, v16, v14
    v_dot2_f32_bf16 v14, v210, v16, v14
    v_dot2_f32_bf16 v14, v211, v16, v14
    buffer_store_dwordx4 v[212:215], v9, s[28:31], s47 offen sc1
    s_add_u32 s47, s47, s51
    v_dot2_f32_bf16 v15, v212, v16, v15
    v_dot2_f32_bf16 v15, v213, v16, v15
    v_dot2_f32_bf16 v15, v214, v16, v15
    v_dot2_f32_bf16 v15, v215, v16, v15
    s_waitcnt lgkmcnt(0)
    ds_read_b64_tr_b16 v[216:217], v8 offset:4608
    ds_read_b64_tr_b16 v[218:219], v8 offset:5184
    ds_read_b64_tr_b16 v[220:221], v8 offset:4640
    ds_read_b64_tr_b16 v[222:223], v8 offset:5216
    ds_read_b64_tr_b16 v[224:225], v8 offset:4672
    ds_read_b64_tr_b16 v[226:227], v8 offset:5248
    ds_read_b64_tr_b16 v[228:229], v8 offset:4704
    ds_read_b64_tr_b16 v[230:231], v8 offset:5280
    s_waitcnt vmcnt(32)
    ds_write_b128 v5, v[64:67] offset:0
    ds_write_b128 v5, v[68:71] offset:1152
    ds_write_b128 v5, v[72:75] offset:2304
    ds_write_b128 v5, v[76:79] offset:3456
    s_waitcnt lgkmcnt(4)
    buffer_store_dwordx4 v[216:219], v9, s[28:31], s44 offen sc1
    s_add_u32 s44, s44, s48
    v_dot2_f32_bf16 v12, v216, v16, v12
    v_dot2_f32_bf16 v12, v217, v16, v12
    v_dot2_f32_bf16 v12, v218, v16, v12
    v_dot2_f32_bf16 v12, v219, v16, v12
    buffer_store_dwordx4 v[220:223], v9, s[28:31], s45 offen sc1
    s_add_u32 s45, s45, s49
    v_dot2_f32_bf16 v13, v220, v16, v13
    v_dot2_f32_bf16 v13, v221, v16, v13
    v_dot2_f32_bf16 v13, v222, v16, v13
    v_dot2_f32_bf16 v13, v223, v16, v13
    buffer_store_dwordx4 v[224:227], v9, s[28:31], s46 offen sc1
    s_add_u32 s46, s46, s50
    v_dot2_f32_bf16 v14, v224, v16, v14
    v_dot2_f32_bf16 v14, v225, v16, v14
    v_dot2_f32_bf16 v14, v226, v16, v14
    v_dot2_f32_bf16 v14, v227, v16, v14
    buffer_store_dwordx4 v[228:231], v9, s[28:31], s47 offen sc1
    s_add_u32 s47, s47, s51
    v_dot2_f32_bf16 v15, v228, v16, v15
    v_dot2_f32_bf16 v15, v229, v16, v15
    v_dot2_f32_bf16 v15, v230, v16, v15
    v_dot2_f32_bf16 v15, v231, v16, v15
    s_waitcnt lgkmcnt(0)
    ds_read_b64_tr_b16 v[200:201], v8 offset:0
    ds_read_b64_tr_b16 v[202:203], v8 offset:576
    ds_read_b64_tr_b16 v[204:205], v8 offset:32
    ds_read_b64_tr_b16 v[206:207], v8 offset:608
    ds_read_b64_tr_b16 v[208:209], v8 offset:64
    ds_read_b64_tr_b16 v[210:211], v8 offset:640
    ds_read_b64_tr_b16 v[212:213], v8 offset:96
    ds_read_b64_tr_b16 v[214:215], v8 offset:672
    s_waitcnt vmcnt(32)
    ds_write_b128 v5, v[80:83] offset:4608
    ds_write_b128 v5, v[84:87] offset:5760
    ds_write_b128 v5, v[88:91] offset:6912
    ds_write_b128 v5, v[92:95] offset:8064
    s_waitcnt lgkmcnt(4)
    buffer_store_dwordx4 v[200:203], v9, s[28:31], s44 offen sc1
    s_add_u32 s44, s44, s48
    v_dot2_f32_bf16 v12, v200, v16, v12
    v_dot2_f32_bf16 v12, v201, v16, v12
    v_dot2_f32_bf16 v12, v202, v16, v12
    v_dot2_f32_bf16 v12, v203, v16, v12
    buffer_store_dwordx4 v[204:207], v9, s[28:31], s45 offen sc1
    s_add_u32 s45, s45, s49
    v_dot2_f32_bf16 v13, v204, v16, v13
    v_dot2_f32_bf16 v13, v205, v16, v13
    v_dot2_f32_bf16 v13, v206, v16, v13
    v_dot2_f32_bf16 v13, v207, v16, v13
    buffer_store_dwordx4 v[208:211], v9, s[28:31], s46 offen sc1
    s_add_u32 s46, s46, s50
    v_dot2_f32_bf16 v14, v208, v16, v14
    v_dot2_f32_bf16 v14, v209, v16, v14
    v_dot2_f32_bf16 v14, v210, v16, v14
    v_dot2_f32_bf16 v14, v211, v16, v14
    buffer_store_dwordx4 v[212:215], v9, s[28:31], s47 offen sc1
    s_add_u32 s47, s47, s51
    v_dot2_f32_bf16 v15, v212, v16, v15
    v_dot2_f32_bf16 v15, v213, v16, v15
    v_dot2_f32_bf16 v15, v214, v16, v15
    v_dot2_f32_bf16 v15, v215, v16, v15
    s_waitcnt lgkmcnt(0)
    ds_read_b64_tr_b16 v[216:217], v8 offset:4608
    ds_read_b64_tr_b16 v[218:219], v8 offset:5184
    ds_read_b64_tr_b16 v[220:221], v8 offset:4640
    ds_read_b64_tr_b16 v[222:223], v8 offset:5216
    ds_read_b64_tr_b16 v[224:225], v8 offset:4672
    ds_read_b64_tr_b16 v[226:227], v8 offset:5248
    ds_read_b64_tr_b16 v[228:229], v8 offset:4704
    ds_read_b64_tr_b16 v[230:231], v8 offset:5280
    s_waitcnt vmcnt(32)
    ds_write_b128 v5, v[96:99] offset:0
    ds_write_b128 v5, v[100:103] offset:1152
    ds_write_b128 v5, v[104:107] offset:2304
    ds_write_b128 v5, v[108:111] offset:3456
    s_waitcnt lgkmcnt(4)
    buffer_store_dwordx4 v[216:219], v9, s[28:31], s44 offen sc1
    s_add_u32 s44, s44, s48
    v_dot2_f32_bf16 v12, v216, v16, v12
    v_dot2_f32_bf16 v12, v217, v16, v12
    v_dot2_f32_bf16 v12, v218, v16, v12
    v_dot2_f32_bf16 v12, v219, v16, v12
    buffer_store_dwordx4 v[220:223], v9, s[28:31], s45 offen sc1
    s_add_u32 s45, s45, s49
    v_dot2_f32_bf16 v13, v220, v16, v13
    v_dot2_f32_bf16 v13, v221, v16, v13
    v_dot2_f32_bf16 v13, v222, v16, v13
    v_dot2_f32_bf16 v13, v223, v16, v13
    buffer_store_dwordx4 v[224:227], v9, s[28:31], s46 offen sc1
    s_add_u32 s46, s46, s50
    v_dot2_f32_bf16 v14, v224, v16, v14
    v_dot2_f32_bf16 v14, v225, v16, v14
    v_dot2_f32_bf16 v14, v226, v16, v14
    v_dot2_f32_bf16 v14, v227, v16, v14
    buffer_store_dwordx4 v[228:231], v9, s[28:31], s47 offen sc1
    s_add_u32 s47, s47, s51
    v_dot2_f32_bf16 v15, v228, v16, v15
    v_dot2_f32_bf16 v15, v229, v16, v15
    v_dot2_f32_bf16 v15, v230, v16, v15
    v_dot2_f32_bf16 v15, v231, v16, v15
    s_waitcnt lgkmcnt(0)
    ds_read_b64_tr_b16 v[200:201], v8 offset:0
    ds_read_b64_tr_b16 v[202:203], v8 offset:576
    ds_read_b64_tr_b16 v[204:205], v8 offset:32
    ds_read_b64_tr_b16 v[206:207], v8 offset:608
    ds_read_b64_tr_b16 v[208:209], v8 offset:64
    ds_read_b64_tr_b16 v[210:211], v8 offset:640
    ds_read_b64_tr_b16 v[212:213], v8 offset:96
    ds_read_b64_tr_b16 v[214:215], v8 offset:672
    s_waitcnt vmcnt(32)
    ds_write_b128 v5, v[112:115] offset:4608
    ds_write_b128 v5, v[116:119] offset:5760
    ds_write_b128 v5, v[120:123] offset:6912
    ds_write_b128 v5, v[124:127] offset:8064
    s_waitcnt lgkmcnt(4)
    buffer_store_dwordx4 v[200:203], v9, s[28:31], s44 offen sc1
    s_add_u32 s44, s44, s48
    v_dot2_f32_bf16 v12, v200, v16, v12
    v_dot2_f32_bf16 v12, v201, v16, v12
    v_dot2_f32_bf16 v12, v202, v16, v12
    v_dot2_f32_bf16 v12, v203, v16, v12
    buffer_store_dwordx4 v[204:207], v9, s[28:31], s45 offen sc1
    s_add_u32 s45, s45, s49
    v_dot2_f32_bf16 v13, v204, v16, v13
    v_dot2_f32_bf16 v13, v205, v16, v13
    v_dot2_f32_bf16 v13, v206, v16, v13
    v_dot2_f32_bf16 v13, v207, v16, v13
    buffer_store_dwordx4 v[208:211], v9, s[28:31], s46 offen sc1
    s_add_u32 s46, s46, s50
    v_dot2_f32_bf16 v14, v208, v16, v14
    v_dot2_f32_bf16 v14, v209, v16, v14
    v_dot2_f32_bf16 v14, v210, v16, v14
    v_dot2_f32_bf16 v14, v211, v16, v14
    buffer_store_dwordx4 v[212:215], v9, s[28:31], s47 offen sc1
    s_add_u32 s47, s47, s51
    v_dot2_f32_bf16 v15, v212, v16, v15
    v_dot2_f32_bf16 v15, v213, v16, v15
    v_dot2_f32_bf16 v15, v214, v16, v15
    v_dot2_f32_bf16 v15, v215, v16, v15
    s_waitcnt lgkmcnt(0)
    ds_read_b64_tr_b16 v[216:217], v8 offset:4608
    ds_read_b64_tr_b16 v[218:219], v8 offset:5184
    ds_read_b64_tr_b16 v[220:221], v8 offset:4640
    ds_read_b64_tr_b16 v[222:223], v8 offset:5216
    ds_read_b64_tr_b16 v[224:225], v8 offset:4672
    ds_read_b64_tr_b16 v[226:227], v8 offset:5248
    ds_read_b64_tr_b16 v[228:229], v8 offset:4704
    ds_read_b64_tr_b16 v[230:231], v8 offset:5280
    s_waitcnt vmcnt(32)
    ds_write_b128 v5, v[128:131] offset:0
    ds_write_b128 v5, v[132:135] offset:1152
    ds_write_b128 v5, v[136:139] offset:2304
    ds_write_b128 v5, v[140:143] offset:3456
    s_waitcnt lgkmcnt(4)
    buffer_store_dwordx4 v[216:219], v9, s[28:31], s44 offen sc1
    s_add_u32 s44, s44, s48
    v_dot2_f32_bf16 v12, v216, v16, v12
    v_dot2_f32_bf16 v12, v217, v16, v12
    v_dot2_f32_bf16 v12, v218, v16, v12
    v_dot2_f32_bf16 v12, v219, v16, v12
    buffer_store_dwordx4 v[220:223], v9, s[28:31], s45 offen sc1
    s_add_u32 s45, s45, s49
    v_dot2_f32_bf16 v13, v220, v16, v13
    v_dot2_f32_bf16 v13, v221, v16, v13
    v_dot2_f32_bf16 v13, v222, v16, v13
    v_dot2_f32_bf16 v13, v223, v16, v13
    buffer_store_dwordx4 v[224:227], v9, s[28:31], s46 offen sc1
    s_add_u32 s46, s46, s50
    v_dot2_f32_bf16 v14, v224, v16, v14
    v_dot2_f32_bf16 v14, v225, v16, v14
    v_dot2_f32_bf16 v14, v226, v16, v14
    v_dot2_f32_bf16 v14, v227, v16, v14
    buffer_store_dwordx4 v[228:231], v9, s[28:31], s47 offen sc1
    s_add_u32 s47, s47, s51
    v_dot2_f32_bf16 v15, v228, v16, v15
    v_dot2_f32_bf16 v15, v229, v16, v15
    v_dot2_f32_bf16 v15, v230, v16, v15
    v_dot2_f32_bf16 v15, v231, v16, v15
    s_waitcnt lgkmcnt(0)
    ds_read_b64_tr_b16 v[200:201], v8 offset:0
    ds_read_b64_tr_b16 v[202:203], v8 offset:576
    ds_read_b64_tr_b16 v[204:205], v8 offset:32
    ds_read_b64_tr_b16 v[206:207], v8 offset:608
    ds_read_b64_tr_b16 v[208:209], v8 offset:64
    ds_read_b64_tr_b16 v[210:211], v8 offset:640
    ds_read_b64_tr_b16 v[212:213], v8 offset:96
    ds_read_b64_tr_b16 v[214:215], v8 offset:672
    s_waitcnt vmcnt(32)
    ds_write_b128 v5, v[144:147] offset:4608
    ds_write_b128 v5, v[148:151] offset:5760
    ds_write_b128 v5, v[152:155] offset:6912
    ds_write_b128 v5, v[156:159] offset:8064
    s_waitcnt lgkmcnt(4)
    buffer_store_dwordx4 v[200:203], v9, s[28:31], s44 offen sc1
    s_add_u32 s44, s44, s48
    v_dot2_f32_bf16 v12, v200, v16, v12
    v_dot2_f32_bf16 v12, v201, v16, v12
    v_dot2_f32_bf16 v12, v202, v16, v12
    v_dot2_f32_bf16 v12, v203, v16, v12
    buffer_store_dwordx4 v[204:207], v9, s[28:31], s45 offen sc1
    s_add_u32 s45, s45, s49
    v_dot2_f32_bf16 v13, v204, v16, v13
    v_dot2_f32_bf16 v13, v205, v16, v13
    v_dot2_f32_bf16 v13, v206, v16, v13
    v_dot2_f32_bf16 v13, v207, v16, v13
    buffer_store_dwordx4 v[208:211], v9, s[28:31], s46 offen sc1
    s_add_u32 s46, s46, s50
    v_dot2_f32_bf16 v14, v208, v16, v14
    v_dot2_f32_bf16 v14, v209, v16, v14
    v_dot2_f32_bf16 v14, v210, v16, v14
    v_dot2_f32_bf16 v14, v211, v16, v14
    buffer_store_dwordx4 v[212:215], v9, s[28:31], s47 offen sc1
    s_add_u32 s47, s47, s51
    v_dot2_f32_bf16 v15, v212, v16, v15
    v_dot2_f32_bf16 v15, v213, v16, v15
    v_dot2_f32_bf16 v15, v214, v16, v15
    v_dot2_f32_bf16 v15, v215, v16, v15
    s_waitcnt lgkmcnt(0)
    ds_read_b64_tr_b16 v[216:217], v8 offset:4608
    ds_read_b64_tr_b16 v[218:219], v8 offset:5184
    ds_read_b64_tr_b16 v[220:221], v8 offset:4640
    ds_read_b64_tr_b16 v[222:223], v8 offset:5216
    ds_read_b64_tr_b16 v[224:225], v8 offset:4672
    ds_read_b64_tr_b16 v[226:227], v8 offset:5248
    ds_read_b64_tr_b16 v[228:229], v8 offset:4704
    ds_read_b64_tr_b16 v[230:231], v8 offset:5280
    s_waitcnt vmcnt(32)
    ds_write_b128 v5, v[160:163] offset:0
    ds_write_b128 v5, v[164:167] offset:1152
    ds_write_b128 v5, v[168:171] offset:2304
    ds_write_b128 v5, v[172:175] offset:3456
    s_waitcnt lgkmcnt(4)
    buffer_store_dwordx4 v[216:219], v9, s[28:31], s44 offen sc1
    s_add_u32 s44, s44, s48
    v_dot2_f32_bf16 v12, v216, v16, v12
    v_dot2_f32_bf16 v12, v217, v16, v12
    v_dot2_f32_bf16 v12, v218, v16, v12
    v_dot2_f32_bf16 v12, v219, v16, v12
    buffer_store_dwordx4 v[220:223], v9, s[28:31], s45 offen sc1
    s_add_u32 s45, s45, s49
    v_dot2_f32_bf16 v13, v220, v16, v13
    v_dot2_f32_bf16 v13, v221, v16, v13
    v_dot2_f32_bf16 v13, v222, v16, v13
    v_dot2_f32_bf16 v13, v223, v16, v13
    buffer_store_dwordx4 v[224:227], v9, s[28:31], s46 offen sc1
    s_add_u32 s46, s46, s50
    v_dot2_f32_bf16 v14, v224, v16, v14
    v_dot2_f32_bf16 v14, v225, v16, v14
    v_dot2_f32_bf16 v14, v226, v16, v14
    v_dot2_f32_bf16 v14, v227, v16, v14
    buffer_store_dwordx4 v[228:231], v9, s[28:31], s47 offen sc1
    s_add_u32 s47, s47, s51
    v_dot2_f32_bf16 v15, v228, v16, v15
    v_dot2_f32_bf16 v15, v229, v16, v15
    v_dot2_f32_bf16 v15, v230, v16, v15
    v_dot2_f32_bf16 v15, v231, v16, v15
    s_waitcnt lgkmcnt(0)
    ds_read_b64_tr_b16 v[200:201], v8 offset:0
    ds_read_b64_tr_b16 v[202:203], v8 offset:576
    ds_read_b64_tr_b16 v[204:205], v8 offset:32
    ds_read_b64_tr_b16 v[206:207], v8 offset:608
    ds_read_b64_tr_b16 v[208:209], v8 offset:64
    ds_read_b64_tr_b16 v[210:211], v8 offset:640
    ds_read_b64_tr_b16 v[212:213], v8 offset:96
    ds_read_b64_tr_b16 v[214:215], v8 offset:672
    s_waitcnt vmcnt(32)
    ds_write_b128 v5, v[176:179] offset:4608
    ds_write_b128 v5, v[180:183] offset:5760
    ds_write_b128 v5, v[184:187] offset:6912
    ds_write_b128 v5, v[188:191] offset:8064
    s_waitcnt lgkmcnt(4)
    buffer_store_dwordx4 v[200:203], v9, s[28:31], s44 offen sc1
    s_add_u32 s44, s44, s48
    v_dot2_f32_bf16 v12, v200, v16, v12
    v_dot2_f32_bf16 v12, v201, v16, v12
    v_dot2_f32_bf16 v12, v202, v16, v12
    v_dot2_f32_bf16 v12, v203, v16, v12
    buffer_store_dwordx4 v[204:207], v9, s[28:31], s45 offen sc1
    s_add_u32 s45, s45, s49
    v_dot2_f32_bf16 v13, v204, v16, v13
    v_dot2_f32_bf16 v13, v205, v16, v13
    v_dot2_f32_bf16 v13, v206, v16, v13
    v_dot2_f32_bf16 v13, v207, v16, v13
    buffer_store_dwordx4 v[208:211], v9, s[28:31], s46 offen sc1
    s_add_u32 s46, s46, s50
    v_dot2_f32_bf16 v14, v208, v16, v14
    v_dot2_f32_bf16 v14, v209, v16, v14
    v_dot2_f32_bf16 v14, v210, v16, v14
    v_dot2_f32_bf16 v14, v211, v16, v14
    buffer_store_dwordx4 v[212:215], v9, s[28:31], s47 offen sc1
    s_add_u32 s47, s47, s51
    v_dot2_f32_bf16 v15, v212, v16, v15
    v_dot2_f32_bf16 v15, v213, v16, v15
    v_dot2_f32_bf16 v15, v214, v16, v15
    v_dot2_f32_bf16 v15, v215, v16, v15
    s_waitcnt lgkmcnt(0)
    ds_read_b64_tr_b16 v[216:217], v8 offset:4608
    ds_read_b64_tr_b16 v[218:219], v8 offset:5184
    ds_read_b64_tr_b16 v[220:221], v8 offset:4640
    ds_read_b64_tr_b16 v[222:223], v8 offset:5216
    ds_read_b64_tr_b16 v[224:225], v8 offset:4672
    ds_read_b64_tr_b16 v[226:227], v8 offset:5248
    ds_read_b64_tr_b16 v[228:229], v8 offset:4704
    ds_read_b64_tr_b16 v[230:231], v8 offset:5280
    s_waitcnt lgkmcnt(0)
    buffer_store_dwordx4 v[216:219], v9, s[28:31], s44 offen sc1
    s_add_u32 s44, s44, s48
    v_dot2_f32_bf16 v12, v216, v16, v12
    v_dot2_f32_bf16 v12, v217, v16, v12
    v_dot2_f32_bf16 v12, v218, v16, v12
    v_dot2_f32_bf16 v12, v219, v16, v12
    buffer_store_dwordx4 v[220:223], v9, s[28:31], s45 offen sc1
    s_add_u32 s45, s45, s49
    v_dot2_f32_bf16 v13, v220, v16, v13
    v_dot2_f32_bf16 v13, v221, v16, v13
    v_dot2_f32_bf16 v13, v222, v16, v13
    v_dot2_f32_bf16 v13, v223, v16, v13
    buffer_store_dwordx4 v[224:227], v9, s[28:31], s46 offen sc1
    s_add_u32 s46, s46, s50
    v_dot2_f32_bf16 v14, v224, v16, v14
    v_dot2_f32_bf16 v14, v225, v16, v14
    v_dot2_f32_bf16 v14, v226, v16, v14
    v_dot2_f32_bf16 v14, v227, v16, v14
    buffer_store_dwordx4 v[228:231], v9, s[28:31], s47 offen sc1
    s_add_u32 s47, s47, s51
    v_dot2_f32_bf16 v15, v228, v16, v15
    v_dot2_f32_bf16 v15, v229, v16, v15
    v_dot2_f32_bf16 v15, v230, v16, v15
    v_dot2_f32_bf16 v15, v231, v16, v15
    s_nop 2
    v_mov_b32 v20, v12
    v_mov_b32 v21, v13
    v_mov_b32 v22, v14
    v_mov_b32 v23, v15
    s_nop 1
    v_permlane32_swap_b32 v20, v12
    v_permlane32_swap_b32 v21, v13
    v_permlane32_swap_b32 v22, v14
    v_permlane32_swap_b32 v23, v15
    s_nop 1
    v_add_f32 v12, v12, v20
    v_add_f32 v13, v13, v21
    v_add_f32 v14, v14, v22
    v_add_f32 v15, v15, v23
    v_mov_b32 v20, v12
    v_mov_b32 v21, v13
    v_mov_b32 v22, v14
    v_mov_b32 v23, v15
    s_nop 1
    v_permlane16_swap_b32 v20, v12
    v_permlane16_swap_b32 v21, v13
    v_permlane16_swap_b32 v22, v14
    v_permlane16_swap_b32 v23, v15
    s_nop 1
    v_add_f32 v12, v12, v20
    v_add_f32 v13, v13, v21
    v_add_f32 v14, v14, v22
    v_add_f32 v15, v15, v23
    s_mul_i32 s38, s33, 7168
    s_lshl_b32 s39, s35, 8
    s_add_u32 s38, s38, s39
    s_add_u32 s38, s38, 8130560
    v_lshlrev_b32 v17, 2, v1
    s_mov_b64 exec, 0xffff
    buffer_store_dword v12, v17, s[28:31], s38 offen offset:0 sc1
    buffer_store_dword v13, v17, s[28:31], s38 offen offset:64 sc1
    buffer_store_dword v14, v17, s[28:31], s38 offen offset:128 sc1
    buffer_store_dword v15, v17, s[28:31], s38 offen offset:192 sc1
    s_endpgm
prep_kernel_pk28:
    s_mov_b32 s24, s18
    s_mov_b32 s25, s19
    s_mov_b32 s26, 2211840
    s_mov_b32 s27, 0x00020000
    s_sub_u32 s32, s21, 94
    s_mul_i32 s33, s32, 52429
    s_lshr_b32 s33, s33, 19
    s_mul_i32 s35, s33, 10
    s_sub_u32 s35, s32, s35
    v_mul_u32_u24 v10, 1280, v3
    v_lshl_add_u32 v10, v4, 4, v10
    s_mul_i32 s36, s33, 368640
    s_lshl_b32 s37, s35, 7
    s_add_u32 s36, s36, s37
    buffer_load_dwordx4 v[32:35], v10, s[24:27], s36 offen nt
    s_add_u32 s36, s36, 10240
    buffer_load_dwordx4 v[36:39], v10, s[24:27], s36 offen nt
    s_add_u32 s36, s36, 10240
    buffer_load_dwordx4 v[40:43], v10, s[24:27], s36 offen nt
    s_add_u32 s36, s36, 10240
    buffer_load_dwordx4 v[44:47], v10, s[24:27], s36 offen nt
    s_add_u32 s36, s36, 10240
    buffer_load_dwordx4 v[48:51], v10, s[24:27], s36 offen nt
    s_add_u32 s36, s36, 10240
    buffer_load_dwordx4 v[52:55], v10, s[24:27], s36 offen nt
    s_add_u32 s36, s36, 10240
    buffer_load_dwordx4 v[56:59], v10, s[24:27], s36 offen nt
    s_add_u32 s36, s36, 10240
    buffer_load_dwordx4 v[60:63], v10, s[24:27], s36 offen nt
    s_add_u32 s36, s36, 10240
    buffer_load_dwordx4 v[64:67], v10, s[24:27], s36 offen nt
    s_add_u32 s36, s36, 10240
    buffer_load_dwordx4 v[68:71], v10, s[24:27], s36 offen nt
    s_add_u32 s36, s36, 10240
    buffer_load_dwordx4 v[72:75], v10, s[24:27], s36 offen nt
    s_add_u32 s36, s36, 10240
    buffer_load_dwordx4 v[76:79], v10, s[24:27], s36 offen nt
    s_add_u32 s36, s36, 10240
    buffer_load_dwordx4 v[80:83], v10, s[24:27], s36 offen nt
    s_add_u32 s36, s36, 10240
    buffer_load_dwordx4 v[84:87], v10, s[24:27], s36 offen nt
    s_add_u32 s36, s36, 10240
    buffer_load_dwordx4 v[88:91], v10, s[24:27], s36 offen nt
    s_add_u32 s36, s36, 10240
    buffer_load_dwordx4 v[92:95], v10, s[24:27], s36 offen nt
    s_add_u32 s36, s36, 10240
    buffer_load_dwordx4 v[96:99], v10, s[24:27], s36 offen nt
    s_add_u32 s36, s36, 10240
    buffer_load_dwordx4 v[100:103], v10, s[24:27], s36 offen nt
    s_add_u32 s36, s36, 10240
    buffer_load_dwordx4 v[104:107], v10, s[24:27], s36 offen nt
    s_add_u32 s36, s36, 10240
    buffer_load_dwordx4 v[108:111], v10, s[24:27], s36 offen nt
    s_add_u32 s36, s36, 10240
    buffer_load_dwordx4 v[112:115], v10, s[24:27], s36 offen nt
    s_add_u32 s36, s36, 10240
    buffer_load_dwordx4 v[116:119], v10, s[24:27], s36 offen nt
    s_add_u32 s36, s36, 10240
    buffer_load_dwordx4 v[120:123], v10, s[24:27], s36 offen nt
    s_add_u32 s36, s36, 10240
    buffer_load_dwordx4 v[124:127], v10, s[24:27], s36 offen nt
    s_add_u32 s36, s36, 10240
    buffer_load_dwordx4 v[128:131], v10, s[24:27], s36 offen nt
    s_add_u32 s36, s36, 10240
    buffer_load_dwordx4 v[132:135], v10, s[24:27], s36 offen nt
    s_add_u32 s36, s36, 10240
    buffer_load_dwordx4 v[136:139], v10, s[24:27], s36 offen nt
    s_add_u32 s36, s36, 10240
    buffer_load_dwordx4 v[140:143], v10, s[24:27], s36 offen nt
    s_add_u32 s36, s36, 10240
    buffer_load_dwordx4 v[144:147], v10, s[24:27], s36 offen nt
    s_add_u32 s36, s36, 10240
    buffer_load_dwordx4 v[148:151], v10, s[24:27], s36 offen nt
    s_add_u32 s36, s36, 10240
    buffer_load_dwordx4 v[152:155], v10, s[24:27], s36 offen nt
    s_add_u32 s36, s36, 10240
    buffer_load_dwordx4 v[156:159], v10, s[24:27], s36 offen nt
    s_add_u32 s36, s36, 10240
    buffer_load_dwordx4 v[160:163], v10, s[24:27], s36 offen nt
    s_add_u32 s36, s36, 10240
    buffer_load_dwordx4 v[164:167], v10, s[24:27], s36 offen nt
    s_add_u32 s36, s36, 10240
    buffer_load_dwordx4 v[168:171], v10, s[24:27], s36 offen nt
    s_add_u32 s36, s36, 10240
    buffer_load_dwordx4 v[172:175], v10, s[24:27], s36 offen nt
    s_lshl_b32 s36, s35, 2
    s_add_u32 s36, s36, 0
    s_mul_i32 s38, s36, 13108
    s_lshr_b32 s38, s38, 16
    s_mul_i32 s39, s38, 5
    s_sub_u32 s39, s36, s39
    s_sub_u32 s41, s39, 1
    s_cmp_eq_u32 s39, 0
    s_cselect_b32 s41, 4, s41
    s_and_b32 s40, s38, 1
    s_cmp_eq_u32 s40, 1
    s_cselect_b32 s39, s41, s39
    s_mul_i32 s40, s33, 21846
    s_lshr_b32 s40, s40, 16
    s_mul_i32 s41, s40, 3
    s_sub_u32 s41, s33, s41
    s_mul_i32 s37, s38, 270
    s_mul_i32 s41, s41, 90
    s_add_u32 s37, s37, s41
    s_mul_i32 s40, s40, 5
    s_add_u32 s37, s37, s40
    s_add_u32 s37, s37, s39
    s_lshl_b32 s37, s37, 10
    s_add_u32 s44, s37, 27168768
    s_movk_i32 s48, 10240
    s_lshl_b32 s36, s35, 2
    s_add_u32 s36, s36, 1
    s_mul_i32 s38, s36, 13108
    s_lshr_b32 s38, s38, 16
    s_mul_i32 s39, s38, 5
    s_sub_u32 s39, s36, s39
    s_sub_u32 s41, s39, 1
    s_cmp_eq_u32 s39, 0
    s_cselect_b32 s41, 4, s41
    s_and_b32 s40, s38, 1
    s_cmp_eq_u32 s40, 1
    s_cselect_b32 s39, s41, s39
    s_mul_i32 s40, s33, 21846
    s_lshr_b32 s40, s40, 16
    s_mul_i32 s41, s40, 3
    s_sub_u32 s41, s33, s41
    s_mul_i32 s37, s38, 270
    s_mul_i32 s41, s41, 90
    s_add_u32 s37, s37, s41
    s_mul_i32 s40, s40, 5
    s_add_u32 s37, s37, s40
    s_add_u32 s37, s37, s39
    s_lshl_b32 s37, s37, 10
    s_add_u32 s45, s37, 27168768
    s_movk_i32 s49, 10240
    s_lshl_b32 s36, s35, 2
    s_add_u32 s36, s36, 2
    s_mul_i32 s38, s36, 13108
    s_lshr_b32 s38, s38, 16
    s_mul_i32 s39, s38, 5
    s_sub_u32 s39, s36, s39
    s_sub_u32 s41, s39, 1
    s_cmp_eq_u32 s39, 0
    s_cselect_b32 s41, 4, s41
    s_and_b32 s40, s38, 1
    s_cmp_eq_u32 s40, 1
    s_cselect_b32 s39, s41, s39
    s_mul_i32 s40, s33, 21846
    s_lshr_b32 s40, s40, 16
    s_mul_i32 s41, s40, 3
    s_sub_u32 s41, s33, s41
    s_mul_i32 s37, s38, 270
    s_mul_i32 s41, s41, 90
    s_add_u32 s37, s37, s41
    s_mul_i32 s40, s40, 5
    s_add_u32 s37, s37, s40
    s_add_u32 s37, s37, s39
    s_lshl_b32 s37, s37, 10
    s_add_u32 s46, s37, 27168768
    s_movk_i32 s50, 10240
    s_lshl_b32 s36, s35, 2
    s_add_u32 s36, s36, 3
    s_mul_i32 s38, s36, 13108
    s_lshr_b32 s38, s38, 16
    s_mul_i32 s39, s38, 5
    s_sub_u32 s39, s36, s39
    s_sub_u32 s41, s39, 1
    s_cmp_eq_u32 s39, 0
    s_cselect_b32 s41, 4, s41
    s_and_b32 s40, s38, 1
    s_cmp_eq_u32 s40, 1
    s_cselect_b32 s39, s41, s39
    s_mul_i32 s40, s33, 21846
    s_lshr_b32 s40, s40, 16
    s_mul_i32 s41, s40, 3
    s_sub_u32 s41, s33, s41
    s_mul_i32 s37, s38, 270
    s_mul_i32 s41, s41, 90
    s_add_u32 s37, s37, s41
    s_mul_i32 s40, s40, 5
    s_add_u32 s37, s37, s40
    s_add_u32 s37, s37, s39
    s_lshl_b32 s37, s37, 10
    s_add_u32 s47, s37, 27168768
    s_movk_i32 s51, 10240
    s_waitcnt vmcnt(32)
    ds_write_b128 v5, v[32:35] offset:0
    ds_write_b128 v5, v[36:39] offset:1152
    ds_write_b128 v5, v[40:43] offset:2304
    ds_write_b128 v5, v[44:47] offset:3456
    s_waitcnt lgkmcnt(0)
    ds_read_b64_tr_b16 v[200:201], v8 offset:0
    ds_read_b64_tr_b16 v[202:203], v8 offset:576
    ds_read_b64_tr_b16 v[204:205], v8 offset:32
    ds_read_b64_tr_b16 v[206:207], v8 offset:608
    ds_read_b64_tr_b16 v[208:209], v8 offset:64
    ds_read_b64_tr_b16 v[210:211], v8 offset:640
    ds_read_b64_tr_b16 v[212:213], v8 offset:96
    ds_read_b64_tr_b16 v[214:215], v8 offset:672
    s_waitcnt vmcnt(28)
    ds_write_b128 v5, v[48:51] offset:4608
    ds_write_b128 v5, v[52:55] offset:5760
    ds_write_b128 v5, v[56:59] offset:6912
    ds_write_b128 v5, v[60:63] offset:8064
    s_waitcnt lgkmcnt(4)
    buffer_store_dwordx4 v[200:203], v9, s[28:31], s44 offen sc1
    s_add_u32 s44, s44, s48
    buffer_store_dwordx4 v[204:207], v9, s[28:31], s45 offen sc1
    s_add_u32 s45, s45, s49
    buffer_store_dwordx4 v[208:211], v9, s[28:31], s46 offen sc1
    s_add_u32 s46, s46, s50
    buffer_store_dwordx4 v[212:215], v9, s[28:31], s47 offen sc1
    s_add_u32 s47, s47, s51
    s_waitcnt lgkmcnt(0)
    ds_read_b64_tr_b16 v[216:217], v8 offset:4608
    ds_read_b64_tr_b16 v[218:219], v8 offset:5184
    ds_read_b64_tr_b16 v[220:221], v8 offset:4640
    ds_read_b64_tr_b16 v[222:223], v8 offset:5216
    ds_read_b64_tr_b16 v[224:225], v8 offset:4672
    ds_read_b64_tr_b16 v[226:227], v8 offset:5248
    ds_read_b64_tr_b16 v[228:229], v8 offset:4704
    ds_read_b64_tr_b16 v[230:231], v8 offset:5280
    s_waitcnt vmcnt(28)
    ds_write_b128 v5, v[64:67] offset:0
    ds_write_b128 v5, v[68:71] offset:1152
    ds_write_b128 v5, v[72:75] offset:2304
    ds_write_b128 v5, v[76:79] offset:3456
    s_waitcnt lgkmcnt(4)
    buffer_store_dwordx4 v[216:219], v9, s[28:31], s44 offen sc1
    s_add_u32 s44, s44, s48
    buffer_store_dwordx4 v[220:223], v9, s[28:31], s45 offen sc1
    s_add_u32 s45, s45, s49
    buffer_store_dwordx4 v[224:227], v9, s[28:31], s46 offen sc1
    s_add_u32 s46, s46, s50
    buffer_store_dwordx4 v[228:231], v9, s[28:31], s47 offen sc1
    s_add_u32 s47, s47, s51
    s_waitcnt lgkmcnt(0)
    ds_read_b64_tr_b16 v[200:201], v8 offset:0
    ds_read_b64_tr_b16 v[202:203], v8 offset:576
    ds_read_b64_tr_b16 v[204:205], v8 offset:32
    ds_read_b64_tr_b16 v[206:207], v8 offset:608
    ds_read_b64_tr_b16 v[208:209], v8 offset:64
    ds_read_b64_tr_b16 v[210:211], v8 offset:640
    ds_read_b64_tr_b16 v[212:213], v8 offset:96
    ds_read_b64_tr_b16 v[214:215], v8 offset:672
    s_waitcnt vmcnt(28)
    ds_write_b128 v5, v[80:83] offset:4608
    ds_write_b128 v5, v[84:87] offset:5760
    ds_write_b128 v5, v[88:91] offset:6912
    ds_write_b128 v5, v[92:95] offset:8064
    s_waitcnt lgkmcnt(4)
    buffer_store_dwordx4 v[200:203], v9, s[28:31], s44 offen sc1
    s_add_u32 s44, s44, s48
    buffer_store_dwordx4 v[204:207], v9, s[28:31], s45 offen sc1
    s_add_u32 s45, s45, s49
    buffer_store_dwordx4 v[208:211], v9, s[28:31], s46 offen sc1
    s_add_u32 s46, s46, s50
    buffer_store_dwordx4 v[212:215], v9, s[28:31], s47 offen sc1
    s_add_u32 s47, s47, s51
    s_waitcnt lgkmcnt(0)
    ds_read_b64_tr_b16 v[216:217], v8 offset:4608
    ds_read_b64_tr_b16 v[218:219], v8 offset:5184
    ds_read_b64_tr_b16 v[220:221], v8 offset:4640
    ds_read_b64_tr_b16 v[222:223], v8 offset:5216
    ds_read_b64_tr_b16 v[224:225], v8 offset:4672
    ds_read_b64_tr_b16 v[226:227], v8 offset:5248
    ds_read_b64_tr_b16 v[228:229], v8 offset:4704
    ds_read_b64_tr_b16 v[230:231], v8 offset:5280
    s_waitcnt vmcnt(28)
    ds_write_b128 v5, v[96:99] offset:0
    ds_write_b128 v5, v[100:103] offset:1152
    ds_write_b128 v5, v[104:107] offset:2304
    ds_write_b128 v5, v[108:111] offset:3456
    s_waitcnt lgkmcnt(4)
    buffer_store_dwordx4 v[216:219], v9, s[28:31], s44 offen sc1
    s_add_u32 s44, s44, s48
    buffer_store_dwordx4 v[220:223], v9, s[28:31], s45 offen sc1
    s_add_u32 s45, s45, s49
    buffer_store_dwordx4 v[224:227], v9, s[28:31], s46 offen sc1
    s_add_u32 s46, s46, s50
    buffer_store_dwordx4 v[228:231], v9, s[28:31], s47 offen sc1
    s_add_u32 s47, s47, s51
    s_waitcnt lgkmcnt(0)
    ds_read_b64_tr_b16 v[200:201], v8 offset:0
    ds_read_b64_tr_b16 v[202:203], v8 offset:576
    ds_read_b64_tr_b16 v[204:205], v8 offset:32
    ds_read_b64_tr_b16 v[206:207], v8 offset:608
    ds_read_b64_tr_b16 v[208:209], v8 offset:64
    ds_read_b64_tr_b16 v[210:211], v8 offset:640
    ds_read_b64_tr_b16 v[212:213], v8 offset:96
    ds_read_b64_tr_b16 v[214:215], v8 offset:672
    s_waitcnt vmcnt(28)
    ds_write_b128 v5, v[112:115] offset:4608
    ds_write_b128 v5, v[116:119] offset:5760
    ds_write_b128 v5, v[120:123] offset:6912
    ds_write_b128 v5, v[124:127] offset:8064
    s_waitcnt lgkmcnt(4)
    buffer_store_dwordx4 v[200:203], v9, s[28:31], s44 offen sc1
    s_add_u32 s44, s44, s48
    buffer_store_dwordx4 v[204:207], v9, s[28:31], s45 offen sc1
    s_add_u32 s45, s45, s49
    buffer_store_dwordx4 v[208:211], v9, s[28:31], s46 offen sc1
    s_add_u32 s46, s46, s50
    buffer_store_dwordx4 v[212:215], v9, s[28:31], s47 offen sc1
    s_add_u32 s47, s47, s51
    s_waitcnt lgkmcnt(0)
    ds_read_b64_tr_b16 v[216:217], v8 offset:4608
    ds_read_b64_tr_b16 v[218:219], v8 offset:5184
    ds_read_b64_tr_b16 v[220:221], v8 offset:4640
    ds_read_b64_tr_b16 v[222:223], v8 offset:5216
    ds_read_b64_tr_b16 v[224:225], v8 offset:4672
    ds_read_b64_tr_b16 v[226:227], v8 offset:5248
    ds_read_b64_tr_b16 v[228:229], v8 offset:4704
    ds_read_b64_tr_b16 v[230:231], v8 offset:5280
    s_waitcnt vmcnt(28)
    ds_write_b128 v5, v[128:131] offset:0
    ds_write_b128 v5, v[132:135] offset:1152
    ds_write_b128 v5, v[136:139] offset:2304
    ds_write_b128 v5, v[140:143] offset:3456
    s_waitcnt lgkmcnt(4)
    buffer_store_dwordx4 v[216:219], v9, s[28:31], s44 offen sc1
    s_add_u32 s44, s44, s48
    buffer_store_dwordx4 v[220:223], v9, s[28:31], s45 offen sc1
    s_add_u32 s45, s45, s49
    buffer_store_dwordx4 v[224:227], v9, s[28:31], s46 offen sc1
    s_add_u32 s46, s46, s50
    buffer_store_dwordx4 v[228:231], v9, s[28:31], s47 offen sc1
    s_add_u32 s47, s47, s51
    s_waitcnt lgkmcnt(0)
    ds_read_b64_tr_b16 v[200:201], v8 offset:0
    ds_read_b64_tr_b16 v[202:203], v8 offset:576
    ds_read_b64_tr_b16 v[204:205], v8 offset:32
    ds_read_b64_tr_b16 v[206:207], v8 offset:608
    ds_read_b64_tr_b16 v[208:209], v8 offset:64
    ds_read_b64_tr_b16 v[210:211], v8 offset:640
    ds_read_b64_tr_b16 v[212:213], v8 offset:96
    ds_read_b64_tr_b16 v[214:215], v8 offset:672
    s_waitcnt vmcnt(28)
    ds_write_b128 v5, v[144:147] offset:4608
    ds_write_b128 v5, v[148:151] offset:5760
    ds_write_b128 v5, v[152:155] offset:6912
    ds_write_b128 v5, v[156:159] offset:8064
    s_waitcnt lgkmcnt(4)
    buffer_store_dwordx4 v[200:203], v9, s[28:31], s44 offen sc1
    s_add_u32 s44, s44, s48
    buffer_store_dwordx4 v[204:207], v9, s[28:31], s45 offen sc1
    s_add_u32 s45, s45, s49
    buffer_store_dwordx4 v[208:211], v9, s[28:31], s46 offen sc1
    s_add_u32 s46, s46, s50
    buffer_store_dwordx4 v[212:215], v9, s[28:31], s47 offen sc1
    s_add_u32 s47, s47, s51
    s_waitcnt lgkmcnt(0)
    ds_read_b64_tr_b16 v[216:217], v8 offset:4608
    ds_read_b64_tr_b16 v[218:219], v8 offset:5184
    ds_read_b64_tr_b16 v[220:221], v8 offset:4640
    ds_read_b64_tr_b16 v[222:223], v8 offset:5216
    ds_read_b64_tr_b16 v[224:225], v8 offset:4672
    ds_read_b64_tr_b16 v[226:227], v8 offset:5248
    ds_read_b64_tr_b16 v[228:229], v8 offset:4704
    ds_read_b64_tr_b16 v[230:231], v8 offset:5280
    s_waitcnt vmcnt(28)
    ds_write_b128 v5, v[160:163] offset:0
    ds_write_b128 v5, v[164:167] offset:1152
    ds_write_b128 v5, v[168:171] offset:2304
    ds_write_b128 v5, v[172:175] offset:3456
    s_waitcnt lgkmcnt(4)
    buffer_store_dwordx4 v[216:219], v9, s[28:31], s44 offen sc1
    s_add_u32 s44, s44, s48
    buffer_store_dwordx4 v[220:223], v9, s[28:31], s45 offen sc1
    s_add_u32 s45, s45, s49
    buffer_store_dwordx4 v[224:227], v9, s[28:31], s46 offen sc1
    s_add_u32 s46, s46, s50
    buffer_store_dwordx4 v[228:231], v9, s[28:31], s47 offen sc1
    s_add_u32 s47, s47, s51
    s_waitcnt lgkmcnt(0)
    ds_read_b64_tr_b16 v[200:201], v8 offset:0
    ds_read_b64_tr_b16 v[202:203], v8 offset:576
    ds_read_b64_tr_b16 v[204:205], v8 offset:32
    ds_read_b64_tr_b16 v[206:207], v8 offset:608
    ds_read_b64_tr_b16 v[208:209], v8 offset:64
    ds_read_b64_tr_b16 v[210:211], v8 offset:640
    ds_read_b64_tr_b16 v[212:213], v8 offset:96
    ds_read_b64_tr_b16 v[214:215], v8 offset:672
    s_waitcnt lgkmcnt(0)
    buffer_store_dwordx4 v[200:203], v9, s[28:31], s44 offen sc1
    s_add_u32 s44, s44, s48
    buffer_store_dwordx4 v[204:207], v9, s[28:31], s45 offen sc1
    s_add_u32 s45, s45, s49
    buffer_store_dwordx4 v[208:211], v9, s[28:31], s46 offen sc1
    s_add_u32 s46, s46, s50
    buffer_store_dwordx4 v[212:215], v9, s[28:31], s47 offen sc1
    s_add_u32 s47, s47, s51
    s_endpgm
.globl chain_kernel
.p2align 8
.type chain_kernel,@function
chain_kernel:
    s_cmp_ge_u32 s2, 256
    s_cbranch_scc1 chain_end
    s_load_dwordx2 s[4:5], s[0:1], 0
    s_load_dwordx2 s[6:7], s[0:1], 104
    s_load_dwordx2 s[10:11], s[0:1], 120
    v_lshrrev_b32 v2, 6, v0
    v_and_b32 v1, 63, v0
    v_readfirstlane_b32 s20, v2
    s_and_b32 s25, s2, 7
    s_lshr_b32 s26, s2, 3
    s_lshl_b32 s23, s25, 3
    s_lshr_b32 s27, s26, 2
    s_add_u32 s23, s23, s27
    s_and_b32 s24, s26, 3
    s_and_b32 s21, s20, 1
    s_lshr_b32 s22, s20, 1
    v_lshrrev_b32 v3, 4, v1
    v_and_b32 v4, 15, v1
    v_lshlrev_b32 v8, 4, v1
    s_waitcnt lgkmcnt(0)
    s_mov_b32 s28, s10
    s_mov_b32 s29, s11
    s_mov_b32 s30, 268435456
    s_mov_b32 s31, 0x00020000
    s_mul_i32 s25, s20, 10240
    s_add_u32 s10, s25, 0
    s_mul_i32 s11, s23, 40960
    s_add_u32 s11, s11, s25
    s_add_u32 s11, s11, 5492736
    s_lshl_b32 s12, s20, 10
    s_add_u32 s13, s12, 8121856
    s_add_u32 s12, s12, 130560
    s_lshl_b32 s14, s21, 10
    s_add_u32 s14, s14, 139264
    s_mul_i32 s15, s21, 7168
    s_mul_i32 s25, s24, 640
    s_add_u32 s15, s15, s25
    s_add_u32 s15, s15, 8146944
    s_mov_b32 m0, s10
    s_add_u32 s10, s10, 4096
    buffer_load_dwordx4 v8, s[28:31], s11 offen offset:0 lds
    buffer_load_dwordx4 v8, s[28:31], s11 offen offset:1024 lds
    buffer_load_dwordx4 v8, s[28:31], s11 offen offset:2048 lds
    buffer_load_dwordx4 v8, s[28:31], s11 offen offset:3072 lds
    s_add_u32 s11, s11, 4096
    s_mov_b32 m0, s10
    s_add_u32 s10, s10, 4096
    buffer_load_dwordx4 v8, s[28:31], s11 offen offset:0 lds
    buffer_load_dwordx4 v8, s[28:31], s11 offen offset:1024 lds
    buffer_load_dwordx4 v8, s[28:31], s11 offen offset:2048 lds
    buffer_load_dwordx4 v8, s[28:31], s11 offen offset:3072 lds
    s_add_u32 s11, s11, 4096
    s_mov_b32 m0, s10
    s_add_u32 s10, s10, 4096
    buffer_load_dwordx4 v8, s[28:31], s11 offen offset:0 lds
    buffer_load_dwordx4 v8, s[28:31], s11 offen offset:1024 lds
    s_mov_b32 m0, s12
    s_nop 0
    buffer_load_dwordx4 v8, s[28:31], s13 offen lds
    s_mov_b32 m0, 134656
    s_mov_b32 s13, 8125952
    buffer_load_dwordx4 v8, s[28:31], s13 offen lds
    s_mov_b32 m0, s14
    s_nop 0
    buffer_load_dwordx4 v8, s[28:31], s15 offen lds
    s_mov_b32 s32, s6
    s_mov_b32 s33, s7
    s_mov_b32 s34, 2621440
    s_mov_b32 s35, 0x00020000
    s_mul_i32 s36, s24, 200
    s_mul_i32 s37, s21, 100
    s_add_u32 s36, s36, s37
    s_mul_i32 s37, s22, 50
    s_add_u32 s36, s36, s37
    s_lshl_b32 s36, s36, 10
    s_add_u32 s37, s36, 24055808
    s_add_u32 s36, s36, 23236608
    v_lshrrev_b32 v2, 1, v3
    s_lshl_b32 s26, s21, 2
    v_add_u32 v2, s26, v2
    v_and_b32 v7, 7, v4
    buffer_load_dwordx4 a[0:3], v8, s[28:31], s36 offen offset:0
    v_xor_b32 v2, v2, v7
    v_lshlrev_b32 v2, 4, v2
    v_lshl_add_u32 v226, v4, 8, v2
    v_and_b32 v2, 1, v3
    v_lshl_add_u32 v226, v2, 3, v226
    s_mul_i32 s26, s22, 20480
    s_add_u32 s27, s26, 0
    v_add_u32 v226, s27, v226
    v_lshlrev_b32 v227, 5, v4
    v_add_u32 v227, 122880, v227
    s_lshl_b32 s27, s21, 3
    v_add_u32 v2, s27, v3
    v_xor_b32 v2, v2, v7
    v_lshlrev_b32 v2, 4, v2
    v_and_b32 v7, 3, v4
    v_lshl_add_u32 v2, v7, 8, v2
    v_lshrrev_b32 v7, 2, v4
    buffer_load_dwordx4 a[4:7], v8, s[28:31], s36 offen offset:1024
    v_lshl_add_u32 v2, v7, 10, v2
    s_add_u32 s27, s26, 40960
    v_add_u32 v228, s27, v2
    v_xor_b32 v2, v4, v3
    v_lshlrev_b32 v2, 4, v2
    v_lshl_add_u32 v2, v3, 8, v2
    v_xor_b32 v7, 64, v2
    s_mul_i32 s26, s22, 30720
    s_add_u32 s26, s26, 40960
    s_mul_i32 s27, s22, 10240
    s_sub_u32 s27, 61440, s27
    v_add_u32 v229, s26, v2
    v_add_u32 v230, s26, v7
    v_add_u32 v231, s27, v2
    v_add_u32 v232, s27, v7
    v_lshlrev_b32 v2, 4, v3
    s_mul_i32 s26, s21, 384
    buffer_load_dwordx4 a[8:11], v8, s[28:31], s36 offen offset:2048
    s_add_u32 s26, s26, 139264
    v_add_u32 v233, s26, v2
    s_mul_i32 s26, s21, 64
    s_add_u32 s26, s26, 139520
    v_add_u32 v234, s26, v2
    s_lshl_b32 s26, s22, 7
    s_add_u32 s26, s26, 138240
    v_lshl_add_u32 v235, v4, 3, s26
    s_mul_i32 s39, s24, 5
    s_mul_i32 s40, s21, 3
    s_add_u32 s40, s40, s39
    s_add_u32 s41, s39, 2
    v_lshrrev_b32 v12, 1, v3
    v_and_b32 v13, 1, v3
    v_lshlrev_b32 v13, 3, v13
    s_add_u32 s26, s40, 0
    buffer_load_dwordx4 a[12:15], v8, s[28:31], s36 offen offset:3072
    v_add_u32 v14, 0, v12
    s_and_b32 s27, s26, 1
    s_lshl_b32 s27, s27, 2
    v_add_u32 v15, s27, v14
    v_xor_b32 v15, v15, v4
    v_lshlrev_b32 v15, 4, v15
    v_lshl_add_u32 v15, v14, 8, v15
    v_add_u32 v15, v15, v13
    s_mul_i32 s27, s22, 20
    s_add_u32 s27, s27, s26
    s_lshl_b32 s27, s27, 10
    s_add_u32 s27, s27, 40960
    v_add_u32 v236, s27, v15
    s_add_u32 s26, s40, 0
    v_add_u32 v14, 2, v12
    s_and_b32 s27, s26, 1
    s_lshl_b32 s27, s27, 2
    s_add_u32 s36, s36, 4096
    buffer_load_dwordx4 a[16:19], v8, s[28:31], s36 offen offset:0
    v_add_u32 v15, s27, v14
    v_xor_b32 v15, v15, v4
    v_lshlrev_b32 v15, 4, v15
    v_lshl_add_u32 v15, v14, 8, v15
    v_add_u32 v15, v15, v13
    s_mul_i32 s27, s22, 20
    s_add_u32 s27, s27, s26
    s_lshl_b32 s27, s27, 10
    s_add_u32 s27, s27, 40960
    v_add_u32 v237, s27, v15
    s_add_u32 s26, s40, 1
    v_add_u32 v14, 0, v12
    s_and_b32 s27, s26, 1
    s_lshl_b32 s27, s27, 2
    v_add_u32 v15, s27, v14
    v_xor_b32 v15, v15, v4
    v_lshlrev_b32 v15, 4, v15
    buffer_load_dwordx4 a[20:23], v8, s[28:31], s36 offen offset:1024
    v_lshl_add_u32 v15, v14, 8, v15
    v_add_u32 v15, v15, v13
    s_mul_i32 s27, s22, 20
    s_add_u32 s27, s27, s26
    s_lshl_b32 s27, s27, 10
    s_add_u32 s27, s27, 40960
    v_add_u32 v238, s27, v15
    s_add_u32 s26, s40, 1
    v_add_u32 v14, 2, v12
    s_and_b32 s27, s26, 1
    s_lshl_b32 s27, s27, 2
    v_add_u32 v15, s27, v14
    v_xor_b32 v15, v15, v4
    v_lshlrev_b32 v15, 4, v15
    v_lshl_add_u32 v15, v14, 8, v15
    v_add_u32 v15, v15, v13
    s_mul_i32 s27, s22, 20
    buffer_load_dwordx4 a[24:27], v8, s[28:31], s36 offen offset:2048
    s_add_u32 s27, s27, s26
    s_lshl_b32 s27, s27, 10
    s_add_u32 s27, s27, 40960
    v_add_u32 v239, s27, v15
    s_mov_b32 s26, s41
    s_lshl_b32 s27, s21, 1
    v_add_u32 v14, s27, v12
    s_and_b32 s27, s26, 1
    s_lshl_b32 s27, s27, 2
    v_add_u32 v15, s27, v14
    v_xor_b32 v15, v15, v4
    v_lshlrev_b32 v15, 4, v15
    v_lshl_add_u32 v15, v14, 8, v15
    v_add_u32 v15, v15, v13
    s_mul_i32 s27, s22, 20
    s_add_u32 s27, s27, s26
    s_lshl_b32 s27, s27, 10
    buffer_load_dwordx4 a[28:31], v8, s[28:31], s36 offen offset:3072
    s_add_u32 s27, s27, 40960
    v_add_u32 v240, s27, v15
    s_lshr_b32 s26, s24, 1
    s_add_u32 s26, s26, 1
    s_sub_u32 s27, 0, s26
    s_and_b32 s42, s24, 1
    s_cmp_eq_u32 s42, 1
    s_cselect_b32 s42, s27, s26
    s_lshl_b32 s43, s23, 5
    s_lshl_b32 s26, s22, 4
    s_add_u32 s43, s43, s26
    v_add_u32 v241, s43, v4
    v_add_u32 v241, s42, v241
    s_movk_i32 s27, 2048
    v_cmp_gt_u32 s[60:61], s27, v241
    v_lshrrev_b32 v242, 4, v241
    s_add_u32 s36, s36, 4096
    buffer_load_dwordx4 a[32:35], v8, s[28:31], s36 offen offset:0
    v_and_b32 v241, 15, v241
    s_mov_b32 s27, 20480
    v_mul_lo_u32 v242, v242, s27
    v_lshl_add_u32 v242, v241, 4, v242
    v_and_b32 v241, 1, v3
    v_lshlrev_b32 v241, 9, v241
    v_lshrrev_b32 v2, 1, v3
    v_lshl_add_u32 v241, v2, 8, v241
    v_add_u32 v241, v241, v242
    s_lshl_b32 s27, s21, 9
    v_lshl_add_u32 v242, v2, 8, v242
    v_add_u32 v242, s27, v242
    v_and_b32 v2, 1, v3
    v_lshl_add_u32 v242, v2, 3, v242
    v_add_u32 v243, s43, v4
    v_lshrrev_b32 v244, 4, v243
    v_and_b32 v243, 15, v243
    buffer_load_dwordx4 a[36:39], v8, s[28:31], s36 offen offset:1024
    s_mov_b32 s27, 20480
    v_mul_lo_u32 v244, v244, s27
    v_lshl_add_u32 v244, v243, 4, v244
    v_and_b32 v243, 1, v3
    v_lshlrev_b32 v243, 9, v243
    v_lshrrev_b32 v2, 1, v3
    v_lshl_add_u32 v243, v2, 8, v243
    v_add_u32 v243, v243, v244
    s_lshl_b32 s27, s21, 9
    v_lshl_add_u32 v244, v2, 8, v244
    v_add_u32 v244, s27, v244
    v_and_b32 v2, 1, v3
    v_lshl_add_u32 v244, v2, 3, v244
    s_lshl_b32 s44, s40, 10
    s_add_u32 s38, s44, 13406208
    s_add_u32 s44, s44, 10784768
    s_lshl_b32 s45, s41, 10
    buffer_load_dwordx4 a[40:43], v8, s[28:31], s36 offen offset:2048
    s_add_u32 s39, s45, 13406208
    s_add_u32 s45, s45, 10784768
    s_lshl_b32 s46, s23, 2
    s_add_u32 s46, s46, s24
    s_lshl_b32 s46, s46, 7
    s_add_u32 s49, s46, 29413376
    s_add_u32 s46, s46, 29380608
    v_add_u32 v7, 1, v1
    v_lshrrev_b32 v7, 1, v7
    v_add_u32 v7, s23, v7
    v_subrev_u32 v7, 1, v7
    v_max_i32 v7, 0, v7
    v_min_i32 v7, 63, v7
    v_lshrrev_b32 v2, 1, v1
    s_lshl_b32 s26, s22, 1
    v_add_u32 v2, s26, v2
    v_lshl_add_u32 v7, v7, 2, v2
    buffer_load_dwordx4 a[44:47], v8, s[28:31], s36 offen offset:3072
    v_lshlrev_b32 v245, 7, v7
    s_lshl_b32 s26, s23, 1
    s_add_u32 s27, s26, s22
    s_mul_i32 s27, s27, 20
    s_mul_i32 s3, s22, 10
    s_add_u32 s27, s27, s3
    s_lshl_b32 s27, s27, 10
    s_add_u32 s50, s27, 10784768
    s_add_u32 s27, s26, 1
    s_sub_u32 s27, s27, s22
    s_mul_i32 s27, s27, 20
    s_add_u32 s27, s27, s3
    s_lshl_b32 s27, s27, 10
    s_add_u32 s51, s27, 10784768
    s_mul_i32 s26, s20, 5120
    s_add_u32 s26, s26, 143360
    s_add_u32 s36, s36, 4096
    buffer_load_dwordx4 a[48:51], v8, s[28:31], s36 offen offset:0
    v_add_u32 v246, s26, v8
    s_xor_b32 s27, s20, 2
    s_mul_i32 s27, s27, 5120
    s_add_u32 s27, s27, 143360
    v_add_u32 v247, s27, v8
    s_lshr_b32 s26, s2, 3
    s_and_b32 s3, s2, 7
    s_and_b32 s4, s3, 1
    s_lshr_b32 s3, s3, 1
    s_and_b32 s52, s26, 7
    s_lshl_b32 s27, s4, 3
    s_add_u32 s52, s52, s27
    s_lshr_b32 s27, s26, 3
    s_lshl_b32 s53, s3, 2
    s_add_u32 s53, s53, s27
    s_and_b32 s57, s26, 3
    buffer_load_dwordx4 a[52:55], v8, s[28:31], s36 offen offset:1024
    s_lshl_b32 s27, s4, 2
    s_add_u32 s57, s57, s27
    s_lshr_b32 s27, s26, 2
    s_lshl_b32 s58, s3, 3
    s_add_u32 s58, s58, s27
    s_and_b32 s57, s26, 7
    s_lshr_b32 s27, s26, 3
    s_and_b32 s58, s2, 7
    s_lshl_b32 s58, s58, 2
    s_add_u32 s58, s58, s27
    s_mul_i32 s54, s52, 143360
    s_add_u32 s54, s54, 24875008
    s_mul_i32 s59, s57, 276480
    s_add_u32 s59, s59, 27168768
    v_mov_b32 v224, 0x3f803f80
    v_mov_b32 v216, 0
    buffer_load_dwordx4 a[56:59], v8, s[28:31], s36 offen offset:2048
    v_mov_b32 v217, 0
    v_mov_b32 v220, 0
    v_mov_b32 v221, 0
    v_mov_b32 v218, 0
    v_mov_b32 v219, 0
    v_mov_b32 v222, 0
    v_mov_b32 v223, 0
    buffer_load_dwordx4 a[60:63], v8, s[28:31], s36 offen offset:3072
    s_add_u32 s36, s36, 4096
    buffer_load_dwordx4 a[64:67], v8, s[28:31], s36 offen offset:0
    s_waitcnt vmcnt(17)
    s_barrier
    buffer_load_dwordx4 a[68:71], v8, s[28:31], s36 offen offset:1024
    v_xor_b32 v12, 32, v226
    ds_read_b64 v[32:33], v226 offset:0
    ds_read_b64 v[34:35], v226 offset:128
    ds_read_b64 v[36:37], v12 offset:0
    ds_read_b64 v[38:39], v12 offset:128
    ds_read_b64 v[40:41], v226 offset:4096
    ds_read_b64 v[42:43], v226 offset:4224
    buffer_load_dwordx4 a[72:75], v8, s[28:31], s36 offen offset:2048
    s_waitcnt lgkmcnt(4)
    v_dot2_f32_bf16 v220, v32, v224, v220
    v_lshlrev_b32 v72, 16, v32
    v_dot2_f32_bf16 v221, v32, v32, v221
    v_and_b32 v73, 0xffff0000, v32
    v_dot2_f32_bf16 v220, v33, v224, v220
    ds_read_b64 v[44:45], v12 offset:4096
    v_lshlrev_b32 v74, 16, v33
    v_dot2_f32_bf16 v221, v33, v33, v221
    v_and_b32 v75, 0xffff0000, v33
    v_dot2_f32_bf16 v220, v34, v224, v220
    ds_read_b64 v[46:47], v12 offset:4224
    v_lshlrev_b32 v76, 16, v34
    buffer_load_dwordx4 a[76:79], v8, s[28:31], s36 offen offset:3072
    v_dot2_f32_bf16 v221, v34, v34, v221
    v_and_b32 v77, 0xffff0000, v34
    v_dot2_f32_bf16 v220, v35, v224, v220
    v_lshlrev_b32 v78, 16, v35
    v_dot2_f32_bf16 v221, v35, v35, v221
    v_and_b32 v79, 0xffff0000, v35
    s_waitcnt lgkmcnt(4)
    v_dot2_f32_bf16 v222, v36, v224, v222
    v_lshlrev_b32 v80, 16, v36
    v_dot2_f32_bf16 v223, v36, v36, v223
    v_and_b32 v81, 0xffff0000, v36
    v_dot2_f32_bf16 v222, v37, v224, v222
    ds_read_b64 v[48:49], v226 offset:8192
    v_lshlrev_b32 v82, 16, v37
    v_dot2_f32_bf16 v223, v37, v37, v223
    s_add_u32 s36, s36, 4096
    buffer_load_dwordx4 a[80:83], v8, s[28:31], s36 offen offset:0
    v_and_b32 v83, 0xffff0000, v37
    v_dot2_f32_bf16 v222, v38, v224, v222
    ds_read_b64 v[50:51], v226 offset:8320
    v_lshlrev_b32 v84, 16, v38
    v_dot2_f32_bf16 v223, v38, v38, v223
    v_and_b32 v85, 0xffff0000, v38
    v_dot2_f32_bf16 v222, v39, v224, v222
    v_lshlrev_b32 v86, 16, v39
    v_dot2_f32_bf16 v223, v39, v39, v223
    v_and_b32 v87, 0xffff0000, v39
    s_waitcnt lgkmcnt(4)
    v_dot2_f32_bf16 v220, v40, v224, v220
    v_lshlrev_b32 v88, 16, v40
    v_dot2_f32_bf16 v221, v40, v40, v221
    v_and_b32 v89, 0xffff0000, v40
    buffer_load_dwordx4 a[84:87], v8, s[28:31], s36 offen offset:1024
    v_dot2_f32_bf16 v220, v41, v224, v220
    ds_read_b64 v[52:53], v12 offset:8192
    v_lshlrev_b32 v90, 16, v41
    v_dot2_f32_bf16 v221, v41, v41, v221
    v_and_b32 v91, 0xffff0000, v41
    v_dot2_f32_bf16 v220, v42, v224, v220
    ds_read_b64 v[54:55], v12 offset:8320
    v_lshlrev_b32 v92, 16, v42
    v_dot2_f32_bf16 v221, v42, v42, v221
    v_and_b32 v93, 0xffff0000, v42
    v_dot2_f32_bf16 v220, v43, v224, v220
    v_lshlrev_b32 v94, 16, v43
    v_dot2_f32_bf16 v221, v43, v43, v221
    buffer_load_dwordx4 a[88:91], v8, s[28:31], s36 offen offset:2048
    v_and_b32 v95, 0xffff0000, v43
    s_waitcnt lgkmcnt(4)
    v_dot2_f32_bf16 v222, v44, v224, v222
    v_lshlrev_b32 v96, 16, v44
    v_dot2_f32_bf16 v223, v44, v44, v223
    v_and_b32 v97, 0xffff0000, v44
    v_dot2_f32_bf16 v222, v45, v224, v222
    ds_read_b64 v[56:57], v226 offset:12288
    v_lshlrev_b32 v98, 16, v45
    v_dot2_f32_bf16 v223, v45, v45, v223
    v_and_b32 v99, 0xffff0000, v45
    v_dot2_f32_bf16 v222, v46, v224, v222
    ds_read_b64 v[58:59], v226 offset:12416
    buffer_load_dwordx4 a[92:95], v8, s[28:31], s36 offen offset:3072
    v_lshlrev_b32 v100, 16, v46
    v_dot2_f32_bf16 v223, v46, v46, v223
    v_and_b32 v101, 0xffff0000, v46
    v_dot2_f32_bf16 v222, v47, v224, v222
    v_lshlrev_b32 v102, 16, v47
    v_dot2_f32_bf16 v223, v47, v47, v223
    v_and_b32 v103, 0xffff0000, v47
    s_waitcnt lgkmcnt(4)
    v_dot2_f32_bf16 v220, v48, v224, v220
    v_lshlrev_b32 v104, 16, v48
    v_dot2_f32_bf16 v221, v48, v48, v221
    v_and_b32 v105, 0xffff0000, v48
    v_dot2_f32_bf16 v220, v49, v224, v220
    ds_read_b64 v[60:61], v12 offset:12288
    v_lshlrev_b32 v106, 16, v49
    s_add_u32 s36, s36, 4096
    buffer_load_dwordx4 a[96:99], v8, s[28:31], s36 offen offset:0
    v_dot2_f32_bf16 v221, v49, v49, v221
    v_and_b32 v107, 0xffff0000, v49
    v_dot2_f32_bf16 v220, v50, v224, v220
    ds_read_b64 v[62:63], v12 offset:12416
    v_lshlrev_b32 v108, 16, v50
    v_dot2_f32_bf16 v221, v50, v50, v221
    v_and_b32 v109, 0xffff0000, v50
    v_dot2_f32_bf16 v220, v51, v224, v220
    v_lshlrev_b32 v110, 16, v51
    v_dot2_f32_bf16 v221, v51, v51, v221
    v_and_b32 v111, 0xffff0000, v51
    s_waitcnt lgkmcnt(4)
    v_dot2_f32_bf16 v222, v52, v224, v222
    v_lshlrev_b32 v112, 16, v52
    v_dot2_f32_bf16 v223, v52, v52, v223
    buffer_load_dwordx4 a[100:103], v8, s[28:31], s36 offen offset:1024
    v_and_b32 v113, 0xffff0000, v52
    v_dot2_f32_bf16 v222, v53, v224, v222
    ds_read_b64 v[64:65], v226 offset:16384
    v_lshlrev_b32 v114, 16, v53
    v_dot2_f32_bf16 v223, v53, v53, v223
    v_and_b32 v115, 0xffff0000, v53
    v_dot2_f32_bf16 v222, v54, v224, v222
    ds_read_b64 v[66:67], v226 offset:16512
    v_lshlrev_b32 v116, 16, v54
    v_dot2_f32_bf16 v223, v54, v54, v223
    v_and_b32 v117, 0xffff0000, v54
    v_dot2_f32_bf16 v222, v55, v224, v222
    v_lshlrev_b32 v118, 16, v55
    buffer_load_dwordx4 a[104:107], v8, s[28:31], s36 offen offset:2048
    v_dot2_f32_bf16 v223, v55, v55, v223
    v_and_b32 v119, 0xffff0000, v55
    s_waitcnt lgkmcnt(4)
    v_dot2_f32_bf16 v220, v56, v224, v220
    v_lshlrev_b32 v120, 16, v56
    v_dot2_f32_bf16 v221, v56, v56, v221
    v_and_b32 v121, 0xffff0000, v56
    v_dot2_f32_bf16 v220, v57, v224, v220
    ds_read_b64 v[68:69], v12 offset:16384
    v_lshlrev_b32 v122, 16, v57
    v_dot2_f32_bf16 v221, v57, v57, v221
    v_and_b32 v123, 0xffff0000, v57
    v_dot2_f32_bf16 v220, v58, v224, v220
    ds_read_b64 v[70:71], v12 offset:16512
    buffer_load_dwordx4 a[108:111], v8, s[28:31], s36 offen offset:3072
    v_lshlrev_b32 v124, 16, v58
    v_dot2_f32_bf16 v221, v58, v58, v221
    v_and_b32 v125, 0xffff0000, v58
    v_dot2_f32_bf16 v220, v59, v224, v220
    v_lshlrev_b32 v126, 16, v59
    v_dot2_f32_bf16 v221, v59, v59, v221
    v_and_b32 v127, 0xffff0000, v59
    s_waitcnt lgkmcnt(4)
    v_dot2_f32_bf16 v222, v60, v224, v222
    v_lshlrev_b32 v128, 16, v60
    v_dot2_f32_bf16 v223, v60, v60, v223
    v_and_b32 v129, 0xffff0000, v60
    v_dot2_f32_bf16 v222, v61, v224, v222
    v_lshlrev_b32 v130, 16, v61
    v_dot2_f32_bf16 v223, v61, v61, v223
    v_and_b32 v131, 0xffff0000, v61
    v_dot2_f32_bf16 v222, v62, v224, v222
    s_add_u32 s36, s36, 4096
    buffer_load_dwordx4 a[112:115], v8, s[28:31], s36 offen offset:0
    v_lshlrev_b32 v132, 16, v62
    v_dot2_f32_bf16 v223, v62, v62, v223
    v_and_b32 v133, 0xffff0000, v62
    v_dot2_f32_bf16 v222, v63, v224, v222
    v_lshlrev_b32 v134, 16, v63
    v_dot2_f32_bf16 v223, v63, v63, v223
    v_and_b32 v135, 0xffff0000, v63
    s_waitcnt lgkmcnt(2)
    v_dot2_f32_bf16 v220, v64, v224, v220
    v_lshlrev_b32 v136, 16, v64
    v_dot2_f32_bf16 v221, v64, v64, v221
    v_and_b32 v137, 0xffff0000, v64
    v_dot2_f32_bf16 v220, v65, v224, v220
    v_lshlrev_b32 v138, 16, v65
    v_dot2_f32_bf16 v221, v65, v65, v221
    v_and_b32 v139, 0xffff0000, v65
    v_dot2_f32_bf16 v220, v66, v224, v220
    buffer_load_dwordx4 a[116:119], v8, s[28:31], s36 offen offset:1024
    v_lshlrev_b32 v140, 16, v66
    v_dot2_f32_bf16 v221, v66, v66, v221
    v_and_b32 v141, 0xffff0000, v66
    v_dot2_f32_bf16 v220, v67, v224, v220
    v_lshlrev_b32 v142, 16, v67
    v_dot2_f32_bf16 v221, v67, v67, v221
    v_and_b32 v143, 0xffff0000, v67
    s_waitcnt lgkmcnt(0)
    v_dot2_f32_bf16 v222, v68, v224, v222
    v_lshlrev_b32 v144, 16, v68
    v_dot2_f32_bf16 v223, v68, v68, v223
    v_and_b32 v145, 0xffff0000, v68
    v_dot2_f32_bf16 v222, v69, v224, v222
    v_lshlrev_b32 v146, 16, v69
    v_dot2_f32_bf16 v223, v69, v69, v223
    v_and_b32 v147, 0xffff0000, v69
    v_dot2_f32_bf16 v222, v70, v224, v222
    buffer_load_dwordx4 a[120:123], v8, s[28:31], s36 offen offset:2048
    v_lshlrev_b32 v148, 16, v70
    v_dot2_f32_bf16 v223, v70, v70, v223
    v_and_b32 v149, 0xffff0000, v70
    v_dot2_f32_bf16 v222, v71, v224, v222
    v_lshlrev_b32 v150, 16, v71
    v_dot2_f32_bf16 v223, v71, v71, v223
    v_and_b32 v151, 0xffff0000, v71
    s_nop 2
    s_nop 1
    v_add_f32_dpp v220, v220, v220 quad_perm:[1,0,3,2] row_mask:0xf bank_mask:0xf
    v_add_f32_dpp v221, v221, v221 quad_perm:[1,0,3,2] row_mask:0xf bank_mask:0xf
    v_add_f32_dpp v222, v222, v222 quad_perm:[1,0,3,2] row_mask:0xf bank_mask:0xf
    v_add_f32_dpp v223, v223, v223 quad_perm:[1,0,3,2] row_mask:0xf bank_mask:0xf
    v_add_f32_dpp v220, v220, v220 quad_perm:[2,3,0,1] row_mask:0xf bank_mask:0xf
    v_add_f32_dpp v221, v221, v221 quad_perm:[2,3,0,1] row_mask:0xf bank_mask:0xf
    v_add_f32_dpp v222, v222, v222 quad_perm:[2,3,0,1] row_mask:0xf bank_mask:0xf
    v_add_f32_dpp v223, v223, v223 quad_perm:[2,3,0,1] row_mask:0xf bank_mask:0xf
    buffer_load_dwordx4 a[124:127], v8, s[28:31], s36 offen offset:3072
    v_add_f32_dpp v220, v220, v220 row_half_mirror row_mask:0xf bank_mask:0xf
    v_add_f32_dpp v221, v221, v221 row_half_mirror row_mask:0xf bank_mask:0xf
    v_add_f32_dpp v222, v222, v222 row_half_mirror row_mask:0xf bank_mask:0xf
    v_add_f32_dpp v223, v223, v223 row_half_mirror row_mask:0xf bank_mask:0xf
    v_add_f32_dpp v220, v220, v220 row_mirror row_mask:0xf bank_mask:0xf
    v_add_f32_dpp v221, v221, v221 row_mirror row_mask:0xf bank_mask:0xf
    v_add_f32_dpp v222, v222, v222 row_mirror row_mask:0xf bank_mask:0xf
    v_add_f32_dpp v223, v223, v223 row_mirror row_mask:0xf bank_mask:0xf
    v_mul_f32 v220, 0x3acccccd, v220
    v_mul_f32 v222, 0x3acccccd, v222
    v_mul_f32 v221, 0x3acccccd, v221
    v_mul_f32 v223, 0x3acccccd, v223
    v_fma_f32 v221, -v220, v220, v221
    v_fma_f32 v223, -v222, v222, v223
    v_max_f32 v221, 0, v221
    v_max_f32 v223, 0, v223
    v_cvt_pk_bf16_f32 v192, v220, v221
    s_add_u32 s36, s36, 4096
    buffer_load_dwordx4 a[128:131], v8, s[28:31], s36 offen offset:0
    v_cvt_pk_bf16_f32 v193, v222, v223
    v_lshlrev_b32 v220, 16, v192
    v_lshlrev_b32 v222, 16, v193
    v_and_b32 v221, 0xffff0000, v192
    v_and_b32 v223, 0xffff0000, v193
    v_add_f32 v221, 0x3727c5ac, v221
    v_add_f32 v223, 0x3727c5ac, v223
    v_cvt_pk_bf16_f32 v192, v221, v221
    v_cvt_pk_bf16_f32 v193, v223, v223
    v_lshlrev_b32 v221, 16, v192
    v_lshlrev_b32 v223, 16, v193
    v_sqrt_f32 v221, v221
    v_sqrt_f32 v223, v223
    s_nop 0
    s_nop 0
    v_cvt_pk_bf16_f32 v192, v221, v221
    buffer_load_dwordx4 a[132:135], v8, s[28:31], s36 offen offset:1024
    v_cvt_pk_bf16_f32 v193, v223, v223
    v_lshlrev_b32 v221, 16, v192
    v_lshlrev_b32 v223, 16, v193
    v_rcp_f32 v221, v221
    v_rcp_f32 v223, v223
    s_nop 0
    s_nop 0
    v_mul_f32 v220, v220, v221
    v_mul_f32 v222, v222, v223
    v_sub_f32 v220, 0, v220
    v_sub_f32 v222, 0, v222
    v_mov_b32 v216, 0
    v_mov_b32 v217, 0
    v_mov_b32 v218, 0
    v_mov_b32 v219, 0
    buffer_load_dwordx4 a[136:139], v8, s[28:31], s36 offen offset:2048
    v_xor_b32 v12, 64, v228
    ds_read_b128 v[152:155], v227 offset:10240
    ds_read_b128 v[156:159], v227 offset:10256
    ds_read_b128 v[160:163], v227 offset:7680
    ds_read_b128 v[164:167], v227 offset:7696
    s_waitcnt lgkmcnt(0)
    v_pk_fma_f32 v[72:73], v[72:73], v[220:221], v[220:221] op_sel:[0,1,0] op_sel_hi:[1,1,0]
    v_pk_fma_f32 v[74:75], v[74:75], v[220:221], v[220:221] op_sel:[0,1,0] op_sel_hi:[1,1,0]
    v_pk_fma_f32 v[76:77], v[76:77], v[220:221], v[220:221] op_sel:[0,1,0] op_sel_hi:[1,1,0]
    buffer_load_dwordx4 a[140:143], v8, s[28:31], s36 offen offset:3072
    ds_read_b128 v[168:171], v227 offset:10752
    v_pk_fma_f32 v[78:79], v[78:79], v[220:221], v[220:221] op_sel:[0,1,0] op_sel_hi:[1,1,0]
    v_pk_fma_f32 v[72:73], v[72:73], v[152:153], v[160:161]
    v_pk_fma_f32 v[74:75], v[74:75], v[154:155], v[162:163]
    ds_read_b128 v[172:175], v227 offset:10768
    v_pk_fma_f32 v[76:77], v[76:77], v[156:157], v[164:165]
    v_pk_fma_f32 v[78:79], v[78:79], v[158:159], v[166:167]
    v_cvt_pk_bf16_f32 v32, v72, v73
    ds_read_b128 v[176:179], v227 offset:8192
    v_cvt_pk_bf16_f32 v33, v74, v75
    v_cvt_pk_bf16_f32 v34, v76, v77
    s_add_u32 s36, s36, 4096
    buffer_load_dwordx4 a[144:147], v8, s[28:31], s36 offen offset:0
    v_cvt_pk_bf16_f32 v35, v78, v79
    ds_read_b128 v[180:183], v227 offset:8208
    v_dot2_f32_bf16 v216, v32, v224, v216
    v_dot2_f32_bf16 v217, v32, v32, v217
    v_dot2_f32_bf16 v216, v33, v224, v216
    v_dot2_f32_bf16 v217, v33, v33, v217
    v_dot2_f32_bf16 v216, v34, v224, v216
    v_dot2_f32_bf16 v217, v34, v34, v217
    v_dot2_f32_bf16 v216, v35, v224, v216
    v_dot2_f32_bf16 v217, v35, v35, v217
    ds_write_b128 v228, v[32:35] offset:0
    buffer_load_dwordx4 a[148:151], v8, s[28:31], s36 offen offset:1024
    v_pk_fma_f32 v[80:81], v[80:81], v[222:223], v[222:223] op_sel:[0,1,0] op_sel_hi:[1,1,0]
    v_pk_fma_f32 v[82:83], v[82:83], v[222:223], v[222:223] op_sel:[0,1,0] op_sel_hi:[1,1,0]
    v_pk_fma_f32 v[84:85], v[84:85], v[222:223], v[222:223] op_sel:[0,1,0] op_sel_hi:[1,1,0]
    v_pk_fma_f32 v[86:87], v[86:87], v[222:223], v[222:223] op_sel:[0,1,0] op_sel_hi:[1,1,0]
    v_pk_fma_f32 v[80:81], v[80:81], v[152:153], v[160:161]
    v_pk_fma_f32 v[82:83], v[82:83], v[154:155], v[162:163]
    v_pk_fma_f32 v[84:85], v[84:85], v[156:157], v[164:165]
    v_pk_fma_f32 v[86:87], v[86:87], v[158:159], v[166:167]
    v_cvt_pk_bf16_f32 v36, v80, v81
    v_cvt_pk_bf16_f32 v37, v82, v83
    v_cvt_pk_bf16_f32 v38, v84, v85
    v_cvt_pk_bf16_f32 v39, v86, v87
    v_dot2_f32_bf16 v218, v36, v224, v218
    v_dot2_f32_bf16 v219, v36, v36, v219
    v_dot2_f32_bf16 v218, v37, v224, v218
    v_dot2_f32_bf16 v219, v37, v37, v219
    v_dot2_f32_bf16 v218, v38, v224, v218
    buffer_load_dwordx4 a[152:155], v8, s[28:31], s36 offen offset:2048
    v_dot2_f32_bf16 v219, v38, v38, v219
    v_dot2_f32_bf16 v218, v39, v224, v218
    v_dot2_f32_bf16 v219, v39, v39, v219
    ds_write_b128 v12, v[36:39] offset:0
    s_waitcnt lgkmcnt(1)
    v_pk_fma_f32 v[88:89], v[88:89], v[220:221], v[220:221] op_sel:[0,1,0] op_sel_hi:[1,1,0]
    v_pk_fma_f32 v[90:91], v[90:91], v[220:221], v[220:221] op_sel:[0,1,0] op_sel_hi:[1,1,0]
    v_pk_fma_f32 v[92:93], v[92:93], v[220:221], v[220:221] op_sel:[0,1,0] op_sel_hi:[1,1,0]
    ds_read_b128 v[152:155], v227 offset:11264
    buffer_load_dwordx4 a[156:159], v8, s[28:31], s36 offen offset:3072
    v_pk_fma_f32 v[94:95], v[94:95], v[220:221], v[220:221] op_sel:[0,1,0] op_sel_hi:[1,1,0]
    v_pk_fma_f32 v[88:89], v[88:89], v[168:169], v[176:177]
    v_pk_fma_f32 v[90:91], v[90:91], v[170:171], v[178:179]
    ds_read_b128 v[156:159], v227 offset:11280
    v_pk_fma_f32 v[92:93], v[92:93], v[172:173], v[180:181]
    v_pk_fma_f32 v[94:95], v[94:95], v[174:175], v[182:183]
    v_cvt_pk_bf16_f32 v40, v88, v89
    ds_read_b128 v[160:163], v227 offset:8704
    v_cvt_pk_bf16_f32 v41, v90, v91
    v_cvt_pk_bf16_f32 v42, v92, v93
    v_cvt_pk_bf16_f32 v43, v94, v95
    ds_read_b128 v[164:167], v227 offset:8720
    s_add_u32 s36, s36, 4096
    buffer_load_dwordx4 a[160:163], v8, s[28:31], s36 offen offset:0
    v_dot2_f32_bf16 v216, v40, v224, v216
    v_dot2_f32_bf16 v217, v40, v40, v217
    v_dot2_f32_bf16 v216, v41, v224, v216
    v_dot2_f32_bf16 v217, v41, v41, v217
    v_dot2_f32_bf16 v216, v42, v224, v216
    v_dot2_f32_bf16 v217, v42, v42, v217
    v_dot2_f32_bf16 v216, v43, v224, v216
    v_dot2_f32_bf16 v217, v43, v43, v217
    ds_write_b128 v228, v[40:43] offset:4096
    v_pk_fma_f32 v[96:97], v[96:97], v[222:223], v[222:223] op_sel:[0,1,0] op_sel_hi:[1,1,0]
    buffer_load_dwordx4 a[164:167], v8, s[28:31], s36 offen offset:1024
    v_pk_fma_f32 v[98:99], v[98:99], v[222:223], v[222:223] op_sel:[0,1,0] op_sel_hi:[1,1,0]
    v_pk_fma_f32 v[100:101], v[100:101], v[222:223], v[222:223] op_sel:[0,1,0] op_sel_hi:[1,1,0]
    v_pk_fma_f32 v[102:103], v[102:103], v[222:223], v[222:223] op_sel:[0,1,0] op_sel_hi:[1,1,0]
    v_pk_fma_f32 v[96:97], v[96:97], v[168:169], v[176:177]
    v_pk_fma_f32 v[98:99], v[98:99], v[170:171], v[178:179]
    v_pk_fma_f32 v[100:101], v[100:101], v[172:173], v[180:181]
    v_pk_fma_f32 v[102:103], v[102:103], v[174:175], v[182:183]
    v_cvt_pk_bf16_f32 v44, v96, v97
    v_cvt_pk_bf16_f32 v45, v98, v99
    v_cvt_pk_bf16_f32 v46, v100, v101
    v_cvt_pk_bf16_f32 v47, v102, v103
    v_dot2_f32_bf16 v218, v44, v224, v218
    v_dot2_f32_bf16 v219, v44, v44, v219
    v_dot2_f32_bf16 v218, v45, v224, v218
    v_dot2_f32_bf16 v219, v45, v45, v219
    v_dot2_f32_bf16 v218, v46, v224, v218
    v_dot2_f32_bf16 v219, v46, v46, v219
    buffer_load_dwordx4 a[168:171], v8, s[28:31], s36 offen offset:2048
    v_dot2_f32_bf16 v218, v47, v224, v218
    v_dot2_f32_bf16 v219, v47, v47, v219
    ds_write_b128 v12, v[44:47] offset:4096
    s_waitcnt lgkmcnt(1)
    v_pk_fma_f32 v[104:105], v[104:105], v[220:221], v[220:221] op_sel:[0,1,0] op_sel_hi:[1,1,0]
    v_pk_fma_f32 v[106:107], v[106:107], v[220:221], v[220:221] op_sel:[0,1,0] op_sel_hi:[1,1,0]
    v_pk_fma_f32 v[108:109], v[108:109], v[220:221], v[220:221] op_sel:[0,1,0] op_sel_hi:[1,1,0]
    ds_read_b128 v[168:171], v227 offset:11776
    buffer_load_dwordx4 a[172:175], v8, s[28:31], s36 offen offset:3072
    v_pk_fma_f32 v[110:111], v[110:111], v[220:221], v[220:221] op_sel:[0,1,0] op_sel_hi:[1,1,0]
    v_pk_fma_f32 v[104:105], v[104:105], v[152:153], v[160:161]
    v_pk_fma_f32 v[106:107], v[106:107], v[154:155], v[162:163]
    ds_read_b128 v[172:175], v227 offset:11792
    v_pk_fma_f32 v[108:109], v[108:109], v[156:157], v[164:165]
    v_pk_fma_f32 v[110:111], v[110:111], v[158:159], v[166:167]
    v_cvt_pk_bf16_f32 v48, v104, v105
    ds_read_b128 v[176:179], v227 offset:9216
    v_cvt_pk_bf16_f32 v49, v106, v107
    v_cvt_pk_bf16_f32 v50, v108, v109
    v_cvt_pk_bf16_f32 v51, v110, v111
    ds_read_b128 v[180:183], v227 offset:9232
    s_add_u32 s36, s36, 4096
    buffer_load_dwordx4 a[176:179], v8, s[28:31], s36 offen offset:0
    v_dot2_f32_bf16 v216, v48, v224, v216
    v_dot2_f32_bf16 v217, v48, v48, v217
    v_dot2_f32_bf16 v216, v49, v224, v216
    v_dot2_f32_bf16 v217, v49, v49, v217
    v_dot2_f32_bf16 v216, v50, v224, v216
    v_dot2_f32_bf16 v217, v50, v50, v217
    v_dot2_f32_bf16 v216, v51, v224, v216
    v_dot2_f32_bf16 v217, v51, v51, v217
    ds_write_b128 v228, v[48:51] offset:8192
    v_pk_fma_f32 v[112:113], v[112:113], v[222:223], v[222:223] op_sel:[0,1,0] op_sel_hi:[1,1,0]
    buffer_load_dwordx4 a[180:183], v8, s[28:31], s36 offen offset:1024
    v_pk_fma_f32 v[114:115], v[114:115], v[222:223], v[222:223] op_sel:[0,1,0] op_sel_hi:[1,1,0]
    v_pk_fma_f32 v[116:117], v[116:117], v[222:223], v[222:223] op_sel:[0,1,0] op_sel_hi:[1,1,0]
    v_pk_fma_f32 v[118:119], v[118:119], v[222:223], v[222:223] op_sel:[0,1,0] op_sel_hi:[1,1,0]
    v_pk_fma_f32 v[112:113], v[112:113], v[152:153], v[160:161]
    v_pk_fma_f32 v[114:115], v[114:115], v[154:155], v[162:163]
    v_pk_fma_f32 v[116:117], v[116:117], v[156:157], v[164:165]
    v_pk_fma_f32 v[118:119], v[118:119], v[158:159], v[166:167]
    v_cvt_pk_bf16_f32 v52, v112, v113
    v_cvt_pk_bf16_f32 v53, v114, v115
    v_cvt_pk_bf16_f32 v54, v116, v117
    v_cvt_pk_bf16_f32 v55, v118, v119
    v_dot2_f32_bf16 v218, v52, v224, v218
    v_dot2_f32_bf16 v219, v52, v52, v219
    v_dot2_f32_bf16 v218, v53, v224, v218
    v_dot2_f32_bf16 v219, v53, v53, v219
    v_dot2_f32_bf16 v218, v54, v224, v218
    v_dot2_f32_bf16 v219, v54, v54, v219
    buffer_load_dwordx4 a[184:187], v8, s[28:31], s36 offen offset:2048
    v_dot2_f32_bf16 v218, v55, v224, v218
    v_dot2_f32_bf16 v219, v55, v55, v219
    ds_write_b128 v12, v[52:55] offset:8192
    s_waitcnt lgkmcnt(1)
    v_pk_fma_f32 v[120:121], v[120:121], v[220:221], v[220:221] op_sel:[0,1,0] op_sel_hi:[1,1,0]
    v_pk_fma_f32 v[122:123], v[122:123], v[220:221], v[220:221] op_sel:[0,1,0] op_sel_hi:[1,1,0]
    v_pk_fma_f32 v[124:125], v[124:125], v[220:221], v[220:221] op_sel:[0,1,0] op_sel_hi:[1,1,0]
    ds_read_b128 v[152:155], v227 offset:12288
    buffer_load_dwordx4 a[188:191], v8, s[28:31], s36 offen offset:3072
    v_pk_fma_f32 v[126:127], v[126:127], v[220:221], v[220:221] op_sel:[0,1,0] op_sel_hi:[1,1,0]
    v_pk_fma_f32 v[120:121], v[120:121], v[168:169], v[176:177]
    v_pk_fma_f32 v[122:123], v[122:123], v[170:171], v[178:179]
    ds_read_b128 v[156:159], v227 offset:12304
    v_pk_fma_f32 v[124:125], v[124:125], v[172:173], v[180:181]
    v_pk_fma_f32 v[126:127], v[126:127], v[174:175], v[182:183]
    v_cvt_pk_bf16_f32 v56, v120, v121
    ds_read_b128 v[160:163], v227 offset:9728
    v_cvt_pk_bf16_f32 v57, v122, v123
    v_cvt_pk_bf16_f32 v58, v124, v125
    v_cvt_pk_bf16_f32 v59, v126, v127
    ds_read_b128 v[164:167], v227 offset:9744
    s_add_u32 s36, s36, 4096
    buffer_load_dwordx4 a[192:195], v8, s[28:31], s36 offen offset:0
    v_dot2_f32_bf16 v216, v56, v224, v216
    v_dot2_f32_bf16 v217, v56, v56, v217
    v_dot2_f32_bf16 v216, v57, v224, v216
    v_dot2_f32_bf16 v217, v57, v57, v217
    v_dot2_f32_bf16 v216, v58, v224, v216
    v_dot2_f32_bf16 v217, v58, v58, v217
    v_dot2_f32_bf16 v216, v59, v224, v216
    v_dot2_f32_bf16 v217, v59, v59, v217
    ds_write_b128 v228, v[56:59] offset:12288
    v_pk_fma_f32 v[128:129], v[128:129], v[222:223], v[222:223] op_sel:[0,1,0] op_sel_hi:[1,1,0]
    buffer_load_dwordx4 a[196:199], v8, s[28:31], s36 offen offset:1024
    v_pk_fma_f32 v[130:131], v[130:131], v[222:223], v[222:223] op_sel:[0,1,0] op_sel_hi:[1,1,0]
    v_pk_fma_f32 v[132:133], v[132:133], v[222:223], v[222:223] op_sel:[0,1,0] op_sel_hi:[1,1,0]
    v_pk_fma_f32 v[134:135], v[134:135], v[222:223], v[222:223] op_sel:[0,1,0] op_sel_hi:[1,1,0]
    v_pk_fma_f32 v[128:129], v[128:129], v[168:169], v[176:177]
    v_pk_fma_f32 v[130:131], v[130:131], v[170:171], v[178:179]
    v_pk_fma_f32 v[132:133], v[132:133], v[172:173], v[180:181]
    v_pk_fma_f32 v[134:135], v[134:135], v[174:175], v[182:183]
    v_cvt_pk_bf16_f32 v60, v128, v129
    v_cvt_pk_bf16_f32 v61, v130, v131
    v_cvt_pk_bf16_f32 v62, v132, v133
    v_cvt_pk_bf16_f32 v63, v134, v135
    v_dot2_f32_bf16 v218, v60, v224, v218
    v_dot2_f32_bf16 v219, v60, v60, v219
    v_dot2_f32_bf16 v218, v61, v224, v218
    v_dot2_f32_bf16 v219, v61, v61, v219
    v_dot2_f32_bf16 v218, v62, v224, v218
    v_dot2_f32_bf16 v219, v62, v62, v219
    buffer_load_dwordx4 a[200:203], v8, s[28:31], s37 offen offset:0
    v_dot2_f32_bf16 v218, v63, v224, v218
    v_dot2_f32_bf16 v219, v63, v63, v219
    ds_write_b128 v12, v[60:63] offset:12288
    s_waitcnt lgkmcnt(1)
    v_pk_fma_f32 v[136:137], v[136:137], v[220:221], v[220:221] op_sel:[0,1,0] op_sel_hi:[1,1,0]
    v_pk_fma_f32 v[138:139], v[138:139], v[220:221], v[220:221] op_sel:[0,1,0] op_sel_hi:[1,1,0]
    v_pk_fma_f32 v[140:141], v[140:141], v[220:221], v[220:221] op_sel:[0,1,0] op_sel_hi:[1,1,0]
    v_pk_fma_f32 v[142:143], v[142:143], v[220:221], v[220:221] op_sel:[0,1,0] op_sel_hi:[1,1,0]
    v_pk_fma_f32 v[136:137], v[136:137], v[152:153], v[160:161]
    v_pk_fma_f32 v[138:139], v[138:139], v[154:155], v[162:163]
    buffer_load_dwordx4 a[204:207], v8, s[28:31], s37 offen offset:1024
    v_pk_fma_f32 v[140:141], v[140:141], v[156:157], v[164:165]
    v_pk_fma_f32 v[142:143], v[142:143], v[158:159], v[166:167]
    v_cvt_pk_bf16_f32 v64, v136, v137
    v_cvt_pk_bf16_f32 v65, v138, v139
    v_cvt_pk_bf16_f32 v66, v140, v141
    v_cvt_pk_bf16_f32 v67, v142, v143
    v_dot2_f32_bf16 v216, v64, v224, v216
    v_dot2_f32_bf16 v217, v64, v64, v217
    v_dot2_f32_bf16 v216, v65, v224, v216
    v_dot2_f32_bf16 v217, v65, v65, v217
    v_dot2_f32_bf16 v216, v66, v224, v216
    v_dot2_f32_bf16 v217, v66, v66, v217
    v_dot2_f32_bf16 v216, v67, v224, v216
    v_dot2_f32_bf16 v217, v67, v67, v217
    ds_write_b128 v228, v[64:67] offset:16384
    buffer_load_dwordx4 a[208:211], v8, s[28:31], s37 offen offset:2048
    v_pk_fma_f32 v[144:145], v[144:145], v[222:223], v[222:223] op_sel:[0,1,0] op_sel_hi:[1,1,0]
    v_pk_fma_f32 v[146:147], v[146:147], v[222:223], v[222:223] op_sel:[0,1,0] op_sel_hi:[1,1,0]
    v_pk_fma_f32 v[148:149], v[148:149], v[222:223], v[222:223] op_sel:[0,1,0] op_sel_hi:[1,1,0]
    v_pk_fma_f32 v[150:151], v[150:151], v[222:223], v[222:223] op_sel:[0,1,0] op_sel_hi:[1,1,0]
    v_pk_fma_f32 v[144:145], v[144:145], v[152:153], v[160:161]
    v_pk_fma_f32 v[146:147], v[146:147], v[154:155], v[162:163]
    v_pk_fma_f32 v[148:149], v[148:149], v[156:157], v[164:165]
    v_pk_fma_f32 v[150:151], v[150:151], v[158:159], v[166:167]
    v_cvt_pk_bf16_f32 v68, v144, v145
    v_cvt_pk_bf16_f32 v69, v146, v147
    v_cvt_pk_bf16_f32 v70, v148, v149
    v_cvt_pk_bf16_f32 v71, v150, v151
    v_dot2_f32_bf16 v218, v68, v224, v218
    v_dot2_f32_bf16 v219, v68, v68, v219
    v_dot2_f32_bf16 v218, v69, v224, v218
    v_dot2_f32_bf16 v219, v69, v69, v219
    v_dot2_f32_bf16 v218, v70, v224, v218
    buffer_load_dwordx4 a[212:215], v8, s[28:31], s37 offen offset:3072
    v_dot2_f32_bf16 v219, v70, v70, v219
    v_dot2_f32_bf16 v218, v71, v224, v218
    v_dot2_f32_bf16 v219, v71, v71, v219
    ds_write_b128 v12, v[68:71] offset:16384
    s_waitcnt lgkmcnt(0)
    s_barrier
    ds_read_b128 v[72:75], v229 offset:0
    ds_read_b128 v[76:79], v231 offset:0
    s_add_u32 s37, s37, 4096
    buffer_load_dwordx4 a[216:219], v8, s[28:31], s37 offen offset:0
    s_waitcnt vmcnt(50) lgkmcnt(0)
    v_mfma_f32_16x16x32_bf16 v[32:35], a[0:3], v[72:75], 0
    v_mfma_f32_16x16x32_bf16 v[52:55], a[0:3], v[76:79], 0
    ds_read_b128 v[80:83], v230 offset:1024
    v_mfma_f32_16x16x32_bf16 v[36:39], a[4:7], v[72:75], 0
    v_mfma_f32_16x16x32_bf16 v[56:59], a[4:7], v[76:79], 0
    buffer_load_dwordx4 a[220:223], v8, s[28:31], s37 offen offset:1024
    ds_read_b128 v[84:87], v232 offset:1024
    v_mfma_f32_16x16x32_bf16 v[40:43], a[8:11], v[72:75], 0
    v_mfma_f32_16x16x32_bf16 v[60:63], a[8:11], v[76:79], 0
    ds_read_b128 v[112:115], v233 offset:0
    v_mfma_f32_16x16x32_bf16 v[44:47], a[12:15], v[72:75], 0
    buffer_load_dwordx4 a[224:227], v8, s[28:31], s37 offen offset:2048
    v_mfma_f32_16x16x32_bf16 v[64:67], a[12:15], v[76:79], 0
    ds_read_b128 v[132:135], v233 offset:1024
    v_mfma_f32_16x16x32_bf16 v[48:51], a[16:19], v[72:75], 0
    v_mfma_f32_16x16x32_bf16 v[68:71], a[16:19], v[76:79], 0
    s_waitcnt vmcnt(47) lgkmcnt(0)
    v_mfma_f32_16x16x32_bf16 v[32:35], a[20:23], v[80:83], v[32:35]
    buffer_load_dwordx4 a[228:231], v8, s[28:31], s37 offen offset:3072
    v_add_f32_dpp v216, v216, v216 quad_perm:[1,0,3,2] row_mask:0xf bank_mask:0xf
    v_mfma_f32_16x16x32_bf16 v[52:55], a[20:23], v[84:87], v[52:55]
    ds_read_b128 v[72:75], v229 offset:2048
    v_mfma_f32_16x16x32_bf16 v[36:39], a[24:27], v[80:83], v[36:39]
    v_add_f32_dpp v217, v217, v217 quad_perm:[1,0,3,2] row_mask:0xf bank_mask:0xf
    v_mfma_f32_16x16x32_bf16 v[56:59], a[24:27], v[84:87], v[56:59]
    ds_read_b128 v[76:79], v231 offset:2048
    s_add_u32 s37, s37, 4096
    buffer_load_dwordx4 a[232:235], v8, s[28:31], s37 offen offset:0
    v_mfma_f32_16x16x32_bf16 v[40:43], a[28:31], v[80:83], v[40:43]
    v_add_f32_dpp v218, v218, v218 quad_perm:[1,0,3,2] row_mask:0xf bank_mask:0xf
    v_mfma_f32_16x16x32_bf16 v[60:63], a[28:31], v[84:87], v[60:63]
    ds_read_b128 v[116:119], v233 offset:64
    v_mfma_f32_16x16x32_bf16 v[44:47], a[32:35], v[80:83], v[44:47]
    v_add_f32_dpp v219, v219, v219 quad_perm:[1,0,3,2] row_mask:0xf bank_mask:0xf
    v_mfma_f32_16x16x32_bf16 v[64:67], a[32:35], v[84:87], v[64:67]
    buffer_load_dwordx4 a[236:239], v8, s[28:31], s37 offen offset:1024
    ds_read_b128 v[136:139], v233 offset:1088
    v_mfma_f32_16x16x32_bf16 v[48:51], a[36:39], v[80:83], v[48:51]
    v_add_f32_dpp v216, v216, v216 quad_perm:[2,3,0,1] row_mask:0xf bank_mask:0xf
    v_mfma_f32_16x16x32_bf16 v[68:71], a[36:39], v[84:87], v[68:71]
    v_add_f32_dpp v217, v217, v217 quad_perm:[2,3,0,1] row_mask:0xf bank_mask:0xf
    s_waitcnt vmcnt(45) lgkmcnt(0)
    v_mfma_f32_16x16x32_bf16 v[32:35], a[40:43], v[72:75], v[32:35]
    buffer_load_dwordx4 a[240:243], v8, s[28:31], s37 offen offset:2048
    v_add_f32_dpp v218, v218, v218 quad_perm:[2,3,0,1] row_mask:0xf bank_mask:0xf
    v_mfma_f32_16x16x32_bf16 v[52:55], a[40:43], v[76:79], v[52:55]
    ds_read_b128 v[80:83], v230 offset:3072
    v_mfma_f32_16x16x32_bf16 v[36:39], a[44:47], v[72:75], v[36:39]
    v_add_f32_dpp v219, v219, v219 quad_perm:[2,3,0,1] row_mask:0xf bank_mask:0xf
    v_mfma_f32_16x16x32_bf16 v[56:59], a[44:47], v[76:79], v[56:59]
    ds_read_b128 v[84:87], v232 offset:3072
    buffer_load_dwordx4 a[244:247], v8, s[28:31], s37 offen offset:3072
    v_mfma_f32_16x16x32_bf16 v[40:43], a[48:51], v[72:75], v[40:43]
    v_add_f32_dpp v216, v216, v216 row_half_mirror row_mask:0xf bank_mask:0xf
    v_mfma_f32_16x16x32_bf16 v[60:63], a[48:51], v[76:79], v[60:63]
    ds_read_b128 v[120:123], v233 offset:128
    v_mfma_f32_16x16x32_bf16 v[44:47], a[52:55], v[72:75], v[44:47]
    v_add_f32_dpp v217, v217, v217 row_half_mirror row_mask:0xf bank_mask:0xf
    v_mfma_f32_16x16x32_bf16 v[64:67], a[52:55], v[76:79], v[64:67]
    s_add_u32 s37, s37, 4096
    buffer_load_dwordx4 a[248:251], v8, s[28:31], s37 offen offset:0
    ds_read_b128 v[140:143], v233 offset:1152
    v_mfma_f32_16x16x32_bf16 v[48:51], a[56:59], v[72:75], v[48:51]
    v_add_f32_dpp v218, v218, v218 row_half_mirror row_mask:0xf bank_mask:0xf
    v_mfma_f32_16x16x32_bf16 v[68:71], a[56:59], v[76:79], v[68:71]
    v_add_f32_dpp v219, v219, v219 row_half_mirror row_mask:0xf bank_mask:0xf
    s_waitcnt vmcnt(43) lgkmcnt(0)
    v_mfma_f32_16x16x32_bf16 v[32:35], a[60:63], v[80:83], v[32:35]
    buffer_load_dwordx4 a[252:255], v8, s[28:31], s37 offen offset:1024
    v_add_f32_dpp v216, v216, v216 row_mirror row_mask:0xf bank_mask:0xf
    v_mfma_f32_16x16x32_bf16 v[52:55], a[60:63], v[84:87], v[52:55]
    ds_read_b128 v[72:75], v229 offset:4096
    v_mfma_f32_16x16x32_bf16 v[36:39], a[64:67], v[80:83], v[36:39]
    v_add_f32_dpp v217, v217, v217 row_mirror row_mask:0xf bank_mask:0xf
    v_mfma_f32_16x16x32_bf16 v[56:59], a[64:67], v[84:87], v[56:59]
    ds_read_b128 v[76:79], v231 offset:4096
    buffer_load_dwordx4 a[0:3], v8, s[28:31], s37 offen offset:2048
    v_mfma_f32_16x16x32_bf16 v[40:43], a[68:71], v[80:83], v[40:43]
    v_add_f32_dpp v218, v218, v218 row_mirror row_mask:0xf bank_mask:0xf
    v_mfma_f32_16x16x32_bf16 v[60:63], a[68:71], v[84:87], v[60:63]
    ds_read_b128 v[124:127], v233 offset:192
    v_mfma_f32_16x16x32_bf16 v[44:47], a[72:75], v[80:83], v[44:47]
    v_add_f32_dpp v219, v219, v219 row_mirror row_mask:0xf bank_mask:0xf
    v_mfma_f32_16x16x32_bf16 v[64:67], a[72:75], v[84:87], v[64:67]
    buffer_load_dwordx4 a[4:7], v8, s[28:31], s37 offen offset:3072
    ds_read_b128 v[144:147], v233 offset:1216
    v_mfma_f32_16x16x32_bf16 v[48:51], a[76:79], v[80:83], v[48:51]
    v_mul_f32 v216, 0x3acccccd, v216
    v_mfma_f32_16x16x32_bf16 v[68:71], a[76:79], v[84:87], v[68:71]
    v_mul_f32 v218, 0x3acccccd, v218
    s_waitcnt vmcnt(41) lgkmcnt(0)
    v_mfma_f32_16x16x32_bf16 v[32:35], a[80:83], v[72:75], v[32:35]
    s_add_u32 s37, s37, 4096
    buffer_load_dwordx4 a[8:11], v8, s[28:31], s37 offen offset:0
    v_mul_f32 v217, 0x3acccccd, v217
    v_mfma_f32_16x16x32_bf16 v[52:55], a[80:83], v[76:79], v[52:55]
    ds_read_b128 v[80:83], v230 offset:5120
    v_mfma_f32_16x16x32_bf16 v[36:39], a[84:87], v[72:75], v[36:39]
    v_mul_f32 v219, 0x3acccccd, v219
    v_mfma_f32_16x16x32_bf16 v[56:59], a[84:87], v[76:79], v[56:59]
    ds_read_b128 v[84:87], v232 offset:5120
    buffer_load_dwordx4 a[12:15], v8, s[28:31], s37 offen offset:1024
    v_mfma_f32_16x16x32_bf16 v[40:43], a[88:91], v[72:75], v[40:43]
    v_fma_f32 v217, -v216, v216, v217
    v_mfma_f32_16x16x32_bf16 v[60:63], a[88:91], v[76:79], v[60:63]
    ds_read_b128 v[128:131], v234
    v_mfma_f32_16x16x32_bf16 v[44:47], a[92:95], v[72:75], v[44:47]
    v_fma_f32 v219, -v218, v218, v219
    v_mfma_f32_16x16x32_bf16 v[64:67], a[92:95], v[76:79], v[64:67]
    buffer_load_dwordx4 a[16:19], v8, s[28:31], s37 offen offset:2048
    ds_read_b128 v[148:151], v234 offset:1024
    v_mfma_f32_16x16x32_bf16 v[48:51], a[96:99], v[72:75], v[48:51]
    v_max_f32 v217, 0, v217
    v_mfma_f32_16x16x32_bf16 v[68:71], a[96:99], v[76:79], v[68:71]
    v_max_f32 v219, 0, v219
    s_waitcnt vmcnt(39) lgkmcnt(0)
    v_mfma_f32_16x16x32_bf16 v[32:35], a[100:103], v[80:83], v[32:35]
    buffer_load_dwordx4 a[20:23], v8, s[28:31], s37 offen offset:3072
    v_cvt_pk_bf16_f32 v192, v216, v217
    v_mfma_f32_16x16x32_bf16 v[52:55], a[100:103], v[84:87], v[52:55]
    ds_read_b128 v[72:75], v229 offset:6144
    v_mfma_f32_16x16x32_bf16 v[36:39], a[104:107], v[80:83], v[36:39]
    v_cvt_pk_bf16_f32 v193, v218, v219
    v_mfma_f32_16x16x32_bf16 v[56:59], a[104:107], v[84:87], v[56:59]
    ds_read_b128 v[76:79], v231 offset:6144
    s_add_u32 s37, s37, 4096
    buffer_load_dwordx4 a[24:27], v8, s[28:31], s37 offen offset:0
    v_mfma_f32_16x16x32_bf16 v[40:43], a[108:111], v[80:83], v[40:43]
    v_lshlrev_b32 v216, 16, v192
    v_mfma_f32_16x16x32_bf16 v[60:63], a[108:111], v[84:87], v[60:63]
    ds_read_b64 v[16:17], v236
    v_mfma_f32_16x16x32_bf16 v[44:47], a[112:115], v[80:83], v[44:47]
    v_lshlrev_b32 v218, 16, v193
    v_mfma_f32_16x16x32_bf16 v[64:67], a[112:115], v[84:87], v[64:67]
    buffer_load_dwordx4 a[28:31], v8, s[28:31], s37 offen offset:1024
    ds_read_b64 v[18:19], v237
    v_mfma_f32_16x16x32_bf16 v[48:51], a[116:119], v[80:83], v[48:51]
    v_and_b32 v217, 0xffff0000, v192
    v_mfma_f32_16x16x32_bf16 v[68:71], a[116:119], v[84:87], v[68:71]
    v_and_b32 v219, 0xffff0000, v193
    s_waitcnt vmcnt(37) lgkmcnt(0)
    v_mfma_f32_16x16x32_bf16 v[32:35], a[120:123], v[72:75], v[32:35]
    buffer_load_dwordx4 a[32:35], v8, s[28:31], s37 offen offset:2048
    v_add_f32 v217, 0x3727c5ac, v217
    v_mfma_f32_16x16x32_bf16 v[52:55], a[120:123], v[76:79], v[52:55]
    ds_read_b128 v[80:83], v230 offset:7168
    v_mfma_f32_16x16x32_bf16 v[36:39], a[124:127], v[72:75], v[36:39]
    v_add_f32 v219, 0x3727c5ac, v219
    v_mfma_f32_16x16x32_bf16 v[56:59], a[124:127], v[76:79], v[56:59]
    ds_read_b128 v[84:87], v232 offset:7168
    buffer_load_dwordx4 a[36:39], v8, s[28:31], s37 offen offset:3072
    v_mfma_f32_16x16x32_bf16 v[40:43], a[128:131], v[72:75], v[40:43]
    v_cvt_pk_bf16_f32 v192, v217, v217
    v_mfma_f32_16x16x32_bf16 v[60:63], a[128:131], v[76:79], v[60:63]
    ds_read_b64 v[20:21], v238
    v_mfma_f32_16x16x32_bf16 v[44:47], a[132:135], v[72:75], v[44:47]
    v_cvt_pk_bf16_f32 v193, v219, v219
    v_mfma_f32_16x16x32_bf16 v[64:67], a[132:135], v[76:79], v[64:67]
    s_add_u32 s37, s37, 4096
    buffer_load_dwordx4 a[40:43], v8, s[28:31], s37 offen offset:0
    ds_read_b64 v[22:23], v239
    v_mfma_f32_16x16x32_bf16 v[48:51], a[136:139], v[72:75], v[48:51]
    v_lshlrev_b32 v217, 16, v192
    v_mfma_f32_16x16x32_bf16 v[68:71], a[136:139], v[76:79], v[68:71]
    v_lshlrev_b32 v219, 16, v193
    s_waitcnt vmcnt(35) lgkmcnt(0)
    v_mfma_f32_16x16x32_bf16 v[32:35], a[140:143], v[80:83], v[32:35]
    buffer_load_dwordx4 a[44:47], v8, s[28:31], s37 offen offset:1024
    v_sqrt_f32 v217, v217
    v_mfma_f32_16x16x32_bf16 v[52:55], a[140:143], v[84:87], v[52:55]
    ds_read_b128 v[72:75], v229 offset:8192
    v_mfma_f32_16x16x32_bf16 v[36:39], a[144:147], v[80:83], v[36:39]
    v_sqrt_f32 v219, v219
    v_mfma_f32_16x16x32_bf16 v[56:59], a[144:147], v[84:87], v[56:59]
    buffer_load_dwordx4 a[48:51], v8, s[28:31], s37 offen offset:2048
    ds_read_b128 v[76:79], v231 offset:8192
    v_mfma_f32_16x16x32_bf16 v[40:43], a[148:151], v[80:83], v[40:43]
    v_cvt_pk_bf16_f32 v192, v217, v217
    v_mfma_f32_16x16x32_bf16 v[60:63], a[148:151], v[84:87], v[60:63]
    ds_read_b64 v[24:25], v240
    v_mfma_f32_16x16x32_bf16 v[44:47], a[152:155], v[80:83], v[44:47]
    buffer_load_dwordx4 a[52:55], v8, s[28:31], s37 offen offset:3072
    v_cvt_pk_bf16_f32 v193, v219, v219
    v_mfma_f32_16x16x32_bf16 v[64:67], a[152:155], v[84:87], v[64:67]
    v_lshlrev_b32 v217, 16, v192
    v_mfma_f32_16x16x32_bf16 v[48:51], a[156:159], v[80:83], v[48:51]
    v_lshlrev_b32 v219, 16, v193
    v_mfma_f32_16x16x32_bf16 v[68:71], a[156:159], v[84:87], v[68:71]
    v_rcp_f32 v217, v217
    s_waitcnt vmcnt(33) lgkmcnt(0)
    s_add_u32 s37, s37, 4096
    buffer_load_dwordx4 a[56:59], v8, s[28:31], s37 offen offset:0
    v_mfma_f32_16x16x32_bf16 v[32:35], a[160:163], v[72:75], v[32:35]
    v_rcp_f32 v219, v219
    v_mfma_f32_16x16x32_bf16 v[52:55], a[160:163], v[76:79], v[52:55]
    ds_read_b128 v[80:83], v230 offset:9216
    v_mfma_f32_16x16x32_bf16 v[36:39], a[164:167], v[72:75], v[36:39]
    v_mul_f32 v216, v216, v217
    buffer_load_dwordx4 a[60:63], v8, s[28:31], s37 offen offset:1024
    v_mfma_f32_16x16x32_bf16 v[56:59], a[164:167], v[76:79], v[56:59]
    ds_read_b128 v[84:87], v232 offset:9216
    v_mfma_f32_16x16x32_bf16 v[40:43], a[168:171], v[72:75], v[40:43]
    v_mul_f32 v218, v218, v219
    v_mfma_f32_16x16x32_bf16 v[60:63], a[168:171], v[76:79], v[60:63]
    v_sub_f32 v216, 0, v216
    v_mfma_f32_16x16x32_bf16 v[44:47], a[172:175], v[72:75], v[44:47]
    buffer_load_dwordx4 a[64:67], v8, s[28:31], s37 offen offset:2048
    v_sub_f32 v218, 0, v218
    v_mfma_f32_16x16x32_bf16 v[64:67], a[172:175], v[76:79], v[64:67]
    s_lshl_b32 s26, s20, 6
    v_mfma_f32_16x16x32_bf16 v[48:51], a[176:179], v[72:75], v[48:51]
    v_lshl_add_u32 v2, v3, 3, s26
    v_mfma_f32_16x16x32_bf16 v[68:71], a[176:179], v[76:79], v[68:71]
    v_add_u32 v2, 138240, v2
    s_waitcnt vmcnt(31) lgkmcnt(0)
    v_mfma_f32_16x16x32_bf16 v[32:35], a[180:183], v[80:83], v[32:35]
    buffer_load_dwordx4 a[68:71], v8, s[28:31], s37 offen offset:3072
    ds_write_b64 v2, v[216:217]
    v_mfma_f32_16x16x32_bf16 v[52:55], a[180:183], v[84:87], v[52:55]
    ds_write_b64 v2, v[218:219] offset:32
    s_add_u32 s37, s37, 4096
    buffer_load_dwordx4 a[72:75], v8, s[28:31], s37 offen offset:0
    v_mfma_f32_16x16x32_bf16 v[36:39], a[184:187], v[80:83], v[36:39]
    v_mfma_f32_16x16x32_bf16 v[56:59], a[184:187], v[84:87], v[56:59]
    v_mfma_f32_16x16x32_bf16 v[40:43], a[188:191], v[80:83], v[40:43]
    v_mfma_f32_16x16x32_bf16 v[60:63], a[188:191], v[84:87], v[60:63]
    v_mfma_f32_16x16x32_bf16 v[44:47], a[192:195], v[80:83], v[44:47]
    buffer_load_dwordx4 a[76:79], v8, s[28:31], s37 offen offset:1024
    v_mfma_f32_16x16x32_bf16 v[64:67], a[192:195], v[84:87], v[64:67]
    v_mfma_f32_16x16x32_bf16 v[48:51], a[196:199], v[80:83], v[48:51]
    v_mfma_f32_16x16x32_bf16 v[68:71], a[196:199], v[84:87], v[68:71]
    s_waitcnt lgkmcnt(0)
    s_nop 4
    ds_write_b128 v246, v[52:55] offset:0
    buffer_load_dwordx4 a[80:83], v8, s[28:31], s37 offen offset:2048
    ds_write_b128 v246, v[56:59] offset:1024
    ds_write_b128 v246, v[60:63] offset:2048
    buffer_load_dwordx4 a[84:87], v8, s[28:31], s37 offen offset:3072
    ds_write_b128 v246, v[64:67] offset:3072
    ds_write_b128 v246, v[68:71] offset:4096
    s_add_u32 s37, s37, 4096
    buffer_load_dwordx4 a[88:91], v8, s[28:31], s37 offen offset:0
    v_pk_add_f32 v[112:113], v[112:113], v[132:133]
    v_pk_add_f32 v[114:115], v[114:115], v[134:135]
    v_pk_add_f32 v[116:117], v[116:117], v[136:137]
    v_pk_add_f32 v[118:119], v[118:119], v[138:139]
    v_pk_add_f32 v[120:121], v[120:121], v[140:141]
    v_pk_add_f32 v[122:123], v[122:123], v[142:143]
    v_pk_add_f32 v[124:125], v[124:125], v[144:145]
    v_pk_add_f32 v[126:127], v[126:127], v[146:147]
    v_pk_add_f32 v[128:129], v[128:129], v[148:149]
    v_pk_add_f32 v[130:131], v[130:131], v[150:151]
    v_mov_b32 v30, 0xbdd2d3e8
    v_mov_b32 v31, 0xc0135761
    s_waitcnt lgkmcnt(0)
    s_barrier
    ds_read_b64 v[152:153], v235
    buffer_load_dwordx4 a[92:95], v8, s[28:31], s37 offen offset:1024
    ds_read_b128 v[88:91], v247 offset:0
    ds_read_b128 v[92:95], v247 offset:1024
    ds_read_b128 v[96:99], v247 offset:2048
    ds_read_b128 v[100:103], v247 offset:3072
    ds_read_b128 v[104:107], v247 offset:4096
    s_waitcnt lgkmcnt(5)
    v_pk_mul_f32 v[112:113], v[112:113], v[152:153] op_sel_hi:[1,0]
    buffer_load_dwordx4 a[96:99], v8, s[28:31], s37 offen offset:2048
    v_pk_mul_f32 v[114:115], v[114:115], v[152:153] op_sel_hi:[1,0]
    v_pk_mul_f32 v[116:117], v[116:117], v[152:153] op_sel_hi:[1,0]
    v_pk_mul_f32 v[118:119], v[118:119], v[152:153] op_sel_hi:[1,0]
    v_pk_mul_f32 v[120:121], v[120:121], v[152:153] op_sel_hi:[1,0]
    v_pk_mul_f32 v[122:123], v[122:123], v[152:153] op_sel_hi:[1,0]
    v_pk_mul_f32 v[124:125], v[124:125], v[152:153] op_sel_hi:[1,0]
    v_pk_mul_f32 v[126:127], v[126:127], v[152:153] op_sel_hi:[1,0]
    v_pk_mul_f32 v[128:129], v[128:129], v[152:153] op_sel_hi:[1,0]
    v_pk_mul_f32 v[130:131], v[130:131], v[152:153] op_sel_hi:[1,0]
    s_waitcnt lgkmcnt(4)
    v_pk_add_f32 v[32:33], v[32:33], v[88:89]
    v_pk_add_f32 v[34:35], v[34:35], v[90:91]
    s_waitcnt lgkmcnt(3)
    v_pk_add_f32 v[36:37], v[36:37], v[92:93]
    v_pk_add_f32 v[38:39], v[38:39], v[94:95]
    s_waitcnt lgkmcnt(2)
    v_pk_add_f32 v[40:41], v[40:41], v[96:97]
    buffer_load_dwordx4 a[100:103], v8, s[28:31], s37 offen offset:3072
    v_pk_add_f32 v[42:43], v[42:43], v[98:99]
    s_waitcnt lgkmcnt(1)
    v_pk_add_f32 v[44:45], v[44:45], v[100:101]
    v_pk_add_f32 v[46:47], v[46:47], v[102:103]
    s_waitcnt lgkmcnt(0)
    v_pk_add_f32 v[48:49], v[48:49], v[104:105]
    v_pk_add_f32 v[50:51], v[50:51], v[106:107]
    v_pk_fma_f32 v[32:33], v[32:33], v[152:153], v[112:113] op_sel:[0,1,0] op_sel_hi:[1,1,1]
    v_pk_fma_f32 v[34:35], v[34:35], v[152:153], v[114:115] op_sel:[0,1,0] op_sel_hi:[1,1,1]
    v_pk_fma_f32 v[36:37], v[36:37], v[152:153], v[116:117] op_sel:[0,1,0] op_sel_hi:[1,1,1]
    v_pk_fma_f32 v[38:39], v[38:39], v[152:153], v[118:119] op_sel:[0,1,0] op_sel_hi:[1,1,1]
    v_pk_fma_f32 v[40:41], v[40:41], v[152:153], v[120:121] op_sel:[0,1,0] op_sel_hi:[1,1,1]
    v_pk_fma_f32 v[42:43], v[42:43], v[152:153], v[122:123] op_sel:[0,1,0] op_sel_hi:[1,1,1]
    v_pk_fma_f32 v[44:45], v[44:45], v[152:153], v[124:125] op_sel:[0,1,0] op_sel_hi:[1,1,1]
    v_pk_fma_f32 v[46:47], v[46:47], v[152:153], v[126:127] op_sel:[0,1,0] op_sel_hi:[1,1,1]
    v_pk_fma_f32 v[48:49], v[48:49], v[152:153], v[128:129] op_sel:[0,1,0] op_sel_hi:[1,1,1]
    v_pk_fma_f32 v[50:51], v[50:51], v[152:153], v[130:131] op_sel:[0,1,0] op_sel_hi:[1,1,1]
    s_add_u32 s37, s37, 4096
    buffer_load_dwordx4 a[104:107], v8, s[28:31], s37 offen offset:0
    v_pk_mul_f32 v[192:193], v[32:33], v[32:33]
    v_pk_mul_f32 v[194:195], v[34:35], v[34:35]
    v_pk_mul_f32 v[196:197], v[36:37], v[36:37]
    v_pk_mul_f32 v[198:199], v[38:39], v[38:39]
    v_pk_mul_f32 v[200:201], v[40:41], v[40:41]
    v_pk_mul_f32 v[202:203], v[42:43], v[42:43]
    v_pk_mul_f32 v[204:205], v[44:45], v[44:45]
    v_pk_mul_f32 v[206:207], v[46:47], v[46:47]
    v_pk_mul_f32 v[208:209], v[48:49], v[48:49]
    v_pk_mul_f32 v[210:211], v[50:51], v[50:51]
    v_pk_fma_f32 v[192:193], v[192:193], v[30:31], v[30:31] op_sel:[0,0,1] op_sel_hi:[1,0,1]
    v_pk_fma_f32 v[194:195], v[194:195], v[30:31], v[30:31] op_sel:[0,0,1] op_sel_hi:[1,0,1]
    v_pk_fma_f32 v[196:197], v[196:197], v[30:31], v[30:31] op_sel:[0,0,1] op_sel_hi:[1,0,1]
    v_pk_fma_f32 v[198:199], v[198:199], v[30:31], v[30:31] op_sel:[0,0,1] op_sel_hi:[1,0,1]
    v_pk_fma_f32 v[200:201], v[200:201], v[30:31], v[30:31] op_sel:[0,0,1] op_sel_hi:[1,0,1]
    v_pk_fma_f32 v[202:203], v[202:203], v[30:31], v[30:31] op_sel:[0,0,1] op_sel_hi:[1,0,1]
    v_pk_fma_f32 v[204:205], v[204:205], v[30:31], v[30:31] op_sel:[0,0,1] op_sel_hi:[1,0,1]
    buffer_load_dwordx4 a[108:111], v8, s[28:31], s37 offen offset:1024
    v_pk_fma_f32 v[206:207], v[206:207], v[30:31], v[30:31] op_sel:[0,0,1] op_sel_hi:[1,0,1]
    v_pk_fma_f32 v[208:209], v[208:209], v[30:31], v[30:31] op_sel:[0,0,1] op_sel_hi:[1,0,1]
    v_pk_fma_f32 v[210:211], v[210:211], v[30:31], v[30:31] op_sel:[0,0,1] op_sel_hi:[1,0,1]
    v_pk_mul_f32 v[192:193], v[192:193], v[32:33]
    v_pk_mul_f32 v[194:195], v[194:195], v[34:35]
    v_pk_mul_f32 v[196:197], v[196:197], v[36:37]
    v_pk_mul_f32 v[198:199], v[198:199], v[38:39]
    v_pk_mul_f32 v[200:201], v[200:201], v[40:41]
    v_pk_mul_f32 v[202:203], v[202:203], v[42:43]
    v_pk_mul_f32 v[204:205], v[204:205], v[44:45]
    v_pk_mul_f32 v[206:207], v[206:207], v[46:47]
    v_pk_mul_f32 v[208:209], v[208:209], v[48:49]
    v_pk_mul_f32 v[210:211], v[210:211], v[50:51]
    v_exp_f32 v192, v192
    v_exp_f32 v193, v193
    buffer_load_dwordx4 a[112:115], v8, s[28:31], s37 offen offset:2048
    v_exp_f32 v194, v194
    v_exp_f32 v195, v195
    v_exp_f32 v196, v196
    v_exp_f32 v197, v197
    v_exp_f32 v198, v198
    v_exp_f32 v199, v199
    v_exp_f32 v200, v200
    v_exp_f32 v201, v201
    v_exp_f32 v202, v202
    buffer_load_dwordx4 a[116:119], v8, s[28:31], s37 offen offset:3072
    v_exp_f32 v203, v203
    v_exp_f32 v204, v204
    v_exp_f32 v205, v205
    v_exp_f32 v206, v206
    v_exp_f32 v207, v207
    v_exp_f32 v208, v208
    v_exp_f32 v209, v209
    v_exp_f32 v210, v210
    v_exp_f32 v211, v211
    s_add_u32 s37, s37, 4096
    buffer_load_dwordx4 a[120:123], v8, s[28:31], s37 offen offset:0
    v_pk_add_f32 v[192:193], v[192:193], 1.0 op_sel_hi:[1,0]
    v_pk_add_f32 v[194:195], v[194:195], 1.0 op_sel_hi:[1,0]
    v_pk_add_f32 v[196:197], v[196:197], 1.0 op_sel_hi:[1,0]
    v_pk_add_f32 v[198:199], v[198:199], 1.0 op_sel_hi:[1,0]
    v_pk_add_f32 v[200:201], v[200:201], 1.0 op_sel_hi:[1,0]
    v_pk_add_f32 v[202:203], v[202:203], 1.0 op_sel_hi:[1,0]
    v_pk_add_f32 v[204:205], v[204:205], 1.0 op_sel_hi:[1,0]
    v_pk_add_f32 v[206:207], v[206:207], 1.0 op_sel_hi:[1,0]
    v_pk_add_f32 v[208:209], v[208:209], 1.0 op_sel_hi:[1,0]
    v_pk_add_f32 v[210:211], v[210:211], 1.0 op_sel_hi:[1,0]
    v_rcp_f32 v192, v192
    v_rcp_f32 v193, v193
    v_rcp_f32 v194, v194
    v_rcp_f32 v195, v195
    buffer_load_dwordx4 a[124:127], v8, s[28:31], s37 offen offset:1024
    v_rcp_f32 v196, v196
    v_rcp_f32 v197, v197
    v_rcp_f32 v198, v198
    v_rcp_f32 v199, v199
    v_rcp_f32 v200, v200
    v_rcp_f32 v201, v201
    v_rcp_f32 v202, v202
    v_rcp_f32 v203, v203
    v_rcp_f32 v204, v204
    buffer_load_dwordx4 a[128:131], v8, s[28:31], s37 offen offset:2048
    v_rcp_f32 v205, v205
    v_rcp_f32 v206, v206
    v_rcp_f32 v207, v207
    v_rcp_f32 v208, v208
    v_rcp_f32 v209, v209
    v_rcp_f32 v210, v210
    v_rcp_f32 v211, v211
    v_pk_mul_f32 v[32:33], v[32:33], v[192:193]
    v_pk_mul_f32 v[34:35], v[34:35], v[194:195]
    v_pk_mul_f32 v[36:37], v[36:37], v[196:197]
    buffer_load_dwordx4 a[132:135], v8, s[28:31], s37 offen offset:3072
    v_pk_mul_f32 v[38:39], v[38:39], v[198:199]
    v_pk_mul_f32 v[40:41], v[40:41], v[200:201]
    v_pk_mul_f32 v[42:43], v[42:43], v[202:203]
    v_pk_mul_f32 v[44:45], v[44:45], v[204:205]
    v_pk_mul_f32 v[46:47], v[46:47], v[206:207]
    v_pk_mul_f32 v[48:49], v[48:49], v[208:209]
    v_pk_mul_f32 v[50:51], v[50:51], v[210:211]
    v_cvt_pk_bf16_f32 v180, v32, v33
    v_cvt_pk_bf16_f32 v181, v34, v35
    v_cvt_pk_bf16_f32 v182, v36, v37
    v_cvt_pk_bf16_f32 v183, v38, v39
    v_cvt_pk_bf16_f32 v184, v40, v41
    v_cvt_pk_bf16_f32 v185, v42, v43
    v_cvt_pk_bf16_f32 v186, v44, v45
    v_cvt_pk_bf16_f32 v187, v46, v47
    v_cvt_pk_bf16_f32 v188, v48, v49
    v_cvt_pk_bf16_f32 v189, v50, v51
    s_nop 1
    v_permlane16_swap_b32 v180, v182
    v_permlane16_swap_b32 v181, v183
    v_permlane16_swap_b32 v184, v186
    v_permlane16_swap_b32 v185, v187
    s_mov_b64 exec, s[60:61]
    buffer_store_dwordx4 v[180:183], v241, s[28:31], s44 offen sc1
    buffer_store_dwordx4 v[184:187], v241, s[28:31], s44 offen offset:1024 sc1
    buffer_store_dwordx2 v[188:189], v242, s[28:31], s45 offen sc1
    s_mov_b64 exec, -1
    s_waitcnt vmcnt(0)
    s_barrier
    s_cmp_lg_u32 s20, 0
    s_cbranch_scc1 chain_kernel_sig1
    v_mov_b32 v2, 1
    v_mov_b32 v7, 0
    s_mov_b64 exec, 1
    buffer_store_dword v2, v7, s[28:31], s46 offen sc1
    s_mov_b64 exec, -1
chain_kernel_sig1:
    s_add_u32 s37, s37, 4096
    buffer_load_dwordx4 a[136:139], v8, s[28:31], s37 offen offset:0
    buffer_load_dwordx4 a[140:143], v8, s[28:31], s37 offen offset:1024
    s_mul_i32 s25, s20, 10
    s_lshl_b32 s25, s25, 10
    s_add_u32 s62, s25, 0
    s_add_u32 s63, s25, s54
    s_add_u32 s63, s63, 0
    s_mov_b32 m0, s62
    buffer_load_dwordx4 v8, s[28:31], s63 offen offset:0 lds
    buffer_load_dwordx4 v8, s[28:31], s63 offen offset:1024 lds
    buffer_load_dwordx4 v8, s[28:31], s63 offen offset:2048 lds
    buffer_load_dwordx4 v8, s[28:31], s63 offen offset:3072 lds
    s_add_u32 s62, s62, 4096
    s_add_u32 s63, s63, 4096
    s_mov_b32 m0, s62
    buffer_load_dwordx4 v8, s[28:31], s63 offen offset:0 lds
    buffer_load_dwordx4 v8, s[28:31], s63 offen offset:1024 lds
    buffer_load_dwordx4 v8, s[28:31], s63 offen offset:2048 lds
    buffer_load_dwordx4 v8, s[28:31], s63 offen offset:3072 lds
    s_add_u32 s62, s62, 4096
    s_add_u32 s63, s63, 4096
    s_mov_b32 m0, s62
    buffer_load_dwordx4 v8, s[28:31], s63 offen offset:0 lds
    buffer_load_dwordx4 v8, s[28:31], s63 offen offset:1024 lds
    s_lshl_b32 s26, s53, 3
    s_lshl_b32 s27, s20, 1
    s_add_u32 s56, s26, s27
    s_mul_i32 s6, s56, 20480
    s_add_u32 s6, s6, 13406208
    s_add_u32 s7, s6, 20480
    s_lshl_b32 s26, s53, 2
    s_add_u32 s26, s26, s20
    s_lshl_b32 s26, s26, 9
    s_add_u32 s8, s26, 29413376
    v_lshlrev_b32 v228, 3, v4
    v_lshl_add_u32 v228, v3, 8, v228
    s_lshl_b32 s9, s56, 10
    s_add_u32 s9, s9, 23105536
    s_and_b32 s42, s52, 1
    s_mul_i32 s12, s52, 7
    s_add_u32 s13, s12, 1
    s_lshr_b32 s13, s13, 1
    s_add_u32 s26, s13, 3
    s_sub_u32 s27, s13, 1
    s_cmp_eq_u32 s42, 1
    s_cselect_b32 s12, s27, s26
    s_lshl_b32 s13, s13, 10
    s_add_u32 s13, s13, 16027648
    s_lshl_b32 s12, s12, 10
    s_add_u32 s12, s12, 16027648
    s_lshl_b32 s14, s56, 4
    s_lshl_b32 s15, s53, 4
    s_add_u32 s15, s15, s52
    s_lshl_b32 s15, s15, 2
    s_add_u32 s15, s15, s20
    s_lshl_b32 s15, s15, 7
    s_add_u32 s15, s15, 29446144
    s_lshr_b32 s26, s43, 4
    s_lshl_b32 s26, s26, 3
    s_lshl_b32 s27, s24, 1
    s_add_u32 s26, s26, s27
    s_add_u32 s26, s26, s21
    s_lshl_b32 s26, s26, 7
    s_add_u32 s19, s26, 23105536
    v_add_u32 v226, s14, v4
    v_lshrrev_b32 v227, 4, v226
    v_and_b32 v226, 15, v226
    s_mov_b32 s27, 55296
    v_mul_lo_u32 v227, v227, s27
    v_lshl_add_u32 v227, v226, 4, v227
    v_and_b32 v226, 1, v3
    v_lshlrev_b32 v226, 9, v226
    v_lshrrev_b32 v2, 1, v3
    v_lshl_add_u32 v226, v2, 8, v226
    v_add_u32 v226, v226, v227
    s_lshl_b32 s27, s42, 9
    v_lshl_add_u32 v227, v2, 8, v227
    v_add_u32 v227, s27, v227
    v_and_b32 v2, 1, v3
    v_lshl_add_u32 v227, v2, 3, v227
    s_mov_b32 s48, 29380608
    s_mov_b32 s47, 0
    s_mov_b64 exec, 15
chain_kernel_poll2:
    buffer_load_dword v2, v245, s[28:31], s48 offen sc1
    s_add_u32 s47, s47, 1
    s_waitcnt vmcnt(0)
    v_cmp_ne_u32 vcc, 1, v2
    s_cmp_ge_u32 s47, 200000
    s_cbranch_scc1 chain_kernel_polld3
    s_cbranch_vccnz chain_kernel_poll2
chain_kernel_polld3:
    s_mov_b64 exec, -1
    buffer_load_dwordx4 v[72:75], v8, s[28:31], s50 offen offset:0 sc1
    buffer_load_dwordx4 v[76:79], v8, s[28:31], s51 offen offset:0 sc1
    buffer_load_dwordx4 v[80:83], v8, s[28:31], s50 offen offset:1024 sc1
    buffer_load_dwordx4 v[84:87], v8, s[28:31], s51 offen offset:1024 sc1
    buffer_load_dwordx4 v[88:91], v8, s[28:31], s50 offen offset:2048 sc1
    buffer_load_dwordx4 v[92:95], v8, s[28:31], s51 offen offset:2048 sc1
    buffer_load_dwordx4 v[96:99], v8, s[28:31], s50 offen offset:3072 sc1
    buffer_load_dwordx4 v[100:103], v8, s[28:31], s51 offen offset:3072 sc1
    s_add_u32 s50, s50, 4096
    s_add_u32 s51, s51, 4096
    buffer_load_dwordx4 v[104:107], v8, s[28:31], s50 offen offset:0 sc1
    buffer_load_dwordx4 v[108:111], v8, s[28:31], s51 offen offset:0 sc1
    s_waitcnt vmcnt(8)
    v_mfma_f32_16x16x32_bf16 v[32:35], a[200:203], v[72:75], 0
    v_mfma_f32_16x16x32_bf16 v[52:55], a[200:203], v[76:79], 0
    buffer_load_dwordx4 v[112:115], v8, s[28:31], s50 offen offset:1024 sc1
    v_mfma_f32_16x16x32_bf16 v[36:39], a[204:207], v[72:75], 0
    v_mfma_f32_16x16x32_bf16 v[56:59], a[204:207], v[76:79], 0
    v_mfma_f32_16x16x32_bf16 v[40:43], a[208:211], v[72:75], 0
    v_mfma_f32_16x16x32_bf16 v[60:63], a[208:211], v[76:79], 0
    buffer_load_dwordx4 v[116:119], v8, s[28:31], s51 offen offset:1024 sc1
    v_mfma_f32_16x16x32_bf16 v[44:47], a[212:215], v[72:75], 0
    v_mfma_f32_16x16x32_bf16 v[64:67], a[212:215], v[76:79], 0
    v_mfma_f32_16x16x32_bf16 v[48:51], a[216:219], v[72:75], 0
    v_mfma_f32_16x16x32_bf16 v[68:71], a[216:219], v[76:79], 0
    s_waitcnt vmcnt(8)
    v_mfma_f32_16x16x32_bf16 v[32:35], a[220:223], v[80:83], v[32:35]
    v_mfma_f32_16x16x32_bf16 v[52:55], a[220:223], v[84:87], v[52:55]
    buffer_load_dwordx4 v[120:123], v8, s[28:31], s50 offen offset:2048 sc1
    v_mfma_f32_16x16x32_bf16 v[36:39], a[224:227], v[80:83], v[36:39]
    v_mfma_f32_16x16x32_bf16 v[56:59], a[224:227], v[84:87], v[56:59]
    v_mfma_f32_16x16x32_bf16 v[40:43], a[228:231], v[80:83], v[40:43]
    v_mfma_f32_16x16x32_bf16 v[60:63], a[228:231], v[84:87], v[60:63]
    buffer_load_dwordx4 v[124:127], v8, s[28:31], s51 offen offset:2048 sc1
    v_mfma_f32_16x16x32_bf16 v[44:47], a[232:235], v[80:83], v[44:47]
    v_mfma_f32_16x16x32_bf16 v[64:67], a[232:235], v[84:87], v[64:67]
    v_mfma_f32_16x16x32_bf16 v[48:51], a[236:239], v[80:83], v[48:51]
    v_mfma_f32_16x16x32_bf16 v[68:71], a[236:239], v[84:87], v[68:71]
    s_waitcnt vmcnt(8)
    v_mfma_f32_16x16x32_bf16 v[32:35], a[240:243], v[88:91], v[32:35]
    v_mfma_f32_16x16x32_bf16 v[52:55], a[240:243], v[92:95], v[52:55]
    buffer_load_dwordx4 v[128:131], v8, s[28:31], s50 offen offset:3072 sc1
    v_mfma_f32_16x16x32_bf16 v[36:39], a[244:247], v[88:91], v[36:39]
    v_mfma_f32_16x16x32_bf16 v[56:59], a[244:247], v[92:95], v[56:59]
    v_mfma_f32_16x16x32_bf16 v[40:43], a[248:251], v[88:91], v[40:43]
    v_mfma_f32_16x16x32_bf16 v[60:63], a[248:251], v[92:95], v[60:63]
    buffer_load_dwordx4 v[132:135], v8, s[28:31], s51 offen offset:3072 sc1
    v_mfma_f32_16x16x32_bf16 v[44:47], a[252:255], v[88:91], v[44:47]
    v_mfma_f32_16x16x32_bf16 v[64:67], a[252:255], v[92:95], v[64:67]
    v_mfma_f32_16x16x32_bf16 v[48:51], a[0:3], v[88:91], v[48:51]
    v_mfma_f32_16x16x32_bf16 v[68:71], a[0:3], v[92:95], v[68:71]
    s_waitcnt vmcnt(8)
    v_mfma_f32_16x16x32_bf16 v[32:35], a[4:7], v[96:99], v[32:35]
    v_mfma_f32_16x16x32_bf16 v[52:55], a[4:7], v[100:103], v[52:55]
    s_add_u32 s50, s50, 4096
    s_add_u32 s51, s51, 4096
    buffer_load_dwordx4 v[136:139], v8, s[28:31], s50 offen offset:0 sc1
    v_mfma_f32_16x16x32_bf16 v[36:39], a[8:11], v[96:99], v[36:39]
    v_mfma_f32_16x16x32_bf16 v[56:59], a[8:11], v[100:103], v[56:59]
    v_mfma_f32_16x16x32_bf16 v[40:43], a[12:15], v[96:99], v[40:43]
    v_mfma_f32_16x16x32_bf16 v[60:63], a[12:15], v[100:103], v[60:63]
    buffer_load_dwordx4 v[140:143], v8, s[28:31], s51 offen offset:0 sc1
    v_mfma_f32_16x16x32_bf16 v[44:47], a[16:19], v[96:99], v[44:47]
    v_mfma_f32_16x16x32_bf16 v[64:67], a[16:19], v[100:103], v[64:67]
    v_mfma_f32_16x16x32_bf16 v[48:51], a[20:23], v[96:99], v[48:51]
    v_mfma_f32_16x16x32_bf16 v[68:71], a[20:23], v[100:103], v[68:71]
    s_waitcnt vmcnt(8)
    v_mfma_f32_16x16x32_bf16 v[32:35], a[24:27], v[104:107], v[32:35]
    v_mfma_f32_16x16x32_bf16 v[52:55], a[24:27], v[108:111], v[52:55]
    buffer_load_dwordx4 v[144:147], v8, s[28:31], s50 offen offset:1024 sc1
    v_mfma_f32_16x16x32_bf16 v[36:39], a[28:31], v[104:107], v[36:39]
    v_mfma_f32_16x16x32_bf16 v[56:59], a[28:31], v[108:111], v[56:59]
    v_mfma_f32_16x16x32_bf16 v[40:43], a[32:35], v[104:107], v[40:43]
    v_mfma_f32_16x16x32_bf16 v[60:63], a[32:35], v[108:111], v[60:63]
    buffer_load_dwordx4 v[148:151], v8, s[28:31], s51 offen offset:1024 sc1
    v_mfma_f32_16x16x32_bf16 v[44:47], a[36:39], v[104:107], v[44:47]
    v_mfma_f32_16x16x32_bf16 v[64:67], a[36:39], v[108:111], v[64:67]
    s_mul_i32 s25, s20, 20
    s_lshl_b32 s25, s25, 10
    s_add_u32 s62, s25, 40960
    s_add_u32 s63, s25, s54
    s_add_u32 s63, s63, 40960
    s_mov_b32 m0, s62
    buffer_load_dwordx4 v8, s[28:31], s63 offen offset:0 lds
    v_mfma_f32_16x16x32_bf16 v[48:51], a[40:43], v[104:107], v[48:51]
    v_mfma_f32_16x16x32_bf16 v[68:71], a[40:43], v[108:111], v[68:71]
    s_waitcnt vmcnt(9)
    v_mfma_f32_16x16x32_bf16 v[32:35], a[44:47], v[112:115], v[32:35]
    v_mfma_f32_16x16x32_bf16 v[52:55], a[44:47], v[116:119], v[52:55]
    buffer_load_dwordx4 v8, s[28:31], s63 offen offset:1024 lds
    v_mfma_f32_16x16x32_bf16 v[36:39], a[48:51], v[112:115], v[36:39]
    v_mfma_f32_16x16x32_bf16 v[56:59], a[48:51], v[116:119], v[56:59]
    buffer_load_dwordx4 v8, s[28:31], s63 offen offset:2048 lds
    v_mfma_f32_16x16x32_bf16 v[40:43], a[52:55], v[112:115], v[40:43]
    v_mfma_f32_16x16x32_bf16 v[60:63], a[52:55], v[116:119], v[60:63]
    v_mfma_f32_16x16x32_bf16 v[44:47], a[56:59], v[112:115], v[44:47]
    v_mfma_f32_16x16x32_bf16 v[64:67], a[56:59], v[116:119], v[64:67]
    buffer_load_dwordx4 v8, s[28:31], s63 offen offset:3072 lds
    v_mfma_f32_16x16x32_bf16 v[48:51], a[60:63], v[112:115], v[48:51]
    v_mfma_f32_16x16x32_bf16 v[68:71], a[60:63], v[116:119], v[68:71]
    s_waitcnt vmcnt(10)
    v_mfma_f32_16x16x32_bf16 v[32:35], a[64:67], v[120:123], v[32:35]
    v_mfma_f32_16x16x32_bf16 v[52:55], a[64:67], v[124:127], v[52:55]
    s_add_u32 s62, s62, 4096
    s_add_u32 s63, s63, 4096
    s_mov_b32 m0, s62
    buffer_load_dwordx4 v8, s[28:31], s63 offen offset:0 lds
    v_mfma_f32_16x16x32_bf16 v[36:39], a[68:71], v[120:123], v[36:39]
    v_mfma_f32_16x16x32_bf16 v[56:59], a[68:71], v[124:127], v[56:59]
    buffer_load_dwordx4 v8, s[28:31], s63 offen offset:1024 lds
    v_mfma_f32_16x16x32_bf16 v[40:43], a[72:75], v[120:123], v[40:43]
    v_mfma_f32_16x16x32_bf16 v[60:63], a[72:75], v[124:127], v[60:63]
    v_mfma_f32_16x16x32_bf16 v[44:47], a[76:79], v[120:123], v[44:47]
    v_mfma_f32_16x16x32_bf16 v[64:67], a[76:79], v[124:127], v[64:67]
    buffer_load_dwordx4 v8, s[28:31], s63 offen offset:2048 lds
    v_mfma_f32_16x16x32_bf16 v[48:51], a[80:83], v[120:123], v[48:51]
    v_mfma_f32_16x16x32_bf16 v[68:71], a[80:83], v[124:127], v[68:71]
    s_waitcnt vmcnt(11)
    v_mfma_f32_16x16x32_bf16 v[32:35], a[84:87], v[128:131], v[32:35]
    v_mfma_f32_16x16x32_bf16 v[52:55], a[84:87], v[132:135], v[52:55]
    buffer_load_dwordx4 v8, s[28:31], s63 offen offset:3072 lds
    v_mfma_f32_16x16x32_bf16 v[36:39], a[88:91], v[128:131], v[36:39]
    v_mfma_f32_16x16x32_bf16 v[56:59], a[88:91], v[132:135], v[56:59]
    s_add_u32 s62, s62, 4096
    s_add_u32 s63, s63, 4096
    s_mov_b32 m0, s62
    buffer_load_dwordx4 v8, s[28:31], s63 offen offset:0 lds
    v_mfma_f32_16x16x32_bf16 v[40:43], a[92:95], v[128:131], v[40:43]
    v_mfma_f32_16x16x32_bf16 v[60:63], a[92:95], v[132:135], v[60:63]
    v_mfma_f32_16x16x32_bf16 v[44:47], a[96:99], v[128:131], v[44:47]
    v_mfma_f32_16x16x32_bf16 v[64:67], a[96:99], v[132:135], v[64:67]
    buffer_load_dwordx4 v8, s[28:31], s63 offen offset:1024 lds
    v_mfma_f32_16x16x32_bf16 v[48:51], a[100:103], v[128:131], v[48:51]
    v_mfma_f32_16x16x32_bf16 v[68:71], a[100:103], v[132:135], v[68:71]
    s_waitcnt vmcnt(12)
    v_mfma_f32_16x16x32_bf16 v[32:35], a[104:107], v[136:139], v[32:35]
    v_mfma_f32_16x16x32_bf16 v[52:55], a[104:107], v[140:143], v[52:55]
    buffer_load_dwordx4 v8, s[28:31], s63 offen offset:2048 lds
    v_mfma_f32_16x16x32_bf16 v[36:39], a[108:111], v[136:139], v[36:39]
    v_mfma_f32_16x16x32_bf16 v[56:59], a[108:111], v[140:143], v[56:59]
    buffer_load_dwordx4 v8, s[28:31], s63 offen offset:3072 lds
    v_mfma_f32_16x16x32_bf16 v[40:43], a[112:115], v[136:139], v[40:43]
    v_mfma_f32_16x16x32_bf16 v[60:63], a[112:115], v[140:143], v[60:63]
    v_mfma_f32_16x16x32_bf16 v[44:47], a[116:119], v[136:139], v[44:47]
    v_mfma_f32_16x16x32_bf16 v[64:67], a[116:119], v[140:143], v[64:67]
    s_add_u32 s62, s62, 4096
    s_add_u32 s63, s63, 4096
    s_mov_b32 m0, s62
    buffer_load_dwordx4 v8, s[28:31], s63 offen offset:0 lds
    v_mfma_f32_16x16x32_bf16 v[48:51], a[120:123], v[136:139], v[48:51]
    v_mfma_f32_16x16x32_bf16 v[68:71], a[120:123], v[140:143], v[68:71]
    s_waitcnt vmcnt(13)
    v_mfma_f32_16x16x32_bf16 v[32:35], a[124:127], v[144:147], v[32:35]
    v_mfma_f32_16x16x32_bf16 v[52:55], a[124:127], v[148:151], v[52:55]
    buffer_load_dwordx4 v8, s[28:31], s63 offen offset:1024 lds
    v_mfma_f32_16x16x32_bf16 v[36:39], a[128:131], v[144:147], v[36:39]
    v_mfma_f32_16x16x32_bf16 v[56:59], a[128:131], v[148:151], v[56:59]
    buffer_load_dwordx4 v8, s[28:31], s63 offen offset:2048 lds
    v_mfma_f32_16x16x32_bf16 v[40:43], a[132:135], v[144:147], v[40:43]
    v_mfma_f32_16x16x32_bf16 v[60:63], a[132:135], v[148:151], v[60:63]
    v_mfma_f32_16x16x32_bf16 v[44:47], a[136:139], v[144:147], v[44:47]
    v_mfma_f32_16x16x32_bf16 v[64:67], a[136:139], v[148:151], v[64:67]
    buffer_load_dwordx4 v8, s[28:31], s63 offen offset:3072 lds
    v_mfma_f32_16x16x32_bf16 v[48:51], a[140:143], v[144:147], v[48:51]
    v_mfma_f32_16x16x32_bf16 v[68:71], a[140:143], v[148:151], v[68:71]
    s_nop 4
    ds_write_b128 v246, v[52:55] offset:0
    ds_write_b128 v246, v[56:59] offset:1024
    ds_write_b128 v246, v[60:63] offset:2048
    ds_write_b128 v246, v[64:67] offset:3072
    ds_write_b128 v246, v[68:71] offset:4096
    v_lshlrev_b32 v112, 16, v16
    v_and_b32 v113, 0xffff0000, v16
    v_lshlrev_b32 v114, 16, v17
    v_and_b32 v115, 0xffff0000, v17
    v_lshlrev_b32 v116, 16, v18
    v_and_b32 v117, 0xffff0000, v18
    v_lshlrev_b32 v118, 16, v19
    v_and_b32 v119, 0xffff0000, v19
    v_lshlrev_b32 v120, 16, v20
    v_and_b32 v121, 0xffff0000, v20
    v_lshlrev_b32 v122, 16, v21
    v_and_b32 v123, 0xffff0000, v21
    v_lshlrev_b32 v124, 16, v22
    v_and_b32 v125, 0xffff0000, v22
    v_lshlrev_b32 v126, 16, v23
    v_and_b32 v127, 0xffff0000, v23
    v_lshlrev_b32 v128, 16, v24
    v_and_b32 v129, 0xffff0000, v24
    v_lshlrev_b32 v130, 16, v25
    v_and_b32 v131, 0xffff0000, v25
    v_pk_add_f32 v[32:33], v[32:33], v[112:113]
    v_pk_add_f32 v[34:35], v[34:35], v[114:115]
    v_pk_add_f32 v[36:37], v[36:37], v[116:117]
    v_pk_add_f32 v[38:39], v[38:39], v[118:119]
    v_pk_add_f32 v[40:41], v[40:41], v[120:121]
    v_pk_add_f32 v[42:43], v[42:43], v[122:123]
    v_pk_add_f32 v[44:45], v[44:45], v[124:125]
    v_pk_add_f32 v[46:47], v[46:47], v[126:127]
    v_pk_add_f32 v[48:49], v[48:49], v[128:129]
    v_pk_add_f32 v[50:51], v[50:51], v[130:131]
    v_mov_b32 v28, 0
    v_mov_b32 v29, 0
    s_add_u32 s62, s62, 4096
    s_add_u32 s63, s63, 4096
    s_mov_b32 m0, s62
    buffer_load_dwordx4 v8, s[28:31], s63 offen offset:0 lds
    buffer_load_dwordx4 v8, s[28:31], s63 offen offset:1024 lds
    buffer_load_dwordx4 v8, s[28:31], s63 offen offset:2048 lds
    buffer_load_dwordx4 v8, s[28:31], s63 offen offset:3072 lds
    s_mul_i32 s25, s20, 5
    s_lshl_b32 s25, s25, 10
    s_add_u32 s62, s25, 122880
    s_add_u32 s63, s25, s54
    s_add_u32 s63, s63, 122880
    s_mov_b32 m0, s62
    buffer_load_dwordx4 v8, s[28:31], s63 offen offset:0 lds
    buffer_load_dwordx4 v8, s[28:31], s63 offen offset:1024 lds
    buffer_load_dwordx4 v8, s[28:31], s63 offen offset:2048 lds
    buffer_load_dwordx4 v8, s[28:31], s63 offen offset:3072 lds
    s_add_u32 s62, s62, 4096
    s_add_u32 s63, s63, 4096
    s_mov_b32 m0, s62
    buffer_load_dwordx4 v8, s[28:31], s63 offen offset:0 lds
    s_waitcnt lgkmcnt(0)
    s_barrier
    ds_read_b128 v[88:91], v247 offset:0
    ds_read_b128 v[92:95], v247 offset:1024
    ds_read_b128 v[96:99], v247 offset:2048
    ds_read_b128 v[100:103], v247 offset:3072
    ds_read_b128 v[104:107], v247 offset:4096
    s_waitcnt lgkmcnt(4)
    v_pk_add_f32 v[32:33], v[32:33], v[88:89]
    v_pk_add_f32 v[34:35], v[34:35], v[90:91]
    v_cvt_pk_bf16_f32 v180, v32, v33
    v_cvt_pk_bf16_f32 v181, v34, v35
    s_waitcnt lgkmcnt(3)
    v_pk_add_f32 v[36:37], v[36:37], v[92:93]
    v_pk_add_f32 v[38:39], v[38:39], v[94:95]
    v_cvt_pk_bf16_f32 v182, v36, v37
    v_cvt_pk_bf16_f32 v183, v38, v39
    s_waitcnt lgkmcnt(2)
    v_pk_add_f32 v[40:41], v[40:41], v[96:97]
    v_pk_add_f32 v[42:43], v[42:43], v[98:99]
    v_cvt_pk_bf16_f32 v184, v40, v41
    v_cvt_pk_bf16_f32 v185, v42, v43
    s_waitcnt lgkmcnt(1)
    v_pk_add_f32 v[44:45], v[44:45], v[100:101]
    v_pk_add_f32 v[46:47], v[46:47], v[102:103]
    v_cvt_pk_bf16_f32 v186, v44, v45
    v_cvt_pk_bf16_f32 v187, v46, v47
    s_waitcnt lgkmcnt(0)
    v_pk_add_f32 v[48:49], v[48:49], v[104:105]
    v_pk_add_f32 v[50:51], v[50:51], v[106:107]
    v_cvt_pk_bf16_f32 v188, v48, v49
    v_cvt_pk_bf16_f32 v189, v50, v51
    v_dot2_f32_bf16 v28, v180, v224, v28
    v_dot2_f32_bf16 v29, v180, v180, v29
    v_dot2_f32_bf16 v28, v181, v224, v28
    v_dot2_f32_bf16 v29, v181, v181, v29
    v_dot2_f32_bf16 v28, v182, v224, v28
    v_dot2_f32_bf16 v29, v182, v182, v29
    v_dot2_f32_bf16 v28, v183, v224, v28
    v_dot2_f32_bf16 v29, v183, v183, v29
    v_dot2_f32_bf16 v28, v184, v224, v28
    v_dot2_f32_bf16 v29, v184, v184, v29
    v_dot2_f32_bf16 v28, v185, v224, v28
    v_dot2_f32_bf16 v29, v185, v185, v29
    v_dot2_f32_bf16 v28, v186, v224, v28
    v_dot2_f32_bf16 v29, v186, v186, v29
    v_dot2_f32_bf16 v28, v187, v224, v28
    v_dot2_f32_bf16 v29, v187, v187, v29
    v_dot2_f32_bf16 v28, v188, v224, v28
    v_dot2_f32_bf16 v29, v188, v188, v29
    v_dot2_f32_bf16 v28, v189, v224, v28
    v_dot2_f32_bf16 v29, v189, v189, v29
    s_nop 1
    v_permlane16_swap_b32 v180, v182
    v_permlane16_swap_b32 v181, v183
    v_permlane16_swap_b32 v184, v186
    v_permlane16_swap_b32 v185, v187
    buffer_store_dwordx4 v[180:183], v243, s[28:31], s38 offen sc1
    buffer_store_dwordx4 v[184:187], v243, s[28:31], s38 offen offset:1024 sc1
    buffer_store_dwordx2 v[188:189], v244, s[28:31], s39 offen sc1
    v_mov_b32 v160, v28
    v_mov_b32 v161, v29
    s_nop 1
    v_permlane32_swap_b32 v160, v28
    v_permlane32_swap_b32 v161, v29
    s_nop 1
    v_add_f32 v28, v28, v160
    v_add_f32 v29, v29, v161
    v_mov_b32 v160, v28
    v_mov_b32 v161, v29
    s_nop 1
    v_permlane16_swap_b32 v160, v28
    v_permlane16_swap_b32 v161, v29
    s_nop 1
    v_add_f32 v28, v28, v160
    v_add_f32 v29, v29, v161
    v_lshlrev_b32 v2, 3, v4
    s_mov_b64 exec, 0xffff
    buffer_store_dwordx2 v[28:29], v2, s[28:31], s19 offen sc1
    s_mov_b64 exec, -1
    s_waitcnt vmcnt(0)
    s_barrier
    s_cmp_lg_u32 s20, 0
    s_cbranch_scc1 chain_kernel_sig4
    v_mov_b32 v2, 1
    v_mov_b32 v7, 0
    s_mov_b64 exec, 1
    buffer_store_dword v2, v7, s[28:31], s49 offen sc1
    s_mov_b64 exec, -1
chain_kernel_sig4:
    v_and_b32 v2, 31, v1
    v_lshlrev_b32 v2, 4, v2
    v_lshrrev_b32 v7, 5, v1
    v_mul_u32_u24 v7, 7168, v7
    v_add_u32 v2, v2, v7
    s_mul_i32 s26, s52, 448
    s_add_u32 s26, s26, 8130560
    s_mov_b32 m0, 162816
    s_nop 0
    buffer_load_dwordx4 v2, s[28:31], s26 offen lds
    s_and_b32 s36, s57, 1
    s_lshl_b32 s43, s58, 6
    s_lshl_b32 s26, s21, 5
    s_add_u32 s43, s43, s26
    s_lshl_b32 s26, s22, 4
    s_add_u32 s43, s43, s26
    s_mul_i32 s40, s57, 5
    s_add_u32 s41, s40, 1
    s_lshr_b32 s41, s41, 1
    s_add_u32 s26, s41, 2
    s_sub_u32 s27, s41, 1
    s_cmp_eq_u32 s36, 1
    s_cselect_b32 s40, s27, s26
    s_lshl_b32 s44, s41, 10
    s_lshl_b32 s45, s40, 10
    s_lshl_b32 s26, s36, 9
    s_add_u32 s45, s45, s26
    s_lshr_b32 s26, s58, 1
    s_lshl_b32 s26, s26, 4
    s_mul_i32 s27, s22, 7
    s_add_u32 s26, s26, s27
    s_lshl_b32 s26, s26, 2
    s_and_b32 s27, s58, 1
    s_lshl_b32 s27, s27, 1
    s_add_u32 s26, s26, s27
    s_add_u32 s26, s26, s21
    s_lshl_b32 s26, s26, 7
    s_add_u32 s48, s26, 29446144
    v_lshlrev_b32 v234, 9, v1
    s_lshl_b32 s26, s58, 2
    s_lshl_b32 s27, s21, 1
    s_add_u32 s26, s26, s27
    s_add_u32 s27, s26, s22
    s_mul_i32 s27, s27, 54
    s_mul_i32 s39, s22, 27
    s_add_u32 s27, s27, s39
    s_lshl_b32 s27, s27, 10
    s_add_u32 s50, s27, 16027648
    s_add_u32 s27, s26, 1
    s_sub_u32 s27, s27, s22
    s_mul_i32 s27, s27, 54
    s_add_u32 s27, s27, s39
    s_lshl_b32 s27, s27, 10
    s_add_u32 s51, s27, 16027648
    v_add_u32 v9, s43, v4
    v_lshrrev_b32 v11, 4, v9
    v_and_b32 v10, 15, v9
    v_mul_u32_u24 v11, 20480, v11
    v_lshl_add_u32 v11, v10, 4, v11
    v_lshrrev_b32 v2, 1, v3
    v_lshl_add_u32 v11, v2, 8, v11
    v_and_b32 v7, 1, v3
    v_lshl_add_u32 v230, v7, 3, v11
    v_mul_u32_u24 v9, 1280, v9
    v_lshlrev_b32 v7, 5, v7
    v_lshl_add_u32 v7, v2, 4, v7
    v_add_u32 v231, v9, v7
    v_lshl_add_u32 v232, v3, 3, v9
    v_lshlrev_b32 v233, 4, v3
    v_add_u32 v9, s43, v4
    v_lshrrev_b32 v10, 4, v9
    v_mul_u32_u24 v10, 20480, v10
    v_and_b32 v11, 1, v9
    v_lshl_add_u32 v10, v11, 3, v10
    v_lshl_add_u32 v10, v3, 7, v10
    v_bfe_u32 v11, v9, 1, 3
    s_mul_i32 s26, s57, 20
    s_lshl_b32 s27, s36, 2
    s_add_u32 s27, s27, s26
    s_mul_i32 s3, s36, 16
    s_sub_u32 s3, 16, s3
    s_add_u32 s3, s3, s26
    s_add_u32 s4, s27, 0
    v_add_u32 v2, s4, v3
    v_bfe_u32 v2, v2, 1, 3
    v_xor_b32 v2, v2, v11
    v_lshl_add_u32 v2, v2, 4, v10
    s_lshl_b32 s4, s4, 7
    v_add_u32 v235, s4, v2
    s_add_u32 s4, s27, 4
    v_add_u32 v2, s4, v3
    v_bfe_u32 v2, v2, 1, 3
    v_xor_b32 v2, v2, v11
    v_lshl_add_u32 v2, v2, 4, v10
    s_lshl_b32 s4, s4, 7
    v_add_u32 v236, s4, v2
    s_add_u32 s4, s27, 8
    v_add_u32 v2, s4, v3
    v_bfe_u32 v2, v2, 1, 3
    v_xor_b32 v2, v2, v11
    v_lshl_add_u32 v2, v2, 4, v10
    s_lshl_b32 s4, s4, 7
    v_add_u32 v237, s4, v2
    s_add_u32 s4, s27, 12
    v_add_u32 v2, s4, v3
    v_bfe_u32 v2, v2, 1, 3
    v_xor_b32 v2, v2, v11
    v_lshl_add_u32 v2, v2, 4, v10
    s_lshl_b32 s4, s4, 7
    v_add_u32 v238, s4, v2
    s_mov_b32 s4, s3
    v_add_u32 v2, s4, v3
    v_bfe_u32 v2, v2, 1, 3
    v_xor_b32 v2, v2, v11
    v_lshl_add_u32 v2, v2, 4, v10
    s_lshl_b32 s4, s4, 7
    v_add_u32 v239, s4, v2
    s_mul_i32 s37, s57, 320
    s_add_u32 s37, s37, 8126976
    s_mul_i32 s26, s36, 256
    s_sub_u32 s26, 256, s26
    s_add_u32 s38, s37, s26
    s_lshl_b32 s26, s36, 6
    s_add_u32 s37, s37, s26
    s_mul_i32 s26, s57, 160
    s_lshl_b32 s27, s36, 5
    s_add_u32 s46, s26, s27
    s_mul_i32 s27, s36, 128
    s_sub_u32 s27, 128, s27
    s_add_u32 s49, s26, s27
    s_waitcnt vmcnt(0)
    s_lshl_b32 s26, s42, 6
    v_lshlrev_b32 v2, 4, v3
    v_add_u32 v7, 162816, v2
    v_add_u32 v2, s26, v7
    s_mul_i32 s26, s42, 384
    s_sub_u32 s26, 384, s26
    v_add_u32 v7, s26, v7
    ds_read_b128 v[88:91], v2 offset:0
    ds_read_b128 v[116:119], v2 offset:512
    ds_read_b128 v[92:95], v2 offset:64
    ds_read_b128 v[120:123], v2 offset:576
    ds_read_b128 v[96:99], v2 offset:128
    ds_read_b128 v[124:127], v2 offset:640
    ds_read_b128 v[100:103], v2 offset:192
    ds_read_b128 v[128:131], v2 offset:704
    ds_read_b128 v[104:107], v2 offset:256
    ds_read_b128 v[132:135], v2 offset:768
    ds_read_b128 v[108:111], v2 offset:320
    ds_read_b128 v[136:139], v2 offset:832
    ds_read_b128 v[112:115], v7
    ds_read_b128 v[140:143], v7 offset:512
    s_waitcnt lgkmcnt(0)
    v_pk_add_f32 v[88:89], v[88:89], v[116:117]
    v_pk_add_f32 v[90:91], v[90:91], v[118:119]
    v_pk_add_f32 v[92:93], v[92:93], v[120:121]
    v_pk_add_f32 v[94:95], v[94:95], v[122:123]
    v_pk_add_f32 v[96:97], v[96:97], v[124:125]
    v_pk_add_f32 v[98:99], v[98:99], v[126:127]
    v_pk_add_f32 v[100:101], v[100:101], v[128:129]
    v_pk_add_f32 v[102:103], v[102:103], v[130:131]
    v_pk_add_f32 v[104:105], v[104:105], v[132:133]
    v_pk_add_f32 v[106:107], v[106:107], v[134:135]
    v_pk_add_f32 v[108:109], v[108:109], v[136:137]
    v_pk_add_f32 v[110:111], v[110:111], v[138:139]
    v_pk_add_f32 v[112:113], v[112:113], v[140:141]
    v_pk_add_f32 v[114:115], v[114:115], v[142:143]
    v_mov_b32 v12, v8
    v_add_u32 v13, 0x10000, v8
    v_add_u32 v14, 0x20000, v8
    ds_read_b128 a[160:163], v12 offset:0
    ds_read_b128 a[164:167], v12 offset:1024
    ds_read_b128 a[168:171], v12 offset:2048
    ds_read_b128 a[172:175], v12 offset:3072
    ds_read_b128 a[176:179], v13 offset:57344
    ds_read_b128 a[180:183], v12 offset:4096
    ds_read_b128 a[184:187], v12 offset:5120
    ds_read_b128 a[188:191], v12 offset:6144
    ds_read_b128 a[192:195], v12 offset:7168
    ds_read_b128 a[196:199], v13 offset:58368
    ds_read_b128 a[200:203], v12 offset:8192
    v_lshlrev_b32 v7, 7, v1
    s_mov_b32 s47, 0
    s_mov_b64 exec, 15
chain_kernel_poll5:
    buffer_load_dword v2, v7, s[28:31], s8 offen sc1
    s_add_u32 s47, s47, 1
    s_waitcnt vmcnt(0)
    v_cmp_ne_u32 vcc, 1, v2
    s_cmp_ge_u32 s47, 200000
    s_cbranch_scc1 chain_kernel_polld6
    s_cbranch_vccnz chain_kernel_poll5
chain_kernel_polld6:
    s_mov_b64 exec, -1
    buffer_load_dwordx4 a[0:3], v8, s[28:31], s6 offen offset:0 sc1
    buffer_load_dwordx4 a[4:7], v8, s[28:31], s7 offen offset:0 sc1
    buffer_load_dwordx4 a[8:11], v8, s[28:31], s6 offen offset:1024 sc1
    buffer_load_dwordx4 a[12:15], v8, s[28:31], s7 offen offset:1024 sc1
    buffer_load_dwordx4 a[16:19], v8, s[28:31], s6 offen offset:2048 sc1
    buffer_load_dwordx4 a[20:23], v8, s[28:31], s7 offen offset:2048 sc1
    buffer_load_dwordx4 a[24:27], v8, s[28:31], s6 offen offset:3072 sc1
    buffer_load_dwordx4 a[28:31], v8, s[28:31], s7 offen offset:3072 sc1
    s_add_u32 s6, s6, 4096
    s_add_u32 s7, s7, 4096
    buffer_load_dwordx4 a[32:35], v8, s[28:31], s6 offen offset:0 sc1
    buffer_load_dwordx4 a[36:39], v8, s[28:31], s7 offen offset:0 sc1
    s_waitcnt vmcnt(8) lgkmcnt(6)
    v_mfma_f32_16x16x32_bf16 v[32:35], a[160:163], a[0:3], 0
    v_mfma_f32_16x16x32_bf16 v[60:63], a[160:163], a[4:7], 0
    ds_read_b128 a[204:207], v12 offset:9216
    buffer_load_dwordx4 a[40:43], v8, s[28:31], s6 offen offset:1024 sc1
    v_mfma_f32_16x16x32_bf16 v[36:39], a[164:167], a[0:3], 0
    v_mfma_f32_16x16x32_bf16 v[64:67], a[164:167], a[4:7], 0
    ds_read_b128 a[160:163], v12 offset:10240
    v_mfma_f32_16x16x32_bf16 v[40:43], a[168:171], a[0:3], 0
    v_mfma_f32_16x16x32_bf16 v[68:71], a[168:171], a[4:7], 0
    ds_read_b128 a[164:167], v12 offset:11264
    buffer_load_dwordx4 a[44:47], v8, s[28:31], s7 offen offset:1024 sc1
    v_mfma_f32_16x16x32_bf16 v[44:47], a[172:175], a[0:3], 0
    v_mfma_f32_16x16x32_bf16 v[72:75], a[172:175], a[4:7], 0
    ds_read_b128 a[168:171], v13 offset:59392
    v_mfma_f32_16x16x32_bf16 v[56:59], a[176:179], a[0:3], 0
    v_mfma_f32_16x16x32_bf16 v[84:87], a[176:179], a[4:7], 0
    ds_read_b128 a[172:175], v12 offset:12288
    s_waitcnt vmcnt(8) lgkmcnt(6)
    v_mfma_f32_16x16x32_bf16 v[32:35], a[180:183], a[8:11], v[32:35]
    v_mfma_f32_16x16x32_bf16 v[60:63], a[180:183], a[12:15], v[60:63]
    ds_read_b128 a[176:179], v12 offset:13312
    buffer_load_dwordx4 a[48:51], v8, s[28:31], s6 offen offset:2048 sc1
    v_mfma_f32_16x16x32_bf16 v[36:39], a[184:187], a[8:11], v[36:39]
    v_mfma_f32_16x16x32_bf16 v[64:67], a[184:187], a[12:15], v[64:67]
    ds_read_b128 a[180:183], v12 offset:14336
    v_mfma_f32_16x16x32_bf16 v[40:43], a[188:191], a[8:11], v[40:43]
    v_mfma_f32_16x16x32_bf16 v[68:71], a[188:191], a[12:15], v[68:71]
    ds_read_b128 a[184:187], v12 offset:15360
    buffer_load_dwordx4 a[52:55], v8, s[28:31], s7 offen offset:2048 sc1
    v_mfma_f32_16x16x32_bf16 v[44:47], a[192:195], a[8:11], v[44:47]
    v_mfma_f32_16x16x32_bf16 v[72:75], a[192:195], a[12:15], v[72:75]
    ds_read_b128 a[188:191], v13 offset:60416
    v_mfma_f32_16x16x32_bf16 v[56:59], a[196:199], a[8:11], v[56:59]
    v_mfma_f32_16x16x32_bf16 v[84:87], a[196:199], a[12:15], v[84:87]
    ds_read_b128 a[192:195], v12 offset:16384
    s_waitcnt vmcnt(8) lgkmcnt(6)
    v_mfma_f32_16x16x32_bf16 v[32:35], a[200:203], a[16:19], v[32:35]
    v_mfma_f32_16x16x32_bf16 v[60:63], a[200:203], a[20:23], v[60:63]
    ds_read_b128 a[196:199], v12 offset:17408
    buffer_load_dwordx4 a[56:59], v8, s[28:31], s6 offen offset:3072 sc1
    v_mfma_f32_16x16x32_bf16 v[36:39], a[204:207], a[16:19], v[36:39]
    v_mfma_f32_16x16x32_bf16 v[64:67], a[204:207], a[20:23], v[64:67]
    ds_read_b128 a[200:203], v12 offset:18432
    v_mfma_f32_16x16x32_bf16 v[40:43], a[160:163], a[16:19], v[40:43]
    v_mfma_f32_16x16x32_bf16 v[68:71], a[160:163], a[20:23], v[68:71]
    ds_read_b128 a[204:207], v12 offset:19456
    buffer_load_dwordx4 a[60:63], v8, s[28:31], s7 offen offset:3072 sc1
    v_mfma_f32_16x16x32_bf16 v[44:47], a[164:167], a[16:19], v[44:47]
    v_mfma_f32_16x16x32_bf16 v[72:75], a[164:167], a[20:23], v[72:75]
    ds_read_b128 a[160:163], v13 offset:61440
    v_mfma_f32_16x16x32_bf16 v[56:59], a[168:171], a[16:19], v[56:59]
    v_mfma_f32_16x16x32_bf16 v[84:87], a[168:171], a[20:23], v[84:87]
    ds_read_b128 a[164:167], v12 offset:20480
    s_waitcnt vmcnt(8) lgkmcnt(6)
    v_mfma_f32_16x16x32_bf16 v[32:35], a[172:175], a[24:27], v[32:35]
    v_mfma_f32_16x16x32_bf16 v[60:63], a[172:175], a[28:31], v[60:63]
    ds_read_b128 a[168:171], v12 offset:21504
    s_add_u32 s6, s6, 4096
    s_add_u32 s7, s7, 4096
    buffer_load_dwordx4 a[64:67], v8, s[28:31], s6 offen offset:0 sc1
    v_mfma_f32_16x16x32_bf16 v[36:39], a[176:179], a[24:27], v[36:39]
    v_mfma_f32_16x16x32_bf16 v[64:67], a[176:179], a[28:31], v[64:67]
    ds_read_b128 a[172:175], v12 offset:22528
    v_mfma_f32_16x16x32_bf16 v[40:43], a[180:183], a[24:27], v[40:43]
    v_mfma_f32_16x16x32_bf16 v[68:71], a[180:183], a[28:31], v[68:71]
    ds_read_b128 a[176:179], v12 offset:23552
    buffer_load_dwordx4 a[68:71], v8, s[28:31], s7 offen offset:0 sc1
    v_mfma_f32_16x16x32_bf16 v[44:47], a[184:187], a[24:27], v[44:47]
    v_mfma_f32_16x16x32_bf16 v[72:75], a[184:187], a[28:31], v[72:75]
    ds_read_b128 a[180:183], v13 offset:62464
    v_mfma_f32_16x16x32_bf16 v[56:59], a[188:191], a[24:27], v[56:59]
    v_mfma_f32_16x16x32_bf16 v[84:87], a[188:191], a[28:31], v[84:87]
    ds_read_b128 a[184:187], v12 offset:24576
    s_waitcnt vmcnt(8) lgkmcnt(6)
    v_mfma_f32_16x16x32_bf16 v[32:35], a[192:195], a[32:35], v[32:35]
    v_mfma_f32_16x16x32_bf16 v[60:63], a[192:195], a[36:39], v[60:63]
    ds_read_b128 a[188:191], v12 offset:25600
    buffer_load_dwordx4 a[72:75], v8, s[28:31], s6 offen offset:1024 sc1
    v_mfma_f32_16x16x32_bf16 v[36:39], a[196:199], a[32:35], v[36:39]
    v_mfma_f32_16x16x32_bf16 v[64:67], a[196:199], a[36:39], v[64:67]
    ds_read_b128 a[192:195], v12 offset:26624
    v_mfma_f32_16x16x32_bf16 v[40:43], a[200:203], a[32:35], v[40:43]
    v_mfma_f32_16x16x32_bf16 v[68:71], a[200:203], a[36:39], v[68:71]
    ds_read_b128 a[196:199], v12 offset:27648
    buffer_load_dwordx4 a[76:79], v8, s[28:31], s7 offen offset:1024 sc1
    v_mfma_f32_16x16x32_bf16 v[44:47], a[204:207], a[32:35], v[44:47]
    v_mfma_f32_16x16x32_bf16 v[72:75], a[204:207], a[36:39], v[72:75]
    ds_read_b128 a[200:203], v13 offset:63488
    v_mfma_f32_16x16x32_bf16 v[56:59], a[160:163], a[32:35], v[56:59]
    v_mfma_f32_16x16x32_bf16 v[84:87], a[160:163], a[36:39], v[84:87]
    ds_read_b128 a[204:207], v12 offset:28672
    s_waitcnt vmcnt(8) lgkmcnt(6)
    v_mfma_f32_16x16x32_bf16 v[32:35], a[164:167], a[40:43], v[32:35]
    v_mfma_f32_16x16x32_bf16 v[60:63], a[164:167], a[44:47], v[60:63]
    ds_read_b128 a[160:163], v12 offset:29696
    buffer_load_dwordx4 a[80:83], v8, s[28:31], s6 offen offset:2048 sc1
    v_mfma_f32_16x16x32_bf16 v[36:39], a[168:171], a[40:43], v[36:39]
    v_mfma_f32_16x16x32_bf16 v[64:67], a[168:171], a[44:47], v[64:67]
    ds_read_b128 a[164:167], v12 offset:30720
    v_mfma_f32_16x16x32_bf16 v[40:43], a[172:175], a[40:43], v[40:43]
    v_mfma_f32_16x16x32_bf16 v[68:71], a[172:175], a[44:47], v[68:71]
    ds_read_b128 a[168:171], v12 offset:31744
    buffer_load_dwordx4 a[84:87], v8, s[28:31], s7 offen offset:2048 sc1
    v_mfma_f32_16x16x32_bf16 v[44:47], a[176:179], a[40:43], v[44:47]
    v_mfma_f32_16x16x32_bf16 v[72:75], a[176:179], a[44:47], v[72:75]
    ds_read_b128 a[172:175], v13 offset:64512
    v_mfma_f32_16x16x32_bf16 v[56:59], a[180:183], a[40:43], v[56:59]
    v_mfma_f32_16x16x32_bf16 v[84:87], a[180:183], a[44:47], v[84:87]
    ds_read_b128 a[176:179], v12 offset:32768
    s_waitcnt vmcnt(8) lgkmcnt(6)
    v_mfma_f32_16x16x32_bf16 v[32:35], a[184:187], a[48:51], v[32:35]
    v_mfma_f32_16x16x32_bf16 v[60:63], a[184:187], a[52:55], v[60:63]
    ds_read_b128 a[180:183], v12 offset:33792
    buffer_load_dwordx4 a[88:91], v8, s[28:31], s6 offen offset:3072 sc1
    v_mfma_f32_16x16x32_bf16 v[36:39], a[188:191], a[48:51], v[36:39]
    v_mfma_f32_16x16x32_bf16 v[64:67], a[188:191], a[52:55], v[64:67]
    ds_read_b128 a[184:187], v12 offset:34816
    v_mfma_f32_16x16x32_bf16 v[40:43], a[192:195], a[48:51], v[40:43]
    v_mfma_f32_16x16x32_bf16 v[68:71], a[192:195], a[52:55], v[68:71]
    ds_read_b128 a[188:191], v12 offset:35840
    buffer_load_dwordx4 a[92:95], v8, s[28:31], s7 offen offset:3072 sc1
    v_mfma_f32_16x16x32_bf16 v[44:47], a[196:199], a[48:51], v[44:47]
    v_mfma_f32_16x16x32_bf16 v[72:75], a[196:199], a[52:55], v[72:75]
    ds_read_b128 a[192:195], v14 offset:0
    v_mfma_f32_16x16x32_bf16 v[56:59], a[200:203], a[48:51], v[56:59]
    v_mfma_f32_16x16x32_bf16 v[84:87], a[200:203], a[52:55], v[84:87]
    ds_read_b128 a[196:199], v12 offset:36864
    s_waitcnt vmcnt(8) lgkmcnt(6)
    v_mfma_f32_16x16x32_bf16 v[32:35], a[204:207], a[56:59], v[32:35]
    v_mfma_f32_16x16x32_bf16 v[60:63], a[204:207], a[60:63], v[60:63]
    ds_read_b128 a[200:203], v12 offset:37888
    s_add_u32 s6, s6, 4096
    s_add_u32 s7, s7, 4096
    buffer_load_dwordx4 a[96:99], v8, s[28:31], s6 offen offset:0 sc1
    v_mfma_f32_16x16x32_bf16 v[36:39], a[160:163], a[56:59], v[36:39]
    v_mfma_f32_16x16x32_bf16 v[64:67], a[160:163], a[60:63], v[64:67]
    ds_read_b128 a[204:207], v12 offset:38912
    v_mfma_f32_16x16x32_bf16 v[40:43], a[164:167], a[56:59], v[40:43]
    v_mfma_f32_16x16x32_bf16 v[68:71], a[164:167], a[60:63], v[68:71]
    ds_read_b128 a[160:163], v12 offset:39936
    buffer_load_dwordx4 a[100:103], v8, s[28:31], s7 offen offset:0 sc1
    v_mfma_f32_16x16x32_bf16 v[44:47], a[168:171], a[56:59], v[44:47]
    v_mfma_f32_16x16x32_bf16 v[72:75], a[168:171], a[60:63], v[72:75]
    ds_read_b128 a[164:167], v14 offset:1024
    v_mfma_f32_16x16x32_bf16 v[56:59], a[172:175], a[56:59], v[56:59]
    v_mfma_f32_16x16x32_bf16 v[84:87], a[172:175], a[60:63], v[84:87]
    ds_read_b128 a[168:171], v12 offset:40960
    s_waitcnt vmcnt(8) lgkmcnt(6)
    v_mfma_f32_16x16x32_bf16 v[32:35], a[176:179], a[64:67], v[32:35]
    v_mfma_f32_16x16x32_bf16 v[60:63], a[176:179], a[68:71], v[60:63]
    ds_read_b128 a[172:175], v12 offset:41984
    buffer_load_dwordx4 a[104:107], v8, s[28:31], s6 offen offset:1024 sc1
    v_mfma_f32_16x16x32_bf16 v[36:39], a[180:183], a[64:67], v[36:39]
    v_mfma_f32_16x16x32_bf16 v[64:67], a[180:183], a[68:71], v[64:67]
    ds_read_b128 a[176:179], v12 offset:43008
    v_mfma_f32_16x16x32_bf16 v[40:43], a[184:187], a[64:67], v[40:43]
    v_mfma_f32_16x16x32_bf16 v[68:71], a[184:187], a[68:71], v[68:71]
    ds_read_b128 a[180:183], v12 offset:44032
    buffer_load_dwordx4 a[108:111], v8, s[28:31], s7 offen offset:1024 sc1
    v_mfma_f32_16x16x32_bf16 v[44:47], a[188:191], a[64:67], v[44:47]
    v_mfma_f32_16x16x32_bf16 v[72:75], a[188:191], a[68:71], v[72:75]
    ds_read_b128 a[184:187], v14 offset:2048
    v_mfma_f32_16x16x32_bf16 v[56:59], a[192:195], a[64:67], v[56:59]
    v_mfma_f32_16x16x32_bf16 v[84:87], a[192:195], a[68:71], v[84:87]
    ds_read_b128 a[188:191], v12 offset:45056
    buffer_load_dwordx4 a[112:115], v8, s[28:31], s6 offen offset:2048 sc1
    s_waitcnt vmcnt(9) lgkmcnt(6)
    v_mfma_f32_16x16x32_bf16 v[32:35], a[196:199], a[72:75], v[32:35]
    v_mfma_f32_16x16x32_bf16 v[60:63], a[196:199], a[76:79], v[60:63]
    ds_read_b128 a[192:195], v12 offset:46080
    buffer_load_dwordx4 a[116:119], v8, s[28:31], s7 offen offset:2048 sc1
    v_mfma_f32_16x16x32_bf16 v[36:39], a[200:203], a[72:75], v[36:39]
    v_mfma_f32_16x16x32_bf16 v[64:67], a[200:203], a[76:79], v[64:67]
    ds_read_b128 a[196:199], v12 offset:47104
    v_mfma_f32_16x16x32_bf16 v[40:43], a[204:207], a[72:75], v[40:43]
    v_mfma_f32_16x16x32_bf16 v[68:71], a[204:207], a[76:79], v[68:71]
    ds_read_b128 a[200:203], v12 offset:48128
    buffer_load_dwordx4 a[120:123], v8, s[28:31], s6 offen offset:3072 sc1
    v_mfma_f32_16x16x32_bf16 v[44:47], a[160:163], a[72:75], v[44:47]
    v_mfma_f32_16x16x32_bf16 v[72:75], a[160:163], a[76:79], v[72:75]
    ds_read_b128 a[204:207], v14 offset:3072
    v_mfma_f32_16x16x32_bf16 v[56:59], a[164:167], a[72:75], v[56:59]
    v_mfma_f32_16x16x32_bf16 v[84:87], a[164:167], a[76:79], v[84:87]
    ds_read_b128 a[160:163], v12 offset:49152
    buffer_load_dwordx4 a[124:127], v8, s[28:31], s7 offen offset:3072 sc1
    s_waitcnt vmcnt(10) lgkmcnt(6)
    v_mfma_f32_16x16x32_bf16 v[32:35], a[168:171], a[80:83], v[32:35]
    v_mfma_f32_16x16x32_bf16 v[60:63], a[168:171], a[84:87], v[60:63]
    ds_read_b128 a[164:167], v12 offset:50176
    s_add_u32 s6, s6, 4096
    s_add_u32 s7, s7, 4096
    buffer_load_dwordx4 a[128:131], v8, s[28:31], s6 offen offset:0 sc1
    v_mfma_f32_16x16x32_bf16 v[36:39], a[172:175], a[80:83], v[36:39]
    v_mfma_f32_16x16x32_bf16 v[64:67], a[172:175], a[84:87], v[64:67]
    ds_read_b128 a[168:171], v12 offset:51200
    v_mfma_f32_16x16x32_bf16 v[40:43], a[176:179], a[80:83], v[40:43]
    v_mfma_f32_16x16x32_bf16 v[68:71], a[176:179], a[84:87], v[68:71]
    ds_read_b128 a[172:175], v12 offset:52224
    buffer_load_dwordx4 a[132:135], v8, s[28:31], s7 offen offset:0 sc1
    v_mfma_f32_16x16x32_bf16 v[44:47], a[180:183], a[80:83], v[44:47]
    v_mfma_f32_16x16x32_bf16 v[72:75], a[180:183], a[84:87], v[72:75]
    ds_read_b128 a[176:179], v14 offset:4096
    v_mfma_f32_16x16x32_bf16 v[56:59], a[184:187], a[80:83], v[56:59]
    v_mfma_f32_16x16x32_bf16 v[84:87], a[184:187], a[84:87], v[84:87]
    ds_read_b128 a[180:183], v12 offset:53248
    buffer_load_dwordx4 a[136:139], v8, s[28:31], s6 offen offset:1024 sc1
    s_waitcnt vmcnt(11) lgkmcnt(6)
    v_mfma_f32_16x16x32_bf16 v[32:35], a[188:191], a[88:91], v[32:35]
    v_mfma_f32_16x16x32_bf16 v[60:63], a[188:191], a[92:95], v[60:63]
    ds_read_b128 a[184:187], v12 offset:54272
    buffer_load_dwordx4 a[140:143], v8, s[28:31], s7 offen offset:1024 sc1
    v_mfma_f32_16x16x32_bf16 v[36:39], a[192:195], a[88:91], v[36:39]
    v_mfma_f32_16x16x32_bf16 v[64:67], a[192:195], a[92:95], v[64:67]
    ds_read_b128 a[188:191], v12 offset:55296
    v_mfma_f32_16x16x32_bf16 v[40:43], a[196:199], a[88:91], v[40:43]
    v_mfma_f32_16x16x32_bf16 v[68:71], a[196:199], a[92:95], v[68:71]
    ds_read_b128 a[192:195], v12 offset:56320
    buffer_load_dwordx4 a[144:147], v8, s[28:31], s6 offen offset:2048 sc1
    v_mfma_f32_16x16x32_bf16 v[44:47], a[200:203], a[88:91], v[44:47]
    v_mfma_f32_16x16x32_bf16 v[72:75], a[200:203], a[92:95], v[72:75]
    ds_read_b128 a[196:199], v14 offset:5120
    v_mfma_f32_16x16x32_bf16 v[56:59], a[204:207], a[88:91], v[56:59]
    v_mfma_f32_16x16x32_bf16 v[84:87], a[204:207], a[92:95], v[84:87]
    ds_read_b128 a[200:203], v12 offset:57344
    buffer_load_dwordx4 a[148:151], v8, s[28:31], s7 offen offset:2048 sc1
    s_waitcnt vmcnt(12) lgkmcnt(6)
    v_mfma_f32_16x16x32_bf16 v[32:35], a[160:163], a[96:99], v[32:35]
    v_mfma_f32_16x16x32_bf16 v[60:63], a[160:163], a[100:103], v[60:63]
    ds_read_b128 a[204:207], v12 offset:58368
    buffer_load_dwordx4 a[152:155], v8, s[28:31], s6 offen offset:3072 sc1
    v_mfma_f32_16x16x32_bf16 v[36:39], a[164:167], a[96:99], v[36:39]
    v_mfma_f32_16x16x32_bf16 v[64:67], a[164:167], a[100:103], v[64:67]
    ds_read_b128 a[160:163], v12 offset:59392
    v_mfma_f32_16x16x32_bf16 v[40:43], a[168:171], a[96:99], v[40:43]
    v_mfma_f32_16x16x32_bf16 v[68:71], a[168:171], a[100:103], v[68:71]
    ds_read_b128 a[164:167], v12 offset:60416
    buffer_load_dwordx4 a[156:159], v8, s[28:31], s7 offen offset:3072 sc1
    v_mfma_f32_16x16x32_bf16 v[44:47], a[172:175], a[96:99], v[44:47]
    v_mfma_f32_16x16x32_bf16 v[72:75], a[172:175], a[100:103], v[72:75]
    ds_read_b128 a[168:171], v14 offset:6144
    v_mfma_f32_16x16x32_bf16 v[56:59], a[176:179], a[96:99], v[56:59]
    v_mfma_f32_16x16x32_bf16 v[84:87], a[176:179], a[100:103], v[84:87]
    ds_read_b128 a[172:175], v12 offset:61440
    buffer_load_dwordx2 v[16:17], v228, s[28:31], s9 offen offset:0 sc1
    s_waitcnt vmcnt(13) lgkmcnt(6)
    v_mfma_f32_16x16x32_bf16 v[32:35], a[180:183], a[104:107], v[32:35]
    v_mfma_f32_16x16x32_bf16 v[60:63], a[180:183], a[108:111], v[60:63]
    ds_read_b128 a[176:179], v12 offset:62464
    buffer_load_dwordx2 v[18:19], v228, s[28:31], s9 offen offset:128 sc1
    v_mfma_f32_16x16x32_bf16 v[36:39], a[184:187], a[104:107], v[36:39]
    v_mfma_f32_16x16x32_bf16 v[64:67], a[184:187], a[108:111], v[64:67]
    ds_read_b128 a[180:183], v12 offset:63488
    v_mfma_f32_16x16x32_bf16 v[40:43], a[188:191], a[104:107], v[40:43]
    v_mfma_f32_16x16x32_bf16 v[68:71], a[188:191], a[108:111], v[68:71]
    ds_read_b128 a[184:187], v12 offset:64512
    buffer_load_dwordx2 v[20:21], v228, s[28:31], s9 offen offset:1024 sc1
    v_mfma_f32_16x16x32_bf16 v[44:47], a[192:195], a[104:107], v[44:47]
    v_mfma_f32_16x16x32_bf16 v[72:75], a[192:195], a[108:111], v[72:75]
    ds_read_b128 a[188:191], v14 offset:7168
    v_mfma_f32_16x16x32_bf16 v[56:59], a[196:199], a[104:107], v[56:59]
    v_mfma_f32_16x16x32_bf16 v[84:87], a[196:199], a[108:111], v[84:87]
    ds_read_b128 a[192:195], v13 offset:0
    buffer_load_dwordx2 v[22:23], v228, s[28:31], s9 offen offset:1152 sc1
    s_waitcnt vmcnt(14) lgkmcnt(6)
    v_mfma_f32_16x16x32_bf16 v[32:35], a[200:203], a[112:115], v[32:35]
    v_mfma_f32_16x16x32_bf16 v[60:63], a[200:203], a[116:119], v[60:63]
    ds_read_b128 a[196:199], v13 offset:1024
    s_mov_b32 s26, 5492736
    buffer_load_dwordx2 v[116:117], v235, s[28:31], s26 offen
    v_mfma_f32_16x16x32_bf16 v[36:39], a[204:207], a[112:115], v[36:39]
    v_mfma_f32_16x16x32_bf16 v[64:67], a[204:207], a[116:119], v[64:67]
    ds_read_b128 a[200:203], v13 offset:2048
    v_mfma_f32_16x16x32_bf16 v[40:43], a[160:163], a[112:115], v[40:43]
    v_mfma_f32_16x16x32_bf16 v[68:71], a[160:163], a[116:119], v[68:71]
    ds_read_b128 a[204:207], v13 offset:3072
    s_mov_b32 s26, 5492736
    buffer_load_dwordx2 v[118:119], v236, s[28:31], s26 offen
    v_mfma_f32_16x16x32_bf16 v[44:47], a[164:167], a[112:115], v[44:47]
    v_mfma_f32_16x16x32_bf16 v[72:75], a[164:167], a[116:119], v[72:75]
    ds_read_b128 a[160:163], v14 offset:8192
    v_mfma_f32_16x16x32_bf16 v[56:59], a[168:171], a[112:115], v[56:59]
    v_mfma_f32_16x16x32_bf16 v[84:87], a[168:171], a[116:119], v[84:87]
    ds_read_b128 a[164:167], v13 offset:4096
    s_mov_b32 s26, 5492736
    buffer_load_dwordx2 v[120:121], v237, s[28:31], s26 offen
    s_waitcnt vmcnt(15) lgkmcnt(6)
    v_mfma_f32_16x16x32_bf16 v[32:35], a[172:175], a[120:123], v[32:35]
    v_mfma_f32_16x16x32_bf16 v[60:63], a[172:175], a[124:127], v[60:63]
    ds_read_b128 a[168:171], v13 offset:5120
    s_mov_b32 s26, 5492736
    buffer_load_dwordx2 v[122:123], v238, s[28:31], s26 offen
    v_mfma_f32_16x16x32_bf16 v[36:39], a[176:179], a[120:123], v[36:39]
    v_mfma_f32_16x16x32_bf16 v[64:67], a[176:179], a[124:127], v[64:67]
    ds_read_b128 a[172:175], v13 offset:6144
    v_mfma_f32_16x16x32_bf16 v[40:43], a[180:183], a[120:123], v[40:43]
    v_mfma_f32_16x16x32_bf16 v[68:71], a[180:183], a[124:127], v[68:71]
    ds_read_b128 a[176:179], v13 offset:7168
    s_mov_b32 s26, 5492736
    buffer_load_dwordx2 v[124:125], v239, s[28:31], s26 offen
    v_mfma_f32_16x16x32_bf16 v[44:47], a[184:187], a[120:123], v[44:47]
    v_mfma_f32_16x16x32_bf16 v[72:75], a[184:187], a[124:127], v[72:75]
    ds_read_b128 a[180:183], v14 offset:9216
    v_mfma_f32_16x16x32_bf16 v[56:59], a[188:191], a[120:123], v[56:59]
    v_mfma_f32_16x16x32_bf16 v[84:87], a[188:191], a[124:127], v[84:87]
    ds_read_b128 a[184:187], v13 offset:8192
    buffer_load_dwordx4 v[204:207], v233, s[28:31], s37 offen offset:0
    s_waitcnt vmcnt(16) lgkmcnt(6)
    v_mfma_f32_16x16x32_bf16 v[32:35], a[192:195], a[128:131], v[32:35]
    v_mfma_f32_16x16x32_bf16 v[60:63], a[192:195], a[132:135], v[60:63]
    ds_read_b128 a[188:191], v13 offset:9216
    buffer_load_dwordx4 v[208:211], v233, s[28:31], s37 offen offset:64
    v_mfma_f32_16x16x32_bf16 v[36:39], a[196:199], a[128:131], v[36:39]
    v_mfma_f32_16x16x32_bf16 v[64:67], a[196:199], a[132:135], v[64:67]
    ds_read_b128 a[192:195], v13 offset:10240
    v_mfma_f32_16x16x32_bf16 v[40:43], a[200:203], a[128:131], v[40:43]
    v_mfma_f32_16x16x32_bf16 v[68:71], a[200:203], a[132:135], v[68:71]
    ds_read_b128 a[196:199], v13 offset:11264
    buffer_load_dwordx4 v[212:215], v233, s[28:31], s37 offen offset:128
    v_mfma_f32_16x16x32_bf16 v[44:47], a[204:207], a[128:131], v[44:47]
    v_mfma_f32_16x16x32_bf16 v[72:75], a[204:207], a[132:135], v[72:75]
    ds_read_b128 a[200:203], v14 offset:10240
    v_mfma_f32_16x16x32_bf16 v[56:59], a[160:163], a[128:131], v[56:59]
    v_mfma_f32_16x16x32_bf16 v[84:87], a[160:163], a[132:135], v[84:87]
    ds_read_b128 a[204:207], v13 offset:12288
    buffer_load_dwordx4 v[216:219], v233, s[28:31], s37 offen offset:192
    s_waitcnt vmcnt(17) lgkmcnt(6)
    v_mfma_f32_16x16x32_bf16 v[32:35], a[164:167], a[136:139], v[32:35]
    v_mfma_f32_16x16x32_bf16 v[60:63], a[164:167], a[140:143], v[60:63]
    ds_read_b128 a[160:163], v13 offset:13312
    buffer_load_dwordx4 v[220:223], v233, s[28:31], s38 offen
    v_mfma_f32_16x16x32_bf16 v[36:39], a[168:171], a[136:139], v[36:39]
    v_mfma_f32_16x16x32_bf16 v[64:67], a[168:171], a[140:143], v[64:67]
    ds_read_b128 a[164:167], v13 offset:14336
    s_mul_i32 s25, s20, 3
    s_min_u32 s25, s25, 7
    s_lshl_b32 s25, s25, 10
    s_add_u32 s62, s25, 143360
    s_add_u32 s63, s25, s59
    s_add_u32 s63, s63, 0
    s_mov_b32 m0, s62
    buffer_load_dwordx4 v8, s[28:31], s63 offen offset:0 lds
    v_mfma_f32_16x16x32_bf16 v[40:43], a[172:175], a[136:139], v[40:43]
    v_mfma_f32_16x16x32_bf16 v[68:71], a[172:175], a[140:143], v[68:71]
    ds_read_b128 a[168:171], v13 offset:15360
    v_mfma_f32_16x16x32_bf16 v[44:47], a[176:179], a[136:139], v[44:47]
    v_mfma_f32_16x16x32_bf16 v[72:75], a[176:179], a[140:143], v[72:75]
    ds_read_b128 a[172:175], v14 offset:11264
    buffer_load_dwordx4 v8, s[28:31], s63 offen offset:1024 lds
    v_mfma_f32_16x16x32_bf16 v[56:59], a[180:183], a[136:139], v[56:59]
    v_mfma_f32_16x16x32_bf16 v[84:87], a[180:183], a[140:143], v[84:87]
    ds_read_b128 a[176:179], v13 offset:16384
    s_waitcnt vmcnt(18) lgkmcnt(6)
    v_mfma_f32_16x16x32_bf16 v[32:35], a[184:187], a[144:147], v[32:35]
    v_mfma_f32_16x16x32_bf16 v[60:63], a[184:187], a[148:151], v[60:63]
    ds_read_b128 a[180:183], v13 offset:17408
    v_mfma_f32_16x16x32_bf16 v[36:39], a[188:191], a[144:147], v[36:39]
    v_mfma_f32_16x16x32_bf16 v[64:67], a[188:191], a[148:151], v[64:67]
    ds_read_b128 a[184:187], v13 offset:18432
    buffer_load_dwordx4 v8, s[28:31], s63 offen offset:2048 lds
    v_mfma_f32_16x16x32_bf16 v[40:43], a[192:195], a[144:147], v[40:43]
    v_mfma_f32_16x16x32_bf16 v[68:71], a[192:195], a[148:151], v[68:71]
    ds_read_b128 a[188:191], v13 offset:19456
    v_mfma_f32_16x16x32_bf16 v[44:47], a[196:199], a[144:147], v[44:47]
    v_mfma_f32_16x16x32_bf16 v[72:75], a[196:199], a[148:151], v[72:75]
    ds_read_b128 a[192:195], v13 offset:20480
    v_mfma_f32_16x16x32_bf16 v[56:59], a[200:203], a[144:147], v[56:59]
    v_mfma_f32_16x16x32_bf16 v[84:87], a[200:203], a[148:151], v[84:87]
    ds_read_b128 a[196:199], v13 offset:21504
    s_waitcnt vmcnt(17) lgkmcnt(6)
    v_mfma_f32_16x16x32_bf16 v[32:35], a[204:207], a[152:155], v[32:35]
    v_mfma_f32_16x16x32_bf16 v[60:63], a[204:207], a[156:159], v[60:63]
    ds_read_b128 a[200:203], v13 offset:22528
    v_mfma_f32_16x16x32_bf16 v[36:39], a[160:163], a[152:155], v[36:39]
    v_mfma_f32_16x16x32_bf16 v[64:67], a[160:163], a[156:159], v[64:67]
    ds_read_b128 a[204:207], v13 offset:23552
    v_mfma_f32_16x16x32_bf16 v[40:43], a[164:167], a[152:155], v[40:43]
    v_mfma_f32_16x16x32_bf16 v[68:71], a[164:167], a[156:159], v[68:71]
    ds_read_b128 a[160:163], v13 offset:24576
    v_mfma_f32_16x16x32_bf16 v[44:47], a[168:171], a[152:155], v[44:47]
    v_mfma_f32_16x16x32_bf16 v[72:75], a[168:171], a[156:159], v[72:75]
    ds_read_b128 a[164:167], v13 offset:25600
    v_mfma_f32_16x16x32_bf16 v[56:59], a[172:175], a[152:155], v[56:59]
    v_mfma_f32_16x16x32_bf16 v[84:87], a[172:175], a[156:159], v[84:87]
    ds_read_b128 a[168:171], v13 offset:26624
    s_waitcnt lgkmcnt(7)
    v_mfma_f32_16x16x32_bf16 v[48:51], a[176:179], a[0:3], 0
    v_mfma_f32_16x16x32_bf16 v[76:79], a[176:179], a[4:7], 0
    ds_read_b128 a[172:175], v13 offset:27648
    v_mfma_f32_16x16x32_bf16 v[52:55], a[180:183], a[0:3], 0
    v_mfma_f32_16x16x32_bf16 v[80:83], a[180:183], a[4:7], 0
    ds_read_b128 a[176:179], v13 offset:28672
    v_mfma_f32_16x16x32_bf16 v[48:51], a[184:187], a[8:11], v[48:51]
    v_mfma_f32_16x16x32_bf16 v[76:79], a[184:187], a[12:15], v[76:79]
    ds_read_b128 a[180:183], v13 offset:29696
    v_mfma_f32_16x16x32_bf16 v[52:55], a[188:191], a[8:11], v[52:55]
    v_mfma_f32_16x16x32_bf16 v[80:83], a[188:191], a[12:15], v[80:83]
    ds_read_b128 a[184:187], v13 offset:30720
    s_barrier
    s_waitcnt lgkmcnt(7)
    v_mfma_f32_16x16x32_bf16 v[48:51], a[192:195], a[16:19], v[48:51]
    v_mfma_f32_16x16x32_bf16 v[76:79], a[192:195], a[20:23], v[76:79]
    ds_read_b128 a[188:191], v13 offset:31744
    s_mul_i32 s25, s20, 20
    s_lshl_b32 s25, s25, 10
    s_add_u32 s62, s25, 0
    s_add_u32 s63, s25, s59
    s_add_u32 s63, s63, 10240
    s_mov_b32 m0, s62
    buffer_load_dwordx4 v8, s[28:31], s63 offen offset:0 lds
    v_mfma_f32_16x16x32_bf16 v[52:55], a[196:199], a[16:19], v[52:55]
    v_mfma_f32_16x16x32_bf16 v[80:83], a[196:199], a[20:23], v[80:83]
    ds_read_b128 a[192:195], v13 offset:32768
    buffer_load_dwordx4 v8, s[28:31], s63 offen offset:1024 lds
    v_mfma_f32_16x16x32_bf16 v[48:51], a[200:203], a[24:27], v[48:51]
    v_mfma_f32_16x16x32_bf16 v[76:79], a[200:203], a[28:31], v[76:79]
    ds_read_b128 a[196:199], v13 offset:33792
    buffer_load_dwordx4 v8, s[28:31], s63 offen offset:2048 lds
    v_mfma_f32_16x16x32_bf16 v[52:55], a[204:207], a[24:27], v[52:55]
    v_mfma_f32_16x16x32_bf16 v[80:83], a[204:207], a[28:31], v[80:83]
    ds_read_b128 a[200:203], v13 offset:34816
    buffer_load_dwordx4 v8, s[28:31], s63 offen offset:3072 lds
    s_waitcnt lgkmcnt(7)
    v_mfma_f32_16x16x32_bf16 v[48:51], a[160:163], a[32:35], v[48:51]
    v_mfma_f32_16x16x32_bf16 v[76:79], a[160:163], a[36:39], v[76:79]
    ds_read_b128 a[204:207], v13 offset:35840
    s_add_u32 s62, s62, 4096
    s_add_u32 s63, s63, 4096
    s_mov_b32 m0, s62
    buffer_load_dwordx4 v8, s[28:31], s63 offen offset:0 lds
    v_mfma_f32_16x16x32_bf16 v[52:55], a[164:167], a[32:35], v[52:55]
    v_mfma_f32_16x16x32_bf16 v[80:83], a[164:167], a[36:39], v[80:83]
    ds_read_b128 a[160:163], v13 offset:36864
    buffer_load_dwordx4 v8, s[28:31], s63 offen offset:1024 lds
    v_mfma_f32_16x16x32_bf16 v[48:51], a[168:171], a[40:43], v[48:51]
    v_mfma_f32_16x16x32_bf16 v[76:79], a[168:171], a[44:47], v[76:79]
    ds_read_b128 a[164:167], v13 offset:37888
    buffer_load_dwordx4 v8, s[28:31], s63 offen offset:2048 lds
    v_mfma_f32_16x16x32_bf16 v[52:55], a[172:175], a[40:43], v[52:55]
    v_mfma_f32_16x16x32_bf16 v[80:83], a[172:175], a[44:47], v[80:83]
    ds_read_b128 a[168:171], v13 offset:38912
    buffer_load_dwordx4 v8, s[28:31], s63 offen offset:3072 lds
    s_waitcnt lgkmcnt(7)
    v_mfma_f32_16x16x32_bf16 v[48:51], a[176:179], a[48:51], v[48:51]
    v_mfma_f32_16x16x32_bf16 v[76:79], a[176:179], a[52:55], v[76:79]
    ds_read_b128 a[172:175], v13 offset:39936
    s_add_u32 s62, s62, 4096
    s_add_u32 s63, s63, 4096
    s_mov_b32 m0, s62
    buffer_load_dwordx4 v8, s[28:31], s63 offen offset:0 lds
    v_mfma_f32_16x16x32_bf16 v[52:55], a[180:183], a[48:51], v[52:55]
    v_mfma_f32_16x16x32_bf16 v[80:83], a[180:183], a[52:55], v[80:83]
    ds_read_b128 a[176:179], v13 offset:40960
    buffer_load_dwordx4 v8, s[28:31], s63 offen offset:1024 lds
    v_mfma_f32_16x16x32_bf16 v[48:51], a[184:187], a[56:59], v[48:51]
    v_mfma_f32_16x16x32_bf16 v[76:79], a[184:187], a[60:63], v[76:79]
    ds_read_b128 a[180:183], v13 offset:41984
    buffer_load_dwordx4 v8, s[28:31], s63 offen offset:2048 lds
    v_mfma_f32_16x16x32_bf16 v[52:55], a[188:191], a[56:59], v[52:55]
    v_mfma_f32_16x16x32_bf16 v[80:83], a[188:191], a[60:63], v[80:83]
    ds_read_b128 a[184:187], v13 offset:43008
    buffer_load_dwordx4 v8, s[28:31], s63 offen offset:3072 lds
    s_waitcnt lgkmcnt(7)
    v_mfma_f32_16x16x32_bf16 v[48:51], a[192:195], a[64:67], v[48:51]
    v_mfma_f32_16x16x32_bf16 v[76:79], a[192:195], a[68:71], v[76:79]
    ds_read_b128 a[188:191], v13 offset:44032
    s_add_u32 s62, s62, 4096
    s_add_u32 s63, s63, 4096
    s_mov_b32 m0, s62
    buffer_load_dwordx4 v8, s[28:31], s63 offen offset:0 lds
    v_mfma_f32_16x16x32_bf16 v[52:55], a[196:199], a[64:67], v[52:55]
    v_mfma_f32_16x16x32_bf16 v[80:83], a[196:199], a[68:71], v[80:83]
    ds_read_b128 a[192:195], v13 offset:45056
    buffer_load_dwordx4 v8, s[28:31], s63 offen offset:1024 lds
    v_mfma_f32_16x16x32_bf16 v[48:51], a[200:203], a[72:75], v[48:51]
    v_mfma_f32_16x16x32_bf16 v[76:79], a[200:203], a[76:79], v[76:79]
    ds_read_b128 a[196:199], v13 offset:46080
    buffer_load_dwordx4 v8, s[28:31], s63 offen offset:2048 lds
    v_mfma_f32_16x16x32_bf16 v[52:55], a[204:207], a[72:75], v[52:55]
    v_mfma_f32_16x16x32_bf16 v[80:83], a[204:207], a[76:79], v[80:83]
    ds_read_b128 a[200:203], v13 offset:47104
    buffer_load_dwordx4 v8, s[28:31], s63 offen offset:3072 lds
    s_waitcnt lgkmcnt(7)
    v_mfma_f32_16x16x32_bf16 v[48:51], a[160:163], a[80:83], v[48:51]
    v_mfma_f32_16x16x32_bf16 v[76:79], a[160:163], a[84:87], v[76:79]
    ds_read_b128 a[204:207], v13 offset:48128
    s_add_u32 s62, s62, 4096
    s_add_u32 s63, s63, 4096
    s_mov_b32 m0, s62
    buffer_load_dwordx4 v8, s[28:31], s63 offen offset:0 lds
    v_mfma_f32_16x16x32_bf16 v[52:55], a[164:167], a[80:83], v[52:55]
    v_mfma_f32_16x16x32_bf16 v[80:83], a[164:167], a[84:87], v[80:83]
    ds_read_b128 a[160:163], v13 offset:49152
    buffer_load_dwordx4 v8, s[28:31], s63 offen offset:1024 lds
    v_mfma_f32_16x16x32_bf16 v[48:51], a[168:171], a[88:91], v[48:51]
    v_mfma_f32_16x16x32_bf16 v[76:79], a[168:171], a[92:95], v[76:79]
    ds_read_b128 a[164:167], v13 offset:50176
    buffer_load_dwordx4 v8, s[28:31], s63 offen offset:2048 lds
    v_mfma_f32_16x16x32_bf16 v[52:55], a[172:175], a[88:91], v[52:55]
    v_mfma_f32_16x16x32_bf16 v[80:83], a[172:175], a[92:95], v[80:83]
    ds_read_b128 a[168:171], v13 offset:51200
    buffer_load_dwordx4 v8, s[28:31], s63 offen offset:3072 lds
    s_waitcnt lgkmcnt(7)
    v_mfma_f32_16x16x32_bf16 v[48:51], a[176:179], a[96:99], v[48:51]
    v_mfma_f32_16x16x32_bf16 v[76:79], a[176:179], a[100:103], v[76:79]
    ds_read_b128 a[172:175], v13 offset:52224
    s_mul_i32 s25, s20, 3
    s_min_u32 s25, s25, 7
    s_lshl_b32 s25, s25, 10
    s_add_u32 s62, s25, 153600
    s_add_u32 s63, s25, s59
    s_add_u32 s63, s63, 92160
    s_mov_b32 m0, s62
    buffer_load_dwordx4 v8, s[28:31], s63 offen offset:0 lds
    v_mfma_f32_16x16x32_bf16 v[52:55], a[180:183], a[96:99], v[52:55]
    v_mfma_f32_16x16x32_bf16 v[80:83], a[180:183], a[100:103], v[80:83]
    ds_read_b128 a[176:179], v13 offset:53248
    buffer_load_dwordx4 v8, s[28:31], s63 offen offset:1024 lds
    v_mfma_f32_16x16x32_bf16 v[48:51], a[184:187], a[104:107], v[48:51]
    v_mfma_f32_16x16x32_bf16 v[76:79], a[184:187], a[108:111], v[76:79]
    ds_read_b128 a[180:183], v13 offset:54272
    buffer_load_dwordx4 v8, s[28:31], s63 offen offset:2048 lds
    v_mfma_f32_16x16x32_bf16 v[52:55], a[188:191], a[104:107], v[52:55]
    v_mfma_f32_16x16x32_bf16 v[80:83], a[188:191], a[108:111], v[80:83]
    ds_read_b128 a[184:187], v13 offset:55296
    s_mul_i32 s25, s20, 5
    s_lshl_b32 s25, s25, 10
    s_add_u32 s62, s25, 122880
    s_add_u32 s63, s25, s59
    s_add_u32 s63, s63, 102400
    s_mov_b32 m0, s62
    buffer_load_dwordx4 v8, s[28:31], s63 offen offset:0 lds
    s_waitcnt lgkmcnt(7)
    v_mfma_f32_16x16x32_bf16 v[48:51], a[192:195], a[112:115], v[48:51]
    v_mfma_f32_16x16x32_bf16 v[76:79], a[192:195], a[116:119], v[76:79]
    ds_read_b128 a[188:191], v13 offset:56320
    buffer_load_dwordx4 v8, s[28:31], s63 offen offset:1024 lds
    v_mfma_f32_16x16x32_bf16 v[52:55], a[196:199], a[112:115], v[52:55]
    v_mfma_f32_16x16x32_bf16 v[80:83], a[196:199], a[116:119], v[80:83]
    buffer_load_dwordx4 v8, s[28:31], s63 offen offset:2048 lds
    v_mfma_f32_16x16x32_bf16 v[48:51], a[200:203], a[120:123], v[48:51]
    v_mfma_f32_16x16x32_bf16 v[76:79], a[200:203], a[124:127], v[76:79]
    buffer_load_dwordx4 v8, s[28:31], s63 offen offset:3072 lds
    v_mfma_f32_16x16x32_bf16 v[52:55], a[204:207], a[120:123], v[52:55]
    v_mfma_f32_16x16x32_bf16 v[80:83], a[204:207], a[124:127], v[80:83]
    s_add_u32 s62, s62, 4096
    s_add_u32 s63, s63, 4096
    s_mov_b32 m0, s62
    buffer_load_dwordx4 v8, s[28:31], s63 offen offset:0 lds
    s_waitcnt lgkmcnt(4)
    v_mfma_f32_16x16x32_bf16 v[48:51], a[160:163], a[128:131], v[48:51]
    v_mfma_f32_16x16x32_bf16 v[76:79], a[160:163], a[132:135], v[76:79]
    v_mfma_f32_16x16x32_bf16 v[52:55], a[164:167], a[128:131], v[52:55]
    v_mfma_f32_16x16x32_bf16 v[80:83], a[164:167], a[132:135], v[80:83]
    v_mfma_f32_16x16x32_bf16 v[48:51], a[168:171], a[136:139], v[48:51]
    v_mfma_f32_16x16x32_bf16 v[76:79], a[168:171], a[140:143], v[76:79]
    v_mfma_f32_16x16x32_bf16 v[52:55], a[172:175], a[136:139], v[52:55]
    v_mfma_f32_16x16x32_bf16 v[80:83], a[172:175], a[140:143], v[80:83]
    s_waitcnt lgkmcnt(0)
    v_mfma_f32_16x16x32_bf16 v[48:51], a[176:179], a[144:147], v[48:51]
    v_mfma_f32_16x16x32_bf16 v[76:79], a[176:179], a[148:151], v[76:79]
    v_mfma_f32_16x16x32_bf16 v[52:55], a[180:183], a[144:147], v[52:55]
    v_mfma_f32_16x16x32_bf16 v[80:83], a[180:183], a[148:151], v[80:83]
    v_mfma_f32_16x16x32_bf16 v[48:51], a[184:187], a[152:155], v[48:51]
    v_mfma_f32_16x16x32_bf16 v[76:79], a[184:187], a[156:159], v[76:79]
    v_mfma_f32_16x16x32_bf16 v[52:55], a[188:191], a[152:155], v[52:55]
    v_mfma_f32_16x16x32_bf16 v[80:83], a[188:191], a[156:159], v[80:83]
    s_barrier
    s_mul_i32 s26, s22, 5120
    s_add_u32 s55, s59, s26
    s_add_u32 s55, s55, 194560
    s_waitcnt vmcnt(41)
    v_add_f32 v16, v16, v18
    v_add_f32 v17, v17, v19
    v_add_f32 v20, v20, v22
    v_add_f32 v21, v21, v23
    s_nop 0
    v_mov_b32 v24, v16
    v_mov_b32 v25, v17
    v_mov_b32 v26, v20
    v_mov_b32 v27, v21
    s_nop 1
    v_permlane32_swap_b32 v24, v16
    v_permlane32_swap_b32 v25, v17
    v_permlane32_swap_b32 v26, v20
    v_permlane32_swap_b32 v27, v21
    s_mul_i32 s25, s20, 10
    s_lshl_b32 s25, s25, 10
    s_add_u32 s62, s25, 81920
    s_add_u32 s63, s25, s59
    s_add_u32 s63, s63, 122880
    s_mov_b32 m0, s62
    buffer_load_dwordx4 v8, s[28:31], s63 offen offset:0 lds
    s_nop 1
    v_add_f32 v16, v16, v24
    v_add_f32 v17, v17, v25
    v_add_f32 v20, v20, v26
    v_add_f32 v21, v21, v27
    v_mov_b32 v24, v16
    v_mov_b32 v25, v17
    v_mov_b32 v26, v20
    v_mov_b32 v27, v21
    s_nop 1
    v_permlane16_swap_b32 v24, v16
    v_permlane16_swap_b32 v25, v17
    v_permlane16_swap_b32 v26, v20
    v_permlane16_swap_b32 v27, v21
    s_nop 1
    v_add_f32 v16, v16, v24
    buffer_load_dwordx4 v8, s[28:31], s63 offen offset:1024 lds
    v_add_f32 v17, v17, v25
    v_add_f32 v20, v20, v26
    v_add_f32 v21, v21, v27
    v_mul_f32 v16, 0x3acccccd, v16
    v_mul_f32 v20, 0x3acccccd, v20
    v_mul_f32 v17, 0x3acccccd, v17
    v_mul_f32 v21, 0x3acccccd, v21
    v_fma_f32 v17, -v16, v16, v17
    v_fma_f32 v21, -v20, v20, v21
    v_max_f32 v17, 0, v17
    v_max_f32 v21, 0, v21
    v_cvt_pk_bf16_f32 v18, v16, v17
    v_cvt_pk_bf16_f32 v22, v20, v21
    v_lshlrev_b32 v16, 16, v18
    v_lshlrev_b32 v20, 16, v22
    v_and_b32 v17, 0xffff0000, v18
    v_and_b32 v21, 0xffff0000, v22
    v_add_f32 v17, 0x3727c5ac, v17
    v_add_f32 v21, 0x3727c5ac, v21
    buffer_load_dwordx4 v8, s[28:31], s63 offen offset:2048 lds
    v_cvt_pk_bf16_f32 v18, v17, v17
    v_cvt_pk_bf16_f32 v22, v21, v21
    v_lshlrev_b32 v17, 16, v18
    v_lshlrev_b32 v21, 16, v22
    v_sqrt_f32 v17, v17
    v_sqrt_f32 v21, v21
    s_nop 0
    s_nop 0
    v_cvt_pk_bf16_f32 v18, v17, v17
    v_cvt_pk_bf16_f32 v22, v21, v21
    v_lshlrev_b32 v17, 16, v18
    v_lshlrev_b32 v21, 16, v22
    v_rcp_f32 v17, v17
    v_rcp_f32 v21, v21
    s_nop 0
    s_nop 0
    v_mul_f32 v16, v16, v17
    buffer_load_dwordx4 v8, s[28:31], s63 offen offset:3072 lds
    v_mul_f32 v20, v20, v21
    v_sub_f32 v16, 0, v16
    v_sub_f32 v20, 0, v20
    v_mov_b32 v30, 0xbdd2d3e8
    v_mov_b32 v31, 0xc0135761
    v_pk_mul_f32 v[176:177], v[88:89], v[16:17] op_sel_hi:[1,0]
    v_pk_mul_f32 v[178:179], v[90:91], v[16:17] op_sel_hi:[1,0]
    v_pk_mul_f32 v[180:181], v[92:93], v[16:17] op_sel_hi:[1,0]
    v_pk_mul_f32 v[182:183], v[94:95], v[16:17] op_sel_hi:[1,0]
    v_pk_mul_f32 v[184:185], v[96:97], v[16:17] op_sel_hi:[1,0]
    v_pk_mul_f32 v[186:187], v[98:99], v[16:17] op_sel_hi:[1,0]
    v_pk_mul_f32 v[188:189], v[100:101], v[16:17] op_sel_hi:[1,0]
    v_pk_mul_f32 v[190:191], v[102:103], v[16:17] op_sel_hi:[1,0]
    v_pk_mul_f32 v[192:193], v[104:105], v[16:17] op_sel_hi:[1,0]
    v_pk_mul_f32 v[194:195], v[106:107], v[16:17] op_sel_hi:[1,0]
    v_pk_mul_f32 v[196:197], v[108:109], v[16:17] op_sel_hi:[1,0]
    v_pk_mul_f32 v[198:199], v[110:111], v[16:17] op_sel_hi:[1,0]
    v_pk_mul_f32 v[200:201], v[112:113], v[16:17] op_sel_hi:[1,0]
    v_pk_mul_f32 v[202:203], v[114:115], v[16:17] op_sel_hi:[1,0]
    s_add_u32 s62, s62, 4096
    s_add_u32 s63, s63, 4096
    s_mov_b32 m0, s62
    buffer_load_dwordx4 v8, s[28:31], s63 offen offset:0 lds
    v_pk_fma_f32 v[32:33], v[32:33], v[16:17], v[176:177] op_sel:[0,1,0] op_sel_hi:[1,1,1]
    v_pk_fma_f32 v[34:35], v[34:35], v[16:17], v[178:179] op_sel:[0,1,0] op_sel_hi:[1,1,1]
    v_pk_fma_f32 v[36:37], v[36:37], v[16:17], v[180:181] op_sel:[0,1,0] op_sel_hi:[1,1,1]
    v_pk_fma_f32 v[38:39], v[38:39], v[16:17], v[182:183] op_sel:[0,1,0] op_sel_hi:[1,1,1]
    v_pk_fma_f32 v[40:41], v[40:41], v[16:17], v[184:185] op_sel:[0,1,0] op_sel_hi:[1,1,1]
    v_pk_fma_f32 v[42:43], v[42:43], v[16:17], v[186:187] op_sel:[0,1,0] op_sel_hi:[1,1,1]
    v_pk_fma_f32 v[44:45], v[44:45], v[16:17], v[188:189] op_sel:[0,1,0] op_sel_hi:[1,1,1]
    v_pk_fma_f32 v[46:47], v[46:47], v[16:17], v[190:191] op_sel:[0,1,0] op_sel_hi:[1,1,1]
    v_pk_fma_f32 v[48:49], v[48:49], v[16:17], v[192:193] op_sel:[0,1,0] op_sel_hi:[1,1,1]
    v_pk_fma_f32 v[50:51], v[50:51], v[16:17], v[194:195] op_sel:[0,1,0] op_sel_hi:[1,1,1]
    v_pk_fma_f32 v[52:53], v[52:53], v[16:17], v[196:197] op_sel:[0,1,0] op_sel_hi:[1,1,1]
    v_pk_fma_f32 v[54:55], v[54:55], v[16:17], v[198:199] op_sel:[0,1,0] op_sel_hi:[1,1,1]
    v_pk_fma_f32 v[56:57], v[56:57], v[16:17], v[200:201] op_sel:[0,1,0] op_sel_hi:[1,1,1]
    v_pk_fma_f32 v[58:59], v[58:59], v[16:17], v[202:203] op_sel:[0,1,0] op_sel_hi:[1,1,1]
    v_pk_mul_f32 v[176:177], v[32:33], v[32:33]
    v_pk_mul_f32 v[178:179], v[34:35], v[34:35]
    v_pk_mul_f32 v[180:181], v[36:37], v[36:37]
    v_pk_mul_f32 v[182:183], v[38:39], v[38:39]
    v_pk_mul_f32 v[184:185], v[40:41], v[40:41]
    buffer_load_dwordx4 v8, s[28:31], s63 offen offset:1024 lds
    v_pk_mul_f32 v[186:187], v[42:43], v[42:43]
    v_pk_mul_f32 v[188:189], v[44:45], v[44:45]
    v_pk_mul_f32 v[190:191], v[46:47], v[46:47]
    v_pk_mul_f32 v[192:193], v[48:49], v[48:49]
    v_pk_mul_f32 v[194:195], v[50:51], v[50:51]
    v_pk_mul_f32 v[196:197], v[52:53], v[52:53]
    v_pk_mul_f32 v[198:199], v[54:55], v[54:55]
    v_pk_mul_f32 v[200:201], v[56:57], v[56:57]
    v_pk_mul_f32 v[202:203], v[58:59], v[58:59]
    v_pk_fma_f32 v[176:177], v[176:177], v[30:31], v[30:31] op_sel:[0,0,1] op_sel_hi:[1,0,1]
    v_pk_fma_f32 v[178:179], v[178:179], v[30:31], v[30:31] op_sel:[0,0,1] op_sel_hi:[1,0,1]
    v_pk_fma_f32 v[180:181], v[180:181], v[30:31], v[30:31] op_sel:[0,0,1] op_sel_hi:[1,0,1]
    v_pk_fma_f32 v[182:183], v[182:183], v[30:31], v[30:31] op_sel:[0,0,1] op_sel_hi:[1,0,1]
    v_pk_fma_f32 v[184:185], v[184:185], v[30:31], v[30:31] op_sel:[0,0,1] op_sel_hi:[1,0,1]
    v_pk_fma_f32 v[186:187], v[186:187], v[30:31], v[30:31] op_sel:[0,0,1] op_sel_hi:[1,0,1]
    v_pk_fma_f32 v[188:189], v[188:189], v[30:31], v[30:31] op_sel:[0,0,1] op_sel_hi:[1,0,1]
    v_pk_fma_f32 v[190:191], v[190:191], v[30:31], v[30:31] op_sel:[0,0,1] op_sel_hi:[1,0,1]
    v_pk_fma_f32 v[192:193], v[192:193], v[30:31], v[30:31] op_sel:[0,0,1] op_sel_hi:[1,0,1]
    v_pk_fma_f32 v[194:195], v[194:195], v[30:31], v[30:31] op_sel:[0,0,1] op_sel_hi:[1,0,1]
    buffer_load_dwordx4 v8, s[28:31], s63 offen offset:2048 lds
    v_pk_fma_f32 v[196:197], v[196:197], v[30:31], v[30:31] op_sel:[0,0,1] op_sel_hi:[1,0,1]
    v_pk_fma_f32 v[198:199], v[198:199], v[30:31], v[30:31] op_sel:[0,0,1] op_sel_hi:[1,0,1]
    v_pk_fma_f32 v[200:201], v[200:201], v[30:31], v[30:31] op_sel:[0,0,1] op_sel_hi:[1,0,1]
    v_pk_fma_f32 v[202:203], v[202:203], v[30:31], v[30:31] op_sel:[0,0,1] op_sel_hi:[1,0,1]
    v_pk_mul_f32 v[176:177], v[176:177], v[32:33]
    v_pk_mul_f32 v[178:179], v[178:179], v[34:35]
    v_pk_mul_f32 v[180:181], v[180:181], v[36:37]
    v_pk_mul_f32 v[182:183], v[182:183], v[38:39]
    v_pk_mul_f32 v[184:185], v[184:185], v[40:41]
    v_pk_mul_f32 v[186:187], v[186:187], v[42:43]
    v_pk_mul_f32 v[188:189], v[188:189], v[44:45]
    v_pk_mul_f32 v[190:191], v[190:191], v[46:47]
    v_pk_mul_f32 v[192:193], v[192:193], v[48:49]
    v_pk_mul_f32 v[194:195], v[194:195], v[50:51]
    v_pk_mul_f32 v[196:197], v[196:197], v[52:53]
    v_pk_mul_f32 v[198:199], v[198:199], v[54:55]
    v_pk_mul_f32 v[200:201], v[200:201], v[56:57]
    v_pk_mul_f32 v[202:203], v[202:203], v[58:59]
    v_exp_f32 v176, v176
    buffer_load_dwordx4 v8, s[28:31], s63 offen offset:3072 lds
    v_exp_f32 v177, v177
    v_exp_f32 v178, v178
    v_exp_f32 v179, v179
    v_exp_f32 v180, v180
    v_exp_f32 v181, v181
    v_exp_f32 v182, v182
    v_exp_f32 v183, v183
    v_exp_f32 v184, v184
    v_exp_f32 v185, v185
    v_exp_f32 v186, v186
    s_add_u32 s62, s62, 4096
    s_add_u32 s63, s63, 4096
    s_mov_b32 m0, s62
    buffer_load_dwordx4 v8, s[28:31], s63 offen offset:0 lds
    v_exp_f32 v187, v187
    v_exp_f32 v188, v188
    v_exp_f32 v189, v189
    v_exp_f32 v190, v190
    v_exp_f32 v191, v191
    v_exp_f32 v192, v192
    v_exp_f32 v193, v193
    v_exp_f32 v194, v194
    v_exp_f32 v195, v195
    v_exp_f32 v196, v196
    buffer_load_dwordx4 v8, s[28:31], s63 offen offset:1024 lds
    v_exp_f32 v197, v197
    v_exp_f32 v198, v198
    v_exp_f32 v199, v199
    v_exp_f32 v200, v200
    v_exp_f32 v201, v201
    v_exp_f32 v202, v202
    v_exp_f32 v203, v203
    v_pk_add_f32 v[176:177], v[176:177], 1.0 op_sel_hi:[1,0]
    v_pk_add_f32 v[178:179], v[178:179], 1.0 op_sel_hi:[1,0]
    v_pk_add_f32 v[180:181], v[180:181], 1.0 op_sel_hi:[1,0]
    v_pk_add_f32 v[182:183], v[182:183], 1.0 op_sel_hi:[1,0]
    v_pk_add_f32 v[184:185], v[184:185], 1.0 op_sel_hi:[1,0]
    buffer_load_dwordx4 a[96:99], v8, s[28:31], s55 offen offset:0
    v_pk_add_f32 v[186:187], v[186:187], 1.0 op_sel_hi:[1,0]
    v_pk_add_f32 v[188:189], v[188:189], 1.0 op_sel_hi:[1,0]
    v_pk_add_f32 v[190:191], v[190:191], 1.0 op_sel_hi:[1,0]
    v_pk_add_f32 v[192:193], v[192:193], 1.0 op_sel_hi:[1,0]
    v_pk_add_f32 v[194:195], v[194:195], 1.0 op_sel_hi:[1,0]
    v_pk_add_f32 v[196:197], v[196:197], 1.0 op_sel_hi:[1,0]
    v_pk_add_f32 v[198:199], v[198:199], 1.0 op_sel_hi:[1,0]
    v_pk_add_f32 v[200:201], v[200:201], 1.0 op_sel_hi:[1,0]
    v_pk_add_f32 v[202:203], v[202:203], 1.0 op_sel_hi:[1,0]
    v_rcp_f32 v176, v176
    v_rcp_f32 v177, v177
    v_rcp_f32 v178, v178
    v_rcp_f32 v179, v179
    v_rcp_f32 v180, v180
    buffer_load_dwordx4 a[100:103], v8, s[28:31], s55 offen offset:1024
    v_rcp_f32 v181, v181
    v_rcp_f32 v182, v182
    v_rcp_f32 v183, v183
    v_rcp_f32 v184, v184
    v_rcp_f32 v185, v185
    v_rcp_f32 v186, v186
    v_rcp_f32 v187, v187
    v_rcp_f32 v188, v188
    v_rcp_f32 v189, v189
    v_rcp_f32 v190, v190
    buffer_load_dwordx4 a[104:107], v8, s[28:31], s55 offen offset:2048
    v_rcp_f32 v191, v191
    v_rcp_f32 v192, v192
    v_rcp_f32 v193, v193
    v_rcp_f32 v194, v194
    v_rcp_f32 v195, v195
    v_rcp_f32 v196, v196
    v_rcp_f32 v197, v197
    v_rcp_f32 v198, v198
    v_rcp_f32 v199, v199
    v_rcp_f32 v200, v200
    buffer_load_dwordx4 a[108:111], v8, s[28:31], s55 offen offset:3072
    v_rcp_f32 v201, v201
    v_rcp_f32 v202, v202
    v_rcp_f32 v203, v203
    v_pk_mul_f32 v[32:33], v[32:33], v[176:177]
    v_pk_mul_f32 v[34:35], v[34:35], v[178:179]
    v_pk_mul_f32 v[36:37], v[36:37], v[180:181]
    v_pk_mul_f32 v[38:39], v[38:39], v[182:183]
    v_pk_mul_f32 v[40:41], v[40:41], v[184:185]
    v_pk_mul_f32 v[42:43], v[42:43], v[186:187]
    v_pk_mul_f32 v[44:45], v[44:45], v[188:189]
    v_pk_mul_f32 v[46:47], v[46:47], v[190:191]
    v_pk_mul_f32 v[48:49], v[48:49], v[192:193]
    v_pk_mul_f32 v[50:51], v[50:51], v[194:195]
    v_pk_mul_f32 v[52:53], v[52:53], v[196:197]
    v_pk_mul_f32 v[54:55], v[54:55], v[198:199]
    v_pk_mul_f32 v[56:57], v[56:57], v[200:201]
    s_add_u32 s55, s55, 4096
    buffer_load_dwordx4 a[112:115], v8, s[28:31], s55 offen offset:0
    s_add_u32 s55, s55, 6144
    v_pk_mul_f32 v[58:59], v[58:59], v[202:203]
    v_cvt_pk_bf16_f32 v144, v32, v33
    v_cvt_pk_bf16_f32 v145, v34, v35
    v_cvt_pk_bf16_f32 v146, v36, v37
    v_cvt_pk_bf16_f32 v147, v38, v39
    v_cvt_pk_bf16_f32 v148, v40, v41
    v_cvt_pk_bf16_f32 v149, v42, v43
    v_cvt_pk_bf16_f32 v150, v44, v45
    v_cvt_pk_bf16_f32 v151, v46, v47
    v_cvt_pk_bf16_f32 v152, v48, v49
    v_cvt_pk_bf16_f32 v153, v50, v51
    v_cvt_pk_bf16_f32 v154, v52, v53
    v_cvt_pk_bf16_f32 v155, v54, v55
    v_cvt_pk_bf16_f32 v156, v56, v57
    v_cvt_pk_bf16_f32 v157, v58, v59
    s_nop 1
    v_permlane16_swap_b32 v144, v146
    v_permlane16_swap_b32 v145, v147
    v_permlane16_swap_b32 v148, v150
    v_permlane16_swap_b32 v149, v151
    v_permlane16_swap_b32 v152, v154
    v_permlane16_swap_b32 v153, v155
    s_add_u32 s26, s13, 0
    s_add_u32 s27, s12, 0
    buffer_store_dwordx4 v[144:147], v226, s[28:31], s26 offen sc1
    buffer_store_dwordx2 v[156:157], v227, s[28:31], s27 offen sc1
    s_cmp_eq_u32 s52, 15
    s_cbranch_scc1 chain_kernel_j157
    buffer_store_dwordx4 v[148:151], v226, s[28:31], s26 offen offset:1024 sc1
    buffer_store_dwordx4 v[152:155], v226, s[28:31], s26 offen offset:2048 sc1
chain_kernel_j157:
    v_pk_mul_f32 v[176:177], v[88:89], v[20:21] op_sel_hi:[1,0]
    buffer_load_dwordx4 a[116:119], v8, s[28:31], s55 offen offset:0
    v_pk_mul_f32 v[178:179], v[90:91], v[20:21] op_sel_hi:[1,0]
    v_pk_mul_f32 v[180:181], v[92:93], v[20:21] op_sel_hi:[1,0]
    v_pk_mul_f32 v[182:183], v[94:95], v[20:21] op_sel_hi:[1,0]
    v_pk_mul_f32 v[184:185], v[96:97], v[20:21] op_sel_hi:[1,0]
    v_pk_mul_f32 v[186:187], v[98:99], v[20:21] op_sel_hi:[1,0]
    v_pk_mul_f32 v[188:189], v[100:101], v[20:21] op_sel_hi:[1,0]
    v_pk_mul_f32 v[190:191], v[102:103], v[20:21] op_sel_hi:[1,0]
    v_pk_mul_f32 v[192:193], v[104:105], v[20:21] op_sel_hi:[1,0]
    v_pk_mul_f32 v[194:195], v[106:107], v[20:21] op_sel_hi:[1,0]
    v_pk_mul_f32 v[196:197], v[108:109], v[20:21] op_sel_hi:[1,0]
    v_pk_mul_f32 v[198:199], v[110:111], v[20:21] op_sel_hi:[1,0]
    v_pk_mul_f32 v[200:201], v[112:113], v[20:21] op_sel_hi:[1,0]
    v_pk_mul_f32 v[202:203], v[114:115], v[20:21] op_sel_hi:[1,0]
    v_pk_fma_f32 v[60:61], v[60:61], v[20:21], v[176:177] op_sel:[0,1,0] op_sel_hi:[1,1,1]
    v_pk_fma_f32 v[62:63], v[62:63], v[20:21], v[178:179] op_sel:[0,1,0] op_sel_hi:[1,1,1]
    v_pk_fma_f32 v[64:65], v[64:65], v[20:21], v[180:181] op_sel:[0,1,0] op_sel_hi:[1,1,1]
    v_pk_fma_f32 v[66:67], v[66:67], v[20:21], v[182:183] op_sel:[0,1,0] op_sel_hi:[1,1,1]
    v_pk_fma_f32 v[68:69], v[68:69], v[20:21], v[184:185] op_sel:[0,1,0] op_sel_hi:[1,1,1]
    v_pk_fma_f32 v[70:71], v[70:71], v[20:21], v[186:187] op_sel:[0,1,0] op_sel_hi:[1,1,1]
    buffer_load_dwordx4 a[120:123], v8, s[28:31], s55 offen offset:1024
    v_pk_fma_f32 v[72:73], v[72:73], v[20:21], v[188:189] op_sel:[0,1,0] op_sel_hi:[1,1,1]
    v_pk_fma_f32 v[74:75], v[74:75], v[20:21], v[190:191] op_sel:[0,1,0] op_sel_hi:[1,1,1]
    v_pk_fma_f32 v[76:77], v[76:77], v[20:21], v[192:193] op_sel:[0,1,0] op_sel_hi:[1,1,1]
    v_pk_fma_f32 v[78:79], v[78:79], v[20:21], v[194:195] op_sel:[0,1,0] op_sel_hi:[1,1,1]
    v_pk_fma_f32 v[80:81], v[80:81], v[20:21], v[196:197] op_sel:[0,1,0] op_sel_hi:[1,1,1]
    v_pk_fma_f32 v[82:83], v[82:83], v[20:21], v[198:199] op_sel:[0,1,0] op_sel_hi:[1,1,1]
    v_pk_fma_f32 v[84:85], v[84:85], v[20:21], v[200:201] op_sel:[0,1,0] op_sel_hi:[1,1,1]
    v_pk_fma_f32 v[86:87], v[86:87], v[20:21], v[202:203] op_sel:[0,1,0] op_sel_hi:[1,1,1]
    v_pk_mul_f32 v[176:177], v[60:61], v[60:61]
    v_pk_mul_f32 v[178:179], v[62:63], v[62:63]
    v_pk_mul_f32 v[180:181], v[64:65], v[64:65]
    v_pk_mul_f32 v[182:183], v[66:67], v[66:67]
    v_pk_mul_f32 v[184:185], v[68:69], v[68:69]
    v_pk_mul_f32 v[186:187], v[70:71], v[70:71]
    v_pk_mul_f32 v[188:189], v[72:73], v[72:73]
    v_pk_mul_f32 v[190:191], v[74:75], v[74:75]
    v_pk_mul_f32 v[192:193], v[76:77], v[76:77]
    v_pk_mul_f32 v[194:195], v[78:79], v[78:79]
    v_pk_mul_f32 v[196:197], v[80:81], v[80:81]
    buffer_load_dwordx4 a[124:127], v8, s[28:31], s55 offen offset:2048
    v_pk_mul_f32 v[198:199], v[82:83], v[82:83]
    v_pk_mul_f32 v[200:201], v[84:85], v[84:85]
    v_pk_mul_f32 v[202:203], v[86:87], v[86:87]
    v_pk_fma_f32 v[176:177], v[176:177], v[30:31], v[30:31] op_sel:[0,0,1] op_sel_hi:[1,0,1]
    v_pk_fma_f32 v[178:179], v[178:179], v[30:31], v[30:31] op_sel:[0,0,1] op_sel_hi:[1,0,1]
    v_pk_fma_f32 v[180:181], v[180:181], v[30:31], v[30:31] op_sel:[0,0,1] op_sel_hi:[1,0,1]
    v_pk_fma_f32 v[182:183], v[182:183], v[30:31], v[30:31] op_sel:[0,0,1] op_sel_hi:[1,0,1]
    v_pk_fma_f32 v[184:185], v[184:185], v[30:31], v[30:31] op_sel:[0,0,1] op_sel_hi:[1,0,1]
    v_pk_fma_f32 v[186:187], v[186:187], v[30:31], v[30:31] op_sel:[0,0,1] op_sel_hi:[1,0,1]
    v_pk_fma_f32 v[188:189], v[188:189], v[30:31], v[30:31] op_sel:[0,0,1] op_sel_hi:[1,0,1]
    v_pk_fma_f32 v[190:191], v[190:191], v[30:31], v[30:31] op_sel:[0,0,1] op_sel_hi:[1,0,1]
    v_pk_fma_f32 v[192:193], v[192:193], v[30:31], v[30:31] op_sel:[0,0,1] op_sel_hi:[1,0,1]
    v_pk_fma_f32 v[194:195], v[194:195], v[30:31], v[30:31] op_sel:[0,0,1] op_sel_hi:[1,0,1]
    v_pk_fma_f32 v[196:197], v[196:197], v[30:31], v[30:31] op_sel:[0,0,1] op_sel_hi:[1,0,1]
    v_pk_fma_f32 v[198:199], v[198:199], v[30:31], v[30:31] op_sel:[0,0,1] op_sel_hi:[1,0,1]
    v_pk_fma_f32 v[200:201], v[200:201], v[30:31], v[30:31] op_sel:[0,0,1] op_sel_hi:[1,0,1]
    v_pk_fma_f32 v[202:203], v[202:203], v[30:31], v[30:31] op_sel:[0,0,1] op_sel_hi:[1,0,1]
    v_pk_mul_f32 v[176:177], v[176:177], v[60:61]
    v_pk_mul_f32 v[178:179], v[178:179], v[62:63]
    buffer_load_dwordx4 a[128:131], v8, s[28:31], s55 offen offset:3072
    v_pk_mul_f32 v[180:181], v[180:181], v[64:65]
    v_pk_mul_f32 v[182:183], v[182:183], v[66:67]
    v_pk_mul_f32 v[184:185], v[184:185], v[68:69]
    v_pk_mul_f32 v[186:187], v[186:187], v[70:71]
    v_pk_mul_f32 v[188:189], v[188:189], v[72:73]
    v_pk_mul_f32 v[190:191], v[190:191], v[74:75]
    v_pk_mul_f32 v[192:193], v[192:193], v[76:77]
    v_pk_mul_f32 v[194:195], v[194:195], v[78:79]
    v_pk_mul_f32 v[196:197], v[196:197], v[80:81]
    v_pk_mul_f32 v[198:199], v[198:199], v[82:83]
    v_pk_mul_f32 v[200:201], v[200:201], v[84:85]
    v_pk_mul_f32 v[202:203], v[202:203], v[86:87]
    v_exp_f32 v176, v176
    v_exp_f32 v177, v177
    v_exp_f32 v178, v178
    v_exp_f32 v179, v179
    s_add_u32 s55, s55, 4096
    buffer_load_dwordx4 a[132:135], v8, s[28:31], s55 offen offset:0
    s_add_u32 s55, s55, 6144
    v_exp_f32 v180, v180
    v_exp_f32 v181, v181
    v_exp_f32 v182, v182
    v_exp_f32 v183, v183
    v_exp_f32 v184, v184
    v_exp_f32 v185, v185
    v_exp_f32 v186, v186
    v_exp_f32 v187, v187
    v_exp_f32 v188, v188
    v_exp_f32 v189, v189
    buffer_load_dwordx4 a[136:139], v8, s[28:31], s55 offen offset:0
    v_exp_f32 v190, v190
    v_exp_f32 v191, v191
    v_exp_f32 v192, v192
    v_exp_f32 v193, v193
    v_exp_f32 v194, v194
    v_exp_f32 v195, v195
    v_exp_f32 v196, v196
    v_exp_f32 v197, v197
    v_exp_f32 v198, v198
    v_exp_f32 v199, v199
    buffer_load_dwordx4 a[140:143], v8, s[28:31], s55 offen offset:1024
    v_exp_f32 v200, v200
    v_exp_f32 v201, v201
    v_exp_f32 v202, v202
    v_exp_f32 v203, v203
    v_pk_add_f32 v[176:177], v[176:177], 1.0 op_sel_hi:[1,0]
    v_pk_add_f32 v[178:179], v[178:179], 1.0 op_sel_hi:[1,0]
    v_pk_add_f32 v[180:181], v[180:181], 1.0 op_sel_hi:[1,0]
    v_pk_add_f32 v[182:183], v[182:183], 1.0 op_sel_hi:[1,0]
    v_pk_add_f32 v[184:185], v[184:185], 1.0 op_sel_hi:[1,0]
    v_pk_add_f32 v[186:187], v[186:187], 1.0 op_sel_hi:[1,0]
    v_pk_add_f32 v[188:189], v[188:189], 1.0 op_sel_hi:[1,0]
    v_pk_add_f32 v[190:191], v[190:191], 1.0 op_sel_hi:[1,0]
    v_pk_add_f32 v[192:193], v[192:193], 1.0 op_sel_hi:[1,0]
    v_pk_add_f32 v[194:195], v[194:195], 1.0 op_sel_hi:[1,0]
    v_pk_add_f32 v[196:197], v[196:197], 1.0 op_sel_hi:[1,0]
    buffer_load_dwordx4 a[144:147], v8, s[28:31], s55 offen offset:2048
    v_pk_add_f32 v[198:199], v[198:199], 1.0 op_sel_hi:[1,0]
    v_pk_add_f32 v[200:201], v[200:201], 1.0 op_sel_hi:[1,0]
    v_pk_add_f32 v[202:203], v[202:203], 1.0 op_sel_hi:[1,0]
    v_rcp_f32 v176, v176
    v_rcp_f32 v177, v177
    v_rcp_f32 v178, v178
    v_rcp_f32 v179, v179
    v_rcp_f32 v180, v180
    v_rcp_f32 v181, v181
    v_rcp_f32 v182, v182
    v_rcp_f32 v183, v183
    buffer_load_dwordx4 a[148:151], v8, s[28:31], s55 offen offset:3072
    v_rcp_f32 v184, v184
    v_rcp_f32 v185, v185
    v_rcp_f32 v186, v186
    v_rcp_f32 v187, v187
    v_rcp_f32 v188, v188
    v_rcp_f32 v189, v189
    v_rcp_f32 v190, v190
    v_rcp_f32 v191, v191
    v_rcp_f32 v192, v192
    v_rcp_f32 v193, v193
    s_add_u32 s55, s55, 4096
    buffer_load_dwordx4 a[152:155], v8, s[28:31], s55 offen offset:0
    s_add_u32 s55, s55, 6144
    v_rcp_f32 v194, v194
    v_rcp_f32 v195, v195
    v_rcp_f32 v196, v196
    v_rcp_f32 v197, v197
    v_rcp_f32 v198, v198
    v_rcp_f32 v199, v199
    v_rcp_f32 v200, v200
    v_rcp_f32 v201, v201
    v_rcp_f32 v202, v202
    v_rcp_f32 v203, v203
    buffer_load_dwordx4 a[156:159], v8, s[28:31], s55 offen offset:0
    v_pk_mul_f32 v[60:61], v[60:61], v[176:177]
    v_pk_mul_f32 v[62:63], v[62:63], v[178:179]
    v_pk_mul_f32 v[64:65], v[64:65], v[180:181]
    v_pk_mul_f32 v[66:67], v[66:67], v[182:183]
    v_pk_mul_f32 v[68:69], v[68:69], v[184:185]
    v_pk_mul_f32 v[70:71], v[70:71], v[186:187]
    v_pk_mul_f32 v[72:73], v[72:73], v[188:189]
    v_pk_mul_f32 v[74:75], v[74:75], v[190:191]
    v_pk_mul_f32 v[76:77], v[76:77], v[192:193]
    v_pk_mul_f32 v[78:79], v[78:79], v[194:195]
    v_pk_mul_f32 v[80:81], v[80:81], v[196:197]
    v_pk_mul_f32 v[82:83], v[82:83], v[198:199]
    v_pk_mul_f32 v[84:85], v[84:85], v[200:201]
    v_pk_mul_f32 v[86:87], v[86:87], v[202:203]
    v_cvt_pk_bf16_f32 v160, v60, v61
    v_cvt_pk_bf16_f32 v161, v62, v63
    v_cvt_pk_bf16_f32 v162, v64, v65
    v_cvt_pk_bf16_f32 v163, v66, v67
    v_cvt_pk_bf16_f32 v164, v68, v69
    v_cvt_pk_bf16_f32 v165, v70, v71
    v_cvt_pk_bf16_f32 v166, v72, v73
    v_cvt_pk_bf16_f32 v167, v74, v75
    v_cvt_pk_bf16_f32 v168, v76, v77
    v_cvt_pk_bf16_f32 v169, v78, v79
    v_cvt_pk_bf16_f32 v170, v80, v81
    v_cvt_pk_bf16_f32 v171, v82, v83
    v_cvt_pk_bf16_f32 v172, v84, v85
    v_cvt_pk_bf16_f32 v173, v86, v87
    s_nop 1
    v_permlane16_swap_b32 v160, v162
    v_permlane16_swap_b32 v161, v163
    v_permlane16_swap_b32 v164, v166
    v_permlane16_swap_b32 v165, v167
    v_permlane16_swap_b32 v168, v170
    v_permlane16_swap_b32 v169, v171
    s_add_u32 s26, s13, 55296
    s_add_u32 s27, s12, 55296
    buffer_store_dwordx4 v[160:163], v226, s[28:31], s26 offen sc1
    buffer_store_dwordx2 v[172:173], v227, s[28:31], s27 offen sc1
    s_cmp_eq_u32 s52, 15
    s_cbranch_scc1 chain_kernel_j158
    buffer_store_dwordx4 v[164:167], v226, s[28:31], s26 offen offset:1024 sc1
    buffer_store_dwordx4 v[168:171], v226, s[28:31], s26 offen offset:2048 sc1
chain_kernel_j158:
    s_waitcnt vmcnt(0)
    v_mov_b32 v2, 1
    v_mov_b32 v7, 0
    s_mov_b64 exec, 1
    buffer_store_dword v2, v7, s[28:31], s15 offen sc1
    s_mov_b64 exec, -1
    buffer_load_dwordx4 a[160:163], v8, s[28:31], s55 offen offset:1024
    buffer_load_dwordx4 a[164:167], v8, s[28:31], s55 offen offset:2048
    buffer_load_dwordx4 a[168:171], v8, s[28:31], s55 offen offset:3072
    s_add_u32 s55, s55, 4096
    buffer_load_dwordx4 a[172:175], v8, s[28:31], s55 offen offset:0
    s_add_u32 s55, s55, 6144
    buffer_load_dwordx4 a[176:179], v8, s[28:31], s55 offen offset:0
    buffer_load_dwordx4 a[180:183], v8, s[28:31], s55 offen offset:1024
    buffer_load_dwordx4 a[184:187], v8, s[28:31], s55 offen offset:2048
    buffer_load_dwordx4 a[188:191], v8, s[28:31], s55 offen offset:3072
    s_add_u32 s55, s55, 4096
    buffer_load_dwordx4 a[192:195], v8, s[28:31], s55 offen offset:0
    s_add_u32 s55, s55, 6144
    buffer_load_dwordx4 a[196:199], v8, s[28:31], s55 offen offset:0
    buffer_load_dwordx4 a[200:203], v8, s[28:31], s55 offen offset:1024
    buffer_load_dwordx4 a[204:207], v8, s[28:31], s55 offen offset:2048
    buffer_load_dwordx4 a[208:211], v8, s[28:31], s55 offen offset:3072
    s_add_u32 s55, s55, 4096
    buffer_load_dwordx4 a[212:215], v8, s[28:31], s55 offen offset:0
    s_add_u32 s55, s55, 6144
    buffer_load_dwordx4 a[216:219], v8, s[28:31], s55 offen offset:0
    buffer_load_dwordx4 a[220:223], v8, s[28:31], s55 offen offset:1024
    buffer_load_dwordx4 a[224:227], v8, s[28:31], s55 offen offset:2048
    buffer_load_dwordx4 a[228:231], v8, s[28:31], s55 offen offset:3072
    s_add_u32 s55, s55, 4096
    buffer_load_dwordx4 a[232:235], v8, s[28:31], s55 offen offset:0
    s_add_u32 s55, s55, 6144
    buffer_load_dwordx4 a[236:239], v8, s[28:31], s55 offen offset:0
    buffer_load_dwordx4 a[240:243], v8, s[28:31], s55 offen offset:1024
    buffer_load_dwordx4 a[244:247], v8, s[28:31], s55 offen offset:2048
    buffer_load_dwordx4 a[248:251], v8, s[28:31], s55 offen offset:3072
    s_add_u32 s55, s55, 4096
    buffer_load_dwordx4 a[252:255], v8, s[28:31], s55 offen offset:0
    s_add_u32 s55, s55, 6144
    s_mul_i32 s26, s22, 5120
    v_add_u32 v12, s26, v8
    v_add_u32 v13, 0x10000, v12
    v_add_u32 v14, 0x20000, v12
    s_mov_b32 s47, 0
    s_mov_b64 exec, 511
chain_kernel_poll9:
    buffer_load_dword v2, v234, s[28:31], s48 offen sc1
    s_add_u32 s47, s47, 1
    s_waitcnt vmcnt(0)
    v_cmp_ne_u32 vcc, 1, v2
    s_cmp_ge_u32 s47, 200000
    s_cbranch_scc1 chain_kernel_polld10
    s_cbranch_vccnz chain_kernel_poll9
chain_kernel_polld10:
    s_mov_b64 exec, -1
    buffer_load_dwordx4 a[0:3], v8, s[28:31], s50 offen offset:0 sc1
    buffer_load_dwordx4 a[4:7], v8, s[28:31], s51 offen offset:0 sc1
    buffer_load_dwordx4 a[8:11], v8, s[28:31], s50 offen offset:1024 sc1
    buffer_load_dwordx4 a[12:15], v8, s[28:31], s51 offen offset:1024 sc1
    buffer_load_dwordx4 a[16:19], v8, s[28:31], s50 offen offset:2048 sc1
    buffer_load_dwordx4 a[20:23], v8, s[28:31], s51 offen offset:2048 sc1
    buffer_load_dwordx4 a[24:27], v8, s[28:31], s50 offen offset:3072 sc1
    buffer_load_dwordx4 a[28:31], v8, s[28:31], s51 offen offset:3072 sc1
    s_add_u32 s50, s50, 4096
    s_add_u32 s51, s51, 4096
    buffer_load_dwordx4 a[32:35], v8, s[28:31], s50 offen offset:0 sc1
    buffer_load_dwordx4 a[36:39], v8, s[28:31], s51 offen offset:0 sc1
    s_barrier
    ds_read_b128 v[136:139], v14 offset:12288
    ds_read_b128 v[140:143], v14 offset:13312
    ds_read_b128 v[144:147], v14 offset:14336
    ds_read_b128 v[148:151], v14 offset:15360
    ds_read_b128 v[152:155], v14 offset:16384
    ds_read_b128 v[156:159], v12 offset:0
    ds_read_b128 v[160:163], v12 offset:1024
    ds_read_b128 v[164:167], v12 offset:2048
    ds_read_b128 v[168:171], v12 offset:3072
    ds_read_b128 v[172:175], v12 offset:4096
    ds_read_b128 v[176:179], v12 offset:10240
    s_waitcnt vmcnt(8) lgkmcnt(6)
    v_mfma_f32_16x16x32_bf16 v[32:35], v[136:139], a[0:3], 0
    v_mfma_f32_16x16x32_bf16 v[52:55], v[136:139], a[4:7], 0
    ds_read_b128 v[180:183], v12 offset:11264
    buffer_load_dwordx4 a[40:43], v8, s[28:31], s50 offen offset:1024 sc1
    v_mfma_f32_16x16x32_bf16 v[36:39], v[140:143], a[0:3], 0
    v_mfma_f32_16x16x32_bf16 v[56:59], v[140:143], a[4:7], 0
    ds_read_b128 v[136:139], v12 offset:12288
    v_mfma_f32_16x16x32_bf16 v[40:43], v[144:147], a[0:3], 0
    v_mfma_f32_16x16x32_bf16 v[60:63], v[144:147], a[4:7], 0
    ds_read_b128 v[140:143], v12 offset:13312
    buffer_load_dwordx4 a[44:47], v8, s[28:31], s51 offen offset:1024 sc1
    v_mfma_f32_16x16x32_bf16 v[44:47], v[148:151], a[0:3], 0
    v_mfma_f32_16x16x32_bf16 v[64:67], v[148:151], a[4:7], 0
    ds_read_b128 v[144:147], v12 offset:14336
    v_mfma_f32_16x16x32_bf16 v[48:51], v[152:155], a[0:3], 0
    v_mfma_f32_16x16x32_bf16 v[68:71], v[152:155], a[4:7], 0
    ds_read_b128 v[148:151], v12 offset:20480
    buffer_load_dwordx4 a[48:51], v8, s[28:31], s50 offen offset:2048 sc1
    s_waitcnt vmcnt(9) lgkmcnt(6)
    v_mfma_f32_16x16x32_bf16 v[32:35], v[156:159], a[8:11], v[32:35]
    v_mfma_f32_16x16x32_bf16 v[52:55], v[156:159], a[12:15], v[52:55]
    ds_read_b128 v[152:155], v12 offset:21504
    v_mfma_f32_16x16x32_bf16 v[36:39], v[160:163], a[8:11], v[36:39]
    v_mfma_f32_16x16x32_bf16 v[56:59], v[160:163], a[12:15], v[56:59]
    ds_read_b128 v[156:159], v12 offset:22528
    buffer_load_dwordx4 a[52:55], v8, s[28:31], s51 offen offset:2048 sc1
    v_mfma_f32_16x16x32_bf16 v[40:43], v[164:167], a[8:11], v[40:43]
    v_mfma_f32_16x16x32_bf16 v[60:63], v[164:167], a[12:15], v[60:63]
    ds_read_b128 v[160:163], v12 offset:23552
    v_mfma_f32_16x16x32_bf16 v[44:47], v[168:171], a[8:11], v[44:47]
    v_mfma_f32_16x16x32_bf16 v[64:67], v[168:171], a[12:15], v[64:67]
    ds_read_b128 v[164:167], v12 offset:24576
    buffer_load_dwordx4 a[56:59], v8, s[28:31], s50 offen offset:3072 sc1
    v_mfma_f32_16x16x32_bf16 v[48:51], v[172:175], a[8:11], v[48:51]
    v_mfma_f32_16x16x32_bf16 v[68:71], v[172:175], a[12:15], v[68:71]
    s_waitcnt lgkmcnt(5)
    s_barrier
    ds_read_b128 v[168:171], v12 offset:30720
    s_mul_i32 s25, s20, 3
    s_min_u32 s25, s25, 7
    s_lshl_b32 s25, s25, 10
    s_add_u32 s62, s25, 143360
    s_add_u32 s63, s25, s59
    s_add_u32 s63, s63, 163840
    s_mov_b32 m0, s62
    buffer_load_dwordx4 v8, s[28:31], s63 offen offset:0 lds
    s_waitcnt vmcnt(10) lgkmcnt(6)
    v_mfma_f32_16x16x32_bf16 v[32:35], v[176:179], a[16:19], v[32:35]
    v_mfma_f32_16x16x32_bf16 v[52:55], v[176:179], a[20:23], v[52:55]
    ds_read_b128 v[172:175], v12 offset:31744
    buffer_load_dwordx4 v8, s[28:31], s63 offen offset:1024 lds
    v_mfma_f32_16x16x32_bf16 v[36:39], v[180:183], a[16:19], v[36:39]
    v_mfma_f32_16x16x32_bf16 v[56:59], v[180:183], a[20:23], v[56:59]
    ds_read_b128 v[176:179], v12 offset:32768
    buffer_load_dwordx4 v8, s[28:31], s63 offen offset:2048 lds
    v_mfma_f32_16x16x32_bf16 v[40:43], v[136:139], a[16:19], v[40:43]
    v_mfma_f32_16x16x32_bf16 v[60:63], v[136:139], a[20:23], v[60:63]
    ds_read_b128 v[180:183], v12 offset:33792
    s_mul_i32 s25, s20, 5
    s_lshl_b32 s25, s25, 10
    s_add_u32 s62, s25, 0
    s_add_u32 s63, s25, s59
    s_add_u32 s63, s63, 174080
    s_mov_b32 m0, s62
    buffer_load_dwordx4 v8, s[28:31], s63 offen offset:0 lds
    v_mfma_f32_16x16x32_bf16 v[44:47], v[140:143], a[16:19], v[44:47]
    v_mfma_f32_16x16x32_bf16 v[64:67], v[140:143], a[20:23], v[64:67]
    ds_read_b128 v[136:139], v12 offset:34816
    buffer_load_dwordx4 v8, s[28:31], s63 offen offset:1024 lds
    v_mfma_f32_16x16x32_bf16 v[48:51], v[144:147], a[16:19], v[48:51]
    v_mfma_f32_16x16x32_bf16 v[68:71], v[144:147], a[20:23], v[68:71]
    ds_read_b128 v[140:143], v12 offset:40960
    buffer_load_dwordx4 v8, s[28:31], s63 offen offset:2048 lds
    s_waitcnt vmcnt(13) lgkmcnt(6)
    v_mfma_f32_16x16x32_bf16 v[32:35], v[148:151], a[24:27], v[32:35]
    v_mfma_f32_16x16x32_bf16 v[52:55], v[148:151], a[28:31], v[52:55]
    ds_read_b128 v[144:147], v12 offset:41984
    buffer_load_dwordx4 v8, s[28:31], s63 offen offset:3072 lds
    v_mfma_f32_16x16x32_bf16 v[36:39], v[152:155], a[24:27], v[36:39]
    v_mfma_f32_16x16x32_bf16 v[56:59], v[152:155], a[28:31], v[56:59]
    ds_read_b128 v[148:151], v12 offset:43008
    s_add_u32 s62, s62, 4096
    s_add_u32 s63, s63, 4096
    s_mov_b32 m0, s62
    buffer_load_dwordx4 v8, s[28:31], s63 offen offset:0 lds
    v_mfma_f32_16x16x32_bf16 v[40:43], v[156:159], a[24:27], v[40:43]
    v_mfma_f32_16x16x32_bf16 v[60:63], v[156:159], a[28:31], v[60:63]
    ds_read_b128 v[152:155], v12 offset:44032
    v_mfma_f32_16x16x32_bf16 v[44:47], v[160:163], a[24:27], v[44:47]
    v_mfma_f32_16x16x32_bf16 v[64:67], v[160:163], a[28:31], v[64:67]
    ds_read_b128 v[156:159], v12 offset:45056
    buffer_load_dwordx4 a[60:63], v8, s[28:31], s51 offen offset:3072 sc1
    v_mfma_f32_16x16x32_bf16 v[48:51], v[164:167], a[24:27], v[48:51]
    v_mfma_f32_16x16x32_bf16 v[68:71], v[164:167], a[28:31], v[68:71]
    ds_read_b128 v[160:163], v12 offset:51200
    s_waitcnt vmcnt(14) lgkmcnt(6)
    v_mfma_f32_16x16x32_bf16 v[32:35], v[168:171], a[32:35], v[32:35]
    v_mfma_f32_16x16x32_bf16 v[52:55], v[168:171], a[36:39], v[52:55]
    ds_read_b128 v[164:167], v12 offset:52224
    s_add_u32 s50, s50, 4096
    s_add_u32 s51, s51, 4096
    buffer_load_dwordx4 a[64:67], v8, s[28:31], s50 offen offset:0 sc1
    v_mfma_f32_16x16x32_bf16 v[36:39], v[172:175], a[32:35], v[36:39]
    v_mfma_f32_16x16x32_bf16 v[56:59], v[172:175], a[36:39], v[56:59]
    ds_read_b128 v[168:171], v12 offset:53248
    v_mfma_f32_16x16x32_bf16 v[40:43], v[176:179], a[32:35], v[40:43]
    v_mfma_f32_16x16x32_bf16 v[60:63], v[176:179], a[36:39], v[60:63]
    ds_read_b128 v[172:175], v12 offset:54272
    buffer_load_dwordx4 a[68:71], v8, s[28:31], s51 offen offset:0 sc1
    v_mfma_f32_16x16x32_bf16 v[44:47], v[180:183], a[32:35], v[44:47]
    v_mfma_f32_16x16x32_bf16 v[64:67], v[180:183], a[36:39], v[64:67]
    ds_read_b128 v[176:179], v12 offset:55296
    v_mfma_f32_16x16x32_bf16 v[48:51], v[136:139], a[32:35], v[48:51]
    v_mfma_f32_16x16x32_bf16 v[68:71], v[136:139], a[36:39], v[68:71]
    ds_read_b128 v[180:183], v12 offset:61440
    buffer_load_dwordx4 a[72:75], v8, s[28:31], s50 offen offset:1024 sc1
    s_waitcnt vmcnt(15) lgkmcnt(6)
    v_mfma_f32_16x16x32_bf16 v[32:35], v[140:143], a[40:43], v[32:35]
    v_mfma_f32_16x16x32_bf16 v[52:55], v[140:143], a[44:47], v[52:55]
    ds_read_b128 v[136:139], v12 offset:62464
    v_mfma_f32_16x16x32_bf16 v[36:39], v[144:147], a[40:43], v[36:39]
    v_mfma_f32_16x16x32_bf16 v[56:59], v[144:147], a[44:47], v[56:59]
    ds_read_b128 v[140:143], v12 offset:63488
    buffer_load_dwordx4 a[76:79], v8, s[28:31], s51 offen offset:1024 sc1
    v_mfma_f32_16x16x32_bf16 v[40:43], v[148:151], a[40:43], v[40:43]
    v_mfma_f32_16x16x32_bf16 v[60:63], v[148:151], a[44:47], v[60:63]
    ds_read_b128 v[144:147], v12 offset:64512
    v_mfma_f32_16x16x32_bf16 v[44:47], v[152:155], a[40:43], v[44:47]
    v_mfma_f32_16x16x32_bf16 v[64:67], v[152:155], a[44:47], v[64:67]
    ds_read_b128 v[148:151], v13 offset:0
    buffer_load_dwordx4 a[80:83], v8, s[28:31], s50 offen offset:2048 sc1
    v_mfma_f32_16x16x32_bf16 v[48:51], v[156:159], a[40:43], v[48:51]
    v_mfma_f32_16x16x32_bf16 v[68:71], v[156:159], a[44:47], v[68:71]
    ds_read_b128 v[152:155], v13 offset:6144
    s_waitcnt vmcnt(15) lgkmcnt(6)
    v_mfma_f32_16x16x32_bf16 v[32:35], v[160:163], a[48:51], v[32:35]
    v_mfma_f32_16x16x32_bf16 v[52:55], v[160:163], a[52:55], v[52:55]
    ds_read_b128 v[156:159], v13 offset:7168
    buffer_load_dwordx4 a[84:87], v8, s[28:31], s51 offen offset:2048 sc1
    v_mfma_f32_16x16x32_bf16 v[36:39], v[164:167], a[48:51], v[36:39]
    v_mfma_f32_16x16x32_bf16 v[56:59], v[164:167], a[52:55], v[56:59]
    ds_read_b128 v[160:163], v13 offset:8192
    v_mfma_f32_16x16x32_bf16 v[40:43], v[168:171], a[48:51], v[40:43]
    v_mfma_f32_16x16x32_bf16 v[60:63], v[168:171], a[52:55], v[60:63]
    ds_read_b128 v[164:167], v13 offset:9216
    buffer_load_dwordx4 a[88:91], v8, s[28:31], s50 offen offset:3072 sc1
    v_mfma_f32_16x16x32_bf16 v[44:47], v[172:175], a[48:51], v[44:47]
    v_mfma_f32_16x16x32_bf16 v[64:67], v[172:175], a[52:55], v[64:67]
    ds_read_b128 v[168:171], v13 offset:10240
    v_mfma_f32_16x16x32_bf16 v[48:51], v[176:179], a[48:51], v[48:51]
    v_mfma_f32_16x16x32_bf16 v[68:71], v[176:179], a[52:55], v[68:71]
    ds_read_b128 v[172:175], v14 offset:22528
    buffer_load_dwordx4 a[92:95], v8, s[28:31], s51 offen offset:3072 sc1
    s_waitcnt vmcnt(8) lgkmcnt(6)
    v_mfma_f32_16x16x32_bf16 v[32:35], v[180:183], a[56:59], v[32:35]
    v_mfma_f32_16x16x32_bf16 v[52:55], v[180:183], a[60:63], v[52:55]
    ds_read_b128 v[176:179], v14 offset:23552
    v_mfma_f32_16x16x32_bf16 v[36:39], v[136:139], a[56:59], v[36:39]
    v_mfma_f32_16x16x32_bf16 v[56:59], v[136:139], a[60:63], v[56:59]
    ds_read_b128 v[180:183], v14 offset:24576
    s_add_u32 s50, s50, 4096
    s_add_u32 s51, s51, 4096
    buffer_load_dwordx4 a[0:3], v8, s[28:31], s50 offen offset:0 sc1
    v_mfma_f32_16x16x32_bf16 v[40:43], v[140:143], a[56:59], v[40:43]
    v_mfma_f32_16x16x32_bf16 v[60:63], v[140:143], a[60:63], v[60:63]
    ds_read_b128 v[136:139], v14 offset:25600
    v_mfma_f32_16x16x32_bf16 v[44:47], v[144:147], a[56:59], v[44:47]
    v_mfma_f32_16x16x32_bf16 v[64:67], v[144:147], a[60:63], v[64:67]
    ds_read_b128 v[140:143], v14 offset:26624
    buffer_load_dwordx4 a[4:7], v8, s[28:31], s51 offen offset:0 sc1
    v_mfma_f32_16x16x32_bf16 v[48:51], v[148:151], a[56:59], v[48:51]
    v_mfma_f32_16x16x32_bf16 v[68:71], v[148:151], a[60:63], v[68:71]
    ds_read_b128 v[144:147], v13 offset:57344
    s_waitcnt vmcnt(8) lgkmcnt(6)
    v_mfma_f32_16x16x32_bf16 v[32:35], v[152:155], a[64:67], v[32:35]
    v_mfma_f32_16x16x32_bf16 v[52:55], v[152:155], a[68:71], v[52:55]
    ds_read_b128 v[148:151], v13 offset:58368
    buffer_load_dwordx4 a[8:11], v8, s[28:31], s50 offen offset:1024 sc1
    v_mfma_f32_16x16x32_bf16 v[36:39], v[156:159], a[64:67], v[36:39]
    v_mfma_f32_16x16x32_bf16 v[56:59], v[156:159], a[68:71], v[56:59]
    ds_read_b128 v[152:155], v13 offset:59392
    buffer_load_dwordx4 a[12:15], v8, s[28:31], s51 offen offset:1024 sc1
    v_mfma_f32_16x16x32_bf16 v[40:43], v[160:163], a[64:67], v[40:43]
    v_mfma_f32_16x16x32_bf16 v[60:63], v[160:163], a[68:71], v[60:63]
    ds_read_b128 v[156:159], v13 offset:60416
    buffer_load_dwordx4 a[16:19], v8, s[28:31], s50 offen offset:2048 sc1
    v_mfma_f32_16x16x32_bf16 v[44:47], v[164:167], a[64:67], v[44:47]
    v_mfma_f32_16x16x32_bf16 v[64:67], v[164:167], a[68:71], v[64:67]
    ds_read_b128 v[160:163], v13 offset:61440
    v_mfma_f32_16x16x32_bf16 v[48:51], v[168:171], a[64:67], v[48:51]
    v_mfma_f32_16x16x32_bf16 v[68:71], v[168:171], a[68:71], v[68:71]
    ds_read_b128 v[164:167], v14 offset:2048
    buffer_load_dwordx4 a[20:23], v8, s[28:31], s51 offen offset:2048 sc1
    s_waitcnt vmcnt(10) lgkmcnt(6)
    v_mfma_f32_16x16x32_bf16 v[32:35], v[172:175], a[72:75], v[32:35]
    v_mfma_f32_16x16x32_bf16 v[52:55], v[172:175], a[76:79], v[52:55]
    ds_read_b128 v[168:171], v14 offset:3072
    s_add_u32 s26, s44, 13406208
    buffer_load_dwordx2 v[96:97], v230, s[28:31], s26 offen sc1
    v_mfma_f32_16x16x32_bf16 v[36:39], v[176:179], a[72:75], v[36:39]
    v_mfma_f32_16x16x32_bf16 v[56:59], v[176:179], a[76:79], v[56:59]
    ds_read_b128 v[172:175], v14 offset:4096
    s_add_u32 s26, s44, 13406720
    buffer_load_dwordx2 v[98:99], v230, s[28:31], s26 offen sc1
    v_mfma_f32_16x16x32_bf16 v[40:43], v[180:183], a[72:75], v[40:43]
    v_mfma_f32_16x16x32_bf16 v[60:63], v[180:183], a[76:79], v[60:63]
    ds_read_b128 v[176:179], v14 offset:5120
    v_mfma_f32_16x16x32_bf16 v[44:47], v[136:139], a[72:75], v[44:47]
    v_mfma_f32_16x16x32_bf16 v[64:67], v[136:139], a[76:79], v[64:67]
    ds_read_b128 v[180:183], v14 offset:6144
    s_add_u32 s26, s44, 13407232
    buffer_load_dwordx2 v[100:101], v230, s[28:31], s26 offen sc1
    v_mfma_f32_16x16x32_bf16 v[48:51], v[140:143], a[72:75], v[48:51]
    v_mfma_f32_16x16x32_bf16 v[68:71], v[140:143], a[76:79], v[68:71]
    ds_read_b128 v[136:139], v13 offset:16384
    s_waitcnt vmcnt(11) lgkmcnt(6)
    v_mfma_f32_16x16x32_bf16 v[32:35], v[144:147], a[80:83], v[32:35]
    v_mfma_f32_16x16x32_bf16 v[52:55], v[144:147], a[84:87], v[52:55]
    ds_read_b128 v[140:143], v13 offset:17408
    s_add_u32 s26, s44, 13407744
    buffer_load_dwordx2 v[102:103], v230, s[28:31], s26 offen sc1
    v_mfma_f32_16x16x32_bf16 v[36:39], v[148:151], a[80:83], v[36:39]
    v_mfma_f32_16x16x32_bf16 v[56:59], v[148:151], a[84:87], v[56:59]
    ds_read_b128 v[144:147], v13 offset:18432
    v_mfma_f32_16x16x32_bf16 v[40:43], v[152:155], a[80:83], v[40:43]
    v_mfma_f32_16x16x32_bf16 v[60:63], v[152:155], a[84:87], v[60:63]
    ds_read_b128 v[148:151], v13 offset:19456
    s_add_u32 s26, s45, 13406208
    buffer_load_dwordx2 v[104:105], v230, s[28:31], s26 offen sc1
    v_mfma_f32_16x16x32_bf16 v[44:47], v[156:159], a[80:83], v[44:47]
    v_mfma_f32_16x16x32_bf16 v[64:67], v[156:159], a[84:87], v[64:67]
    ds_read_b128 v[152:155], v13 offset:20480
    v_mfma_f32_16x16x32_bf16 v[48:51], v[160:163], a[80:83], v[48:51]
    v_mfma_f32_16x16x32_bf16 v[68:71], v[160:163], a[84:87], v[68:71]
    ds_read_b128 v[156:159], v13 offset:26624
    buffer_load_dwordx4 a[24:27], v8, s[28:31], s50 offen offset:3072 sc1
    s_waitcnt vmcnt(12) lgkmcnt(6)
    v_mfma_f32_16x16x32_bf16 v[32:35], v[164:167], a[88:91], v[32:35]
    v_mfma_f32_16x16x32_bf16 v[52:55], v[164:167], a[92:95], v[52:55]
    ds_read_b128 v[160:163], v13 offset:27648
    v_mfma_f32_16x16x32_bf16 v[36:39], v[168:171], a[88:91], v[36:39]
    v_mfma_f32_16x16x32_bf16 v[56:59], v[168:171], a[92:95], v[56:59]
    ds_read_b128 v[164:167], v13 offset:28672
    buffer_load_dwordx4 a[28:31], v8, s[28:31], s51 offen offset:3072 sc1
    v_mfma_f32_16x16x32_bf16 v[40:43], v[172:175], a[88:91], v[40:43]
    v_mfma_f32_16x16x32_bf16 v[60:63], v[172:175], a[92:95], v[60:63]
    ds_read_b128 v[168:171], v13 offset:29696
    v_mfma_f32_16x16x32_bf16 v[44:47], v[176:179], a[88:91], v[44:47]
    v_mfma_f32_16x16x32_bf16 v[64:67], v[176:179], a[92:95], v[64:67]
    ds_read_b128 v[172:175], v13 offset:30720
    s_add_u32 s50, s50, 4096
    s_add_u32 s51, s51, 4096
    buffer_load_dwordx4 a[32:35], v8, s[28:31], s50 offen offset:0 sc1
    v_mfma_f32_16x16x32_bf16 v[48:51], v[180:183], a[88:91], v[48:51]
    v_mfma_f32_16x16x32_bf16 v[68:71], v[180:183], a[92:95], v[68:71]
    ds_read_b128 v[176:179], v13 offset:36864
    s_waitcnt vmcnt(12) lgkmcnt(6)
    v_mfma_f32_16x16x32_bf16 v[32:35], v[136:139], a[0:3], v[32:35]
    v_mfma_f32_16x16x32_bf16 v[52:55], v[136:139], a[4:7], v[52:55]
    ds_read_b128 v[180:183], v13 offset:37888
    buffer_load_dwordx4 a[36:39], v8, s[28:31], s51 offen offset:0 sc1
    v_mfma_f32_16x16x32_bf16 v[36:39], v[140:143], a[0:3], v[36:39]
    v_mfma_f32_16x16x32_bf16 v[56:59], v[140:143], a[4:7], v[56:59]
    ds_read_b128 v[136:139], v13 offset:38912
    v_mfma_f32_16x16x32_bf16 v[40:43], v[144:147], a[0:3], v[40:43]
    v_mfma_f32_16x16x32_bf16 v[60:63], v[144:147], a[4:7], v[60:63]
    ds_read_b128 v[140:143], v13 offset:39936
    buffer_load_dwordx4 a[40:43], v8, s[28:31], s50 offen offset:1024 sc1
    v_mfma_f32_16x16x32_bf16 v[44:47], v[148:151], a[0:3], v[44:47]
    v_mfma_f32_16x16x32_bf16 v[64:67], v[148:151], a[4:7], v[64:67]
    ds_read_b128 v[144:147], v13 offset:40960
    v_mfma_f32_16x16x32_bf16 v[48:51], v[152:155], a[0:3], v[48:51]
    v_mfma_f32_16x16x32_bf16 v[68:71], v[152:155], a[4:7], v[68:71]
    ds_read_b128 v[148:151], v13 offset:47104
    buffer_load_dwordx4 a[44:47], v8, s[28:31], s51 offen offset:1024 sc1
    s_waitcnt vmcnt(13) lgkmcnt(6)
    v_mfma_f32_16x16x32_bf16 v[32:35], v[156:159], a[8:11], v[32:35]
    v_mfma_f32_16x16x32_bf16 v[52:55], v[156:159], a[12:15], v[52:55]
    ds_read_b128 v[152:155], v13 offset:48128
    v_mfma_f32_16x16x32_bf16 v[36:39], v[160:163], a[8:11], v[36:39]
    v_mfma_f32_16x16x32_bf16 v[56:59], v[160:163], a[12:15], v[56:59]
    ds_read_b128 v[156:159], v13 offset:49152
    buffer_load_dwordx4 a[48:51], v8, s[28:31], s50 offen offset:2048 sc1
    v_mfma_f32_16x16x32_bf16 v[40:43], v[164:167], a[8:11], v[40:43]
    v_mfma_f32_16x16x32_bf16 v[60:63], v[164:167], a[12:15], v[60:63]
    ds_read_b128 v[160:163], v13 offset:50176
    v_mfma_f32_16x16x32_bf16 v[44:47], v[168:171], a[8:11], v[44:47]
    v_mfma_f32_16x16x32_bf16 v[64:67], v[168:171], a[12:15], v[64:67]
    ds_read_b128 v[164:167], v13 offset:51200
    buffer_load_dwordx4 a[52:55], v8, s[28:31], s51 offen offset:2048 sc1
    v_mfma_f32_16x16x32_bf16 v[48:51], v[172:175], a[8:11], v[48:51]
    v_mfma_f32_16x16x32_bf16 v[68:71], v[172:175], a[12:15], v[68:71]
    s_barrier
    ds_read_b128 v[168:171], v14 offset:12288
    s_waitcnt vmcnt(13) lgkmcnt(6)
    v_mfma_f32_16x16x32_bf16 v[32:35], v[176:179], a[16:19], v[32:35]
    v_mfma_f32_16x16x32_bf16 v[52:55], v[176:179], a[20:23], v[52:55]
    ds_read_b128 v[172:175], v14 offset:13312
    buffer_load_dwordx4 a[56:59], v8, s[28:31], s50 offen offset:3072 sc1
    v_mfma_f32_16x16x32_bf16 v[36:39], v[180:183], a[16:19], v[36:39]
    v_mfma_f32_16x16x32_bf16 v[56:59], v[180:183], a[20:23], v[56:59]
    ds_read_b128 v[176:179], v14 offset:14336
    v_mfma_f32_16x16x32_bf16 v[40:43], v[136:139], a[16:19], v[40:43]
    v_mfma_f32_16x16x32_bf16 v[60:63], v[136:139], a[20:23], v[60:63]
    ds_read_b128 v[180:183], v14 offset:15360
    buffer_load_dwordx4 a[60:63], v8, s[28:31], s51 offen offset:3072 sc1
    v_mfma_f32_16x16x32_bf16 v[44:47], v[140:143], a[16:19], v[44:47]
    v_mfma_f32_16x16x32_bf16 v[64:67], v[140:143], a[20:23], v[64:67]
    ds_read_b128 v[136:139], v14 offset:16384
    v_mfma_f32_16x16x32_bf16 v[48:51], v[144:147], a[16:19], v[48:51]
    v_mfma_f32_16x16x32_bf16 v[68:71], v[144:147], a[20:23], v[68:71]
    ds_read_b128 v[140:143], v12 offset:0
    s_add_u32 s50, s50, 4096
    s_add_u32 s51, s51, 4096
    buffer_load_dwordx4 a[64:67], v8, s[28:31], s50 offen offset:0 sc1
    s_waitcnt vmcnt(9) lgkmcnt(6)
    v_mfma_f32_16x16x32_bf16 v[32:35], v[148:151], a[24:27], v[32:35]
    v_mfma_f32_16x16x32_bf16 v[52:55], v[148:151], a[28:31], v[52:55]
    ds_read_b128 v[144:147], v12 offset:1024
    v_mfma_f32_16x16x32_bf16 v[36:39], v[152:155], a[24:27], v[36:39]
    v_mfma_f32_16x16x32_bf16 v[56:59], v[152:155], a[28:31], v[56:59]
    ds_read_b128 v[148:151], v12 offset:2048
    buffer_load_dwordx4 a[68:71], v8, s[28:31], s51 offen offset:0 sc1
    v_mfma_f32_16x16x32_bf16 v[40:43], v[156:159], a[24:27], v[40:43]
    v_mfma_f32_16x16x32_bf16 v[60:63], v[156:159], a[28:31], v[60:63]
    ds_read_b128 v[152:155], v12 offset:3072
    v_mfma_f32_16x16x32_bf16 v[44:47], v[160:163], a[24:27], v[44:47]
    v_mfma_f32_16x16x32_bf16 v[64:67], v[160:163], a[28:31], v[64:67]
    ds_read_b128 v[156:159], v12 offset:4096
    buffer_load_dwordx4 a[72:75], v8, s[28:31], s50 offen offset:1024 sc1
    v_mfma_f32_16x16x32_bf16 v[48:51], v[164:167], a[24:27], v[48:51]
    v_mfma_f32_16x16x32_bf16 v[68:71], v[164:167], a[28:31], v[68:71]
    ds_read_b128 v[160:163], v12 offset:10240
    s_waitcnt vmcnt(9) lgkmcnt(6)
    v_mfma_f32_16x16x32_bf16 v[32:35], v[168:171], a[32:35], v[32:35]
    v_mfma_f32_16x16x32_bf16 v[52:55], v[168:171], a[36:39], v[52:55]
    ds_read_b128 v[164:167], v12 offset:11264
    buffer_load_dwordx4 a[76:79], v8, s[28:31], s51 offen offset:1024 sc1
    v_mfma_f32_16x16x32_bf16 v[36:39], v[172:175], a[32:35], v[36:39]
    v_mfma_f32_16x16x32_bf16 v[56:59], v[172:175], a[36:39], v[56:59]
    ds_read_b128 v[168:171], v12 offset:12288
    v_mfma_f32_16x16x32_bf16 v[40:43], v[176:179], a[32:35], v[40:43]
    v_mfma_f32_16x16x32_bf16 v[60:63], v[176:179], a[36:39], v[60:63]
    ds_read_b128 v[172:175], v12 offset:13312
    buffer_load_dwordx4 a[80:83], v8, s[28:31], s50 offen offset:2048 sc1
    v_mfma_f32_16x16x32_bf16 v[44:47], v[180:183], a[32:35], v[44:47]
    v_mfma_f32_16x16x32_bf16 v[64:67], v[180:183], a[36:39], v[64:67]
    ds_read_b128 v[176:179], v12 offset:14336
    v_mfma_f32_16x16x32_bf16 v[48:51], v[136:139], a[32:35], v[48:51]
    v_mfma_f32_16x16x32_bf16 v[68:71], v[136:139], a[36:39], v[68:71]
    buffer_load_dwordx4 a[84:87], v8, s[28:31], s51 offen offset:2048 sc1
    s_waitcnt vmcnt(10) lgkmcnt(5)
    v_mfma_f32_16x16x32_bf16 v[32:35], v[140:143], a[40:43], v[32:35]
    v_mfma_f32_16x16x32_bf16 v[52:55], v[140:143], a[44:47], v[52:55]
    v_mfma_f32_16x16x32_bf16 v[36:39], v[144:147], a[40:43], v[36:39]
    v_mfma_f32_16x16x32_bf16 v[56:59], v[144:147], a[44:47], v[56:59]
    buffer_load_dwordx4 a[88:91], v8, s[28:31], s50 offen offset:3072 sc1
    v_mfma_f32_16x16x32_bf16 v[40:43], v[148:151], a[40:43], v[40:43]
    v_mfma_f32_16x16x32_bf16 v[60:63], v[148:151], a[44:47], v[60:63]
    v_mfma_f32_16x16x32_bf16 v[44:47], v[152:155], a[40:43], v[44:47]
    v_mfma_f32_16x16x32_bf16 v[64:67], v[152:155], a[44:47], v[64:67]
    buffer_load_dwordx4 a[92:95], v8, s[28:31], s51 offen offset:3072 sc1
    v_mfma_f32_16x16x32_bf16 v[48:51], v[156:159], a[40:43], v[48:51]
    v_mfma_f32_16x16x32_bf16 v[68:71], v[156:159], a[44:47], v[68:71]
    s_waitcnt vmcnt(10) lgkmcnt(0)
    v_mfma_f32_16x16x32_bf16 v[32:35], v[160:163], a[48:51], v[32:35]
    v_mfma_f32_16x16x32_bf16 v[52:55], v[160:163], a[52:55], v[52:55]
    s_add_u32 s50, s50, 4096
    s_add_u32 s51, s51, 4096
    buffer_load_dwordx4 a[0:3], v8, s[28:31], s50 offen offset:0 sc1
    v_mfma_f32_16x16x32_bf16 v[36:39], v[164:167], a[48:51], v[36:39]
    v_mfma_f32_16x16x32_bf16 v[56:59], v[164:167], a[52:55], v[56:59]
    v_mfma_f32_16x16x32_bf16 v[40:43], v[168:171], a[48:51], v[40:43]
    v_mfma_f32_16x16x32_bf16 v[60:63], v[168:171], a[52:55], v[60:63]
    buffer_load_dwordx4 a[4:7], v8, s[28:31], s51 offen offset:0 sc1
    v_mfma_f32_16x16x32_bf16 v[44:47], v[172:175], a[48:51], v[44:47]
    v_mfma_f32_16x16x32_bf16 v[64:67], v[172:175], a[52:55], v[64:67]
    v_mfma_f32_16x16x32_bf16 v[48:51], v[176:179], a[48:51], v[48:51]
    v_mfma_f32_16x16x32_bf16 v[68:71], v[176:179], a[52:55], v[68:71]
    s_waitcnt vmcnt(10)
    v_mfma_f32_16x16x32_bf16 v[32:35], a[96:99], a[56:59], v[32:35]
    v_mfma_f32_16x16x32_bf16 v[52:55], a[96:99], a[60:63], v[52:55]
    v_mfma_f32_16x16x32_bf16 v[36:39], a[100:103], a[56:59], v[36:39]
    v_mfma_f32_16x16x32_bf16 v[56:59], a[100:103], a[60:63], v[56:59]
    buffer_load_dwordx4 a[8:11], v8, s[28:31], s50 offen offset:1024 sc1
    v_mfma_f32_16x16x32_bf16 v[40:43], a[104:107], a[56:59], v[40:43]
    v_mfma_f32_16x16x32_bf16 v[60:63], a[104:107], a[60:63], v[60:63]
    v_mfma_f32_16x16x32_bf16 v[44:47], a[108:111], a[56:59], v[44:47]
    v_mfma_f32_16x16x32_bf16 v[64:67], a[108:111], a[60:63], v[64:67]
    buffer_load_dwordx4 a[12:15], v8, s[28:31], s51 offen offset:1024 sc1
    v_mfma_f32_16x16x32_bf16 v[48:51], a[112:115], a[56:59], v[48:51]
    v_mfma_f32_16x16x32_bf16 v[68:71], a[112:115], a[60:63], v[68:71]
    s_waitcnt vmcnt(10)
    v_mfma_f32_16x16x32_bf16 v[32:35], a[116:119], a[64:67], v[32:35]
    v_mfma_f32_16x16x32_bf16 v[52:55], a[116:119], a[68:71], v[52:55]
    buffer_load_dwordx4 a[16:19], v8, s[28:31], s50 offen offset:2048 sc1
    v_mfma_f32_16x16x32_bf16 v[36:39], a[120:123], a[64:67], v[36:39]
    v_mfma_f32_16x16x32_bf16 v[56:59], a[120:123], a[68:71], v[56:59]
    v_mfma_f32_16x16x32_bf16 v[40:43], a[124:127], a[64:67], v[40:43]
    v_mfma_f32_16x16x32_bf16 v[60:63], a[124:127], a[68:71], v[60:63]
    buffer_load_dwordx4 a[20:23], v8, s[28:31], s51 offen offset:2048 sc1
    v_mfma_f32_16x16x32_bf16 v[44:47], a[128:131], a[64:67], v[44:47]
    v_mfma_f32_16x16x32_bf16 v[64:67], a[128:131], a[68:71], v[64:67]
    v_mfma_f32_16x16x32_bf16 v[48:51], a[132:135], a[64:67], v[48:51]
    v_mfma_f32_16x16x32_bf16 v[68:71], a[132:135], a[68:71], v[68:71]
    s_waitcnt vmcnt(10)
    v_mfma_f32_16x16x32_bf16 v[32:35], a[136:139], a[72:75], v[32:35]
    v_mfma_f32_16x16x32_bf16 v[52:55], a[136:139], a[76:79], v[52:55]
    v_mfma_f32_16x16x32_bf16 v[36:39], a[140:143], a[72:75], v[36:39]
    v_mfma_f32_16x16x32_bf16 v[56:59], a[140:143], a[76:79], v[56:59]
    v_mfma_f32_16x16x32_bf16 v[40:43], a[144:147], a[72:75], v[40:43]
    v_mfma_f32_16x16x32_bf16 v[60:63], a[144:147], a[76:79], v[60:63]
    v_mfma_f32_16x16x32_bf16 v[44:47], a[148:151], a[72:75], v[44:47]
    v_mfma_f32_16x16x32_bf16 v[64:67], a[148:151], a[76:79], v[64:67]
    v_mfma_f32_16x16x32_bf16 v[48:51], a[152:155], a[72:75], v[48:51]
    v_mfma_f32_16x16x32_bf16 v[68:71], a[152:155], a[76:79], v[68:71]
    s_waitcnt vmcnt(8)
    v_mfma_f32_16x16x32_bf16 v[32:35], a[156:159], a[80:83], v[32:35]
    v_mfma_f32_16x16x32_bf16 v[52:55], a[156:159], a[84:87], v[52:55]
    v_mfma_f32_16x16x32_bf16 v[36:39], a[160:163], a[80:83], v[36:39]
    v_mfma_f32_16x16x32_bf16 v[56:59], a[160:163], a[84:87], v[56:59]
    v_mfma_f32_16x16x32_bf16 v[40:43], a[164:167], a[80:83], v[40:43]
    v_mfma_f32_16x16x32_bf16 v[60:63], a[164:167], a[84:87], v[60:63]
    v_mfma_f32_16x16x32_bf16 v[44:47], a[168:171], a[80:83], v[44:47]
    v_mfma_f32_16x16x32_bf16 v[64:67], a[168:171], a[84:87], v[64:67]
    v_mfma_f32_16x16x32_bf16 v[48:51], a[172:175], a[80:83], v[48:51]
    v_mfma_f32_16x16x32_bf16 v[68:71], a[172:175], a[84:87], v[68:71]
    s_waitcnt vmcnt(6)
    v_mfma_f32_16x16x32_bf16 v[32:35], a[176:179], a[88:91], v[32:35]
    v_mfma_f32_16x16x32_bf16 v[52:55], a[176:179], a[92:95], v[52:55]
    v_mfma_f32_16x16x32_bf16 v[36:39], a[180:183], a[88:91], v[36:39]
    v_mfma_f32_16x16x32_bf16 v[56:59], a[180:183], a[92:95], v[56:59]
    v_mfma_f32_16x16x32_bf16 v[40:43], a[184:187], a[88:91], v[40:43]
    v_mfma_f32_16x16x32_bf16 v[60:63], a[184:187], a[92:95], v[60:63]
    v_mfma_f32_16x16x32_bf16 v[44:47], a[188:191], a[88:91], v[44:47]
    v_mfma_f32_16x16x32_bf16 v[64:67], a[188:191], a[92:95], v[64:67]
    v_mfma_f32_16x16x32_bf16 v[48:51], a[192:195], a[88:91], v[48:51]
    v_mfma_f32_16x16x32_bf16 v[68:71], a[192:195], a[92:95], v[68:71]
    s_waitcnt vmcnt(4)
    v_mfma_f32_16x16x32_bf16 v[32:35], a[196:199], a[0:3], v[32:35]
    v_mfma_f32_16x16x32_bf16 v[52:55], a[196:199], a[4:7], v[52:55]
    v_mfma_f32_16x16x32_bf16 v[36:39], a[200:203], a[0:3], v[36:39]
    v_mfma_f32_16x16x32_bf16 v[56:59], a[200:203], a[4:7], v[56:59]
    v_mfma_f32_16x16x32_bf16 v[40:43], a[204:207], a[0:3], v[40:43]
    v_mfma_f32_16x16x32_bf16 v[60:63], a[204:207], a[4:7], v[60:63]
    v_mfma_f32_16x16x32_bf16 v[44:47], a[208:211], a[0:3], v[44:47]
    v_mfma_f32_16x16x32_bf16 v[64:67], a[208:211], a[4:7], v[64:67]
    v_mfma_f32_16x16x32_bf16 v[48:51], a[212:215], a[0:3], v[48:51]
    v_mfma_f32_16x16x32_bf16 v[68:71], a[212:215], a[4:7], v[68:71]
    s_waitcnt vmcnt(2)
    v_mfma_f32_16x16x32_bf16 v[32:35], a[216:219], a[8:11], v[32:35]
    v_mfma_f32_16x16x32_bf16 v[52:55], a[216:219], a[12:15], v[52:55]
    v_mfma_f32_16x16x32_bf16 v[36:39], a[220:223], a[8:11], v[36:39]
    v_mfma_f32_16x16x32_bf16 v[56:59], a[220:223], a[12:15], v[56:59]
    v_mfma_f32_16x16x32_bf16 v[40:43], a[224:227], a[8:11], v[40:43]
    v_mfma_f32_16x16x32_bf16 v[60:63], a[224:227], a[12:15], v[60:63]
    v_mfma_f32_16x16x32_bf16 v[44:47], a[228:231], a[8:11], v[44:47]
    v_mfma_f32_16x16x32_bf16 v[64:67], a[228:231], a[12:15], v[64:67]
    v_mfma_f32_16x16x32_bf16 v[48:51], a[232:235], a[8:11], v[48:51]
    v_mfma_f32_16x16x32_bf16 v[68:71], a[232:235], a[12:15], v[68:71]
    s_waitcnt vmcnt(0)
    v_mfma_f32_16x16x32_bf16 v[32:35], a[236:239], a[16:19], v[32:35]
    v_mfma_f32_16x16x32_bf16 v[52:55], a[236:239], a[20:23], v[52:55]
    v_mfma_f32_16x16x32_bf16 v[36:39], a[240:243], a[16:19], v[36:39]
    v_mfma_f32_16x16x32_bf16 v[56:59], a[240:243], a[20:23], v[56:59]
    v_mfma_f32_16x16x32_bf16 v[40:43], a[244:247], a[16:19], v[40:43]
    v_mfma_f32_16x16x32_bf16 v[60:63], a[244:247], a[20:23], v[60:63]
    v_mfma_f32_16x16x32_bf16 v[44:47], a[248:251], a[16:19], v[44:47]
    v_mfma_f32_16x16x32_bf16 v[64:67], a[248:251], a[20:23], v[64:67]
    v_mfma_f32_16x16x32_bf16 v[48:51], a[252:255], a[16:19], v[48:51]
    v_mfma_f32_16x16x32_bf16 v[68:71], a[252:255], a[20:23], v[68:71]
    s_barrier
    s_nop 4
    ds_write_b128 v246, v[52:55] offset:0
    ds_write_b128 v246, v[56:59] offset:1024
    ds_write_b128 v246, v[60:63] offset:2048
    ds_write_b128 v246, v[64:67] offset:3072
    ds_write_b128 v246, v[68:71] offset:4096
    v_lshlrev_b32 v136, 16, v96
    v_and_b32 v137, 0xffff0000, v96
    v_lshlrev_b32 v138, 16, v97
    v_and_b32 v139, 0xffff0000, v97
    v_lshlrev_b32 v156, 16, v116
    v_and_b32 v157, 0xffff0000, v116
    v_lshlrev_b32 v158, 16, v117
    v_and_b32 v159, 0xffff0000, v117
    v_lshlrev_b32 v140, 16, v98
    v_and_b32 v141, 0xffff0000, v98
    v_lshlrev_b32 v142, 16, v99
    v_and_b32 v143, 0xffff0000, v99
    v_lshlrev_b32 v160, 16, v118
    v_and_b32 v161, 0xffff0000, v118
    v_lshlrev_b32 v162, 16, v119
    v_and_b32 v163, 0xffff0000, v119
    v_lshlrev_b32 v144, 16, v100
    v_and_b32 v145, 0xffff0000, v100
    v_lshlrev_b32 v146, 16, v101
    v_and_b32 v147, 0xffff0000, v101
    v_lshlrev_b32 v164, 16, v120
    v_and_b32 v165, 0xffff0000, v120
    v_lshlrev_b32 v166, 16, v121
    v_and_b32 v167, 0xffff0000, v121
    v_lshlrev_b32 v148, 16, v102
    v_and_b32 v149, 0xffff0000, v102
    v_lshlrev_b32 v150, 16, v103
    v_and_b32 v151, 0xffff0000, v103
    v_lshlrev_b32 v168, 16, v122
    v_and_b32 v169, 0xffff0000, v122
    v_lshlrev_b32 v170, 16, v123
    v_and_b32 v171, 0xffff0000, v123
    v_lshlrev_b32 v152, 16, v104
    v_and_b32 v153, 0xffff0000, v104
    v_lshlrev_b32 v154, 16, v105
    v_and_b32 v155, 0xffff0000, v105
    v_lshlrev_b32 v172, 16, v124
    v_and_b32 v173, 0xffff0000, v124
    v_lshlrev_b32 v174, 16, v125
    v_and_b32 v175, 0xffff0000, v125
    v_pk_add_f32 v[32:33], v[32:33], v[136:137]
    v_pk_add_f32 v[34:35], v[34:35], v[138:139]
    v_pk_add_f32 v[36:37], v[36:37], v[140:141]
    v_pk_add_f32 v[38:39], v[38:39], v[142:143]
    v_pk_add_f32 v[40:41], v[40:41], v[144:145]
    v_pk_add_f32 v[42:43], v[42:43], v[146:147]
    v_pk_add_f32 v[44:45], v[44:45], v[148:149]
    v_pk_add_f32 v[46:47], v[46:47], v[150:151]
    v_pk_add_f32 v[48:49], v[48:49], v[152:153]
    v_pk_add_f32 v[50:51], v[50:51], v[154:155]
    s_waitcnt lgkmcnt(0)
    s_barrier
    ds_read_b128 v[72:75], v247 offset:0
    ds_read_b128 v[76:79], v247 offset:1024
    ds_read_b128 v[80:83], v247 offset:2048
    ds_read_b128 v[84:87], v247 offset:3072
    ds_read_b128 v[88:91], v247 offset:4096
    s_waitcnt lgkmcnt(4)
    v_pk_add_f32 v[32:33], v[32:33], v[72:73]
    v_pk_add_f32 v[34:35], v[34:35], v[74:75]
    v_pk_fma_f32 v[32:33], v[32:33], v[204:205], v[156:157]
    v_pk_fma_f32 v[34:35], v[34:35], v[206:207], v[158:159]
    v_cvt_pk_bf16_f32 v180, v32, v33
    v_cvt_pk_bf16_f32 v181, v34, v35
    s_waitcnt lgkmcnt(3)
    v_pk_add_f32 v[36:37], v[36:37], v[76:77]
    v_pk_add_f32 v[38:39], v[38:39], v[78:79]
    v_pk_fma_f32 v[36:37], v[36:37], v[208:209], v[160:161]
    v_pk_fma_f32 v[38:39], v[38:39], v[210:211], v[162:163]
    v_cvt_pk_bf16_f32 v182, v36, v37
    v_cvt_pk_bf16_f32 v183, v38, v39
    s_waitcnt lgkmcnt(2)
    v_pk_add_f32 v[40:41], v[40:41], v[80:81]
    v_pk_add_f32 v[42:43], v[42:43], v[82:83]
    v_pk_fma_f32 v[40:41], v[40:41], v[212:213], v[164:165]
    v_pk_fma_f32 v[42:43], v[42:43], v[214:215], v[166:167]
    v_cvt_pk_bf16_f32 v184, v40, v41
    v_cvt_pk_bf16_f32 v185, v42, v43
    s_waitcnt lgkmcnt(1)
    v_pk_add_f32 v[44:45], v[44:45], v[84:85]
    v_pk_add_f32 v[46:47], v[46:47], v[86:87]
    v_pk_fma_f32 v[44:45], v[44:45], v[216:217], v[168:169]
    v_pk_fma_f32 v[46:47], v[46:47], v[218:219], v[170:171]
    v_cvt_pk_bf16_f32 v186, v44, v45
    v_cvt_pk_bf16_f32 v187, v46, v47
    s_waitcnt lgkmcnt(0)
    v_pk_add_f32 v[48:49], v[48:49], v[88:89]
    v_pk_add_f32 v[50:51], v[50:51], v[90:91]
    v_pk_fma_f32 v[48:49], v[48:49], v[220:221], v[172:173]
    v_pk_fma_f32 v[50:51], v[50:51], v[222:223], v[174:175]
    v_cvt_pk_bf16_f32 v188, v48, v49
    v_cvt_pk_bf16_f32 v189, v50, v51
    s_nop 1
    v_permlane16_swap_b32 v180, v182
    v_permlane16_swap_b32 v181, v183
    v_permlane16_swap_b32 v184, v186
    v_permlane16_swap_b32 v185, v187
    buffer_store_dwordx4 v[180:183], v231, s[32:35], s46 offen sc1
    buffer_store_dwordx4 v[184:187], v231, s[32:35], s46 offen offset:64 sc1
    buffer_store_dwordx2 v[188:189], v232, s[32:35], s49 offen sc1
    s_endpgm
chain_end:
    s_endpgm
.section .rodata,"a"
.p2align 6
.amdhsa_kernel prep_kernel
  .amdhsa_next_free_vgpr 256
  .amdhsa_next_free_sgpr 100
  .amdhsa_accum_offset 256
  .amdhsa_group_segment_fixed_size 0
  .amdhsa_kernarg_size 128
  .amdhsa_user_sgpr_count 2
  .amdhsa_user_sgpr_kernarg_segment_ptr 1
  .amdhsa_system_sgpr_workgroup_id_x 1
  .amdhsa_float_denorm_mode_32 3
.end_amdhsa_kernel
.p2align 6
.amdhsa_kernel chain_kernel
  .amdhsa_next_free_vgpr 512
  .amdhsa_next_free_sgpr 100
  .amdhsa_accum_offset 256
  .amdhsa_group_segment_fixed_size 0
  .amdhsa_kernarg_size 128
  .amdhsa_user_sgpr_count 2
  .amdhsa_user_sgpr_kernarg_segment_ptr 1
  .amdhsa_system_sgpr_workgroup_id_x 1
  .amdhsa_float_denorm_mode_32 3
.end_amdhsa_kernel
```

```asm
; @launch kernel=prep_kernel grid=(512,1,1) block=(512,1,1) lds=88064
; @launch kernel=chain_kernel grid=(256,1,1) block=(256,1,1) lds=163840
.amdgcn_target "amdgcn-amd-amdhsa--gfx950"
.text
.globl prep_kernel
.p2align 8
.type prep_kernel,@function
prep_kernel:
    s_cmp_ge_u32 s2, 512
    s_cbranch_scc1 prep_end
    s_load_dwordx4 s[4:7], s[0:1], 8
    s_load_dwordx2 s[8:9], s[0:1], 24
    s_load_dwordx2 s[10:11], s[0:1], 120
    s_load_dwordx8 s[12:19], s[0:1], 56
    s_load_dwordx2 s[60:61], s[0:1], 0
    s_load_dwordx2 s[62:63], s[0:1], 96
    s_load_dwordx2 s[52:53], s[0:1], 88
    s_load_dwordx2 s[54:55], s[0:1], 112
    s_load_dwordx4 s[56:59], s[0:1], 32
    s_memrealtime s[64:65]
    v_lshrrev_b32 v2, 6, v0
    v_and_b32 v1, 63, v0
    v_readfirstlane_b32 s20, v2
    s_waitcnt lgkmcnt(0)
    s_mov_b32 s28, s10
    s_mov_b32 s29, s11
    s_mov_b32 s30, 268435456
    s_mov_b32 s31, 0x00020000
    s_mov_b32 s48, s54
    s_mov_b32 s49, s55
    s_mov_b32 s50, 256
    s_mov_b32 s51, 0x00020000
    s_cmp_ge_u32 s2, 416
    s_cbranch_scc1 p_pack
    s_cmp_ge_u32 s2, 256
    s_cbranch_scc1 p_conv
    s_cmp_ge_u32 s2, 160
    s_cbranch_scc1 p_aux
    s_or_b32 s21, s2, s20
    s_cmp_lg_u32 s21, 0
    s_cbranch_scc1 prep_kernel_n01
    s_or_b32 s64, s64, 1
    v_mov_b32 v3, s64
    v_mov_b32 v4, 0
    s_mov_b64 exec, 1
    buffer_store_dword v3, v4, s[48:51], 0 offen sc1
    s_mov_b64 exec, -1
prep_kernel_n01:
    s_mov_b32 s45, s20
    s_mov_b32 s16, s4
    s_mov_b32 s17, s5
    s_mov_b32 s18, 2621440
    s_mov_b32 s19, 0x00020000
    s_mov_b32 s20, s6
    s_mov_b32 s21, s7
    s_mov_b32 s22, 2621440
    s_mov_b32 s23, 0x00020000
    s_mov_b32 s24, s8
    s_mov_b32 s25, s9
    s_mov_b32 s26, 5120
    s_mov_b32 s27, 0x00020000
    s_lshr_b32 s47, s45, 2
    s_lshl_b32 s46, s2, 1
    s_add_u32 s46, s46, s47
    v_and_b32 v0, 255, v0
    s_mul_i32 s32, s46, 52429
    s_lshr_b32 s32, s32, 19
    s_mul_i32 s33, s32, 10
    s_sub_u32 s33, s46, s33
    s_lshl_b32 s43, s47, 13
    v_and_b32 v1, 15, v0
    v_lshrrev_b32 v2, 4, v0
    s_lshl_b32 s34, s32, 6
    v_lshl_add_u32 v3, v2, 2, s34
    v_mul_u32_u24 v4, 1280, v3
    s_lshl_b32 s35, s33, 7
    v_lshl_add_u32 v5, v1, 3, s35
    v_add_u32 v4, v4, v5
    v_subrev_u32 v6, 3840, v4
    v_subrev_u32 v7, 2560, v4
    v_subrev_u32 v8, 1280, v4
    buffer_load_dwordx2 v[10:11], v6, s[16:19], 0 offen nt
    buffer_load_dwordx2 v[12:13], v7, s[16:19], 0 offen nt
    buffer_load_dwordx2 v[14:15], v8, s[16:19], 0 offen nt
    buffer_load_dwordx2 v[16:17], v4, s[16:19], 0 offen offset:0 nt
    buffer_load_dwordx2 v[18:19], v4, s[16:19], 0 offen offset:1280 nt
    buffer_load_dwordx2 v[20:21], v4, s[16:19], 0 offen offset:2560 nt
    buffer_load_dwordx2 v[22:23], v4, s[16:19], 0 offen offset:3840 nt
    v_lshlrev_b32 v100, 2, v5
    buffer_load_dwordx4 v[32:35], v100, s[24:27], 0 offen
    buffer_load_dwordx4 v[36:39], v100, s[24:27], 0 offen offset:16
    buffer_load_dwordx2 v[24:25], v4, s[20:23], 0 offen offset:0 nt
    buffer_load_dwordx2 v[26:27], v4, s[20:23], 0 offen offset:1280 nt
    buffer_load_dwordx2 v[28:29], v4, s[20:23], 0 offen offset:2560 nt
    buffer_load_dwordx2 v[30:31], v4, s[20:23], 0 offen offset:3840 nt
    v_lshlrev_b32 v100, 9, v1
    v_sub_u32 v101, 15, v2
    v_lshl_add_u32 v100, v101, 3, v100
    v_add_u32 v100, s43, v100
    v_lshrrev_b32 v101, 3, v0
    v_mul_u32_u24 v101, 4352, v101
    v_and_b32 v102, 7, v0
    v_lshl_add_u32 v103, v102, 4, v101
    v_lshlrev_b32 v104, 4, v0
    v_add_u32 v104, s43, v104
    s_mul_i32 s36, s33, 278528
    s_lshr_b32 s37, s32, 1
    s_mul_i32 s37, s37, 272
    s_add_u32 s36, s36, s37
    s_add_u32 s36, s36, 0
    s_and_b32 s37, s32, 1
    s_lshl_b32 s38, s37, 7
    s_sub_u32 s38, 128, s38
    s_add_u32 s38, s38, s36
    s_lshl_b32 s44, s33, 5
    s_add_u32 s44, s44, s32
    s_lshl_b32 s44, s44, 7
    s_add_u32 s44, s44, 29642752
    s_waitcnt vmcnt(4)
    v_mov_b32 v123, 0
    buffer_load_dword v122, v123, s[48:51], 0 offen sc1
    v_lshlrev_b32 v40, 16, v32
    v_and_b32 v44, 0xffff0000, v32
    v_lshlrev_b32 v48, 16, v33
    v_and_b32 v52, 0xffff0000, v33
    v_lshlrev_b32 v41, 16, v34
    v_and_b32 v45, 0xffff0000, v34
    v_lshlrev_b32 v49, 16, v35
    v_and_b32 v53, 0xffff0000, v35
    v_lshlrev_b32 v42, 16, v36
    v_and_b32 v46, 0xffff0000, v36
    v_lshlrev_b32 v50, 16, v37
    v_and_b32 v54, 0xffff0000, v37
    v_lshlrev_b32 v43, 16, v38
    v_and_b32 v47, 0xffff0000, v38
    v_lshlrev_b32 v51, 16, v39
    v_and_b32 v55, 0xffff0000, v39
    v_lshlrev_b32 v56, 16, v10
    v_and_b32 v57, 0xffff0000, v10
    v_lshlrev_b32 v58, 16, v11
    v_and_b32 v59, 0xffff0000, v11
    v_lshlrev_b32 v60, 16, v12
    v_and_b32 v61, 0xffff0000, v12
    v_lshlrev_b32 v62, 16, v13
    v_and_b32 v63, 0xffff0000, v13
    v_lshlrev_b32 v64, 16, v14
    v_and_b32 v65, 0xffff0000, v14
    v_lshlrev_b32 v66, 16, v15
    v_and_b32 v67, 0xffff0000, v15
    v_lshlrev_b32 v68, 16, v16
    v_and_b32 v69, 0xffff0000, v16
    v_lshlrev_b32 v70, 16, v17
    v_and_b32 v71, 0xffff0000, v17
    v_lshlrev_b32 v72, 16, v18
    v_and_b32 v73, 0xffff0000, v18
    v_lshlrev_b32 v74, 16, v19
    v_and_b32 v75, 0xffff0000, v19
    v_lshlrev_b32 v76, 16, v20
    v_and_b32 v77, 0xffff0000, v20
    v_lshlrev_b32 v78, 16, v21
    v_and_b32 v79, 0xffff0000, v21
    v_lshlrev_b32 v80, 16, v22
    v_and_b32 v81, 0xffff0000, v22
    v_lshlrev_b32 v82, 16, v23
    v_and_b32 v83, 0xffff0000, v23
    v_pk_mul_f32 v[84:85], v[56:57], v[52:53]
    v_pk_mul_f32 v[86:87], v[58:59], v[54:55]
    v_pk_mul_f32 v[88:89], v[60:61], v[52:53]
    v_pk_mul_f32 v[90:91], v[62:63], v[54:55]
    v_pk_mul_f32 v[92:93], v[64:65], v[52:53]
    v_pk_mul_f32 v[94:95], v[66:67], v[54:55]
    v_pk_mul_f32 v[96:97], v[68:69], v[52:53]
    v_pk_mul_f32 v[98:99], v[70:71], v[54:55]
    v_pk_fma_f32 v[84:85], v[60:61], v[48:49], v[84:85]
    v_pk_fma_f32 v[86:87], v[62:63], v[50:51], v[86:87]
    v_pk_fma_f32 v[88:89], v[64:65], v[48:49], v[88:89]
    v_pk_fma_f32 v[90:91], v[66:67], v[50:51], v[90:91]
    v_pk_fma_f32 v[92:93], v[68:69], v[48:49], v[92:93]
    v_pk_fma_f32 v[94:95], v[70:71], v[50:51], v[94:95]
    v_pk_fma_f32 v[96:97], v[72:73], v[48:49], v[96:97]
    v_pk_fma_f32 v[98:99], v[74:75], v[50:51], v[98:99]
    v_pk_fma_f32 v[84:85], v[64:65], v[44:45], v[84:85]
    v_pk_fma_f32 v[86:87], v[66:67], v[46:47], v[86:87]
    v_pk_fma_f32 v[88:89], v[68:69], v[44:45], v[88:89]
    v_pk_fma_f32 v[90:91], v[70:71], v[46:47], v[90:91]
    v_pk_fma_f32 v[92:93], v[72:73], v[44:45], v[92:93]
    v_pk_fma_f32 v[94:95], v[74:75], v[46:47], v[94:95]
    v_pk_fma_f32 v[96:97], v[76:77], v[44:45], v[96:97]
    v_pk_fma_f32 v[98:99], v[78:79], v[46:47], v[98:99]
    v_pk_fma_f32 v[84:85], v[68:69], v[40:41], v[84:85]
    v_pk_fma_f32 v[86:87], v[70:71], v[42:43], v[86:87]
    v_pk_fma_f32 v[88:89], v[72:73], v[40:41], v[88:89]
    v_pk_fma_f32 v[90:91], v[74:75], v[42:43], v[90:91]
    v_pk_fma_f32 v[92:93], v[76:77], v[40:41], v[92:93]
    v_pk_fma_f32 v[94:95], v[78:79], v[42:43], v[94:95]
    v_pk_fma_f32 v[96:97], v[80:81], v[40:41], v[96:97]
    v_pk_fma_f32 v[98:99], v[82:83], v[42:43], v[98:99]
    v_cvt_pk_bf16_f32 v56, v84, v85
    v_cvt_pk_bf16_f32 v57, v86, v87
    v_cvt_pk_bf16_f32 v58, v88, v89
    v_cvt_pk_bf16_f32 v59, v90, v91
    v_cvt_pk_bf16_f32 v60, v92, v93
    v_cvt_pk_bf16_f32 v61, v94, v95
    v_cvt_pk_bf16_f32 v62, v96, v97
    v_cvt_pk_bf16_f32 v63, v98, v99
    s_waitcnt vmcnt(1)
    v_lshlrev_b32 v84, 16, v56
    v_and_b32 v85, 0xffff0000, v56
    v_lshlrev_b32 v86, 16, v57
    v_and_b32 v87, 0xffff0000, v57
    v_lshlrev_b32 v88, 16, v58
    v_and_b32 v89, 0xffff0000, v58
    v_lshlrev_b32 v90, 16, v59
    v_and_b32 v91, 0xffff0000, v59
    v_lshlrev_b32 v92, 16, v60
    v_and_b32 v93, 0xffff0000, v60
    v_lshlrev_b32 v94, 16, v61
    v_and_b32 v95, 0xffff0000, v61
    v_lshlrev_b32 v96, 16, v62
    v_and_b32 v97, 0xffff0000, v62
    v_lshlrev_b32 v98, 16, v63
    v_and_b32 v99, 0xffff0000, v63
    v_lshlrev_b32 v64, 16, v24
    v_and_b32 v65, 0xffff0000, v24
    v_pk_mul_f32 v[84:85], v[84:85], v[64:65]
    v_lshlrev_b32 v66, 16, v25
    v_and_b32 v67, 0xffff0000, v25
    v_pk_mul_f32 v[86:87], v[86:87], v[66:67]
    v_lshlrev_b32 v68, 16, v26
    v_and_b32 v69, 0xffff0000, v26
    v_pk_mul_f32 v[88:89], v[88:89], v[68:69]
    v_lshlrev_b32 v70, 16, v27
    v_and_b32 v71, 0xffff0000, v27
    v_pk_mul_f32 v[90:91], v[90:91], v[70:71]
    v_lshlrev_b32 v64, 16, v28
    v_and_b32 v65, 0xffff0000, v28
    v_pk_mul_f32 v[92:93], v[92:93], v[64:65]
    v_lshlrev_b32 v66, 16, v29
    v_and_b32 v67, 0xffff0000, v29
    v_pk_mul_f32 v[94:95], v[94:95], v[66:67]
    v_lshlrev_b32 v68, 16, v30
    v_and_b32 v69, 0xffff0000, v30
    v_pk_mul_f32 v[96:97], v[96:97], v[68:69]
    v_lshlrev_b32 v70, 16, v31
    v_and_b32 v71, 0xffff0000, v31
    v_pk_mul_f32 v[98:99], v[98:99], v[70:71]
    v_cvt_pk_bf16_f32 v64, v96, v92
    v_cvt_pk_bf16_f32 v65, v88, v84
    v_cvt_pk_bf16_f32 v66, v97, v93
    v_cvt_pk_bf16_f32 v67, v89, v85
    v_cvt_pk_bf16_f32 v68, v98, v94
    v_cvt_pk_bf16_f32 v69, v90, v86
    v_cvt_pk_bf16_f32 v70, v99, v95
    v_cvt_pk_bf16_f32 v71, v91, v87
    ds_write_b64 v100, v[64:65] offset:0
    ds_write_b64 v100, v[66:67] offset:128
    ds_write_b64 v100, v[68:69] offset:256
    ds_write_b64 v100, v[70:71] offset:384
    s_waitcnt lgkmcnt(0)
    s_barrier
    ds_read_b128 v[10:13], v104 offset:0
    ds_read_b128 v[14:17], v104 offset:4096
    s_waitcnt lgkmcnt(1)
    buffer_store_dwordx4 v[10:13], v103, s[28:31], s38 offen sc1
    s_add_u32 s38, s38, 139264
    s_waitcnt lgkmcnt(0)
    buffer_store_dwordx4 v[14:17], v103, s[28:31], s38 offen sc1
    s_add_u32 s38, s38, 139264
    v_cmp_eq_u32 vcc, 0, v102
    s_and_saveexec_b64 s[66:67], vcc
    s_cmp_eq_u32 s37, 0
    s_cbranch_scc1 prep_kernel_L2
    s_cmp_eq_u32 s32, 31
    s_cbranch_scc1 prep_kernel_L3
    buffer_store_dwordx4 v[10:13], v101, s[28:31], s36 offen offset:528 sc1
    s_add_u32 s36, s36, 139264
    buffer_store_dwordx4 v[14:17], v101, s[28:31], s36 offen offset:528 sc1
    s_add_u32 s36, s36, 139264
    s_branch prep_kernel_L3
prep_kernel_L2:
    s_cmp_lg_u32 s32, 0
    s_cbranch_scc1 prep_kernel_L3
    v_mov_b32 v108, 0
    v_mov_b32 v109, 0
    v_mov_b32 v110, 0
    v_mov_b32 v111, 0
    buffer_store_dwordx4 v[108:111], v101, s[28:31], s36 offen offset:256 sc1
    s_add_u32 s36, s36, 139264
    buffer_store_dwordx4 v[108:111], v101, s[28:31], s36 offen offset:256 sc1
    s_add_u32 s36, s36, 139264
prep_kernel_L3:
    s_mov_b64 exec, -1
    s_waitcnt vmcnt(0)
    s_barrier
    s_and_b32 s45, s45, 3
    s_cmp_lg_u32 s45, 0
    s_cbranch_scc1 prep_end
    s_mov_b32 s47, 0
prep_kernel_nn4:
    v_readfirstlane_b32 s46, v122
    s_add_u32 s47, s47, 1
    s_cmp_lg_u32 s46, 0
    s_cbranch_scc1 prep_kernel_nd5
    s_cmp_ge_u32 s47, 200000
    s_cbranch_scc1 prep_kernel_nd5
    buffer_load_dword v122, v123, s[48:51], 0 offen sc1
    s_waitcnt vmcnt(0)
    s_branch prep_kernel_nn4
prep_kernel_nd5:
    v_mov_b32 v124, s46
    v_mov_b32 v125, 0
    s_mov_b64 exec, 1
    buffer_store_dword v124, v125, s[28:31], s44 offen sc1
    s_endpgm
prep_end:
    s_endpgm
p_aux:
    v_mov_b32 v251, 0
    buffer_load_dword v250, v251, s[48:51], 0 offen sc1
    s_waitcnt vmcnt(0)
    s_mov_b32 s47, 0
prep_kernel_nn6:
    v_readfirstlane_b32 s46, v250
    s_add_u32 s47, s47, 1
    s_cmp_lg_u32 s46, 0
    s_cbranch_scc1 prep_kernel_nd7
    s_cmp_ge_u32 s47, 200000
    s_cbranch_scc1 prep_kernel_nd7
    buffer_load_dword v250, v251, s[48:51], 0 offen sc1
    s_waitcnt vmcnt(0)
    s_branch prep_kernel_nn6
prep_kernel_nd7:
    s_sub_u32 s21, s2, 160
    s_cmp_ge_u32 s20, 6
    s_cbranch_scc1 prep_end
    s_cmp_ge_u32 s20, 3
    s_cbranch_scc1 p_misc
    s_cmp_eq_u32 s20, 0
    s_cbranch_scc1 p_st
    s_cmp_eq_u32 s20, 2
    s_cbranch_scc1 p_aux2
    s_add_u32 s21, s21, 96
    s_cmp_lt_u32 s21, 128
    s_cbranch_scc1 p_st
    s_sub_u32 s21, s21, 128
    s_branch p_mod
p_aux2:
    s_cmp_ge_u32 s21, 56
    s_cbranch_scc1 prep_end
    s_add_u32 s21, s21, 64
p_mod:
    s_lshr_b32 s32, s21, 2
    s_and_b32 s33, s21, 3
    v_lshrrev_b32 v4, 3, v1
    v_and_b32 v3, 7, v1
    s_mul_i32 s34, s33, 160
    v_add_u32 v4, s34, v4
    v_lshlrev_b32 v5, 1, v4
    v_mul_u32_u24 v6, 7680, v4
    s_lshl_b32 s36, s32, 7
    v_lshl_add_u32 v7, v3, 4, s36
    v_add_u32 v6, v6, v7
    s_mov_b32 s16, s52
    s_mov_b32 s17, s53
    s_mov_b32 s18, 1280
    s_mov_b32 s19, 0x00020000
    s_mov_b32 s24, s62
    s_mov_b32 s25, s63
    s_mov_b32 s26, 4915200
    s_mov_b32 s27, 0x00020000
    s_mul_i32 s35, s33, 320
    v_lshlrev_b32 v5, 3, v1
    buffer_load_dwordx2 v[30:31], v5, s[16:19], s35 offen
    s_mov_b32 s37, 0
    buffer_load_dwordx4 v[32:35], v6, s[24:27], s37 offen nt
    s_add_u32 s37, s37, 61440
    buffer_load_dwordx4 v[36:39], v6, s[24:27], s37 offen nt
    s_add_u32 s37, s37, 61440
    buffer_load_dwordx4 v[40:43], v6, s[24:27], s37 offen nt
    s_add_u32 s37, s37, 61440
    buffer_load_dwordx4 v[44:47], v6, s[24:27], s37 offen nt
    s_add_u32 s37, s37, 61440
    buffer_load_dwordx4 v[48:51], v6, s[24:27], s37 offen nt
    s_add_u32 s37, s37, 61440
    buffer_load_dwordx4 v[52:55], v6, s[24:27], s37 offen nt
    s_add_u32 s37, s37, 61440
    buffer_load_dwordx4 v[56:59], v6, s[24:27], s37 offen nt
    s_add_u32 s37, s37, 61440
    buffer_load_dwordx4 v[60:63], v6, s[24:27], s37 offen nt
    s_add_u32 s37, s37, 61440
    buffer_load_dwordx4 v[64:67], v6, s[24:27], s37 offen nt
    s_add_u32 s37, s37, 61440
    buffer_load_dwordx4 v[68:71], v6, s[24:27], s37 offen nt
    s_add_u32 s37, s37, 61440
    buffer_load_dwordx4 v[72:75], v6, s[24:27], s37 offen nt
    s_add_u32 s37, s37, 61440
    buffer_load_dwordx4 v[76:79], v6, s[24:27], s37 offen nt
    s_add_u32 s37, s37, 61440
    buffer_load_dwordx4 v[80:83], v6, s[24:27], s37 offen nt
    s_add_u32 s37, s37, 61440
    buffer_load_dwordx4 v[84:87], v6, s[24:27], s37 offen nt
    s_add_u32 s37, s37, 61440
    buffer_load_dwordx4 v[88:91], v6, s[24:27], s37 offen nt
    s_add_u32 s37, s37, 61440
    buffer_load_dwordx4 v[92:95], v6, s[24:27], s37 offen nt
    s_add_u32 s37, s37, 61440
    buffer_load_dwordx4 v[96:99], v6, s[24:27], s37 offen nt
    s_add_u32 s37, s37, 61440
    buffer_load_dwordx4 v[100:103], v6, s[24:27], s37 offen nt
    s_add_u32 s37, s37, 61440
    buffer_load_dwordx4 v[104:107], v6, s[24:27], s37 offen nt
    s_add_u32 s37, s37, 61440
    buffer_load_dwordx4 v[108:111], v6, s[24:27], s37 offen nt
    s_mul_i32 s35, s20, 13824
    v_lshlrev_b32 v5, 4, v1
    v_add_u32 v5, s35, v5
    v_lshrrev_b32 v29, 3, v1
    v_lshlrev_b32 v29, 2, v29
    v_add_u32 v29, s35, v29
    s_waitcnt vmcnt(20)
    v_lshlrev_b32 v8, 16, v30
    v_and_b32 v9, 0xffff0000, v30
    v_lshlrev_b32 v10, 16, v31
    v_and_b32 v11, 0xffff0000, v31
    v_mul_f32 v120, 0xbfb8aa3b, v8
    v_mul_f32 v121, 0xbfb8aa3b, v9
    v_mul_f32 v122, 0xbfb8aa3b, v10
    v_mul_f32 v123, 0xbfb8aa3b, v11
    v_exp_f32 v120, v120
    v_exp_f32 v121, v121
    v_exp_f32 v122, v122
    v_exp_f32 v123, v123
    v_add_f32 v120, 1.0, v120
    v_add_f32 v121, 1.0, v121
    v_add_f32 v122, 1.0, v122
    v_add_f32 v123, 1.0, v123
    v_rcp_f32 v120, v120
    v_rcp_f32 v121, v121
    v_rcp_f32 v122, v122
    v_rcp_f32 v123, v123
    s_nop 0
    v_mul_f32 v8, v8, v120
    v_mul_f32 v9, v9, v121
    v_mul_f32 v10, v10, v122
    v_mul_f32 v11, v11, v123
    v_cvt_pk_bf16_f32 v120, v8, v9
    v_lshlrev_b32 v8, 16, v120
    v_and_b32 v9, 0xffff0000, v120
    v_cvt_pk_bf16_f32 v120, v10, v11
    v_lshlrev_b32 v10, 16, v120
    v_and_b32 v11, 0xffff0000, v120
    ds_write_b128 v5, v[8:11]
    s_waitcnt lgkmcnt(0)
    ds_read_b32 v8, v29 offset:0
    ds_read_b32 v9, v29 offset:32
    ds_read_b32 v10, v29 offset:64
    ds_read_b32 v11, v29 offset:96
    ds_read_b32 v12, v29 offset:128
    ds_read_b32 v13, v29 offset:160
    ds_read_b32 v14, v29 offset:192
    ds_read_b32 v15, v29 offset:224
    ds_read_b32 v16, v29 offset:256
    ds_read_b32 v17, v29 offset:288
    ds_read_b32 v18, v29 offset:320
    ds_read_b32 v19, v29 offset:352
    ds_read_b32 v20, v29 offset:384
    ds_read_b32 v21, v29 offset:416
    ds_read_b32 v22, v29 offset:448
    ds_read_b32 v23, v29 offset:480
    ds_read_b32 v24, v29 offset:512
    ds_read_b32 v25, v29 offset:544
    ds_read_b32 v26, v29 offset:576
    ds_read_b32 v27, v29 offset:608
    s_waitcnt lgkmcnt(0)
    v_mov_b32 v112, 0
    v_mov_b32 v113, 0
    v_mov_b32 v114, 0
    v_mov_b32 v115, 0
    v_mov_b32 v116, 0
    v_mov_b32 v117, 0
    v_mov_b32 v118, 0
    v_mov_b32 v119, 0
    s_waitcnt vmcnt(19)
    v_lshlrev_b32 v120, 16, v32
    v_and_b32 v121, 0xffff0000, v32
    v_lshlrev_b32 v122, 16, v33
    v_and_b32 v123, 0xffff0000, v33
    v_lshlrev_b32 v124, 16, v34
    v_and_b32 v125, 0xffff0000, v34
    v_lshlrev_b32 v126, 16, v35
    v_and_b32 v127, 0xffff0000, v35
    v_pk_fma_f32 v[112:113], v[120:121], v[8:9], v[112:113] op_sel:[0,0,0] op_sel_hi:[1,0,1]
    v_pk_fma_f32 v[114:115], v[122:123], v[8:9], v[114:115] op_sel:[0,0,0] op_sel_hi:[1,0,1]
    v_pk_fma_f32 v[116:117], v[124:125], v[8:9], v[116:117] op_sel:[0,0,0] op_sel_hi:[1,0,1]
    v_pk_fma_f32 v[118:119], v[126:127], v[8:9], v[118:119] op_sel:[0,0,0] op_sel_hi:[1,0,1]
    s_waitcnt vmcnt(18)
    v_lshlrev_b32 v120, 16, v36
    v_and_b32 v121, 0xffff0000, v36
    v_lshlrev_b32 v122, 16, v37
    v_and_b32 v123, 0xffff0000, v37
    v_lshlrev_b32 v124, 16, v38
    v_and_b32 v125, 0xffff0000, v38
    v_lshlrev_b32 v126, 16, v39
    v_and_b32 v127, 0xffff0000, v39
    v_pk_fma_f32 v[112:113], v[120:121], v[8:9], v[112:113] op_sel:[0,1,0] op_sel_hi:[1,1,1]
    v_pk_fma_f32 v[114:115], v[122:123], v[8:9], v[114:115] op_sel:[0,1,0] op_sel_hi:[1,1,1]
    v_pk_fma_f32 v[116:117], v[124:125], v[8:9], v[116:117] op_sel:[0,1,0] op_sel_hi:[1,1,1]
    v_pk_fma_f32 v[118:119], v[126:127], v[8:9], v[118:119] op_sel:[0,1,0] op_sel_hi:[1,1,1]
    s_waitcnt vmcnt(17)
    v_lshlrev_b32 v120, 16, v40
    v_and_b32 v121, 0xffff0000, v40
    v_lshlrev_b32 v122, 16, v41
    v_and_b32 v123, 0xffff0000, v41
    v_lshlrev_b32 v124, 16, v42
    v_and_b32 v125, 0xffff0000, v42
    v_lshlrev_b32 v126, 16, v43
    v_and_b32 v127, 0xffff0000, v43
    v_pk_fma_f32 v[112:113], v[120:121], v[10:11], v[112:113] op_sel:[0,0,0] op_sel_hi:[1,0,1]
    v_pk_fma_f32 v[114:115], v[122:123], v[10:11], v[114:115] op_sel:[0,0,0] op_sel_hi:[1,0,1]
    v_pk_fma_f32 v[116:117], v[124:125], v[10:11], v[116:117] op_sel:[0,0,0] op_sel_hi:[1,0,1]
    v_pk_fma_f32 v[118:119], v[126:127], v[10:11], v[118:119] op_sel:[0,0,0] op_sel_hi:[1,0,1]
    s_waitcnt vmcnt(16)
    v_lshlrev_b32 v120, 16, v44
    v_and_b32 v121, 0xffff0000, v44
    v_lshlrev_b32 v122, 16, v45
    v_and_b32 v123, 0xffff0000, v45
    v_lshlrev_b32 v124, 16, v46
    v_and_b32 v125, 0xffff0000, v46
    v_lshlrev_b32 v126, 16, v47
    v_and_b32 v127, 0xffff0000, v47
    v_pk_fma_f32 v[112:113], v[120:121], v[10:11], v[112:113] op_sel:[0,1,0] op_sel_hi:[1,1,1]
    v_pk_fma_f32 v[114:115], v[122:123], v[10:11], v[114:115] op_sel:[0,1,0] op_sel_hi:[1,1,1]
    v_pk_fma_f32 v[116:117], v[124:125], v[10:11], v[116:117] op_sel:[0,1,0] op_sel_hi:[1,1,1]
    v_pk_fma_f32 v[118:119], v[126:127], v[10:11], v[118:119] op_sel:[0,1,0] op_sel_hi:[1,1,1]
    s_waitcnt vmcnt(15)
    v_lshlrev_b32 v120, 16, v48
    v_and_b32 v121, 0xffff0000, v48
    v_lshlrev_b32 v122, 16, v49
    v_and_b32 v123, 0xffff0000, v49
    v_lshlrev_b32 v124, 16, v50
    v_and_b32 v125, 0xffff0000, v50
    v_lshlrev_b32 v126, 16, v51
    v_and_b32 v127, 0xffff0000, v51
    v_pk_fma_f32 v[112:113], v[120:121], v[12:13], v[112:113] op_sel:[0,0,0] op_sel_hi:[1,0,1]
    v_pk_fma_f32 v[114:115], v[122:123], v[12:13], v[114:115] op_sel:[0,0,0] op_sel_hi:[1,0,1]
    v_pk_fma_f32 v[116:117], v[124:125], v[12:13], v[116:117] op_sel:[0,0,0] op_sel_hi:[1,0,1]
    v_pk_fma_f32 v[118:119], v[126:127], v[12:13], v[118:119] op_sel:[0,0,0] op_sel_hi:[1,0,1]
    s_waitcnt vmcnt(14)
    v_lshlrev_b32 v120, 16, v52
    v_and_b32 v121, 0xffff0000, v52
    v_lshlrev_b32 v122, 16, v53
    v_and_b32 v123, 0xffff0000, v53
    v_lshlrev_b32 v124, 16, v54
    v_and_b32 v125, 0xffff0000, v54
    v_lshlrev_b32 v126, 16, v55
    v_and_b32 v127, 0xffff0000, v55
    v_pk_fma_f32 v[112:113], v[120:121], v[12:13], v[112:113] op_sel:[0,1,0] op_sel_hi:[1,1,1]
    v_pk_fma_f32 v[114:115], v[122:123], v[12:13], v[114:115] op_sel:[0,1,0] op_sel_hi:[1,1,1]
    v_pk_fma_f32 v[116:117], v[124:125], v[12:13], v[116:117] op_sel:[0,1,0] op_sel_hi:[1,1,1]
    v_pk_fma_f32 v[118:119], v[126:127], v[12:13], v[118:119] op_sel:[0,1,0] op_sel_hi:[1,1,1]
    s_waitcnt vmcnt(13)
    v_lshlrev_b32 v120, 16, v56
    v_and_b32 v121, 0xffff0000, v56
    v_lshlrev_b32 v122, 16, v57
    v_and_b32 v123, 0xffff0000, v57
    v_lshlrev_b32 v124, 16, v58
    v_and_b32 v125, 0xffff0000, v58
    v_lshlrev_b32 v126, 16, v59
    v_and_b32 v127, 0xffff0000, v59
    v_pk_fma_f32 v[112:113], v[120:121], v[14:15], v[112:113] op_sel:[0,0,0] op_sel_hi:[1,0,1]
    v_pk_fma_f32 v[114:115], v[122:123], v[14:15], v[114:115] op_sel:[0,0,0] op_sel_hi:[1,0,1]
    v_pk_fma_f32 v[116:117], v[124:125], v[14:15], v[116:117] op_sel:[0,0,0] op_sel_hi:[1,0,1]
    v_pk_fma_f32 v[118:119], v[126:127], v[14:15], v[118:119] op_sel:[0,0,0] op_sel_hi:[1,0,1]
    s_waitcnt vmcnt(12)
    v_lshlrev_b32 v120, 16, v60
    v_and_b32 v121, 0xffff0000, v60
    v_lshlrev_b32 v122, 16, v61
    v_and_b32 v123, 0xffff0000, v61
    v_lshlrev_b32 v124, 16, v62
    v_and_b32 v125, 0xffff0000, v62
    v_lshlrev_b32 v126, 16, v63
    v_and_b32 v127, 0xffff0000, v63
    v_pk_fma_f32 v[112:113], v[120:121], v[14:15], v[112:113] op_sel:[0,1,0] op_sel_hi:[1,1,1]
    v_pk_fma_f32 v[114:115], v[122:123], v[14:15], v[114:115] op_sel:[0,1,0] op_sel_hi:[1,1,1]
    v_pk_fma_f32 v[116:117], v[124:125], v[14:15], v[116:117] op_sel:[0,1,0] op_sel_hi:[1,1,1]
    v_pk_fma_f32 v[118:119], v[126:127], v[14:15], v[118:119] op_sel:[0,1,0] op_sel_hi:[1,1,1]
    s_waitcnt vmcnt(11)
    v_lshlrev_b32 v120, 16, v64
    v_and_b32 v121, 0xffff0000, v64
    v_lshlrev_b32 v122, 16, v65
    v_and_b32 v123, 0xffff0000, v65
    v_lshlrev_b32 v124, 16, v66
    v_and_b32 v125, 0xffff0000, v66
    v_lshlrev_b32 v126, 16, v67
    v_and_b32 v127, 0xffff0000, v67
    v_pk_fma_f32 v[112:113], v[120:121], v[16:17], v[112:113] op_sel:[0,0,0] op_sel_hi:[1,0,1]
    v_pk_fma_f32 v[114:115], v[122:123], v[16:17], v[114:115] op_sel:[0,0,0] op_sel_hi:[1,0,1]
    v_pk_fma_f32 v[116:117], v[124:125], v[16:17], v[116:117] op_sel:[0,0,0] op_sel_hi:[1,0,1]
    v_pk_fma_f32 v[118:119], v[126:127], v[16:17], v[118:119] op_sel:[0,0,0] op_sel_hi:[1,0,1]
    s_waitcnt vmcnt(10)
    v_lshlrev_b32 v120, 16, v68
    v_and_b32 v121, 0xffff0000, v68
    v_lshlrev_b32 v122, 16, v69
    v_and_b32 v123, 0xffff0000, v69
    v_lshlrev_b32 v124, 16, v70
    v_and_b32 v125, 0xffff0000, v70
    v_lshlrev_b32 v126, 16, v71
    v_and_b32 v127, 0xffff0000, v71
    v_pk_fma_f32 v[112:113], v[120:121], v[16:17], v[112:113] op_sel:[0,1,0] op_sel_hi:[1,1,1]
    v_pk_fma_f32 v[114:115], v[122:123], v[16:17], v[114:115] op_sel:[0,1,0] op_sel_hi:[1,1,1]
    v_pk_fma_f32 v[116:117], v[124:125], v[16:17], v[116:117] op_sel:[0,1,0] op_sel_hi:[1,1,1]
    v_pk_fma_f32 v[118:119], v[126:127], v[16:17], v[118:119] op_sel:[0,1,0] op_sel_hi:[1,1,1]
    s_waitcnt vmcnt(9)
    v_lshlrev_b32 v120, 16, v72
    v_and_b32 v121, 0xffff0000, v72
    v_lshlrev_b32 v122, 16, v73
    v_and_b32 v123, 0xffff0000, v73
    v_lshlrev_b32 v124, 16, v74
    v_and_b32 v125, 0xffff0000, v74
    v_lshlrev_b32 v126, 16, v75
    v_and_b32 v127, 0xffff0000, v75
    v_pk_fma_f32 v[112:113], v[120:121], v[18:19], v[112:113] op_sel:[0,0,0] op_sel_hi:[1,0,1]
    v_pk_fma_f32 v[114:115], v[122:123], v[18:19], v[114:115] op_sel:[0,0,0] op_sel_hi:[1,0,1]
    v_pk_fma_f32 v[116:117], v[124:125], v[18:19], v[116:117] op_sel:[0,0,0] op_sel_hi:[1,0,1]
    v_pk_fma_f32 v[118:119], v[126:127], v[18:19], v[118:119] op_sel:[0,0,0] op_sel_hi:[1,0,1]
    s_waitcnt vmcnt(8)
    v_lshlrev_b32 v120, 16, v76
    v_and_b32 v121, 0xffff0000, v76
    v_lshlrev_b32 v122, 16, v77
    v_and_b32 v123, 0xffff0000, v77
    v_lshlrev_b32 v124, 16, v78
    v_and_b32 v125, 0xffff0000, v78
    v_lshlrev_b32 v126, 16, v79
    v_and_b32 v127, 0xffff0000, v79
    v_pk_fma_f32 v[112:113], v[120:121], v[18:19], v[112:113] op_sel:[0,1,0] op_sel_hi:[1,1,1]
    v_pk_fma_f32 v[114:115], v[122:123], v[18:19], v[114:115] op_sel:[0,1,0] op_sel_hi:[1,1,1]
    v_pk_fma_f32 v[116:117], v[124:125], v[18:19], v[116:117] op_sel:[0,1,0] op_sel_hi:[1,1,1]
    v_pk_fma_f32 v[118:119], v[126:127], v[18:19], v[118:119] op_sel:[0,1,0] op_sel_hi:[1,1,1]
    s_waitcnt vmcnt(7)
    v_lshlrev_b32 v120, 16, v80
    v_and_b32 v121, 0xffff0000, v80
    v_lshlrev_b32 v122, 16, v81
    v_and_b32 v123, 0xffff0000, v81
    v_lshlrev_b32 v124, 16, v82
    v_and_b32 v125, 0xffff0000, v82
    v_lshlrev_b32 v126, 16, v83
    v_and_b32 v127, 0xffff0000, v83
    v_pk_fma_f32 v[112:113], v[120:121], v[20:21], v[112:113] op_sel:[0,0,0] op_sel_hi:[1,0,1]
    v_pk_fma_f32 v[114:115], v[122:123], v[20:21], v[114:115] op_sel:[0,0,0] op_sel_hi:[1,0,1]
    v_pk_fma_f32 v[116:117], v[124:125], v[20:21], v[116:117] op_sel:[0,0,0] op_sel_hi:[1,0,1]
    v_pk_fma_f32 v[118:119], v[126:127], v[20:21], v[118:119] op_sel:[0,0,0] op_sel_hi:[1,0,1]
    s_waitcnt vmcnt(6)
    v_lshlrev_b32 v120, 16, v84
    v_and_b32 v121, 0xffff0000, v84
    v_lshlrev_b32 v122, 16, v85
    v_and_b32 v123, 0xffff0000, v85
    v_lshlrev_b32 v124, 16, v86
    v_and_b32 v125, 0xffff0000, v86
    v_lshlrev_b32 v126, 16, v87
    v_and_b32 v127, 0xffff0000, v87
    v_pk_fma_f32 v[112:113], v[120:121], v[20:21], v[112:113] op_sel:[0,1,0] op_sel_hi:[1,1,1]
    v_pk_fma_f32 v[114:115], v[122:123], v[20:21], v[114:115] op_sel:[0,1,0] op_sel_hi:[1,1,1]
    v_pk_fma_f32 v[116:117], v[124:125], v[20:21], v[116:117] op_sel:[0,1,0] op_sel_hi:[1,1,1]
    v_pk_fma_f32 v[118:119], v[126:127], v[20:21], v[118:119] op_sel:[0,1,0] op_sel_hi:[1,1,1]
    s_waitcnt vmcnt(5)
    v_lshlrev_b32 v120, 16, v88
    v_and_b32 v121, 0xffff0000, v88
    v_lshlrev_b32 v122, 16, v89
    v_and_b32 v123, 0xffff0000, v89
    v_lshlrev_b32 v124, 16, v90
    v_and_b32 v125, 0xffff0000, v90
    v_lshlrev_b32 v126, 16, v91
    v_and_b32 v127, 0xffff0000, v91
    v_pk_fma_f32 v[112:113], v[120:121], v[22:23], v[112:113] op_sel:[0,0,0] op_sel_hi:[1,0,1]
    v_pk_fma_f32 v[114:115], v[122:123], v[22:23], v[114:115] op_sel:[0,0,0] op_sel_hi:[1,0,1]
    v_pk_fma_f32 v[116:117], v[124:125], v[22:23], v[116:117] op_sel:[0,0,0] op_sel_hi:[1,0,1]
    v_pk_fma_f32 v[118:119], v[126:127], v[22:23], v[118:119] op_sel:[0,0,0] op_sel_hi:[1,0,1]
    s_waitcnt vmcnt(4)
    v_lshlrev_b32 v120, 16, v92
    v_and_b32 v121, 0xffff0000, v92
    v_lshlrev_b32 v122, 16, v93
    v_and_b32 v123, 0xffff0000, v93
    v_lshlrev_b32 v124, 16, v94
    v_and_b32 v125, 0xffff0000, v94
    v_lshlrev_b32 v126, 16, v95
    v_and_b32 v127, 0xffff0000, v95
    v_pk_fma_f32 v[112:113], v[120:121], v[22:23], v[112:113] op_sel:[0,1,0] op_sel_hi:[1,1,1]
    v_pk_fma_f32 v[114:115], v[122:123], v[22:23], v[114:115] op_sel:[0,1,0] op_sel_hi:[1,1,1]
    v_pk_fma_f32 v[116:117], v[124:125], v[22:23], v[116:117] op_sel:[0,1,0] op_sel_hi:[1,1,1]
    v_pk_fma_f32 v[118:119], v[126:127], v[22:23], v[118:119] op_sel:[0,1,0] op_sel_hi:[1,1,1]
    s_waitcnt vmcnt(3)
    v_lshlrev_b32 v120, 16, v96
    v_and_b32 v121, 0xffff0000, v96
    v_lshlrev_b32 v122, 16, v97
    v_and_b32 v123, 0xffff0000, v97
    v_lshlrev_b32 v124, 16, v98
    v_and_b32 v125, 0xffff0000, v98
    v_lshlrev_b32 v126, 16, v99
    v_and_b32 v127, 0xffff0000, v99
    v_pk_fma_f32 v[112:113], v[120:121], v[24:25], v[112:113] op_sel:[0,0,0] op_sel_hi:[1,0,1]
    v_pk_fma_f32 v[114:115], v[122:123], v[24:25], v[114:115] op_sel:[0,0,0] op_sel_hi:[1,0,1]
    v_pk_fma_f32 v[116:117], v[124:125], v[24:25], v[116:117] op_sel:[0,0,0] op_sel_hi:[1,0,1]
    v_pk_fma_f32 v[118:119], v[126:127], v[24:25], v[118:119] op_sel:[0,0,0] op_sel_hi:[1,0,1]
    s_waitcnt vmcnt(2)
    v_lshlrev_b32 v120, 16, v100
    v_and_b32 v121, 0xffff0000, v100
    v_lshlrev_b32 v122, 16, v101
    v_and_b32 v123, 0xffff0000, v101
    v_lshlrev_b32 v124, 16, v102
    v_and_b32 v125, 0xffff0000, v102
    v_lshlrev_b32 v126, 16, v103
    v_and_b32 v127, 0xffff0000, v103
    v_pk_fma_f32 v[112:113], v[120:121], v[24:25], v[112:113] op_sel:[0,1,0] op_sel_hi:[1,1,1]
    v_pk_fma_f32 v[114:115], v[122:123], v[24:25], v[114:115] op_sel:[0,1,0] op_sel_hi:[1,1,1]
    v_pk_fma_f32 v[116:117], v[124:125], v[24:25], v[116:117] op_sel:[0,1,0] op_sel_hi:[1,1,1]
    v_pk_fma_f32 v[118:119], v[126:127], v[24:25], v[118:119] op_sel:[0,1,0] op_sel_hi:[1,1,1]
    s_waitcnt vmcnt(1)
    v_lshlrev_b32 v120, 16, v104
    v_and_b32 v121, 0xffff0000, v104
    v_lshlrev_b32 v122, 16, v105
    v_and_b32 v123, 0xffff0000, v105
    v_lshlrev_b32 v124, 16, v106
    v_and_b32 v125, 0xffff0000, v106
    v_lshlrev_b32 v126, 16, v107
    v_and_b32 v127, 0xffff0000, v107
    v_pk_fma_f32 v[112:113], v[120:121], v[26:27], v[112:113] op_sel:[0,0,0] op_sel_hi:[1,0,1]
    v_pk_fma_f32 v[114:115], v[122:123], v[26:27], v[114:115] op_sel:[0,0,0] op_sel_hi:[1,0,1]
    v_pk_fma_f32 v[116:117], v[124:125], v[26:27], v[116:117] op_sel:[0,0,0] op_sel_hi:[1,0,1]
    v_pk_fma_f32 v[118:119], v[126:127], v[26:27], v[118:119] op_sel:[0,0,0] op_sel_hi:[1,0,1]
    s_waitcnt vmcnt(0)
    v_lshlrev_b32 v120, 16, v108
    v_and_b32 v121, 0xffff0000, v108
    v_lshlrev_b32 v122, 16, v109
    v_and_b32 v123, 0xffff0000, v109
    v_lshlrev_b32 v124, 16, v110
    v_and_b32 v125, 0xffff0000, v110
    v_lshlrev_b32 v126, 16, v111
    v_and_b32 v127, 0xffff0000, v111
    v_pk_fma_f32 v[112:113], v[120:121], v[26:27], v[112:113] op_sel:[0,1,0] op_sel_hi:[1,1,1]
    v_pk_fma_f32 v[114:115], v[122:123], v[26:27], v[114:115] op_sel:[0,1,0] op_sel_hi:[1,1,1]
    v_pk_fma_f32 v[116:117], v[124:125], v[26:27], v[116:117] op_sel:[0,1,0] op_sel_hi:[1,1,1]
    v_pk_fma_f32 v[118:119], v[126:127], v[26:27], v[118:119] op_sel:[0,1,0] op_sel_hi:[1,1,1]
    s_nop 1
    v_add_f32_dpp v112, v112, v112 row_ror:8 row_mask:0xf bank_mask:0xf
    v_add_f32_dpp v113, v113, v113 row_ror:8 row_mask:0xf bank_mask:0xf
    v_add_f32_dpp v114, v114, v114 row_ror:8 row_mask:0xf bank_mask:0xf
    v_add_f32_dpp v115, v115, v115 row_ror:8 row_mask:0xf bank_mask:0xf
    v_add_f32_dpp v116, v116, v116 row_ror:8 row_mask:0xf bank_mask:0xf
    v_add_f32_dpp v117, v117, v117 row_ror:8 row_mask:0xf bank_mask:0xf
    v_add_f32_dpp v118, v118, v118 row_ror:8 row_mask:0xf bank_mask:0xf
    v_add_f32_dpp v119, v119, v119 row_ror:8 row_mask:0xf bank_mask:0xf
    v_mov_b32 v120, v112
    v_mov_b32 v121, v113
    v_mov_b32 v122, v114
    v_mov_b32 v123, v115
    v_mov_b32 v124, v116
    v_mov_b32 v125, v117
    v_mov_b32 v126, v118
    v_mov_b32 v127, v119
    s_nop 1
    v_permlane32_swap_b32 v120, v112
    v_permlane32_swap_b32 v121, v113
    v_permlane32_swap_b32 v122, v114
    v_permlane32_swap_b32 v123, v115
    v_permlane32_swap_b32 v124, v116
    v_permlane32_swap_b32 v125, v117
    v_permlane32_swap_b32 v126, v118
    v_permlane32_swap_b32 v127, v119
    s_nop 1
    v_add_f32 v112, v112, v120
    v_add_f32 v113, v113, v121
    v_add_f32 v114, v114, v122
    v_add_f32 v115, v115, v123
    v_add_f32 v116, v116, v124
    v_add_f32 v117, v117, v125
    v_add_f32 v118, v118, v126
    v_add_f32 v119, v119, v127
    v_mov_b32 v120, v112
    v_mov_b32 v121, v113
    v_mov_b32 v122, v114
    v_mov_b32 v123, v115
    v_mov_b32 v124, v116
    v_mov_b32 v125, v117
    v_mov_b32 v126, v118
    v_mov_b32 v127, v119
    s_nop 1
    v_permlane16_swap_b32 v120, v112
    v_permlane16_swap_b32 v121, v113
    v_permlane16_swap_b32 v122, v114
    v_permlane16_swap_b32 v123, v115
    v_permlane16_swap_b32 v124, v116
    v_permlane16_swap_b32 v125, v117
    v_permlane16_swap_b32 v126, v118
    v_permlane16_swap_b32 v127, v119
    s_nop 1
    v_add_f32 v112, v112, v120
    v_add_f32 v113, v113, v121
    v_add_f32 v114, v114, v122
    v_add_f32 v115, v115, v123
    v_add_f32 v116, v116, v124
    v_add_f32 v117, v117, v125
    v_add_f32 v118, v118, v126
    v_add_f32 v119, v119, v127
    v_lshlrev_b32 v7, 5, v3
    s_mul_i32 s36, s33, 15360
    s_lshl_b32 s37, s32, 8
    s_add_u32 s37, s37, s36
    s_add_u32 s37, s37, 2793472
    s_lshl_b32 s44, s21, 7
    s_add_u32 s44, s44, 29700096
    s_mov_b64 exec, 0xff
    buffer_store_dwordx4 v[112:115], v7, s[28:31], s37 offen sc1
    buffer_store_dwordx4 v[116:119], v7, s[28:31], s37 offen offset:16 sc1
    s_mov_b64 exec, -1
    s_waitcnt vmcnt(0)
    s_mov_b32 s47, 0
prep_kernel_nn8:
    v_readfirstlane_b32 s46, v250
    s_add_u32 s47, s47, 1
    s_cmp_lg_u32 s46, 0
    s_cbranch_scc1 prep_kernel_nd9
    s_cmp_ge_u32 s47, 200000
    s_cbranch_scc1 prep_kernel_nd9
    buffer_load_dword v250, v251, s[48:51], 0 offen sc1
    s_waitcnt vmcnt(0)
    s_branch prep_kernel_nn8
prep_kernel_nd9:
    v_mov_b32 v132, s46
    v_mov_b32 v133, 0
    s_mov_b64 exec, 1
    buffer_store_dword v132, v133, s[28:31], s44 offen sc1
    s_endpgm
p_st:
    s_mov_b32 s16, s60
    s_mov_b32 s17, s61
    s_mov_b32 s18, 2621440
    s_mov_b32 s19, 0x00020000
    v_lshrrev_b32 v5, 3, v1
    v_and_b32 v6, 7, v1
    s_lshl_b32 s23, s21, 4
    v_add_u32 v7, s23, v5
    v_mul_u32_u24 v9, 1280, v7
    v_lshl_add_u32 v9, v6, 4, v9
    v_mov_b32 v20, 0x3f803f80
    s_mov_b32 s24, 0
    buffer_load_dwordx4 v[32:35], v9, s[16:19], s24 offen offset:0 nt
    buffer_load_dwordx4 v[36:39], v9, s[16:19], s24 offen offset:128 nt
    buffer_load_dwordx4 v[40:43], v9, s[16:19], s24 offen offset:256 nt
    buffer_load_dwordx4 v[44:47], v9, s[16:19], s24 offen offset:384 nt
    buffer_load_dwordx4 v[48:51], v9, s[16:19], s24 offen offset:512 nt
    buffer_load_dwordx4 v[52:55], v9, s[16:19], s24 offen offset:640 nt
    buffer_load_dwordx4 v[56:59], v9, s[16:19], s24 offen offset:768 nt
    buffer_load_dwordx4 v[60:63], v9, s[16:19], s24 offen offset:896 nt
    buffer_load_dwordx4 v[64:67], v9, s[16:19], s24 offen offset:1024 nt
    buffer_load_dwordx4 v[68:71], v9, s[16:19], s24 offen offset:1152 nt
    s_add_u32 s24, s24, 10240
    buffer_load_dwordx4 v[72:75], v9, s[16:19], s24 offen offset:0 nt
    buffer_load_dwordx4 v[76:79], v9, s[16:19], s24 offen offset:128 nt
    buffer_load_dwordx4 v[80:83], v9, s[16:19], s24 offen offset:256 nt
    buffer_load_dwordx4 v[84:87], v9, s[16:19], s24 offen offset:384 nt
    buffer_load_dwordx4 v[88:91], v9, s[16:19], s24 offen offset:512 nt
    buffer_load_dwordx4 v[92:95], v9, s[16:19], s24 offen offset:640 nt
    buffer_load_dwordx4 v[96:99], v9, s[16:19], s24 offen offset:768 nt
    buffer_load_dwordx4 v[100:103], v9, s[16:19], s24 offen offset:896 nt
    buffer_load_dwordx4 v[104:107], v9, s[16:19], s24 offen offset:1024 nt
    buffer_load_dwordx4 v[108:111], v9, s[16:19], s24 offen offset:1152 nt
    v_and_b32 v21, 1, v5
    v_lshl_add_u32 v21, v6, 1, v21
    v_lshlrev_b32 v21, 7, v21
    v_lshrrev_b32 v22, 1, v5
    v_xor_b32 v22, v22, v6
    v_lshl_add_u32 v21, v22, 4, v21
    v_xor_b32 v23, 64, v21
    s_mul_i32 s25, s21, 20480
    s_add_u32 s25, s25, 2854912
    v_mov_b32 v10, 0
    v_mov_b32 v11, 0
    v_mov_b32 v12, 0
    v_mov_b32 v13, 0
    s_waitcnt vmcnt(19)
    v_dot2_f32_bf16 v10, v32, v20, v10
    v_dot2_f32_bf16 v11, v32, v32, v11
    v_dot2_f32_bf16 v10, v33, v20, v10
    v_dot2_f32_bf16 v11, v33, v33, v11
    v_dot2_f32_bf16 v10, v34, v20, v10
    v_dot2_f32_bf16 v11, v34, v34, v11
    v_dot2_f32_bf16 v10, v35, v20, v10
    v_dot2_f32_bf16 v11, v35, v35, v11
    v_mov_b32 v120, v32
    v_mov_b32 v121, v33
    v_mov_b32 v122, v34
    v_mov_b32 v123, v35
    v_mov_b32_dpp v120, v34 row_ror:8 row_mask:0xf bank_mask:0xc
    v_mov_b32_dpp v121, v35 row_ror:8 row_mask:0xf bank_mask:0xc
    v_mov_b32_dpp v122, v32 row_ror:8 row_mask:0xf bank_mask:0x3
    v_mov_b32_dpp v123, v33 row_ror:8 row_mask:0xf bank_mask:0x3
    s_add_u32 s26, s25, 0
    buffer_store_dwordx4 v[120:123], v21, s[28:31], s26 offen sc1
    s_waitcnt vmcnt(19)
    v_dot2_f32_bf16 v10, v36, v20, v10
    v_dot2_f32_bf16 v11, v36, v36, v11
    v_dot2_f32_bf16 v10, v37, v20, v10
    v_dot2_f32_bf16 v11, v37, v37, v11
    v_dot2_f32_bf16 v10, v38, v20, v10
    v_dot2_f32_bf16 v11, v38, v38, v11
    v_dot2_f32_bf16 v10, v39, v20, v10
    v_dot2_f32_bf16 v11, v39, v39, v11
    v_mov_b32 v124, v36
    v_mov_b32 v125, v37
    v_mov_b32 v126, v38
    v_mov_b32 v127, v39
    v_mov_b32_dpp v124, v38 row_ror:8 row_mask:0xf bank_mask:0xc
    v_mov_b32_dpp v125, v39 row_ror:8 row_mask:0xf bank_mask:0xc
    v_mov_b32_dpp v126, v36 row_ror:8 row_mask:0xf bank_mask:0x3
    v_mov_b32_dpp v127, v37 row_ror:8 row_mask:0xf bank_mask:0x3
    s_add_u32 s26, s25, 2048
    buffer_store_dwordx4 v[124:127], v21, s[28:31], s26 offen sc1
    s_waitcnt vmcnt(19)
    v_dot2_f32_bf16 v10, v40, v20, v10
    v_dot2_f32_bf16 v11, v40, v40, v11
    v_dot2_f32_bf16 v10, v41, v20, v10
    v_dot2_f32_bf16 v11, v41, v41, v11
    v_dot2_f32_bf16 v10, v42, v20, v10
    v_dot2_f32_bf16 v11, v42, v42, v11
    v_dot2_f32_bf16 v10, v43, v20, v10
    v_dot2_f32_bf16 v11, v43, v43, v11
    v_mov_b32 v120, v40
    v_mov_b32 v121, v41
    v_mov_b32 v122, v42
    v_mov_b32 v123, v43
    v_mov_b32_dpp v120, v42 row_ror:8 row_mask:0xf bank_mask:0xc
    v_mov_b32_dpp v121, v43 row_ror:8 row_mask:0xf bank_mask:0xc
    v_mov_b32_dpp v122, v40 row_ror:8 row_mask:0xf bank_mask:0x3
    v_mov_b32_dpp v123, v41 row_ror:8 row_mask:0xf bank_mask:0x3
    s_add_u32 s26, s25, 4096
    buffer_store_dwordx4 v[120:123], v21, s[28:31], s26 offen sc1
    s_waitcnt vmcnt(19)
    v_dot2_f32_bf16 v10, v44, v20, v10
    v_dot2_f32_bf16 v11, v44, v44, v11
    v_dot2_f32_bf16 v10, v45, v20, v10
    v_dot2_f32_bf16 v11, v45, v45, v11
    v_dot2_f32_bf16 v10, v46, v20, v10
    v_dot2_f32_bf16 v11, v46, v46, v11
    v_dot2_f32_bf16 v10, v47, v20, v10
    v_dot2_f32_bf16 v11, v47, v47, v11
    v_mov_b32 v124, v44
    v_mov_b32 v125, v45
    v_mov_b32 v126, v46
    v_mov_b32 v127, v47
    v_mov_b32_dpp v124, v46 row_ror:8 row_mask:0xf bank_mask:0xc
    v_mov_b32_dpp v125, v47 row_ror:8 row_mask:0xf bank_mask:0xc
    v_mov_b32_dpp v126, v44 row_ror:8 row_mask:0xf bank_mask:0x3
    v_mov_b32_dpp v127, v45 row_ror:8 row_mask:0xf bank_mask:0x3
    s_add_u32 s26, s25, 6144
    buffer_store_dwordx4 v[124:127], v21, s[28:31], s26 offen sc1
    s_waitcnt vmcnt(19)
    v_dot2_f32_bf16 v10, v48, v20, v10
    v_dot2_f32_bf16 v11, v48, v48, v11
    v_dot2_f32_bf16 v10, v49, v20, v10
    v_dot2_f32_bf16 v11, v49, v49, v11
    v_dot2_f32_bf16 v10, v50, v20, v10
    v_dot2_f32_bf16 v11, v50, v50, v11
    v_dot2_f32_bf16 v10, v51, v20, v10
    v_dot2_f32_bf16 v11, v51, v51, v11
    v_mov_b32 v120, v48
    v_mov_b32 v121, v49
    v_mov_b32 v122, v50
    v_mov_b32 v123, v51
    v_mov_b32_dpp v120, v50 row_ror:8 row_mask:0xf bank_mask:0xc
    v_mov_b32_dpp v121, v51 row_ror:8 row_mask:0xf bank_mask:0xc
    v_mov_b32_dpp v122, v48 row_ror:8 row_mask:0xf bank_mask:0x3
    v_mov_b32_dpp v123, v49 row_ror:8 row_mask:0xf bank_mask:0x3
    s_add_u32 s26, s25, 8192
    buffer_store_dwordx4 v[120:123], v21, s[28:31], s26 offen sc1
    s_waitcnt vmcnt(19)
    v_dot2_f32_bf16 v10, v52, v20, v10
    v_dot2_f32_bf16 v11, v52, v52, v11
    v_dot2_f32_bf16 v10, v53, v20, v10
    v_dot2_f32_bf16 v11, v53, v53, v11
    v_dot2_f32_bf16 v10, v54, v20, v10
    v_dot2_f32_bf16 v11, v54, v54, v11
    v_dot2_f32_bf16 v10, v55, v20, v10
    v_dot2_f32_bf16 v11, v55, v55, v11
    v_mov_b32 v124, v52
    v_mov_b32 v125, v53
    v_mov_b32 v126, v54
    v_mov_b32 v127, v55
    v_mov_b32_dpp v124, v54 row_ror:8 row_mask:0xf bank_mask:0xc
    v_mov_b32_dpp v125, v55 row_ror:8 row_mask:0xf bank_mask:0xc
    v_mov_b32_dpp v126, v52 row_ror:8 row_mask:0xf bank_mask:0x3
    v_mov_b32_dpp v127, v53 row_ror:8 row_mask:0xf bank_mask:0x3
    s_add_u32 s26, s25, 10240
    buffer_store_dwordx4 v[124:127], v21, s[28:31], s26 offen sc1
    s_waitcnt vmcnt(19)
    v_dot2_f32_bf16 v10, v56, v20, v10
    v_dot2_f32_bf16 v11, v56, v56, v11
    v_dot2_f32_bf16 v10, v57, v20, v10
    v_dot2_f32_bf16 v11, v57, v57, v11
    v_dot2_f32_bf16 v10, v58, v20, v10
    v_dot2_f32_bf16 v11, v58, v58, v11
    v_dot2_f32_bf16 v10, v59, v20, v10
    v_dot2_f32_bf16 v11, v59, v59, v11
    v_mov_b32 v120, v56
    v_mov_b32 v121, v57
    v_mov_b32 v122, v58
    v_mov_b32 v123, v59
    v_mov_b32_dpp v120, v58 row_ror:8 row_mask:0xf bank_mask:0xc
    v_mov_b32_dpp v121, v59 row_ror:8 row_mask:0xf bank_mask:0xc
    v_mov_b32_dpp v122, v56 row_ror:8 row_mask:0xf bank_mask:0x3
    v_mov_b32_dpp v123, v57 row_ror:8 row_mask:0xf bank_mask:0x3
    s_add_u32 s26, s25, 12288
    buffer_store_dwordx4 v[120:123], v21, s[28:31], s26 offen sc1
    s_waitcnt vmcnt(19)
    v_dot2_f32_bf16 v10, v60, v20, v10
    v_dot2_f32_bf16 v11, v60, v60, v11
    v_dot2_f32_bf16 v10, v61, v20, v10
    v_dot2_f32_bf16 v11, v61, v61, v11
    v_dot2_f32_bf16 v10, v62, v20, v10
    v_dot2_f32_bf16 v11, v62, v62, v11
    v_dot2_f32_bf16 v10, v63, v20, v10
    v_dot2_f32_bf16 v11, v63, v63, v11
    v_mov_b32 v124, v60
    v_mov_b32 v125, v61
    v_mov_b32 v126, v62
    v_mov_b32 v127, v63
    v_mov_b32_dpp v124, v62 row_ror:8 row_mask:0xf bank_mask:0xc
    v_mov_b32_dpp v125, v63 row_ror:8 row_mask:0xf bank_mask:0xc
    v_mov_b32_dpp v126, v60 row_ror:8 row_mask:0xf bank_mask:0x3
    v_mov_b32_dpp v127, v61 row_ror:8 row_mask:0xf bank_mask:0x3
    s_add_u32 s26, s25, 14336
    buffer_store_dwordx4 v[124:127], v21, s[28:31], s26 offen sc1
    s_waitcnt vmcnt(19)
    v_dot2_f32_bf16 v10, v64, v20, v10
    v_dot2_f32_bf16 v11, v64, v64, v11
    v_dot2_f32_bf16 v10, v65, v20, v10
    v_dot2_f32_bf16 v11, v65, v65, v11
    v_dot2_f32_bf16 v10, v66, v20, v10
    v_dot2_f32_bf16 v11, v66, v66, v11
    v_dot2_f32_bf16 v10, v67, v20, v10
    v_dot2_f32_bf16 v11, v67, v67, v11
    v_mov_b32 v120, v64
    v_mov_b32 v121, v65
    v_mov_b32 v122, v66
    v_mov_b32 v123, v67
    v_mov_b32_dpp v120, v66 row_ror:8 row_mask:0xf bank_mask:0xc
    v_mov_b32_dpp v121, v67 row_ror:8 row_mask:0xf bank_mask:0xc
    v_mov_b32_dpp v122, v64 row_ror:8 row_mask:0xf bank_mask:0x3
    v_mov_b32_dpp v123, v65 row_ror:8 row_mask:0xf bank_mask:0x3
    s_add_u32 s26, s25, 16384
    buffer_store_dwordx4 v[120:123], v21, s[28:31], s26 offen sc1
    s_waitcnt vmcnt(19)
    v_dot2_f32_bf16 v10, v68, v20, v10
    v_dot2_f32_bf16 v11, v68, v68, v11
    v_dot2_f32_bf16 v10, v69, v20, v10
    v_dot2_f32_bf16 v11, v69, v69, v11
    v_dot2_f32_bf16 v10, v70, v20, v10
    v_dot2_f32_bf16 v11, v70, v70, v11
    v_dot2_f32_bf16 v10, v71, v20, v10
    v_dot2_f32_bf16 v11, v71, v71, v11
    v_mov_b32 v124, v68
    v_mov_b32 v125, v69
    v_mov_b32 v126, v70
    v_mov_b32 v127, v71
    v_mov_b32_dpp v124, v70 row_ror:8 row_mask:0xf bank_mask:0xc
    v_mov_b32_dpp v125, v71 row_ror:8 row_mask:0xf bank_mask:0xc
    v_mov_b32_dpp v126, v68 row_ror:8 row_mask:0xf bank_mask:0x3
    v_mov_b32_dpp v127, v69 row_ror:8 row_mask:0xf bank_mask:0x3
    s_add_u32 s26, s25, 18432
    buffer_store_dwordx4 v[124:127], v21, s[28:31], s26 offen sc1
    s_waitcnt vmcnt(19)
    v_dot2_f32_bf16 v12, v72, v20, v12
    v_dot2_f32_bf16 v13, v72, v72, v13
    v_dot2_f32_bf16 v12, v73, v20, v12
    v_dot2_f32_bf16 v13, v73, v73, v13
    v_dot2_f32_bf16 v12, v74, v20, v12
    v_dot2_f32_bf16 v13, v74, v74, v13
    v_dot2_f32_bf16 v12, v75, v20, v12
    v_dot2_f32_bf16 v13, v75, v75, v13
    v_mov_b32 v120, v72
    v_mov_b32 v121, v73
    v_mov_b32 v122, v74
    v_mov_b32 v123, v75
    v_mov_b32_dpp v120, v74 row_ror:8 row_mask:0xf bank_mask:0xc
    v_mov_b32_dpp v121, v75 row_ror:8 row_mask:0xf bank_mask:0xc
    v_mov_b32_dpp v122, v72 row_ror:8 row_mask:0xf bank_mask:0x3
    v_mov_b32_dpp v123, v73 row_ror:8 row_mask:0xf bank_mask:0x3
    s_add_u32 s26, s25, 0
    buffer_store_dwordx4 v[120:123], v23, s[28:31], s26 offen sc1
    s_waitcnt vmcnt(19)
    v_dot2_f32_bf16 v12, v76, v20, v12
    v_dot2_f32_bf16 v13, v76, v76, v13
    v_dot2_f32_bf16 v12, v77, v20, v12
    v_dot2_f32_bf16 v13, v77, v77, v13
    v_dot2_f32_bf16 v12, v78, v20, v12
    v_dot2_f32_bf16 v13, v78, v78, v13
    v_dot2_f32_bf16 v12, v79, v20, v12
    v_dot2_f32_bf16 v13, v79, v79, v13
    v_mov_b32 v124, v76
    v_mov_b32 v125, v77
    v_mov_b32 v126, v78
    v_mov_b32 v127, v79
    v_mov_b32_dpp v124, v78 row_ror:8 row_mask:0xf bank_mask:0xc
    v_mov_b32_dpp v125, v79 row_ror:8 row_mask:0xf bank_mask:0xc
    v_mov_b32_dpp v126, v76 row_ror:8 row_mask:0xf bank_mask:0x3
    v_mov_b32_dpp v127, v77 row_ror:8 row_mask:0xf bank_mask:0x3
    s_add_u32 s26, s25, 2048
    buffer_store_dwordx4 v[124:127], v23, s[28:31], s26 offen sc1
    s_waitcnt vmcnt(19)
    v_dot2_f32_bf16 v12, v80, v20, v12
    v_dot2_f32_bf16 v13, v80, v80, v13
    v_dot2_f32_bf16 v12, v81, v20, v12
    v_dot2_f32_bf16 v13, v81, v81, v13
    v_dot2_f32_bf16 v12, v82, v20, v12
    v_dot2_f32_bf16 v13, v82, v82, v13
    v_dot2_f32_bf16 v12, v83, v20, v12
    v_dot2_f32_bf16 v13, v83, v83, v13
    v_mov_b32 v120, v80
    v_mov_b32 v121, v81
    v_mov_b32 v122, v82
    v_mov_b32 v123, v83
    v_mov_b32_dpp v120, v82 row_ror:8 row_mask:0xf bank_mask:0xc
    v_mov_b32_dpp v121, v83 row_ror:8 row_mask:0xf bank_mask:0xc
    v_mov_b32_dpp v122, v80 row_ror:8 row_mask:0xf bank_mask:0x3
    v_mov_b32_dpp v123, v81 row_ror:8 row_mask:0xf bank_mask:0x3
    s_add_u32 s26, s25, 4096
    buffer_store_dwordx4 v[120:123], v23, s[28:31], s26 offen sc1
    s_waitcnt vmcnt(19)
    v_dot2_f32_bf16 v12, v84, v20, v12
    v_dot2_f32_bf16 v13, v84, v84, v13
    v_dot2_f32_bf16 v12, v85, v20, v12
    v_dot2_f32_bf16 v13, v85, v85, v13
    v_dot2_f32_bf16 v12, v86, v20, v12
    v_dot2_f32_bf16 v13, v86, v86, v13
    v_dot2_f32_bf16 v12, v87, v20, v12
    v_dot2_f32_bf16 v13, v87, v87, v13
    v_mov_b32 v124, v84
    v_mov_b32 v125, v85
    v_mov_b32 v126, v86
    v_mov_b32 v127, v87
    v_mov_b32_dpp v124, v86 row_ror:8 row_mask:0xf bank_mask:0xc
    v_mov_b32_dpp v125, v87 row_ror:8 row_mask:0xf bank_mask:0xc
    v_mov_b32_dpp v126, v84 row_ror:8 row_mask:0xf bank_mask:0x3
    v_mov_b32_dpp v127, v85 row_ror:8 row_mask:0xf bank_mask:0x3
    s_add_u32 s26, s25, 6144
    buffer_store_dwordx4 v[124:127], v23, s[28:31], s26 offen sc1
    s_waitcnt vmcnt(19)
    v_dot2_f32_bf16 v12, v88, v20, v12
    v_dot2_f32_bf16 v13, v88, v88, v13
    v_dot2_f32_bf16 v12, v89, v20, v12
    v_dot2_f32_bf16 v13, v89, v89, v13
    v_dot2_f32_bf16 v12, v90, v20, v12
    v_dot2_f32_bf16 v13, v90, v90, v13
    v_dot2_f32_bf16 v12, v91, v20, v12
    v_dot2_f32_bf16 v13, v91, v91, v13
    v_mov_b32 v120, v88
    v_mov_b32 v121, v89
    v_mov_b32 v122, v90
    v_mov_b32 v123, v91
    v_mov_b32_dpp v120, v90 row_ror:8 row_mask:0xf bank_mask:0xc
    v_mov_b32_dpp v121, v91 row_ror:8 row_mask:0xf bank_mask:0xc
    v_mov_b32_dpp v122, v88 row_ror:8 row_mask:0xf bank_mask:0x3
    v_mov_b32_dpp v123, v89 row_ror:8 row_mask:0xf bank_mask:0x3
    s_add_u32 s26, s25, 8192
    buffer_store_dwordx4 v[120:123], v23, s[28:31], s26 offen sc1
    s_waitcnt vmcnt(19)
    v_dot2_f32_bf16 v12, v92, v20, v12
    v_dot2_f32_bf16 v13, v92, v92, v13
    v_dot2_f32_bf16 v12, v93, v20, v12
    v_dot2_f32_bf16 v13, v93, v93, v13
    v_dot2_f32_bf16 v12, v94, v20, v12
    v_dot2_f32_bf16 v13, v94, v94, v13
    v_dot2_f32_bf16 v12, v95, v20, v12
    v_dot2_f32_bf16 v13, v95, v95, v13
    v_mov_b32 v124, v92
    v_mov_b32 v125, v93
    v_mov_b32 v126, v94
    v_mov_b32 v127, v95
    v_mov_b32_dpp v124, v94 row_ror:8 row_mask:0xf bank_mask:0xc
    v_mov_b32_dpp v125, v95 row_ror:8 row_mask:0xf bank_mask:0xc
    v_mov_b32_dpp v126, v92 row_ror:8 row_mask:0xf bank_mask:0x3
    v_mov_b32_dpp v127, v93 row_ror:8 row_mask:0xf bank_mask:0x3
    s_add_u32 s26, s25, 10240
    buffer_store_dwordx4 v[124:127], v23, s[28:31], s26 offen sc1
    s_waitcnt vmcnt(19)
    v_dot2_f32_bf16 v12, v96, v20, v12
    v_dot2_f32_bf16 v13, v96, v96, v13
    v_dot2_f32_bf16 v12, v97, v20, v12
    v_dot2_f32_bf16 v13, v97, v97, v13
    v_dot2_f32_bf16 v12, v98, v20, v12
    v_dot2_f32_bf16 v13, v98, v98, v13
    v_dot2_f32_bf16 v12, v99, v20, v12
    v_dot2_f32_bf16 v13, v99, v99, v13
    v_mov_b32 v120, v96
    v_mov_b32 v121, v97
    v_mov_b32 v122, v98
    v_mov_b32 v123, v99
    v_mov_b32_dpp v120, v98 row_ror:8 row_mask:0xf bank_mask:0xc
    v_mov_b32_dpp v121, v99 row_ror:8 row_mask:0xf bank_mask:0xc
    v_mov_b32_dpp v122, v96 row_ror:8 row_mask:0xf bank_mask:0x3
    v_mov_b32_dpp v123, v97 row_ror:8 row_mask:0xf bank_mask:0x3
    s_add_u32 s26, s25, 12288
    buffer_store_dwordx4 v[120:123], v23, s[28:31], s26 offen sc1
    s_waitcnt vmcnt(19)
    v_dot2_f32_bf16 v12, v100, v20, v12
    v_dot2_f32_bf16 v13, v100, v100, v13
    v_dot2_f32_bf16 v12, v101, v20, v12
    v_dot2_f32_bf16 v13, v101, v101, v13
    v_dot2_f32_bf16 v12, v102, v20, v12
    v_dot2_f32_bf16 v13, v102, v102, v13
    v_dot2_f32_bf16 v12, v103, v20, v12
    v_dot2_f32_bf16 v13, v103, v103, v13
    v_mov_b32 v124, v100
    v_mov_b32 v125, v101
    v_mov_b32 v126, v102
    v_mov_b32 v127, v103
    v_mov_b32_dpp v124, v102 row_ror:8 row_mask:0xf bank_mask:0xc
    v_mov_b32_dpp v125, v103 row_ror:8 row_mask:0xf bank_mask:0xc
    v_mov_b32_dpp v126, v100 row_ror:8 row_mask:0xf bank_mask:0x3
    v_mov_b32_dpp v127, v101 row_ror:8 row_mask:0xf bank_mask:0x3
    s_add_u32 s26, s25, 14336
    buffer_store_dwordx4 v[124:127], v23, s[28:31], s26 offen sc1
    s_waitcnt vmcnt(19)
    v_dot2_f32_bf16 v12, v104, v20, v12
    v_dot2_f32_bf16 v13, v104, v104, v13
    v_dot2_f32_bf16 v12, v105, v20, v12
    v_dot2_f32_bf16 v13, v105, v105, v13
    v_dot2_f32_bf16 v12, v106, v20, v12
    v_dot2_f32_bf16 v13, v106, v106, v13
    v_dot2_f32_bf16 v12, v107, v20, v12
    v_dot2_f32_bf16 v13, v107, v107, v13
    v_mov_b32 v120, v104
    v_mov_b32 v121, v105
    v_mov_b32 v122, v106
    v_mov_b32 v123, v107
    v_mov_b32_dpp v120, v106 row_ror:8 row_mask:0xf bank_mask:0xc
    v_mov_b32_dpp v121, v107 row_ror:8 row_mask:0xf bank_mask:0xc
    v_mov_b32_dpp v122, v104 row_ror:8 row_mask:0xf bank_mask:0x3
    v_mov_b32_dpp v123, v105 row_ror:8 row_mask:0xf bank_mask:0x3
    s_add_u32 s26, s25, 16384
    buffer_store_dwordx4 v[120:123], v23, s[28:31], s26 offen sc1
    s_waitcnt vmcnt(19)
    v_dot2_f32_bf16 v12, v108, v20, v12
    v_dot2_f32_bf16 v13, v108, v108, v13
    v_dot2_f32_bf16 v12, v109, v20, v12
    v_dot2_f32_bf16 v13, v109, v109, v13
    v_dot2_f32_bf16 v12, v110, v20, v12
    v_dot2_f32_bf16 v13, v110, v110, v13
    v_dot2_f32_bf16 v12, v111, v20, v12
    v_dot2_f32_bf16 v13, v111, v111, v13
    v_mov_b32 v124, v108
    v_mov_b32 v125, v109
    v_mov_b32 v126, v110
    v_mov_b32 v127, v111
    v_mov_b32_dpp v124, v110 row_ror:8 row_mask:0xf bank_mask:0xc
    v_mov_b32_dpp v125, v111 row_ror:8 row_mask:0xf bank_mask:0xc
    v_mov_b32_dpp v126, v108 row_ror:8 row_mask:0xf bank_mask:0x3
    v_mov_b32_dpp v127, v109 row_ror:8 row_mask:0xf bank_mask:0x3
    s_add_u32 s26, s25, 18432
    buffer_store_dwordx4 v[124:127], v23, s[28:31], s26 offen sc1
    s_nop 2
    v_add_f32_dpp v10, v10, v10 quad_perm:[1,0,3,2] row_mask:0xf bank_mask:0xf
    v_add_f32_dpp v11, v11, v11 quad_perm:[1,0,3,2] row_mask:0xf bank_mask:0xf
    v_add_f32_dpp v12, v12, v12 quad_perm:[1,0,3,2] row_mask:0xf bank_mask:0xf
    v_add_f32_dpp v13, v13, v13 quad_perm:[1,0,3,2] row_mask:0xf bank_mask:0xf
    v_add_f32_dpp v10, v10, v10 quad_perm:[2,3,0,1] row_mask:0xf bank_mask:0xf
    v_add_f32_dpp v11, v11, v11 quad_perm:[2,3,0,1] row_mask:0xf bank_mask:0xf
    v_add_f32_dpp v12, v12, v12 quad_perm:[2,3,0,1] row_mask:0xf bank_mask:0xf
    v_add_f32_dpp v13, v13, v13 quad_perm:[2,3,0,1] row_mask:0xf bank_mask:0xf
    v_add_f32_dpp v10, v10, v10 row_half_mirror row_mask:0xf bank_mask:0xf
    v_add_f32_dpp v11, v11, v11 row_half_mirror row_mask:0xf bank_mask:0xf
    v_add_f32_dpp v12, v12, v12 row_half_mirror row_mask:0xf bank_mask:0xf
    v_add_f32_dpp v13, v13, v13 row_half_mirror row_mask:0xf bank_mask:0xf
    v_mul_f32 v10, 0x3acccccd, v10
    v_mul_f32 v12, 0x3acccccd, v12
    v_mul_f32 v11, 0x3acccccd, v11
    v_mul_f32 v13, 0x3acccccd, v13
    v_fma_f32 v11, -v10, v10, v11
    v_fma_f32 v13, -v12, v12, v13
    v_max_f32 v11, 0, v11
    v_max_f32 v13, 0, v13
    v_cvt_pk_bf16_f32 v24, v10, v11
    v_cvt_pk_bf16_f32 v25, v12, v13
    v_lshlrev_b32 v10, 16, v24
    v_lshlrev_b32 v12, 16, v25
    v_and_b32 v11, 0xffff0000, v24
    v_and_b32 v13, 0xffff0000, v25
    v_add_f32 v11, 0x3727c5ac, v11
    v_add_f32 v13, 0x3727c5ac, v13
    v_cvt_pk_bf16_f32 v24, v11, v11
    v_cvt_pk_bf16_f32 v25, v13, v13
    v_lshlrev_b32 v11, 16, v24
    v_lshlrev_b32 v13, 16, v25
    v_sqrt_f32 v11, v11
    v_sqrt_f32 v13, v13
    s_nop 0
    s_nop 0
    v_cvt_pk_bf16_f32 v24, v11, v11
    v_cvt_pk_bf16_f32 v25, v13, v13
    v_lshlrev_b32 v11, 16, v24
    v_lshlrev_b32 v13, 16, v25
    v_rcp_f32 v11, v11
    v_rcp_f32 v13, v13
    s_nop 0
    s_nop 0
    v_mul_f32 v10, v10, v11
    v_mul_f32 v12, v12, v13
    v_sub_f32 v10, 0, v10
    v_sub_f32 v12, 0, v12
    v_lshlrev_b32 v7, 3, v7
    v_cmp_eq_u32 vcc, 0, v6
    s_lshl_b32 s44, s21, 7
    s_add_u32 s44, s44, 29683712
    s_mov_b32 s23, 5476352
    s_and_saveexec_b64 s[66:67], vcc
    buffer_store_dwordx2 v[10:11], v7, s[28:31], s23 offen offset:0 sc1
    buffer_store_dwordx2 v[12:13], v7, s[28:31], s23 offen offset:64 sc1
    s_mov_b64 exec, -1
    s_waitcnt vmcnt(0)
    s_mov_b32 s47, 0
prep_kernel_nn10:
    v_readfirstlane_b32 s46, v250
    s_add_u32 s47, s47, 1
    s_cmp_lg_u32 s46, 0
    s_cbranch_scc1 prep_kernel_nd11
    s_cmp_ge_u32 s47, 200000
    s_cbranch_scc1 prep_kernel_nd11
    buffer_load_dword v250, v251, s[48:51], 0 offen sc1
    s_waitcnt vmcnt(0)
    s_branch prep_kernel_nn10
prep_kernel_nd11:
    v_mov_b32 v30, s46
    v_mov_b32 v31, 0
    s_mov_b64 exec, 1
    buffer_store_dword v30, v31, s[28:31], s44 offen sc1
    s_endpgm
p_misc:
    s_sub_u32 s24, s20, 3
    s_mul_i32 s23, s24, 96
    s_add_u32 s23, s23, s21
    s_cmp_ge_u32 s23, 256
    s_cbranch_scc1 prep_end
    s_mul_i32 s22, s24, 12
    s_lshr_b32 s25, s21, 3
    s_add_u32 s22, s22, s25
    v_lshlrev_b32 v1, 4, v1
    v_mov_b32 v60, 0
    v_mov_b32 v61, 0
    v_mov_b32 v62, 0
    v_mov_b32 v63, 0
    s_lshl_b32 s24, s23, 10
    s_add_u32 s25, s24, 29380608
    s_add_u32 s26, s24, 10784768
    s_add_u32 s27, s24, 13365248
    s_cmp_ge_u32 s23, 20
    s_cselect_b32 s26, s27, s26
    s_cmp_ge_u32 s23, 256
    s_cbranch_scc1 prep_kernel_nz12
    buffer_store_dwordx4 v[60:63], v1, s[28:31], s25 offen sc1
prep_kernel_nz12:
    s_cmp_ge_u32 s23, 40
    s_cbranch_scc1 prep_kernel_nz13
    buffer_store_dwordx4 v[60:63], v1, s[28:31], s26 offen sc1
prep_kernel_nz13:
    s_getpc_b64 s[24:25]
p_pcref:
    s_sub_u32 s24, s24, p_pcref-prep_kernel
    s_subb_u32 s25, s25, 0
    s_lshl_b32 s23, s22, 11
    s_add_u32 s26, s23, 0
    s_min_u32 s26, s26, (chain_end-prep_kernel-1020)&0xfffffff0
    v_add_u32 v64, s26, v1
    v_mov_b32 v5, s25
    v_add_co_u32 v4, vcc, s24, v64
    v_addc_co_u32 v5, vcc, 0, v5, vcc
    global_load_dwordx4 v[72:75], v[4:5], off
    s_add_u32 s26, s23, 1024
    s_min_u32 s26, s26, (chain_end-prep_kernel-1020)&0xfffffff0
    v_add_u32 v64, s26, v1
    v_mov_b32 v5, s25
    v_add_co_u32 v4, vcc, s24, v64
    v_addc_co_u32 v5, vcc, 0, v5, vcc
    global_load_dwordx4 v[76:79], v[4:5], off
    s_waitcnt vmcnt(0)
    s_endpgm
p_conv:
    s_cmp_ge_u32 s20, 4
    s_cbranch_scc1 prep_end
    s_setprio 3
    s_and_b32 s21, s2, 7
    s_mul_i32 s21, s21, 20
    s_sub_u32 s2, s2, 256
    s_lshr_b32 s2, s2, 3
    s_add_u32 s2, s2, s21
    s_mov_b32 s24, s56
    s_mov_b32 s25, s57
    s_mov_b32 s26, 2621440
    s_mov_b32 s27, 0x00020000
    s_lshl_b32 s21, s2, 3
    s_add_u32 s22, s58, s21
    s_addc_u32 s23, s59, 0
    s_load_dwordx2 s[32:33], s[22:23], 0
    s_lshl_b32 s21, s2, 2
    s_add_u32 s21, s21, s20
    s_mul_i32 s34, s20, 13824
    v_lshlrev_b32 v3, 4, v1
    s_lshl_b32 s35, s21, 12
    s_add_u32 s36, s34, 256
    s_mov_b32 m0, s36
    s_mul_i32 s37, s21, 4352
    s_add_u32 s37, s37, 0
    buffer_load_dwordx4 v3, s[24:27], s35 offen offset:0 nt lds
    buffer_load_dwordx4 v3, s[24:27], s35 offen offset:1024 nt lds
    buffer_load_dwordx4 v3, s[24:27], s35 offen offset:2048 nt lds
    buffer_load_dwordx4 v3, s[24:27], s35 offen offset:3072 nt lds
    s_add_u32 s36, s34, 9728
    s_mov_b32 m0, s36
    s_add_u32 s40, s35, 8
    v_mov_b32 v16, 0
    buffer_load_dwordx4 v3, s[24:27], s40 offen offset:0 lds
    buffer_load_dwordx4 v3, s[24:27], s40 offen offset:1024 lds
    buffer_load_dwordx4 v3, s[24:27], s40 offen offset:2048 lds
    buffer_load_dwordx4 v3, s[24:27], s40 offen offset:3072 lds
    buffer_load_dwordx2 v[252:253], v16, s[24:27], s35 offen
    v_lshrrev_b32 v4, 3, v0
    v_mul_u32_u24 v4, 20480, v4
    s_lshr_b32 s38, s2, 1
    s_and_b32 s38, s38, 7
    v_and_b32 v5, 7, v0
    v_xor_b32 v5, s38, v5
    v_lshl_add_u32 v4, v5, 4, v4
    s_lshl_b32 s38, s2, 7
    v_mov_b32 v16, 0
    buffer_load_dword v17, v16, s[48:51], 0 offen sc1
    s_waitcnt vmcnt(0)
    s_mov_b32 s47, 0
prep_kernel_nn14:
    v_readfirstlane_b32 s46, v17
    s_add_u32 s47, s47, 1
    s_cmp_lg_u32 s46, 0
    s_cbranch_scc1 prep_kernel_nd15
    s_cmp_ge_u32 s47, 200000
    s_cbranch_scc1 prep_kernel_nd15
    buffer_load_dword v17, v16, s[48:51], 0 offen sc1
    s_waitcnt vmcnt(0)
    s_branch prep_kernel_nn14
prep_kernel_nd15:
    s_lshr_b32 s40, s2, 4
    s_lshl_b32 s40, s40, 12
    s_add_u32 s40, s40, 29642752
    v_lshlrev_b32 v16, 7, v1
    s_cmp_lg_u32 s20, 0
    s_cbranch_scc1 prep_kernel_w016
    s_mov_b32 s47, 0
    s_mov_b32 exec_lo, -1
    s_mov_b32 exec_hi, 0
prep_kernel_pl17:
    buffer_load_dword v17, v16, s[28:31], s40 offen sc1
    s_add_u32 s47, s47, 1
    s_waitcnt vmcnt(0)
    v_cmp_ne_u32 vcc, s46, v17
    s_cmp_ge_u32 s47, 200000
    s_cbranch_scc1 prep_kernel_pd18
    s_cbranch_vccz prep_kernel_pd18
    s_sleep 8
    s_branch prep_kernel_pl17
prep_kernel_pd18:
    s_mov_b64 exec, -1
prep_kernel_w016:
    s_barrier
    s_add_u32 s36, s34, 4352
    s_mov_b32 m0, s36
    s_nop 0
    buffer_load_dwordx4 v3, s[28:31], s37 offen offset:0 sc1 lds
    buffer_load_dwordx4 v3, s[28:31], s37 offen offset:1024 sc1 lds
    buffer_load_dwordx4 v3, s[28:31], s37 offen offset:2048 sc1 lds
    buffer_load_dwordx4 v3, s[28:31], s37 offen offset:3072 sc1 lds
    s_add_u32 s36, s34, 8448
    s_mov_b32 m0, s36
    s_add_u32 s37, s37, 4096
    buffer_load_dwordx4 v3, s[28:31], s37 offen sc1 lds
    v_lshl_add_u32 v5, v1, 2, s34
    v_mov_b32 v6, 0
    ds_write_b32 v5, v6
    ds_write_b32 v5, v6 offset:9472
    v_and_b32 v7, 15, v1
    v_bfe_u32 v8, v1, 4, 1
    v_lshrrev_b32 v9, 5, v1
    v_mul_u32_u24 v10, 272, v7
    v_lshl_add_u32 v10, v9, 4, v10
    v_add_u32 v10, s34, v10
    v_add_u32 v10, 4356, v10
    v_lshlrev_b32 v11, 2, v8
    v_sub_u32 v10, v10, v11
    v_and_b32 v12, 7, v1
    v_mul_u32_u24 v13, 272, v12
    v_lshl_add_u32 v13, v9, 4, v13
    v_add_u32 v13, s34, v13
    v_add_u32 v13, 4356, v13
    v_sub_u32 v13, v13, v11
    v_bfe_u32 v11, v1, 3, 1
    v_lshlrev_b32 v11, 4, v11
    v_sub_u32 v11, 16, v11
    v_and_b32 v14, 31, v1
    v_lshlrev_b32 v14, 3, v14
    v_lshl_add_u32 v14, v9, 4, v14
    v_add_u32 v14, s34, v14
    v_and_b32 v17, 1, v1
    v_mul_u32_u24 v17, 9464, v17
    v_sub_u32 v17, 9472, v17
    v_add_u32 v14, v17, v14
    v_cmp_ne_u32 vcc, 0, v12
    v_mov_b32 v16, 0
    s_nop 1
    v_cndmask_b32 v15, v16, -1, vcc
    s_add_u32 s36, s34, 9720
    v_mov_b32 v17, s36
    s_waitcnt vmcnt(0) lgkmcnt(0)
    s_mov_b64 exec, 1
    ds_write_b64 v17, v[252:253]
    s_mov_b64 exec, -1
    s_waitcnt lgkmcnt(0)
    ds_read_b128 v[176:179], v14 offset:1792
    ds_read_b128 v[180:183], v14 offset:1824
    ds_read_b128 v[184:187], v14 offset:1856
    ds_read_b128 v[188:191], v14 offset:1888
    ds_read_b128 v[192:195], v14 offset:1920
    ds_read_b128 v[196:199], v14 offset:1952
    ds_read_b128 v[200:203], v14 offset:1984
    ds_read_b128 v[204:207], v14 offset:2016
    ds_read2_b32 v[64:65], v10 offset0:0 offset1:1
    ds_read2_b32 v[66:67], v10 offset0:2 offset1:3
    ds_read2_b32 v[68:69], v10 offset0:8 offset1:9
    ds_read2_b32 v[70:71], v10 offset0:10 offset1:11
    ds_read2_b32 v[72:73], v10 offset0:16 offset1:17
    ds_read2_b32 v[74:75], v10 offset0:18 offset1:19
    ds_read2_b32 v[76:77], v10 offset0:24 offset1:25
    ds_read2_b32 v[78:79], v10 offset0:26 offset1:27
    ds_read2_b32 v[80:81], v10 offset0:32 offset1:33
    ds_read2_b32 v[82:83], v10 offset0:34 offset1:35
    ds_read2_b32 v[84:85], v10 offset0:40 offset1:41
    ds_read2_b32 v[86:87], v10 offset0:42 offset1:43
    ds_read2_b32 v[88:89], v10 offset0:48 offset1:49
    ds_read2_b32 v[90:91], v10 offset0:50 offset1:51
    ds_read2_b32 v[92:93], v10 offset0:56 offset1:57
    ds_read2_b32 v[94:95], v10 offset0:58 offset1:59
    s_waitcnt lgkmcnt(0)
    v_mfma_f32_32x32x16_bf16 v[144:159], v[176:179], v[64:67], 0
    ds_read_b32 v16, v10 offset:16
    ds_read_b32 v17, v10 offset:48
    ds_read_b32 v18, v10 offset:80
    ds_read_b32 v19, v10 offset:112
    ds_read_b32 v20, v10 offset:144
    ds_read_b32 v21, v10 offset:176
    ds_read_b32 v22, v10 offset:208
    ds_read_b32 v23, v10 offset:240
    ds_read2_b32 v[96:97], v13 offset0:0 offset1:1
    ds_read2_b32 v[98:99], v13 offset0:2 offset1:3
    ds_read_b32 v24, v13 offset:16
    ds_read2_b32 v[100:101], v13 offset0:8 offset1:9
    ds_read2_b32 v[102:103], v13 offset0:10 offset1:11
    ds_read_b32 v25, v13 offset:48
    ds_read2_b32 v[104:105], v13 offset0:16 offset1:17
    ds_read2_b32 v[106:107], v13 offset0:18 offset1:19
    v_mfma_f32_32x32x16_bf16 v[144:159], v[180:183], v[68:71], v[144:159]
    ds_read_b32 v26, v13 offset:80
    ds_read2_b32 v[108:109], v13 offset0:24 offset1:25
    ds_read2_b32 v[110:111], v13 offset0:26 offset1:27
    ds_read_b32 v27, v13 offset:112
    ds_read2_b32 v[112:113], v13 offset0:32 offset1:33
    ds_read2_b32 v[114:115], v13 offset0:34 offset1:35
    ds_read_b32 v28, v13 offset:144
    ds_read2_b32 v[116:117], v13 offset0:40 offset1:41
    ds_read2_b32 v[118:119], v13 offset0:42 offset1:43
    ds_read_b32 v29, v13 offset:176
    ds_read2_b32 v[120:121], v13 offset0:48 offset1:49
    ds_read2_b32 v[122:123], v13 offset0:50 offset1:51
    ds_read_b32 v30, v13 offset:208
    ds_read2_b32 v[124:125], v13 offset0:56 offset1:57
    ds_read2_b32 v[126:127], v13 offset0:58 offset1:59
    ds_read_b32 v31, v13 offset:240
    v_mfma_f32_32x32x16_bf16 v[144:159], v[184:187], v[72:75], v[144:159]
    s_waitcnt lgkmcnt(15)
    s_waitcnt lgkmcnt(0)
    v_alignbit_b32 v32, v65, v64, 16
    v_alignbit_b32 v33, v66, v65, 16
    v_alignbit_b32 v34, v67, v66, 16
    v_alignbit_b32 v35, v16, v67, 16
    v_mfma_f32_32x32x16_bf16 v[144:159], v[188:191], v[76:79], v[144:159]
    v_alignbit_b32 v36, v69, v68, 16
    v_alignbit_b32 v37, v70, v69, 16
    v_alignbit_b32 v38, v71, v70, 16
    v_alignbit_b32 v39, v17, v71, 16
    v_alignbit_b32 v40, v73, v72, 16
    v_alignbit_b32 v41, v74, v73, 16
    v_mfma_f32_32x32x16_bf16 v[144:159], v[192:195], v[80:83], v[144:159]
    v_alignbit_b32 v42, v75, v74, 16
    v_alignbit_b32 v43, v18, v75, 16
    v_alignbit_b32 v44, v77, v76, 16
    v_alignbit_b32 v45, v78, v77, 16
    v_alignbit_b32 v46, v79, v78, 16
    v_alignbit_b32 v47, v19, v79, 16
    v_mfma_f32_32x32x16_bf16 v[144:159], v[196:199], v[84:87], v[144:159]
    v_alignbit_b32 v48, v81, v80, 16
    v_alignbit_b32 v49, v82, v81, 16
    v_alignbit_b32 v50, v83, v82, 16
    v_alignbit_b32 v51, v20, v83, 16
    v_alignbit_b32 v52, v85, v84, 16
    v_alignbit_b32 v53, v86, v85, 16
    v_mfma_f32_32x32x16_bf16 v[144:159], v[200:203], v[88:91], v[144:159]
    v_alignbit_b32 v54, v87, v86, 16
    v_alignbit_b32 v55, v21, v87, 16
    v_alignbit_b32 v56, v89, v88, 16
    v_alignbit_b32 v57, v90, v89, 16
    v_alignbit_b32 v58, v91, v90, 16
    v_alignbit_b32 v59, v22, v91, 16
    v_mfma_f32_32x32x16_bf16 v[144:159], v[204:207], v[92:95], v[144:159]
    v_alignbit_b32 v60, v93, v92, 16
    v_alignbit_b32 v61, v94, v93, 16
    v_alignbit_b32 v62, v95, v94, 16
    v_alignbit_b32 v63, v23, v95, 16
    s_nop 0
    v_mfma_f32_32x32x16_bf16 v[128:143], v[176:179], v[32:35], 0
    ds_read_b128 v[208:211], v14 offset:3840
    s_nop 3
    v_mfma_f32_32x32x16_bf16 v[128:143], v[180:183], v[36:39], v[128:143]
    ds_read_b128 v[212:215], v14 offset:3872
    s_nop 3
    v_mfma_f32_32x32x16_bf16 v[128:143], v[184:187], v[40:43], v[128:143]
    ds_read_b128 v[216:219], v14 offset:3904
    v_alignbit_b32 v96, v97, v96, v11
    v_alignbit_b32 v97, v98, v97, v11
    v_alignbit_b32 v98, v99, v98, v11
    v_alignbit_b32 v99, v24, v99, v11
    v_alignbit_b32 v100, v101, v100, v11
    v_alignbit_b32 v101, v102, v101, v11
    v_alignbit_b32 v102, v103, v102, v11
    v_alignbit_b32 v103, v25, v103, v11
    v_alignbit_b32 v104, v105, v104, v11
    v_mfma_f32_32x32x16_bf16 v[128:143], v[188:191], v[44:47], v[128:143]
    ds_read_b128 v[220:223], v14 offset:3936
    v_alignbit_b32 v105, v106, v105, v11
    v_alignbit_b32 v106, v107, v106, v11
    v_alignbit_b32 v107, v26, v107, v11
    v_alignbit_b32 v108, v109, v108, v11
    v_alignbit_b32 v109, v110, v109, v11
    v_alignbit_b32 v110, v111, v110, v11
    v_alignbit_b32 v111, v27, v111, v11
    v_mov_b32_dpp v144, v144 row_shr:1 row_mask:0xf bank_mask:0xf bound_ctrl:0
    v_mfma_f32_32x32x16_bf16 v[128:143], v[192:195], v[48:51], v[128:143]
    ds_read_b128 v[224:227], v14 offset:3968
    v_mov_b32_dpp v145, v145 row_shr:1 row_mask:0xf bank_mask:0xf bound_ctrl:0
    v_mov_b32_dpp v146, v146 row_shr:1 row_mask:0xf bank_mask:0xf bound_ctrl:0
    v_mov_b32_dpp v147, v147 row_shr:1 row_mask:0xf bank_mask:0xf bound_ctrl:0
    v_mov_b32_dpp v148, v148 row_shr:1 row_mask:0xf bank_mask:0xf bound_ctrl:0
    v_mov_b32_dpp v149, v149 row_shr:1 row_mask:0xf bank_mask:0xf bound_ctrl:0
    v_mov_b32_dpp v150, v150 row_shr:1 row_mask:0xf bank_mask:0xf bound_ctrl:0
    v_mov_b32_dpp v151, v151 row_shr:1 row_mask:0xf bank_mask:0xf bound_ctrl:0
    v_mov_b32_dpp v152, v152 row_shr:1 row_mask:0xf bank_mask:0xf bound_ctrl:0
    v_mfma_f32_32x32x16_bf16 v[128:143], v[196:199], v[52:55], v[128:143]
    ds_read_b128 v[228:231], v14 offset:4000
    v_mov_b32_dpp v153, v153 row_shr:1 row_mask:0xf bank_mask:0xf bound_ctrl:0
    v_mov_b32_dpp v154, v154 row_shr:1 row_mask:0xf bank_mask:0xf bound_ctrl:0
    v_mov_b32_dpp v155, v155 row_shr:1 row_mask:0xf bank_mask:0xf bound_ctrl:0
    v_mov_b32_dpp v156, v156 row_shr:1 row_mask:0xf bank_mask:0xf bound_ctrl:0
    v_mov_b32_dpp v157, v157 row_shr:1 row_mask:0xf bank_mask:0xf bound_ctrl:0
    v_mov_b32_dpp v158, v158 row_shr:1 row_mask:0xf bank_mask:0xf bound_ctrl:0
    v_mov_b32_dpp v159, v159 row_shr:1 row_mask:0xf bank_mask:0xf bound_ctrl:0
    v_alignbit_b32 v112, v113, v112, v11
    v_mfma_f32_32x32x16_bf16 v[128:143], v[200:203], v[56:59], v[128:143]
    ds_read_b128 v[232:235], v14 offset:4032
    v_alignbit_b32 v113, v114, v113, v11
    v_alignbit_b32 v114, v115, v114, v11
    v_alignbit_b32 v115, v28, v115, v11
    v_alignbit_b32 v116, v117, v116, v11
    v_alignbit_b32 v117, v118, v117, v11
    v_alignbit_b32 v118, v119, v118, v11
    v_alignbit_b32 v119, v29, v119, v11
    v_alignbit_b32 v120, v121, v120, v11
    v_mfma_f32_32x32x16_bf16 v[128:143], v[204:207], v[60:63], v[128:143]
    ds_read_b128 v[236:239], v14 offset:4064
    v_alignbit_b32 v121, v122, v121, v11
    v_alignbit_b32 v122, v123, v122, v11
    v_alignbit_b32 v123, v30, v123, v11
    v_alignbit_b32 v124, v125, v124, v11
    v_alignbit_b32 v125, v126, v125, v11
    v_alignbit_b32 v126, v127, v126, v11
    v_alignbit_b32 v127, v31, v127, v11
    s_nop 0
    s_waitcnt lgkmcnt(0)
    v_mfma_f32_32x32x16_bf16 v[160:175], v[208:211], v[96:99], 0
    ds_read_b128 v[176:179], v14 offset:1536
    ds_read_b128 v[180:183], v14 offset:1568
    s_nop 2
    v_mfma_f32_32x32x16_bf16 v[160:175], v[212:215], v[100:103], v[160:175]
    ds_read_b128 v[184:187], v14 offset:1600
    ds_read_b128 v[188:191], v14 offset:1632
    s_nop 2
    v_mfma_f32_32x32x16_bf16 v[160:175], v[216:219], v[104:107], v[160:175]
    ds_read_b128 v[192:195], v14 offset:1664
    ds_read_b128 v[196:199], v14 offset:1696
    v_mov_b32_dpp v128, v128 row_shr:1 row_mask:0xf bank_mask:0xf bound_ctrl:0
    v_mov_b32_dpp v129, v129 row_shr:1 row_mask:0xf bank_mask:0xf bound_ctrl:0
    v_mov_b32_dpp v130, v130 row_shr:1 row_mask:0xf bank_mask:0xf bound_ctrl:0
    v_mfma_f32_32x32x16_bf16 v[160:175], v[220:223], v[108:111], v[160:175]
    ds_read_b128 v[200:203], v14 offset:1728
    v_mov_b32_dpp v131, v131 row_shr:1 row_mask:0xf bank_mask:0xf bound_ctrl:0
    v_mov_b32_dpp v132, v132 row_shr:1 row_mask:0xf bank_mask:0xf bound_ctrl:0
    v_mov_b32_dpp v133, v133 row_shr:1 row_mask:0xf bank_mask:0xf bound_ctrl:0
    v_mfma_f32_32x32x16_bf16 v[160:175], v[224:227], v[112:115], v[160:175]
    ds_read_b128 v[204:207], v14 offset:1760
    v_mov_b32_dpp v134, v134 row_shr:1 row_mask:0xf bank_mask:0xf bound_ctrl:0
    v_mov_b32_dpp v135, v135 row_shr:1 row_mask:0xf bank_mask:0xf bound_ctrl:0
    v_mov_b32_dpp v136, v136 row_shr:1 row_mask:0xf bank_mask:0xf bound_ctrl:0
    v_mfma_f32_32x32x16_bf16 v[160:175], v[228:231], v[116:119], v[160:175]
    v_mov_b32_dpp v137, v137 row_shr:1 row_mask:0xf bank_mask:0xf bound_ctrl:0
    v_mov_b32_dpp v138, v138 row_shr:1 row_mask:0xf bank_mask:0xf bound_ctrl:0
    v_mov_b32_dpp v139, v139 row_shr:1 row_mask:0xf bank_mask:0xf bound_ctrl:0
    v_mfma_f32_32x32x16_bf16 v[160:175], v[232:235], v[120:123], v[160:175]
    v_mov_b32_dpp v140, v140 row_shr:1 row_mask:0xf bank_mask:0xf bound_ctrl:0
    v_mov_b32_dpp v141, v141 row_shr:1 row_mask:0xf bank_mask:0xf bound_ctrl:0
    v_mfma_f32_32x32x16_bf16 v[160:175], v[236:239], v[124:127], v[160:175]
    v_mov_b32_dpp v142, v142 row_shr:1 row_mask:0xf bank_mask:0xf bound_ctrl:0
    v_mov_b32_dpp v143, v143 row_shr:1 row_mask:0xf bank_mask:0xf bound_ctrl:0
    s_waitcnt lgkmcnt(0)
    v_mfma_f32_32x32x16_bf16 v[144:159], v[176:179], v[64:67], v[144:159]
    ds_read_b128 v[208:211], v14 offset:3584
    s_nop 3
    v_mfma_f32_32x32x16_bf16 v[144:159], v[180:183], v[68:71], v[144:159]
    ds_read_b128 v[212:215], v14 offset:3616
    s_nop 3
    v_mfma_f32_32x32x16_bf16 v[144:159], v[184:187], v[72:75], v[144:159]
    ds_read_b128 v[216:219], v14 offset:3648
    v_and_b32_dpp v160, v160, v15 row_shr:1 row_mask:0xf bank_mask:0xf bound_ctrl:0
    v_and_b32_dpp v161, v161, v15 row_shr:1 row_mask:0xf bank_mask:0xf bound_ctrl:0
    v_and_b32_dpp v162, v162, v15 row_shr:1 row_mask:0xf bank_mask:0xf bound_ctrl:0
    v_mfma_f32_32x32x16_bf16 v[144:159], v[188:191], v[76:79], v[144:159]
    ds_read_b128 v[220:223], v14 offset:3680
    v_and_b32_dpp v163, v163, v15 row_shr:1 row_mask:0xf bank_mask:0xf bound_ctrl:0
    v_and_b32_dpp v164, v164, v15 row_shr:1 row_mask:0xf bank_mask:0xf bound_ctrl:0
    v_and_b32_dpp v165, v165, v15 row_shr:1 row_mask:0xf bank_mask:0xf bound_ctrl:0
    v_mfma_f32_32x32x16_bf16 v[144:159], v[192:195], v[80:83], v[144:159]
    ds_read_b128 v[224:227], v14 offset:3712
    v_and_b32_dpp v166, v166, v15 row_shr:1 row_mask:0xf bank_mask:0xf bound_ctrl:0
    v_and_b32_dpp v167, v167, v15 row_shr:1 row_mask:0xf bank_mask:0xf bound_ctrl:0
    v_and_b32_dpp v168, v168, v15 row_shr:1 row_mask:0xf bank_mask:0xf bound_ctrl:0
    v_mfma_f32_32x32x16_bf16 v[144:159], v[196:199], v[84:87], v[144:159]
    ds_read_b128 v[228:231], v14 offset:3744
    v_and_b32_dpp v169, v169, v15 row_shr:1 row_mask:0xf bank_mask:0xf bound_ctrl:0
    v_and_b32_dpp v170, v170, v15 row_shr:1 row_mask:0xf bank_mask:0xf bound_ctrl:0
    v_and_b32_dpp v171, v171, v15 row_shr:1 row_mask:0xf bank_mask:0xf bound_ctrl:0
    v_mfma_f32_32x32x16_bf16 v[144:159], v[200:203], v[88:91], v[144:159]
    ds_read_b128 v[232:235], v14 offset:3776
    v_and_b32_dpp v172, v172, v15 row_shr:1 row_mask:0xf bank_mask:0xf bound_ctrl:0
    v_and_b32_dpp v173, v173, v15 row_shr:1 row_mask:0xf bank_mask:0xf bound_ctrl:0
    v_mfma_f32_32x32x16_bf16 v[144:159], v[204:207], v[92:95], v[144:159]
    ds_read_b128 v[236:239], v14 offset:3808
    v_and_b32_dpp v174, v174, v15 row_shr:1 row_mask:0xf bank_mask:0xf bound_ctrl:0
    v_and_b32_dpp v175, v175, v15 row_shr:1 row_mask:0xf bank_mask:0xf bound_ctrl:0
    v_mfma_f32_32x32x16_bf16 v[128:143], v[176:179], v[32:35], v[128:143]
    s_nop 4
    v_mfma_f32_32x32x16_bf16 v[128:143], v[180:183], v[36:39], v[128:143]
    s_nop 4
    v_mfma_f32_32x32x16_bf16 v[128:143], v[184:187], v[40:43], v[128:143]
    v_mov_b32_dpp v144, v144 row_shr:1 row_mask:0xf bank_mask:0xf bound_ctrl:0
    v_mov_b32_dpp v145, v145 row_shr:1 row_mask:0xf bank_mask:0xf bound_ctrl:0
    v_mov_b32_dpp v146, v146 row_shr:1 row_mask:0xf bank_mask:0xf bound_ctrl:0
    v_mfma_f32_32x32x16_bf16 v[128:143], v[188:191], v[44:47], v[128:143]
    v_mov_b32_dpp v147, v147 row_shr:1 row_mask:0xf bank_mask:0xf bound_ctrl:0
    v_mov_b32_dpp v148, v148 row_shr:1 row_mask:0xf bank_mask:0xf bound_ctrl:0
    v_mov_b32_dpp v149, v149 row_shr:1 row_mask:0xf bank_mask:0xf bound_ctrl:0
    v_mfma_f32_32x32x16_bf16 v[128:143], v[192:195], v[48:51], v[128:143]
    v_mov_b32_dpp v150, v150 row_shr:1 row_mask:0xf bank_mask:0xf bound_ctrl:0
    v_mov_b32_dpp v151, v151 row_shr:1 row_mask:0xf bank_mask:0xf bound_ctrl:0
    v_mov_b32_dpp v152, v152 row_shr:1 row_mask:0xf bank_mask:0xf bound_ctrl:0
    v_mfma_f32_32x32x16_bf16 v[128:143], v[196:199], v[52:55], v[128:143]
    v_mov_b32_dpp v153, v153 row_shr:1 row_mask:0xf bank_mask:0xf bound_ctrl:0
    v_mov_b32_dpp v154, v154 row_shr:1 row_mask:0xf bank_mask:0xf bound_ctrl:0
    v_mov_b32_dpp v155, v155 row_shr:1 row_mask:0xf bank_mask:0xf bound_ctrl:0
    v_mfma_f32_32x32x16_bf16 v[128:143], v[200:203], v[56:59], v[128:143]
    v_mov_b32_dpp v156, v156 row_shr:1 row_mask:0xf bank_mask:0xf bound_ctrl:0
    v_mov_b32_dpp v157, v157 row_shr:1 row_mask:0xf bank_mask:0xf bound_ctrl:0
    v_mfma_f32_32x32x16_bf16 v[128:143], v[204:207], v[60:63], v[128:143]
    v_mov_b32_dpp v158, v158 row_shr:1 row_mask:0xf bank_mask:0xf bound_ctrl:0
    v_mov_b32_dpp v159, v159 row_shr:1 row_mask:0xf bank_mask:0xf bound_ctrl:0
    s_waitcnt lgkmcnt(0)
    v_mfma_f32_32x32x16_bf16 v[160:175], v[208:211], v[96:99], v[160:175]
    ds_read_b128 v[176:179], v14 offset:1280
    ds_read_b128 v[180:183], v14 offset:1312
    s_nop 2
    v_mfma_f32_32x32x16_bf16 v[160:175], v[212:215], v[100:103], v[160:175]
    ds_read_b128 v[184:187], v14 offset:1344
    ds_read_b128 v[188:191], v14 offset:1376
    s_nop 2
    v_mfma_f32_32x32x16_bf16 v[160:175], v[216:219], v[104:107], v[160:175]
    ds_read_b128 v[192:195], v14 offset:1408
    ds_read_b128 v[196:199], v14 offset:1440
    v_mov_b32_dpp v128, v128 row_shr:1 row_mask:0xf bank_mask:0xf bound_ctrl:0
    v_mov_b32_dpp v129, v129 row_shr:1 row_mask:0xf bank_mask:0xf bound_ctrl:0
    v_mov_b32_dpp v130, v130 row_shr:1 row_mask:0xf bank_mask:0xf bound_ctrl:0
    v_mfma_f32_32x32x16_bf16 v[160:175], v[220:223], v[108:111], v[160:175]
    ds_read_b128 v[200:203], v14 offset:1472
    v_mov_b32_dpp v131, v131 row_shr:1 row_mask:0xf bank_mask:0xf bound_ctrl:0
    v_mov_b32_dpp v132, v132 row_shr:1 row_mask:0xf bank_mask:0xf bound_ctrl:0
    v_mov_b32_dpp v133, v133 row_shr:1 row_mask:0xf bank_mask:0xf bound_ctrl:0
    v_mfma_f32_32x32x16_bf16 v[160:175], v[224:227], v[112:115], v[160:175]
    ds_read_b128 v[204:207], v14 offset:1504
    v_mov_b32_dpp v134, v134 row_shr:1 row_mask:0xf bank_mask:0xf bound_ctrl:0
    v_mov_b32_dpp v135, v135 row_shr:1 row_mask:0xf bank_mask:0xf bound_ctrl:0
    v_mov_b32_dpp v136, v136 row_shr:1 row_mask:0xf bank_mask:0xf bound_ctrl:0
    v_mfma_f32_32x32x16_bf16 v[160:175], v[228:231], v[116:119], v[160:175]
    v_mov_b32_dpp v137, v137 row_shr:1 row_mask:0xf bank_mask:0xf bound_ctrl:0
    v_mov_b32_dpp v138, v138 row_shr:1 row_mask:0xf bank_mask:0xf bound_ctrl:0
    v_mov_b32_dpp v139, v139 row_shr:1 row_mask:0xf bank_mask:0xf bound_ctrl:0
    v_mfma_f32_32x32x16_bf16 v[160:175], v[232:235], v[120:123], v[160:175]
    v_mov_b32_dpp v140, v140 row_shr:1 row_mask:0xf bank_mask:0xf bound_ctrl:0
    v_mov_b32_dpp v141, v141 row_shr:1 row_mask:0xf bank_mask:0xf bound_ctrl:0
    v_mfma_f32_32x32x16_bf16 v[160:175], v[236:239], v[124:127], v[160:175]
    v_mov_b32_dpp v142, v142 row_shr:1 row_mask:0xf bank_mask:0xf bound_ctrl:0
    v_mov_b32_dpp v143, v143 row_shr:1 row_mask:0xf bank_mask:0xf bound_ctrl:0
    s_waitcnt lgkmcnt(0)
    v_mfma_f32_32x32x16_bf16 v[144:159], v[176:179], v[64:67], v[144:159]
    ds_read_b128 v[208:211], v14 offset:3328
    s_nop 3
    v_mfma_f32_32x32x16_bf16 v[144:159], v[180:183], v[68:71], v[144:159]
    ds_read_b128 v[212:215], v14 offset:3360
    s_nop 3
    v_mfma_f32_32x32x16_bf16 v[144:159], v[184:187], v[72:75], v[144:159]
    ds_read_b128 v[216:219], v14 offset:3392
    v_and_b32_dpp v160, v160, v15 row_shr:1 row_mask:0xf bank_mask:0xf bound_ctrl:0
    v_and_b32_dpp v161, v161, v15 row_shr:1 row_mask:0xf bank_mask:0xf bound_ctrl:0
    v_and_b32_dpp v162, v162, v15 row_shr:1 row_mask:0xf bank_mask:0xf bound_ctrl:0
    v_mfma_f32_32x32x16_bf16 v[144:159], v[188:191], v[76:79], v[144:159]
    ds_read_b128 v[220:223], v14 offset:3424
    v_and_b32_dpp v163, v163, v15 row_shr:1 row_mask:0xf bank_mask:0xf bound_ctrl:0
    v_and_b32_dpp v164, v164, v15 row_shr:1 row_mask:0xf bank_mask:0xf bound_ctrl:0
    v_and_b32_dpp v165, v165, v15 row_shr:1 row_mask:0xf bank_mask:0xf bound_ctrl:0
    v_mfma_f32_32x32x16_bf16 v[144:159], v[192:195], v[80:83], v[144:159]
    ds_read_b128 v[224:227], v14 offset:3456
    v_and_b32_dpp v166, v166, v15 row_shr:1 row_mask:0xf bank_mask:0xf bound_ctrl:0
    v_and_b32_dpp v167, v167, v15 row_shr:1 row_mask:0xf bank_mask:0xf bound_ctrl:0
    v_and_b32_dpp v168, v168, v15 row_shr:1 row_mask:0xf bank_mask:0xf bound_ctrl:0
    v_mfma_f32_32x32x16_bf16 v[144:159], v[196:199], v[84:87], v[144:159]
    ds_read_b128 v[228:231], v14 offset:3488
    v_and_b32_dpp v169, v169, v15 row_shr:1 row_mask:0xf bank_mask:0xf bound_ctrl:0
    v_and_b32_dpp v170, v170, v15 row_shr:1 row_mask:0xf bank_mask:0xf bound_ctrl:0
    v_and_b32_dpp v171, v171, v15 row_shr:1 row_mask:0xf bank_mask:0xf bound_ctrl:0
    v_mfma_f32_32x32x16_bf16 v[144:159], v[200:203], v[88:91], v[144:159]
    ds_read_b128 v[232:235], v14 offset:3520
    v_and_b32_dpp v172, v172, v15 row_shr:1 row_mask:0xf bank_mask:0xf bound_ctrl:0
    v_and_b32_dpp v173, v173, v15 row_shr:1 row_mask:0xf bank_mask:0xf bound_ctrl:0
    v_mfma_f32_32x32x16_bf16 v[144:159], v[204:207], v[92:95], v[144:159]
    ds_read_b128 v[236:239], v14 offset:3552
    v_and_b32_dpp v174, v174, v15 row_shr:1 row_mask:0xf bank_mask:0xf bound_ctrl:0
    v_and_b32_dpp v175, v175, v15 row_shr:1 row_mask:0xf bank_mask:0xf bound_ctrl:0
    v_mfma_f32_32x32x16_bf16 v[128:143], v[176:179], v[32:35], v[128:143]
    s_nop 4
    v_mfma_f32_32x32x16_bf16 v[128:143], v[180:183], v[36:39], v[128:143]
    s_nop 4
    v_mfma_f32_32x32x16_bf16 v[128:143], v[184:187], v[40:43], v[128:143]
    v_mov_b32_dpp v144, v144 row_shr:1 row_mask:0xf bank_mask:0xf bound_ctrl:0
    v_mov_b32_dpp v145, v145 row_shr:1 row_mask:0xf bank_mask:0xf bound_ctrl:0
    v_mov_b32_dpp v146, v146 row_shr:1 row_mask:0xf bank_mask:0xf bound_ctrl:0
    v_mfma_f32_32x32x16_bf16 v[128:143], v[188:191], v[44:47], v[128:143]
    v_mov_b32_dpp v147, v147 row_shr:1 row_mask:0xf bank_mask:0xf bound_ctrl:0
    v_mov_b32_dpp v148, v148 row_shr:1 row_mask:0xf bank_mask:0xf bound_ctrl:0
    v_mov_b32_dpp v149, v149 row_shr:1 row_mask:0xf bank_mask:0xf bound_ctrl:0
    v_mfma_f32_32x32x16_bf16 v[128:143], v[192:195], v[48:51], v[128:143]
    v_mov_b32_dpp v150, v150 row_shr:1 row_mask:0xf bank_mask:0xf bound_ctrl:0
    v_mov_b32_dpp v151, v151 row_shr:1 row_mask:0xf bank_mask:0xf bound_ctrl:0
    v_mov_b32_dpp v152, v152 row_shr:1 row_mask:0xf bank_mask:0xf bound_ctrl:0
    v_mfma_f32_32x32x16_bf16 v[128:143], v[196:199], v[52:55], v[128:143]
    v_mov_b32_dpp v153, v153 row_shr:1 row_mask:0xf bank_mask:0xf bound_ctrl:0
    v_mov_b32_dpp v154, v154 row_shr:1 row_mask:0xf bank_mask:0xf bound_ctrl:0
    v_mov_b32_dpp v155, v155 row_shr:1 row_mask:0xf bank_mask:0xf bound_ctrl:0
    v_mfma_f32_32x32x16_bf16 v[128:143], v[200:203], v[56:59], v[128:143]
    v_mov_b32_dpp v156, v156 row_shr:1 row_mask:0xf bank_mask:0xf bound_ctrl:0
    v_mov_b32_dpp v157, v157 row_shr:1 row_mask:0xf bank_mask:0xf bound_ctrl:0
    v_mfma_f32_32x32x16_bf16 v[128:143], v[204:207], v[60:63], v[128:143]
    v_mov_b32_dpp v158, v158 row_shr:1 row_mask:0xf bank_mask:0xf bound_ctrl:0
    v_mov_b32_dpp v159, v159 row_shr:1 row_mask:0xf bank_mask:0xf bound_ctrl:0
    s_waitcnt lgkmcnt(0)
    v_mfma_f32_32x32x16_bf16 v[160:175], v[208:211], v[96:99], v[160:175]
    ds_read_b128 v[176:179], v14 offset:1024
    ds_read_b128 v[180:183], v14 offset:1056
    s_nop 2
    v_mfma_f32_32x32x16_bf16 v[160:175], v[212:215], v[100:103], v[160:175]
    ds_read_b128 v[184:187], v14 offset:1088
    ds_read_b128 v[188:191], v14 offset:1120
    s_nop 2
    v_mfma_f32_32x32x16_bf16 v[160:175], v[216:219], v[104:107], v[160:175]
    ds_read_b128 v[192:195], v14 offset:1152
    ds_read_b128 v[196:199], v14 offset:1184
    v_mov_b32_dpp v128, v128 row_shr:1 row_mask:0xf bank_mask:0xf bound_ctrl:0
    v_mov_b32_dpp v129, v129 row_shr:1 row_mask:0xf bank_mask:0xf bound_ctrl:0
    v_mov_b32_dpp v130, v130 row_shr:1 row_mask:0xf bank_mask:0xf bound_ctrl:0
    v_mfma_f32_32x32x16_bf16 v[160:175], v[220:223], v[108:111], v[160:175]
    ds_read_b128 v[200:203], v14 offset:1216
    v_mov_b32_dpp v131, v131 row_shr:1 row_mask:0xf bank_mask:0xf bound_ctrl:0
    v_mov_b32_dpp v132, v132 row_shr:1 row_mask:0xf bank_mask:0xf bound_ctrl:0
    v_mov_b32_dpp v133, v133 row_shr:1 row_mask:0xf bank_mask:0xf bound_ctrl:0
    v_mfma_f32_32x32x16_bf16 v[160:175], v[224:227], v[112:115], v[160:175]
    ds_read_b128 v[204:207], v14 offset:1248
    v_mov_b32_dpp v134, v134 row_shr:1 row_mask:0xf bank_mask:0xf bound_ctrl:0
    v_mov_b32_dpp v135, v135 row_shr:1 row_mask:0xf bank_mask:0xf bound_ctrl:0
    v_mov_b32_dpp v136, v136 row_shr:1 row_mask:0xf bank_mask:0xf bound_ctrl:0
    v_mfma_f32_32x32x16_bf16 v[160:175], v[228:231], v[116:119], v[160:175]
    v_mov_b32_dpp v137, v137 row_shr:1 row_mask:0xf bank_mask:0xf bound_ctrl:0
    v_mov_b32_dpp v138, v138 row_shr:1 row_mask:0xf bank_mask:0xf bound_ctrl:0
    v_mov_b32_dpp v139, v139 row_shr:1 row_mask:0xf bank_mask:0xf bound_ctrl:0
    v_mfma_f32_32x32x16_bf16 v[160:175], v[232:235], v[120:123], v[160:175]
    v_mov_b32_dpp v140, v140 row_shr:1 row_mask:0xf bank_mask:0xf bound_ctrl:0
    v_mov_b32_dpp v141, v141 row_shr:1 row_mask:0xf bank_mask:0xf bound_ctrl:0
    v_mfma_f32_32x32x16_bf16 v[160:175], v[236:239], v[124:127], v[160:175]
    v_mov_b32_dpp v142, v142 row_shr:1 row_mask:0xf bank_mask:0xf bound_ctrl:0
    v_mov_b32_dpp v143, v143 row_shr:1 row_mask:0xf bank_mask:0xf bound_ctrl:0
    s_lshr_b32 s40, s2, 4
    s_lshl_b32 s40, s40, 9
    s_add_u32 s40, s40, 29700096
    s_mov_b32 s41, 29683712
    v_lshrrev_b32 v16, 2, v1
    v_mul_u32_u24 v16, 5120, v16
    v_and_b32 v17, 3, v1
    v_lshl_add_u32 v16, v17, 7, v16
    v_lshlrev_b32 v18, 7, v1
    v_mov_b32 v17, s46
    s_add_u32 s42, s41, 8192
    buffer_load_dword v19, v18, s[28:31], s41 offen sc1
    buffer_load_dword v28, v18, s[28:31], s42 offen sc1
    s_mov_b64 exec, 0xfff
    buffer_load_dword v17, v16, s[28:31], s40 offen sc1
    s_mov_b64 exec, -1
    s_waitcnt lgkmcnt(0)
    v_mfma_f32_32x32x16_bf16 v[144:159], v[176:179], v[64:67], v[144:159]
    ds_read_b128 v[208:211], v14 offset:3072
    s_nop 3
    v_mfma_f32_32x32x16_bf16 v[144:159], v[180:183], v[68:71], v[144:159]
    ds_read_b128 v[212:215], v14 offset:3104
    s_nop 3
    v_mfma_f32_32x32x16_bf16 v[144:159], v[184:187], v[72:75], v[144:159]
    ds_read_b128 v[216:219], v14 offset:3136
    v_and_b32_dpp v160, v160, v15 row_shr:1 row_mask:0xf bank_mask:0xf bound_ctrl:0
    v_and_b32_dpp v161, v161, v15 row_shr:1 row_mask:0xf bank_mask:0xf bound_ctrl:0
    v_and_b32_dpp v162, v162, v15 row_shr:1 row_mask:0xf bank_mask:0xf bound_ctrl:0
    v_mfma_f32_32x32x16_bf16 v[144:159], v[188:191], v[76:79], v[144:159]
    ds_read_b128 v[220:223], v14 offset:3168
    v_and_b32_dpp v163, v163, v15 row_shr:1 row_mask:0xf bank_mask:0xf bound_ctrl:0
    v_and_b32_dpp v164, v164, v15 row_shr:1 row_mask:0xf bank_mask:0xf bound_ctrl:0
    v_and_b32_dpp v165, v165, v15 row_shr:1 row_mask:0xf bank_mask:0xf bound_ctrl:0
    v_mfma_f32_32x32x16_bf16 v[144:159], v[192:195], v[80:83], v[144:159]
    ds_read_b128 v[224:227], v14 offset:3200
    v_and_b32_dpp v166, v166, v15 row_shr:1 row_mask:0xf bank_mask:0xf bound_ctrl:0
    v_and_b32_dpp v167, v167, v15 row_shr:1 row_mask:0xf bank_mask:0xf bound_ctrl:0
    v_and_b32_dpp v168, v168, v15 row_shr:1 row_mask:0xf bank_mask:0xf bound_ctrl:0
    v_mfma_f32_32x32x16_bf16 v[144:159], v[196:199], v[84:87], v[144:159]
    ds_read_b128 v[228:231], v14 offset:3232
    v_and_b32_dpp v169, v169, v15 row_shr:1 row_mask:0xf bank_mask:0xf bound_ctrl:0
    v_and_b32_dpp v170, v170, v15 row_shr:1 row_mask:0xf bank_mask:0xf bound_ctrl:0
    v_and_b32_dpp v171, v171, v15 row_shr:1 row_mask:0xf bank_mask:0xf bound_ctrl:0
    v_mfma_f32_32x32x16_bf16 v[144:159], v[200:203], v[88:91], v[144:159]
    ds_read_b128 v[232:235], v14 offset:3264
    v_and_b32_dpp v172, v172, v15 row_shr:1 row_mask:0xf bank_mask:0xf bound_ctrl:0
    v_and_b32_dpp v173, v173, v15 row_shr:1 row_mask:0xf bank_mask:0xf bound_ctrl:0
    v_mfma_f32_32x32x16_bf16 v[144:159], v[204:207], v[92:95], v[144:159]
    ds_read_b128 v[236:239], v14 offset:3296
    v_and_b32_dpp v174, v174, v15 row_shr:1 row_mask:0xf bank_mask:0xf bound_ctrl:0
    v_and_b32_dpp v175, v175, v15 row_shr:1 row_mask:0xf bank_mask:0xf bound_ctrl:0
    v_mfma_f32_32x32x16_bf16 v[128:143], v[176:179], v[32:35], v[128:143]
    s_nop 4
    v_mfma_f32_32x32x16_bf16 v[128:143], v[180:183], v[36:39], v[128:143]
    s_nop 4
    v_mfma_f32_32x32x16_bf16 v[128:143], v[184:187], v[40:43], v[128:143]
    v_mov_b32_dpp v144, v144 row_shr:1 row_mask:0xf bank_mask:0xf bound_ctrl:0
    v_mov_b32_dpp v145, v145 row_shr:1 row_mask:0xf bank_mask:0xf bound_ctrl:0
    v_mov_b32_dpp v146, v146 row_shr:1 row_mask:0xf bank_mask:0xf bound_ctrl:0
    v_mfma_f32_32x32x16_bf16 v[128:143], v[188:191], v[44:47], v[128:143]
    v_mov_b32_dpp v147, v147 row_shr:1 row_mask:0xf bank_mask:0xf bound_ctrl:0
    v_mov_b32_dpp v148, v148 row_shr:1 row_mask:0xf bank_mask:0xf bound_ctrl:0
    v_mov_b32_dpp v149, v149 row_shr:1 row_mask:0xf bank_mask:0xf bound_ctrl:0
    v_mfma_f32_32x32x16_bf16 v[128:143], v[192:195], v[48:51], v[128:143]
    v_mov_b32_dpp v150, v150 row_shr:1 row_mask:0xf bank_mask:0xf bound_ctrl:0
    v_mov_b32_dpp v151, v151 row_shr:1 row_mask:0xf bank_mask:0xf bound_ctrl:0
    v_mov_b32_dpp v152, v152 row_shr:1 row_mask:0xf bank_mask:0xf bound_ctrl:0
    v_mfma_f32_32x32x16_bf16 v[128:143], v[196:199], v[52:55], v[128:143]
    v_mov_b32_dpp v153, v153 row_shr:1 row_mask:0xf bank_mask:0xf bound_ctrl:0
    v_mov_b32_dpp v154, v154 row_shr:1 row_mask:0xf bank_mask:0xf bound_ctrl:0
    v_mov_b32_dpp v155, v155 row_shr:1 row_mask:0xf bank_mask:0xf bound_ctrl:0
    v_mfma_f32_32x32x16_bf16 v[128:143], v[200:203], v[56:59], v[128:143]
    v_mov_b32_dpp v156, v156 row_shr:1 row_mask:0xf bank_mask:0xf bound_ctrl:0
    v_mov_b32_dpp v157, v157 row_shr:1 row_mask:0xf bank_mask:0xf bound_ctrl:0
    v_mfma_f32_32x32x16_bf16 v[128:143], v[204:207], v[60:63], v[128:143]
    v_mov_b32_dpp v158, v158 row_shr:1 row_mask:0xf bank_mask:0xf bound_ctrl:0
    v_mov_b32_dpp v159, v159 row_shr:1 row_mask:0xf bank_mask:0xf bound_ctrl:0
    s_waitcnt lgkmcnt(0)
    v_mfma_f32_32x32x16_bf16 v[160:175], v[208:211], v[96:99], v[160:175]
    ds_read_b128 v[176:179], v14 offset:768
    ds_read_b128 v[180:183], v14 offset:800
    s_nop 2
    v_mfma_f32_32x32x16_bf16 v[160:175], v[212:215], v[100:103], v[160:175]
    ds_read_b128 v[184:187], v14 offset:832
    ds_read_b128 v[188:191], v14 offset:864
    s_nop 2
    v_mfma_f32_32x32x16_bf16 v[160:175], v[216:219], v[104:107], v[160:175]
    ds_read_b128 v[192:195], v14 offset:896
    ds_read_b128 v[196:199], v14 offset:928
    v_mov_b32_dpp v128, v128 row_shr:1 row_mask:0xf bank_mask:0xf bound_ctrl:0
    v_mov_b32_dpp v129, v129 row_shr:1 row_mask:0xf bank_mask:0xf bound_ctrl:0
    v_mov_b32_dpp v130, v130 row_shr:1 row_mask:0xf bank_mask:0xf bound_ctrl:0
    v_mfma_f32_32x32x16_bf16 v[160:175], v[220:223], v[108:111], v[160:175]
    ds_read_b128 v[200:203], v14 offset:960
    v_mov_b32_dpp v131, v131 row_shr:1 row_mask:0xf bank_mask:0xf bound_ctrl:0
    v_mov_b32_dpp v132, v132 row_shr:1 row_mask:0xf bank_mask:0xf bound_ctrl:0
    v_mov_b32_dpp v133, v133 row_shr:1 row_mask:0xf bank_mask:0xf bound_ctrl:0
    v_mfma_f32_32x32x16_bf16 v[160:175], v[224:227], v[112:115], v[160:175]
    ds_read_b128 v[204:207], v14 offset:992
    v_mov_b32_dpp v134, v134 row_shr:1 row_mask:0xf bank_mask:0xf bound_ctrl:0
    v_mov_b32_dpp v135, v135 row_shr:1 row_mask:0xf bank_mask:0xf bound_ctrl:0
    v_mov_b32_dpp v136, v136 row_shr:1 row_mask:0xf bank_mask:0xf bound_ctrl:0
    v_mfma_f32_32x32x16_bf16 v[160:175], v[228:231], v[116:119], v[160:175]
    v_mov_b32_dpp v137, v137 row_shr:1 row_mask:0xf bank_mask:0xf bound_ctrl:0
    v_mov_b32_dpp v138, v138 row_shr:1 row_mask:0xf bank_mask:0xf bound_ctrl:0
    v_mov_b32_dpp v139, v139 row_shr:1 row_mask:0xf bank_mask:0xf bound_ctrl:0
    v_mfma_f32_32x32x16_bf16 v[160:175], v[232:235], v[120:123], v[160:175]
    v_mov_b32_dpp v140, v140 row_shr:1 row_mask:0xf bank_mask:0xf bound_ctrl:0
    v_mov_b32_dpp v141, v141 row_shr:1 row_mask:0xf bank_mask:0xf bound_ctrl:0
    v_mfma_f32_32x32x16_bf16 v[160:175], v[236:239], v[124:127], v[160:175]
    v_mov_b32_dpp v142, v142 row_shr:1 row_mask:0xf bank_mask:0xf bound_ctrl:0
    v_mov_b32_dpp v143, v143 row_shr:1 row_mask:0xf bank_mask:0xf bound_ctrl:0
    s_mov_b32 s47, 0
prep_kernel_mp19:
    s_waitcnt vmcnt(0)
    v_cmp_ne_u32 vcc, s46, v17
    v_cmp_ne_u32 s[66:67], s46, v19
    v_cmp_ne_u32 s[68:69], s46, v28
    s_add_u32 s47, s47, 1
    s_nop 2
    s_or_b64 vcc, vcc, s[66:67]
    s_or_b64 vcc, vcc, s[68:69]
    s_cmp_ge_u32 s47, 200000
    s_cbranch_scc1 prep_kernel_md20
    s_cbranch_vccz prep_kernel_md20
    buffer_load_dword v19, v18, s[28:31], s41 offen sc1
    buffer_load_dword v28, v18, s[28:31], s42 offen sc1
    s_mov_b64 exec, 0xfff
    buffer_load_dword v17, v16, s[28:31], s40 offen sc1
    s_mov_b64 exec, -1
    s_branch prep_kernel_mp19
prep_kernel_md20:
    s_lshl_b32 s40, s2, 4
    s_add_u32 s40, s40, 2793472
    v_lshrrev_b32 v16, 2, v1
    v_mul_u32_u24 v16, 2560, v16
    v_and_b32 v17, 3, v1
    v_mul_u32_u24 v17, 15360, v17
    v_add_u32 v16, v16, v17
    v_lshlrev_b32 v18, 4, v1
    s_mov_b64 exec, 0xfff
    buffer_load_dwordx4 v[20:23], v16, s[28:31], s40 offen sc1
    s_mov_b64 exec, -1
    s_lshl_b32 s43, s20, 10
    s_waitcnt lgkmcnt(0)
    v_mfma_f32_32x32x16_bf16 v[144:159], v[176:179], v[64:67], v[144:159]
    ds_read_b128 v[208:211], v14 offset:2816
    s_nop 3
    v_mfma_f32_32x32x16_bf16 v[144:159], v[180:183], v[68:71], v[144:159]
    ds_read_b128 v[212:215], v14 offset:2848
    s_nop 3
    v_mfma_f32_32x32x16_bf16 v[144:159], v[184:187], v[72:75], v[144:159]
    ds_read_b128 v[216:219], v14 offset:2880
    v_and_b32_dpp v160, v160, v15 row_shr:1 row_mask:0xf bank_mask:0xf bound_ctrl:0
    v_and_b32_dpp v161, v161, v15 row_shr:1 row_mask:0xf bank_mask:0xf bound_ctrl:0
    v_and_b32_dpp v162, v162, v15 row_shr:1 row_mask:0xf bank_mask:0xf bound_ctrl:0
    v_mfma_f32_32x32x16_bf16 v[144:159], v[188:191], v[76:79], v[144:159]
    ds_read_b128 v[220:223], v14 offset:2912
    v_and_b32_dpp v163, v163, v15 row_shr:1 row_mask:0xf bank_mask:0xf bound_ctrl:0
    v_and_b32_dpp v164, v164, v15 row_shr:1 row_mask:0xf bank_mask:0xf bound_ctrl:0
    v_and_b32_dpp v165, v165, v15 row_shr:1 row_mask:0xf bank_mask:0xf bound_ctrl:0
    v_mfma_f32_32x32x16_bf16 v[144:159], v[192:195], v[80:83], v[144:159]
    ds_read_b128 v[224:227], v14 offset:2944
    v_and_b32_dpp v166, v166, v15 row_shr:1 row_mask:0xf bank_mask:0xf bound_ctrl:0
    v_and_b32_dpp v167, v167, v15 row_shr:1 row_mask:0xf bank_mask:0xf bound_ctrl:0
    v_and_b32_dpp v168, v168, v15 row_shr:1 row_mask:0xf bank_mask:0xf bound_ctrl:0
    v_mfma_f32_32x32x16_bf16 v[144:159], v[196:199], v[84:87], v[144:159]
    ds_read_b128 v[228:231], v14 offset:2976
    v_and_b32_dpp v169, v169, v15 row_shr:1 row_mask:0xf bank_mask:0xf bound_ctrl:0
    v_and_b32_dpp v170, v170, v15 row_shr:1 row_mask:0xf bank_mask:0xf bound_ctrl:0
    v_and_b32_dpp v171, v171, v15 row_shr:1 row_mask:0xf bank_mask:0xf bound_ctrl:0
    v_mfma_f32_32x32x16_bf16 v[144:159], v[200:203], v[88:91], v[144:159]
    ds_read_b128 v[232:235], v14 offset:3008
    v_and_b32_dpp v172, v172, v15 row_shr:1 row_mask:0xf bank_mask:0xf bound_ctrl:0
    v_and_b32_dpp v173, v173, v15 row_shr:1 row_mask:0xf bank_mask:0xf bound_ctrl:0
    v_mfma_f32_32x32x16_bf16 v[144:159], v[204:207], v[92:95], v[144:159]
    ds_read_b128 v[236:239], v14 offset:3040
    v_and_b32_dpp v174, v174, v15 row_shr:1 row_mask:0xf bank_mask:0xf bound_ctrl:0
    v_and_b32_dpp v175, v175, v15 row_shr:1 row_mask:0xf bank_mask:0xf bound_ctrl:0
    v_mfma_f32_32x32x16_bf16 v[128:143], v[176:179], v[32:35], v[128:143]
    s_add_u32 m0, s43, 71680
    s_add_u32 s39, s43, 5476352
    buffer_load_dwordx4 v18, s[28:31], s39 offen sc1 lds
    s_nop 3
    v_mfma_f32_32x32x16_bf16 v[128:143], v[180:183], v[36:39], v[128:143]
    s_add_u32 m0, s43, 55296
    s_add_u32 s39, s38, 2854912
    buffer_load_dwordx4 v4, s[28:31], s39 offen sc1 lds
    s_nop 3
    v_mfma_f32_32x32x16_bf16 v[128:143], v[184:187], v[40:43], v[128:143]
    v_mov_b32_dpp v144, v144 row_shr:1 row_mask:0xf bank_mask:0xf bound_ctrl:0
    v_mov_b32_dpp v145, v145 row_shr:1 row_mask:0xf bank_mask:0xf bound_ctrl:0
    v_mov_b32_dpp v146, v146 row_shr:1 row_mask:0xf bank_mask:0xf bound_ctrl:0
    v_mfma_f32_32x32x16_bf16 v[128:143], v[188:191], v[44:47], v[128:143]
    v_mov_b32_dpp v147, v147 row_shr:1 row_mask:0xf bank_mask:0xf bound_ctrl:0
    v_mov_b32_dpp v148, v148 row_shr:1 row_mask:0xf bank_mask:0xf bound_ctrl:0
    v_mov_b32_dpp v149, v149 row_shr:1 row_mask:0xf bank_mask:0xf bound_ctrl:0
    v_mfma_f32_32x32x16_bf16 v[128:143], v[192:195], v[48:51], v[128:143]
    v_mov_b32_dpp v150, v150 row_shr:1 row_mask:0xf bank_mask:0xf bound_ctrl:0
    v_mov_b32_dpp v151, v151 row_shr:1 row_mask:0xf bank_mask:0xf bound_ctrl:0
    v_mov_b32_dpp v152, v152 row_shr:1 row_mask:0xf bank_mask:0xf bound_ctrl:0
    v_mfma_f32_32x32x16_bf16 v[128:143], v[196:199], v[52:55], v[128:143]
    v_mov_b32_dpp v153, v153 row_shr:1 row_mask:0xf bank_mask:0xf bound_ctrl:0
    v_mov_b32_dpp v154, v154 row_shr:1 row_mask:0xf bank_mask:0xf bound_ctrl:0
    v_mov_b32_dpp v155, v155 row_shr:1 row_mask:0xf bank_mask:0xf bound_ctrl:0
    v_mfma_f32_32x32x16_bf16 v[128:143], v[200:203], v[56:59], v[128:143]
    v_mov_b32_dpp v156, v156 row_shr:1 row_mask:0xf bank_mask:0xf bound_ctrl:0
    v_mov_b32_dpp v157, v157 row_shr:1 row_mask:0xf bank_mask:0xf bound_ctrl:0
    v_mfma_f32_32x32x16_bf16 v[128:143], v[204:207], v[60:63], v[128:143]
    v_mov_b32_dpp v158, v158 row_shr:1 row_mask:0xf bank_mask:0xf bound_ctrl:0
    v_mov_b32_dpp v159, v159 row_shr:1 row_mask:0xf bank_mask:0xf bound_ctrl:0
    s_waitcnt lgkmcnt(0)
    v_mfma_f32_32x32x16_bf16 v[160:175], v[208:211], v[96:99], v[160:175]
    ds_read_b128 v[176:179], v14 offset:512
    ds_read_b128 v[180:183], v14 offset:544
    s_nop 2
    v_mfma_f32_32x32x16_bf16 v[160:175], v[212:215], v[100:103], v[160:175]
    ds_read_b128 v[184:187], v14 offset:576
    ds_read_b128 v[188:191], v14 offset:608
    s_nop 2
    v_mfma_f32_32x32x16_bf16 v[160:175], v[216:219], v[104:107], v[160:175]
    ds_read_b128 v[192:195], v14 offset:640
    v_mov_b32_dpp v128, v128 row_shr:1 row_mask:0xf bank_mask:0xf bound_ctrl:0
    v_mov_b32_dpp v129, v129 row_shr:1 row_mask:0xf bank_mask:0xf bound_ctrl:0
    v_mov_b32_dpp v130, v130 row_shr:1 row_mask:0xf bank_mask:0xf bound_ctrl:0
    v_mfma_f32_32x32x16_bf16 v[160:175], v[220:223], v[108:111], v[160:175]
    ds_read_b128 v[196:199], v14 offset:672
    v_mov_b32_dpp v131, v131 row_shr:1 row_mask:0xf bank_mask:0xf bound_ctrl:0
    v_mov_b32_dpp v132, v132 row_shr:1 row_mask:0xf bank_mask:0xf bound_ctrl:0
    v_mov_b32_dpp v133, v133 row_shr:1 row_mask:0xf bank_mask:0xf bound_ctrl:0
    v_mfma_f32_32x32x16_bf16 v[160:175], v[224:227], v[112:115], v[160:175]
    ds_read_b128 v[200:203], v14 offset:704
    v_mov_b32_dpp v134, v134 row_shr:1 row_mask:0xf bank_mask:0xf bound_ctrl:0
    v_mov_b32_dpp v135, v135 row_shr:1 row_mask:0xf bank_mask:0xf bound_ctrl:0
    v_mov_b32_dpp v136, v136 row_shr:1 row_mask:0xf bank_mask:0xf bound_ctrl:0
    v_mfma_f32_32x32x16_bf16 v[160:175], v[228:231], v[116:119], v[160:175]
    ds_read_b128 v[204:207], v14 offset:736
    v_mov_b32_dpp v137, v137 row_shr:1 row_mask:0xf bank_mask:0xf bound_ctrl:0
    v_mov_b32_dpp v138, v138 row_shr:1 row_mask:0xf bank_mask:0xf bound_ctrl:0
    v_mov_b32_dpp v139, v139 row_shr:1 row_mask:0xf bank_mask:0xf bound_ctrl:0
    v_mfma_f32_32x32x16_bf16 v[160:175], v[232:235], v[120:123], v[160:175]
    s_add_u32 m0, s43, 75776
    s_add_u32 s39, s43, 5480448
    buffer_load_dwordx4 v18, s[28:31], s39 offen sc1 lds
    v_mov_b32_dpp v140, v140 row_shr:1 row_mask:0xf bank_mask:0xf bound_ctrl:0
    v_mov_b32_dpp v141, v141 row_shr:1 row_mask:0xf bank_mask:0xf bound_ctrl:0
    v_mfma_f32_32x32x16_bf16 v[160:175], v[236:239], v[124:127], v[160:175]
    s_add_u32 m0, s43, 59392
    s_add_u32 s39, s38, 3510272
    buffer_load_dwordx4 v4, s[28:31], s39 offen sc1 lds
    v_mov_b32_dpp v142, v142 row_shr:1 row_mask:0xf bank_mask:0xf bound_ctrl:0
    v_mov_b32_dpp v143, v143 row_shr:1 row_mask:0xf bank_mask:0xf bound_ctrl:0
    s_waitcnt lgkmcnt(0)
    v_mfma_f32_32x32x16_bf16 v[144:159], v[176:179], v[64:67], v[144:159]
    ds_read_b128 v[208:211], v14 offset:2560
    s_nop 3
    v_mfma_f32_32x32x16_bf16 v[144:159], v[180:183], v[68:71], v[144:159]
    ds_read_b128 v[212:215], v14 offset:2592
    s_nop 3
    v_mfma_f32_32x32x16_bf16 v[144:159], v[184:187], v[72:75], v[144:159]
    ds_read_b128 v[216:219], v14 offset:2624
    v_and_b32_dpp v160, v160, v15 row_shr:1 row_mask:0xf bank_mask:0xf bound_ctrl:0
    v_and_b32_dpp v161, v161, v15 row_shr:1 row_mask:0xf bank_mask:0xf bound_ctrl:0
    v_and_b32_dpp v162, v162, v15 row_shr:1 row_mask:0xf bank_mask:0xf bound_ctrl:0
    v_mfma_f32_32x32x16_bf16 v[144:159], v[188:191], v[76:79], v[144:159]
    ds_read_b128 v[220:223], v14 offset:2656
    v_and_b32_dpp v163, v163, v15 row_shr:1 row_mask:0xf bank_mask:0xf bound_ctrl:0
    v_and_b32_dpp v164, v164, v15 row_shr:1 row_mask:0xf bank_mask:0xf bound_ctrl:0
    v_and_b32_dpp v165, v165, v15 row_shr:1 row_mask:0xf bank_mask:0xf bound_ctrl:0
    v_mfma_f32_32x32x16_bf16 v[144:159], v[192:195], v[80:83], v[144:159]
    ds_read_b128 v[224:227], v14 offset:2688
    v_and_b32_dpp v166, v166, v15 row_shr:1 row_mask:0xf bank_mask:0xf bound_ctrl:0
    v_and_b32_dpp v167, v167, v15 row_shr:1 row_mask:0xf bank_mask:0xf bound_ctrl:0
    v_and_b32_dpp v168, v168, v15 row_shr:1 row_mask:0xf bank_mask:0xf bound_ctrl:0
    v_mfma_f32_32x32x16_bf16 v[144:159], v[196:199], v[84:87], v[144:159]
    ds_read_b128 v[228:231], v14 offset:2720
    v_and_b32_dpp v169, v169, v15 row_shr:1 row_mask:0xf bank_mask:0xf bound_ctrl:0
    v_and_b32_dpp v170, v170, v15 row_shr:1 row_mask:0xf bank_mask:0xf bound_ctrl:0
    v_and_b32_dpp v171, v171, v15 row_shr:1 row_mask:0xf bank_mask:0xf bound_ctrl:0
    v_mfma_f32_32x32x16_bf16 v[144:159], v[200:203], v[88:91], v[144:159]
    ds_read_b128 v[232:235], v14 offset:2752
    v_and_b32_dpp v172, v172, v15 row_shr:1 row_mask:0xf bank_mask:0xf bound_ctrl:0
    v_and_b32_dpp v173, v173, v15 row_shr:1 row_mask:0xf bank_mask:0xf bound_ctrl:0
    v_mfma_f32_32x32x16_bf16 v[144:159], v[204:207], v[92:95], v[144:159]
    ds_read_b128 v[236:239], v14 offset:2784
    v_and_b32_dpp v174, v174, v15 row_shr:1 row_mask:0xf bank_mask:0xf bound_ctrl:0
    v_and_b32_dpp v175, v175, v15 row_shr:1 row_mask:0xf bank_mask:0xf bound_ctrl:0
    v_mfma_f32_32x32x16_bf16 v[128:143], v[176:179], v[32:35], v[128:143]
    s_add_u32 m0, s43, 79872
    s_add_u32 s39, s43, 5484544
    buffer_load_dwordx4 v18, s[28:31], s39 offen sc1 lds
    s_nop 3
    v_mfma_f32_32x32x16_bf16 v[128:143], v[180:183], v[36:39], v[128:143]
    s_add_u32 m0, s43, 63488
    s_add_u32 s39, s38, 4165632
    buffer_load_dwordx4 v4, s[28:31], s39 offen sc1 lds
    s_nop 3
    v_mfma_f32_32x32x16_bf16 v[128:143], v[184:187], v[40:43], v[128:143]
    v_mov_b32_dpp v144, v144 row_shr:1 row_mask:0xf bank_mask:0xf bound_ctrl:0
    v_mov_b32_dpp v145, v145 row_shr:1 row_mask:0xf bank_mask:0xf bound_ctrl:0
    v_mov_b32_dpp v146, v146 row_shr:1 row_mask:0xf bank_mask:0xf bound_ctrl:0
    v_mfma_f32_32x32x16_bf16 v[128:143], v[188:191], v[44:47], v[128:143]
    v_mov_b32_dpp v147, v147 row_shr:1 row_mask:0xf bank_mask:0xf bound_ctrl:0
    v_mov_b32_dpp v148, v148 row_shr:1 row_mask:0xf bank_mask:0xf bound_ctrl:0
    v_mov_b32_dpp v149, v149 row_shr:1 row_mask:0xf bank_mask:0xf bound_ctrl:0
    v_mfma_f32_32x32x16_bf16 v[128:143], v[192:195], v[48:51], v[128:143]
    v_mov_b32_dpp v150, v150 row_shr:1 row_mask:0xf bank_mask:0xf bound_ctrl:0
    v_mov_b32_dpp v151, v151 row_shr:1 row_mask:0xf bank_mask:0xf bound_ctrl:0
    v_mov_b32_dpp v152, v152 row_shr:1 row_mask:0xf bank_mask:0xf bound_ctrl:0
    v_mfma_f32_32x32x16_bf16 v[128:143], v[196:199], v[52:55], v[128:143]
    v_mov_b32_dpp v153, v153 row_shr:1 row_mask:0xf bank_mask:0xf bound_ctrl:0
    v_mov_b32_dpp v154, v154 row_shr:1 row_mask:0xf bank_mask:0xf bound_ctrl:0
    v_mov_b32_dpp v155, v155 row_shr:1 row_mask:0xf bank_mask:0xf bound_ctrl:0
    v_mfma_f32_32x32x16_bf16 v[128:143], v[200:203], v[56:59], v[128:143]
    v_mov_b32_dpp v156, v156 row_shr:1 row_mask:0xf bank_mask:0xf bound_ctrl:0
    v_mov_b32_dpp v157, v157 row_shr:1 row_mask:0xf bank_mask:0xf bound_ctrl:0
    v_mfma_f32_32x32x16_bf16 v[128:143], v[204:207], v[60:63], v[128:143]
    v_mov_b32_dpp v158, v158 row_shr:1 row_mask:0xf bank_mask:0xf bound_ctrl:0
    v_mov_b32_dpp v159, v159 row_shr:1 row_mask:0xf bank_mask:0xf bound_ctrl:0
    s_waitcnt lgkmcnt(0)
    v_mfma_f32_32x32x16_bf16 v[160:175], v[208:211], v[96:99], v[160:175]
    ds_read_b128 v[176:179], v14 offset:256
    ds_read_b128 v[180:183], v14 offset:288
    s_nop 2
    v_mfma_f32_32x32x16_bf16 v[160:175], v[212:215], v[100:103], v[160:175]
    ds_read_b128 v[184:187], v14 offset:320
    ds_read_b128 v[188:191], v14 offset:352
    s_nop 2
    v_mfma_f32_32x32x16_bf16 v[160:175], v[216:219], v[104:107], v[160:175]
    ds_read_b128 v[192:195], v14 offset:384
    v_mov_b32_dpp v128, v128 row_shr:1 row_mask:0xf bank_mask:0xf bound_ctrl:0
    v_mov_b32_dpp v129, v129 row_shr:1 row_mask:0xf bank_mask:0xf bound_ctrl:0
    v_mov_b32_dpp v130, v130 row_shr:1 row_mask:0xf bank_mask:0xf bound_ctrl:0
    v_mfma_f32_32x32x16_bf16 v[160:175], v[220:223], v[108:111], v[160:175]
    ds_read_b128 v[196:199], v14 offset:416
    v_mov_b32_dpp v131, v131 row_shr:1 row_mask:0xf bank_mask:0xf bound_ctrl:0
    v_mov_b32_dpp v132, v132 row_shr:1 row_mask:0xf bank_mask:0xf bound_ctrl:0
    v_mov_b32_dpp v133, v133 row_shr:1 row_mask:0xf bank_mask:0xf bound_ctrl:0
    v_mfma_f32_32x32x16_bf16 v[160:175], v[224:227], v[112:115], v[160:175]
    ds_read_b128 v[200:203], v14 offset:448
    v_mov_b32_dpp v134, v134 row_shr:1 row_mask:0xf bank_mask:0xf bound_ctrl:0
    v_mov_b32_dpp v135, v135 row_shr:1 row_mask:0xf bank_mask:0xf bound_ctrl:0
    v_mov_b32_dpp v136, v136 row_shr:1 row_mask:0xf bank_mask:0xf bound_ctrl:0
    v_mfma_f32_32x32x16_bf16 v[160:175], v[228:231], v[116:119], v[160:175]
    ds_read_b128 v[204:207], v14 offset:480
    v_mov_b32_dpp v137, v137 row_shr:1 row_mask:0xf bank_mask:0xf bound_ctrl:0
    v_mov_b32_dpp v138, v138 row_shr:1 row_mask:0xf bank_mask:0xf bound_ctrl:0
    v_mov_b32_dpp v139, v139 row_shr:1 row_mask:0xf bank_mask:0xf bound_ctrl:0
    v_mfma_f32_32x32x16_bf16 v[160:175], v[232:235], v[120:123], v[160:175]
    s_add_u32 m0, s43, 83968
    s_add_u32 s39, s43, 5488640
    buffer_load_dwordx4 v18, s[28:31], s39 offen sc1 lds
    v_mov_b32_dpp v140, v140 row_shr:1 row_mask:0xf bank_mask:0xf bound_ctrl:0
    v_mov_b32_dpp v141, v141 row_shr:1 row_mask:0xf bank_mask:0xf bound_ctrl:0
    v_mfma_f32_32x32x16_bf16 v[160:175], v[236:239], v[124:127], v[160:175]
    s_add_u32 m0, s43, 67584
    s_add_u32 s39, s38, 4820992
    buffer_load_dwordx4 v4, s[28:31], s39 offen sc1 lds
    v_mov_b32_dpp v142, v142 row_shr:1 row_mask:0xf bank_mask:0xf bound_ctrl:0
    v_mov_b32_dpp v143, v143 row_shr:1 row_mask:0xf bank_mask:0xf bound_ctrl:0
    s_waitcnt lgkmcnt(0)
    v_mfma_f32_32x32x16_bf16 v[144:159], v[176:179], v[64:67], v[144:159]
    ds_read_b128 v[208:211], v14 offset:2304
    s_nop 3
    v_mfma_f32_32x32x16_bf16 v[144:159], v[180:183], v[68:71], v[144:159]
    ds_read_b128 v[212:215], v14 offset:2336
    s_nop 3
    v_mfma_f32_32x32x16_bf16 v[144:159], v[184:187], v[72:75], v[144:159]
    ds_read_b128 v[216:219], v14 offset:2368
    v_and_b32_dpp v160, v160, v15 row_shr:1 row_mask:0xf bank_mask:0xf bound_ctrl:0
    v_and_b32_dpp v161, v161, v15 row_shr:1 row_mask:0xf bank_mask:0xf bound_ctrl:0
    v_and_b32_dpp v162, v162, v15 row_shr:1 row_mask:0xf bank_mask:0xf bound_ctrl:0
    v_mfma_f32_32x32x16_bf16 v[144:159], v[188:191], v[76:79], v[144:159]
    ds_read_b128 v[220:223], v14 offset:2400
    v_and_b32_dpp v163, v163, v15 row_shr:1 row_mask:0xf bank_mask:0xf bound_ctrl:0
    v_and_b32_dpp v164, v164, v15 row_shr:1 row_mask:0xf bank_mask:0xf bound_ctrl:0
    v_and_b32_dpp v165, v165, v15 row_shr:1 row_mask:0xf bank_mask:0xf bound_ctrl:0
    v_mfma_f32_32x32x16_bf16 v[144:159], v[192:195], v[80:83], v[144:159]
    ds_read_b128 v[224:227], v14 offset:2432
    v_and_b32_dpp v166, v166, v15 row_shr:1 row_mask:0xf bank_mask:0xf bound_ctrl:0
    v_and_b32_dpp v167, v167, v15 row_shr:1 row_mask:0xf bank_mask:0xf bound_ctrl:0
    v_and_b32_dpp v168, v168, v15 row_shr:1 row_mask:0xf bank_mask:0xf bound_ctrl:0
    v_mfma_f32_32x32x16_bf16 v[144:159], v[196:199], v[84:87], v[144:159]
    ds_read_b128 v[228:231], v14 offset:2464
    v_and_b32_dpp v169, v169, v15 row_shr:1 row_mask:0xf bank_mask:0xf bound_ctrl:0
    v_and_b32_dpp v170, v170, v15 row_shr:1 row_mask:0xf bank_mask:0xf bound_ctrl:0
    v_and_b32_dpp v171, v171, v15 row_shr:1 row_mask:0xf bank_mask:0xf bound_ctrl:0
    v_mfma_f32_32x32x16_bf16 v[144:159], v[200:203], v[88:91], v[144:159]
    ds_read_b128 v[232:235], v14 offset:2496
    v_and_b32_dpp v172, v172, v15 row_shr:1 row_mask:0xf bank_mask:0xf bound_ctrl:0
    v_and_b32_dpp v173, v173, v15 row_shr:1 row_mask:0xf bank_mask:0xf bound_ctrl:0
    v_mfma_f32_32x32x16_bf16 v[144:159], v[204:207], v[92:95], v[144:159]
    ds_read_b128 v[236:239], v14 offset:2528
    v_and_b32_dpp v174, v174, v15 row_shr:1 row_mask:0xf bank_mask:0xf bound_ctrl:0
    v_and_b32_dpp v175, v175, v15 row_shr:1 row_mask:0xf bank_mask:0xf bound_ctrl:0
    v_mfma_f32_32x32x16_bf16 v[128:143], v[176:179], v[32:35], v[128:143]
    s_nop 4
    v_mfma_f32_32x32x16_bf16 v[128:143], v[180:183], v[36:39], v[128:143]
    s_nop 4
    v_mfma_f32_32x32x16_bf16 v[128:143], v[184:187], v[40:43], v[128:143]
    v_mov_b32_dpp v144, v144 row_shr:1 row_mask:0xf bank_mask:0xf bound_ctrl:0
    v_mov_b32_dpp v145, v145 row_shr:1 row_mask:0xf bank_mask:0xf bound_ctrl:0
    v_mov_b32_dpp v146, v146 row_shr:1 row_mask:0xf bank_mask:0xf bound_ctrl:0
    v_mfma_f32_32x32x16_bf16 v[128:143], v[188:191], v[44:47], v[128:143]
    v_mov_b32_dpp v147, v147 row_shr:1 row_mask:0xf bank_mask:0xf bound_ctrl:0
    v_mov_b32_dpp v148, v148 row_shr:1 row_mask:0xf bank_mask:0xf bound_ctrl:0
    v_mov_b32_dpp v149, v149 row_shr:1 row_mask:0xf bank_mask:0xf bound_ctrl:0
    v_mfma_f32_32x32x16_bf16 v[128:143], v[192:195], v[48:51], v[128:143]
    v_mov_b32_dpp v150, v150 row_shr:1 row_mask:0xf bank_mask:0xf bound_ctrl:0
    v_mov_b32_dpp v151, v151 row_shr:1 row_mask:0xf bank_mask:0xf bound_ctrl:0
    v_mov_b32_dpp v152, v152 row_shr:1 row_mask:0xf bank_mask:0xf bound_ctrl:0
    v_mfma_f32_32x32x16_bf16 v[128:143], v[196:199], v[52:55], v[128:143]
    v_mov_b32_dpp v153, v153 row_shr:1 row_mask:0xf bank_mask:0xf bound_ctrl:0
    v_mov_b32_dpp v154, v154 row_shr:1 row_mask:0xf bank_mask:0xf bound_ctrl:0
    v_mov_b32_dpp v155, v155 row_shr:1 row_mask:0xf bank_mask:0xf bound_ctrl:0
    v_mfma_f32_32x32x16_bf16 v[128:143], v[200:203], v[56:59], v[128:143]
    v_mov_b32_dpp v156, v156 row_shr:1 row_mask:0xf bank_mask:0xf bound_ctrl:0
    v_mov_b32_dpp v157, v157 row_shr:1 row_mask:0xf bank_mask:0xf bound_ctrl:0
    v_mfma_f32_32x32x16_bf16 v[128:143], v[204:207], v[60:63], v[128:143]
    v_mov_b32_dpp v158, v158 row_shr:1 row_mask:0xf bank_mask:0xf bound_ctrl:0
    v_mov_b32_dpp v159, v159 row_shr:1 row_mask:0xf bank_mask:0xf bound_ctrl:0
    s_waitcnt lgkmcnt(0)
    v_mfma_f32_32x32x16_bf16 v[160:175], v[208:211], v[96:99], v[160:175]
    ds_read_b128 v[176:179], v14 offset:0
    ds_read_b128 v[180:183], v14 offset:32
    s_nop 2
    v_mfma_f32_32x32x16_bf16 v[160:175], v[212:215], v[100:103], v[160:175]
    ds_read_b128 v[184:187], v14 offset:64
    ds_read_b128 v[188:191], v14 offset:96
    s_nop 2
    v_mfma_f32_32x32x16_bf16 v[160:175], v[216:219], v[104:107], v[160:175]
    ds_read_b128 v[192:195], v14 offset:128
    ds_read_b128 v[196:199], v14 offset:160
    v_mov_b32_dpp v128, v128 row_shr:1 row_mask:0xf bank_mask:0xf bound_ctrl:0
    v_mov_b32_dpp v129, v129 row_shr:1 row_mask:0xf bank_mask:0xf bound_ctrl:0
    v_mov_b32_dpp v130, v130 row_shr:1 row_mask:0xf bank_mask:0xf bound_ctrl:0
    v_mfma_f32_32x32x16_bf16 v[160:175], v[220:223], v[108:111], v[160:175]
    ds_read_b128 v[200:203], v14 offset:192
    v_mov_b32_dpp v131, v131 row_shr:1 row_mask:0xf bank_mask:0xf bound_ctrl:0
    v_mov_b32_dpp v132, v132 row_shr:1 row_mask:0xf bank_mask:0xf bound_ctrl:0
    v_mov_b32_dpp v133, v133 row_shr:1 row_mask:0xf bank_mask:0xf bound_ctrl:0
    v_mfma_f32_32x32x16_bf16 v[160:175], v[224:227], v[112:115], v[160:175]
    ds_read_b128 v[204:207], v14 offset:224
    v_mov_b32_dpp v134, v134 row_shr:1 row_mask:0xf bank_mask:0xf bound_ctrl:0
    v_mov_b32_dpp v135, v135 row_shr:1 row_mask:0xf bank_mask:0xf bound_ctrl:0
    v_mov_b32_dpp v136, v136 row_shr:1 row_mask:0xf bank_mask:0xf bound_ctrl:0
    v_mfma_f32_32x32x16_bf16 v[160:175], v[228:231], v[116:119], v[160:175]
    v_mov_b32_dpp v137, v137 row_shr:1 row_mask:0xf bank_mask:0xf bound_ctrl:0
    v_mov_b32_dpp v138, v138 row_shr:1 row_mask:0xf bank_mask:0xf bound_ctrl:0
    v_mov_b32_dpp v139, v139 row_shr:1 row_mask:0xf bank_mask:0xf bound_ctrl:0
    v_mfma_f32_32x32x16_bf16 v[160:175], v[232:235], v[120:123], v[160:175]
    v_mov_b32_dpp v140, v140 row_shr:1 row_mask:0xf bank_mask:0xf bound_ctrl:0
    v_mov_b32_dpp v141, v141 row_shr:1 row_mask:0xf bank_mask:0xf bound_ctrl:0
    v_mfma_f32_32x32x16_bf16 v[160:175], v[236:239], v[124:127], v[160:175]
    v_mov_b32_dpp v142, v142 row_shr:1 row_mask:0xf bank_mask:0xf bound_ctrl:0
    v_mov_b32_dpp v143, v143 row_shr:1 row_mask:0xf bank_mask:0xf bound_ctrl:0
    s_waitcnt lgkmcnt(0)
    v_mfma_f32_32x32x16_bf16 v[144:159], v[176:179], v[64:67], v[144:159]
    ds_read_b128 v[208:211], v14 offset:2048
    s_nop 3
    v_mfma_f32_32x32x16_bf16 v[144:159], v[180:183], v[68:71], v[144:159]
    ds_read_b128 v[212:215], v14 offset:2080
    s_nop 3
    v_mfma_f32_32x32x16_bf16 v[144:159], v[184:187], v[72:75], v[144:159]
    ds_read_b128 v[216:219], v14 offset:2112
    v_and_b32_dpp v160, v160, v15 row_shr:1 row_mask:0xf bank_mask:0xf bound_ctrl:0
    v_and_b32_dpp v161, v161, v15 row_shr:1 row_mask:0xf bank_mask:0xf bound_ctrl:0
    v_and_b32_dpp v162, v162, v15 row_shr:1 row_mask:0xf bank_mask:0xf bound_ctrl:0
    v_mfma_f32_32x32x16_bf16 v[144:159], v[188:191], v[76:79], v[144:159]
    ds_read_b128 v[220:223], v14 offset:2144
    v_and_b32_dpp v163, v163, v15 row_shr:1 row_mask:0xf bank_mask:0xf bound_ctrl:0
    v_and_b32_dpp v164, v164, v15 row_shr:1 row_mask:0xf bank_mask:0xf bound_ctrl:0
    v_and_b32_dpp v165, v165, v15 row_shr:1 row_mask:0xf bank_mask:0xf bound_ctrl:0
    v_mfma_f32_32x32x16_bf16 v[144:159], v[192:195], v[80:83], v[144:159]
    ds_read_b128 v[224:227], v14 offset:2176
    v_and_b32_dpp v166, v166, v15 row_shr:1 row_mask:0xf bank_mask:0xf bound_ctrl:0
    v_and_b32_dpp v167, v167, v15 row_shr:1 row_mask:0xf bank_mask:0xf bound_ctrl:0
    v_and_b32_dpp v168, v168, v15 row_shr:1 row_mask:0xf bank_mask:0xf bound_ctrl:0
    v_mfma_f32_32x32x16_bf16 v[144:159], v[196:199], v[84:87], v[144:159]
    ds_read_b128 v[228:231], v14 offset:2208
    v_and_b32_dpp v169, v169, v15 row_shr:1 row_mask:0xf bank_mask:0xf bound_ctrl:0
    v_and_b32_dpp v170, v170, v15 row_shr:1 row_mask:0xf bank_mask:0xf bound_ctrl:0
    v_and_b32_dpp v171, v171, v15 row_shr:1 row_mask:0xf bank_mask:0xf bound_ctrl:0
    v_mfma_f32_32x32x16_bf16 v[144:159], v[200:203], v[88:91], v[144:159]
    ds_read_b128 v[232:235], v14 offset:2240
    v_and_b32_dpp v172, v172, v15 row_shr:1 row_mask:0xf bank_mask:0xf bound_ctrl:0
    v_and_b32_dpp v173, v173, v15 row_shr:1 row_mask:0xf bank_mask:0xf bound_ctrl:0
    v_mfma_f32_32x32x16_bf16 v[144:159], v[204:207], v[92:95], v[144:159]
    ds_read_b128 v[236:239], v14 offset:2272
    v_and_b32_dpp v174, v174, v15 row_shr:1 row_mask:0xf bank_mask:0xf bound_ctrl:0
    v_and_b32_dpp v175, v175, v15 row_shr:1 row_mask:0xf bank_mask:0xf bound_ctrl:0
    v_mfma_f32_32x32x16_bf16 v[128:143], v[176:179], v[32:35], v[128:143]
    v_mfma_f32_32x32x16_bf16 v[128:143], v[180:183], v[36:39], v[128:143]
    v_mfma_f32_32x32x16_bf16 v[128:143], v[184:187], v[40:43], v[128:143]
    v_mfma_f32_32x32x16_bf16 v[128:143], v[188:191], v[44:47], v[128:143]
    v_mfma_f32_32x32x16_bf16 v[128:143], v[192:195], v[48:51], v[128:143]
    v_mfma_f32_32x32x16_bf16 v[128:143], v[196:199], v[52:55], v[128:143]
    v_mfma_f32_32x32x16_bf16 v[128:143], v[200:203], v[56:59], v[128:143]
    v_mfma_f32_32x32x16_bf16 v[128:143], v[204:207], v[60:63], v[128:143]
    s_waitcnt lgkmcnt(0)
    v_mfma_f32_32x32x16_bf16 v[160:175], v[208:211], v[96:99], v[160:175]
    v_mfma_f32_32x32x16_bf16 v[160:175], v[212:215], v[100:103], v[160:175]
    v_mfma_f32_32x32x16_bf16 v[160:175], v[216:219], v[104:107], v[160:175]
    v_mfma_f32_32x32x16_bf16 v[160:175], v[220:223], v[108:111], v[160:175]
    v_mfma_f32_32x32x16_bf16 v[160:175], v[224:227], v[112:115], v[160:175]
    v_mfma_f32_32x32x16_bf16 v[160:175], v[228:231], v[116:119], v[160:175]
    v_mfma_f32_32x32x16_bf16 v[160:175], v[232:235], v[120:123], v[160:175]
    v_mfma_f32_32x32x16_bf16 v[160:175], v[236:239], v[124:127], v[160:175]
    s_nop 11
    v_add_f32_dpp v128, v160, v128 row_shr:8 row_mask:0xf bank_mask:0xf bound_ctrl:0
    v_add_f32_dpp v129, v161, v129 row_shr:8 row_mask:0xf bank_mask:0xf bound_ctrl:0
    v_add_f32_dpp v130, v162, v130 row_shr:8 row_mask:0xf bank_mask:0xf bound_ctrl:0
    v_add_f32_dpp v131, v163, v131 row_shr:8 row_mask:0xf bank_mask:0xf bound_ctrl:0
    v_add_f32_dpp v132, v164, v132 row_shr:8 row_mask:0xf bank_mask:0xf bound_ctrl:0
    v_add_f32_dpp v133, v165, v133 row_shr:8 row_mask:0xf bank_mask:0xf bound_ctrl:0
    v_add_f32_dpp v134, v166, v134 row_shr:8 row_mask:0xf bank_mask:0xf bound_ctrl:0
    v_add_f32_dpp v135, v167, v135 row_shr:8 row_mask:0xf bank_mask:0xf bound_ctrl:0
    v_add_f32_dpp v136, v168, v136 row_shr:8 row_mask:0xf bank_mask:0xf bound_ctrl:0
    v_add_f32_dpp v137, v169, v137 row_shr:8 row_mask:0xf bank_mask:0xf bound_ctrl:0
    v_add_f32_dpp v138, v170, v138 row_shr:8 row_mask:0xf bank_mask:0xf bound_ctrl:0
    v_add_f32_dpp v139, v171, v139 row_shr:8 row_mask:0xf bank_mask:0xf bound_ctrl:0
    v_add_f32_dpp v140, v172, v140 row_shr:8 row_mask:0xf bank_mask:0xf bound_ctrl:0
    v_add_f32_dpp v141, v173, v141 row_shr:8 row_mask:0xf bank_mask:0xf bound_ctrl:0
    v_add_f32_dpp v142, v174, v142 row_shr:8 row_mask:0xf bank_mask:0xf bound_ctrl:0
    v_add_f32_dpp v143, v175, v143 row_shr:8 row_mask:0xf bank_mask:0xf bound_ctrl:0
    s_mov_b32 s42, 0xff00ff00
    s_mov_b32 s43, 0xff00ff00
    s_mov_b64 exec, s[42:43]
    v_add_f32 v144, v160, v144
    v_add_f32 v145, v161, v145
    v_add_f32 v146, v162, v146
    v_add_f32 v147, v163, v147
    v_add_f32 v148, v164, v148
    v_add_f32 v149, v165, v149
    v_add_f32 v150, v166, v150
    v_add_f32 v151, v167, v151
    v_add_f32 v152, v168, v152
    v_add_f32 v153, v169, v153
    v_add_f32 v154, v170, v154
    v_add_f32 v155, v171, v155
    v_add_f32 v156, v172, v156
    v_add_f32 v157, v173, v157
    v_add_f32 v158, v174, v158
    v_add_f32 v159, v175, v159
    s_mov_b64 exec, -1
    v_mul_u32_u24 v16, 264, v7
    v_lshl_add_u32 v16, v9, 5, v16
    v_lshl_add_u32 v16, v8, 2, v16
    v_add_u32 v16, s34, v16
    v_cvt_pk_bf16_f32 v32, v128, v144
    v_cvt_pk_bf16_f32 v33, v129, v145
    v_cvt_pk_bf16_f32 v34, v130, v146
    v_cvt_pk_bf16_f32 v35, v131, v147
    v_cvt_pk_bf16_f32 v36, v132, v148
    v_cvt_pk_bf16_f32 v37, v133, v149
    v_cvt_pk_bf16_f32 v38, v134, v150
    v_cvt_pk_bf16_f32 v39, v135, v151
    v_cvt_pk_bf16_f32 v40, v136, v152
    v_cvt_pk_bf16_f32 v41, v137, v153
    v_cvt_pk_bf16_f32 v42, v138, v154
    v_cvt_pk_bf16_f32 v43, v139, v155
    v_cvt_pk_bf16_f32 v44, v140, v156
    v_cvt_pk_bf16_f32 v45, v141, v157
    v_cvt_pk_bf16_f32 v46, v142, v158
    v_cvt_pk_bf16_f32 v47, v143, v159
    ds_write_b32 v16, v32 offset:0
    ds_write_b32 v16, v33 offset:8
    ds_write_b32 v16, v34 offset:16
    ds_write_b32 v16, v35 offset:24
    ds_write_b32 v16, v36 offset:64
    ds_write_b32 v16, v37 offset:72
    ds_write_b32 v16, v38 offset:80
    ds_write_b32 v16, v39 offset:88
    ds_write_b32 v16, v40 offset:128
    ds_write_b32 v16, v41 offset:136
    ds_write_b32 v16, v42 offset:144
    ds_write_b32 v16, v43 offset:152
    ds_write_b32 v16, v44 offset:192
    ds_write_b32 v16, v45 offset:200
    ds_write_b32 v16, v46 offset:208
    ds_write_b32 v16, v47 offset:216
    s_lshl_b32 s44, s32, 16
    s_and_b32 s45, s32, 0xffff0000
    s_lshl_b32 s46, s33, 16
    s_and_b32 s47, s33, 0xffff0000
    v_mul_u32_u24 v17, 264, v2
    v_lshl_add_u32 v17, v1, 2, v17
    s_waitcnt lgkmcnt(0)
    s_barrier
    v_mul_u32_u24 v19, 272, v2
    v_lshlrev_b32 v18, 2, v1
    v_sub_u32 v19, v19, v18
    v_add_u32 v19, 4604, v19
    ds_read_b32 v48, v17 offset:0
    ds_read_b32 v49, v17 offset:13824
    ds_read_b32 v50, v17 offset:27648
    ds_read_b32 v51, v17 offset:41472
    ds_read_b32 v52, v17 offset:1056
    ds_read_b32 v53, v17 offset:14880
    ds_read_b32 v54, v17 offset:28704
    ds_read_b32 v55, v17 offset:42528
    ds_read_b32 v56, v17 offset:2112
    ds_read_b32 v57, v17 offset:15936
    ds_read_b32 v58, v17 offset:29760
    ds_read_b32 v59, v17 offset:43584
    ds_read_b32 v60, v17 offset:3168
    ds_read_b32 v61, v17 offset:16992
    ds_read_b32 v62, v17 offset:30816
    ds_read_b32 v63, v17 offset:44640
    s_waitcnt lgkmcnt(0)
    ds_read_b32 v224, v19 offset:0
    ds_read_b32 v225, v19 offset:13824
    ds_read_b32 v226, v19 offset:27648
    ds_read_b32 v227, v19 offset:41472
    ds_read_b32 v228, v19 offset:1088
    ds_read_b32 v229, v19 offset:14912
    ds_read_b32 v230, v19 offset:28736
    ds_read_b32 v231, v19 offset:42560
    ds_read_b32 v232, v19 offset:2176
    ds_read_b32 v233, v19 offset:16000
    ds_read_b32 v234, v19 offset:29824
    ds_read_b32 v235, v19 offset:43648
    ds_read_b32 v236, v19 offset:3264
    ds_read_b32 v237, v19 offset:17088
    ds_read_b32 v238, v19 offset:30912
    ds_read_b32 v239, v19 offset:44736
    v_mov_b32 v28, s44
    v_mov_b32 v29, s45
    v_mov_b32 v30, s46
    v_mov_b32 v31, s47
    s_waitcnt vmcnt(0)
    v_lshlrev_b32 v18, 4, v0
    v_add_u32 v18, 55296, v18
    s_waitcnt lgkmcnt(0)
    ds_read_b128 v[176:179], v18 offset:0
    ds_read_b128 v[144:147], v18 offset:16384
    ds_read_b128 v[180:183], v18 offset:4096
    ds_read_b128 v[148:151], v18 offset:20480
    ds_read_b128 v[184:187], v18 offset:8192
    ds_read_b128 v[152:155], v18 offset:24576
    ds_read_b128 v[188:191], v18 offset:12288
    ds_read_b128 v[156:159], v18 offset:28672
    s_nop 1
    v_add_f32_dpp v20, v20, v20 quad_perm:[1,0,3,2] row_mask:0xf bank_mask:0xf
    v_add_f32_dpp v21, v21, v21 quad_perm:[1,0,3,2] row_mask:0xf bank_mask:0xf
    v_add_f32_dpp v22, v22, v22 quad_perm:[1,0,3,2] row_mask:0xf bank_mask:0xf
    v_add_f32_dpp v23, v23, v23 quad_perm:[1,0,3,2] row_mask:0xf bank_mask:0xf
    s_nop 1
    v_add_f32_dpp v20, v20, v20 quad_perm:[2,3,0,1] row_mask:0xf bank_mask:0xf
    v_add_f32_dpp v21, v21, v21 quad_perm:[2,3,0,1] row_mask:0xf bank_mask:0xf
    v_add_f32_dpp v22, v22, v22 quad_perm:[2,3,0,1] row_mask:0xf bank_mask:0xf
    v_add_f32_dpp v23, v23, v23 quad_perm:[2,3,0,1] row_mask:0xf bank_mask:0xf
    s_nop 1
    v_cvt_pk_bf16_f32 v24, v20, v21
    v_lshlrev_b32 v20, 16, v24
    v_and_b32 v21, 0xffff0000, v24
    v_cvt_pk_bf16_f32 v24, v22, v23
    v_lshlrev_b32 v22, 16, v24
    v_and_b32 v23, 0xffff0000, v24
    v_add_f32 v24, 1.0, v20
    v_add_f32 v25, 1.0, v21
    v_add_f32 v26, 1.0, v22
    v_add_f32 v27, 1.0, v23
    v_cvt_pk_bf16_f32 v10, v24, v25
    v_lshlrev_b32 v24, 16, v10
    v_and_b32 v25, 0xffff0000, v10
    v_cvt_pk_bf16_f32 v10, v26, v27
    v_lshlrev_b32 v26, 16, v10
    v_and_b32 v27, 0xffff0000, v10
    s_nop 1
    v_readlane_b32 s68, v20, 0
    v_readlane_b32 s72, v24, 4
    v_readlane_b32 s76, v20, 8
    v_readlane_b32 s69, v21, 0
    v_readlane_b32 s73, v25, 4
    v_readlane_b32 s77, v21, 8
    v_readlane_b32 s70, v22, 0
    v_readlane_b32 s74, v26, 4
    v_readlane_b32 s78, v22, 8
    v_readlane_b32 s71, v23, 0
    v_readlane_b32 s75, v27, 4
    v_readlane_b32 s79, v23, 8
    s_nop 1
    v_mov_b32 v10, s76
    v_mov_b32 v11, s77
    v_mov_b32 v12, s78
    v_mov_b32 v13, s79
    v_mul_f32 v160, s72, v10
    v_mul_f32 v164, s68, v10
    v_mul_f32 v161, s73, v11
    v_mul_f32 v165, s69, v11
    v_mul_f32 v162, s74, v12
    v_mul_f32 v166, s70, v12
    v_mul_f32 v163, s75, v13
    v_mul_f32 v167, s71, v13
    s_waitcnt lgkmcnt(0)
    v_lshlrev_b32 v68, 16, v224
    v_and_b32 v64, 0xffff0000, v224
    v_lshlrev_b32 v69, 16, v225
    v_and_b32 v65, 0xffff0000, v225
    v_lshlrev_b32 v70, 16, v226
    v_and_b32 v66, 0xffff0000, v226
    v_lshlrev_b32 v71, 16, v227
    v_and_b32 v67, 0xffff0000, v227
    v_lshlrev_b32 v74, 16, v48
    v_and_b32 v78, 0xffff0000, v48
    v_lshlrev_b32 v75, 16, v49
    v_and_b32 v79, 0xffff0000, v49
    v_lshlrev_b32 v76, 16, v50
    v_and_b32 v80, 0xffff0000, v50
    v_lshlrev_b32 v77, 16, v51
    v_and_b32 v81, 0xffff0000, v51
    v_lshlrev_b32 v112, 16, v176
    v_and_b32 v113, 0xffff0000, v176
    v_lshlrev_b32 v114, 16, v177
    v_and_b32 v115, 0xffff0000, v177
    v_lshlrev_b32 v116, 16, v178
    v_and_b32 v117, 0xffff0000, v178
    v_lshlrev_b32 v118, 16, v179
    v_and_b32 v119, 0xffff0000, v179
    v_pk_fma_f32 v[64:65], v[64:65], v[28:29], v[74:75]
    v_pk_fma_f32 v[66:67], v[66:67], v[30:31], v[76:77]
    v_pk_fma_f32 v[68:69], v[68:69], v[28:29], v[78:79]
    v_pk_fma_f32 v[70:71], v[70:71], v[30:31], v[80:81]
    v_pk_fma_f32 v[120:121], v[112:113], v[144:145], v[144:145] op_sel:[0,1,0] op_sel_hi:[1,1,0]
    v_pk_fma_f32 v[122:123], v[114:115], v[144:145], v[144:145] op_sel:[0,1,0] op_sel_hi:[1,1,0]
    v_pk_fma_f32 v[124:125], v[116:117], v[146:147], v[146:147] op_sel:[0,1,0] op_sel_hi:[1,1,0]
    v_pk_fma_f32 v[126:127], v[118:119], v[146:147], v[146:147] op_sel:[0,1,0] op_sel_hi:[1,1,0]
    v_pk_fma_f32 v[120:121], v[120:121], v[160:161], v[164:165]
    v_pk_fma_f32 v[122:123], v[122:123], v[162:163], v[166:167]
    v_pk_fma_f32 v[124:125], v[124:125], v[160:161], v[164:165]
    v_pk_fma_f32 v[126:127], v[126:127], v[162:163], v[166:167]
    v_pk_fma_f32 v[64:65], v[64:65], v[120:121], v[112:113]
    v_pk_fma_f32 v[66:67], v[66:67], v[122:123], v[114:115]
    v_pk_fma_f32 v[68:69], v[68:69], v[124:125], v[116:117]
    v_pk_fma_f32 v[70:71], v[70:71], v[126:127], v[118:119]
    v_cvt_pk_bf16_f32 v96, v64, v65
    v_cvt_pk_bf16_f32 v97, v66, v67
    v_cvt_pk_bf16_f32 v98, v68, v69
    v_cvt_pk_bf16_f32 v99, v70, v71
    v_lshlrev_b32 v68, 16, v228
    v_and_b32 v64, 0xffff0000, v228
    v_lshlrev_b32 v69, 16, v229
    v_and_b32 v65, 0xffff0000, v229
    v_lshlrev_b32 v70, 16, v230
    v_and_b32 v66, 0xffff0000, v230
    v_lshlrev_b32 v71, 16, v231
    v_and_b32 v67, 0xffff0000, v231
    v_lshlrev_b32 v74, 16, v52
    v_and_b32 v78, 0xffff0000, v52
    v_lshlrev_b32 v75, 16, v53
    v_and_b32 v79, 0xffff0000, v53
    v_lshlrev_b32 v76, 16, v54
    v_and_b32 v80, 0xffff0000, v54
    v_lshlrev_b32 v77, 16, v55
    v_and_b32 v81, 0xffff0000, v55
    v_lshlrev_b32 v112, 16, v180
    v_and_b32 v113, 0xffff0000, v180
    v_lshlrev_b32 v114, 16, v181
    v_and_b32 v115, 0xffff0000, v181
    v_lshlrev_b32 v116, 16, v182
    v_and_b32 v117, 0xffff0000, v182
    v_lshlrev_b32 v118, 16, v183
    v_and_b32 v119, 0xffff0000, v183
    v_pk_fma_f32 v[64:65], v[64:65], v[28:29], v[74:75]
    v_pk_fma_f32 v[66:67], v[66:67], v[30:31], v[76:77]
    v_pk_fma_f32 v[68:69], v[68:69], v[28:29], v[78:79]
    v_pk_fma_f32 v[70:71], v[70:71], v[30:31], v[80:81]
    v_pk_fma_f32 v[120:121], v[112:113], v[148:149], v[148:149] op_sel:[0,1,0] op_sel_hi:[1,1,0]
    v_pk_fma_f32 v[122:123], v[114:115], v[148:149], v[148:149] op_sel:[0,1,0] op_sel_hi:[1,1,0]
    v_pk_fma_f32 v[124:125], v[116:117], v[150:151], v[150:151] op_sel:[0,1,0] op_sel_hi:[1,1,0]
    v_pk_fma_f32 v[126:127], v[118:119], v[150:151], v[150:151] op_sel:[0,1,0] op_sel_hi:[1,1,0]
    v_pk_fma_f32 v[120:121], v[120:121], v[160:161], v[164:165]
    v_pk_fma_f32 v[122:123], v[122:123], v[162:163], v[166:167]
    v_pk_fma_f32 v[124:125], v[124:125], v[160:161], v[164:165]
    v_pk_fma_f32 v[126:127], v[126:127], v[162:163], v[166:167]
    v_pk_fma_f32 v[64:65], v[64:65], v[120:121], v[112:113]
    v_pk_fma_f32 v[66:67], v[66:67], v[122:123], v[114:115]
    v_pk_fma_f32 v[68:69], v[68:69], v[124:125], v[116:117]
    v_pk_fma_f32 v[70:71], v[70:71], v[126:127], v[118:119]
    v_cvt_pk_bf16_f32 v100, v64, v65
    v_cvt_pk_bf16_f32 v101, v66, v67
    v_cvt_pk_bf16_f32 v102, v68, v69
    v_cvt_pk_bf16_f32 v103, v70, v71
    v_lshlrev_b32 v68, 16, v232
    v_and_b32 v64, 0xffff0000, v232
    v_lshlrev_b32 v69, 16, v233
    v_and_b32 v65, 0xffff0000, v233
    v_lshlrev_b32 v70, 16, v234
    v_and_b32 v66, 0xffff0000, v234
    v_lshlrev_b32 v71, 16, v235
    v_and_b32 v67, 0xffff0000, v235
    v_lshlrev_b32 v74, 16, v56
    v_and_b32 v78, 0xffff0000, v56
    v_lshlrev_b32 v75, 16, v57
    v_and_b32 v79, 0xffff0000, v57
    v_lshlrev_b32 v76, 16, v58
    v_and_b32 v80, 0xffff0000, v58
    v_lshlrev_b32 v77, 16, v59
    v_and_b32 v81, 0xffff0000, v59
    v_lshlrev_b32 v112, 16, v184
    v_and_b32 v113, 0xffff0000, v184
    v_lshlrev_b32 v114, 16, v185
    v_and_b32 v115, 0xffff0000, v185
    v_lshlrev_b32 v116, 16, v186
    v_and_b32 v117, 0xffff0000, v186
    v_lshlrev_b32 v118, 16, v187
    v_and_b32 v119, 0xffff0000, v187
    v_pk_fma_f32 v[64:65], v[64:65], v[28:29], v[74:75]
    v_pk_fma_f32 v[66:67], v[66:67], v[30:31], v[76:77]
    v_pk_fma_f32 v[68:69], v[68:69], v[28:29], v[78:79]
    v_pk_fma_f32 v[70:71], v[70:71], v[30:31], v[80:81]
    v_pk_fma_f32 v[120:121], v[112:113], v[152:153], v[152:153] op_sel:[0,1,0] op_sel_hi:[1,1,0]
    v_pk_fma_f32 v[122:123], v[114:115], v[152:153], v[152:153] op_sel:[0,1,0] op_sel_hi:[1,1,0]
    v_pk_fma_f32 v[124:125], v[116:117], v[154:155], v[154:155] op_sel:[0,1,0] op_sel_hi:[1,1,0]
    v_pk_fma_f32 v[126:127], v[118:119], v[154:155], v[154:155] op_sel:[0,1,0] op_sel_hi:[1,1,0]
    v_pk_fma_f32 v[120:121], v[120:121], v[160:161], v[164:165]
    v_pk_fma_f32 v[122:123], v[122:123], v[162:163], v[166:167]
    v_pk_fma_f32 v[124:125], v[124:125], v[160:161], v[164:165]
    v_pk_fma_f32 v[126:127], v[126:127], v[162:163], v[166:167]
    v_pk_fma_f32 v[64:65], v[64:65], v[120:121], v[112:113]
    v_pk_fma_f32 v[66:67], v[66:67], v[122:123], v[114:115]
    v_pk_fma_f32 v[68:69], v[68:69], v[124:125], v[116:117]
    v_pk_fma_f32 v[70:71], v[70:71], v[126:127], v[118:119]
    v_cvt_pk_bf16_f32 v104, v64, v65
    v_cvt_pk_bf16_f32 v105, v66, v67
    v_cvt_pk_bf16_f32 v106, v68, v69
    v_cvt_pk_bf16_f32 v107, v70, v71
    v_lshlrev_b32 v68, 16, v236
    v_and_b32 v64, 0xffff0000, v236
    v_lshlrev_b32 v69, 16, v237
    v_and_b32 v65, 0xffff0000, v237
    v_lshlrev_b32 v70, 16, v238
    v_and_b32 v66, 0xffff0000, v238
    v_lshlrev_b32 v71, 16, v239
    v_and_b32 v67, 0xffff0000, v239
    v_lshlrev_b32 v74, 16, v60
    v_and_b32 v78, 0xffff0000, v60
    v_lshlrev_b32 v75, 16, v61
    v_and_b32 v79, 0xffff0000, v61
    v_lshlrev_b32 v76, 16, v62
    v_and_b32 v80, 0xffff0000, v62
    v_lshlrev_b32 v77, 16, v63
    v_and_b32 v81, 0xffff0000, v63
    v_lshlrev_b32 v112, 16, v188
    v_and_b32 v113, 0xffff0000, v188
    v_lshlrev_b32 v114, 16, v189
    v_and_b32 v115, 0xffff0000, v189
    v_lshlrev_b32 v116, 16, v190
    v_and_b32 v117, 0xffff0000, v190
    v_lshlrev_b32 v118, 16, v191
    v_and_b32 v119, 0xffff0000, v191
    v_pk_fma_f32 v[64:65], v[64:65], v[28:29], v[74:75]
    v_pk_fma_f32 v[66:67], v[66:67], v[30:31], v[76:77]
    v_pk_fma_f32 v[68:69], v[68:69], v[28:29], v[78:79]
    v_pk_fma_f32 v[70:71], v[70:71], v[30:31], v[80:81]
    v_pk_fma_f32 v[120:121], v[112:113], v[156:157], v[156:157] op_sel:[0,1,0] op_sel_hi:[1,1,0]
    v_pk_fma_f32 v[122:123], v[114:115], v[156:157], v[156:157] op_sel:[0,1,0] op_sel_hi:[1,1,0]
    v_pk_fma_f32 v[124:125], v[116:117], v[158:159], v[158:159] op_sel:[0,1,0] op_sel_hi:[1,1,0]
    v_pk_fma_f32 v[126:127], v[118:119], v[158:159], v[158:159] op_sel:[0,1,0] op_sel_hi:[1,1,0]
    v_pk_fma_f32 v[120:121], v[120:121], v[160:161], v[164:165]
    v_pk_fma_f32 v[122:123], v[122:123], v[162:163], v[166:167]
    v_pk_fma_f32 v[124:125], v[124:125], v[160:161], v[164:165]
    v_pk_fma_f32 v[126:127], v[126:127], v[162:163], v[166:167]
    v_pk_fma_f32 v[64:65], v[64:65], v[120:121], v[112:113]
    v_pk_fma_f32 v[66:67], v[66:67], v[122:123], v[114:115]
    v_pk_fma_f32 v[68:69], v[68:69], v[124:125], v[116:117]
    v_pk_fma_f32 v[70:71], v[70:71], v[126:127], v[118:119]
    v_cvt_pk_bf16_f32 v108, v64, v65
    v_cvt_pk_bf16_f32 v109, v66, v67
    v_cvt_pk_bf16_f32 v110, v68, v69
    v_cvt_pk_bf16_f32 v111, v70, v71
    s_add_u32 s39, s38, 5492736
    buffer_store_dwordx4 v[96:99], v4, s[28:31], s39 offen sc1
    s_add_u32 s39, s39, 655360
    buffer_store_dwordx4 v[100:103], v4, s[28:31], s39 offen sc1
    s_add_u32 s39, s39, 655360
    buffer_store_dwordx4 v[104:107], v4, s[28:31], s39 offen sc1
    s_add_u32 s39, s39, 655360
    buffer_store_dwordx4 v[108:111], v4, s[28:31], s39 offen sc1
    s_add_u32 s39, s39, 655360
    s_waitcnt vmcnt(0)
    s_endpgm
p_pack:
    s_sub_u32 s21, s2, 416
    s_mul_i32 s34, s20, 13824
    s_cmp_ge_u32 s20, 4
    s_cbranch_scc1 prep_end
    s_cmp_eq_u32 s20, 0
    s_cbranch_scc1 k1_pack
    s_cmp_eq_u32 s20, 1
    s_cbranch_scc0 p_pk2
    s_cmp_lt_u32 s21, 58
    s_cbranch_scc0 p_pk1
    s_add_u32 s21, s21, 96
    s_branch k1_pack
p_pk1:
    s_sub_u32 s21, s21, 58
    s_cmp_ge_u32 s21, 30
    s_cbranch_scc1 prep_end
    s_branch p_fin
p_pk2:
    s_sub_u32 s22, s20, 2
    s_mul_i32 s22, s22, 96
    s_add_u32 s21, s21, s22
    s_cmp_ge_u32 s21, 120
    s_cbranch_scc1 prep_end
    s_add_u32 s21, s21, 120
    v_mov_b32 v251, 0
    buffer_load_dword v250, v251, s[48:51], 0 offen sc1
    s_branch p_mod
p_fin:
    s_add_u32 s21, s21, 30
    v_mov_b32 v16, 0
    buffer_load_dword v17, v16, s[48:51], 0 offen sc1
    s_waitcnt vmcnt(0)
    s_mov_b32 s47, 0
prep_kernel_nn21:
    v_readfirstlane_b32 s46, v17
    s_add_u32 s47, s47, 1
    s_cmp_lg_u32 s46, 0
    s_cbranch_scc1 prep_kernel_nd22
    s_cmp_ge_u32 s47, 200000
    s_cbranch_scc1 prep_kernel_nd22
    buffer_load_dword v17, v16, s[48:51], 0 offen sc1
    s_waitcnt vmcnt(0)
    s_branch prep_kernel_nn21
prep_kernel_nd22:
    s_lshl_b32 s40, s21, 9
    s_add_u32 s40, s40, 29700096
    v_lshlrev_b32 v16, 7, v1
    s_mov_b32 s47, 0
    s_mov_b64 exec, 15
prep_kernel_pl23:
    buffer_load_dword v17, v16, s[28:31], s40 offen sc1
    s_add_u32 s47, s47, 1
    s_waitcnt vmcnt(0)
    v_cmp_ne_u32 vcc, s46, v17
    s_cmp_ge_u32 s47, 200000
    s_cbranch_scc1 prep_kernel_pd24
    s_cbranch_vccz prep_kernel_pd24
    s_sleep 8
    s_branch prep_kernel_pl23
prep_kernel_pd24:
    s_mov_b64 exec, -1
    v_lshlrev_b32 v7, 2, v1
    s_lshl_b32 s22, s21, 8
    s_add_u32 s23, s22, 2793472
    buffer_load_dword v10, v7, s[28:31], s23 offen sc1
    s_add_u32 s23, s23, 15360
    buffer_load_dword v11, v7, s[28:31], s23 offen sc1
    s_add_u32 s23, s23, 15360
    buffer_load_dword v12, v7, s[28:31], s23 offen sc1
    s_add_u32 s23, s23, 15360
    buffer_load_dword v13, v7, s[28:31], s23 offen sc1
    s_waitcnt vmcnt(0)
    v_add_f32 v10, v10, v11
    v_add_f32 v12, v12, v13
    s_nop 0
    v_add_f32 v10, v10, v12
    s_nop 0
    v_cvt_pk_bf16_f32 v10, v10, v10
    s_nop 0
    v_lshlrev_b32 v10, 16, v10
    s_sub_u32 s24, s21, 10
    s_cmp_lt_u32 s24, 10
    s_cbranch_scc1 prep_kernel_f125
    s_sub_u32 s24, s21, 40
    s_cmp_lt_u32 s24, 10
    s_cbranch_scc0 prep_kernel_f226
prep_kernel_f125:
    v_add_f32 v10, 1.0, v10
    s_nop 0
    v_cvt_pk_bf16_f32 v10, v10, v10
    s_nop 0
    v_lshlrev_b32 v10, 16, v10
prep_kernel_f226:
    s_add_u32 s22, s22, 8114176
    buffer_store_dword v10, v7, s[28:31], s22 offen sc1
    s_endpgm
k1_pack:
    v_lshrrev_b32 v3, 3, v1
    v_and_b32 v4, 7, v1
    v_mul_u32_u24 v5, 144, v3
    v_lshl_add_u32 v5, v4, 4, v5
    v_add_u32 v5, s34, v5
    v_and_b32 v6, 15, v1
    v_lshrrev_b32 v7, 4, v1
    v_lshrrev_b32 v8, 2, v6
    v_lshl_add_u32 v8, v7, 3, v8
    v_mul_u32_u24 v8, 144, v8
    v_and_b32 v9, 3, v6
    v_lshl_add_u32 v8, v9, 3, v8
    v_add_u32 v8, s34, v8
    v_lshlrev_b32 v9, 4, v1
    s_cmp_lt_u32 s21, 20
    s_cbranch_scc1 prep_kernel_pk27
    s_cmp_lt_u32 s21, 40
    s_cbranch_scc1 prep_kernel_pk28
    s_cmp_lt_u32 s21, 94
    s_cbranch_scc1 prep_kernel_pk29
    s_branch prep_kernel_pk30
prep_kernel_pk27:
    s_mov_b32 s24, s12
    s_mov_b32 s25, s13
    s_mov_b32 s26, 819200
    s_mov_b32 s27, 0x00020000
    s_sub_u32 s32, s21, 0
    s_mul_i32 s33, s32, 52429
    s_lshr_b32 s33, s33, 19
    s_mul_i32 s35, s33, 10
    s_sub_u32 s35, s32, s35
    v_mul_u32_u24 v10, 1280, v3
    v_lshl_add_u32 v10, v4, 4, v10
    s_mul_i32 s36, s33, 409600
    s_lshl_b32 s37, s35, 7
    s_add_u32 s36, s36, s37
    buffer_load_dwordx4 v[32:35], v10, s[24:27], s36 offen nt
    s_add_u32 s36, s36, 10240
    buffer_load_dwordx4 v[36:39], v10, s[24:27], s36 offen nt
    s_add_u32 s36, s36, 10240
    buffer_load_dwordx4 v[40:43], v10, s[24:27], s36 offen nt
    s_add_u32 s36, s36, 10240
    buffer_load_dwordx4 v[44:47], v10, s[24:27], s36 offen nt
    s_add_u32 s36, s36, 10240
    buffer_load_dwordx4 v[48:51], v10, s[24:27], s36 offen nt
    s_add_u32 s36, s36, 10240
    buffer_load_dwordx4 v[52:55], v10, s[24:27], s36 offen nt
    s_add_u32 s36, s36, 10240
    buffer_load_dwordx4 v[56:59], v10, s[24:27], s36 offen nt
    s_add_u32 s36, s36, 10240
    buffer_load_dwordx4 v[60:63], v10, s[24:27], s36 offen nt
    s_add_u32 s36, s36, 10240
    buffer_load_dwordx4 v[64:67], v10, s[24:27], s36 offen nt
    s_add_u32 s36, s36, 10240
    buffer_load_dwordx4 v[68:71], v10, s[24:27], s36 offen nt
    s_add_u32 s36, s36, 10240
    buffer_load_dwordx4 v[72:75], v10, s[24:27], s36 offen nt
    s_add_u32 s36, s36, 10240
    buffer_load_dwordx4 v[76:79], v10, s[24:27], s36 offen nt
    s_add_u32 s36, s36, 10240
    buffer_load_dwordx4 v[80:83], v10, s[24:27], s36 offen nt
    s_add_u32 s36, s36, 10240
    buffer_load_dwordx4 v[84:87], v10, s[24:27], s36 offen nt
    s_add_u32 s36, s36, 10240
    buffer_load_dwordx4 v[88:91], v10, s[24:27], s36 offen nt
    s_add_u32 s36, s36, 10240
    buffer_load_dwordx4 v[92:95], v10, s[24:27], s36 offen nt
    s_add_u32 s36, s36, 10240
    buffer_load_dwordx4 v[96:99], v10, s[24:27], s36 offen nt
    s_add_u32 s36, s36, 10240
    buffer_load_dwordx4 v[100:103], v10, s[24:27], s36 offen nt
    s_add_u32 s36, s36, 10240
    buffer_load_dwordx4 v[104:107], v10, s[24:27], s36 offen nt
    s_add_u32 s36, s36, 10240
    buffer_load_dwordx4 v[108:111], v10, s[24:27], s36 offen nt
    s_add_u32 s36, s36, 10240
    buffer_load_dwordx4 v[112:115], v10, s[24:27], s36 offen nt
    s_add_u32 s36, s36, 10240
    buffer_load_dwordx4 v[116:119], v10, s[24:27], s36 offen nt
    s_add_u32 s36, s36, 10240
    buffer_load_dwordx4 v[120:123], v10, s[24:27], s36 offen nt
    s_add_u32 s36, s36, 10240
    buffer_load_dwordx4 v[124:127], v10, s[24:27], s36 offen nt
    s_add_u32 s36, s36, 10240
    buffer_load_dwordx4 v[128:131], v10, s[24:27], s36 offen nt
    s_add_u32 s36, s36, 10240
    buffer_load_dwordx4 v[132:135], v10, s[24:27], s36 offen nt
    s_add_u32 s36, s36, 10240
    buffer_load_dwordx4 v[136:139], v10, s[24:27], s36 offen nt
    s_add_u32 s36, s36, 10240
    buffer_load_dwordx4 v[140:143], v10, s[24:27], s36 offen nt
    s_add_u32 s36, s36, 10240
    buffer_load_dwordx4 v[144:147], v10, s[24:27], s36 offen nt
    s_add_u32 s36, s36, 10240
    buffer_load_dwordx4 v[148:151], v10, s[24:27], s36 offen nt
    s_add_u32 s36, s36, 10240
    buffer_load_dwordx4 v[152:155], v10, s[24:27], s36 offen nt
    s_add_u32 s36, s36, 10240
    buffer_load_dwordx4 v[156:159], v10, s[24:27], s36 offen nt
    s_add_u32 s36, s36, 10240
    buffer_load_dwordx4 v[160:163], v10, s[24:27], s36 offen nt
    s_add_u32 s36, s36, 10240
    buffer_load_dwordx4 v[164:167], v10, s[24:27], s36 offen nt
    s_add_u32 s36, s36, 10240
    buffer_load_dwordx4 v[168:171], v10, s[24:27], s36 offen nt
    s_add_u32 s36, s36, 10240
    buffer_load_dwordx4 v[172:175], v10, s[24:27], s36 offen nt
    s_add_u32 s36, s36, 10240
    buffer_load_dwordx4 v[176:179], v10, s[24:27], s36 offen nt
    s_add_u32 s36, s36, 10240
    buffer_load_dwordx4 v[180:183], v10, s[24:27], s36 offen nt
    s_add_u32 s36, s36, 10240
    buffer_load_dwordx4 v[184:187], v10, s[24:27], s36 offen nt
    s_add_u32 s36, s36, 10240
    buffer_load_dwordx4 v[188:191], v10, s[24:27], s36 offen nt
    s_lshl_b32 s36, s35, 2
    s_add_u32 s36, s36, 0
    s_mul_i32 s38, s36, 6554
    s_lshr_b32 s38, s38, 16
    s_mul_i32 s39, s38, 10
    s_sub_u32 s39, s36, s39
    s_cmp_ge_u32 s39, 5
    s_cselect_b32 s40, 1, 0
    s_sub_u32 s41, s39, 6
    s_cmp_eq_u32 s39, 5
    s_cselect_b32 s41, 4, s41
    s_cmp_eq_u32 s40, 1
    s_cselect_b32 s39, s41, s39
    s_mul_i32 s37, s38, 200
    s_mul_i32 s40, s40, 100
    s_add_u32 s37, s37, s40
    s_mul_i32 s40, s33, 50
    s_add_u32 s37, s37, s40
    s_add_u32 s37, s37, s39
    s_lshl_b32 s37, s37, 10
    s_add_u32 s44, s37, 23236608
    s_movk_i32 s48, 5120
    s_lshl_b32 s36, s35, 2
    s_add_u32 s36, s36, 1
    s_mul_i32 s38, s36, 6554
    s_lshr_b32 s38, s38, 16
    s_mul_i32 s39, s38, 10
    s_sub_u32 s39, s36, s39
    s_cmp_ge_u32 s39, 5
    s_cselect_b32 s40, 1, 0
    s_sub_u32 s41, s39, 6
    s_cmp_eq_u32 s39, 5
    s_cselect_b32 s41, 4, s41
    s_cmp_eq_u32 s40, 1
    s_cselect_b32 s39, s41, s39
    s_mul_i32 s37, s38, 200
    s_mul_i32 s40, s40, 100
    s_add_u32 s37, s37, s40
    s_mul_i32 s40, s33, 50
    s_add_u32 s37, s37, s40
    s_add_u32 s37, s37, s39
    s_lshl_b32 s37, s37, 10
    s_add_u32 s45, s37, 23236608
    s_movk_i32 s49, 5120
    s_lshl_b32 s36, s35, 2
    s_add_u32 s36, s36, 2
    s_mul_i32 s38, s36, 6554
    s_lshr_b32 s38, s38, 16
    s_mul_i32 s39, s38, 10
    s_sub_u32 s39, s36, s39
    s_cmp_ge_u32 s39, 5
    s_cselect_b32 s40, 1, 0
    s_sub_u32 s41, s39, 6
    s_cmp_eq_u32 s39, 5
    s_cselect_b32 s41, 4, s41
    s_cmp_eq_u32 s40, 1
    s_cselect_b32 s39, s41, s39
    s_mul_i32 s37, s38, 200
    s_mul_i32 s40, s40, 100
    s_add_u32 s37, s37, s40
    s_mul_i32 s40, s33, 50
    s_add_u32 s37, s37, s40
    s_add_u32 s37, s37, s39
    s_lshl_b32 s37, s37, 10
    s_add_u32 s46, s37, 23236608
    s_movk_i32 s50, 5120
    s_lshl_b32 s36, s35, 2
    s_add_u32 s36, s36, 3
    s_mul_i32 s38, s36, 6554
    s_lshr_b32 s38, s38, 16
    s_mul_i32 s39, s38, 10
    s_sub_u32 s39, s36, s39
    s_cmp_ge_u32 s39, 5
    s_cselect_b32 s40, 1, 0
    s_sub_u32 s41, s39, 6
    s_cmp_eq_u32 s39, 5
    s_cselect_b32 s41, 4, s41
    s_cmp_eq_u32 s40, 1
    s_cselect_b32 s39, s41, s39
    s_mul_i32 s37, s38, 200
    s_mul_i32 s40, s40, 100
    s_add_u32 s37, s37, s40
    s_mul_i32 s40, s33, 50
    s_add_u32 s37, s37, s40
    s_add_u32 s37, s37, s39
    s_lshl_b32 s37, s37, 10
    s_add_u32 s47, s37, 23236608
    s_movk_i32 s51, 5120
    v_mov_b32 v12, 0
    v_mov_b32 v13, 0
    v_mov_b32 v14, 0
    v_mov_b32 v15, 0
    v_mov_b32 v16, 0x3f803f80
    s_waitcnt vmcnt(36)
    ds_write_b128 v5, v[32:35] offset:0
    ds_write_b128 v5, v[36:39] offset:1152
    ds_write_b128 v5, v[40:43] offset:2304
    ds_write_b128 v5, v[44:47] offset:3456
    s_waitcnt lgkmcnt(0)
    ds_read_b64_tr_b16 v[200:201], v8 offset:0
    ds_read_b64_tr_b16 v[202:203], v8 offset:576
    ds_read_b64_tr_b16 v[204:205], v8 offset:32
    ds_read_b64_tr_b16 v[206:207], v8 offset:608
    ds_read_b64_tr_b16 v[208:209], v8 offset:64
    ds_read_b64_tr_b16 v[210:211], v8 offset:640
    ds_read_b64_tr_b16 v[212:213], v8 offset:96
    ds_read_b64_tr_b16 v[214:215], v8 offset:672
    s_waitcnt vmcnt(32)
    ds_write_b128 v5, v[48:51] offset:4608
    ds_write_b128 v5, v[52:55] offset:5760
    ds_write_b128 v5, v[56:59] offset:6912
    ds_write_b128 v5, v[60:63] offset:8064
    s_waitcnt lgkmcnt(4)
    buffer_store_dwordx4 v[200:203], v9, s[28:31], s44 offen sc1
    s_add_u32 s44, s44, s48
    v_dot2_f32_bf16 v12, v200, v16, v12
    v_dot2_f32_bf16 v12, v201, v16, v12
    v_dot2_f32_bf16 v12, v202, v16, v12
    v_dot2_f32_bf16 v12, v203, v16, v12
    buffer_store_dwordx4 v[204:207], v9, s[28:31], s45 offen sc1
    s_add_u32 s45, s45, s49
    v_dot2_f32_bf16 v13, v204, v16, v13
    v_dot2_f32_bf16 v13, v205, v16, v13
    v_dot2_f32_bf16 v13, v206, v16, v13
    v_dot2_f32_bf16 v13, v207, v16, v13
    buffer_store_dwordx4 v[208:211], v9, s[28:31], s46 offen sc1
    s_add_u32 s46, s46, s50
    v_dot2_f32_bf16 v14, v208, v16, v14
    v_dot2_f32_bf16 v14, v209, v16, v14
    v_dot2_f32_bf16 v14, v210, v16, v14
    v_dot2_f32_bf16 v14, v211, v16, v14
    buffer_store_dwordx4 v[212:215], v9, s[28:31], s47 offen sc1
    s_add_u32 s47, s47, s51
    v_dot2_f32_bf16 v15, v212, v16, v15
    v_dot2_f32_bf16 v15, v213, v16, v15
    v_dot2_f32_bf16 v15, v214, v16, v15
    v_dot2_f32_bf16 v15, v215, v16, v15
    s_waitcnt lgkmcnt(0)
    ds_read_b64_tr_b16 v[216:217], v8 offset:4608
    ds_read_b64_tr_b16 v[218:219], v8 offset:5184
    ds_read_b64_tr_b16 v[220:221], v8 offset:4640
    ds_read_b64_tr_b16 v[222:223], v8 offset:5216
    ds_read_b64_tr_b16 v[224:225], v8 offset:4672
    ds_read_b64_tr_b16 v[226:227], v8 offset:5248
    ds_read_b64_tr_b16 v[228:229], v8 offset:4704
    ds_read_b64_tr_b16 v[230:231], v8 offset:5280
    s_waitcnt vmcnt(32)
    ds_write_b128 v5, v[64:67] offset:0
    ds_write_b128 v5, v[68:71] offset:1152
    ds_write_b128 v5, v[72:75] offset:2304
    ds_write_b128 v5, v[76:79] offset:3456
    s_waitcnt lgkmcnt(4)
    buffer_store_dwordx4 v[216:219], v9, s[28:31], s44 offen sc1
    s_add_u32 s44, s44, s48
    v_dot2_f32_bf16 v12, v216, v16, v12
    v_dot2_f32_bf16 v12, v217, v16, v12
    v_dot2_f32_bf16 v12, v218, v16, v12
    v_dot2_f32_bf16 v12, v219, v16, v12
    buffer_store_dwordx4 v[220:223], v9, s[28:31], s45 offen sc1
    s_add_u32 s45, s45, s49
    v_dot2_f32_bf16 v13, v220, v16, v13
    v_dot2_f32_bf16 v13, v221, v16, v13
    v_dot2_f32_bf16 v13, v222, v16, v13
    v_dot2_f32_bf16 v13, v223, v16, v13
    buffer_store_dwordx4 v[224:227], v9, s[28:31], s46 offen sc1
    s_add_u32 s46, s46, s50
    v_dot2_f32_bf16 v14, v224, v16, v14
    v_dot2_f32_bf16 v14, v225, v16, v14
    v_dot2_f32_bf16 v14, v226, v16, v14
    v_dot2_f32_bf16 v14, v227, v16, v14
    buffer_store_dwordx4 v[228:231], v9, s[28:31], s47 offen sc1
    s_add_u32 s47, s47, s51
    v_dot2_f32_bf16 v15, v228, v16, v15
    v_dot2_f32_bf16 v15, v229, v16, v15
    v_dot2_f32_bf16 v15, v230, v16, v15
    v_dot2_f32_bf16 v15, v231, v16, v15
    s_waitcnt lgkmcnt(0)
    ds_read_b64_tr_b16 v[200:201], v8 offset:0
    ds_read_b64_tr_b16 v[202:203], v8 offset:576
    ds_read_b64_tr_b16 v[204:205], v8 offset:32
    ds_read_b64_tr_b16 v[206:207], v8 offset:608
    ds_read_b64_tr_b16 v[208:209], v8 offset:64
    ds_read_b64_tr_b16 v[210:211], v8 offset:640
    ds_read_b64_tr_b16 v[212:213], v8 offset:96
    ds_read_b64_tr_b16 v[214:215], v8 offset:672
    s_waitcnt vmcnt(32)
    ds_write_b128 v5, v[80:83] offset:4608
    ds_write_b128 v5, v[84:87] offset:5760
    ds_write_b128 v5, v[88:91] offset:6912
    ds_write_b128 v5, v[92:95] offset:8064
    s_waitcnt lgkmcnt(4)
    buffer_store_dwordx4 v[200:203], v9, s[28:31], s44 offen sc1
    s_add_u32 s44, s44, s48
    v_dot2_f32_bf16 v12, v200, v16, v12
    v_dot2_f32_bf16 v12, v201, v16, v12
    v_dot2_f32_bf16 v12, v202, v16, v12
    v_dot2_f32_bf16 v12, v203, v16, v12
    buffer_store_dwordx4 v[204:207], v9, s[28:31], s45 offen sc1
    s_add_u32 s45, s45, s49
    v_dot2_f32_bf16 v13, v204, v16, v13
    v_dot2_f32_bf16 v13, v205, v16, v13
    v_dot2_f32_bf16 v13, v206, v16, v13
    v_dot2_f32_bf16 v13, v207, v16, v13
    buffer_store_dwordx4 v[208:211], v9, s[28:31], s46 offen sc1
    s_add_u32 s46, s46, s50
    v_dot2_f32_bf16 v14, v208, v16, v14
    v_dot2_f32_bf16 v14, v209, v16, v14
    v_dot2_f32_bf16 v14, v210, v16, v14
    v_dot2_f32_bf16 v14, v211, v16, v14
    buffer_store_dwordx4 v[212:215], v9, s[28:31], s47 offen sc1
    s_add_u32 s47, s47, s51
    v_dot2_f32_bf16 v15, v212, v16, v15
    v_dot2_f32_bf16 v15, v213, v16, v15
    v_dot2_f32_bf16 v15, v214, v16, v15
    v_dot2_f32_bf16 v15, v215, v16, v15
    s_waitcnt lgkmcnt(0)
    ds_read_b64_tr_b16 v[216:217], v8 offset:4608
    ds_read_b64_tr_b16 v[218:219], v8 offset:5184
    ds_read_b64_tr_b16 v[220:221], v8 offset:4640
    ds_read_b64_tr_b16 v[222:223], v8 offset:5216
    ds_read_b64_tr_b16 v[224:225], v8 offset:4672
    ds_read_b64_tr_b16 v[226:227], v8 offset:5248
    ds_read_b64_tr_b16 v[228:229], v8 offset:4704
    ds_read_b64_tr_b16 v[230:231], v8 offset:5280
    s_waitcnt vmcnt(32)
    ds_write_b128 v5, v[96:99] offset:0
    ds_write_b128 v5, v[100:103] offset:1152
    ds_write_b128 v5, v[104:107] offset:2304
    ds_write_b128 v5, v[108:111] offset:3456
    s_waitcnt lgkmcnt(4)
    buffer_store_dwordx4 v[216:219], v9, s[28:31], s44 offen sc1
    s_add_u32 s44, s44, s48
    v_dot2_f32_bf16 v12, v216, v16, v12
    v_dot2_f32_bf16 v12, v217, v16, v12
    v_dot2_f32_bf16 v12, v218, v16, v12
    v_dot2_f32_bf16 v12, v219, v16, v12
    buffer_store_dwordx4 v[220:223], v9, s[28:31], s45 offen sc1
    s_add_u32 s45, s45, s49
    v_dot2_f32_bf16 v13, v220, v16, v13
    v_dot2_f32_bf16 v13, v221, v16, v13
    v_dot2_f32_bf16 v13, v222, v16, v13
    v_dot2_f32_bf16 v13, v223, v16, v13
    buffer_store_dwordx4 v[224:227], v9, s[28:31], s46 offen sc1
    s_add_u32 s46, s46, s50
    v_dot2_f32_bf16 v14, v224, v16, v14
    v_dot2_f32_bf16 v14, v225, v16, v14
    v_dot2_f32_bf16 v14, v226, v16, v14
    v_dot2_f32_bf16 v14, v227, v16, v14
    buffer_store_dwordx4 v[228:231], v9, s[28:31], s47 offen sc1
    s_add_u32 s47, s47, s51
    v_dot2_f32_bf16 v15, v228, v16, v15
    v_dot2_f32_bf16 v15, v229, v16, v15
    v_dot2_f32_bf16 v15, v230, v16, v15
    v_dot2_f32_bf16 v15, v231, v16, v15
    s_waitcnt lgkmcnt(0)
    ds_read_b64_tr_b16 v[200:201], v8 offset:0
    ds_read_b64_tr_b16 v[202:203], v8 offset:576
    ds_read_b64_tr_b16 v[204:205], v8 offset:32
    ds_read_b64_tr_b16 v[206:207], v8 offset:608
    ds_read_b64_tr_b16 v[208:209], v8 offset:64
    ds_read_b64_tr_b16 v[210:211], v8 offset:640
    ds_read_b64_tr_b16 v[212:213], v8 offset:96
    ds_read_b64_tr_b16 v[214:215], v8 offset:672
    s_waitcnt vmcnt(32)
    ds_write_b128 v5, v[112:115] offset:4608
    ds_write_b128 v5, v[116:119] offset:5760
    ds_write_b128 v5, v[120:123] offset:6912
    ds_write_b128 v5, v[124:127] offset:8064
    s_waitcnt lgkmcnt(4)
    buffer_store_dwordx4 v[200:203], v9, s[28:31], s44 offen sc1
    s_add_u32 s44, s44, s48
    v_dot2_f32_bf16 v12, v200, v16, v12
    v_dot2_f32_bf16 v12, v201, v16, v12
    v_dot2_f32_bf16 v12, v202, v16, v12
    v_dot2_f32_bf16 v12, v203, v16, v12
    buffer_store_dwordx4 v[204:207], v9, s[28:31], s45 offen sc1
    s_add_u32 s45, s45, s49
    v_dot2_f32_bf16 v13, v204, v16, v13
    v_dot2_f32_bf16 v13, v205, v16, v13
    v_dot2_f32_bf16 v13, v206, v16, v13
    v_dot2_f32_bf16 v13, v207, v16, v13
    buffer_store_dwordx4 v[208:211], v9, s[28:31], s46 offen sc1
    s_add_u32 s46, s46, s50
    v_dot2_f32_bf16 v14, v208, v16, v14
    v_dot2_f32_bf16 v14, v209, v16, v14
    v_dot2_f32_bf16 v14, v210, v16, v14
    v_dot2_f32_bf16 v14, v211, v16, v14
    buffer_store_dwordx4 v[212:215], v9, s[28:31], s47 offen sc1
    s_add_u32 s47, s47, s51
    v_dot2_f32_bf16 v15, v212, v16, v15
    v_dot2_f32_bf16 v15, v213, v16, v15
    v_dot2_f32_bf16 v15, v214, v16, v15
    v_dot2_f32_bf16 v15, v215, v16, v15
    s_waitcnt lgkmcnt(0)
    ds_read_b64_tr_b16 v[216:217], v8 offset:4608
    ds_read_b64_tr_b16 v[218:219], v8 offset:5184
    ds_read_b64_tr_b16 v[220:221], v8 offset:4640
    ds_read_b64_tr_b16 v[222:223], v8 offset:5216
    ds_read_b64_tr_b16 v[224:225], v8 offset:4672
    ds_read_b64_tr_b16 v[226:227], v8 offset:5248
    ds_read_b64_tr_b16 v[228:229], v8 offset:4704
    ds_read_b64_tr_b16 v[230:231], v8 offset:5280
    s_waitcnt vmcnt(32)
    ds_write_b128 v5, v[128:131] offset:0
    ds_write_b128 v5, v[132:135] offset:1152
    ds_write_b128 v5, v[136:139] offset:2304
    ds_write_b128 v5, v[140:143] offset:3456
    s_waitcnt lgkmcnt(4)
    buffer_store_dwordx4 v[216:219], v9, s[28:31], s44 offen sc1
    s_add_u32 s44, s44, s48
    v_dot2_f32_bf16 v12, v216, v16, v12
    v_dot2_f32_bf16 v12, v217, v16, v12
    v_dot2_f32_bf16 v12, v218, v16, v12
    v_dot2_f32_bf16 v12, v219, v16, v12
    buffer_store_dwordx4 v[220:223], v9, s[28:31], s45 offen sc1
    s_add_u32 s45, s45, s49
    v_dot2_f32_bf16 v13, v220, v16, v13
    v_dot2_f32_bf16 v13, v221, v16, v13
    v_dot2_f32_bf16 v13, v222, v16, v13
    v_dot2_f32_bf16 v13, v223, v16, v13
    buffer_store_dwordx4 v[224:227], v9, s[28:31], s46 offen sc1
    s_add_u32 s46, s46, s50
    v_dot2_f32_bf16 v14, v224, v16, v14
    v_dot2_f32_bf16 v14, v225, v16, v14
    v_dot2_f32_bf16 v14, v226, v16, v14
    v_dot2_f32_bf16 v14, v227, v16, v14
    buffer_store_dwordx4 v[228:231], v9, s[28:31], s47 offen sc1
    s_add_u32 s47, s47, s51
    v_dot2_f32_bf16 v15, v228, v16, v15
    v_dot2_f32_bf16 v15, v229, v16, v15
    v_dot2_f32_bf16 v15, v230, v16, v15
    v_dot2_f32_bf16 v15, v231, v16, v15
    s_waitcnt lgkmcnt(0)
    ds_read_b64_tr_b16 v[200:201], v8 offset:0
    ds_read_b64_tr_b16 v[202:203], v8 offset:576
    ds_read_b64_tr_b16 v[204:205], v8 offset:32
    ds_read_b64_tr_b16 v[206:207], v8 offset:608
    ds_read_b64_tr_b16 v[208:209], v8 offset:64
    ds_read_b64_tr_b16 v[210:211], v8 offset:640
    ds_read_b64_tr_b16 v[212:213], v8 offset:96
    ds_read_b64_tr_b16 v[214:215], v8 offset:672
    s_waitcnt vmcnt(32)
    ds_write_b128 v5, v[144:147] offset:4608
    ds_write_b128 v5, v[148:151] offset:5760
    ds_write_b128 v5, v[152:155] offset:6912
    ds_write_b128 v5, v[156:159] offset:8064
    s_waitcnt lgkmcnt(4)
    buffer_store_dwordx4 v[200:203], v9, s[28:31], s44 offen sc1
    s_add_u32 s44, s44, s48
    v_dot2_f32_bf16 v12, v200, v16, v12
    v_dot2_f32_bf16 v12, v201, v16, v12
    v_dot2_f32_bf16 v12, v202, v16, v12
    v_dot2_f32_bf16 v12, v203, v16, v12
    buffer_store_dwordx4 v[204:207], v9, s[28:31], s45 offen sc1
    s_add_u32 s45, s45, s49
    v_dot2_f32_bf16 v13, v204, v16, v13
    v_dot2_f32_bf16 v13, v205, v16, v13
    v_dot2_f32_bf16 v13, v206, v16, v13
    v_dot2_f32_bf16 v13, v207, v16, v13
    buffer_store_dwordx4 v[208:211], v9, s[28:31], s46 offen sc1
    s_add_u32 s46, s46, s50
    v_dot2_f32_bf16 v14, v208, v16, v14
    v_dot2_f32_bf16 v14, v209, v16, v14
    v_dot2_f32_bf16 v14, v210, v16, v14
    v_dot2_f32_bf16 v14, v211, v16, v14
    buffer_store_dwordx4 v[212:215], v9, s[28:31], s47 offen sc1
    s_add_u32 s47, s47, s51
    v_dot2_f32_bf16 v15, v212, v16, v15
    v_dot2_f32_bf16 v15, v213, v16, v15
    v_dot2_f32_bf16 v15, v214, v16, v15
    v_dot2_f32_bf16 v15, v215, v16, v15
    s_waitcnt lgkmcnt(0)
    ds_read_b64_tr_b16 v[216:217], v8 offset:4608
    ds_read_b64_tr_b16 v[218:219], v8 offset:5184
    ds_read_b64_tr_b16 v[220:221], v8 offset:4640
    ds_read_b64_tr_b16 v[222:223], v8 offset:5216
    ds_read_b64_tr_b16 v[224:225], v8 offset:4672
    ds_read_b64_tr_b16 v[226:227], v8 offset:5248
    ds_read_b64_tr_b16 v[228:229], v8 offset:4704
    ds_read_b64_tr_b16 v[230:231], v8 offset:5280
    s_waitcnt vmcnt(32)
    ds_write_b128 v5, v[160:163] offset:0
    ds_write_b128 v5, v[164:167] offset:1152
    ds_write_b128 v5, v[168:171] offset:2304
    ds_write_b128 v5, v[172:175] offset:3456
    s_waitcnt lgkmcnt(4)
    buffer_store_dwordx4 v[216:219], v9, s[28:31], s44 offen sc1
    s_add_u32 s44, s44, s48
    v_dot2_f32_bf16 v12, v216, v16, v12
    v_dot2_f32_bf16 v12, v217, v16, v12
    v_dot2_f32_bf16 v12, v218, v16, v12
    v_dot2_f32_bf16 v12, v219, v16, v12
    buffer_store_dwordx4 v[220:223], v9, s[28:31], s45 offen sc1
    s_add_u32 s45, s45, s49
    v_dot2_f32_bf16 v13, v220, v16, v13
    v_dot2_f32_bf16 v13, v221, v16, v13
    v_dot2_f32_bf16 v13, v222, v16, v13
    v_dot2_f32_bf16 v13, v223, v16, v13
    buffer_store_dwordx4 v[224:227], v9, s[28:31], s46 offen sc1
    s_add_u32 s46, s46, s50
    v_dot2_f32_bf16 v14, v224, v16, v14
    v_dot2_f32_bf16 v14, v225, v16, v14
    v_dot2_f32_bf16 v14, v226, v16, v14
    v_dot2_f32_bf16 v14, v227, v16, v14
    buffer_store_dwordx4 v[228:231], v9, s[28:31], s47 offen sc1
    s_add_u32 s47, s47, s51
    v_dot2_f32_bf16 v15, v228, v16, v15
    v_dot2_f32_bf16 v15, v229, v16, v15
    v_dot2_f32_bf16 v15, v230, v16, v15
    v_dot2_f32_bf16 v15, v231, v16, v15
    s_waitcnt lgkmcnt(0)
    ds_read_b64_tr_b16 v[200:201], v8 offset:0
    ds_read_b64_tr_b16 v[202:203], v8 offset:576
    ds_read_b64_tr_b16 v[204:205], v8 offset:32
    ds_read_b64_tr_b16 v[206:207], v8 offset:608
    ds_read_b64_tr_b16 v[208:209], v8 offset:64
    ds_read_b64_tr_b16 v[210:211], v8 offset:640
    ds_read_b64_tr_b16 v[212:213], v8 offset:96
    ds_read_b64_tr_b16 v[214:215], v8 offset:672
    s_waitcnt vmcnt(32)
    ds_write_b128 v5, v[176:179] offset:4608
    ds_write_b128 v5, v[180:183] offset:5760
    ds_write_b128 v5, v[184:187] offset:6912
    ds_write_b128 v5, v[188:191] offset:8064
    s_waitcnt lgkmcnt(4)
    buffer_store_dwordx4 v[200:203], v9, s[28:31], s44 offen sc1
    s_add_u32 s44, s44, s48
    v_dot2_f32_bf16 v12, v200, v16, v12
    v_dot2_f32_bf16 v12, v201, v16, v12
    v_dot2_f32_bf16 v12, v202, v16, v12
    v_dot2_f32_bf16 v12, v203, v16, v12
    buffer_store_dwordx4 v[204:207], v9, s[28:31], s45 offen sc1
    s_add_u32 s45, s45, s49
    v_dot2_f32_bf16 v13, v204, v16, v13
    v_dot2_f32_bf16 v13, v205, v16, v13
    v_dot2_f32_bf16 v13, v206, v16, v13
    v_dot2_f32_bf16 v13, v207, v16, v13
    buffer_store_dwordx4 v[208:211], v9, s[28:31], s46 offen sc1
    s_add_u32 s46, s46, s50
    v_dot2_f32_bf16 v14, v208, v16, v14
    v_dot2_f32_bf16 v14, v209, v16, v14
    v_dot2_f32_bf16 v14, v210, v16, v14
    v_dot2_f32_bf16 v14, v211, v16, v14
    buffer_store_dwordx4 v[212:215], v9, s[28:31], s47 offen sc1
    s_add_u32 s47, s47, s51
    v_dot2_f32_bf16 v15, v212, v16, v15
    v_dot2_f32_bf16 v15, v213, v16, v15
    v_dot2_f32_bf16 v15, v214, v16, v15
    v_dot2_f32_bf16 v15, v215, v16, v15
    s_waitcnt lgkmcnt(0)
    ds_read_b64_tr_b16 v[216:217], v8 offset:4608
    ds_read_b64_tr_b16 v[218:219], v8 offset:5184
    ds_read_b64_tr_b16 v[220:221], v8 offset:4640
    ds_read_b64_tr_b16 v[222:223], v8 offset:5216
    ds_read_b64_tr_b16 v[224:225], v8 offset:4672
    ds_read_b64_tr_b16 v[226:227], v8 offset:5248
    ds_read_b64_tr_b16 v[228:229], v8 offset:4704
    ds_read_b64_tr_b16 v[230:231], v8 offset:5280
    s_waitcnt lgkmcnt(0)
    buffer_store_dwordx4 v[216:219], v9, s[28:31], s44 offen sc1
    s_add_u32 s44, s44, s48
    v_dot2_f32_bf16 v12, v216, v16, v12
    v_dot2_f32_bf16 v12, v217, v16, v12
    v_dot2_f32_bf16 v12, v218, v16, v12
    v_dot2_f32_bf16 v12, v219, v16, v12
    buffer_store_dwordx4 v[220:223], v9, s[28:31], s45 offen sc1
    s_add_u32 s45, s45, s49
    v_dot2_f32_bf16 v13, v220, v16, v13
    v_dot2_f32_bf16 v13, v221, v16, v13
    v_dot2_f32_bf16 v13, v222, v16, v13
    v_dot2_f32_bf16 v13, v223, v16, v13
    buffer_store_dwordx4 v[224:227], v9, s[28:31], s46 offen sc1
    s_add_u32 s46, s46, s50
    v_dot2_f32_bf16 v14, v224, v16, v14
    v_dot2_f32_bf16 v14, v225, v16, v14
    v_dot2_f32_bf16 v14, v226, v16, v14
    v_dot2_f32_bf16 v14, v227, v16, v14
    buffer_store_dwordx4 v[228:231], v9, s[28:31], s47 offen sc1
    s_add_u32 s47, s47, s51
    v_dot2_f32_bf16 v15, v228, v16, v15
    v_dot2_f32_bf16 v15, v229, v16, v15
    v_dot2_f32_bf16 v15, v230, v16, v15
    v_dot2_f32_bf16 v15, v231, v16, v15
    s_nop 2
    v_mov_b32 v20, v12
    v_mov_b32 v21, v13
    v_mov_b32 v22, v14
    v_mov_b32 v23, v15
    s_nop 1
    v_permlane32_swap_b32 v20, v12
    v_permlane32_swap_b32 v21, v13
    v_permlane32_swap_b32 v22, v14
    v_permlane32_swap_b32 v23, v15
    s_nop 1
    v_add_f32 v12, v12, v20
    v_add_f32 v13, v13, v21
    v_add_f32 v14, v14, v22
    v_add_f32 v15, v15, v23
    v_mov_b32 v20, v12
    v_mov_b32 v21, v13
    v_mov_b32 v22, v14
    v_mov_b32 v23, v15
    s_nop 1
    v_permlane16_swap_b32 v20, v12
    v_permlane16_swap_b32 v21, v13
    v_permlane16_swap_b32 v22, v14
    v_permlane16_swap_b32 v23, v15
    s_nop 1
    v_add_f32 v12, v12, v20
    v_add_f32 v13, v13, v21
    v_add_f32 v14, v14, v22
    v_add_f32 v15, v15, v23
    s_mul_i32 s38, s33, 7168
    s_lshl_b32 s39, s35, 8
    s_add_u32 s38, s38, s39
    s_add_u32 s38, s38, 8146944
    v_lshlrev_b32 v17, 2, v1
    s_mov_b64 exec, 0xffff
    buffer_store_dword v12, v17, s[28:31], s38 offen offset:0 sc1
    buffer_store_dword v13, v17, s[28:31], s38 offen offset:64 sc1
    buffer_store_dword v14, v17, s[28:31], s38 offen offset:128 sc1
    buffer_store_dword v15, v17, s[28:31], s38 offen offset:192 sc1
    s_endpgm
prep_kernel_pk28:
    s_mov_b32 s24, s14
    s_mov_b32 s25, s15
    s_mov_b32 s26, 819200
    s_mov_b32 s27, 0x00020000
    s_sub_u32 s32, s21, 20
    s_mul_i32 s33, s32, 52429
    s_lshr_b32 s33, s33, 19
    s_mul_i32 s35, s33, 10
    s_sub_u32 s35, s32, s35
    v_mul_u32_u24 v10, 1280, v3
    v_lshl_add_u32 v10, v4, 4, v10
    s_mul_i32 s36, s33, 409600
    s_lshl_b32 s37, s35, 7
    s_add_u32 s36, s36, s37
    buffer_load_dwordx4 v[32:35], v10, s[24:27], s36 offen nt
    s_add_u32 s36, s36, 10240
    buffer_load_dwordx4 v[36:39], v10, s[24:27], s36 offen nt
    s_add_u32 s36, s36, 10240
    buffer_load_dwordx4 v[40:43], v10, s[24:27], s36 offen nt
    s_add_u32 s36, s36, 10240
    buffer_load_dwordx4 v[44:47], v10, s[24:27], s36 offen nt
    s_add_u32 s36, s36, 10240
    buffer_load_dwordx4 v[48:51], v10, s[24:27], s36 offen nt
    s_add_u32 s36, s36, 10240
    buffer_load_dwordx4 v[52:55], v10, s[24:27], s36 offen nt
    s_add_u32 s36, s36, 10240
    buffer_load_dwordx4 v[56:59], v10, s[24:27], s36 offen nt
    s_add_u32 s36, s36, 10240
    buffer_load_dwordx4 v[60:63], v10, s[24:27], s36 offen nt
    s_add_u32 s36, s36, 10240
    buffer_load_dwordx4 v[64:67], v10, s[24:27], s36 offen nt
    s_add_u32 s36, s36, 10240
    buffer_load_dwordx4 v[68:71], v10, s[24:27], s36 offen nt
    s_add_u32 s36, s36, 10240
    buffer_load_dwordx4 v[72:75], v10, s[24:27], s36 offen nt
    s_add_u32 s36, s36, 10240
    buffer_load_dwordx4 v[76:79], v10, s[24:27], s36 offen nt
    s_add_u32 s36, s36, 10240
    buffer_load_dwordx4 v[80:83], v10, s[24:27], s36 offen nt
    s_add_u32 s36, s36, 10240
    buffer_load_dwordx4 v[84:87], v10, s[24:27], s36 offen nt
    s_add_u32 s36, s36, 10240
    buffer_load_dwordx4 v[88:91], v10, s[24:27], s36 offen nt
    s_add_u32 s36, s36, 10240
    buffer_load_dwordx4 v[92:95], v10, s[24:27], s36 offen nt
    s_add_u32 s36, s36, 10240
    buffer_load_dwordx4 v[96:99], v10, s[24:27], s36 offen nt
    s_add_u32 s36, s36, 10240
    buffer_load_dwordx4 v[100:103], v10, s[24:27], s36 offen nt
    s_add_u32 s36, s36, 10240
    buffer_load_dwordx4 v[104:107], v10, s[24:27], s36 offen nt
    s_add_u32 s36, s36, 10240
    buffer_load_dwordx4 v[108:111], v10, s[24:27], s36 offen nt
    s_add_u32 s36, s36, 10240
    buffer_load_dwordx4 v[112:115], v10, s[24:27], s36 offen nt
    s_add_u32 s36, s36, 10240
    buffer_load_dwordx4 v[116:119], v10, s[24:27], s36 offen nt
    s_add_u32 s36, s36, 10240
    buffer_load_dwordx4 v[120:123], v10, s[24:27], s36 offen nt
    s_add_u32 s36, s36, 10240
    buffer_load_dwordx4 v[124:127], v10, s[24:27], s36 offen nt
    s_add_u32 s36, s36, 10240
    buffer_load_dwordx4 v[128:131], v10, s[24:27], s36 offen nt
    s_add_u32 s36, s36, 10240
    buffer_load_dwordx4 v[132:135], v10, s[24:27], s36 offen nt
    s_add_u32 s36, s36, 10240
    buffer_load_dwordx4 v[136:139], v10, s[24:27], s36 offen nt
    s_add_u32 s36, s36, 10240
    buffer_load_dwordx4 v[140:143], v10, s[24:27], s36 offen nt
    s_add_u32 s36, s36, 10240
    buffer_load_dwordx4 v[144:147], v10, s[24:27], s36 offen nt
    s_add_u32 s36, s36, 10240
    buffer_load_dwordx4 v[148:151], v10, s[24:27], s36 offen nt
    s_add_u32 s36, s36, 10240
    buffer_load_dwordx4 v[152:155], v10, s[24:27], s36 offen nt
    s_add_u32 s36, s36, 10240
    buffer_load_dwordx4 v[156:159], v10, s[24:27], s36 offen nt
    s_add_u32 s36, s36, 10240
    buffer_load_dwordx4 v[160:163], v10, s[24:27], s36 offen nt
    s_add_u32 s36, s36, 10240
    buffer_load_dwordx4 v[164:167], v10, s[24:27], s36 offen nt
    s_add_u32 s36, s36, 10240
    buffer_load_dwordx4 v[168:171], v10, s[24:27], s36 offen nt
    s_add_u32 s36, s36, 10240
    buffer_load_dwordx4 v[172:175], v10, s[24:27], s36 offen nt
    s_add_u32 s36, s36, 10240
    buffer_load_dwordx4 v[176:179], v10, s[24:27], s36 offen nt
    s_add_u32 s36, s36, 10240
    buffer_load_dwordx4 v[180:183], v10, s[24:27], s36 offen nt
    s_add_u32 s36, s36, 10240
    buffer_load_dwordx4 v[184:187], v10, s[24:27], s36 offen nt
    s_add_u32 s36, s36, 10240
    buffer_load_dwordx4 v[188:191], v10, s[24:27], s36 offen nt
    s_lshl_b32 s36, s35, 2
    s_add_u32 s36, s36, 0
    s_mul_i32 s38, s36, 6554
    s_lshr_b32 s38, s38, 16
    s_mul_i32 s39, s38, 10
    s_sub_u32 s39, s36, s39
    s_cmp_ge_u32 s39, 5
    s_cselect_b32 s40, 1, 0
    s_sub_u32 s41, s39, 6
    s_cmp_eq_u32 s39, 5
    s_cselect_b32 s41, 4, s41
    s_cmp_eq_u32 s40, 1
    s_cselect_b32 s39, s41, s39
    s_mul_i32 s37, s38, 200
    s_mul_i32 s40, s40, 100
    s_add_u32 s37, s37, s40
    s_mul_i32 s40, s33, 50
    s_add_u32 s37, s37, s40
    s_add_u32 s37, s37, s39
    s_lshl_b32 s37, s37, 10
    s_add_u32 s44, s37, 24055808
    s_movk_i32 s48, 5120
    s_lshl_b32 s36, s35, 2
    s_add_u32 s36, s36, 1
    s_mul_i32 s38, s36, 6554
    s_lshr_b32 s38, s38, 16
    s_mul_i32 s39, s38, 10
    s_sub_u32 s39, s36, s39
    s_cmp_ge_u32 s39, 5
    s_cselect_b32 s40, 1, 0
    s_sub_u32 s41, s39, 6
    s_cmp_eq_u32 s39, 5
    s_cselect_b32 s41, 4, s41
    s_cmp_eq_u32 s40, 1
    s_cselect_b32 s39, s41, s39
    s_mul_i32 s37, s38, 200
    s_mul_i32 s40, s40, 100
    s_add_u32 s37, s37, s40
    s_mul_i32 s40, s33, 50
    s_add_u32 s37, s37, s40
    s_add_u32 s37, s37, s39
    s_lshl_b32 s37, s37, 10
    s_add_u32 s45, s37, 24055808
    s_movk_i32 s49, 5120
    s_lshl_b32 s36, s35, 2
    s_add_u32 s36, s36, 2
    s_mul_i32 s38, s36, 6554
    s_lshr_b32 s38, s38, 16
    s_mul_i32 s39, s38, 10
    s_sub_u32 s39, s36, s39
    s_cmp_ge_u32 s39, 5
    s_cselect_b32 s40, 1, 0
    s_sub_u32 s41, s39, 6
    s_cmp_eq_u32 s39, 5
    s_cselect_b32 s41, 4, s41
    s_cmp_eq_u32 s40, 1
    s_cselect_b32 s39, s41, s39
    s_mul_i32 s37, s38, 200
    s_mul_i32 s40, s40, 100
    s_add_u32 s37, s37, s40
    s_mul_i32 s40, s33, 50
    s_add_u32 s37, s37, s40
    s_add_u32 s37, s37, s39
    s_lshl_b32 s37, s37, 10
    s_add_u32 s46, s37, 24055808
    s_movk_i32 s50, 5120
    s_lshl_b32 s36, s35, 2
    s_add_u32 s36, s36, 3
    s_mul_i32 s38, s36, 6554
    s_lshr_b32 s38, s38, 16
    s_mul_i32 s39, s38, 10
    s_sub_u32 s39, s36, s39
    s_cmp_ge_u32 s39, 5
    s_cselect_b32 s40, 1, 0
    s_sub_u32 s41, s39, 6
    s_cmp_eq_u32 s39, 5
    s_cselect_b32 s41, 4, s41
    s_cmp_eq_u32 s40, 1
    s_cselect_b32 s39, s41, s39
    s_mul_i32 s37, s38, 200
    s_mul_i32 s40, s40, 100
    s_add_u32 s37, s37, s40
    s_mul_i32 s40, s33, 50
    s_add_u32 s37, s37, s40
    s_add_u32 s37, s37, s39
    s_lshl_b32 s37, s37, 10
    s_add_u32 s47, s37, 24055808
    s_movk_i32 s51, 5120
    s_waitcnt vmcnt(36)
    ds_write_b128 v5, v[32:35] offset:0
    ds_write_b128 v5, v[36:39] offset:1152
    ds_write_b128 v5, v[40:43] offset:2304
    ds_write_b128 v5, v[44:47] offset:3456
    s_waitcnt lgkmcnt(0)
    ds_read_b64_tr_b16 v[200:201], v8 offset:0
    ds_read_b64_tr_b16 v[202:203], v8 offset:576
    ds_read_b64_tr_b16 v[204:205], v8 offset:32
    ds_read_b64_tr_b16 v[206:207], v8 offset:608
    ds_read_b64_tr_b16 v[208:209], v8 offset:64
    ds_read_b64_tr_b16 v[210:211], v8 offset:640
    ds_read_b64_tr_b16 v[212:213], v8 offset:96
    ds_read_b64_tr_b16 v[214:215], v8 offset:672
    s_waitcnt vmcnt(32)
    ds_write_b128 v5, v[48:51] offset:4608
    ds_write_b128 v5, v[52:55] offset:5760
    ds_write_b128 v5, v[56:59] offset:6912
    ds_write_b128 v5, v[60:63] offset:8064
    s_waitcnt lgkmcnt(4)
    buffer_store_dwordx4 v[200:203], v9, s[28:31], s44 offen sc1
    s_add_u32 s44, s44, s48
    buffer_store_dwordx4 v[204:207], v9, s[28:31], s45 offen sc1
    s_add_u32 s45, s45, s49
    buffer_store_dwordx4 v[208:211], v9, s[28:31], s46 offen sc1
    s_add_u32 s46, s46, s50
    buffer_store_dwordx4 v[212:215], v9, s[28:31], s47 offen sc1
    s_add_u32 s47, s47, s51
    s_waitcnt lgkmcnt(0)
    ds_read_b64_tr_b16 v[216:217], v8 offset:4608
    ds_read_b64_tr_b16 v[218:219], v8 offset:5184
    ds_read_b64_tr_b16 v[220:221], v8 offset:4640
    ds_read_b64_tr_b16 v[222:223], v8 offset:5216
    ds_read_b64_tr_b16 v[224:225], v8 offset:4672
    ds_read_b64_tr_b16 v[226:227], v8 offset:5248
    ds_read_b64_tr_b16 v[228:229], v8 offset:4704
    ds_read_b64_tr_b16 v[230:231], v8 offset:5280
    s_waitcnt vmcnt(32)
    ds_write_b128 v5, v[64:67] offset:0
    ds_write_b128 v5, v[68:71] offset:1152
    ds_write_b128 v5, v[72:75] offset:2304
    ds_write_b128 v5, v[76:79] offset:3456
    s_waitcnt lgkmcnt(4)
    buffer_store_dwordx4 v[216:219], v9, s[28:31], s44 offen sc1
    s_add_u32 s44, s44, s48
    buffer_store_dwordx4 v[220:223], v9, s[28:31], s45 offen sc1
    s_add_u32 s45, s45, s49
    buffer_store_dwordx4 v[224:227], v9, s[28:31], s46 offen sc1
    s_add_u32 s46, s46, s50
    buffer_store_dwordx4 v[228:231], v9, s[28:31], s47 offen sc1
    s_add_u32 s47, s47, s51
    s_waitcnt lgkmcnt(0)
    ds_read_b64_tr_b16 v[200:201], v8 offset:0
    ds_read_b64_tr_b16 v[202:203], v8 offset:576
    ds_read_b64_tr_b16 v[204:205], v8 offset:32
    ds_read_b64_tr_b16 v[206:207], v8 offset:608
    ds_read_b64_tr_b16 v[208:209], v8 offset:64
    ds_read_b64_tr_b16 v[210:211], v8 offset:640
    ds_read_b64_tr_b16 v[212:213], v8 offset:96
    ds_read_b64_tr_b16 v[214:215], v8 offset:672
    s_waitcnt vmcnt(32)
    ds_write_b128 v5, v[80:83] offset:4608
    ds_write_b128 v5, v[84:87] offset:5760
    ds_write_b128 v5, v[88:91] offset:6912
    ds_write_b128 v5, v[92:95] offset:8064
    s_waitcnt lgkmcnt(4)
    buffer_store_dwordx4 v[200:203], v9, s[28:31], s44 offen sc1
    s_add_u32 s44, s44, s48
    buffer_store_dwordx4 v[204:207], v9, s[28:31], s45 offen sc1
    s_add_u32 s45, s45, s49
    buffer_store_dwordx4 v[208:211], v9, s[28:31], s46 offen sc1
    s_add_u32 s46, s46, s50
    buffer_store_dwordx4 v[212:215], v9, s[28:31], s47 offen sc1
    s_add_u32 s47, s47, s51
    s_waitcnt lgkmcnt(0)
    ds_read_b64_tr_b16 v[216:217], v8 offset:4608
    ds_read_b64_tr_b16 v[218:219], v8 offset:5184
    ds_read_b64_tr_b16 v[220:221], v8 offset:4640
    ds_read_b64_tr_b16 v[222:223], v8 offset:5216
    ds_read_b64_tr_b16 v[224:225], v8 offset:4672
    ds_read_b64_tr_b16 v[226:227], v8 offset:5248
    ds_read_b64_tr_b16 v[228:229], v8 offset:4704
    ds_read_b64_tr_b16 v[230:231], v8 offset:5280
    s_waitcnt vmcnt(32)
    ds_write_b128 v5, v[96:99] offset:0
    ds_write_b128 v5, v[100:103] offset:1152
    ds_write_b128 v5, v[104:107] offset:2304
    ds_write_b128 v5, v[108:111] offset:3456
    s_waitcnt lgkmcnt(4)
    buffer_store_dwordx4 v[216:219], v9, s[28:31], s44 offen sc1
    s_add_u32 s44, s44, s48
    buffer_store_dwordx4 v[220:223], v9, s[28:31], s45 offen sc1
    s_add_u32 s45, s45, s49
    buffer_store_dwordx4 v[224:227], v9, s[28:31], s46 offen sc1
    s_add_u32 s46, s46, s50
    buffer_store_dwordx4 v[228:231], v9, s[28:31], s47 offen sc1
    s_add_u32 s47, s47, s51
    s_waitcnt lgkmcnt(0)
    ds_read_b64_tr_b16 v[200:201], v8 offset:0
    ds_read_b64_tr_b16 v[202:203], v8 offset:576
    ds_read_b64_tr_b16 v[204:205], v8 offset:32
    ds_read_b64_tr_b16 v[206:207], v8 offset:608
    ds_read_b64_tr_b16 v[208:209], v8 offset:64
    ds_read_b64_tr_b16 v[210:211], v8 offset:640
    ds_read_b64_tr_b16 v[212:213], v8 offset:96
    ds_read_b64_tr_b16 v[214:215], v8 offset:672
    s_waitcnt vmcnt(32)
    ds_write_b128 v5, v[112:115] offset:4608
    ds_write_b128 v5, v[116:119] offset:5760
    ds_write_b128 v5, v[120:123] offset:6912
    ds_write_b128 v5, v[124:127] offset:8064
    s_waitcnt lgkmcnt(4)
    buffer_store_dwordx4 v[200:203], v9, s[28:31], s44 offen sc1
    s_add_u32 s44, s44, s48
    buffer_store_dwordx4 v[204:207], v9, s[28:31], s45 offen sc1
    s_add_u32 s45, s45, s49
    buffer_store_dwordx4 v[208:211], v9, s[28:31], s46 offen sc1
    s_add_u32 s46, s46, s50
    buffer_store_dwordx4 v[212:215], v9, s[28:31], s47 offen sc1
    s_add_u32 s47, s47, s51
    s_waitcnt lgkmcnt(0)
    ds_read_b64_tr_b16 v[216:217], v8 offset:4608
    ds_read_b64_tr_b16 v[218:219], v8 offset:5184
    ds_read_b64_tr_b16 v[220:221], v8 offset:4640
    ds_read_b64_tr_b16 v[222:223], v8 offset:5216
    ds_read_b64_tr_b16 v[224:225], v8 offset:4672
    ds_read_b64_tr_b16 v[226:227], v8 offset:5248
    ds_read_b64_tr_b16 v[228:229], v8 offset:4704
    ds_read_b64_tr_b16 v[230:231], v8 offset:5280
    s_waitcnt vmcnt(32)
    ds_write_b128 v5, v[128:131] offset:0
    ds_write_b128 v5, v[132:135] offset:1152
    ds_write_b128 v5, v[136:139] offset:2304
    ds_write_b128 v5, v[140:143] offset:3456
    s_waitcnt lgkmcnt(4)
    buffer_store_dwordx4 v[216:219], v9, s[28:31], s44 offen sc1
    s_add_u32 s44, s44, s48
    buffer_store_dwordx4 v[220:223], v9, s[28:31], s45 offen sc1
    s_add_u32 s45, s45, s49
    buffer_store_dwordx4 v[224:227], v9, s[28:31], s46 offen sc1
    s_add_u32 s46, s46, s50
    buffer_store_dwordx4 v[228:231], v9, s[28:31], s47 offen sc1
    s_add_u32 s47, s47, s51
    s_waitcnt lgkmcnt(0)
    ds_read_b64_tr_b16 v[200:201], v8 offset:0
    ds_read_b64_tr_b16 v[202:203], v8 offset:576
    ds_read_b64_tr_b16 v[204:205], v8 offset:32
    ds_read_b64_tr_b16 v[206:207], v8 offset:608
    ds_read_b64_tr_b16 v[208:209], v8 offset:64
    ds_read_b64_tr_b16 v[210:211], v8 offset:640
    ds_read_b64_tr_b16 v[212:213], v8 offset:96
    ds_read_b64_tr_b16 v[214:215], v8 offset:672
    s_waitcnt vmcnt(32)
    ds_write_b128 v5, v[144:147] offset:4608
    ds_write_b128 v5, v[148:151] offset:5760
    ds_write_b128 v5, v[152:155] offset:6912
    ds_write_b128 v5, v[156:159] offset:8064
    s_waitcnt lgkmcnt(4)
    buffer_store_dwordx4 v[200:203], v9, s[28:31], s44 offen sc1
    s_add_u32 s44, s44, s48
    buffer_store_dwordx4 v[204:207], v9, s[28:31], s45 offen sc1
    s_add_u32 s45, s45, s49
    buffer_store_dwordx4 v[208:211], v9, s[28:31], s46 offen sc1
    s_add_u32 s46, s46, s50
    buffer_store_dwordx4 v[212:215], v9, s[28:31], s47 offen sc1
    s_add_u32 s47, s47, s51
    s_waitcnt lgkmcnt(0)
    ds_read_b64_tr_b16 v[216:217], v8 offset:4608
    ds_read_b64_tr_b16 v[218:219], v8 offset:5184
    ds_read_b64_tr_b16 v[220:221], v8 offset:4640
    ds_read_b64_tr_b16 v[222:223], v8 offset:5216
    ds_read_b64_tr_b16 v[224:225], v8 offset:4672
    ds_read_b64_tr_b16 v[226:227], v8 offset:5248
    ds_read_b64_tr_b16 v[228:229], v8 offset:4704
    ds_read_b64_tr_b16 v[230:231], v8 offset:5280
    s_waitcnt vmcnt(32)
    ds_write_b128 v5, v[160:163] offset:0
    ds_write_b128 v5, v[164:167] offset:1152
    ds_write_b128 v5, v[168:171] offset:2304
    ds_write_b128 v5, v[172:175] offset:3456
    s_waitcnt lgkmcnt(4)
    buffer_store_dwordx4 v[216:219], v9, s[28:31], s44 offen sc1
    s_add_u32 s44, s44, s48
    buffer_store_dwordx4 v[220:223], v9, s[28:31], s45 offen sc1
    s_add_u32 s45, s45, s49
    buffer_store_dwordx4 v[224:227], v9, s[28:31], s46 offen sc1
    s_add_u32 s46, s46, s50
    buffer_store_dwordx4 v[228:231], v9, s[28:31], s47 offen sc1
    s_add_u32 s47, s47, s51
    s_waitcnt lgkmcnt(0)
    ds_read_b64_tr_b16 v[200:201], v8 offset:0
    ds_read_b64_tr_b16 v[202:203], v8 offset:576
    ds_read_b64_tr_b16 v[204:205], v8 offset:32
    ds_read_b64_tr_b16 v[206:207], v8 offset:608
    ds_read_b64_tr_b16 v[208:209], v8 offset:64
    ds_read_b64_tr_b16 v[210:211], v8 offset:640
    ds_read_b64_tr_b16 v[212:213], v8 offset:96
    ds_read_b64_tr_b16 v[214:215], v8 offset:672
    s_waitcnt vmcnt(32)
    ds_write_b128 v5, v[176:179] offset:4608
    ds_write_b128 v5, v[180:183] offset:5760
    ds_write_b128 v5, v[184:187] offset:6912
    ds_write_b128 v5, v[188:191] offset:8064
    s_waitcnt lgkmcnt(4)
    buffer_store_dwordx4 v[200:203], v9, s[28:31], s44 offen sc1
    s_add_u32 s44, s44, s48
    buffer_store_dwordx4 v[204:207], v9, s[28:31], s45 offen sc1
    s_add_u32 s45, s45, s49
    buffer_store_dwordx4 v[208:211], v9, s[28:31], s46 offen sc1
    s_add_u32 s46, s46, s50
    buffer_store_dwordx4 v[212:215], v9, s[28:31], s47 offen sc1
    s_add_u32 s47, s47, s51
    s_waitcnt lgkmcnt(0)
    ds_read_b64_tr_b16 v[216:217], v8 offset:4608
    ds_read_b64_tr_b16 v[218:219], v8 offset:5184
    ds_read_b64_tr_b16 v[220:221], v8 offset:4640
    ds_read_b64_tr_b16 v[222:223], v8 offset:5216
    ds_read_b64_tr_b16 v[224:225], v8 offset:4672
    ds_read_b64_tr_b16 v[226:227], v8 offset:5248
    ds_read_b64_tr_b16 v[228:229], v8 offset:4704
    ds_read_b64_tr_b16 v[230:231], v8 offset:5280
    s_waitcnt lgkmcnt(0)
    buffer_store_dwordx4 v[216:219], v9, s[28:31], s44 offen sc1
    s_add_u32 s44, s44, s48
    buffer_store_dwordx4 v[220:223], v9, s[28:31], s45 offen sc1
    s_add_u32 s45, s45, s49
    buffer_store_dwordx4 v[224:227], v9, s[28:31], s46 offen sc1
    s_add_u32 s46, s46, s50
    buffer_store_dwordx4 v[228:231], v9, s[28:31], s47 offen sc1
    s_add_u32 s47, s47, s51
    s_endpgm
prep_kernel_pk29:
    s_mov_b32 s24, s16
    s_mov_b32 s25, s17
    s_mov_b32 s26, 2211840
    s_mov_b32 s27, 0x00020000
    s_sub_u32 s32, s21, 40
    s_mul_i32 s33, s32, 2428
    s_lshr_b32 s33, s33, 16
    s_mul_i32 s35, s33, 27
    s_sub_u32 s35, s32, s35
    v_mul_u32_u24 v10, 3456, v3
    v_lshl_add_u32 v10, v4, 4, v10
    s_mul_i32 s36, s33, 1105920
    s_lshl_b32 s37, s35, 7
    s_add_u32 s36, s36, s37
    buffer_load_dwordx4 v[32:35], v10, s[24:27], s36 offen nt
    s_add_u32 s36, s36, 27648
    buffer_load_dwordx4 v[36:39], v10, s[24:27], s36 offen nt
    s_add_u32 s36, s36, 27648
    buffer_load_dwordx4 v[40:43], v10, s[24:27], s36 offen nt
    s_add_u32 s36, s36, 27648
    buffer_load_dwordx4 v[44:47], v10, s[24:27], s36 offen nt
    s_add_u32 s36, s36, 27648
    buffer_load_dwordx4 v[48:51], v10, s[24:27], s36 offen nt
    s_add_u32 s36, s36, 27648
    buffer_load_dwordx4 v[52:55], v10, s[24:27], s36 offen nt
    s_add_u32 s36, s36, 27648
    buffer_load_dwordx4 v[56:59], v10, s[24:27], s36 offen nt
    s_add_u32 s36, s36, 27648
    buffer_load_dwordx4 v[60:63], v10, s[24:27], s36 offen nt
    s_add_u32 s36, s36, 27648
    buffer_load_dwordx4 v[64:67], v10, s[24:27], s36 offen nt
    s_add_u32 s36, s36, 27648
    buffer_load_dwordx4 v[68:71], v10, s[24:27], s36 offen nt
    s_add_u32 s36, s36, 27648
    buffer_load_dwordx4 v[72:75], v10, s[24:27], s36 offen nt
    s_add_u32 s36, s36, 27648
    buffer_load_dwordx4 v[76:79], v10, s[24:27], s36 offen nt
    s_add_u32 s36, s36, 27648
    buffer_load_dwordx4 v[80:83], v10, s[24:27], s36 offen nt
    s_add_u32 s36, s36, 27648
    buffer_load_dwordx4 v[84:87], v10, s[24:27], s36 offen nt
    s_add_u32 s36, s36, 27648
    buffer_load_dwordx4 v[88:91], v10, s[24:27], s36 offen nt
    s_add_u32 s36, s36, 27648
    buffer_load_dwordx4 v[92:95], v10, s[24:27], s36 offen nt
    s_add_u32 s36, s36, 27648
    buffer_load_dwordx4 v[96:99], v10, s[24:27], s36 offen nt
    s_add_u32 s36, s36, 27648
    buffer_load_dwordx4 v[100:103], v10, s[24:27], s36 offen nt
    s_add_u32 s36, s36, 27648
    buffer_load_dwordx4 v[104:107], v10, s[24:27], s36 offen nt
    s_add_u32 s36, s36, 27648
    buffer_load_dwordx4 v[108:111], v10, s[24:27], s36 offen nt
    s_add_u32 s36, s36, 27648
    buffer_load_dwordx4 v[112:115], v10, s[24:27], s36 offen nt
    s_add_u32 s36, s36, 27648
    buffer_load_dwordx4 v[116:119], v10, s[24:27], s36 offen nt
    s_add_u32 s36, s36, 27648
    buffer_load_dwordx4 v[120:123], v10, s[24:27], s36 offen nt
    s_add_u32 s36, s36, 27648
    buffer_load_dwordx4 v[124:127], v10, s[24:27], s36 offen nt
    s_add_u32 s36, s36, 27648
    buffer_load_dwordx4 v[128:131], v10, s[24:27], s36 offen nt
    s_add_u32 s36, s36, 27648
    buffer_load_dwordx4 v[132:135], v10, s[24:27], s36 offen nt
    s_add_u32 s36, s36, 27648
    buffer_load_dwordx4 v[136:139], v10, s[24:27], s36 offen nt
    s_add_u32 s36, s36, 27648
    buffer_load_dwordx4 v[140:143], v10, s[24:27], s36 offen nt
    s_add_u32 s36, s36, 27648
    buffer_load_dwordx4 v[144:147], v10, s[24:27], s36 offen nt
    s_add_u32 s36, s36, 27648
    buffer_load_dwordx4 v[148:151], v10, s[24:27], s36 offen nt
    s_add_u32 s36, s36, 27648
    buffer_load_dwordx4 v[152:155], v10, s[24:27], s36 offen nt
    s_add_u32 s36, s36, 27648
    buffer_load_dwordx4 v[156:159], v10, s[24:27], s36 offen nt
    s_add_u32 s36, s36, 27648
    buffer_load_dwordx4 v[160:163], v10, s[24:27], s36 offen nt
    s_add_u32 s36, s36, 27648
    buffer_load_dwordx4 v[164:167], v10, s[24:27], s36 offen nt
    s_add_u32 s36, s36, 27648
    buffer_load_dwordx4 v[168:171], v10, s[24:27], s36 offen nt
    s_add_u32 s36, s36, 27648
    buffer_load_dwordx4 v[172:175], v10, s[24:27], s36 offen nt
    s_add_u32 s36, s36, 27648
    buffer_load_dwordx4 v[176:179], v10, s[24:27], s36 offen nt
    s_add_u32 s36, s36, 27648
    buffer_load_dwordx4 v[180:183], v10, s[24:27], s36 offen nt
    s_add_u32 s36, s36, 27648
    buffer_load_dwordx4 v[184:187], v10, s[24:27], s36 offen nt
    s_add_u32 s36, s36, 27648
    buffer_load_dwordx4 v[188:191], v10, s[24:27], s36 offen nt
    s_lshl_b32 s36, s35, 2
    s_add_u32 s36, s36, 0
    s_mul_i32 s38, s36, 9363
    s_lshr_b32 s38, s38, 16
    s_mul_i32 s39, s38, 7
    s_sub_u32 s39, s36, s39
    s_sub_u32 s41, s39, 1
    s_cmp_eq_u32 s39, 0
    s_cselect_b32 s41, 6, s41
    s_and_b32 s40, s38, 1
    s_cmp_eq_u32 s40, 1
    s_cselect_b32 s39, s41, s39
    s_mov_b32 s41, 4
    s_mov_b32 s40, s39
    s_cmp_ge_u32 s39, 4
    s_cselect_b32 s41, 2, s41
    s_add_u32 s42, s39, 76
    s_cmp_ge_u32 s39, 4
    s_cselect_b32 s40, s42, s40
    s_cmp_eq_u32 s39, 6
    s_cselect_b32 s41, 1, s41
    s_cselect_b32 s40, 120, s40
    s_mul_i32 s42, s33, 10
    s_mul_i32 s42, s42, s41
    s_add_u32 s40, s40, s42
    s_mul_i32 s37, s38, 140
    s_add_u32 s37, s37, s40
    s_lshl_b32 s37, s37, 10
    s_add_u32 s44, s37, 24875008
    s_lshl_b32 s48, s41, 10
    s_lshl_b32 s36, s35, 2
    s_add_u32 s36, s36, 1
    s_mul_i32 s38, s36, 9363
    s_lshr_b32 s38, s38, 16
    s_mul_i32 s39, s38, 7
    s_sub_u32 s39, s36, s39
    s_sub_u32 s41, s39, 1
    s_cmp_eq_u32 s39, 0
    s_cselect_b32 s41, 6, s41
    s_and_b32 s40, s38, 1
    s_cmp_eq_u32 s40, 1
    s_cselect_b32 s39, s41, s39
    s_mov_b32 s41, 4
    s_mov_b32 s40, s39
    s_cmp_ge_u32 s39, 4
    s_cselect_b32 s41, 2, s41
    s_add_u32 s42, s39, 76
    s_cmp_ge_u32 s39, 4
    s_cselect_b32 s40, s42, s40
    s_cmp_eq_u32 s39, 6
    s_cselect_b32 s41, 1, s41
    s_cselect_b32 s40, 120, s40
    s_mul_i32 s42, s33, 10
    s_mul_i32 s42, s42, s41
    s_add_u32 s40, s40, s42
    s_mul_i32 s37, s38, 140
    s_add_u32 s37, s37, s40
    s_lshl_b32 s37, s37, 10
    s_add_u32 s45, s37, 24875008
    s_lshl_b32 s49, s41, 10
    s_lshl_b32 s36, s35, 2
    s_add_u32 s36, s36, 2
    s_mul_i32 s38, s36, 9363
    s_lshr_b32 s38, s38, 16
    s_mul_i32 s39, s38, 7
    s_sub_u32 s39, s36, s39
    s_sub_u32 s41, s39, 1
    s_cmp_eq_u32 s39, 0
    s_cselect_b32 s41, 6, s41
    s_and_b32 s40, s38, 1
    s_cmp_eq_u32 s40, 1
    s_cselect_b32 s39, s41, s39
    s_mov_b32 s41, 4
    s_mov_b32 s40, s39
    s_cmp_ge_u32 s39, 4
    s_cselect_b32 s41, 2, s41
    s_add_u32 s42, s39, 76
    s_cmp_ge_u32 s39, 4
    s_cselect_b32 s40, s42, s40
    s_cmp_eq_u32 s39, 6
    s_cselect_b32 s41, 1, s41
    s_cselect_b32 s40, 120, s40
    s_mul_i32 s42, s33, 10
    s_mul_i32 s42, s42, s41
    s_add_u32 s40, s40, s42
    s_mul_i32 s37, s38, 140
    s_add_u32 s37, s37, s40
    s_lshl_b32 s37, s37, 10
    s_add_u32 s46, s37, 24875008
    s_lshl_b32 s50, s41, 10
    s_lshl_b32 s36, s35, 2
    s_add_u32 s36, s36, 3
    s_mul_i32 s38, s36, 9363
    s_lshr_b32 s38, s38, 16
    s_mul_i32 s39, s38, 7
    s_sub_u32 s39, s36, s39
    s_sub_u32 s41, s39, 1
    s_cmp_eq_u32 s39, 0
    s_cselect_b32 s41, 6, s41
    s_and_b32 s40, s38, 1
    s_cmp_eq_u32 s40, 1
    s_cselect_b32 s39, s41, s39
    s_mov_b32 s41, 4
    s_mov_b32 s40, s39
    s_cmp_ge_u32 s39, 4
    s_cselect_b32 s41, 2, s41
    s_add_u32 s42, s39, 76
    s_cmp_ge_u32 s39, 4
    s_cselect_b32 s40, s42, s40
    s_cmp_eq_u32 s39, 6
    s_cselect_b32 s41, 1, s41
    s_cselect_b32 s40, 120, s40
    s_mul_i32 s42, s33, 10
    s_mul_i32 s42, s42, s41
    s_add_u32 s40, s40, s42
    s_mul_i32 s37, s38, 140
    s_add_u32 s37, s37, s40
    s_lshl_b32 s37, s37, 10
    s_add_u32 s47, s37, 24875008
    s_lshl_b32 s51, s41, 10
    v_mov_b32 v12, 0
    v_mov_b32 v13, 0
    v_mov_b32 v14, 0
    v_mov_b32 v15, 0
    v_mov_b32 v16, 0x3f803f80
    s_waitcnt vmcnt(36)
    ds_write_b128 v5, v[32:35] offset:0
    ds_write_b128 v5, v[36:39] offset:1152
    ds_write_b128 v5, v[40:43] offset:2304
    ds_write_b128 v5, v[44:47] offset:3456
    s_waitcnt lgkmcnt(0)
    ds_read_b64_tr_b16 v[200:201], v8 offset:0
    ds_read_b64_tr_b16 v[202:203], v8 offset:576
    ds_read_b64_tr_b16 v[204:205], v8 offset:32
    ds_read_b64_tr_b16 v[206:207], v8 offset:608
    ds_read_b64_tr_b16 v[208:209], v8 offset:64
    ds_read_b64_tr_b16 v[210:211], v8 offset:640
    ds_read_b64_tr_b16 v[212:213], v8 offset:96
    ds_read_b64_tr_b16 v[214:215], v8 offset:672
    s_waitcnt vmcnt(32)
    ds_write_b128 v5, v[48:51] offset:4608
    ds_write_b128 v5, v[52:55] offset:5760
    ds_write_b128 v5, v[56:59] offset:6912
    ds_write_b128 v5, v[60:63] offset:8064
    s_waitcnt lgkmcnt(4)
    buffer_store_dwordx4 v[200:203], v9, s[28:31], s44 offen sc1
    s_add_u32 s44, s44, s48
    v_dot2_f32_bf16 v12, v200, v16, v12
    v_dot2_f32_bf16 v12, v201, v16, v12
    v_dot2_f32_bf16 v12, v202, v16, v12
    v_dot2_f32_bf16 v12, v203, v16, v12
    buffer_store_dwordx4 v[204:207], v9, s[28:31], s45 offen sc1
    s_add_u32 s45, s45, s49
    v_dot2_f32_bf16 v13, v204, v16, v13
    v_dot2_f32_bf16 v13, v205, v16, v13
    v_dot2_f32_bf16 v13, v206, v16, v13
    v_dot2_f32_bf16 v13, v207, v16, v13
    buffer_store_dwordx4 v[208:211], v9, s[28:31], s46 offen sc1
    s_add_u32 s46, s46, s50
    v_dot2_f32_bf16 v14, v208, v16, v14
    v_dot2_f32_bf16 v14, v209, v16, v14
    v_dot2_f32_bf16 v14, v210, v16, v14
    v_dot2_f32_bf16 v14, v211, v16, v14
    buffer_store_dwordx4 v[212:215], v9, s[28:31], s47 offen sc1
    s_add_u32 s47, s47, s51
    v_dot2_f32_bf16 v15, v212, v16, v15
    v_dot2_f32_bf16 v15, v213, v16, v15
    v_dot2_f32_bf16 v15, v214, v16, v15
    v_dot2_f32_bf16 v15, v215, v16, v15
    s_waitcnt lgkmcnt(0)
    ds_read_b64_tr_b16 v[216:217], v8 offset:4608
    ds_read_b64_tr_b16 v[218:219], v8 offset:5184
    ds_read_b64_tr_b16 v[220:221], v8 offset:4640
    ds_read_b64_tr_b16 v[222:223], v8 offset:5216
    ds_read_b64_tr_b16 v[224:225], v8 offset:4672
    ds_read_b64_tr_b16 v[226:227], v8 offset:5248
    ds_read_b64_tr_b16 v[228:229], v8 offset:4704
    ds_read_b64_tr_b16 v[230:231], v8 offset:5280
    s_waitcnt vmcnt(32)
    ds_write_b128 v5, v[64:67] offset:0
    ds_write_b128 v5, v[68:71] offset:1152
    ds_write_b128 v5, v[72:75] offset:2304
    ds_write_b128 v5, v[76:79] offset:3456
    s_waitcnt lgkmcnt(4)
    buffer_store_dwordx4 v[216:219], v9, s[28:31], s44 offen sc1
    s_add_u32 s44, s44, s48
    v_dot2_f32_bf16 v12, v216, v16, v12
    v_dot2_f32_bf16 v12, v217, v16, v12
    v_dot2_f32_bf16 v12, v218, v16, v12
    v_dot2_f32_bf16 v12, v219, v16, v12
    buffer_store_dwordx4 v[220:223], v9, s[28:31], s45 offen sc1
    s_add_u32 s45, s45, s49
    v_dot2_f32_bf16 v13, v220, v16, v13
    v_dot2_f32_bf16 v13, v221, v16, v13
    v_dot2_f32_bf16 v13, v222, v16, v13
    v_dot2_f32_bf16 v13, v223, v16, v13
    buffer_store_dwordx4 v[224:227], v9, s[28:31], s46 offen sc1
    s_add_u32 s46, s46, s50
    v_dot2_f32_bf16 v14, v224, v16, v14
    v_dot2_f32_bf16 v14, v225, v16, v14
    v_dot2_f32_bf16 v14, v226, v16, v14
    v_dot2_f32_bf16 v14, v227, v16, v14
    buffer_store_dwordx4 v[228:231], v9, s[28:31], s47 offen sc1
    s_add_u32 s47, s47, s51
    v_dot2_f32_bf16 v15, v228, v16, v15
    v_dot2_f32_bf16 v15, v229, v16, v15
    v_dot2_f32_bf16 v15, v230, v16, v15
    v_dot2_f32_bf16 v15, v231, v16, v15
    s_waitcnt lgkmcnt(0)
    ds_read_b64_tr_b16 v[200:201], v8 offset:0
    ds_read_b64_tr_b16 v[202:203], v8 offset:576
    ds_read_b64_tr_b16 v[204:205], v8 offset:32
    ds_read_b64_tr_b16 v[206:207], v8 offset:608
    ds_read_b64_tr_b16 v[208:209], v8 offset:64
    ds_read_b64_tr_b16 v[210:211], v8 offset:640
    ds_read_b64_tr_b16 v[212:213], v8 offset:96
    ds_read_b64_tr_b16 v[214:215], v8 offset:672
    s_waitcnt vmcnt(32)
    ds_write_b128 v5, v[80:83] offset:4608
    ds_write_b128 v5, v[84:87] offset:5760
    ds_write_b128 v5, v[88:91] offset:6912
    ds_write_b128 v5, v[92:95] offset:8064
    s_waitcnt lgkmcnt(4)
    buffer_store_dwordx4 v[200:203], v9, s[28:31], s44 offen sc1
    s_add_u32 s44, s44, s48
    v_dot2_f32_bf16 v12, v200, v16, v12
    v_dot2_f32_bf16 v12, v201, v16, v12
    v_dot2_f32_bf16 v12, v202, v16, v12
    v_dot2_f32_bf16 v12, v203, v16, v12
    buffer_store_dwordx4 v[204:207], v9, s[28:31], s45 offen sc1
    s_add_u32 s45, s45, s49
    v_dot2_f32_bf16 v13, v204, v16, v13
    v_dot2_f32_bf16 v13, v205, v16, v13
    v_dot2_f32_bf16 v13, v206, v16, v13
    v_dot2_f32_bf16 v13, v207, v16, v13
    buffer_store_dwordx4 v[208:211], v9, s[28:31], s46 offen sc1
    s_add_u32 s46, s46, s50
    v_dot2_f32_bf16 v14, v208, v16, v14
    v_dot2_f32_bf16 v14, v209, v16, v14
    v_dot2_f32_bf16 v14, v210, v16, v14
    v_dot2_f32_bf16 v14, v211, v16, v14
    buffer_store_dwordx4 v[212:215], v9, s[28:31], s47 offen sc1
    s_add_u32 s47, s47, s51
    v_dot2_f32_bf16 v15, v212, v16, v15
    v_dot2_f32_bf16 v15, v213, v16, v15
    v_dot2_f32_bf16 v15, v214, v16, v15
    v_dot2_f32_bf16 v15, v215, v16, v15
    s_waitcnt lgkmcnt(0)
    ds_read_b64_tr_b16 v[216:217], v8 offset:4608
    ds_read_b64_tr_b16 v[218:219], v8 offset:5184
    ds_read_b64_tr_b16 v[220:221], v8 offset:4640
    ds_read_b64_tr_b16 v[222:223], v8 offset:5216
    ds_read_b64_tr_b16 v[224:225], v8 offset:4672
    ds_read_b64_tr_b16 v[226:227], v8 offset:5248
    ds_read_b64_tr_b16 v[228:229], v8 offset:4704
    ds_read_b64_tr_b16 v[230:231], v8 offset:5280
    s_waitcnt vmcnt(32)
    ds_write_b128 v5, v[96:99] offset:0
    ds_write_b128 v5, v[100:103] offset:1152
    ds_write_b128 v5, v[104:107] offset:2304
    ds_write_b128 v5, v[108:111] offset:3456
    s_waitcnt lgkmcnt(4)
    buffer_store_dwordx4 v[216:219], v9, s[28:31], s44 offen sc1
    s_add_u32 s44, s44, s48
    v_dot2_f32_bf16 v12, v216, v16, v12
    v_dot2_f32_bf16 v12, v217, v16, v12
    v_dot2_f32_bf16 v12, v218, v16, v12
    v_dot2_f32_bf16 v12, v219, v16, v12
    buffer_store_dwordx4 v[220:223], v9, s[28:31], s45 offen sc1
    s_add_u32 s45, s45, s49
    v_dot2_f32_bf16 v13, v220, v16, v13
    v_dot2_f32_bf16 v13, v221, v16, v13
    v_dot2_f32_bf16 v13, v222, v16, v13
    v_dot2_f32_bf16 v13, v223, v16, v13
    buffer_store_dwordx4 v[224:227], v9, s[28:31], s46 offen sc1
    s_add_u32 s46, s46, s50
    v_dot2_f32_bf16 v14, v224, v16, v14
    v_dot2_f32_bf16 v14, v225, v16, v14
    v_dot2_f32_bf16 v14, v226, v16, v14
    v_dot2_f32_bf16 v14, v227, v16, v14
    buffer_store_dwordx4 v[228:231], v9, s[28:31], s47 offen sc1
    s_add_u32 s47, s47, s51
    v_dot2_f32_bf16 v15, v228, v16, v15
    v_dot2_f32_bf16 v15, v229, v16, v15
    v_dot2_f32_bf16 v15, v230, v16, v15
    v_dot2_f32_bf16 v15, v231, v16, v15
    s_waitcnt lgkmcnt(0)
    ds_read_b64_tr_b16 v[200:201], v8 offset:0
    ds_read_b64_tr_b16 v[202:203], v8 offset:576
    ds_read_b64_tr_b16 v[204:205], v8 offset:32
    ds_read_b64_tr_b16 v[206:207], v8 offset:608
    ds_read_b64_tr_b16 v[208:209], v8 offset:64
    ds_read_b64_tr_b16 v[210:211], v8 offset:640
    ds_read_b64_tr_b16 v[212:213], v8 offset:96
    ds_read_b64_tr_b16 v[214:215], v8 offset:672
    s_waitcnt vmcnt(32)
    ds_write_b128 v5, v[112:115] offset:4608
    ds_write_b128 v5, v[116:119] offset:5760
    ds_write_b128 v5, v[120:123] offset:6912
    ds_write_b128 v5, v[124:127] offset:8064
    s_waitcnt lgkmcnt(4)
    buffer_store_dwordx4 v[200:203], v9, s[28:31], s44 offen sc1
    s_add_u32 s44, s44, s48
    v_dot2_f32_bf16 v12, v200, v16, v12
    v_dot2_f32_bf16 v12, v201, v16, v12
    v_dot2_f32_bf16 v12, v202, v16, v12
    v_dot2_f32_bf16 v12, v203, v16, v12
    buffer_store_dwordx4 v[204:207], v9, s[28:31], s45 offen sc1
    s_add_u32 s45, s45, s49
    v_dot2_f32_bf16 v13, v204, v16, v13
    v_dot2_f32_bf16 v13, v205, v16, v13
    v_dot2_f32_bf16 v13, v206, v16, v13
    v_dot2_f32_bf16 v13, v207, v16, v13
    buffer_store_dwordx4 v[208:211], v9, s[28:31], s46 offen sc1
    s_add_u32 s46, s46, s50
    v_dot2_f32_bf16 v14, v208, v16, v14
    v_dot2_f32_bf16 v14, v209, v16, v14
    v_dot2_f32_bf16 v14, v210, v16, v14
    v_dot2_f32_bf16 v14, v211, v16, v14
    buffer_store_dwordx4 v[212:215], v9, s[28:31], s47 offen sc1
    s_add_u32 s47, s47, s51
    v_dot2_f32_bf16 v15, v212, v16, v15
    v_dot2_f32_bf16 v15, v213, v16, v15
    v_dot2_f32_bf16 v15, v214, v16, v15
    v_dot2_f32_bf16 v15, v215, v16, v15
    s_waitcnt lgkmcnt(0)
    ds_read_b64_tr_b16 v[216:217], v8 offset:4608
    ds_read_b64_tr_b16 v[218:219], v8 offset:5184
    ds_read_b64_tr_b16 v[220:221], v8 offset:4640
    ds_read_b64_tr_b16 v[222:223], v8 offset:5216
    ds_read_b64_tr_b16 v[224:225], v8 offset:4672
    ds_read_b64_tr_b16 v[226:227], v8 offset:5248
    ds_read_b64_tr_b16 v[228:229], v8 offset:4704
    ds_read_b64_tr_b16 v[230:231], v8 offset:5280
    s_waitcnt vmcnt(32)
    ds_write_b128 v5, v[128:131] offset:0
    ds_write_b128 v5, v[132:135] offset:1152
    ds_write_b128 v5, v[136:139] offset:2304
    ds_write_b128 v5, v[140:143] offset:3456
    s_waitcnt lgkmcnt(4)
    buffer_store_dwordx4 v[216:219], v9, s[28:31], s44 offen sc1
    s_add_u32 s44, s44, s48
    v_dot2_f32_bf16 v12, v216, v16, v12
    v_dot2_f32_bf16 v12, v217, v16, v12
    v_dot2_f32_bf16 v12, v218, v16, v12
    v_dot2_f32_bf16 v12, v219, v16, v12
    buffer_store_dwordx4 v[220:223], v9, s[28:31], s45 offen sc1
    s_add_u32 s45, s45, s49
    v_dot2_f32_bf16 v13, v220, v16, v13
    v_dot2_f32_bf16 v13, v221, v16, v13
    v_dot2_f32_bf16 v13, v222, v16, v13
    v_dot2_f32_bf16 v13, v223, v16, v13
    buffer_store_dwordx4 v[224:227], v9, s[28:31], s46 offen sc1
    s_add_u32 s46, s46, s50
    v_dot2_f32_bf16 v14, v224, v16, v14
    v_dot2_f32_bf16 v14, v225, v16, v14
    v_dot2_f32_bf16 v14, v226, v16, v14
    v_dot2_f32_bf16 v14, v227, v16, v14
    buffer_store_dwordx4 v[228:231], v9, s[28:31], s47 offen sc1
    s_add_u32 s47, s47, s51
    v_dot2_f32_bf16 v15, v228, v16, v15
    v_dot2_f32_bf16 v15, v229, v16, v15
    v_dot2_f32_bf16 v15, v230, v16, v15
    v_dot2_f32_bf16 v15, v231, v16, v15
    s_waitcnt lgkmcnt(0)
    ds_read_b64_tr_b16 v[200:201], v8 offset:0
    ds_read_b64_tr_b16 v[202:203], v8 offset:576
    ds_read_b64_tr_b16 v[204:205], v8 offset:32
    ds_read_b64_tr_b16 v[206:207], v8 offset:608
    ds_read_b64_tr_b16 v[208:209], v8 offset:64
    ds_read_b64_tr_b16 v[210:211], v8 offset:640
    ds_read_b64_tr_b16 v[212:213], v8 offset:96
    ds_read_b64_tr_b16 v[214:215], v8 offset:672
    s_waitcnt vmcnt(32)
    ds_write_b128 v5, v[144:147] offset:4608
    ds_write_b128 v5, v[148:151] offset:5760
    ds_write_b128 v5, v[152:155] offset:6912
    ds_write_b128 v5, v[156:159] offset:8064
    s_waitcnt lgkmcnt(4)
    buffer_store_dwordx4 v[200:203], v9, s[28:31], s44 offen sc1
    s_add_u32 s44, s44, s48
    v_dot2_f32_bf16 v12, v200, v16, v12
    v_dot2_f32_bf16 v12, v201, v16, v12
    v_dot2_f32_bf16 v12, v202, v16, v12
    v_dot2_f32_bf16 v12, v203, v16, v12
    buffer_store_dwordx4 v[204:207], v9, s[28:31], s45 offen sc1
    s_add_u32 s45, s45, s49
    v_dot2_f32_bf16 v13, v204, v16, v13
    v_dot2_f32_bf16 v13, v205, v16, v13
    v_dot2_f32_bf16 v13, v206, v16, v13
    v_dot2_f32_bf16 v13, v207, v16, v13
    buffer_store_dwordx4 v[208:211], v9, s[28:31], s46 offen sc1
    s_add_u32 s46, s46, s50
    v_dot2_f32_bf16 v14, v208, v16, v14
    v_dot2_f32_bf16 v14, v209, v16, v14
    v_dot2_f32_bf16 v14, v210, v16, v14
    v_dot2_f32_bf16 v14, v211, v16, v14
    buffer_store_dwordx4 v[212:215], v9, s[28:31], s47 offen sc1
    s_add_u32 s47, s47, s51
    v_dot2_f32_bf16 v15, v212, v16, v15
    v_dot2_f32_bf16 v15, v213, v16, v15
    v_dot2_f32_bf16 v15, v214, v16, v15
    v_dot2_f32_bf16 v15, v215, v16, v15
    s_waitcnt lgkmcnt(0)
    ds_read_b64_tr_b16 v[216:217], v8 offset:4608
    ds_read_b64_tr_b16 v[218:219], v8 offset:5184
    ds_read_b64_tr_b16 v[220:221], v8 offset:4640
    ds_read_b64_tr_b16 v[222:223], v8 offset:5216
    ds_read_b64_tr_b16 v[224:225], v8 offset:4672
    ds_read_b64_tr_b16 v[226:227], v8 offset:5248
    ds_read_b64_tr_b16 v[228:229], v8 offset:4704
    ds_read_b64_tr_b16 v[230:231], v8 offset:5280
    s_waitcnt vmcnt(32)
    ds_write_b128 v5, v[160:163] offset:0
    ds_write_b128 v5, v[164:167] offset:1152
    ds_write_b128 v5, v[168:171] offset:2304
    ds_write_b128 v5, v[172:175] offset:3456
    s_waitcnt lgkmcnt(4)
    buffer_store_dwordx4 v[216:219], v9, s[28:31], s44 offen sc1
    s_add_u32 s44, s44, s48
    v_dot2_f32_bf16 v12, v216, v16, v12
    v_dot2_f32_bf16 v12, v217, v16, v12
    v_dot2_f32_bf16 v12, v218, v16, v12
    v_dot2_f32_bf16 v12, v219, v16, v12
    buffer_store_dwordx4 v[220:223], v9, s[28:31], s45 offen sc1
    s_add_u32 s45, s45, s49
    v_dot2_f32_bf16 v13, v220, v16, v13
    v_dot2_f32_bf16 v13, v221, v16, v13
    v_dot2_f32_bf16 v13, v222, v16, v13
    v_dot2_f32_bf16 v13, v223, v16, v13
    buffer_store_dwordx4 v[224:227], v9, s[28:31], s46 offen sc1
    s_add_u32 s46, s46, s50
    v_dot2_f32_bf16 v14, v224, v16, v14
    v_dot2_f32_bf16 v14, v225, v16, v14
    v_dot2_f32_bf16 v14, v226, v16, v14
    v_dot2_f32_bf16 v14, v227, v16, v14
    buffer_store_dwordx4 v[228:231], v9, s[28:31], s47 offen sc1
    s_add_u32 s47, s47, s51
    v_dot2_f32_bf16 v15, v228, v16, v15
    v_dot2_f32_bf16 v15, v229, v16, v15
    v_dot2_f32_bf16 v15, v230, v16, v15
    v_dot2_f32_bf16 v15, v231, v16, v15
    s_waitcnt lgkmcnt(0)
    ds_read_b64_tr_b16 v[200:201], v8 offset:0
    ds_read_b64_tr_b16 v[202:203], v8 offset:576
    ds_read_b64_tr_b16 v[204:205], v8 offset:32
    ds_read_b64_tr_b16 v[206:207], v8 offset:608
    ds_read_b64_tr_b16 v[208:209], v8 offset:64
    ds_read_b64_tr_b16 v[210:211], v8 offset:640
    ds_read_b64_tr_b16 v[212:213], v8 offset:96
    ds_read_b64_tr_b16 v[214:215], v8 offset:672
    s_waitcnt vmcnt(32)
    ds_write_b128 v5, v[176:179] offset:4608
    ds_write_b128 v5, v[180:183] offset:5760
    ds_write_b128 v5, v[184:187] offset:6912
    ds_write_b128 v5, v[188:191] offset:8064
    s_waitcnt lgkmcnt(4)
    buffer_store_dwordx4 v[200:203], v9, s[28:31], s44 offen sc1
    s_add_u32 s44, s44, s48
    v_dot2_f32_bf16 v12, v200, v16, v12
    v_dot2_f32_bf16 v12, v201, v16, v12
    v_dot2_f32_bf16 v12, v202, v16, v12
    v_dot2_f32_bf16 v12, v203, v16, v12
    buffer_store_dwordx4 v[204:207], v9, s[28:31], s45 offen sc1
    s_add_u32 s45, s45, s49
    v_dot2_f32_bf16 v13, v204, v16, v13
    v_dot2_f32_bf16 v13, v205, v16, v13
    v_dot2_f32_bf16 v13, v206, v16, v13
    v_dot2_f32_bf16 v13, v207, v16, v13
    buffer_store_dwordx4 v[208:211], v9, s[28:31], s46 offen sc1
    s_add_u32 s46, s46, s50
    v_dot2_f32_bf16 v14, v208, v16, v14
    v_dot2_f32_bf16 v14, v209, v16, v14
    v_dot2_f32_bf16 v14, v210, v16, v14
    v_dot2_f32_bf16 v14, v211, v16, v14
    buffer_store_dwordx4 v[212:215], v9, s[28:31], s47 offen sc1
    s_add_u32 s47, s47, s51
    v_dot2_f32_bf16 v15, v212, v16, v15
    v_dot2_f32_bf16 v15, v213, v16, v15
    v_dot2_f32_bf16 v15, v214, v16, v15
    v_dot2_f32_bf16 v15, v215, v16, v15
    s_waitcnt lgkmcnt(0)
    ds_read_b64_tr_b16 v[216:217], v8 offset:4608
    ds_read_b64_tr_b16 v[218:219], v8 offset:5184
    ds_read_b64_tr_b16 v[220:221], v8 offset:4640
    ds_read_b64_tr_b16 v[222:223], v8 offset:5216
    ds_read_b64_tr_b16 v[224:225], v8 offset:4672
    ds_read_b64_tr_b16 v[226:227], v8 offset:5248
    ds_read_b64_tr_b16 v[228:229], v8 offset:4704
    ds_read_b64_tr_b16 v[230:231], v8 offset:5280
    s_waitcnt lgkmcnt(0)
    buffer_store_dwordx4 v[216:219], v9, s[28:31], s44 offen sc1
    s_add_u32 s44, s44, s48
    v_dot2_f32_bf16 v12, v216, v16, v12
    v_dot2_f32_bf16 v12, v217, v16, v12
    v_dot2_f32_bf16 v12, v218, v16, v12
    v_dot2_f32_bf16 v12, v219, v16, v12
    buffer_store_dwordx4 v[220:223], v9, s[28:31], s45 offen sc1
    s_add_u32 s45, s45, s49
    v_dot2_f32_bf16 v13, v220, v16, v13
    v_dot2_f32_bf16 v13, v221, v16, v13
    v_dot2_f32_bf16 v13, v222, v16, v13
    v_dot2_f32_bf16 v13, v223, v16, v13
    buffer_store_dwordx4 v[224:227], v9, s[28:31], s46 offen sc1
    s_add_u32 s46, s46, s50
    v_dot2_f32_bf16 v14, v224, v16, v14
    v_dot2_f32_bf16 v14, v225, v16, v14
    v_dot2_f32_bf16 v14, v226, v16, v14
    v_dot2_f32_bf16 v14, v227, v16, v14
    buffer_store_dwordx4 v[228:231], v9, s[28:31], s47 offen sc1
    s_add_u32 s47, s47, s51
    v_dot2_f32_bf16 v15, v228, v16, v15
    v_dot2_f32_bf16 v15, v229, v16, v15
    v_dot2_f32_bf16 v15, v230, v16, v15
    v_dot2_f32_bf16 v15, v231, v16, v15
    s_nop 2
    v_mov_b32 v20, v12
    v_mov_b32 v21, v13
    v_mov_b32 v22, v14
    v_mov_b32 v23, v15
    s_nop 1
    v_permlane32_swap_b32 v20, v12
    v_permlane32_swap_b32 v21, v13
    v_permlane32_swap_b32 v22, v14
    v_permlane32_swap_b32 v23, v15
    s_nop 1
    v_add_f32 v12, v12, v20
    v_add_f32 v13, v13, v21
    v_add_f32 v14, v14, v22
    v_add_f32 v15, v15, v23
    v_mov_b32 v20, v12
    v_mov_b32 v21, v13
    v_mov_b32 v22, v14
    v_mov_b32 v23, v15
    s_nop 1
    v_permlane16_swap_b32 v20, v12
    v_permlane16_swap_b32 v21, v13
    v_permlane16_swap_b32 v22, v14
    v_permlane16_swap_b32 v23, v15
    s_nop 1
    v_add_f32 v12, v12, v20
    v_add_f32 v13, v13, v21
    v_add_f32 v14, v14, v22
    v_add_f32 v15, v15, v23
    s_mul_i32 s38, s33, 7168
    s_lshl_b32 s39, s35, 8
    s_add_u32 s38, s38, s39
    s_add_u32 s38, s38, 8130560
    v_lshlrev_b32 v17, 2, v1
    s_mov_b64 exec, 0xffff
    buffer_store_dword v12, v17, s[28:31], s38 offen offset:0 sc1
    buffer_store_dword v13, v17, s[28:31], s38 offen offset:64 sc1
    buffer_store_dword v14, v17, s[28:31], s38 offen offset:128 sc1
    buffer_store_dword v15, v17, s[28:31], s38 offen offset:192 sc1
    s_endpgm
prep_kernel_pk30:
    s_mov_b32 s24, s18
    s_mov_b32 s25, s19
    s_mov_b32 s26, 2211840
    s_mov_b32 s27, 0x00020000
    s_sub_u32 s32, s21, 94
    s_mul_i32 s33, s32, 52429
    s_lshr_b32 s33, s33, 19
    s_mul_i32 s35, s33, 10
    s_sub_u32 s35, s32, s35
    v_mul_u32_u24 v10, 1280, v3
    v_lshl_add_u32 v10, v4, 4, v10
    s_mul_i32 s36, s33, 368640
    s_lshl_b32 s37, s35, 7
    s_add_u32 s36, s36, s37
    buffer_load_dwordx4 v[32:35], v10, s[24:27], s36 offen nt
    s_add_u32 s36, s36, 10240
    buffer_load_dwordx4 v[36:39], v10, s[24:27], s36 offen nt
    s_add_u32 s36, s36, 10240
    buffer_load_dwordx4 v[40:43], v10, s[24:27], s36 offen nt
    s_add_u32 s36, s36, 10240
    buffer_load_dwordx4 v[44:47], v10, s[24:27], s36 offen nt
    s_add_u32 s36, s36, 10240
    buffer_load_dwordx4 v[48:51], v10, s[24:27], s36 offen nt
    s_add_u32 s36, s36, 10240
    buffer_load_dwordx4 v[52:55], v10, s[24:27], s36 offen nt
    s_add_u32 s36, s36, 10240
    buffer_load_dwordx4 v[56:59], v10, s[24:27], s36 offen nt
    s_add_u32 s36, s36, 10240
    buffer_load_dwordx4 v[60:63], v10, s[24:27], s36 offen nt
    s_add_u32 s36, s36, 10240
    buffer_load_dwordx4 v[64:67], v10, s[24:27], s36 offen nt
    s_add_u32 s36, s36, 10240
    buffer_load_dwordx4 v[68:71], v10, s[24:27], s36 offen nt
    s_add_u32 s36, s36, 10240
    buffer_load_dwordx4 v[72:75], v10, s[24:27], s36 offen nt
    s_add_u32 s36, s36, 10240
    buffer_load_dwordx4 v[76:79], v10, s[24:27], s36 offen nt
    s_add_u32 s36, s36, 10240
    buffer_load_dwordx4 v[80:83], v10, s[24:27], s36 offen nt
    s_add_u32 s36, s36, 10240
    buffer_load_dwordx4 v[84:87], v10, s[24:27], s36 offen nt
    s_add_u32 s36, s36, 10240
    buffer_load_dwordx4 v[88:91], v10, s[24:27], s36 offen nt
    s_add_u32 s36, s36, 10240
    buffer_load_dwordx4 v[92:95], v10, s[24:27], s36 offen nt
    s_add_u32 s36, s36, 10240
    buffer_load_dwordx4 v[96:99], v10, s[24:27], s36 offen nt
    s_add_u32 s36, s36, 10240
    buffer_load_dwordx4 v[100:103], v10, s[24:27], s36 offen nt
    s_add_u32 s36, s36, 10240
    buffer_load_dwordx4 v[104:107], v10, s[24:27], s36 offen nt
    s_add_u32 s36, s36, 10240
    buffer_load_dwordx4 v[108:111], v10, s[24:27], s36 offen nt
    s_add_u32 s36, s36, 10240
    buffer_load_dwordx4 v[112:115], v10, s[24:27], s36 offen nt
    s_add_u32 s36, s36, 10240
    buffer_load_dwordx4 v[116:119], v10, s[24:27], s36 offen nt
    s_add_u32 s36, s36, 10240
    buffer_load_dwordx4 v[120:123], v10, s[24:27], s36 offen nt
    s_add_u32 s36, s36, 10240
    buffer_load_dwordx4 v[124:127], v10, s[24:27], s36 offen nt
    s_add_u32 s36, s36, 10240
    buffer_load_dwordx4 v[128:131], v10, s[24:27], s36 offen nt
    s_add_u32 s36, s36, 10240
    buffer_load_dwordx4 v[132:135], v10, s[24:27], s36 offen nt
    s_add_u32 s36, s36, 10240
    buffer_load_dwordx4 v[136:139], v10, s[24:27], s36 offen nt
    s_add_u32 s36, s36, 10240
    buffer_load_dwordx4 v[140:143], v10, s[24:27], s36 offen nt
    s_add_u32 s36, s36, 10240
    buffer_load_dwordx4 v[144:147], v10, s[24:27], s36 offen nt
    s_add_u32 s36, s36, 10240
    buffer_load_dwordx4 v[148:151], v10, s[24:27], s36 offen nt
    s_add_u32 s36, s36, 10240
    buffer_load_dwordx4 v[152:155], v10, s[24:27], s36 offen nt
    s_add_u32 s36, s36, 10240
    buffer_load_dwordx4 v[156:159], v10, s[24:27], s36 offen nt
    s_add_u32 s36, s36, 10240
    buffer_load_dwordx4 v[160:163], v10, s[24:27], s36 offen nt
    s_add_u32 s36, s36, 10240
    buffer_load_dwordx4 v[164:167], v10, s[24:27], s36 offen nt
    s_add_u32 s36, s36, 10240
    buffer_load_dwordx4 v[168:171], v10, s[24:27], s36 offen nt
    s_add_u32 s36, s36, 10240
    buffer_load_dwordx4 v[172:175], v10, s[24:27], s36 offen nt
    s_lshl_b32 s36, s35, 2
    s_add_u32 s36, s36, 0
    s_mul_i32 s38, s36, 13108
    s_lshr_b32 s38, s38, 16
    s_mul_i32 s39, s38, 5
    s_sub_u32 s39, s36, s39
    s_sub_u32 s41, s39, 1
    s_cmp_eq_u32 s39, 0
    s_cselect_b32 s41, 4, s41
    s_and_b32 s40, s38, 1
    s_cmp_eq_u32 s40, 1
    s_cselect_b32 s39, s41, s39
    s_mul_i32 s40, s33, 21846
    s_lshr_b32 s40, s40, 16
    s_mul_i32 s41, s40, 3
    s_sub_u32 s41, s33, s41
    s_mul_i32 s37, s38, 270
    s_mul_i32 s41, s41, 90
    s_add_u32 s37, s37, s41
    s_mul_i32 s40, s40, 5
    s_add_u32 s37, s37, s40
    s_add_u32 s37, s37, s39
    s_lshl_b32 s37, s37, 10
    s_add_u32 s44, s37, 27168768
    s_movk_i32 s48, 10240
    s_lshl_b32 s36, s35, 2
    s_add_u32 s36, s36, 1
    s_mul_i32 s38, s36, 13108
    s_lshr_b32 s38, s38, 16
    s_mul_i32 s39, s38, 5
    s_sub_u32 s39, s36, s39
    s_sub_u32 s41, s39, 1
    s_cmp_eq_u32 s39, 0
    s_cselect_b32 s41, 4, s41
    s_and_b32 s40, s38, 1
    s_cmp_eq_u32 s40, 1
    s_cselect_b32 s39, s41, s39
    s_mul_i32 s40, s33, 21846
    s_lshr_b32 s40, s40, 16
    s_mul_i32 s41, s40, 3
    s_sub_u32 s41, s33, s41
    s_mul_i32 s37, s38, 270
    s_mul_i32 s41, s41, 90
    s_add_u32 s37, s37, s41
    s_mul_i32 s40, s40, 5
    s_add_u32 s37, s37, s40
    s_add_u32 s37, s37, s39
    s_lshl_b32 s37, s37, 10
    s_add_u32 s45, s37, 27168768
    s_movk_i32 s49, 10240
    s_lshl_b32 s36, s35, 2
    s_add_u32 s36, s36, 2
    s_mul_i32 s38, s36, 13108
    s_lshr_b32 s38, s38, 16
    s_mul_i32 s39, s38, 5
    s_sub_u32 s39, s36, s39
    s_sub_u32 s41, s39, 1
    s_cmp_eq_u32 s39, 0
    s_cselect_b32 s41, 4, s41
    s_and_b32 s40, s38, 1
    s_cmp_eq_u32 s40, 1
    s_cselect_b32 s39, s41, s39
    s_mul_i32 s40, s33, 21846
    s_lshr_b32 s40, s40, 16
    s_mul_i32 s41, s40, 3
    s_sub_u32 s41, s33, s41
    s_mul_i32 s37, s38, 270
    s_mul_i32 s41, s41, 90
    s_add_u32 s37, s37, s41
    s_mul_i32 s40, s40, 5
    s_add_u32 s37, s37, s40
    s_add_u32 s37, s37, s39
    s_lshl_b32 s37, s37, 10
    s_add_u32 s46, s37, 27168768
    s_movk_i32 s50, 10240
    s_lshl_b32 s36, s35, 2
    s_add_u32 s36, s36, 3
    s_mul_i32 s38, s36, 13108
    s_lshr_b32 s38, s38, 16
    s_mul_i32 s39, s38, 5
    s_sub_u32 s39, s36, s39
    s_sub_u32 s41, s39, 1
    s_cmp_eq_u32 s39, 0
    s_cselect_b32 s41, 4, s41
    s_and_b32 s40, s38, 1
    s_cmp_eq_u32 s40, 1
    s_cselect_b32 s39, s41, s39
    s_mul_i32 s40, s33, 21846
    s_lshr_b32 s40, s40, 16
    s_mul_i32 s41, s40, 3
    s_sub_u32 s41, s33, s41
    s_mul_i32 s37, s38, 270
    s_mul_i32 s41, s41, 90
    s_add_u32 s37, s37, s41
    s_mul_i32 s40, s40, 5
    s_add_u32 s37, s37, s40
    s_add_u32 s37, s37, s39
    s_lshl_b32 s37, s37, 10
    s_add_u32 s47, s37, 27168768
    s_movk_i32 s51, 10240
    s_waitcnt vmcnt(32)
    ds_write_b128 v5, v[32:35] offset:0
    ds_write_b128 v5, v[36:39] offset:1152
    ds_write_b128 v5, v[40:43] offset:2304
    ds_write_b128 v5, v[44:47] offset:3456
    s_waitcnt lgkmcnt(0)
    ds_read_b64_tr_b16 v[200:201], v8 offset:0
    ds_read_b64_tr_b16 v[202:203], v8 offset:576
    ds_read_b64_tr_b16 v[204:205], v8 offset:32
    ds_read_b64_tr_b16 v[206:207], v8 offset:608
    ds_read_b64_tr_b16 v[208:209], v8 offset:64
    ds_read_b64_tr_b16 v[210:211], v8 offset:640
    ds_read_b64_tr_b16 v[212:213], v8 offset:96
    ds_read_b64_tr_b16 v[214:215], v8 offset:672
    s_waitcnt vmcnt(28)
    ds_write_b128 v5, v[48:51] offset:4608
    ds_write_b128 v5, v[52:55] offset:5760
    ds_write_b128 v5, v[56:59] offset:6912
    ds_write_b128 v5, v[60:63] offset:8064
    s_waitcnt lgkmcnt(4)
    buffer_store_dwordx4 v[200:203], v9, s[28:31], s44 offen sc1
    s_add_u32 s44, s44, s48
    buffer_store_dwordx4 v[204:207], v9, s[28:31], s45 offen sc1
    s_add_u32 s45, s45, s49
    buffer_store_dwordx4 v[208:211], v9, s[28:31], s46 offen sc1
    s_add_u32 s46, s46, s50
    buffer_store_dwordx4 v[212:215], v9, s[28:31], s47 offen sc1
    s_add_u32 s47, s47, s51
    s_waitcnt lgkmcnt(0)
    ds_read_b64_tr_b16 v[216:217], v8 offset:4608
    ds_read_b64_tr_b16 v[218:219], v8 offset:5184
    ds_read_b64_tr_b16 v[220:221], v8 offset:4640
    ds_read_b64_tr_b16 v[222:223], v8 offset:5216
    ds_read_b64_tr_b16 v[224:225], v8 offset:4672
    ds_read_b64_tr_b16 v[226:227], v8 offset:5248
    ds_read_b64_tr_b16 v[228:229], v8 offset:4704
    ds_read_b64_tr_b16 v[230:231], v8 offset:5280
    s_waitcnt vmcnt(28)
    ds_write_b128 v5, v[64:67] offset:0
    ds_write_b128 v5, v[68:71] offset:1152
    ds_write_b128 v5, v[72:75] offset:2304
    ds_write_b128 v5, v[76:79] offset:3456
    s_waitcnt lgkmcnt(4)
    buffer_store_dwordx4 v[216:219], v9, s[28:31], s44 offen sc1
    s_add_u32 s44, s44, s48
    buffer_store_dwordx4 v[220:223], v9, s[28:31], s45 offen sc1
    s_add_u32 s45, s45, s49
    buffer_store_dwordx4 v[224:227], v9, s[28:31], s46 offen sc1
    s_add_u32 s46, s46, s50
    buffer_store_dwordx4 v[228:231], v9, s[28:31], s47 offen sc1
    s_add_u32 s47, s47, s51
    s_waitcnt lgkmcnt(0)
    ds_read_b64_tr_b16 v[200:201], v8 offset:0
    ds_read_b64_tr_b16 v[202:203], v8 offset:576
    ds_read_b64_tr_b16 v[204:205], v8 offset:32
    ds_read_b64_tr_b16 v[206:207], v8 offset:608
    ds_read_b64_tr_b16 v[208:209], v8 offset:64
    ds_read_b64_tr_b16 v[210:211], v8 offset:640
    ds_read_b64_tr_b16 v[212:213], v8 offset:96
    ds_read_b64_tr_b16 v[214:215], v8 offset:672
    s_waitcnt vmcnt(28)
    ds_write_b128 v5, v[80:83] offset:4608
    ds_write_b128 v5, v[84:87] offset:5760
    ds_write_b128 v5, v[88:91] offset:6912
    ds_write_b128 v5, v[92:95] offset:8064
    s_waitcnt lgkmcnt(4)
    buffer_store_dwordx4 v[200:203], v9, s[28:31], s44 offen sc1
    s_add_u32 s44, s44, s48
    buffer_store_dwordx4 v[204:207], v9, s[28:31], s45 offen sc1
    s_add_u32 s45, s45, s49
    buffer_store_dwordx4 v[208:211], v9, s[28:31], s46 offen sc1
    s_add_u32 s46, s46, s50
    buffer_store_dwordx4 v[212:215], v9, s[28:31], s47 offen sc1
    s_add_u32 s47, s47, s51
    s_waitcnt lgkmcnt(0)
    ds_read_b64_tr_b16 v[216:217], v8 offset:4608
    ds_read_b64_tr_b16 v[218:219], v8 offset:5184
    ds_read_b64_tr_b16 v[220:221], v8 offset:4640
    ds_read_b64_tr_b16 v[222:223], v8 offset:5216
    ds_read_b64_tr_b16 v[224:225], v8 offset:4672
    ds_read_b64_tr_b16 v[226:227], v8 offset:5248
    ds_read_b64_tr_b16 v[228:229], v8 offset:4704
    ds_read_b64_tr_b16 v[230:231], v8 offset:5280
    s_waitcnt vmcnt(28)
    ds_write_b128 v5, v[96:99] offset:0
    ds_write_b128 v5, v[100:103] offset:1152
    ds_write_b128 v5, v[104:107] offset:2304
    ds_write_b128 v5, v[108:111] offset:3456
    s_waitcnt lgkmcnt(4)
    buffer_store_dwordx4 v[216:219], v9, s[28:31], s44 offen sc1
    s_add_u32 s44, s44, s48
    buffer_store_dwordx4 v[220:223], v9, s[28:31], s45 offen sc1
    s_add_u32 s45, s45, s49
    buffer_store_dwordx4 v[224:227], v9, s[28:31], s46 offen sc1
    s_add_u32 s46, s46, s50
    buffer_store_dwordx4 v[228:231], v9, s[28:31], s47 offen sc1
    s_add_u32 s47, s47, s51
    s_waitcnt lgkmcnt(0)
    ds_read_b64_tr_b16 v[200:201], v8 offset:0
    ds_read_b64_tr_b16 v[202:203], v8 offset:576
    ds_read_b64_tr_b16 v[204:205], v8 offset:32
    ds_read_b64_tr_b16 v[206:207], v8 offset:608
    ds_read_b64_tr_b16 v[208:209], v8 offset:64
    ds_read_b64_tr_b16 v[210:211], v8 offset:640
    ds_read_b64_tr_b16 v[212:213], v8 offset:96
    ds_read_b64_tr_b16 v[214:215], v8 offset:672
    s_waitcnt vmcnt(28)
    ds_write_b128 v5, v[112:115] offset:4608
    ds_write_b128 v5, v[116:119] offset:5760
    ds_write_b128 v5, v[120:123] offset:6912
    ds_write_b128 v5, v[124:127] offset:8064
    s_waitcnt lgkmcnt(4)
    buffer_store_dwordx4 v[200:203], v9, s[28:31], s44 offen sc1
    s_add_u32 s44, s44, s48
    buffer_store_dwordx4 v[204:207], v9, s[28:31], s45 offen sc1
    s_add_u32 s45, s45, s49
    buffer_store_dwordx4 v[208:211], v9, s[28:31], s46 offen sc1
    s_add_u32 s46, s46, s50
    buffer_store_dwordx4 v[212:215], v9, s[28:31], s47 offen sc1
    s_add_u32 s47, s47, s51
    s_waitcnt lgkmcnt(0)
    ds_read_b64_tr_b16 v[216:217], v8 offset:4608
    ds_read_b64_tr_b16 v[218:219], v8 offset:5184
    ds_read_b64_tr_b16 v[220:221], v8 offset:4640
    ds_read_b64_tr_b16 v[222:223], v8 offset:5216
    ds_read_b64_tr_b16 v[224:225], v8 offset:4672
    ds_read_b64_tr_b16 v[226:227], v8 offset:5248
    ds_read_b64_tr_b16 v[228:229], v8 offset:4704
    ds_read_b64_tr_b16 v[230:231], v8 offset:5280
    s_waitcnt vmcnt(28)
    ds_write_b128 v5, v[128:131] offset:0
    ds_write_b128 v5, v[132:135] offset:1152
    ds_write_b128 v5, v[136:139] offset:2304
    ds_write_b128 v5, v[140:143] offset:3456
    s_waitcnt lgkmcnt(4)
    buffer_store_dwordx4 v[216:219], v9, s[28:31], s44 offen sc1
    s_add_u32 s44, s44, s48
    buffer_store_dwordx4 v[220:223], v9, s[28:31], s45 offen sc1
    s_add_u32 s45, s45, s49
    buffer_store_dwordx4 v[224:227], v9, s[28:31], s46 offen sc1
    s_add_u32 s46, s46, s50
    buffer_store_dwordx4 v[228:231], v9, s[28:31], s47 offen sc1
    s_add_u32 s47, s47, s51
    s_waitcnt lgkmcnt(0)
    ds_read_b64_tr_b16 v[200:201], v8 offset:0
    ds_read_b64_tr_b16 v[202:203], v8 offset:576
    ds_read_b64_tr_b16 v[204:205], v8 offset:32
    ds_read_b64_tr_b16 v[206:207], v8 offset:608
    ds_read_b64_tr_b16 v[208:209], v8 offset:64
    ds_read_b64_tr_b16 v[210:211], v8 offset:640
    ds_read_b64_tr_b16 v[212:213], v8 offset:96
    ds_read_b64_tr_b16 v[214:215], v8 offset:672
    s_waitcnt vmcnt(28)
    ds_write_b128 v5, v[144:147] offset:4608
    ds_write_b128 v5, v[148:151] offset:5760
    ds_write_b128 v5, v[152:155] offset:6912
    ds_write_b128 v5, v[156:159] offset:8064
    s_waitcnt lgkmcnt(4)
    buffer_store_dwordx4 v[200:203], v9, s[28:31], s44 offen sc1
    s_add_u32 s44, s44, s48
    buffer_store_dwordx4 v[204:207], v9, s[28:31], s45 offen sc1
    s_add_u32 s45, s45, s49
    buffer_store_dwordx4 v[208:211], v9, s[28:31], s46 offen sc1
    s_add_u32 s46, s46, s50
    buffer_store_dwordx4 v[212:215], v9, s[28:31], s47 offen sc1
    s_add_u32 s47, s47, s51
    s_waitcnt lgkmcnt(0)
    ds_read_b64_tr_b16 v[216:217], v8 offset:4608
    ds_read_b64_tr_b16 v[218:219], v8 offset:5184
    ds_read_b64_tr_b16 v[220:221], v8 offset:4640
    ds_read_b64_tr_b16 v[222:223], v8 offset:5216
    ds_read_b64_tr_b16 v[224:225], v8 offset:4672
    ds_read_b64_tr_b16 v[226:227], v8 offset:5248
    ds_read_b64_tr_b16 v[228:229], v8 offset:4704
    ds_read_b64_tr_b16 v[230:231], v8 offset:5280
    s_waitcnt vmcnt(28)
    ds_write_b128 v5, v[160:163] offset:0
    ds_write_b128 v5, v[164:167] offset:1152
    ds_write_b128 v5, v[168:171] offset:2304
    ds_write_b128 v5, v[172:175] offset:3456
    s_waitcnt lgkmcnt(4)
    buffer_store_dwordx4 v[216:219], v9, s[28:31], s44 offen sc1
    s_add_u32 s44, s44, s48
    buffer_store_dwordx4 v[220:223], v9, s[28:31], s45 offen sc1
    s_add_u32 s45, s45, s49
    buffer_store_dwordx4 v[224:227], v9, s[28:31], s46 offen sc1
    s_add_u32 s46, s46, s50
    buffer_store_dwordx4 v[228:231], v9, s[28:31], s47 offen sc1
    s_add_u32 s47, s47, s51
    s_waitcnt lgkmcnt(0)
    ds_read_b64_tr_b16 v[200:201], v8 offset:0
    ds_read_b64_tr_b16 v[202:203], v8 offset:576
    ds_read_b64_tr_b16 v[204:205], v8 offset:32
    ds_read_b64_tr_b16 v[206:207], v8 offset:608
    ds_read_b64_tr_b16 v[208:209], v8 offset:64
    ds_read_b64_tr_b16 v[210:211], v8 offset:640
    ds_read_b64_tr_b16 v[212:213], v8 offset:96
    ds_read_b64_tr_b16 v[214:215], v8 offset:672
    s_waitcnt lgkmcnt(0)
    buffer_store_dwordx4 v[200:203], v9, s[28:31], s44 offen sc1
    s_add_u32 s44, s44, s48
    buffer_store_dwordx4 v[204:207], v9, s[28:31], s45 offen sc1
    s_add_u32 s45, s45, s49
    buffer_store_dwordx4 v[208:211], v9, s[28:31], s46 offen sc1
    s_add_u32 s46, s46, s50
    buffer_store_dwordx4 v[212:215], v9, s[28:31], s47 offen sc1
    s_add_u32 s47, s47, s51
    s_endpgm
.globl chain_kernel
.p2align 8
.type chain_kernel,@function
chain_kernel:
    s_cmp_ge_u32 s2, 256
    s_cbranch_scc1 chain_end
    s_load_dwordx2 s[4:5], s[0:1], 0
    s_load_dwordx2 s[6:7], s[0:1], 104
    s_load_dwordx2 s[10:11], s[0:1], 120
    v_lshrrev_b32 v2, 6, v0
    v_and_b32 v1, 63, v0
    v_readfirstlane_b32 s20, v2
    s_and_b32 s25, s2, 7
    s_lshr_b32 s26, s2, 3
    s_lshl_b32 s23, s25, 3
    s_lshr_b32 s27, s26, 2
    s_add_u32 s23, s23, s27
    s_and_b32 s24, s26, 3
    s_and_b32 s21, s20, 1
    s_lshr_b32 s22, s20, 1
    v_lshrrev_b32 v3, 4, v1
    v_and_b32 v4, 15, v1
    v_lshlrev_b32 v8, 4, v1
    s_waitcnt lgkmcnt(0)
    s_mov_b32 s28, s10
    s_mov_b32 s29, s11
    s_mov_b32 s30, 268435456
    s_mov_b32 s31, 0x00020000
    s_mul_i32 s25, s20, 10240
    s_add_u32 s10, s25, 0
    s_mul_i32 s11, s23, 40960
    s_add_u32 s11, s11, s25
    s_add_u32 s11, s11, 5492736
    s_lshl_b32 s12, s20, 10
    s_add_u32 s13, s12, 8121856
    s_add_u32 s12, s12, 130560
    s_lshl_b32 s14, s21, 10
    s_add_u32 s14, s14, 139264
    s_mul_i32 s15, s21, 7168
    s_mul_i32 s25, s24, 640
    s_add_u32 s15, s15, s25
    s_add_u32 s15, s15, 8146944
    s_mov_b32 m0, s10
    s_add_u32 s10, s10, 4096
    buffer_load_dwordx4 v8, s[28:31], s11 offen offset:0 lds
    buffer_load_dwordx4 v8, s[28:31], s11 offen offset:1024 lds
    buffer_load_dwordx4 v8, s[28:31], s11 offen offset:2048 lds
    buffer_load_dwordx4 v8, s[28:31], s11 offen offset:3072 lds
    s_add_u32 s11, s11, 4096
    s_mov_b32 m0, s10
    s_add_u32 s10, s10, 4096
    buffer_load_dwordx4 v8, s[28:31], s11 offen offset:0 lds
    buffer_load_dwordx4 v8, s[28:31], s11 offen offset:1024 lds
    buffer_load_dwordx4 v8, s[28:31], s11 offen offset:2048 lds
    buffer_load_dwordx4 v8, s[28:31], s11 offen offset:3072 lds
    s_add_u32 s11, s11, 4096
    s_mov_b32 m0, s10
    s_add_u32 s10, s10, 4096
    buffer_load_dwordx4 v8, s[28:31], s11 offen offset:0 lds
    buffer_load_dwordx4 v8, s[28:31], s11 offen offset:1024 lds
    s_mov_b32 m0, s12
    s_nop 0
    buffer_load_dwordx4 v8, s[28:31], s13 offen lds
    s_mov_b32 m0, 134656
    s_mov_b32 s13, 8125952
    buffer_load_dwordx4 v8, s[28:31], s13 offen lds
    s_mov_b32 m0, s14
    s_nop 0
    buffer_load_dwordx4 v8, s[28:31], s15 offen lds
    s_mov_b32 s32, s6
    s_mov_b32 s33, s7
    s_mov_b32 s34, 2621440
    s_mov_b32 s35, 0x00020000
    s_mul_i32 s36, s24, 200
    s_mul_i32 s37, s21, 100
    s_add_u32 s36, s36, s37
    s_mul_i32 s37, s22, 50
    s_add_u32 s36, s36, s37
    s_lshl_b32 s36, s36, 10
    s_add_u32 s37, s36, 24055808
    s_add_u32 s36, s36, 23236608
    v_lshrrev_b32 v2, 1, v3
    s_lshl_b32 s26, s21, 2
    v_add_u32 v2, s26, v2
    v_and_b32 v7, 7, v4
    buffer_load_dwordx4 a[0:3], v8, s[28:31], s36 offen offset:0
    v_xor_b32 v2, v2, v7
    v_lshlrev_b32 v2, 4, v2
    v_lshl_add_u32 v226, v4, 8, v2
    v_and_b32 v2, 1, v3
    v_lshl_add_u32 v226, v2, 3, v226
    s_mul_i32 s26, s22, 20480
    s_add_u32 s27, s26, 0
    v_add_u32 v226, s27, v226
    v_lshlrev_b32 v227, 5, v4
    v_add_u32 v227, 122880, v227
    s_lshl_b32 s27, s21, 3
    v_add_u32 v2, s27, v3
    v_xor_b32 v2, v2, v7
    v_lshlrev_b32 v2, 4, v2
    v_and_b32 v7, 3, v4
    v_lshl_add_u32 v2, v7, 8, v2
    v_lshrrev_b32 v7, 2, v4
    buffer_load_dwordx4 a[4:7], v8, s[28:31], s36 offen offset:1024
    v_lshl_add_u32 v2, v7, 10, v2
    s_add_u32 s27, s26, 40960
    v_add_u32 v228, s27, v2
    v_xor_b32 v2, v4, v3
    v_lshlrev_b32 v2, 4, v2
    v_lshl_add_u32 v2, v3, 8, v2
    v_xor_b32 v7, 64, v2
    s_mul_i32 s26, s22, 30720
    s_add_u32 s26, s26, 40960
    s_mul_i32 s27, s22, 10240
    s_sub_u32 s27, 61440, s27
    v_add_u32 v229, s26, v2
    v_add_u32 v230, s26, v7
    v_add_u32 v231, s27, v2
    v_add_u32 v232, s27, v7
    v_lshlrev_b32 v2, 4, v3
    s_mul_i32 s26, s21, 384
    buffer_load_dwordx4 a[8:11], v8, s[28:31], s36 offen offset:2048
    s_add_u32 s26, s26, 139264
    v_add_u32 v233, s26, v2
    s_mul_i32 s26, s21, 64
    s_add_u32 s26, s26, 139520
    v_add_u32 v234, s26, v2
    s_lshl_b32 s26, s22, 7
    s_add_u32 s26, s26, 138240
    v_lshl_add_u32 v235, v4, 3, s26
    s_mul_i32 s39, s24, 5
    s_mul_i32 s40, s21, 3
    s_add_u32 s40, s40, s39
    s_add_u32 s41, s39, 2
    v_lshrrev_b32 v12, 1, v3
    v_and_b32 v13, 1, v3
    v_lshlrev_b32 v13, 3, v13
    s_add_u32 s26, s40, 0
    buffer_load_dwordx4 a[12:15], v8, s[28:31], s36 offen offset:3072
    v_add_u32 v14, 0, v12
    s_and_b32 s27, s26, 1
    s_lshl_b32 s27, s27, 2
    v_add_u32 v15, s27, v14
    v_xor_b32 v15, v15, v4
    v_lshlrev_b32 v15, 4, v15
    v_lshl_add_u32 v15, v14, 8, v15
    v_add_u32 v15, v15, v13
    s_mul_i32 s27, s22, 20
    s_add_u32 s27, s27, s26
    s_lshl_b32 s27, s27, 10
    s_add_u32 s27, s27, 40960
    v_add_u32 v236, s27, v15
    s_add_u32 s26, s40, 0
    v_add_u32 v14, 2, v12
    s_and_b32 s27, s26, 1
    s_lshl_b32 s27, s27, 2
    s_add_u32 s36, s36, 4096
    buffer_load_dwordx4 a[16:19], v8, s[28:31], s36 offen offset:0
    v_add_u32 v15, s27, v14
    v_xor_b32 v15, v15, v4
    v_lshlrev_b32 v15, 4, v15
    v_lshl_add_u32 v15, v14, 8, v15
    v_add_u32 v15, v15, v13
    s_mul_i32 s27, s22, 20
    s_add_u32 s27, s27, s26
    s_lshl_b32 s27, s27, 10
    s_add_u32 s27, s27, 40960
    v_add_u32 v237, s27, v15
    s_add_u32 s26, s40, 1
    v_add_u32 v14, 0, v12
    s_and_b32 s27, s26, 1
    s_lshl_b32 s27, s27, 2
    v_add_u32 v15, s27, v14
    v_xor_b32 v15, v15, v4
    v_lshlrev_b32 v15, 4, v15
    buffer_load_dwordx4 a[20:23], v8, s[28:31], s36 offen offset:1024
    v_lshl_add_u32 v15, v14, 8, v15
    v_add_u32 v15, v15, v13
    s_mul_i32 s27, s22, 20
    s_add_u32 s27, s27, s26
    s_lshl_b32 s27, s27, 10
    s_add_u32 s27, s27, 40960
    v_add_u32 v238, s27, v15
    s_add_u32 s26, s40, 1
    v_add_u32 v14, 2, v12
    s_and_b32 s27, s26, 1
    s_lshl_b32 s27, s27, 2
    v_add_u32 v15, s27, v14
    v_xor_b32 v15, v15, v4
    v_lshlrev_b32 v15, 4, v15
    v_lshl_add_u32 v15, v14, 8, v15
    v_add_u32 v15, v15, v13
    s_mul_i32 s27, s22, 20
    buffer_load_dwordx4 a[24:27], v8, s[28:31], s36 offen offset:2048
    s_add_u32 s27, s27, s26
    s_lshl_b32 s27, s27, 10
    s_add_u32 s27, s27, 40960
    v_add_u32 v239, s27, v15
    s_mov_b32 s26, s41
    s_lshl_b32 s27, s21, 1
    v_add_u32 v14, s27, v12
    s_and_b32 s27, s26, 1
    s_lshl_b32 s27, s27, 2
    v_add_u32 v15, s27, v14
    v_xor_b32 v15, v15, v4
    v_lshlrev_b32 v15, 4, v15
    v_lshl_add_u32 v15, v14, 8, v15
    v_add_u32 v15, v15, v13
    s_mul_i32 s27, s22, 20
    s_add_u32 s27, s27, s26
    s_lshl_b32 s27, s27, 10
    buffer_load_dwordx4 a[28:31], v8, s[28:31], s36 offen offset:3072
    s_add_u32 s27, s27, 40960
    v_add_u32 v240, s27, v15
    s_lshr_b32 s26, s24, 1
    s_add_u32 s26, s26, 1
    s_sub_u32 s27, 0, s26
    s_and_b32 s42, s24, 1
    s_cmp_eq_u32 s42, 1
    s_cselect_b32 s42, s27, s26
    s_lshl_b32 s43, s23, 5
    s_lshl_b32 s26, s22, 4
    s_add_u32 s43, s43, s26
    v_add_u32 v241, s43, v4
    v_add_u32 v241, s42, v241
    s_movk_i32 s27, 2048
    v_cmp_gt_u32 s[60:61], s27, v241
    v_lshrrev_b32 v242, 4, v241
    s_add_u32 s36, s36, 4096
    buffer_load_dwordx4 a[32:35], v8, s[28:31], s36 offen offset:0
    v_and_b32 v241, 15, v241
    s_mov_b32 s27, 20480
    v_mul_lo_u32 v242, v242, s27
    v_lshl_add_u32 v242, v241, 4, v242
    v_and_b32 v241, 1, v3
    v_lshlrev_b32 v241, 9, v241
    v_lshrrev_b32 v2, 1, v3
    v_lshl_add_u32 v241, v2, 8, v241
    v_add_u32 v241, v241, v242
    s_lshl_b32 s27, s21, 9
    v_lshl_add_u32 v242, v2, 8, v242
    v_add_u32 v242, s27, v242
    v_and_b32 v2, 1, v3
    v_lshl_add_u32 v242, v2, 3, v242
    v_add_u32 v243, s43, v4
    v_lshrrev_b32 v244, 4, v243
    v_and_b32 v243, 15, v243
    buffer_load_dwordx4 a[36:39], v8, s[28:31], s36 offen offset:1024
    s_mov_b32 s27, 20480
    v_mul_lo_u32 v244, v244, s27
    v_lshl_add_u32 v244, v243, 4, v244
    v_and_b32 v243, 1, v3
    v_lshlrev_b32 v243, 9, v243
    v_lshrrev_b32 v2, 1, v3
    v_lshl_add_u32 v243, v2, 8, v243
    v_add_u32 v243, v243, v244
    s_lshl_b32 s27, s21, 9
    v_lshl_add_u32 v244, v2, 8, v244
    v_add_u32 v244, s27, v244
    v_and_b32 v2, 1, v3
    v_lshl_add_u32 v244, v2, 3, v244
    s_lshl_b32 s44, s40, 10
    s_add_u32 s38, s44, 13406208
    s_add_u32 s44, s44, 10784768
    s_lshl_b32 s45, s41, 10
    buffer_load_dwordx4 a[40:43], v8, s[28:31], s36 offen offset:2048
    s_add_u32 s39, s45, 13406208
    s_add_u32 s45, s45, 10784768
    s_lshl_b32 s46, s23, 2
    s_add_u32 s46, s46, s24
    s_lshl_b32 s46, s46, 7
    s_add_u32 s49, s46, 29413376
    s_add_u32 s46, s46, 29380608
    v_add_u32 v7, 1, v1
    v_lshrrev_b32 v7, 1, v7
    v_add_u32 v7, s23, v7
    v_subrev_u32 v7, 1, v7
    v_max_i32 v7, 0, v7
    v_min_i32 v7, 63, v7
    v_lshrrev_b32 v2, 1, v1
    s_lshl_b32 s26, s22, 1
    v_add_u32 v2, s26, v2
    v_lshl_add_u32 v7, v7, 2, v2
    buffer_load_dwordx4 a[44:47], v8, s[28:31], s36 offen offset:3072
    v_lshlrev_b32 v245, 7, v7
    s_lshl_b32 s26, s23, 1
    s_add_u32 s27, s26, s22
    s_mul_i32 s27, s27, 20
    s_mul_i32 s3, s22, 10
    s_add_u32 s27, s27, s3
    s_lshl_b32 s27, s27, 10
    s_add_u32 s50, s27, 10784768
    s_add_u32 s27, s26, 1
    s_sub_u32 s27, s27, s22
    s_mul_i32 s27, s27, 20
    s_add_u32 s27, s27, s3
    s_lshl_b32 s27, s27, 10
    s_add_u32 s51, s27, 10784768
    s_mul_i32 s26, s20, 5120
    s_add_u32 s26, s26, 143360
    s_add_u32 s36, s36, 4096
    buffer_load_dwordx4 a[48:51], v8, s[28:31], s36 offen offset:0
    v_add_u32 v246, s26, v8
    s_xor_b32 s27, s20, 2
    s_mul_i32 s27, s27, 5120
    s_add_u32 s27, s27, 143360
    v_add_u32 v247, s27, v8
    s_lshr_b32 s26, s2, 3
    s_and_b32 s3, s2, 7
    s_and_b32 s4, s3, 1
    s_lshr_b32 s3, s3, 1
    s_and_b32 s52, s26, 7
    s_lshl_b32 s27, s4, 3
    s_add_u32 s52, s52, s27
    s_lshr_b32 s27, s26, 3
    s_lshl_b32 s53, s3, 2
    s_add_u32 s53, s53, s27
    s_and_b32 s57, s26, 3
    buffer_load_dwordx4 a[52:55], v8, s[28:31], s36 offen offset:1024
    s_lshl_b32 s27, s4, 2
    s_add_u32 s57, s57, s27
    s_lshr_b32 s27, s26, 2
    s_lshl_b32 s58, s3, 3
    s_add_u32 s58, s58, s27
    s_and_b32 s57, s26, 7
    s_lshr_b32 s27, s26, 3
    s_and_b32 s58, s2, 7
    s_lshl_b32 s58, s58, 2
    s_add_u32 s58, s58, s27
    s_mul_i32 s54, s52, 143360
    s_add_u32 s54, s54, 24875008
    s_mul_i32 s59, s57, 276480
    s_add_u32 s59, s59, 27168768
    v_mov_b32 v224, 0x3f803f80
    v_mov_b32 v216, 0
    buffer_load_dwordx4 a[56:59], v8, s[28:31], s36 offen offset:2048
    v_mov_b32 v217, 0
    v_mov_b32 v220, 0
    v_mov_b32 v221, 0
    v_mov_b32 v218, 0
    v_mov_b32 v219, 0
    v_mov_b32 v222, 0
    v_mov_b32 v223, 0
    buffer_load_dwordx4 a[60:63], v8, s[28:31], s36 offen offset:3072
    s_add_u32 s36, s36, 4096
    buffer_load_dwordx4 a[64:67], v8, s[28:31], s36 offen offset:0
    s_waitcnt vmcnt(17)
    s_barrier
    buffer_load_dwordx4 a[68:71], v8, s[28:31], s36 offen offset:1024
    v_xor_b32 v12, 32, v226
    ds_read_b64 v[32:33], v226 offset:0
    ds_read_b64 v[34:35], v226 offset:128
    ds_read_b64 v[36:37], v12 offset:0
    ds_read_b64 v[38:39], v12 offset:128
    ds_read_b64 v[40:41], v226 offset:4096
    ds_read_b64 v[42:43], v226 offset:4224
    buffer_load_dwordx4 a[72:75], v8, s[28:31], s36 offen offset:2048
    s_waitcnt lgkmcnt(4)
    v_dot2_f32_bf16 v220, v32, v224, v220
    v_lshlrev_b32 v72, 16, v32
    v_dot2_f32_bf16 v221, v32, v32, v221
    v_and_b32 v73, 0xffff0000, v32
    v_dot2_f32_bf16 v220, v33, v224, v220
    ds_read_b64 v[44:45], v12 offset:4096
    v_lshlrev_b32 v74, 16, v33
    v_dot2_f32_bf16 v221, v33, v33, v221
    v_and_b32 v75, 0xffff0000, v33
    v_dot2_f32_bf16 v220, v34, v224, v220
    ds_read_b64 v[46:47], v12 offset:4224
    v_lshlrev_b32 v76, 16, v34
    buffer_load_dwordx4 a[76:79], v8, s[28:31], s36 offen offset:3072
    v_dot2_f32_bf16 v221, v34, v34, v221
    v_and_b32 v77, 0xffff0000, v34
    v_dot2_f32_bf16 v220, v35, v224, v220
    v_lshlrev_b32 v78, 16, v35
    v_dot2_f32_bf16 v221, v35, v35, v221
    v_and_b32 v79, 0xffff0000, v35
    s_waitcnt lgkmcnt(4)
    v_dot2_f32_bf16 v222, v36, v224, v222
    v_lshlrev_b32 v80, 16, v36
    v_dot2_f32_bf16 v223, v36, v36, v223
    v_and_b32 v81, 0xffff0000, v36
    v_dot2_f32_bf16 v222, v37, v224, v222
    ds_read_b64 v[48:49], v226 offset:8192
    v_lshlrev_b32 v82, 16, v37
    v_dot2_f32_bf16 v223, v37, v37, v223
    s_add_u32 s36, s36, 4096
    buffer_load_dwordx4 a[80:83], v8, s[28:31], s36 offen offset:0
    v_and_b32 v83, 0xffff0000, v37
    v_dot2_f32_bf16 v222, v38, v224, v222
    ds_read_b64 v[50:51], v226 offset:8320
    v_lshlrev_b32 v84, 16, v38
    v_dot2_f32_bf16 v223, v38, v38, v223
    v_and_b32 v85, 0xffff0000, v38
    v_dot2_f32_bf16 v222, v39, v224, v222
    v_lshlrev_b32 v86, 16, v39
    v_dot2_f32_bf16 v223, v39, v39, v223
    v_and_b32 v87, 0xffff0000, v39
    s_waitcnt lgkmcnt(4)
    v_dot2_f32_bf16 v220, v40, v224, v220
    v_lshlrev_b32 v88, 16, v40
    v_dot2_f32_bf16 v221, v40, v40, v221
    v_and_b32 v89, 0xffff0000, v40
    buffer_load_dwordx4 a[84:87], v8, s[28:31], s36 offen offset:1024
    v_dot2_f32_bf16 v220, v41, v224, v220
    ds_read_b64 v[52:53], v12 offset:8192
    v_lshlrev_b32 v90, 16, v41
    v_dot2_f32_bf16 v221, v41, v41, v221
    v_and_b32 v91, 0xffff0000, v41
    v_dot2_f32_bf16 v220, v42, v224, v220
    ds_read_b64 v[54:55], v12 offset:8320
    v_lshlrev_b32 v92, 16, v42
    v_dot2_f32_bf16 v221, v42, v42, v221
    v_and_b32 v93, 0xffff0000, v42
    v_dot2_f32_bf16 v220, v43, v224, v220
    v_lshlrev_b32 v94, 16, v43
    v_dot2_f32_bf16 v221, v43, v43, v221
    buffer_load_dwordx4 a[88:91], v8, s[28:31], s36 offen offset:2048
    v_and_b32 v95, 0xffff0000, v43
    s_waitcnt lgkmcnt(4)
    v_dot2_f32_bf16 v222, v44, v224, v222
    v_lshlrev_b32 v96, 16, v44
    v_dot2_f32_bf16 v223, v44, v44, v223
    v_and_b32 v97, 0xffff0000, v44
    v_dot2_f32_bf16 v222, v45, v224, v222
    ds_read_b64 v[56:57], v226 offset:12288
    v_lshlrev_b32 v98, 16, v45
    v_dot2_f32_bf16 v223, v45, v45, v223
    v_and_b32 v99, 0xffff0000, v45
    v_dot2_f32_bf16 v222, v46, v224, v222
    ds_read_b64 v[58:59], v226 offset:12416
    buffer_load_dwordx4 a[92:95], v8, s[28:31], s36 offen offset:3072
    v_lshlrev_b32 v100, 16, v46
    v_dot2_f32_bf16 v223, v46, v46, v223
    v_and_b32 v101, 0xffff0000, v46
    v_dot2_f32_bf16 v222, v47, v224, v222
    v_lshlrev_b32 v102, 16, v47
    v_dot2_f32_bf16 v223, v47, v47, v223
    v_and_b32 v103, 0xffff0000, v47
    s_waitcnt lgkmcnt(4)
    v_dot2_f32_bf16 v220, v48, v224, v220
    v_lshlrev_b32 v104, 16, v48
    v_dot2_f32_bf16 v221, v48, v48, v221
    v_and_b32 v105, 0xffff0000, v48
    v_dot2_f32_bf16 v220, v49, v224, v220
    ds_read_b64 v[60:61], v12 offset:12288
    v_lshlrev_b32 v106, 16, v49
    s_add_u32 s36, s36, 4096
    buffer_load_dwordx4 a[96:99], v8, s[28:31], s36 offen offset:0
    v_dot2_f32_bf16 v221, v49, v49, v221
    v_and_b32 v107, 0xffff0000, v49
    v_dot2_f32_bf16 v220, v50, v224, v220
    ds_read_b64 v[62:63], v12 offset:12416
    v_lshlrev_b32 v108, 16, v50
    v_dot2_f32_bf16 v221, v50, v50, v221
    v_and_b32 v109, 0xffff0000, v50
    v_dot2_f32_bf16 v220, v51, v224, v220
    v_lshlrev_b32 v110, 16, v51
    v_dot2_f32_bf16 v221, v51, v51, v221
    v_and_b32 v111, 0xffff0000, v51
    s_waitcnt lgkmcnt(4)
    v_dot2_f32_bf16 v222, v52, v224, v222
    v_lshlrev_b32 v112, 16, v52
    v_dot2_f32_bf16 v223, v52, v52, v223
    buffer_load_dwordx4 a[100:103], v8, s[28:31], s36 offen offset:1024
    v_and_b32 v113, 0xffff0000, v52
    v_dot2_f32_bf16 v222, v53, v224, v222
    ds_read_b64 v[64:65], v226 offset:16384
    v_lshlrev_b32 v114, 16, v53
    v_dot2_f32_bf16 v223, v53, v53, v223
    v_and_b32 v115, 0xffff0000, v53
    v_dot2_f32_bf16 v222, v54, v224, v222
    ds_read_b64 v[66:67], v226 offset:16512
    v_lshlrev_b32 v116, 16, v54
    v_dot2_f32_bf16 v223, v54, v54, v223
    v_and_b32 v117, 0xffff0000, v54
    v_dot2_f32_bf16 v222, v55, v224, v222
    v_lshlrev_b32 v118, 16, v55
    buffer_load_dwordx4 a[104:107], v8, s[28:31], s36 offen offset:2048
    v_dot2_f32_bf16 v223, v55, v55, v223
    v_and_b32 v119, 0xffff0000, v55
    s_waitcnt lgkmcnt(4)
    v_dot2_f32_bf16 v220, v56, v224, v220
    v_lshlrev_b32 v120, 16, v56
    v_dot2_f32_bf16 v221, v56, v56, v221
    v_and_b32 v121, 0xffff0000, v56
    v_dot2_f32_bf16 v220, v57, v224, v220
    ds_read_b64 v[68:69], v12 offset:16384
    v_lshlrev_b32 v122, 16, v57
    v_dot2_f32_bf16 v221, v57, v57, v221
    v_and_b32 v123, 0xffff0000, v57
    v_dot2_f32_bf16 v220, v58, v224, v220
    ds_read_b64 v[70:71], v12 offset:16512
    buffer_load_dwordx4 a[108:111], v8, s[28:31], s36 offen offset:3072
    v_lshlrev_b32 v124, 16, v58
    v_dot2_f32_bf16 v221, v58, v58, v221
    v_and_b32 v125, 0xffff0000, v58
    v_dot2_f32_bf16 v220, v59, v224, v220
    v_lshlrev_b32 v126, 16, v59
    v_dot2_f32_bf16 v221, v59, v59, v221
    v_and_b32 v127, 0xffff0000, v59
    s_waitcnt lgkmcnt(4)
    v_dot2_f32_bf16 v222, v60, v224, v222
    v_lshlrev_b32 v128, 16, v60
    v_dot2_f32_bf16 v223, v60, v60, v223
    v_and_b32 v129, 0xffff0000, v60
    v_dot2_f32_bf16 v222, v61, v224, v222
    v_lshlrev_b32 v130, 16, v61
    v_dot2_f32_bf16 v223, v61, v61, v223
    v_and_b32 v131, 0xffff0000, v61
    v_dot2_f32_bf16 v222, v62, v224, v222
    s_add_u32 s36, s36, 4096
    buffer_load_dwordx4 a[112:115], v8, s[28:31], s36 offen offset:0
    v_lshlrev_b32 v132, 16, v62
    v_dot2_f32_bf16 v223, v62, v62, v223
    v_and_b32 v133, 0xffff0000, v62
    v_dot2_f32_bf16 v222, v63, v224, v222
    v_lshlrev_b32 v134, 16, v63
    v_dot2_f32_bf16 v223, v63, v63, v223
    v_and_b32 v135, 0xffff0000, v63
    s_waitcnt lgkmcnt(2)
    v_dot2_f32_bf16 v220, v64, v224, v220
    v_lshlrev_b32 v136, 16, v64
    v_dot2_f32_bf16 v221, v64, v64, v221
    v_and_b32 v137, 0xffff0000, v64
    v_dot2_f32_bf16 v220, v65, v224, v220
    v_lshlrev_b32 v138, 16, v65
    v_dot2_f32_bf16 v221, v65, v65, v221
    v_and_b32 v139, 0xffff0000, v65
    v_dot2_f32_bf16 v220, v66, v224, v220
    buffer_load_dwordx4 a[116:119], v8, s[28:31], s36 offen offset:1024
    v_lshlrev_b32 v140, 16, v66
    v_dot2_f32_bf16 v221, v66, v66, v221
    v_and_b32 v141, 0xffff0000, v66
    v_dot2_f32_bf16 v220, v67, v224, v220
    v_lshlrev_b32 v142, 16, v67
    v_dot2_f32_bf16 v221, v67, v67, v221
    v_and_b32 v143, 0xffff0000, v67
    s_waitcnt lgkmcnt(0)
    v_dot2_f32_bf16 v222, v68, v224, v222
    v_lshlrev_b32 v144, 16, v68
    v_dot2_f32_bf16 v223, v68, v68, v223
    v_and_b32 v145, 0xffff0000, v68
    v_dot2_f32_bf16 v222, v69, v224, v222
    v_lshlrev_b32 v146, 16, v69
    v_dot2_f32_bf16 v223, v69, v69, v223
    v_and_b32 v147, 0xffff0000, v69
    v_dot2_f32_bf16 v222, v70, v224, v222
    buffer_load_dwordx4 a[120:123], v8, s[28:31], s36 offen offset:2048
    v_lshlrev_b32 v148, 16, v70
    v_dot2_f32_bf16 v223, v70, v70, v223
    v_and_b32 v149, 0xffff0000, v70
    v_dot2_f32_bf16 v222, v71, v224, v222
    v_lshlrev_b32 v150, 16, v71
    v_dot2_f32_bf16 v223, v71, v71, v223
    v_and_b32 v151, 0xffff0000, v71
    s_nop 2
    s_nop 1
    v_add_f32_dpp v220, v220, v220 quad_perm:[1,0,3,2] row_mask:0xf bank_mask:0xf
    v_add_f32_dpp v221, v221, v221 quad_perm:[1,0,3,2] row_mask:0xf bank_mask:0xf
    v_add_f32_dpp v222, v222, v222 quad_perm:[1,0,3,2] row_mask:0xf bank_mask:0xf
    v_add_f32_dpp v223, v223, v223 quad_perm:[1,0,3,2] row_mask:0xf bank_mask:0xf
    v_add_f32_dpp v220, v220, v220 quad_perm:[2,3,0,1] row_mask:0xf bank_mask:0xf
    v_add_f32_dpp v221, v221, v221 quad_perm:[2,3,0,1] row_mask:0xf bank_mask:0xf
    v_add_f32_dpp v222, v222, v222 quad_perm:[2,3,0,1] row_mask:0xf bank_mask:0xf
    v_add_f32_dpp v223, v223, v223 quad_perm:[2,3,0,1] row_mask:0xf bank_mask:0xf
    buffer_load_dwordx4 a[124:127], v8, s[28:31], s36 offen offset:3072
    v_add_f32_dpp v220, v220, v220 row_half_mirror row_mask:0xf bank_mask:0xf
    v_add_f32_dpp v221, v221, v221 row_half_mirror row_mask:0xf bank_mask:0xf
    v_add_f32_dpp v222, v222, v222 row_half_mirror row_mask:0xf bank_mask:0xf
    v_add_f32_dpp v223, v223, v223 row_half_mirror row_mask:0xf bank_mask:0xf
    v_add_f32_dpp v220, v220, v220 row_mirror row_mask:0xf bank_mask:0xf
    v_add_f32_dpp v221, v221, v221 row_mirror row_mask:0xf bank_mask:0xf
    v_add_f32_dpp v222, v222, v222 row_mirror row_mask:0xf bank_mask:0xf
    v_add_f32_dpp v223, v223, v223 row_mirror row_mask:0xf bank_mask:0xf
    v_mul_f32 v220, 0x3acccccd, v220
    v_mul_f32 v222, 0x3acccccd, v222
    v_mul_f32 v221, 0x3acccccd, v221
    v_mul_f32 v223, 0x3acccccd, v223
    v_fma_f32 v221, -v220, v220, v221
    v_fma_f32 v223, -v222, v222, v223
    v_max_f32 v221, 0, v221
    v_max_f32 v223, 0, v223
    v_cvt_pk_bf16_f32 v192, v220, v221
    s_add_u32 s36, s36, 4096
    buffer_load_dwordx4 a[128:131], v8, s[28:31], s36 offen offset:0
    v_cvt_pk_bf16_f32 v193, v222, v223
    v_lshlrev_b32 v220, 16, v192
    v_lshlrev_b32 v222, 16, v193
    v_and_b32 v221, 0xffff0000, v192
    v_and_b32 v223, 0xffff0000, v193
    v_add_f32 v221, 0x3727c5ac, v221
    v_add_f32 v223, 0x3727c5ac, v223
    v_cvt_pk_bf16_f32 v192, v221, v221
    v_cvt_pk_bf16_f32 v193, v223, v223
    v_lshlrev_b32 v221, 16, v192
    v_lshlrev_b32 v223, 16, v193
    v_sqrt_f32 v221, v221
    v_sqrt_f32 v223, v223
    s_nop 0
    s_nop 0
    v_cvt_pk_bf16_f32 v192, v221, v221
    buffer_load_dwordx4 a[132:135], v8, s[28:31], s36 offen offset:1024
    v_cvt_pk_bf16_f32 v193, v223, v223
    v_lshlrev_b32 v221, 16, v192
    v_lshlrev_b32 v223, 16, v193
    v_rcp_f32 v221, v221
    v_rcp_f32 v223, v223
    s_nop 0
    s_nop 0
    v_mul_f32 v220, v220, v221
    v_mul_f32 v222, v222, v223
    v_sub_f32 v220, 0, v220
    v_sub_f32 v222, 0, v222
    v_mov_b32 v216, 0
    v_mov_b32 v217, 0
    v_mov_b32 v218, 0
    v_mov_b32 v219, 0
    buffer_load_dwordx4 a[136:139], v8, s[28:31], s36 offen offset:2048
    v_xor_b32 v12, 64, v228
    ds_read_b128 v[152:155], v227 offset:10240
    ds_read_b128 v[156:159], v227 offset:10256
    ds_read_b128 v[160:163], v227 offset:7680
    ds_read_b128 v[164:167], v227 offset:7696
    s_waitcnt lgkmcnt(0)
    v_pk_fma_f32 v[72:73], v[72:73], v[220:221], v[220:221] op_sel:[0,1,0] op_sel_hi:[1,1,0]
    v_pk_fma_f32 v[74:75], v[74:75], v[220:221], v[220:221] op_sel:[0,1,0] op_sel_hi:[1,1,0]
    v_pk_fma_f32 v[76:77], v[76:77], v[220:221], v[220:221] op_sel:[0,1,0] op_sel_hi:[1,1,0]
    buffer_load_dwordx4 a[140:143], v8, s[28:31], s36 offen offset:3072
    ds_read_b128 v[168:171], v227 offset:10752
    v_pk_fma_f32 v[78:79], v[78:79], v[220:221], v[220:221] op_sel:[0,1,0] op_sel_hi:[1,1,0]
    v_pk_fma_f32 v[72:73], v[72:73], v[152:153], v[160:161]
    v_pk_fma_f32 v[74:75], v[74:75], v[154:155], v[162:163]
    ds_read_b128 v[172:175], v227 offset:10768
    v_pk_fma_f32 v[76:77], v[76:77], v[156:157], v[164:165]
    v_pk_fma_f32 v[78:79], v[78:79], v[158:159], v[166:167]
    v_cvt_pk_bf16_f32 v32, v72, v73
    ds_read_b128 v[176:179], v227 offset:8192
    v_cvt_pk_bf16_f32 v33, v74, v75
    v_cvt_pk_bf16_f32 v34, v76, v77
    s_add_u32 s36, s36, 4096
    buffer_load_dwordx4 a[144:147], v8, s[28:31], s36 offen offset:0
    v_cvt_pk_bf16_f32 v35, v78, v79
    ds_read_b128 v[180:183], v227 offset:8208
    v_dot2_f32_bf16 v216, v32, v224, v216
    v_dot2_f32_bf16 v217, v32, v32, v217
    v_dot2_f32_bf16 v216, v33, v224, v216
    v_dot2_f32_bf16 v217, v33, v33, v217
    v_dot2_f32_bf16 v216, v34, v224, v216
    v_dot2_f32_bf16 v217, v34, v34, v217
    v_dot2_f32_bf16 v216, v35, v224, v216
    v_dot2_f32_bf16 v217, v35, v35, v217
    ds_write_b128 v228, v[32:35] offset:0
    buffer_load_dwordx4 a[148:151], v8, s[28:31], s36 offen offset:1024
    v_pk_fma_f32 v[80:81], v[80:81], v[222:223], v[222:223] op_sel:[0,1,0] op_sel_hi:[1,1,0]
    v_pk_fma_f32 v[82:83], v[82:83], v[222:223], v[222:223] op_sel:[0,1,0] op_sel_hi:[1,1,0]
    v_pk_fma_f32 v[84:85], v[84:85], v[222:223], v[222:223] op_sel:[0,1,0] op_sel_hi:[1,1,0]
    v_pk_fma_f32 v[86:87], v[86:87], v[222:223], v[222:223] op_sel:[0,1,0] op_sel_hi:[1,1,0]
    v_pk_fma_f32 v[80:81], v[80:81], v[152:153], v[160:161]
    v_pk_fma_f32 v[82:83], v[82:83], v[154:155], v[162:163]
    v_pk_fma_f32 v[84:85], v[84:85], v[156:157], v[164:165]
    v_pk_fma_f32 v[86:87], v[86:87], v[158:159], v[166:167]
    v_cvt_pk_bf16_f32 v36, v80, v81
    v_cvt_pk_bf16_f32 v37, v82, v83
    v_cvt_pk_bf16_f32 v38, v84, v85
    v_cvt_pk_bf16_f32 v39, v86, v87
    v_dot2_f32_bf16 v218, v36, v224, v218
    v_dot2_f32_bf16 v219, v36, v36, v219
    v_dot2_f32_bf16 v218, v37, v224, v218
    v_dot2_f32_bf16 v219, v37, v37, v219
    v_dot2_f32_bf16 v218, v38, v224, v218
    buffer_load_dwordx4 a[152:155], v8, s[28:31], s36 offen offset:2048
    v_dot2_f32_bf16 v219, v38, v38, v219
    v_dot2_f32_bf16 v218, v39, v224, v218
    v_dot2_f32_bf16 v219, v39, v39, v219
    ds_write_b128 v12, v[36:39] offset:0
    s_waitcnt lgkmcnt(1)
    v_pk_fma_f32 v[88:89], v[88:89], v[220:221], v[220:221] op_sel:[0,1,0] op_sel_hi:[1,1,0]
    v_pk_fma_f32 v[90:91], v[90:91], v[220:221], v[220:221] op_sel:[0,1,0] op_sel_hi:[1,1,0]
    v_pk_fma_f32 v[92:93], v[92:93], v[220:221], v[220:221] op_sel:[0,1,0] op_sel_hi:[1,1,0]
    ds_read_b128 v[152:155], v227 offset:11264
    buffer_load_dwordx4 a[156:159], v8, s[28:31], s36 offen offset:3072
    v_pk_fma_f32 v[94:95], v[94:95], v[220:221], v[220:221] op_sel:[0,1,0] op_sel_hi:[1,1,0]
    v_pk_fma_f32 v[88:89], v[88:89], v[168:169], v[176:177]
    v_pk_fma_f32 v[90:91], v[90:91], v[170:171], v[178:179]
    ds_read_b128 v[156:159], v227 offset:11280
    v_pk_fma_f32 v[92:93], v[92:93], v[172:173], v[180:181]
    v_pk_fma_f32 v[94:95], v[94:95], v[174:175], v[182:183]
    v_cvt_pk_bf16_f32 v40, v88, v89
    ds_read_b128 v[160:163], v227 offset:8704
    v_cvt_pk_bf16_f32 v41, v90, v91
    v_cvt_pk_bf16_f32 v42, v92, v93
    v_cvt_pk_bf16_f32 v43, v94, v95
    ds_read_b128 v[164:167], v227 offset:8720
    s_add_u32 s36, s36, 4096
    buffer_load_dwordx4 a[160:163], v8, s[28:31], s36 offen offset:0
    v_dot2_f32_bf16 v216, v40, v224, v216
    v_dot2_f32_bf16 v217, v40, v40, v217
    v_dot2_f32_bf16 v216, v41, v224, v216
    v_dot2_f32_bf16 v217, v41, v41, v217
    v_dot2_f32_bf16 v216, v42, v224, v216
    v_dot2_f32_bf16 v217, v42, v42, v217
    v_dot2_f32_bf16 v216, v43, v224, v216
    v_dot2_f32_bf16 v217, v43, v43, v217
    ds_write_b128 v228, v[40:43] offset:4096
    v_pk_fma_f32 v[96:97], v[96:97], v[222:223], v[222:223] op_sel:[0,1,0] op_sel_hi:[1,1,0]
    buffer_load_dwordx4 a[164:167], v8, s[28:31], s36 offen offset:1024
    v_pk_fma_f32 v[98:99], v[98:99], v[222:223], v[222:223] op_sel:[0,1,0] op_sel_hi:[1,1,0]
    v_pk_fma_f32 v[100:101], v[100:101], v[222:223], v[222:223] op_sel:[0,1,0] op_sel_hi:[1,1,0]
    v_pk_fma_f32 v[102:103], v[102:103], v[222:223], v[222:223] op_sel:[0,1,0] op_sel_hi:[1,1,0]
    v_pk_fma_f32 v[96:97], v[96:97], v[168:169], v[176:177]
    v_pk_fma_f32 v[98:99], v[98:99], v[170:171], v[178:179]
    v_pk_fma_f32 v[100:101], v[100:101], v[172:173], v[180:181]
    v_pk_fma_f32 v[102:103], v[102:103], v[174:175], v[182:183]
    v_cvt_pk_bf16_f32 v44, v96, v97
    v_cvt_pk_bf16_f32 v45, v98, v99
    v_cvt_pk_bf16_f32 v46, v100, v101
    v_cvt_pk_bf16_f32 v47, v102, v103
    v_dot2_f32_bf16 v218, v44, v224, v218
    v_dot2_f32_bf16 v219, v44, v44, v219
    v_dot2_f32_bf16 v218, v45, v224, v218
    v_dot2_f32_bf16 v219, v45, v45, v219
    v_dot2_f32_bf16 v218, v46, v224, v218
    v_dot2_f32_bf16 v219, v46, v46, v219
    buffer_load_dwordx4 a[168:171], v8, s[28:31], s36 offen offset:2048
    v_dot2_f32_bf16 v218, v47, v224, v218
    v_dot2_f32_bf16 v219, v47, v47, v219
    ds_write_b128 v12, v[44:47] offset:4096
    s_waitcnt lgkmcnt(1)
    v_pk_fma_f32 v[104:105], v[104:105], v[220:221], v[220:221] op_sel:[0,1,0] op_sel_hi:[1,1,0]
    v_pk_fma_f32 v[106:107], v[106:107], v[220:221], v[220:221] op_sel:[0,1,0] op_sel_hi:[1,1,0]
    v_pk_fma_f32 v[108:109], v[108:109], v[220:221], v[220:221] op_sel:[0,1,0] op_sel_hi:[1,1,0]
    ds_read_b128 v[168:171], v227 offset:11776
    buffer_load_dwordx4 a[172:175], v8, s[28:31], s36 offen offset:3072
    v_pk_fma_f32 v[110:111], v[110:111], v[220:221], v[220:221] op_sel:[0,1,0] op_sel_hi:[1,1,0]
    v_pk_fma_f32 v[104:105], v[104:105], v[152:153], v[160:161]
    v_pk_fma_f32 v[106:107], v[106:107], v[154:155], v[162:163]
    ds_read_b128 v[172:175], v227 offset:11792
    v_pk_fma_f32 v[108:109], v[108:109], v[156:157], v[164:165]
    v_pk_fma_f32 v[110:111], v[110:111], v[158:159], v[166:167]
    v_cvt_pk_bf16_f32 v48, v104, v105
    ds_read_b128 v[176:179], v227 offset:9216
    v_cvt_pk_bf16_f32 v49, v106, v107
    v_cvt_pk_bf16_f32 v50, v108, v109
    v_cvt_pk_bf16_f32 v51, v110, v111
    ds_read_b128 v[180:183], v227 offset:9232
    s_add_u32 s36, s36, 4096
    buffer_load_dwordx4 a[176:179], v8, s[28:31], s36 offen offset:0
    v_dot2_f32_bf16 v216, v48, v224, v216
    v_dot2_f32_bf16 v217, v48, v48, v217
    v_dot2_f32_bf16 v216, v49, v224, v216
    v_dot2_f32_bf16 v217, v49, v49, v217
    v_dot2_f32_bf16 v216, v50, v224, v216
    v_dot2_f32_bf16 v217, v50, v50, v217
    v_dot2_f32_bf16 v216, v51, v224, v216
    v_dot2_f32_bf16 v217, v51, v51, v217
    ds_write_b128 v228, v[48:51] offset:8192
    v_pk_fma_f32 v[112:113], v[112:113], v[222:223], v[222:223] op_sel:[0,1,0] op_sel_hi:[1,1,0]
    buffer_load_dwordx4 a[180:183], v8, s[28:31], s36 offen offset:1024
    v_pk_fma_f32 v[114:115], v[114:115], v[222:223], v[222:223] op_sel:[0,1,0] op_sel_hi:[1,1,0]
    v_pk_fma_f32 v[116:117], v[116:117], v[222:223], v[222:223] op_sel:[0,1,0] op_sel_hi:[1,1,0]
    v_pk_fma_f32 v[118:119], v[118:119], v[222:223], v[222:223] op_sel:[0,1,0] op_sel_hi:[1,1,0]
    v_pk_fma_f32 v[112:113], v[112:113], v[152:153], v[160:161]
    v_pk_fma_f32 v[114:115], v[114:115], v[154:155], v[162:163]
    v_pk_fma_f32 v[116:117], v[116:117], v[156:157], v[164:165]
    v_pk_fma_f32 v[118:119], v[118:119], v[158:159], v[166:167]
    v_cvt_pk_bf16_f32 v52, v112, v113
    v_cvt_pk_bf16_f32 v53, v114, v115
    v_cvt_pk_bf16_f32 v54, v116, v117
    v_cvt_pk_bf16_f32 v55, v118, v119
    v_dot2_f32_bf16 v218, v52, v224, v218
    v_dot2_f32_bf16 v219, v52, v52, v219
    v_dot2_f32_bf16 v218, v53, v224, v218
    v_dot2_f32_bf16 v219, v53, v53, v219
    v_dot2_f32_bf16 v218, v54, v224, v218
    v_dot2_f32_bf16 v219, v54, v54, v219
    buffer_load_dwordx4 a[184:187], v8, s[28:31], s36 offen offset:2048
    v_dot2_f32_bf16 v218, v55, v224, v218
    v_dot2_f32_bf16 v219, v55, v55, v219
    ds_write_b128 v12, v[52:55] offset:8192
    s_waitcnt lgkmcnt(1)
    v_pk_fma_f32 v[120:121], v[120:121], v[220:221], v[220:221] op_sel:[0,1,0] op_sel_hi:[1,1,0]
    v_pk_fma_f32 v[122:123], v[122:123], v[220:221], v[220:221] op_sel:[0,1,0] op_sel_hi:[1,1,0]
    v_pk_fma_f32 v[124:125], v[124:125], v[220:221], v[220:221] op_sel:[0,1,0] op_sel_hi:[1,1,0]
    ds_read_b128 v[152:155], v227 offset:12288
    buffer_load_dwordx4 a[188:191], v8, s[28:31], s36 offen offset:3072
    v_pk_fma_f32 v[126:127], v[126:127], v[220:221], v[220:221] op_sel:[0,1,0] op_sel_hi:[1,1,0]
    v_pk_fma_f32 v[120:121], v[120:121], v[168:169], v[176:177]
    v_pk_fma_f32 v[122:123], v[122:123], v[170:171], v[178:179]
    ds_read_b128 v[156:159], v227 offset:12304
    v_pk_fma_f32 v[124:125], v[124:125], v[172:173], v[180:181]
    v_pk_fma_f32 v[126:127], v[126:127], v[174:175], v[182:183]
    v_cvt_pk_bf16_f32 v56, v120, v121
    ds_read_b128 v[160:163], v227 offset:9728
    v_cvt_pk_bf16_f32 v57, v122, v123
    v_cvt_pk_bf16_f32 v58, v124, v125
    v_cvt_pk_bf16_f32 v59, v126, v127
    ds_read_b128 v[164:167], v227 offset:9744
    s_add_u32 s36, s36, 4096
    buffer_load_dwordx4 a[192:195], v8, s[28:31], s36 offen offset:0
    v_dot2_f32_bf16 v216, v56, v224, v216
    v_dot2_f32_bf16 v217, v56, v56, v217
    v_dot2_f32_bf16 v216, v57, v224, v216
    v_dot2_f32_bf16 v217, v57, v57, v217
    v_dot2_f32_bf16 v216, v58, v224, v216
    v_dot2_f32_bf16 v217, v58, v58, v217
    v_dot2_f32_bf16 v216, v59, v224, v216
    v_dot2_f32_bf16 v217, v59, v59, v217
    ds_write_b128 v228, v[56:59] offset:12288
    v_pk_fma_f32 v[128:129], v[128:129], v[222:223], v[222:223] op_sel:[0,1,0] op_sel_hi:[1,1,0]
    buffer_load_dwordx4 a[196:199], v8, s[28:31], s36 offen offset:1024
    v_pk_fma_f32 v[130:131], v[130:131], v[222:223], v[222:223] op_sel:[0,1,0] op_sel_hi:[1,1,0]
    v_pk_fma_f32 v[132:133], v[132:133], v[222:223], v[222:223] op_sel:[0,1,0] op_sel_hi:[1,1,0]
    v_pk_fma_f32 v[134:135], v[134:135], v[222:223], v[222:223] op_sel:[0,1,0] op_sel_hi:[1,1,0]
    v_pk_fma_f32 v[128:129], v[128:129], v[168:169], v[176:177]
    v_pk_fma_f32 v[130:131], v[130:131], v[170:171], v[178:179]
    v_pk_fma_f32 v[132:133], v[132:133], v[172:173], v[180:181]
    v_pk_fma_f32 v[134:135], v[134:135], v[174:175], v[182:183]
    v_cvt_pk_bf16_f32 v60, v128, v129
    v_cvt_pk_bf16_f32 v61, v130, v131
    v_cvt_pk_bf16_f32 v62, v132, v133
    v_cvt_pk_bf16_f32 v63, v134, v135
    v_dot2_f32_bf16 v218, v60, v224, v218
    v_dot2_f32_bf16 v219, v60, v60, v219
    v_dot2_f32_bf16 v218, v61, v224, v218
    v_dot2_f32_bf16 v219, v61, v61, v219
    v_dot2_f32_bf16 v218, v62, v224, v218
    v_dot2_f32_bf16 v219, v62, v62, v219
    buffer_load_dwordx4 a[200:203], v8, s[28:31], s37 offen offset:0
    v_dot2_f32_bf16 v218, v63, v224, v218
    v_dot2_f32_bf16 v219, v63, v63, v219
    ds_write_b128 v12, v[60:63] offset:12288
    s_waitcnt lgkmcnt(1)
    v_pk_fma_f32 v[136:137], v[136:137], v[220:221], v[220:221] op_sel:[0,1,0] op_sel_hi:[1,1,0]
    v_pk_fma_f32 v[138:139], v[138:139], v[220:221], v[220:221] op_sel:[0,1,0] op_sel_hi:[1,1,0]
    v_pk_fma_f32 v[140:141], v[140:141], v[220:221], v[220:221] op_sel:[0,1,0] op_sel_hi:[1,1,0]
    v_pk_fma_f32 v[142:143], v[142:143], v[220:221], v[220:221] op_sel:[0,1,0] op_sel_hi:[1,1,0]
    v_pk_fma_f32 v[136:137], v[136:137], v[152:153], v[160:161]
    v_pk_fma_f32 v[138:139], v[138:139], v[154:155], v[162:163]
    buffer_load_dwordx4 a[204:207], v8, s[28:31], s37 offen offset:1024
    v_pk_fma_f32 v[140:141], v[140:141], v[156:157], v[164:165]
    v_pk_fma_f32 v[142:143], v[142:143], v[158:159], v[166:167]
    v_cvt_pk_bf16_f32 v64, v136, v137
    v_cvt_pk_bf16_f32 v65, v138, v139
    v_cvt_pk_bf16_f32 v66, v140, v141
    v_cvt_pk_bf16_f32 v67, v142, v143
    v_dot2_f32_bf16 v216, v64, v224, v216
    v_dot2_f32_bf16 v217, v64, v64, v217
    v_dot2_f32_bf16 v216, v65, v224, v216
    v_dot2_f32_bf16 v217, v65, v65, v217
    v_dot2_f32_bf16 v216, v66, v224, v216
    v_dot2_f32_bf16 v217, v66, v66, v217
    v_dot2_f32_bf16 v216, v67, v224, v216
    v_dot2_f32_bf16 v217, v67, v67, v217
    ds_write_b128 v228, v[64:67] offset:16384
    buffer_load_dwordx4 a[208:211], v8, s[28:31], s37 offen offset:2048
    v_pk_fma_f32 v[144:145], v[144:145], v[222:223], v[222:223] op_sel:[0,1,0] op_sel_hi:[1,1,0]
    v_pk_fma_f32 v[146:147], v[146:147], v[222:223], v[222:223] op_sel:[0,1,0] op_sel_hi:[1,1,0]
    v_pk_fma_f32 v[148:149], v[148:149], v[222:223], v[222:223] op_sel:[0,1,0] op_sel_hi:[1,1,0]
    v_pk_fma_f32 v[150:151], v[150:151], v[222:223], v[222:223] op_sel:[0,1,0] op_sel_hi:[1,1,0]
    v_pk_fma_f32 v[144:145], v[144:145], v[152:153], v[160:161]
    v_pk_fma_f32 v[146:147], v[146:147], v[154:155], v[162:163]
    v_pk_fma_f32 v[148:149], v[148:149], v[156:157], v[164:165]
    v_pk_fma_f32 v[150:151], v[150:151], v[158:159], v[166:167]
    v_cvt_pk_bf16_f32 v68, v144, v145
    v_cvt_pk_bf16_f32 v69, v146, v147
    v_cvt_pk_bf16_f32 v70, v148, v149
    v_cvt_pk_bf16_f32 v71, v150, v151
    v_dot2_f32_bf16 v218, v68, v224, v218
    v_dot2_f32_bf16 v219, v68, v68, v219
    v_dot2_f32_bf16 v218, v69, v224, v218
    v_dot2_f32_bf16 v219, v69, v69, v219
    v_dot2_f32_bf16 v218, v70, v224, v218
    buffer_load_dwordx4 a[212:215], v8, s[28:31], s37 offen offset:3072
    v_dot2_f32_bf16 v219, v70, v70, v219
    v_dot2_f32_bf16 v218, v71, v224, v218
    v_dot2_f32_bf16 v219, v71, v71, v219
    ds_write_b128 v12, v[68:71] offset:16384
    s_waitcnt lgkmcnt(0)
    s_barrier
    ds_read_b128 v[72:75], v229 offset:0
    ds_read_b128 v[76:79], v231 offset:0
    s_add_u32 s37, s37, 4096
    buffer_load_dwordx4 a[216:219], v8, s[28:31], s37 offen offset:0
    s_waitcnt vmcnt(50) lgkmcnt(0)
    v_mfma_f32_16x16x32_bf16 v[32:35], a[0:3], v[72:75], 0
    v_mfma_f32_16x16x32_bf16 v[52:55], a[0:3], v[76:79], 0
    ds_read_b128 v[80:83], v230 offset:1024
    v_mfma_f32_16x16x32_bf16 v[36:39], a[4:7], v[72:75], 0
    v_mfma_f32_16x16x32_bf16 v[56:59], a[4:7], v[76:79], 0
    buffer_load_dwordx4 a[220:223], v8, s[28:31], s37 offen offset:1024
    ds_read_b128 v[84:87], v232 offset:1024
    v_mfma_f32_16x16x32_bf16 v[40:43], a[8:11], v[72:75], 0
    v_mfma_f32_16x16x32_bf16 v[60:63], a[8:11], v[76:79], 0
    ds_read_b128 v[112:115], v233 offset:0
    v_mfma_f32_16x16x32_bf16 v[44:47], a[12:15], v[72:75], 0
    buffer_load_dwordx4 a[224:227], v8, s[28:31], s37 offen offset:2048
    v_mfma_f32_16x16x32_bf16 v[64:67], a[12:15], v[76:79], 0
    ds_read_b128 v[132:135], v233 offset:1024
    v_mfma_f32_16x16x32_bf16 v[48:51], a[16:19], v[72:75], 0
    v_mfma_f32_16x16x32_bf16 v[68:71], a[16:19], v[76:79], 0
    s_waitcnt vmcnt(47) lgkmcnt(0)
    v_mfma_f32_16x16x32_bf16 v[32:35], a[20:23], v[80:83], v[32:35]
    buffer_load_dwordx4 a[228:231], v8, s[28:31], s37 offen offset:3072
    v_add_f32_dpp v216, v216, v216 quad_perm:[1,0,3,2] row_mask:0xf bank_mask:0xf
    v_mfma_f32_16x16x32_bf16 v[52:55], a[20:23], v[84:87], v[52:55]
    ds_read_b128 v[72:75], v229 offset:2048
    v_mfma_f32_16x16x32_bf16 v[36:39], a[24:27], v[80:83], v[36:39]
    v_add_f32_dpp v217, v217, v217 quad_perm:[1,0,3,2] row_mask:0xf bank_mask:0xf
    v_mfma_f32_16x16x32_bf16 v[56:59], a[24:27], v[84:87], v[56:59]
    ds_read_b128 v[76:79], v231 offset:2048
    s_add_u32 s37, s37, 4096
    buffer_load_dwordx4 a[232:235], v8, s[28:31], s37 offen offset:0
    v_mfma_f32_16x16x32_bf16 v[40:43], a[28:31], v[80:83], v[40:43]
    v_add_f32_dpp v218, v218, v218 quad_perm:[1,0,3,2] row_mask:0xf bank_mask:0xf
    v_mfma_f32_16x16x32_bf16 v[60:63], a[28:31], v[84:87], v[60:63]
    ds_read_b128 v[116:119], v233 offset:64
    v_mfma_f32_16x16x32_bf16 v[44:47], a[32:35], v[80:83], v[44:47]
    v_add_f32_dpp v219, v219, v219 quad_perm:[1,0,3,2] row_mask:0xf bank_mask:0xf
    v_mfma_f32_16x16x32_bf16 v[64:67], a[32:35], v[84:87], v[64:67]
    buffer_load_dwordx4 a[236:239], v8, s[28:31], s37 offen offset:1024
    ds_read_b128 v[136:139], v233 offset:1088
    v_mfma_f32_16x16x32_bf16 v[48:51], a[36:39], v[80:83], v[48:51]
    v_add_f32_dpp v216, v216, v216 quad_perm:[2,3,0,1] row_mask:0xf bank_mask:0xf
    v_mfma_f32_16x16x32_bf16 v[68:71], a[36:39], v[84:87], v[68:71]
    v_add_f32_dpp v217, v217, v217 quad_perm:[2,3,0,1] row_mask:0xf bank_mask:0xf
    s_waitcnt vmcnt(45) lgkmcnt(0)
    v_mfma_f32_16x16x32_bf16 v[32:35], a[40:43], v[72:75], v[32:35]
    buffer_load_dwordx4 a[240:243], v8, s[28:31], s37 offen offset:2048
    v_add_f32_dpp v218, v218, v218 quad_perm:[2,3,0,1] row_mask:0xf bank_mask:0xf
    v_mfma_f32_16x16x32_bf16 v[52:55], a[40:43], v[76:79], v[52:55]
    ds_read_b128 v[80:83], v230 offset:3072
    v_mfma_f32_16x16x32_bf16 v[36:39], a[44:47], v[72:75], v[36:39]
    v_add_f32_dpp v219, v219, v219 quad_perm:[2,3,0,1] row_mask:0xf bank_mask:0xf
    v_mfma_f32_16x16x32_bf16 v[56:59], a[44:47], v[76:79], v[56:59]
    ds_read_b128 v[84:87], v232 offset:3072
    buffer_load_dwordx4 a[244:247], v8, s[28:31], s37 offen offset:3072
    v_mfma_f32_16x16x32_bf16 v[40:43], a[48:51], v[72:75], v[40:43]
    v_add_f32_dpp v216, v216, v216 row_half_mirror row_mask:0xf bank_mask:0xf
    v_mfma_f32_16x16x32_bf16 v[60:63], a[48:51], v[76:79], v[60:63]
    ds_read_b128 v[120:123], v233 offset:128
    v_mfma_f32_16x16x32_bf16 v[44:47], a[52:55], v[72:75], v[44:47]
    v_add_f32_dpp v217, v217, v217 row_half_mirror row_mask:0xf bank_mask:0xf
    v_mfma_f32_16x16x32_bf16 v[64:67], a[52:55], v[76:79], v[64:67]
    s_add_u32 s37, s37, 4096
    buffer_load_dwordx4 a[248:251], v8, s[28:31], s37 offen offset:0
    ds_read_b128 v[140:143], v233 offset:1152
    v_mfma_f32_16x16x32_bf16 v[48:51], a[56:59], v[72:75], v[48:51]
    v_add_f32_dpp v218, v218, v218 row_half_mirror row_mask:0xf bank_mask:0xf
    v_mfma_f32_16x16x32_bf16 v[68:71], a[56:59], v[76:79], v[68:71]
    v_add_f32_dpp v219, v219, v219 row_half_mirror row_mask:0xf bank_mask:0xf
    s_waitcnt vmcnt(43) lgkmcnt(0)
    v_mfma_f32_16x16x32_bf16 v[32:35], a[60:63], v[80:83], v[32:35]
    buffer_load_dwordx4 a[252:255], v8, s[28:31], s37 offen offset:1024
    v_add_f32_dpp v216, v216, v216 row_mirror row_mask:0xf bank_mask:0xf
    v_mfma_f32_16x16x32_bf16 v[52:55], a[60:63], v[84:87], v[52:55]
    ds_read_b128 v[72:75], v229 offset:4096
    v_mfma_f32_16x16x32_bf16 v[36:39], a[64:67], v[80:83], v[36:39]
    v_add_f32_dpp v217, v217, v217 row_mirror row_mask:0xf bank_mask:0xf
    v_mfma_f32_16x16x32_bf16 v[56:59], a[64:67], v[84:87], v[56:59]
    ds_read_b128 v[76:79], v231 offset:4096
    buffer_load_dwordx4 a[0:3], v8, s[28:31], s37 offen offset:2048
    v_mfma_f32_16x16x32_bf16 v[40:43], a[68:71], v[80:83], v[40:43]
    v_add_f32_dpp v218, v218, v218 row_mirror row_mask:0xf bank_mask:0xf
    v_mfma_f32_16x16x32_bf16 v[60:63], a[68:71], v[84:87], v[60:63]
    ds_read_b128 v[124:127], v233 offset:192
    v_mfma_f32_16x16x32_bf16 v[44:47], a[72:75], v[80:83], v[44:47]
    v_add_f32_dpp v219, v219, v219 row_mirror row_mask:0xf bank_mask:0xf
    v_mfma_f32_16x16x32_bf16 v[64:67], a[72:75], v[84:87], v[64:67]
    buffer_load_dwordx4 a[4:7], v8, s[28:31], s37 offen offset:3072
    ds_read_b128 v[144:147], v233 offset:1216
    v_mfma_f32_16x16x32_bf16 v[48:51], a[76:79], v[80:83], v[48:51]
    v_mul_f32 v216, 0x3acccccd, v216
    v_mfma_f32_16x16x32_bf16 v[68:71], a[76:79], v[84:87], v[68:71]
    v_mul_f32 v218, 0x3acccccd, v218
    s_waitcnt vmcnt(41) lgkmcnt(0)
    v_mfma_f32_16x16x32_bf16 v[32:35], a[80:83], v[72:75], v[32:35]
    s_add_u32 s37, s37, 4096
    buffer_load_dwordx4 a[8:11], v8, s[28:31], s37 offen offset:0
    v_mul_f32 v217, 0x3acccccd, v217
    v_mfma_f32_16x16x32_bf16 v[52:55], a[80:83], v[76:79], v[52:55]
    ds_read_b128 v[80:83], v230 offset:5120
    v_mfma_f32_16x16x32_bf16 v[36:39], a[84:87], v[72:75], v[36:39]
    v_mul_f32 v219, 0x3acccccd, v219
    v_mfma_f32_16x16x32_bf16 v[56:59], a[84:87], v[76:79], v[56:59]
    ds_read_b128 v[84:87], v232 offset:5120
    buffer_load_dwordx4 a[12:15], v8, s[28:31], s37 offen offset:1024
    v_mfma_f32_16x16x32_bf16 v[40:43], a[88:91], v[72:75], v[40:43]
    v_fma_f32 v217, -v216, v216, v217
    v_mfma_f32_16x16x32_bf16 v[60:63], a[88:91], v[76:79], v[60:63]
    ds_read_b128 v[128:131], v234
    v_mfma_f32_16x16x32_bf16 v[44:47], a[92:95], v[72:75], v[44:47]
    v_fma_f32 v219, -v218, v218, v219
    v_mfma_f32_16x16x32_bf16 v[64:67], a[92:95], v[76:79], v[64:67]
    buffer_load_dwordx4 a[16:19], v8, s[28:31], s37 offen offset:2048
    ds_read_b128 v[148:151], v234 offset:1024
    v_mfma_f32_16x16x32_bf16 v[48:51], a[96:99], v[72:75], v[48:51]
    v_max_f32 v217, 0, v217
    v_mfma_f32_16x16x32_bf16 v[68:71], a[96:99], v[76:79], v[68:71]
    v_max_f32 v219, 0, v219
    s_waitcnt vmcnt(39) lgkmcnt(0)
    v_mfma_f32_16x16x32_bf16 v[32:35], a[100:103], v[80:83], v[32:35]
    buffer_load_dwordx4 a[20:23], v8, s[28:31], s37 offen offset:3072
    v_cvt_pk_bf16_f32 v192, v216, v217
    v_mfma_f32_16x16x32_bf16 v[52:55], a[100:103], v[84:87], v[52:55]
    ds_read_b128 v[72:75], v229 offset:6144
    v_mfma_f32_16x16x32_bf16 v[36:39], a[104:107], v[80:83], v[36:39]
    v_cvt_pk_bf16_f32 v193, v218, v219
    v_mfma_f32_16x16x32_bf16 v[56:59], a[104:107], v[84:87], v[56:59]
    ds_read_b128 v[76:79], v231 offset:6144
    s_add_u32 s37, s37, 4096
    buffer_load_dwordx4 a[24:27], v8, s[28:31], s37 offen offset:0
    v_mfma_f32_16x16x32_bf16 v[40:43], a[108:111], v[80:83], v[40:43]
    v_lshlrev_b32 v216, 16, v192
    v_mfma_f32_16x16x32_bf16 v[60:63], a[108:111], v[84:87], v[60:63]
    ds_read_b64 v[16:17], v236
    v_mfma_f32_16x16x32_bf16 v[44:47], a[112:115], v[80:83], v[44:47]
    v_lshlrev_b32 v218, 16, v193
    v_mfma_f32_16x16x32_bf16 v[64:67], a[112:115], v[84:87], v[64:67]
    buffer_load_dwordx4 a[28:31], v8, s[28:31], s37 offen offset:1024
    ds_read_b64 v[18:19], v237
    v_mfma_f32_16x16x32_bf16 v[48:51], a[116:119], v[80:83], v[48:51]
    v_and_b32 v217, 0xffff0000, v192
    v_mfma_f32_16x16x32_bf16 v[68:71], a[116:119], v[84:87], v[68:71]
    v_and_b32 v219, 0xffff0000, v193
    s_waitcnt vmcnt(37) lgkmcnt(0)
    v_mfma_f32_16x16x32_bf16 v[32:35], a[120:123], v[72:75], v[32:35]
    buffer_load_dwordx4 a[32:35], v8, s[28:31], s37 offen offset:2048
    v_add_f32 v217, 0x3727c5ac, v217
    v_mfma_f32_16x16x32_bf16 v[52:55], a[120:123], v[76:79], v[52:55]
    ds_read_b128 v[80:83], v230 offset:7168
    v_mfma_f32_16x16x32_bf16 v[36:39], a[124:127], v[72:75], v[36:39]
    v_add_f32 v219, 0x3727c5ac, v219
    v_mfma_f32_16x16x32_bf16 v[56:59], a[124:127], v[76:79], v[56:59]
    ds_read_b128 v[84:87], v232 offset:7168
    buffer_load_dwordx4 a[36:39], v8, s[28:31], s37 offen offset:3072
    v_mfma_f32_16x16x32_bf16 v[40:43], a[128:131], v[72:75], v[40:43]
    v_cvt_pk_bf16_f32 v192, v217, v217
    v_mfma_f32_16x16x32_bf16 v[60:63], a[128:131], v[76:79], v[60:63]
    ds_read_b64 v[20:21], v238
    v_mfma_f32_16x16x32_bf16 v[44:47], a[132:135], v[72:75], v[44:47]
    v_cvt_pk_bf16_f32 v193, v219, v219
    v_mfma_f32_16x16x32_bf16 v[64:67], a[132:135], v[76:79], v[64:67]
    s_add_u32 s37, s37, 4096
    buffer_load_dwordx4 a[40:43], v8, s[28:31], s37 offen offset:0
    ds_read_b64 v[22:23], v239
    v_mfma_f32_16x16x32_bf16 v[48:51], a[136:139], v[72:75], v[48:51]
    v_lshlrev_b32 v217, 16, v192
    v_mfma_f32_16x16x32_bf16 v[68:71], a[136:139], v[76:79], v[68:71]
    v_lshlrev_b32 v219, 16, v193
    s_waitcnt vmcnt(35) lgkmcnt(0)
    v_mfma_f32_16x16x32_bf16 v[32:35], a[140:143], v[80:83], v[32:35]
    buffer_load_dwordx4 a[44:47], v8, s[28:31], s37 offen offset:1024
    v_sqrt_f32 v217, v217
    v_mfma_f32_16x16x32_bf16 v[52:55], a[140:143], v[84:87], v[52:55]
    ds_read_b128 v[72:75], v229 offset:8192
    v_mfma_f32_16x16x32_bf16 v[36:39], a[144:147], v[80:83], v[36:39]
    v_sqrt_f32 v219, v219
    v_mfma_f32_16x16x32_bf16 v[56:59], a[144:147], v[84:87], v[56:59]
    buffer_load_dwordx4 a[48:51], v8, s[28:31], s37 offen offset:2048
    ds_read_b128 v[76:79], v231 offset:8192
    v_mfma_f32_16x16x32_bf16 v[40:43], a[148:151], v[80:83], v[40:43]
    v_cvt_pk_bf16_f32 v192, v217, v217
    v_mfma_f32_16x16x32_bf16 v[60:63], a[148:151], v[84:87], v[60:63]
    ds_read_b64 v[24:25], v240
    v_mfma_f32_16x16x32_bf16 v[44:47], a[152:155], v[80:83], v[44:47]
    buffer_load_dwordx4 a[52:55], v8, s[28:31], s37 offen offset:3072
    v_cvt_pk_bf16_f32 v193, v219, v219
    v_mfma_f32_16x16x32_bf16 v[64:67], a[152:155], v[84:87], v[64:67]
    v_lshlrev_b32 v217, 16, v192
    v_mfma_f32_16x16x32_bf16 v[48:51], a[156:159], v[80:83], v[48:51]
    v_lshlrev_b32 v219, 16, v193
    v_mfma_f32_16x16x32_bf16 v[68:71], a[156:159], v[84:87], v[68:71]
    v_rcp_f32 v217, v217
    s_waitcnt vmcnt(33) lgkmcnt(0)
    s_add_u32 s37, s37, 4096
    buffer_load_dwordx4 a[56:59], v8, s[28:31], s37 offen offset:0
    v_mfma_f32_16x16x32_bf16 v[32:35], a[160:163], v[72:75], v[32:35]
    v_rcp_f32 v219, v219
    v_mfma_f32_16x16x32_bf16 v[52:55], a[160:163], v[76:79], v[52:55]
    ds_read_b128 v[80:83], v230 offset:9216
    v_mfma_f32_16x16x32_bf16 v[36:39], a[164:167], v[72:75], v[36:39]
    v_mul_f32 v216, v216, v217
    buffer_load_dwordx4 a[60:63], v8, s[28:31], s37 offen offset:1024
    v_mfma_f32_16x16x32_bf16 v[56:59], a[164:167], v[76:79], v[56:59]
    ds_read_b128 v[84:87], v232 offset:9216
    v_mfma_f32_16x16x32_bf16 v[40:43], a[168:171], v[72:75], v[40:43]
    v_mul_f32 v218, v218, v219
    v_mfma_f32_16x16x32_bf16 v[60:63], a[168:171], v[76:79], v[60:63]
    v_sub_f32 v216, 0, v216
    v_mfma_f32_16x16x32_bf16 v[44:47], a[172:175], v[72:75], v[44:47]
    buffer_load_dwordx4 a[64:67], v8, s[28:31], s37 offen offset:2048
    v_sub_f32 v218, 0, v218
    v_mfma_f32_16x16x32_bf16 v[64:67], a[172:175], v[76:79], v[64:67]
    s_lshl_b32 s26, s20, 6
    v_mfma_f32_16x16x32_bf16 v[48:51], a[176:179], v[72:75], v[48:51]
    v_lshl_add_u32 v2, v3, 3, s26
    v_mfma_f32_16x16x32_bf16 v[68:71], a[176:179], v[76:79], v[68:71]
    v_add_u32 v2, 138240, v2
    s_waitcnt vmcnt(31) lgkmcnt(0)
    v_mfma_f32_16x16x32_bf16 v[32:35], a[180:183], v[80:83], v[32:35]
    buffer_load_dwordx4 a[68:71], v8, s[28:31], s37 offen offset:3072
    ds_write_b64 v2, v[216:217]
    v_mfma_f32_16x16x32_bf16 v[52:55], a[180:183], v[84:87], v[52:55]
    ds_write_b64 v2, v[218:219] offset:32
    s_add_u32 s37, s37, 4096
    buffer_load_dwordx4 a[72:75], v8, s[28:31], s37 offen offset:0
    v_mfma_f32_16x16x32_bf16 v[36:39], a[184:187], v[80:83], v[36:39]
    v_mfma_f32_16x16x32_bf16 v[56:59], a[184:187], v[84:87], v[56:59]
    v_mfma_f32_16x16x32_bf16 v[40:43], a[188:191], v[80:83], v[40:43]
    v_mfma_f32_16x16x32_bf16 v[60:63], a[188:191], v[84:87], v[60:63]
    v_mfma_f32_16x16x32_bf16 v[44:47], a[192:195], v[80:83], v[44:47]
    buffer_load_dwordx4 a[76:79], v8, s[28:31], s37 offen offset:1024
    v_mfma_f32_16x16x32_bf16 v[64:67], a[192:195], v[84:87], v[64:67]
    v_mfma_f32_16x16x32_bf16 v[48:51], a[196:199], v[80:83], v[48:51]
    v_mfma_f32_16x16x32_bf16 v[68:71], a[196:199], v[84:87], v[68:71]
    s_waitcnt lgkmcnt(0)
    s_nop 4
    ds_write_b128 v246, v[52:55] offset:0
    buffer_load_dwordx4 a[80:83], v8, s[28:31], s37 offen offset:2048
    ds_write_b128 v246, v[56:59] offset:1024
    ds_write_b128 v246, v[60:63] offset:2048
    buffer_load_dwordx4 a[84:87], v8, s[28:31], s37 offen offset:3072
    ds_write_b128 v246, v[64:67] offset:3072
    ds_write_b128 v246, v[68:71] offset:4096
    s_add_u32 s37, s37, 4096
    buffer_load_dwordx4 a[88:91], v8, s[28:31], s37 offen offset:0
    v_pk_add_f32 v[112:113], v[112:113], v[132:133]
    v_pk_add_f32 v[114:115], v[114:115], v[134:135]
    v_pk_add_f32 v[116:117], v[116:117], v[136:137]
    v_pk_add_f32 v[118:119], v[118:119], v[138:139]
    v_pk_add_f32 v[120:121], v[120:121], v[140:141]
    v_pk_add_f32 v[122:123], v[122:123], v[142:143]
    v_pk_add_f32 v[124:125], v[124:125], v[144:145]
    v_pk_add_f32 v[126:127], v[126:127], v[146:147]
    v_pk_add_f32 v[128:129], v[128:129], v[148:149]
    v_pk_add_f32 v[130:131], v[130:131], v[150:151]
    v_mov_b32 v30, 0xbdd2d3e8
    v_mov_b32 v31, 0xc0135761
    s_waitcnt lgkmcnt(0)
    s_barrier
    ds_read_b64 v[152:153], v235
    buffer_load_dwordx4 a[92:95], v8, s[28:31], s37 offen offset:1024
    ds_read_b128 v[88:91], v247 offset:0
    ds_read_b128 v[92:95], v247 offset:1024
    ds_read_b128 v[96:99], v247 offset:2048
    ds_read_b128 v[100:103], v247 offset:3072
    ds_read_b128 v[104:107], v247 offset:4096
    s_waitcnt lgkmcnt(5)
    v_pk_mul_f32 v[112:113], v[112:113], v[152:153] op_sel_hi:[1,0]
    buffer_load_dwordx4 a[96:99], v8, s[28:31], s37 offen offset:2048
    v_pk_mul_f32 v[114:115], v[114:115], v[152:153] op_sel_hi:[1,0]
    v_pk_mul_f32 v[116:117], v[116:117], v[152:153] op_sel_hi:[1,0]
    v_pk_mul_f32 v[118:119], v[118:119], v[152:153] op_sel_hi:[1,0]
    v_pk_mul_f32 v[120:121], v[120:121], v[152:153] op_sel_hi:[1,0]
    v_pk_mul_f32 v[122:123], v[122:123], v[152:153] op_sel_hi:[1,0]
    v_pk_mul_f32 v[124:125], v[124:125], v[152:153] op_sel_hi:[1,0]
    v_pk_mul_f32 v[126:127], v[126:127], v[152:153] op_sel_hi:[1,0]
    v_pk_mul_f32 v[128:129], v[128:129], v[152:153] op_sel_hi:[1,0]
    v_pk_mul_f32 v[130:131], v[130:131], v[152:153] op_sel_hi:[1,0]
    s_waitcnt lgkmcnt(4)
    v_pk_add_f32 v[32:33], v[32:33], v[88:89]
    v_pk_add_f32 v[34:35], v[34:35], v[90:91]
    s_waitcnt lgkmcnt(3)
    v_pk_add_f32 v[36:37], v[36:37], v[92:93]
    v_pk_add_f32 v[38:39], v[38:39], v[94:95]
    s_waitcnt lgkmcnt(2)
    v_pk_add_f32 v[40:41], v[40:41], v[96:97]
    buffer_load_dwordx4 a[100:103], v8, s[28:31], s37 offen offset:3072
    v_pk_add_f32 v[42:43], v[42:43], v[98:99]
    s_waitcnt lgkmcnt(1)
    v_pk_add_f32 v[44:45], v[44:45], v[100:101]
    v_pk_add_f32 v[46:47], v[46:47], v[102:103]
    s_waitcnt lgkmcnt(0)
    v_pk_add_f32 v[48:49], v[48:49], v[104:105]
    v_pk_add_f32 v[50:51], v[50:51], v[106:107]
    v_pk_fma_f32 v[32:33], v[32:33], v[152:153], v[112:113] op_sel:[0,1,0] op_sel_hi:[1,1,1]
    v_pk_fma_f32 v[34:35], v[34:35], v[152:153], v[114:115] op_sel:[0,1,0] op_sel_hi:[1,1,1]
    v_pk_fma_f32 v[36:37], v[36:37], v[152:153], v[116:117] op_sel:[0,1,0] op_sel_hi:[1,1,1]
    v_pk_fma_f32 v[38:39], v[38:39], v[152:153], v[118:119] op_sel:[0,1,0] op_sel_hi:[1,1,1]
    v_pk_fma_f32 v[40:41], v[40:41], v[152:153], v[120:121] op_sel:[0,1,0] op_sel_hi:[1,1,1]
    v_pk_fma_f32 v[42:43], v[42:43], v[152:153], v[122:123] op_sel:[0,1,0] op_sel_hi:[1,1,1]
    v_pk_fma_f32 v[44:45], v[44:45], v[152:153], v[124:125] op_sel:[0,1,0] op_sel_hi:[1,1,1]
    v_pk_fma_f32 v[46:47], v[46:47], v[152:153], v[126:127] op_sel:[0,1,0] op_sel_hi:[1,1,1]
    v_pk_fma_f32 v[48:49], v[48:49], v[152:153], v[128:129] op_sel:[0,1,0] op_sel_hi:[1,1,1]
    v_pk_fma_f32 v[50:51], v[50:51], v[152:153], v[130:131] op_sel:[0,1,0] op_sel_hi:[1,1,1]
    s_add_u32 s37, s37, 4096
    buffer_load_dwordx4 a[104:107], v8, s[28:31], s37 offen offset:0
    v_pk_mul_f32 v[192:193], v[32:33], v[32:33]
    v_pk_mul_f32 v[194:195], v[34:35], v[34:35]
    v_pk_mul_f32 v[196:197], v[36:37], v[36:37]
    v_pk_mul_f32 v[198:199], v[38:39], v[38:39]
    v_pk_mul_f32 v[200:201], v[40:41], v[40:41]
    v_pk_mul_f32 v[202:203], v[42:43], v[42:43]
    v_pk_mul_f32 v[204:205], v[44:45], v[44:45]
    v_pk_mul_f32 v[206:207], v[46:47], v[46:47]
    v_pk_mul_f32 v[208:209], v[48:49], v[48:49]
    v_pk_mul_f32 v[210:211], v[50:51], v[50:51]
    v_pk_fma_f32 v[192:193], v[192:193], v[30:31], v[30:31] op_sel:[0,0,1] op_sel_hi:[1,0,1]
    v_pk_fma_f32 v[194:195], v[194:195], v[30:31], v[30:31] op_sel:[0,0,1] op_sel_hi:[1,0,1]
    v_pk_fma_f32 v[196:197], v[196:197], v[30:31], v[30:31] op_sel:[0,0,1] op_sel_hi:[1,0,1]
    v_pk_fma_f32 v[198:199], v[198:199], v[30:31], v[30:31] op_sel:[0,0,1] op_sel_hi:[1,0,1]
    v_pk_fma_f32 v[200:201], v[200:201], v[30:31], v[30:31] op_sel:[0,0,1] op_sel_hi:[1,0,1]
    v_pk_fma_f32 v[202:203], v[202:203], v[30:31], v[30:31] op_sel:[0,0,1] op_sel_hi:[1,0,1]
    v_pk_fma_f32 v[204:205], v[204:205], v[30:31], v[30:31] op_sel:[0,0,1] op_sel_hi:[1,0,1]
    buffer_load_dwordx4 a[108:111], v8, s[28:31], s37 offen offset:1024
    v_pk_fma_f32 v[206:207], v[206:207], v[30:31], v[30:31] op_sel:[0,0,1] op_sel_hi:[1,0,1]
    v_pk_fma_f32 v[208:209], v[208:209], v[30:31], v[30:31] op_sel:[0,0,1] op_sel_hi:[1,0,1]
    v_pk_fma_f32 v[210:211], v[210:211], v[30:31], v[30:31] op_sel:[0,0,1] op_sel_hi:[1,0,1]
    v_pk_mul_f32 v[192:193], v[192:193], v[32:33]
    v_pk_mul_f32 v[194:195], v[194:195], v[34:35]
    v_pk_mul_f32 v[196:197], v[196:197], v[36:37]
    v_pk_mul_f32 v[198:199], v[198:199], v[38:39]
    v_pk_mul_f32 v[200:201], v[200:201], v[40:41]
    v_pk_mul_f32 v[202:203], v[202:203], v[42:43]
    v_pk_mul_f32 v[204:205], v[204:205], v[44:45]
    v_pk_mul_f32 v[206:207], v[206:207], v[46:47]
    v_pk_mul_f32 v[208:209], v[208:209], v[48:49]
    v_pk_mul_f32 v[210:211], v[210:211], v[50:51]
    v_exp_f32 v192, v192
    v_exp_f32 v193, v193
    buffer_load_dwordx4 a[112:115], v8, s[28:31], s37 offen offset:2048
    v_exp_f32 v194, v194
    v_exp_f32 v195, v195
    v_exp_f32 v196, v196
    v_exp_f32 v197, v197
    v_exp_f32 v198, v198
    v_exp_f32 v199, v199
    v_exp_f32 v200, v200
    v_exp_f32 v201, v201
    v_exp_f32 v202, v202
    buffer_load_dwordx4 a[116:119], v8, s[28:31], s37 offen offset:3072
    v_exp_f32 v203, v203
    v_exp_f32 v204, v204
    v_exp_f32 v205, v205
    v_exp_f32 v206, v206
    v_exp_f32 v207, v207
    v_exp_f32 v208, v208
    v_exp_f32 v209, v209
    v_exp_f32 v210, v210
    v_exp_f32 v211, v211
    s_add_u32 s37, s37, 4096
    buffer_load_dwordx4 a[120:123], v8, s[28:31], s37 offen offset:0
    v_pk_add_f32 v[192:193], v[192:193], 1.0 op_sel_hi:[1,0]
    v_pk_add_f32 v[194:195], v[194:195], 1.0 op_sel_hi:[1,0]
    v_pk_add_f32 v[196:197], v[196:197], 1.0 op_sel_hi:[1,0]
    v_pk_add_f32 v[198:199], v[198:199], 1.0 op_sel_hi:[1,0]
    v_pk_add_f32 v[200:201], v[200:201], 1.0 op_sel_hi:[1,0]
    v_pk_add_f32 v[202:203], v[202:203], 1.0 op_sel_hi:[1,0]
    v_pk_add_f32 v[204:205], v[204:205], 1.0 op_sel_hi:[1,0]
    v_pk_add_f32 v[206:207], v[206:207], 1.0 op_sel_hi:[1,0]
    v_pk_add_f32 v[208:209], v[208:209], 1.0 op_sel_hi:[1,0]
    v_pk_add_f32 v[210:211], v[210:211], 1.0 op_sel_hi:[1,0]
    v_rcp_f32 v192, v192
    v_rcp_f32 v193, v193
    v_rcp_f32 v194, v194
    v_rcp_f32 v195, v195
    buffer_load_dwordx4 a[124:127], v8, s[28:31], s37 offen offset:1024
    v_rcp_f32 v196, v196
    v_rcp_f32 v197, v197
    v_rcp_f32 v198, v198
    v_rcp_f32 v199, v199
    v_rcp_f32 v200, v200
    v_rcp_f32 v201, v201
    v_rcp_f32 v202, v202
    v_rcp_f32 v203, v203
    v_rcp_f32 v204, v204
    buffer_load_dwordx4 a[128:131], v8, s[28:31], s37 offen offset:2048
    v_rcp_f32 v205, v205
    v_rcp_f32 v206, v206
    v_rcp_f32 v207, v207
    v_rcp_f32 v208, v208
    v_rcp_f32 v209, v209
    v_rcp_f32 v210, v210
    v_rcp_f32 v211, v211
    v_pk_mul_f32 v[32:33], v[32:33], v[192:193]
    v_pk_mul_f32 v[34:35], v[34:35], v[194:195]
    v_pk_mul_f32 v[36:37], v[36:37], v[196:197]
    buffer_load_dwordx4 a[132:135], v8, s[28:31], s37 offen offset:3072
    v_pk_mul_f32 v[38:39], v[38:39], v[198:199]
    v_pk_mul_f32 v[40:41], v[40:41], v[200:201]
    v_pk_mul_f32 v[42:43], v[42:43], v[202:203]
    v_pk_mul_f32 v[44:45], v[44:45], v[204:205]
    v_pk_mul_f32 v[46:47], v[46:47], v[206:207]
    v_pk_mul_f32 v[48:49], v[48:49], v[208:209]
    v_pk_mul_f32 v[50:51], v[50:51], v[210:211]
    v_cvt_pk_bf16_f32 v180, v32, v33
    v_cvt_pk_bf16_f32 v181, v34, v35
    v_cvt_pk_bf16_f32 v182, v36, v37
    v_cvt_pk_bf16_f32 v183, v38, v39
    v_cvt_pk_bf16_f32 v184, v40, v41
    v_cvt_pk_bf16_f32 v185, v42, v43
    v_cvt_pk_bf16_f32 v186, v44, v45
    v_cvt_pk_bf16_f32 v187, v46, v47
    v_cvt_pk_bf16_f32 v188, v48, v49
    v_cvt_pk_bf16_f32 v189, v50, v51
    s_nop 1
    v_permlane16_swap_b32 v180, v182
    v_permlane16_swap_b32 v181, v183
    v_permlane16_swap_b32 v184, v186
    v_permlane16_swap_b32 v185, v187
    s_mov_b64 exec, s[60:61]
    buffer_store_dwordx4 v[180:183], v241, s[28:31], s44 offen sc1
    buffer_store_dwordx4 v[184:187], v241, s[28:31], s44 offen offset:1024 sc1
    buffer_store_dwordx2 v[188:189], v242, s[28:31], s45 offen sc1
    s_mov_b64 exec, -1
    s_waitcnt vmcnt(0)
    s_barrier
    s_cmp_lg_u32 s20, 0
    s_cbranch_scc1 chain_kernel_sig1
    v_mov_b32 v2, 1
    v_mov_b32 v7, 0
    s_mov_b64 exec, 1
    buffer_store_dword v2, v7, s[28:31], s46 offen sc1
    s_mov_b64 exec, -1
chain_kernel_sig1:
    s_add_u32 s37, s37, 4096
    buffer_load_dwordx4 a[136:139], v8, s[28:31], s37 offen offset:0
    buffer_load_dwordx4 a[140:143], v8, s[28:31], s37 offen offset:1024
    s_mul_i32 s25, s20, 10
    s_lshl_b32 s25, s25, 10
    s_add_u32 s62, s25, 0
    s_add_u32 s63, s25, s54
    s_add_u32 s63, s63, 0
    s_mov_b32 m0, s62
    buffer_load_dwordx4 v8, s[28:31], s63 offen offset:0 lds
    buffer_load_dwordx4 v8, s[28:31], s63 offen offset:1024 lds
    buffer_load_dwordx4 v8, s[28:31], s63 offen offset:2048 lds
    buffer_load_dwordx4 v8, s[28:31], s63 offen offset:3072 lds
    s_add_u32 s62, s62, 4096
    s_add_u32 s63, s63, 4096
    s_mov_b32 m0, s62
    buffer_load_dwordx4 v8, s[28:31], s63 offen offset:0 lds
    buffer_load_dwordx4 v8, s[28:31], s63 offen offset:1024 lds
    buffer_load_dwordx4 v8, s[28:31], s63 offen offset:2048 lds
    buffer_load_dwordx4 v8, s[28:31], s63 offen offset:3072 lds
    s_add_u32 s62, s62, 4096
    s_add_u32 s63, s63, 4096
    s_mov_b32 m0, s62
    buffer_load_dwordx4 v8, s[28:31], s63 offen offset:0 lds
    buffer_load_dwordx4 v8, s[28:31], s63 offen offset:1024 lds
    s_lshl_b32 s26, s53, 3
    s_lshl_b32 s27, s20, 1
    s_add_u32 s56, s26, s27
    s_mul_i32 s6, s56, 20480
    s_add_u32 s6, s6, 13406208
    s_add_u32 s7, s6, 20480
    s_lshl_b32 s26, s53, 2
    s_add_u32 s26, s26, s20
    s_lshl_b32 s26, s26, 9
    s_add_u32 s8, s26, 29413376
    v_lshlrev_b32 v228, 3, v4
    v_lshl_add_u32 v228, v3, 8, v228
    s_lshl_b32 s9, s56, 10
    s_add_u32 s9, s9, 23105536
    s_and_b32 s42, s52, 1
    s_mul_i32 s12, s52, 7
    s_add_u32 s13, s12, 1
    s_lshr_b32 s13, s13, 1
    s_add_u32 s26, s13, 3
    s_sub_u32 s27, s13, 1
    s_cmp_eq_u32 s42, 1
    s_cselect_b32 s12, s27, s26
    s_lshl_b32 s13, s13, 10
    s_add_u32 s13, s13, 16027648
    s_lshl_b32 s12, s12, 10
    s_add_u32 s12, s12, 16027648
    s_lshl_b32 s14, s56, 4
    s_lshl_b32 s15, s53, 4
    s_add_u32 s15, s15, s52
    s_lshl_b32 s15, s15, 2
    s_add_u32 s15, s15, s20
    s_lshl_b32 s15, s15, 7
    s_add_u32 s15, s15, 29446144
    s_lshr_b32 s26, s43, 4
    s_lshl_b32 s26, s26, 3
    s_lshl_b32 s27, s24, 1
    s_add_u32 s26, s26, s27
    s_add_u32 s26, s26, s21
    s_lshl_b32 s26, s26, 7
    s_add_u32 s19, s26, 23105536
    v_add_u32 v226, s14, v4
    v_lshrrev_b32 v227, 4, v226
    v_and_b32 v226, 15, v226
    s_mov_b32 s27, 55296
    v_mul_lo_u32 v227, v227, s27
    v_lshl_add_u32 v227, v226, 4, v227
    v_and_b32 v226, 1, v3
    v_lshlrev_b32 v226, 9, v226
    v_lshrrev_b32 v2, 1, v3
    v_lshl_add_u32 v226, v2, 8, v226
    v_add_u32 v226, v226, v227
    s_lshl_b32 s27, s42, 9
    v_lshl_add_u32 v227, v2, 8, v227
    v_add_u32 v227, s27, v227
    v_and_b32 v2, 1, v3
    v_lshl_add_u32 v227, v2, 3, v227
    s_mov_b32 s48, 29380608
    s_mov_b32 s47, 0
    s_mov_b64 exec, 15
chain_kernel_poll2:
    buffer_load_dword v2, v245, s[28:31], s48 offen sc1
    s_add_u32 s47, s47, 1
    s_waitcnt vmcnt(0)
    v_cmp_ne_u32 vcc, 1, v2
    s_cmp_ge_u32 s47, 200000
    s_cbranch_scc1 chain_kernel_polld3
    s_cbranch_vccnz chain_kernel_poll2
chain_kernel_polld3:
    s_mov_b64 exec, -1
    buffer_load_dwordx4 v[72:75], v8, s[28:31], s50 offen offset:0 sc1
    buffer_load_dwordx4 v[76:79], v8, s[28:31], s51 offen offset:0 sc1
    buffer_load_dwordx4 v[80:83], v8, s[28:31], s50 offen offset:1024 sc1
    buffer_load_dwordx4 v[84:87], v8, s[28:31], s51 offen offset:1024 sc1
    buffer_load_dwordx4 v[88:91], v8, s[28:31], s50 offen offset:2048 sc1
    buffer_load_dwordx4 v[92:95], v8, s[28:31], s51 offen offset:2048 sc1
    buffer_load_dwordx4 v[96:99], v8, s[28:31], s50 offen offset:3072 sc1
    buffer_load_dwordx4 v[100:103], v8, s[28:31], s51 offen offset:3072 sc1
    s_add_u32 s50, s50, 4096
    s_add_u32 s51, s51, 4096
    buffer_load_dwordx4 v[104:107], v8, s[28:31], s50 offen offset:0 sc1
    buffer_load_dwordx4 v[108:111], v8, s[28:31], s51 offen offset:0 sc1
    s_waitcnt vmcnt(8)
    v_mfma_f32_16x16x32_bf16 v[32:35], a[200:203], v[72:75], 0
    v_mfma_f32_16x16x32_bf16 v[52:55], a[200:203], v[76:79], 0
    buffer_load_dwordx4 v[112:115], v8, s[28:31], s50 offen offset:1024 sc1
    v_mfma_f32_16x16x32_bf16 v[36:39], a[204:207], v[72:75], 0
    v_mfma_f32_16x16x32_bf16 v[56:59], a[204:207], v[76:79], 0
    v_mfma_f32_16x16x32_bf16 v[40:43], a[208:211], v[72:75], 0
    v_mfma_f32_16x16x32_bf16 v[60:63], a[208:211], v[76:79], 0
    buffer_load_dwordx4 v[116:119], v8, s[28:31], s51 offen offset:1024 sc1
    v_mfma_f32_16x16x32_bf16 v[44:47], a[212:215], v[72:75], 0
    v_mfma_f32_16x16x32_bf16 v[64:67], a[212:215], v[76:79], 0
    v_mfma_f32_16x16x32_bf16 v[48:51], a[216:219], v[72:75], 0
    v_mfma_f32_16x16x32_bf16 v[68:71], a[216:219], v[76:79], 0
    s_waitcnt vmcnt(8)
    v_mfma_f32_16x16x32_bf16 v[32:35], a[220:223], v[80:83], v[32:35]
    v_mfma_f32_16x16x32_bf16 v[52:55], a[220:223], v[84:87], v[52:55]
    buffer_load_dwordx4 v[120:123], v8, s[28:31], s50 offen offset:2048 sc1
    v_mfma_f32_16x16x32_bf16 v[36:39], a[224:227], v[80:83], v[36:39]
    v_mfma_f32_16x16x32_bf16 v[56:59], a[224:227], v[84:87], v[56:59]
    v_mfma_f32_16x16x32_bf16 v[40:43], a[228:231], v[80:83], v[40:43]
    v_mfma_f32_16x16x32_bf16 v[60:63], a[228:231], v[84:87], v[60:63]
    buffer_load_dwordx4 v[124:127], v8, s[28:31], s51 offen offset:2048 sc1
    v_mfma_f32_16x16x32_bf16 v[44:47], a[232:235], v[80:83], v[44:47]
    v_mfma_f32_16x16x32_bf16 v[64:67], a[232:235], v[84:87], v[64:67]
    v_mfma_f32_16x16x32_bf16 v[48:51], a[236:239], v[80:83], v[48:51]
    v_mfma_f32_16x16x32_bf16 v[68:71], a[236:239], v[84:87], v[68:71]
    s_waitcnt vmcnt(8)
    v_mfma_f32_16x16x32_bf16 v[32:35], a[240:243], v[88:91], v[32:35]
    v_mfma_f32_16x16x32_bf16 v[52:55], a[240:243], v[92:95], v[52:55]
    buffer_load_dwordx4 v[128:131], v8, s[28:31], s50 offen offset:3072 sc1
    v_mfma_f32_16x16x32_bf16 v[36:39], a[244:247], v[88:91], v[36:39]
    v_mfma_f32_16x16x32_bf16 v[56:59], a[244:247], v[92:95], v[56:59]
    v_mfma_f32_16x16x32_bf16 v[40:43], a[248:251], v[88:91], v[40:43]
    v_mfma_f32_16x16x32_bf16 v[60:63], a[248:251], v[92:95], v[60:63]
    buffer_load_dwordx4 v[132:135], v8, s[28:31], s51 offen offset:3072 sc1
    v_mfma_f32_16x16x32_bf16 v[44:47], a[252:255], v[88:91], v[44:47]
    v_mfma_f32_16x16x32_bf16 v[64:67], a[252:255], v[92:95], v[64:67]
    v_mfma_f32_16x16x32_bf16 v[48:51], a[0:3], v[88:91], v[48:51]
    v_mfma_f32_16x16x32_bf16 v[68:71], a[0:3], v[92:95], v[68:71]
    s_waitcnt vmcnt(8)
    v_mfma_f32_16x16x32_bf16 v[32:35], a[4:7], v[96:99], v[32:35]
    v_mfma_f32_16x16x32_bf16 v[52:55], a[4:7], v[100:103], v[52:55]
    s_add_u32 s50, s50, 4096
    s_add_u32 s51, s51, 4096
    buffer_load_dwordx4 v[136:139], v8, s[28:31], s50 offen offset:0 sc1
    v_mfma_f32_16x16x32_bf16 v[36:39], a[8:11], v[96:99], v[36:39]
    v_mfma_f32_16x16x32_bf16 v[56:59], a[8:11], v[100:103], v[56:59]
    v_mfma_f32_16x16x32_bf16 v[40:43], a[12:15], v[96:99], v[40:43]
    v_mfma_f32_16x16x32_bf16 v[60:63], a[12:15], v[100:103], v[60:63]
    buffer_load_dwordx4 v[140:143], v8, s[28:31], s51 offen offset:0 sc1
    v_mfma_f32_16x16x32_bf16 v[44:47], a[16:19], v[96:99], v[44:47]
    v_mfma_f32_16x16x32_bf16 v[64:67], a[16:19], v[100:103], v[64:67]
    v_mfma_f32_16x16x32_bf16 v[48:51], a[20:23], v[96:99], v[48:51]
    v_mfma_f32_16x16x32_bf16 v[68:71], a[20:23], v[100:103], v[68:71]
    s_waitcnt vmcnt(8)
    v_mfma_f32_16x16x32_bf16 v[32:35], a[24:27], v[104:107], v[32:35]
    v_mfma_f32_16x16x32_bf16 v[52:55], a[24:27], v[108:111], v[52:55]
    buffer_load_dwordx4 v[144:147], v8, s[28:31], s50 offen offset:1024 sc1
    v_mfma_f32_16x16x32_bf16 v[36:39], a[28:31], v[104:107], v[36:39]
    v_mfma_f32_16x16x32_bf16 v[56:59], a[28:31], v[108:111], v[56:59]
    v_mfma_f32_16x16x32_bf16 v[40:43], a[32:35], v[104:107], v[40:43]
    v_mfma_f32_16x16x32_bf16 v[60:63], a[32:35], v[108:111], v[60:63]
    buffer_load_dwordx4 v[148:151], v8, s[28:31], s51 offen offset:1024 sc1
    v_mfma_f32_16x16x32_bf16 v[44:47], a[36:39], v[104:107], v[44:47]
    v_mfma_f32_16x16x32_bf16 v[64:67], a[36:39], v[108:111], v[64:67]
    s_mul_i32 s25, s20, 20
    s_lshl_b32 s25, s25, 10
    s_add_u32 s62, s25, 40960
    s_add_u32 s63, s25, s54
    s_add_u32 s63, s63, 40960
    s_mov_b32 m0, s62
    buffer_load_dwordx4 v8, s[28:31], s63 offen offset:0 lds
    v_mfma_f32_16x16x32_bf16 v[48:51], a[40:43], v[104:107], v[48:51]
    v_mfma_f32_16x16x32_bf16 v[68:71], a[40:43], v[108:111], v[68:71]
    s_waitcnt vmcnt(9)
    v_mfma_f32_16x16x32_bf16 v[32:35], a[44:47], v[112:115], v[32:35]
    v_mfma_f32_16x16x32_bf16 v[52:55], a[44:47], v[116:119], v[52:55]
    buffer_load_dwordx4 v8, s[28:31], s63 offen offset:1024 lds
    v_mfma_f32_16x16x32_bf16 v[36:39], a[48:51], v[112:115], v[36:39]
    v_mfma_f32_16x16x32_bf16 v[56:59], a[48:51], v[116:119], v[56:59]
    buffer_load_dwordx4 v8, s[28:31], s63 offen offset:2048 lds
    v_mfma_f32_16x16x32_bf16 v[40:43], a[52:55], v[112:115], v[40:43]
    v_mfma_f32_16x16x32_bf16 v[60:63], a[52:55], v[116:119], v[60:63]
    v_mfma_f32_16x16x32_bf16 v[44:47], a[56:59], v[112:115], v[44:47]
    v_mfma_f32_16x16x32_bf16 v[64:67], a[56:59], v[116:119], v[64:67]
    buffer_load_dwordx4 v8, s[28:31], s63 offen offset:3072 lds
    v_mfma_f32_16x16x32_bf16 v[48:51], a[60:63], v[112:115], v[48:51]
    v_mfma_f32_16x16x32_bf16 v[68:71], a[60:63], v[116:119], v[68:71]
    s_waitcnt vmcnt(10)
    v_mfma_f32_16x16x32_bf16 v[32:35], a[64:67], v[120:123], v[32:35]
    v_mfma_f32_16x16x32_bf16 v[52:55], a[64:67], v[124:127], v[52:55]
    s_add_u32 s62, s62, 4096
    s_add_u32 s63, s63, 4096
    s_mov_b32 m0, s62
    buffer_load_dwordx4 v8, s[28:31], s63 offen offset:0 lds
    v_mfma_f32_16x16x32_bf16 v[36:39], a[68:71], v[120:123], v[36:39]
    v_mfma_f32_16x16x32_bf16 v[56:59], a[68:71], v[124:127], v[56:59]
    buffer_load_dwordx4 v8, s[28:31], s63 offen offset:1024 lds
    v_mfma_f32_16x16x32_bf16 v[40:43], a[72:75], v[120:123], v[40:43]
    v_mfma_f32_16x16x32_bf16 v[60:63], a[72:75], v[124:127], v[60:63]
    v_mfma_f32_16x16x32_bf16 v[44:47], a[76:79], v[120:123], v[44:47]
    v_mfma_f32_16x16x32_bf16 v[64:67], a[76:79], v[124:127], v[64:67]
    buffer_load_dwordx4 v8, s[28:31], s63 offen offset:2048 lds
    v_mfma_f32_16x16x32_bf16 v[48:51], a[80:83], v[120:123], v[48:51]
    v_mfma_f32_16x16x32_bf16 v[68:71], a[80:83], v[124:127], v[68:71]
    s_waitcnt vmcnt(11)
    v_mfma_f32_16x16x32_bf16 v[32:35], a[84:87], v[128:131], v[32:35]
    v_mfma_f32_16x16x32_bf16 v[52:55], a[84:87], v[132:135], v[52:55]
    buffer_load_dwordx4 v8, s[28:31], s63 offen offset:3072 lds
    v_mfma_f32_16x16x32_bf16 v[36:39], a[88:91], v[128:131], v[36:39]
    v_mfma_f32_16x16x32_bf16 v[56:59], a[88:91], v[132:135], v[56:59]
    s_add_u32 s62, s62, 4096
    s_add_u32 s63, s63, 4096
    s_mov_b32 m0, s62
    buffer_load_dwordx4 v8, s[28:31], s63 offen offset:0 lds
    v_mfma_f32_16x16x32_bf16 v[40:43], a[92:95], v[128:131], v[40:43]
    v_mfma_f32_16x16x32_bf16 v[60:63], a[92:95], v[132:135], v[60:63]
    v_mfma_f32_16x16x32_bf16 v[44:47], a[96:99], v[128:131], v[44:47]
    v_mfma_f32_16x16x32_bf16 v[64:67], a[96:99], v[132:135], v[64:67]
    buffer_load_dwordx4 v8, s[28:31], s63 offen offset:1024 lds
    v_mfma_f32_16x16x32_bf16 v[48:51], a[100:103], v[128:131], v[48:51]
    v_mfma_f32_16x16x32_bf16 v[68:71], a[100:103], v[132:135], v[68:71]
    s_waitcnt vmcnt(12)
    v_mfma_f32_16x16x32_bf16 v[32:35], a[104:107], v[136:139], v[32:35]
    v_mfma_f32_16x16x32_bf16 v[52:55], a[104:107], v[140:143], v[52:55]
    buffer_load_dwordx4 v8, s[28:31], s63 offen offset:2048 lds
    v_mfma_f32_16x16x32_bf16 v[36:39], a[108:111], v[136:139], v[36:39]
    v_mfma_f32_16x16x32_bf16 v[56:59], a[108:111], v[140:143], v[56:59]
    buffer_load_dwordx4 v8, s[28:31], s63 offen offset:3072 lds
    v_mfma_f32_16x16x32_bf16 v[40:43], a[112:115], v[136:139], v[40:43]
    v_mfma_f32_16x16x32_bf16 v[60:63], a[112:115], v[140:143], v[60:63]
    v_mfma_f32_16x16x32_bf16 v[44:47], a[116:119], v[136:139], v[44:47]
    v_mfma_f32_16x16x32_bf16 v[64:67], a[116:119], v[140:143], v[64:67]
    s_add_u32 s62, s62, 4096
    s_add_u32 s63, s63, 4096
    s_mov_b32 m0, s62
    buffer_load_dwordx4 v8, s[28:31], s63 offen offset:0 lds
    v_mfma_f32_16x16x32_bf16 v[48:51], a[120:123], v[136:139], v[48:51]
    v_mfma_f32_16x16x32_bf16 v[68:71], a[120:123], v[140:143], v[68:71]
    s_waitcnt vmcnt(13)
    v_mfma_f32_16x16x32_bf16 v[32:35], a[124:127], v[144:147], v[32:35]
    v_mfma_f32_16x16x32_bf16 v[52:55], a[124:127], v[148:151], v[52:55]
    buffer_load_dwordx4 v8, s[28:31], s63 offen offset:1024 lds
    v_mfma_f32_16x16x32_bf16 v[36:39], a[128:131], v[144:147], v[36:39]
    v_mfma_f32_16x16x32_bf16 v[56:59], a[128:131], v[148:151], v[56:59]
    buffer_load_dwordx4 v8, s[28:31], s63 offen offset:2048 lds
    v_mfma_f32_16x16x32_bf16 v[40:43], a[132:135], v[144:147], v[40:43]
    v_mfma_f32_16x16x32_bf16 v[60:63], a[132:135], v[148:151], v[60:63]
    v_mfma_f32_16x16x32_bf16 v[44:47], a[136:139], v[144:147], v[44:47]
    v_mfma_f32_16x16x32_bf16 v[64:67], a[136:139], v[148:151], v[64:67]
    buffer_load_dwordx4 v8, s[28:31], s63 offen offset:3072 lds
    v_mfma_f32_16x16x32_bf16 v[48:51], a[140:143], v[144:147], v[48:51]
    v_mfma_f32_16x16x32_bf16 v[68:71], a[140:143], v[148:151], v[68:71]
    s_nop 4
    ds_write_b128 v246, v[52:55] offset:0
    ds_write_b128 v246, v[56:59] offset:1024
    ds_write_b128 v246, v[60:63] offset:2048
    ds_write_b128 v246, v[64:67] offset:3072
    ds_write_b128 v246, v[68:71] offset:4096
    v_lshlrev_b32 v112, 16, v16
    v_and_b32 v113, 0xffff0000, v16
    v_lshlrev_b32 v114, 16, v17
    v_and_b32 v115, 0xffff0000, v17
    v_lshlrev_b32 v116, 16, v18
    v_and_b32 v117, 0xffff0000, v18
    v_lshlrev_b32 v118, 16, v19
    v_and_b32 v119, 0xffff0000, v19
    v_lshlrev_b32 v120, 16, v20
    v_and_b32 v121, 0xffff0000, v20
    v_lshlrev_b32 v122, 16, v21
    v_and_b32 v123, 0xffff0000, v21
    v_lshlrev_b32 v124, 16, v22
    v_and_b32 v125, 0xffff0000, v22
    v_lshlrev_b32 v126, 16, v23
    v_and_b32 v127, 0xffff0000, v23
    v_lshlrev_b32 v128, 16, v24
    v_and_b32 v129, 0xffff0000, v24
    v_lshlrev_b32 v130, 16, v25
    v_and_b32 v131, 0xffff0000, v25
    v_pk_add_f32 v[32:33], v[32:33], v[112:113]
    v_pk_add_f32 v[34:35], v[34:35], v[114:115]
    v_pk_add_f32 v[36:37], v[36:37], v[116:117]
    v_pk_add_f32 v[38:39], v[38:39], v[118:119]
    v_pk_add_f32 v[40:41], v[40:41], v[120:121]
    v_pk_add_f32 v[42:43], v[42:43], v[122:123]
    v_pk_add_f32 v[44:45], v[44:45], v[124:125]
    v_pk_add_f32 v[46:47], v[46:47], v[126:127]
    v_pk_add_f32 v[48:49], v[48:49], v[128:129]
    v_pk_add_f32 v[50:51], v[50:51], v[130:131]
    v_mov_b32 v28, 0
    v_mov_b32 v29, 0
    s_add_u32 s62, s62, 4096
    s_add_u32 s63, s63, 4096
    s_mov_b32 m0, s62
    buffer_load_dwordx4 v8, s[28:31], s63 offen offset:0 lds
    buffer_load_dwordx4 v8, s[28:31], s63 offen offset:1024 lds
    buffer_load_dwordx4 v8, s[28:31], s63 offen offset:2048 lds
    buffer_load_dwordx4 v8, s[28:31], s63 offen offset:3072 lds
    s_mul_i32 s25, s20, 5
    s_lshl_b32 s25, s25, 10
    s_add_u32 s62, s25, 122880
    s_add_u32 s63, s25, s54
    s_add_u32 s63, s63, 122880
    s_mov_b32 m0, s62
    buffer_load_dwordx4 v8, s[28:31], s63 offen offset:0 lds
    buffer_load_dwordx4 v8, s[28:31], s63 offen offset:1024 lds
    buffer_load_dwordx4 v8, s[28:31], s63 offen offset:2048 lds
    buffer_load_dwordx4 v8, s[28:31], s63 offen offset:3072 lds
    s_add_u32 s62, s62, 4096
    s_add_u32 s63, s63, 4096
    s_mov_b32 m0, s62
    buffer_load_dwordx4 v8, s[28:31], s63 offen offset:0 lds
    s_waitcnt lgkmcnt(0)
    s_barrier
    ds_read_b128 v[88:91], v247 offset:0
    ds_read_b128 v[92:95], v247 offset:1024
    ds_read_b128 v[96:99], v247 offset:2048
    ds_read_b128 v[100:103], v247 offset:3072
    ds_read_b128 v[104:107], v247 offset:4096
    s_waitcnt lgkmcnt(4)
    v_pk_add_f32 v[32:33], v[32:33], v[88:89]
    v_pk_add_f32 v[34:35], v[34:35], v[90:91]
    v_cvt_pk_bf16_f32 v180, v32, v33
    v_cvt_pk_bf16_f32 v181, v34, v35
    s_waitcnt lgkmcnt(3)
    v_pk_add_f32 v[36:37], v[36:37], v[92:93]
    v_pk_add_f32 v[38:39], v[38:39], v[94:95]
    v_cvt_pk_bf16_f32 v182, v36, v37
    v_cvt_pk_bf16_f32 v183, v38, v39
    s_waitcnt lgkmcnt(2)
    v_pk_add_f32 v[40:41], v[40:41], v[96:97]
    v_pk_add_f32 v[42:43], v[42:43], v[98:99]
    v_cvt_pk_bf16_f32 v184, v40, v41
    v_cvt_pk_bf16_f32 v185, v42, v43
    s_waitcnt lgkmcnt(1)
    v_pk_add_f32 v[44:45], v[44:45], v[100:101]
    v_pk_add_f32 v[46:47], v[46:47], v[102:103]
    v_cvt_pk_bf16_f32 v186, v44, v45
    v_cvt_pk_bf16_f32 v187, v46, v47
    s_waitcnt lgkmcnt(0)
    v_pk_add_f32 v[48:49], v[48:49], v[104:105]
    v_pk_add_f32 v[50:51], v[50:51], v[106:107]
    v_cvt_pk_bf16_f32 v188, v48, v49
    v_cvt_pk_bf16_f32 v189, v50, v51
    v_dot2_f32_bf16 v28, v180, v224, v28
    v_dot2_f32_bf16 v29, v180, v180, v29
    v_dot2_f32_bf16 v28, v181, v224, v28
    v_dot2_f32_bf16 v29, v181, v181, v29
    v_dot2_f32_bf16 v28, v182, v224, v28
    v_dot2_f32_bf16 v29, v182, v182, v29
    v_dot2_f32_bf16 v28, v183, v224, v28
    v_dot2_f32_bf16 v29, v183, v183, v29
    v_dot2_f32_bf16 v28, v184, v224, v28
    v_dot2_f32_bf16 v29, v184, v184, v29
    v_dot2_f32_bf16 v28, v185, v224, v28
    v_dot2_f32_bf16 v29, v185, v185, v29
    v_dot2_f32_bf16 v28, v186, v224, v28
    v_dot2_f32_bf16 v29, v186, v186, v29
    v_dot2_f32_bf16 v28, v187, v224, v28
    v_dot2_f32_bf16 v29, v187, v187, v29
    v_dot2_f32_bf16 v28, v188, v224, v28
    v_dot2_f32_bf16 v29, v188, v188, v29
    v_dot2_f32_bf16 v28, v189, v224, v28
    v_dot2_f32_bf16 v29, v189, v189, v29
    s_nop 1
    v_permlane16_swap_b32 v180, v182
    v_permlane16_swap_b32 v181, v183
    v_permlane16_swap_b32 v184, v186
    v_permlane16_swap_b32 v185, v187
    buffer_store_dwordx4 v[180:183], v243, s[28:31], s38 offen sc1
    buffer_store_dwordx4 v[184:187], v243, s[28:31], s38 offen offset:1024 sc1
    buffer_store_dwordx2 v[188:189], v244, s[28:31], s39 offen sc1
    v_mov_b32 v160, v28
    v_mov_b32 v161, v29
    s_nop 1
    v_permlane32_swap_b32 v160, v28
    v_permlane32_swap_b32 v161, v29
    s_nop 1
    v_add_f32 v28, v28, v160
    v_add_f32 v29, v29, v161
    v_mov_b32 v160, v28
    v_mov_b32 v161, v29
    s_nop 1
    v_permlane16_swap_b32 v160, v28
    v_permlane16_swap_b32 v161, v29
    s_nop 1
    v_add_f32 v28, v28, v160
    v_add_f32 v29, v29, v161
    v_lshlrev_b32 v2, 3, v4
    s_mov_b64 exec, 0xffff
    buffer_store_dwordx2 v[28:29], v2, s[28:31], s19 offen sc1
    s_mov_b64 exec, -1
    s_waitcnt vmcnt(0)
    s_barrier
    s_cmp_lg_u32 s20, 0
    s_cbranch_scc1 chain_kernel_sig4
    v_mov_b32 v2, 1
    v_mov_b32 v7, 0
    s_mov_b64 exec, 1
    buffer_store_dword v2, v7, s[28:31], s49 offen sc1
    s_mov_b64 exec, -1
chain_kernel_sig4:
    v_and_b32 v2, 31, v1
    v_lshlrev_b32 v2, 4, v2
    v_lshrrev_b32 v7, 5, v1
    v_mul_u32_u24 v7, 7168, v7
    v_add_u32 v2, v2, v7
    s_mul_i32 s26, s52, 448
    s_add_u32 s26, s26, 8130560
    s_mov_b32 m0, 162816
    s_nop 0
    buffer_load_dwordx4 v2, s[28:31], s26 offen lds
    s_and_b32 s36, s57, 1
    s_lshl_b32 s43, s58, 6
    s_lshl_b32 s26, s21, 5
    s_add_u32 s43, s43, s26
    s_lshl_b32 s26, s22, 4
    s_add_u32 s43, s43, s26
    s_mul_i32 s40, s57, 5
    s_add_u32 s41, s40, 1
    s_lshr_b32 s41, s41, 1
    s_add_u32 s26, s41, 2
    s_sub_u32 s27, s41, 1
    s_cmp_eq_u32 s36, 1
    s_cselect_b32 s40, s27, s26
    s_lshl_b32 s44, s41, 10
    s_lshl_b32 s45, s40, 10
    s_lshl_b32 s26, s36, 9
    s_add_u32 s45, s45, s26
    s_lshr_b32 s26, s58, 1
    s_lshl_b32 s26, s26, 4
    s_mul_i32 s27, s22, 7
    s_add_u32 s26, s26, s27
    s_lshl_b32 s26, s26, 2
    s_and_b32 s27, s58, 1
    s_lshl_b32 s27, s27, 1
    s_add_u32 s26, s26, s27
    s_add_u32 s26, s26, s21
    s_lshl_b32 s26, s26, 7
    s_add_u32 s48, s26, 29446144
    v_lshlrev_b32 v234, 9, v1
    s_lshl_b32 s26, s58, 2
    s_lshl_b32 s27, s21, 1
    s_add_u32 s26, s26, s27
    s_add_u32 s27, s26, s22
    s_mul_i32 s27, s27, 54
    s_mul_i32 s39, s22, 27
    s_add_u32 s27, s27, s39
    s_lshl_b32 s27, s27, 10
    s_add_u32 s50, s27, 16027648
    s_add_u32 s27, s26, 1
    s_sub_u32 s27, s27, s22
    s_mul_i32 s27, s27, 54
    s_add_u32 s27, s27, s39
    s_lshl_b32 s27, s27, 10
    s_add_u32 s51, s27, 16027648
    v_add_u32 v9, s43, v4
    v_lshrrev_b32 v11, 4, v9
    v_and_b32 v10, 15, v9
    v_mul_u32_u24 v11, 20480, v11
    v_lshl_add_u32 v11, v10, 4, v11
    v_lshrrev_b32 v2, 1, v3
    v_lshl_add_u32 v11, v2, 8, v11
    v_and_b32 v7, 1, v3
    v_lshl_add_u32 v230, v7, 3, v11
    v_mul_u32_u24 v9, 1280, v9
    v_lshlrev_b32 v7, 5, v7
    v_lshl_add_u32 v7, v2, 4, v7
    v_add_u32 v231, v9, v7
    v_lshl_add_u32 v232, v3, 3, v9
    v_lshlrev_b32 v233, 4, v3
    v_add_u32 v9, s43, v4
    v_lshrrev_b32 v10, 4, v9
    v_mul_u32_u24 v10, 20480, v10
    v_and_b32 v11, 1, v9
    v_lshl_add_u32 v10, v11, 3, v10
    v_lshl_add_u32 v10, v3, 7, v10
    v_bfe_u32 v11, v9, 1, 3
    s_mul_i32 s26, s57, 20
    s_lshl_b32 s27, s36, 2
    s_add_u32 s27, s27, s26
    s_mul_i32 s3, s36, 16
    s_sub_u32 s3, 16, s3
    s_add_u32 s3, s3, s26
    s_add_u32 s4, s27, 0
    v_add_u32 v2, s4, v3
    v_bfe_u32 v2, v2, 1, 3
    v_xor_b32 v2, v2, v11
    v_lshl_add_u32 v2, v2, 4, v10
    s_lshl_b32 s4, s4, 7
    v_add_u32 v235, s4, v2
    s_add_u32 s4, s27, 4
    v_add_u32 v2, s4, v3
    v_bfe_u32 v2, v2, 1, 3
    v_xor_b32 v2, v2, v11
    v_lshl_add_u32 v2, v2, 4, v10
    s_lshl_b32 s4, s4, 7
    v_add_u32 v236, s4, v2
    s_add_u32 s4, s27, 8
    v_add_u32 v2, s4, v3
    v_bfe_u32 v2, v2, 1, 3
    v_xor_b32 v2, v2, v11
    v_lshl_add_u32 v2, v2, 4, v10
    s_lshl_b32 s4, s4, 7
    v_add_u32 v237, s4, v2
    s_add_u32 s4, s27, 12
    v_add_u32 v2, s4, v3
    v_bfe_u32 v2, v2, 1, 3
    v_xor_b32 v2, v2, v11
    v_lshl_add_u32 v2, v2, 4, v10
    s_lshl_b32 s4, s4, 7
    v_add_u32 v238, s4, v2
    s_mov_b32 s4, s3
    v_add_u32 v2, s4, v3
    v_bfe_u32 v2, v2, 1, 3
    v_xor_b32 v2, v2, v11
    v_lshl_add_u32 v2, v2, 4, v10
    s_lshl_b32 s4, s4, 7
    v_add_u32 v239, s4, v2
    s_mul_i32 s37, s57, 320
    s_add_u32 s37, s37, 8126976
    s_mul_i32 s26, s36, 256
    s_sub_u32 s26, 256, s26
    s_add_u32 s38, s37, s26
    s_lshl_b32 s26, s36, 6
    s_add_u32 s37, s37, s26
    s_mul_i32 s26, s57, 160
    s_lshl_b32 s27, s36, 5
    s_add_u32 s46, s26, s27
    s_mul_i32 s27, s36, 128
    s_sub_u32 s27, 128, s27
    s_add_u32 s49, s26, s27
    s_waitcnt vmcnt(0)
    s_lshl_b32 s26, s42, 6
    v_lshlrev_b32 v2, 4, v3
    v_add_u32 v7, 162816, v2
    v_add_u32 v2, s26, v7
    s_mul_i32 s26, s42, 384
    s_sub_u32 s26, 384, s26
    v_add_u32 v7, s26, v7
    ds_read_b128 v[88:91], v2 offset:0
    ds_read_b128 v[116:119], v2 offset:512
    ds_read_b128 v[92:95], v2 offset:64
    ds_read_b128 v[120:123], v2 offset:576
    ds_read_b128 v[96:99], v2 offset:128
    ds_read_b128 v[124:127], v2 offset:640
    ds_read_b128 v[100:103], v2 offset:192
    ds_read_b128 v[128:131], v2 offset:704
    ds_read_b128 v[104:107], v2 offset:256
    ds_read_b128 v[132:135], v2 offset:768
    ds_read_b128 v[108:111], v2 offset:320
    ds_read_b128 v[136:139], v2 offset:832
    ds_read_b128 v[112:115], v7
    ds_read_b128 v[140:143], v7 offset:512
    s_waitcnt lgkmcnt(0)
    v_pk_add_f32 v[88:89], v[88:89], v[116:117]
    v_pk_add_f32 v[90:91], v[90:91], v[118:119]
    v_pk_add_f32 v[92:93], v[92:93], v[120:121]
    v_pk_add_f32 v[94:95], v[94:95], v[122:123]
    v_pk_add_f32 v[96:97], v[96:97], v[124:125]
    v_pk_add_f32 v[98:99], v[98:99], v[126:127]
    v_pk_add_f32 v[100:101], v[100:101], v[128:129]
    v_pk_add_f32 v[102:103], v[102:103], v[130:131]
    v_pk_add_f32 v[104:105], v[104:105], v[132:133]
    v_pk_add_f32 v[106:107], v[106:107], v[134:135]
    v_pk_add_f32 v[108:109], v[108:109], v[136:137]
    v_pk_add_f32 v[110:111], v[110:111], v[138:139]
    v_pk_add_f32 v[112:113], v[112:113], v[140:141]
    v_pk_add_f32 v[114:115], v[114:115], v[142:143]
    v_mov_b32 v12, v8
    v_add_u32 v13, 0x10000, v8
    v_add_u32 v14, 0x20000, v8
    ds_read_b128 a[160:163], v12 offset:0
    ds_read_b128 a[164:167], v12 offset:1024
    ds_read_b128 a[168:171], v12 offset:2048
    ds_read_b128 a[172:175], v12 offset:3072
    ds_read_b128 a[176:179], v13 offset:57344
    ds_read_b128 a[180:183], v12 offset:4096
    ds_read_b128 a[184:187], v12 offset:5120
    ds_read_b128 a[188:191], v12 offset:6144
    ds_read_b128 a[192:195], v12 offset:7168
    ds_read_b128 a[196:199], v13 offset:58368
    ds_read_b128 a[200:203], v12 offset:8192
    v_lshlrev_b32 v7, 7, v1
    s_mov_b32 s47, 0
    s_mov_b64 exec, 15
chain_kernel_poll5:
    buffer_load_dword v2, v7, s[28:31], s8 offen sc1
    s_add_u32 s47, s47, 1
    s_waitcnt vmcnt(0)
    v_cmp_ne_u32 vcc, 1, v2
    s_cmp_ge_u32 s47, 200000
    s_cbranch_scc1 chain_kernel_polld6
    s_cbranch_vccnz chain_kernel_poll5
chain_kernel_polld6:
    s_mov_b64 exec, -1
    buffer_load_dwordx4 a[0:3], v8, s[28:31], s6 offen offset:0 sc1
    buffer_load_dwordx4 a[4:7], v8, s[28:31], s7 offen offset:0 sc1
    buffer_load_dwordx4 a[8:11], v8, s[28:31], s6 offen offset:1024 sc1
    buffer_load_dwordx4 a[12:15], v8, s[28:31], s7 offen offset:1024 sc1
    buffer_load_dwordx4 a[16:19], v8, s[28:31], s6 offen offset:2048 sc1
    buffer_load_dwordx4 a[20:23], v8, s[28:31], s7 offen offset:2048 sc1
    buffer_load_dwordx4 a[24:27], v8, s[28:31], s6 offen offset:3072 sc1
    buffer_load_dwordx4 a[28:31], v8, s[28:31], s7 offen offset:3072 sc1
    s_add_u32 s6, s6, 4096
    s_add_u32 s7, s7, 4096
    buffer_load_dwordx4 a[32:35], v8, s[28:31], s6 offen offset:0 sc1
    buffer_load_dwordx4 a[36:39], v8, s[28:31], s7 offen offset:0 sc1
    s_waitcnt vmcnt(8) lgkmcnt(6)
    v_mfma_f32_16x16x32_bf16 v[32:35], a[160:163], a[0:3], 0
    v_mfma_f32_16x16x32_bf16 v[60:63], a[160:163], a[4:7], 0
    ds_read_b128 a[204:207], v12 offset:9216
    buffer_load_dwordx4 a[40:43], v8, s[28:31], s6 offen offset:1024 sc1
    v_mfma_f32_16x16x32_bf16 v[36:39], a[164:167], a[0:3], 0
    v_mfma_f32_16x16x32_bf16 v[64:67], a[164:167], a[4:7], 0
    ds_read_b128 a[160:163], v12 offset:10240
    v_mfma_f32_16x16x32_bf16 v[40:43], a[168:171], a[0:3], 0
    v_mfma_f32_16x16x32_bf16 v[68:71], a[168:171], a[4:7], 0
    ds_read_b128 a[164:167], v12 offset:11264
    buffer_load_dwordx4 a[44:47], v8, s[28:31], s7 offen offset:1024 sc1
    v_mfma_f32_16x16x32_bf16 v[44:47], a[172:175], a[0:3], 0
    v_mfma_f32_16x16x32_bf16 v[72:75], a[172:175], a[4:7], 0
    ds_read_b128 a[168:171], v13 offset:59392
    v_mfma_f32_16x16x32_bf16 v[56:59], a[176:179], a[0:3], 0
    v_mfma_f32_16x16x32_bf16 v[84:87], a[176:179], a[4:7], 0
    ds_read_b128 a[172:175], v12 offset:12288
    s_waitcnt vmcnt(8) lgkmcnt(6)
    v_mfma_f32_16x16x32_bf16 v[32:35], a[180:183], a[8:11], v[32:35]
    v_mfma_f32_16x16x32_bf16 v[60:63], a[180:183], a[12:15], v[60:63]
    ds_read_b128 a[176:179], v12 offset:13312
    buffer_load_dwordx4 a[48:51], v8, s[28:31], s6 offen offset:2048 sc1
    v_mfma_f32_16x16x32_bf16 v[36:39], a[184:187], a[8:11], v[36:39]
    v_mfma_f32_16x16x32_bf16 v[64:67], a[184:187], a[12:15], v[64:67]
    ds_read_b128 a[180:183], v12 offset:14336
    v_mfma_f32_16x16x32_bf16 v[40:43], a[188:191], a[8:11], v[40:43]
    v_mfma_f32_16x16x32_bf16 v[68:71], a[188:191], a[12:15], v[68:71]
    ds_read_b128 a[184:187], v12 offset:15360
    buffer_load_dwordx4 a[52:55], v8, s[28:31], s7 offen offset:2048 sc1
    v_mfma_f32_16x16x32_bf16 v[44:47], a[192:195], a[8:11], v[44:47]
    v_mfma_f32_16x16x32_bf16 v[72:75], a[192:195], a[12:15], v[72:75]
    ds_read_b128 a[188:191], v13 offset:60416
    v_mfma_f32_16x16x32_bf16 v[56:59], a[196:199], a[8:11], v[56:59]
    v_mfma_f32_16x16x32_bf16 v[84:87], a[196:199], a[12:15], v[84:87]
    ds_read_b128 a[192:195], v12 offset:16384
    s_waitcnt vmcnt(8) lgkmcnt(6)
    v_mfma_f32_16x16x32_bf16 v[32:35], a[200:203], a[16:19], v[32:35]
    v_mfma_f32_16x16x32_bf16 v[60:63], a[200:203], a[20:23], v[60:63]
    ds_read_b128 a[196:199], v12 offset:17408
    buffer_load_dwordx4 a[56:59], v8, s[28:31], s6 offen offset:3072 sc1
    v_mfma_f32_16x16x32_bf16 v[36:39], a[204:207], a[16:19], v[36:39]
    v_mfma_f32_16x16x32_bf16 v[64:67], a[204:207], a[20:23], v[64:67]
    ds_read_b128 a[200:203], v12 offset:18432
    v_mfma_f32_16x16x32_bf16 v[40:43], a[160:163], a[16:19], v[40:43]
    v_mfma_f32_16x16x32_bf16 v[68:71], a[160:163], a[20:23], v[68:71]
    ds_read_b128 a[204:207], v12 offset:19456
    buffer_load_dwordx4 a[60:63], v8, s[28:31], s7 offen offset:3072 sc1
    v_mfma_f32_16x16x32_bf16 v[44:47], a[164:167], a[16:19], v[44:47]
    v_mfma_f32_16x16x32_bf16 v[72:75], a[164:167], a[20:23], v[72:75]
    ds_read_b128 a[160:163], v13 offset:61440
    v_mfma_f32_16x16x32_bf16 v[56:59], a[168:171], a[16:19], v[56:59]
    v_mfma_f32_16x16x32_bf16 v[84:87], a[168:171], a[20:23], v[84:87]
    ds_read_b128 a[164:167], v12 offset:20480
    s_waitcnt vmcnt(8) lgkmcnt(6)
    v_mfma_f32_16x16x32_bf16 v[32:35], a[172:175], a[24:27], v[32:35]
    v_mfma_f32_16x16x32_bf16 v[60:63], a[172:175], a[28:31], v[60:63]
    ds_read_b128 a[168:171], v12 offset:21504
    s_add_u32 s6, s6, 4096
    s_add_u32 s7, s7, 4096
    buffer_load_dwordx4 a[64:67], v8, s[28:31], s6 offen offset:0 sc1
    v_mfma_f32_16x16x32_bf16 v[36:39], a[176:179], a[24:27], v[36:39]
    v_mfma_f32_16x16x32_bf16 v[64:67], a[176:179], a[28:31], v[64:67]
    ds_read_b128 a[172:175], v12 offset:22528
    v_mfma_f32_16x16x32_bf16 v[40:43], a[180:183], a[24:27], v[40:43]
    v_mfma_f32_16x16x32_bf16 v[68:71], a[180:183], a[28:31], v[68:71]
    ds_read_b128 a[176:179], v12 offset:23552
    buffer_load_dwordx4 a[68:71], v8, s[28:31], s7 offen offset:0 sc1
    v_mfma_f32_16x16x32_bf16 v[44:47], a[184:187], a[24:27], v[44:47]
    v_mfma_f32_16x16x32_bf16 v[72:75], a[184:187], a[28:31], v[72:75]
    ds_read_b128 a[180:183], v13 offset:62464
    v_mfma_f32_16x16x32_bf16 v[56:59], a[188:191], a[24:27], v[56:59]
    v_mfma_f32_16x16x32_bf16 v[84:87], a[188:191], a[28:31], v[84:87]
    ds_read_b128 a[184:187], v12 offset:24576
    s_waitcnt vmcnt(8) lgkmcnt(6)
    v_mfma_f32_16x16x32_bf16 v[32:35], a[192:195], a[32:35], v[32:35]
    v_mfma_f32_16x16x32_bf16 v[60:63], a[192:195], a[36:39], v[60:63]
    ds_read_b128 a[188:191], v12 offset:25600
    buffer_load_dwordx4 a[72:75], v8, s[28:31], s6 offen offset:1024 sc1
    v_mfma_f32_16x16x32_bf16 v[36:39], a[196:199], a[32:35], v[36:39]
    v_mfma_f32_16x16x32_bf16 v[64:67], a[196:199], a[36:39], v[64:67]
    ds_read_b128 a[192:195], v12 offset:26624
    v_mfma_f32_16x16x32_bf16 v[40:43], a[200:203], a[32:35], v[40:43]
    v_mfma_f32_16x16x32_bf16 v[68:71], a[200:203], a[36:39], v[68:71]
    ds_read_b128 a[196:199], v12 offset:27648
    buffer_load_dwordx4 a[76:79], v8, s[28:31], s7 offen offset:1024 sc1
    v_mfma_f32_16x16x32_bf16 v[44:47], a[204:207], a[32:35], v[44:47]
    v_mfma_f32_16x16x32_bf16 v[72:75], a[204:207], a[36:39], v[72:75]
    ds_read_b128 a[200:203], v13 offset:63488
    v_mfma_f32_16x16x32_bf16 v[56:59], a[160:163], a[32:35], v[56:59]
    v_mfma_f32_16x16x32_bf16 v[84:87], a[160:163], a[36:39], v[84:87]
    ds_read_b128 a[204:207], v12 offset:28672
    s_waitcnt vmcnt(8) lgkmcnt(6)
    v_mfma_f32_16x16x32_bf16 v[32:35], a[164:167], a[40:43], v[32:35]
    v_mfma_f32_16x16x32_bf16 v[60:63], a[164:167], a[44:47], v[60:63]
    ds_read_b128 a[160:163], v12 offset:29696
    buffer_load_dwordx4 a[80:83], v8, s[28:31], s6 offen offset:2048 sc1
    v_mfma_f32_16x16x32_bf16 v[36:39], a[168:171], a[40:43], v[36:39]
    v_mfma_f32_16x16x32_bf16 v[64:67], a[168:171], a[44:47], v[64:67]
    ds_read_b128 a[164:167], v12 offset:30720
    v_mfma_f32_16x16x32_bf16 v[40:43], a[172:175], a[40:43], v[40:43]
    v_mfma_f32_16x16x32_bf16 v[68:71], a[172:175], a[44:47], v[68:71]
    ds_read_b128 a[168:171], v12 offset:31744
    buffer_load_dwordx4 a[84:87], v8, s[28:31], s7 offen offset:2048 sc1
    v_mfma_f32_16x16x32_bf16 v[44:47], a[176:179], a[40:43], v[44:47]
    v_mfma_f32_16x16x32_bf16 v[72:75], a[176:179], a[44:47], v[72:75]
    ds_read_b128 a[172:175], v13 offset:64512
    v_mfma_f32_16x16x32_bf16 v[56:59], a[180:183], a[40:43], v[56:59]
    v_mfma_f32_16x16x32_bf16 v[84:87], a[180:183], a[44:47], v[84:87]
    ds_read_b128 a[176:179], v12 offset:32768
    s_waitcnt vmcnt(8) lgkmcnt(6)
    v_mfma_f32_16x16x32_bf16 v[32:35], a[184:187], a[48:51], v[32:35]
    v_mfma_f32_16x16x32_bf16 v[60:63], a[184:187], a[52:55], v[60:63]
    ds_read_b128 a[180:183], v12 offset:33792
    buffer_load_dwordx4 a[88:91], v8, s[28:31], s6 offen offset:3072 sc1
    v_mfma_f32_16x16x32_bf16 v[36:39], a[188:191], a[48:51], v[36:39]
    v_mfma_f32_16x16x32_bf16 v[64:67], a[188:191], a[52:55], v[64:67]
    ds_read_b128 a[184:187], v12 offset:34816
    v_mfma_f32_16x16x32_bf16 v[40:43], a[192:195], a[48:51], v[40:43]
    v_mfma_f32_16x16x32_bf16 v[68:71], a[192:195], a[52:55], v[68:71]
    ds_read_b128 a[188:191], v12 offset:35840
    buffer_load_dwordx4 a[92:95], v8, s[28:31], s7 offen offset:3072 sc1
    v_mfma_f32_16x16x32_bf16 v[44:47], a[196:199], a[48:51], v[44:47]
    v_mfma_f32_16x16x32_bf16 v[72:75], a[196:199], a[52:55], v[72:75]
    ds_read_b128 a[192:195], v14 offset:0
    v_mfma_f32_16x16x32_bf16 v[56:59], a[200:203], a[48:51], v[56:59]
    v_mfma_f32_16x16x32_bf16 v[84:87], a[200:203], a[52:55], v[84:87]
    ds_read_b128 a[196:199], v12 offset:36864
    s_waitcnt vmcnt(8) lgkmcnt(6)
    v_mfma_f32_16x16x32_bf16 v[32:35], a[204:207], a[56:59], v[32:35]
    v_mfma_f32_16x16x32_bf16 v[60:63], a[204:207], a[60:63], v[60:63]
    ds_read_b128 a[200:203], v12 offset:37888
    s_add_u32 s6, s6, 4096
    s_add_u32 s7, s7, 4096
    buffer_load_dwordx4 a[96:99], v8, s[28:31], s6 offen offset:0 sc1
    v_mfma_f32_16x16x32_bf16 v[36:39], a[160:163], a[56:59], v[36:39]
    v_mfma_f32_16x16x32_bf16 v[64:67], a[160:163], a[60:63], v[64:67]
    ds_read_b128 a[204:207], v12 offset:38912
    v_mfma_f32_16x16x32_bf16 v[40:43], a[164:167], a[56:59], v[40:43]
    v_mfma_f32_16x16x32_bf16 v[68:71], a[164:167], a[60:63], v[68:71]
    ds_read_b128 a[160:163], v12 offset:39936
    buffer_load_dwordx4 a[100:103], v8, s[28:31], s7 offen offset:0 sc1
    v_mfma_f32_16x16x32_bf16 v[44:47], a[168:171], a[56:59], v[44:47]
    v_mfma_f32_16x16x32_bf16 v[72:75], a[168:171], a[60:63], v[72:75]
    ds_read_b128 a[164:167], v14 offset:1024
    v_mfma_f32_16x16x32_bf16 v[56:59], a[172:175], a[56:59], v[56:59]
    v_mfma_f32_16x16x32_bf16 v[84:87], a[172:175], a[60:63], v[84:87]
    ds_read_b128 a[168:171], v12 offset:40960
    s_waitcnt vmcnt(8) lgkmcnt(6)
    v_mfma_f32_16x16x32_bf16 v[32:35], a[176:179], a[64:67], v[32:35]
    v_mfma_f32_16x16x32_bf16 v[60:63], a[176:179], a[68:71], v[60:63]
    ds_read_b128 a[172:175], v12 offset:41984
    buffer_load_dwordx4 a[104:107], v8, s[28:31], s6 offen offset:1024 sc1
    v_mfma_f32_16x16x32_bf16 v[36:39], a[180:183], a[64:67], v[36:39]
    v_mfma_f32_16x16x32_bf16 v[64:67], a[180:183], a[68:71], v[64:67]
    ds_read_b128 a[176:179], v12 offset:43008
    v_mfma_f32_16x16x32_bf16 v[40:43], a[184:187], a[64:67], v[40:43]
    v_mfma_f32_16x16x32_bf16 v[68:71], a[184:187], a[68:71], v[68:71]
    ds_read_b128 a[180:183], v12 offset:44032
    buffer_load_dwordx4 a[108:111], v8, s[28:31], s7 offen offset:1024 sc1
    v_mfma_f32_16x16x32_bf16 v[44:47], a[188:191], a[64:67], v[44:47]
    v_mfma_f32_16x16x32_bf16 v[72:75], a[188:191], a[68:71], v[72:75]
    ds_read_b128 a[184:187], v14 offset:2048
    v_mfma_f32_16x16x32_bf16 v[56:59], a[192:195], a[64:67], v[56:59]
    v_mfma_f32_16x16x32_bf16 v[84:87], a[192:195], a[68:71], v[84:87]
    ds_read_b128 a[188:191], v12 offset:45056
    buffer_load_dwordx4 a[112:115], v8, s[28:31], s6 offen offset:2048 sc1
    s_waitcnt vmcnt(9) lgkmcnt(6)
    v_mfma_f32_16x16x32_bf16 v[32:35], a[196:199], a[72:75], v[32:35]
    v_mfma_f32_16x16x32_bf16 v[60:63], a[196:199], a[76:79], v[60:63]
    ds_read_b128 a[192:195], v12 offset:46080
    buffer_load_dwordx4 a[116:119], v8, s[28:31], s7 offen offset:2048 sc1
    v_mfma_f32_16x16x32_bf16 v[36:39], a[200:203], a[72:75], v[36:39]
    v_mfma_f32_16x16x32_bf16 v[64:67], a[200:203], a[76:79], v[64:67]
    ds_read_b128 a[196:199], v12 offset:47104
    v_mfma_f32_16x16x32_bf16 v[40:43], a[204:207], a[72:75], v[40:43]
    v_mfma_f32_16x16x32_bf16 v[68:71], a[204:207], a[76:79], v[68:71]
    ds_read_b128 a[200:203], v12 offset:48128
    buffer_load_dwordx4 a[120:123], v8, s[28:31], s6 offen offset:3072 sc1
    v_mfma_f32_16x16x32_bf16 v[44:47], a[160:163], a[72:75], v[44:47]
    v_mfma_f32_16x16x32_bf16 v[72:75], a[160:163], a[76:79], v[72:75]
    ds_read_b128 a[204:207], v14 offset:3072
    v_mfma_f32_16x16x32_bf16 v[56:59], a[164:167], a[72:75], v[56:59]
    v_mfma_f32_16x16x32_bf16 v[84:87], a[164:167], a[76:79], v[84:87]
    ds_read_b128 a[160:163], v12 offset:49152
    buffer_load_dwordx4 a[124:127], v8, s[28:31], s7 offen offset:3072 sc1
    s_waitcnt vmcnt(10) lgkmcnt(6)
    v_mfma_f32_16x16x32_bf16 v[32:35], a[168:171], a[80:83], v[32:35]
    v_mfma_f32_16x16x32_bf16 v[60:63], a[168:171], a[84:87], v[60:63]
    ds_read_b128 a[164:167], v12 offset:50176
    s_add_u32 s6, s6, 4096
    s_add_u32 s7, s7, 4096
    buffer_load_dwordx4 a[128:131], v8, s[28:31], s6 offen offset:0 sc1
    v_mfma_f32_16x16x32_bf16 v[36:39], a[172:175], a[80:83], v[36:39]
    v_mfma_f32_16x16x32_bf16 v[64:67], a[172:175], a[84:87], v[64:67]
    ds_read_b128 a[168:171], v12 offset:51200
    v_mfma_f32_16x16x32_bf16 v[40:43], a[176:179], a[80:83], v[40:43]
    v_mfma_f32_16x16x32_bf16 v[68:71], a[176:179], a[84:87], v[68:71]
    ds_read_b128 a[172:175], v12 offset:52224
    buffer_load_dwordx4 a[132:135], v8, s[28:31], s7 offen offset:0 sc1
    v_mfma_f32_16x16x32_bf16 v[44:47], a[180:183], a[80:83], v[44:47]
    v_mfma_f32_16x16x32_bf16 v[72:75], a[180:183], a[84:87], v[72:75]
    ds_read_b128 a[176:179], v14 offset:4096
    v_mfma_f32_16x16x32_bf16 v[56:59], a[184:187], a[80:83], v[56:59]
    v_mfma_f32_16x16x32_bf16 v[84:87], a[184:187], a[84:87], v[84:87]
    ds_read_b128 a[180:183], v12 offset:53248
    buffer_load_dwordx4 a[136:139], v8, s[28:31], s6 offen offset:1024 sc1
    s_waitcnt vmcnt(11) lgkmcnt(6)
    v_mfma_f32_16x16x32_bf16 v[32:35], a[188:191], a[88:91], v[32:35]
    v_mfma_f32_16x16x32_bf16 v[60:63], a[188:191], a[92:95], v[60:63]
    ds_read_b128 a[184:187], v12 offset:54272
    buffer_load_dwordx4 a[140:143], v8, s[28:31], s7 offen offset:1024 sc1
    v_mfma_f32_16x16x32_bf16 v[36:39], a[192:195], a[88:91], v[36:39]
    v_mfma_f32_16x16x32_bf16 v[64:67], a[192:195], a[92:95], v[64:67]
    ds_read_b128 a[188:191], v12 offset:55296
    v_mfma_f32_16x16x32_bf16 v[40:43], a[196:199], a[88:91], v[40:43]
    v_mfma_f32_16x16x32_bf16 v[68:71], a[196:199], a[92:95], v[68:71]
    ds_read_b128 a[192:195], v12 offset:56320
    buffer_load_dwordx4 a[144:147], v8, s[28:31], s6 offen offset:2048 sc1
    v_mfma_f32_16x16x32_bf16 v[44:47], a[200:203], a[88:91], v[44:47]
    v_mfma_f32_16x16x32_bf16 v[72:75], a[200:203], a[92:95], v[72:75]
    ds_read_b128 a[196:199], v14 offset:5120
    v_mfma_f32_16x16x32_bf16 v[56:59], a[204:207], a[88:91], v[56:59]
    v_mfma_f32_16x16x32_bf16 v[84:87], a[204:207], a[92:95], v[84:87]
    ds_read_b128 a[200:203], v12 offset:57344
    buffer_load_dwordx4 a[148:151], v8, s[28:31], s7 offen offset:2048 sc1
    s_waitcnt vmcnt(12) lgkmcnt(6)
    v_mfma_f32_16x16x32_bf16 v[32:35], a[160:163], a[96:99], v[32:35]
    v_mfma_f32_16x16x32_bf16 v[60:63], a[160:163], a[100:103], v[60:63]
    ds_read_b128 a[204:207], v12 offset:58368
    buffer_load_dwordx4 a[152:155], v8, s[28:31], s6 offen offset:3072 sc1
    v_mfma_f32_16x16x32_bf16 v[36:39], a[164:167], a[96:99], v[36:39]
    v_mfma_f32_16x16x32_bf16 v[64:67], a[164:167], a[100:103], v[64:67]
    ds_read_b128 a[160:163], v12 offset:59392
    v_mfma_f32_16x16x32_bf16 v[40:43], a[168:171], a[96:99], v[40:43]
    v_mfma_f32_16x16x32_bf16 v[68:71], a[168:171], a[100:103], v[68:71]
    ds_read_b128 a[164:167], v12 offset:60416
    buffer_load_dwordx4 a[156:159], v8, s[28:31], s7 offen offset:3072 sc1
    v_mfma_f32_16x16x32_bf16 v[44:47], a[172:175], a[96:99], v[44:47]
    v_mfma_f32_16x16x32_bf16 v[72:75], a[172:175], a[100:103], v[72:75]
    ds_read_b128 a[168:171], v14 offset:6144
    v_mfma_f32_16x16x32_bf16 v[56:59], a[176:179], a[96:99], v[56:59]
    v_mfma_f32_16x16x32_bf16 v[84:87], a[176:179], a[100:103], v[84:87]
    ds_read_b128 a[172:175], v12 offset:61440
    buffer_load_dwordx2 v[16:17], v228, s[28:31], s9 offen offset:0 sc1
    s_waitcnt vmcnt(13) lgkmcnt(6)
    v_mfma_f32_16x16x32_bf16 v[32:35], a[180:183], a[104:107], v[32:35]
    v_mfma_f32_16x16x32_bf16 v[60:63], a[180:183], a[108:111], v[60:63]
    ds_read_b128 a[176:179], v12 offset:62464
    buffer_load_dwordx2 v[18:19], v228, s[28:31], s9 offen offset:128 sc1
    v_mfma_f32_16x16x32_bf16 v[36:39], a[184:187], a[104:107], v[36:39]
    v_mfma_f32_16x16x32_bf16 v[64:67], a[184:187], a[108:111], v[64:67]
    ds_read_b128 a[180:183], v12 offset:63488
    v_mfma_f32_16x16x32_bf16 v[40:43], a[188:191], a[104:107], v[40:43]
    v_mfma_f32_16x16x32_bf16 v[68:71], a[188:191], a[108:111], v[68:71]
    ds_read_b128 a[184:187], v12 offset:64512
    buffer_load_dwordx2 v[20:21], v228, s[28:31], s9 offen offset:1024 sc1
    v_mfma_f32_16x16x32_bf16 v[44:47], a[192:195], a[104:107], v[44:47]
    v_mfma_f32_16x16x32_bf16 v[72:75], a[192:195], a[108:111], v[72:75]
    ds_read_b128 a[188:191], v14 offset:7168
    v_mfma_f32_16x16x32_bf16 v[56:59], a[196:199], a[104:107], v[56:59]
    v_mfma_f32_16x16x32_bf16 v[84:87], a[196:199], a[108:111], v[84:87]
    ds_read_b128 a[192:195], v13 offset:0
    buffer_load_dwordx2 v[22:23], v228, s[28:31], s9 offen offset:1152 sc1
    s_waitcnt vmcnt(14) lgkmcnt(6)
    v_mfma_f32_16x16x32_bf16 v[32:35], a[200:203], a[112:115], v[32:35]
    v_mfma_f32_16x16x32_bf16 v[60:63], a[200:203], a[116:119], v[60:63]
    ds_read_b128 a[196:199], v13 offset:1024
    s_mov_b32 s26, 5492736
    buffer_load_dwordx2 v[116:117], v235, s[28:31], s26 offen
    v_mfma_f32_16x16x32_bf16 v[36:39], a[204:207], a[112:115], v[36:39]
    v_mfma_f32_16x16x32_bf16 v[64:67], a[204:207], a[116:119], v[64:67]
    ds_read_b128 a[200:203], v13 offset:2048
    v_mfma_f32_16x16x32_bf16 v[40:43], a[160:163], a[112:115], v[40:43]
    v_mfma_f32_16x16x32_bf16 v[68:71], a[160:163], a[116:119], v[68:71]
    ds_read_b128 a[204:207], v13 offset:3072
    s_mov_b32 s26, 5492736
    buffer_load_dwordx2 v[118:119], v236, s[28:31], s26 offen
    v_mfma_f32_16x16x32_bf16 v[44:47], a[164:167], a[112:115], v[44:47]
    v_mfma_f32_16x16x32_bf16 v[72:75], a[164:167], a[116:119], v[72:75]
    ds_read_b128 a[160:163], v14 offset:8192
    v_mfma_f32_16x16x32_bf16 v[56:59], a[168:171], a[112:115], v[56:59]
    v_mfma_f32_16x16x32_bf16 v[84:87], a[168:171], a[116:119], v[84:87]
    ds_read_b128 a[164:167], v13 offset:4096
    s_mov_b32 s26, 5492736
    buffer_load_dwordx2 v[120:121], v237, s[28:31], s26 offen
    s_waitcnt vmcnt(15) lgkmcnt(6)
    v_mfma_f32_16x16x32_bf16 v[32:35], a[172:175], a[120:123], v[32:35]
    v_mfma_f32_16x16x32_bf16 v[60:63], a[172:175], a[124:127], v[60:63]
    ds_read_b128 a[168:171], v13 offset:5120
    s_mov_b32 s26, 5492736
    buffer_load_dwordx2 v[122:123], v238, s[28:31], s26 offen
    v_mfma_f32_16x16x32_bf16 v[36:39], a[176:179], a[120:123], v[36:39]
    v_mfma_f32_16x16x32_bf16 v[64:67], a[176:179], a[124:127], v[64:67]
    ds_read_b128 a[172:175], v13 offset:6144
    v_mfma_f32_16x16x32_bf16 v[40:43], a[180:183], a[120:123], v[40:43]
    v_mfma_f32_16x16x32_bf16 v[68:71], a[180:183], a[124:127], v[68:71]
    ds_read_b128 a[176:179], v13 offset:7168
    s_mov_b32 s26, 5492736
    buffer_load_dwordx2 v[124:125], v239, s[28:31], s26 offen
    v_mfma_f32_16x16x32_bf16 v[44:47], a[184:187], a[120:123], v[44:47]
    v_mfma_f32_16x16x32_bf16 v[72:75], a[184:187], a[124:127], v[72:75]
    ds_read_b128 a[180:183], v14 offset:9216
    v_mfma_f32_16x16x32_bf16 v[56:59], a[188:191], a[120:123], v[56:59]
    v_mfma_f32_16x16x32_bf16 v[84:87], a[188:191], a[124:127], v[84:87]
    ds_read_b128 a[184:187], v13 offset:8192
    buffer_load_dwordx4 v[204:207], v233, s[28:31], s37 offen offset:0
    s_waitcnt vmcnt(16) lgkmcnt(6)
    v_mfma_f32_16x16x32_bf16 v[32:35], a[192:195], a[128:131], v[32:35]
    v_mfma_f32_16x16x32_bf16 v[60:63], a[192:195], a[132:135], v[60:63]
    ds_read_b128 a[188:191], v13 offset:9216
    buffer_load_dwordx4 v[208:211], v233, s[28:31], s37 offen offset:64
    v_mfma_f32_16x16x32_bf16 v[36:39], a[196:199], a[128:131], v[36:39]
    v_mfma_f32_16x16x32_bf16 v[64:67], a[196:199], a[132:135], v[64:67]
    ds_read_b128 a[192:195], v13 offset:10240
    v_mfma_f32_16x16x32_bf16 v[40:43], a[200:203], a[128:131], v[40:43]
    v_mfma_f32_16x16x32_bf16 v[68:71], a[200:203], a[132:135], v[68:71]
    ds_read_b128 a[196:199], v13 offset:11264
    buffer_load_dwordx4 v[212:215], v233, s[28:31], s37 offen offset:128
    v_mfma_f32_16x16x32_bf16 v[44:47], a[204:207], a[128:131], v[44:47]
    v_mfma_f32_16x16x32_bf16 v[72:75], a[204:207], a[132:135], v[72:75]
    ds_read_b128 a[200:203], v14 offset:10240
    v_mfma_f32_16x16x32_bf16 v[56:59], a[160:163], a[128:131], v[56:59]
    v_mfma_f32_16x16x32_bf16 v[84:87], a[160:163], a[132:135], v[84:87]
    ds_read_b128 a[204:207], v13 offset:12288
    buffer_load_dwordx4 v[216:219], v233, s[28:31], s37 offen offset:192
    s_waitcnt vmcnt(17) lgkmcnt(6)
    v_mfma_f32_16x16x32_bf16 v[32:35], a[164:167], a[136:139], v[32:35]
    v_mfma_f32_16x16x32_bf16 v[60:63], a[164:167], a[140:143], v[60:63]
    ds_read_b128 a[160:163], v13 offset:13312
    buffer_load_dwordx4 v[220:223], v233, s[28:31], s38 offen
    v_mfma_f32_16x16x32_bf16 v[36:39], a[168:171], a[136:139], v[36:39]
    v_mfma_f32_16x16x32_bf16 v[64:67], a[168:171], a[140:143], v[64:67]
    ds_read_b128 a[164:167], v13 offset:14336
    s_mul_i32 s25, s20, 3
    s_min_u32 s25, s25, 7
    s_lshl_b32 s25, s25, 10
    s_add_u32 s62, s25, 143360
    s_add_u32 s63, s25, s59
    s_add_u32 s63, s63, 0
    s_mov_b32 m0, s62
    buffer_load_dwordx4 v8, s[28:31], s63 offen offset:0 lds
    v_mfma_f32_16x16x32_bf16 v[40:43], a[172:175], a[136:139], v[40:43]
    v_mfma_f32_16x16x32_bf16 v[68:71], a[172:175], a[140:143], v[68:71]
    ds_read_b128 a[168:171], v13 offset:15360
    v_mfma_f32_16x16x32_bf16 v[44:47], a[176:179], a[136:139], v[44:47]
    v_mfma_f32_16x16x32_bf16 v[72:75], a[176:179], a[140:143], v[72:75]
    ds_read_b128 a[172:175], v14 offset:11264
    buffer_load_dwordx4 v8, s[28:31], s63 offen offset:1024 lds
    v_mfma_f32_16x16x32_bf16 v[56:59], a[180:183], a[136:139], v[56:59]
    v_mfma_f32_16x16x32_bf16 v[84:87], a[180:183], a[140:143], v[84:87]
    ds_read_b128 a[176:179], v13 offset:16384
    s_waitcnt vmcnt(18) lgkmcnt(6)
    v_mfma_f32_16x16x32_bf16 v[32:35], a[184:187], a[144:147], v[32:35]
    v_mfma_f32_16x16x32_bf16 v[60:63], a[184:187], a[148:151], v[60:63]
    ds_read_b128 a[180:183], v13 offset:17408
    v_mfma_f32_16x16x32_bf16 v[36:39], a[188:191], a[144:147], v[36:39]
    v_mfma_f32_16x16x32_bf16 v[64:67], a[188:191], a[148:151], v[64:67]
    ds_read_b128 a[184:187], v13 offset:18432
    buffer_load_dwordx4 v8, s[28:31], s63 offen offset:2048 lds
    v_mfma_f32_16x16x32_bf16 v[40:43], a[192:195], a[144:147], v[40:43]
    v_mfma_f32_16x16x32_bf16 v[68:71], a[192:195], a[148:151], v[68:71]
    ds_read_b128 a[188:191], v13 offset:19456
    v_mfma_f32_16x16x32_bf16 v[44:47], a[196:199], a[144:147], v[44:47]
    v_mfma_f32_16x16x32_bf16 v[72:75], a[196:199], a[148:151], v[72:75]
    ds_read_b128 a[192:195], v13 offset:20480
    v_mfma_f32_16x16x32_bf16 v[56:59], a[200:203], a[144:147], v[56:59]
    v_mfma_f32_16x16x32_bf16 v[84:87], a[200:203], a[148:151], v[84:87]
    ds_read_b128 a[196:199], v13 offset:21504
    s_waitcnt vmcnt(17) lgkmcnt(6)
    v_mfma_f32_16x16x32_bf16 v[32:35], a[204:207], a[152:155], v[32:35]
    v_mfma_f32_16x16x32_bf16 v[60:63], a[204:207], a[156:159], v[60:63]
    ds_read_b128 a[200:203], v13 offset:22528
    v_mfma_f32_16x16x32_bf16 v[36:39], a[160:163], a[152:155], v[36:39]
    v_mfma_f32_16x16x32_bf16 v[64:67], a[160:163], a[156:159], v[64:67]
    ds_read_b128 a[204:207], v13 offset:23552
    v_mfma_f32_16x16x32_bf16 v[40:43], a[164:167], a[152:155], v[40:43]
    v_mfma_f32_16x16x32_bf16 v[68:71], a[164:167], a[156:159], v[68:71]
    ds_read_b128 a[160:163], v13 offset:24576
    v_mfma_f32_16x16x32_bf16 v[44:47], a[168:171], a[152:155], v[44:47]
    v_mfma_f32_16x16x32_bf16 v[72:75], a[168:171], a[156:159], v[72:75]
    ds_read_b128 a[164:167], v13 offset:25600
    v_mfma_f32_16x16x32_bf16 v[56:59], a[172:175], a[152:155], v[56:59]
    v_mfma_f32_16x16x32_bf16 v[84:87], a[172:175], a[156:159], v[84:87]
    ds_read_b128 a[168:171], v13 offset:26624
    s_waitcnt lgkmcnt(7)
    v_mfma_f32_16x16x32_bf16 v[48:51], a[176:179], a[0:3], 0
    v_mfma_f32_16x16x32_bf16 v[76:79], a[176:179], a[4:7], 0
    ds_read_b128 a[172:175], v13 offset:27648
    v_mfma_f32_16x16x32_bf16 v[52:55], a[180:183], a[0:3], 0
    v_mfma_f32_16x16x32_bf16 v[80:83], a[180:183], a[4:7], 0
    ds_read_b128 a[176:179], v13 offset:28672
    v_mfma_f32_16x16x32_bf16 v[48:51], a[184:187], a[8:11], v[48:51]
    v_mfma_f32_16x16x32_bf16 v[76:79], a[184:187], a[12:15], v[76:79]
    ds_read_b128 a[180:183], v13 offset:29696
    v_mfma_f32_16x16x32_bf16 v[52:55], a[188:191], a[8:11], v[52:55]
    v_mfma_f32_16x16x32_bf16 v[80:83], a[188:191], a[12:15], v[80:83]
    ds_read_b128 a[184:187], v13 offset:30720
    s_barrier
    s_waitcnt lgkmcnt(7)
    v_mfma_f32_16x16x32_bf16 v[48:51], a[192:195], a[16:19], v[48:51]
    v_mfma_f32_16x16x32_bf16 v[76:79], a[192:195], a[20:23], v[76:79]
    ds_read_b128 a[188:191], v13 offset:31744
    s_mul_i32 s25, s20, 20
    s_lshl_b32 s25, s25, 10
    s_add_u32 s62, s25, 0
    s_add_u32 s63, s25, s59
    s_add_u32 s63, s63, 10240
    s_mov_b32 m0, s62
    buffer_load_dwordx4 v8, s[28:31], s63 offen offset:0 lds
    v_mfma_f32_16x16x32_bf16 v[52:55], a[196:199], a[16:19], v[52:55]
    v_mfma_f32_16x16x32_bf16 v[80:83], a[196:199], a[20:23], v[80:83]
    ds_read_b128 a[192:195], v13 offset:32768
    buffer_load_dwordx4 v8, s[28:31], s63 offen offset:1024 lds
    v_mfma_f32_16x16x32_bf16 v[48:51], a[200:203], a[24:27], v[48:51]
    v_mfma_f32_16x16x32_bf16 v[76:79], a[200:203], a[28:31], v[76:79]
    ds_read_b128 a[196:199], v13 offset:33792
    buffer_load_dwordx4 v8, s[28:31], s63 offen offset:2048 lds
    v_mfma_f32_16x16x32_bf16 v[52:55], a[204:207], a[24:27], v[52:55]
    v_mfma_f32_16x16x32_bf16 v[80:83], a[204:207], a[28:31], v[80:83]
    ds_read_b128 a[200:203], v13 offset:34816
    buffer_load_dwordx4 v8, s[28:31], s63 offen offset:3072 lds
    s_waitcnt lgkmcnt(7)
    v_mfma_f32_16x16x32_bf16 v[48:51], a[160:163], a[32:35], v[48:51]
    v_mfma_f32_16x16x32_bf16 v[76:79], a[160:163], a[36:39], v[76:79]
    ds_read_b128 a[204:207], v13 offset:35840
    s_add_u32 s62, s62, 4096
    s_add_u32 s63, s63, 4096
    s_mov_b32 m0, s62
    buffer_load_dwordx4 v8, s[28:31], s63 offen offset:0 lds
    v_mfma_f32_16x16x32_bf16 v[52:55], a[164:167], a[32:35], v[52:55]
    v_mfma_f32_16x16x32_bf16 v[80:83], a[164:167], a[36:39], v[80:83]
    ds_read_b128 a[160:163], v13 offset:36864
    buffer_load_dwordx4 v8, s[28:31], s63 offen offset:1024 lds
    v_mfma_f32_16x16x32_bf16 v[48:51], a[168:171], a[40:43], v[48:51]
    v_mfma_f32_16x16x32_bf16 v[76:79], a[168:171], a[44:47], v[76:79]
    ds_read_b128 a[164:167], v13 offset:37888
    buffer_load_dwordx4 v8, s[28:31], s63 offen offset:2048 lds
    v_mfma_f32_16x16x32_bf16 v[52:55], a[172:175], a[40:43], v[52:55]
    v_mfma_f32_16x16x32_bf16 v[80:83], a[172:175], a[44:47], v[80:83]
    ds_read_b128 a[168:171], v13 offset:38912
    buffer_load_dwordx4 v8, s[28:31], s63 offen offset:3072 lds
    s_waitcnt lgkmcnt(7)
    v_mfma_f32_16x16x32_bf16 v[48:51], a[176:179], a[48:51], v[48:51]
    v_mfma_f32_16x16x32_bf16 v[76:79], a[176:179], a[52:55], v[76:79]
    ds_read_b128 a[172:175], v13 offset:39936
    s_add_u32 s62, s62, 4096
    s_add_u32 s63, s63, 4096
    s_mov_b32 m0, s62
    buffer_load_dwordx4 v8, s[28:31], s63 offen offset:0 lds
    v_mfma_f32_16x16x32_bf16 v[52:55], a[180:183], a[48:51], v[52:55]
    v_mfma_f32_16x16x32_bf16 v[80:83], a[180:183], a[52:55], v[80:83]
    ds_read_b128 a[176:179], v13 offset:40960
    buffer_load_dwordx4 v8, s[28:31], s63 offen offset:1024 lds
    v_mfma_f32_16x16x32_bf16 v[48:51], a[184:187], a[56:59], v[48:51]
    v_mfma_f32_16x16x32_bf16 v[76:79], a[184:187], a[60:63], v[76:79]
    ds_read_b128 a[180:183], v13 offset:41984
    buffer_load_dwordx4 v8, s[28:31], s63 offen offset:2048 lds
    v_mfma_f32_16x16x32_bf16 v[52:55], a[188:191], a[56:59], v[52:55]
    v_mfma_f32_16x16x32_bf16 v[80:83], a[188:191], a[60:63], v[80:83]
    ds_read_b128 a[184:187], v13 offset:43008
    buffer_load_dwordx4 v8, s[28:31], s63 offen offset:3072 lds
    s_waitcnt lgkmcnt(7)
    v_mfma_f32_16x16x32_bf16 v[48:51], a[192:195], a[64:67], v[48:51]
    v_mfma_f32_16x16x32_bf16 v[76:79], a[192:195], a[68:71], v[76:79]
    ds_read_b128 a[188:191], v13 offset:44032
    s_add_u32 s62, s62, 4096
    s_add_u32 s63, s63, 4096
    s_mov_b32 m0, s62
    buffer_load_dwordx4 v8, s[28:31], s63 offen offset:0 lds
    v_mfma_f32_16x16x32_bf16 v[52:55], a[196:199], a[64:67], v[52:55]
    v_mfma_f32_16x16x32_bf16 v[80:83], a[196:199], a[68:71], v[80:83]
    ds_read_b128 a[192:195], v13 offset:45056
    buffer_load_dwordx4 v8, s[28:31], s63 offen offset:1024 lds
    v_mfma_f32_16x16x32_bf16 v[48:51], a[200:203], a[72:75], v[48:51]
    v_mfma_f32_16x16x32_bf16 v[76:79], a[200:203], a[76:79], v[76:79]
    ds_read_b128 a[196:199], v13 offset:46080
    buffer_load_dwordx4 v8, s[28:31], s63 offen offset:2048 lds
    v_mfma_f32_16x16x32_bf16 v[52:55], a[204:207], a[72:75], v[52:55]
    v_mfma_f32_16x16x32_bf16 v[80:83], a[204:207], a[76:79], v[80:83]
    ds_read_b128 a[200:203], v13 offset:47104
    buffer_load_dwordx4 v8, s[28:31], s63 offen offset:3072 lds
    s_waitcnt lgkmcnt(7)
    v_mfma_f32_16x16x32_bf16 v[48:51], a[160:163], a[80:83], v[48:51]
    v_mfma_f32_16x16x32_bf16 v[76:79], a[160:163], a[84:87], v[76:79]
    ds_read_b128 a[204:207], v13 offset:48128
    s_add_u32 s62, s62, 4096
    s_add_u32 s63, s63, 4096
    s_mov_b32 m0, s62
    buffer_load_dwordx4 v8, s[28:31], s63 offen offset:0 lds
    v_mfma_f32_16x16x32_bf16 v[52:55], a[164:167], a[80:83], v[52:55]
    v_mfma_f32_16x16x32_bf16 v[80:83], a[164:167], a[84:87], v[80:83]
    ds_read_b128 a[160:163], v13 offset:49152
    buffer_load_dwordx4 v8, s[28:31], s63 offen offset:1024 lds
    v_mfma_f32_16x16x32_bf16 v[48:51], a[168:171], a[88:91], v[48:51]
    v_mfma_f32_16x16x32_bf16 v[76:79], a[168:171], a[92:95], v[76:79]
    ds_read_b128 a[164:167], v13 offset:50176
    buffer_load_dwordx4 v8, s[28:31], s63 offen offset:2048 lds
    v_mfma_f32_16x16x32_bf16 v[52:55], a[172:175], a[88:91], v[52:55]
    v_mfma_f32_16x16x32_bf16 v[80:83], a[172:175], a[92:95], v[80:83]
    ds_read_b128 a[168:171], v13 offset:51200
    buffer_load_dwordx4 v8, s[28:31], s63 offen offset:3072 lds
    s_waitcnt lgkmcnt(7)
    v_mfma_f32_16x16x32_bf16 v[48:51], a[176:179], a[96:99], v[48:51]
    v_mfma_f32_16x16x32_bf16 v[76:79], a[176:179], a[100:103], v[76:79]
    ds_read_b128 a[172:175], v13 offset:52224
    s_mul_i32 s25, s20, 3
    s_min_u32 s25, s25, 7
    s_lshl_b32 s25, s25, 10
    s_add_u32 s62, s25, 153600
    s_add_u32 s63, s25, s59
    s_add_u32 s63, s63, 92160
    s_mov_b32 m0, s62
    buffer_load_dwordx4 v8, s[28:31], s63 offen offset:0 lds
    v_mfma_f32_16x16x32_bf16 v[52:55], a[180:183], a[96:99], v[52:55]
    v_mfma_f32_16x16x32_bf16 v[80:83], a[180:183], a[100:103], v[80:83]
    ds_read_b128 a[176:179], v13 offset:53248
    buffer_load_dwordx4 v8, s[28:31], s63 offen offset:1024 lds
    v_mfma_f32_16x16x32_bf16 v[48:51], a[184:187], a[104:107], v[48:51]
    v_mfma_f32_16x16x32_bf16 v[76:79], a[184:187], a[108:111], v[76:79]
    ds_read_b128 a[180:183], v13 offset:54272
    buffer_load_dwordx4 v8, s[28:31], s63 offen offset:2048 lds
    v_mfma_f32_16x16x32_bf16 v[52:55], a[188:191], a[104:107], v[52:55]
    v_mfma_f32_16x16x32_bf16 v[80:83], a[188:191], a[108:111], v[80:83]
    ds_read_b128 a[184:187], v13 offset:55296
    s_mul_i32 s25, s20, 5
    s_lshl_b32 s25, s25, 10
    s_add_u32 s62, s25, 122880
    s_add_u32 s63, s25, s59
    s_add_u32 s63, s63, 102400
    s_mov_b32 m0, s62
    buffer_load_dwordx4 v8, s[28:31], s63 offen offset:0 lds
    s_waitcnt lgkmcnt(7)
    v_mfma_f32_16x16x32_bf16 v[48:51], a[192:195], a[112:115], v[48:51]
    v_mfma_f32_16x16x32_bf16 v[76:79], a[192:195], a[116:119], v[76:79]
    ds_read_b128 a[188:191], v13 offset:56320
    buffer_load_dwordx4 v8, s[28:31], s63 offen offset:1024 lds
    v_mfma_f32_16x16x32_bf16 v[52:55], a[196:199], a[112:115], v[52:55]
    v_mfma_f32_16x16x32_bf16 v[80:83], a[196:199], a[116:119], v[80:83]
    buffer_load_dwordx4 v8, s[28:31], s63 offen offset:2048 lds
    v_mfma_f32_16x16x32_bf16 v[48:51], a[200:203], a[120:123], v[48:51]
    v_mfma_f32_16x16x32_bf16 v[76:79], a[200:203], a[124:127], v[76:79]
    buffer_load_dwordx4 v8, s[28:31], s63 offen offset:3072 lds
    v_mfma_f32_16x16x32_bf16 v[52:55], a[204:207], a[120:123], v[52:55]
    v_mfma_f32_16x16x32_bf16 v[80:83], a[204:207], a[124:127], v[80:83]
    s_add_u32 s62, s62, 4096
    s_add_u32 s63, s63, 4096
    s_mov_b32 m0, s62
    buffer_load_dwordx4 v8, s[28:31], s63 offen offset:0 lds
    s_waitcnt lgkmcnt(4)
    v_mfma_f32_16x16x32_bf16 v[48:51], a[160:163], a[128:131], v[48:51]
    v_mfma_f32_16x16x32_bf16 v[76:79], a[160:163], a[132:135], v[76:79]
    v_mfma_f32_16x16x32_bf16 v[52:55], a[164:167], a[128:131], v[52:55]
    v_mfma_f32_16x16x32_bf16 v[80:83], a[164:167], a[132:135], v[80:83]
    v_mfma_f32_16x16x32_bf16 v[48:51], a[168:171], a[136:139], v[48:51]
    v_mfma_f32_16x16x32_bf16 v[76:79], a[168:171], a[140:143], v[76:79]
    v_mfma_f32_16x16x32_bf16 v[52:55], a[172:175], a[136:139], v[52:55]
    v_mfma_f32_16x16x32_bf16 v[80:83], a[172:175], a[140:143], v[80:83]
    s_waitcnt lgkmcnt(0)
    v_mfma_f32_16x16x32_bf16 v[48:51], a[176:179], a[144:147], v[48:51]
    v_mfma_f32_16x16x32_bf16 v[76:79], a[176:179], a[148:151], v[76:79]
    v_mfma_f32_16x16x32_bf16 v[52:55], a[180:183], a[144:147], v[52:55]
    v_mfma_f32_16x16x32_bf16 v[80:83], a[180:183], a[148:151], v[80:83]
    v_mfma_f32_16x16x32_bf16 v[48:51], a[184:187], a[152:155], v[48:51]
    v_mfma_f32_16x16x32_bf16 v[76:79], a[184:187], a[156:159], v[76:79]
    v_mfma_f32_16x16x32_bf16 v[52:55], a[188:191], a[152:155], v[52:55]
    v_mfma_f32_16x16x32_bf16 v[80:83], a[188:191], a[156:159], v[80:83]
    s_barrier
    s_mul_i32 s26, s22, 5120
    s_add_u32 s55, s59, s26
    s_add_u32 s55, s55, 194560
    s_waitcnt vmcnt(41)
    v_add_f32 v16, v16, v18
    v_add_f32 v17, v17, v19
    v_add_f32 v20, v20, v22
    v_add_f32 v21, v21, v23
    s_nop 0
    v_mov_b32 v24, v16
    v_mov_b32 v25, v17
    v_mov_b32 v26, v20
    v_mov_b32 v27, v21
    s_nop 1
    v_permlane32_swap_b32 v24, v16
    v_permlane32_swap_b32 v25, v17
    v_permlane32_swap_b32 v26, v20
    v_permlane32_swap_b32 v27, v21
    s_mul_i32 s25, s20, 10
    s_lshl_b32 s25, s25, 10
    s_add_u32 s62, s25, 81920
    s_add_u32 s63, s25, s59
    s_add_u32 s63, s63, 122880
    s_mov_b32 m0, s62
    buffer_load_dwordx4 v8, s[28:31], s63 offen offset:0 lds
    s_nop 1
    v_add_f32 v16, v16, v24
    v_add_f32 v17, v17, v25
    v_add_f32 v20, v20, v26
    v_add_f32 v21, v21, v27
    v_mov_b32 v24, v16
    v_mov_b32 v25, v17
    v_mov_b32 v26, v20
    v_mov_b32 v27, v21
    s_nop 1
    v_permlane16_swap_b32 v24, v16
    v_permlane16_swap_b32 v25, v17
    v_permlane16_swap_b32 v26, v20
    v_permlane16_swap_b32 v27, v21
    s_nop 1
    v_add_f32 v16, v16, v24
    buffer_load_dwordx4 v8, s[28:31], s63 offen offset:1024 lds
    v_add_f32 v17, v17, v25
    v_add_f32 v20, v20, v26
    v_add_f32 v21, v21, v27
    v_mul_f32 v16, 0x3acccccd, v16
    v_mul_f32 v20, 0x3acccccd, v20
    v_mul_f32 v17, 0x3acccccd, v17
    v_mul_f32 v21, 0x3acccccd, v21
    v_fma_f32 v17, -v16, v16, v17
    v_fma_f32 v21, -v20, v20, v21
    v_max_f32 v17, 0, v17
    v_max_f32 v21, 0, v21
    v_cvt_pk_bf16_f32 v18, v16, v17
    v_cvt_pk_bf16_f32 v22, v20, v21
    v_lshlrev_b32 v16, 16, v18
    v_lshlrev_b32 v20, 16, v22
    v_and_b32 v17, 0xffff0000, v18
    v_and_b32 v21, 0xffff0000, v22
    v_add_f32 v17, 0x3727c5ac, v17
    v_add_f32 v21, 0x3727c5ac, v21
    buffer_load_dwordx4 v8, s[28:31], s63 offen offset:2048 lds
    v_cvt_pk_bf16_f32 v18, v17, v17
    v_cvt_pk_bf16_f32 v22, v21, v21
    v_lshlrev_b32 v17, 16, v18
    v_lshlrev_b32 v21, 16, v22
    v_sqrt_f32 v17, v17
    v_sqrt_f32 v21, v21
    s_nop 0
    s_nop 0
    v_cvt_pk_bf16_f32 v18, v17, v17
    v_cvt_pk_bf16_f32 v22, v21, v21
    v_lshlrev_b32 v17, 16, v18
    v_lshlrev_b32 v21, 16, v22
    v_rcp_f32 v17, v17
    v_rcp_f32 v21, v21
    s_nop 0
    s_nop 0
    v_mul_f32 v16, v16, v17
    buffer_load_dwordx4 v8, s[28:31], s63 offen offset:3072 lds
    v_mul_f32 v20, v20, v21
    v_sub_f32 v16, 0, v16
    v_sub_f32 v20, 0, v20
    v_mov_b32 v30, 0xbdd2d3e8
    v_mov_b32 v31, 0xc0135761
    v_pk_mul_f32 v[176:177], v[88:89], v[16:17] op_sel_hi:[1,0]
    v_pk_mul_f32 v[178:179], v[90:91], v[16:17] op_sel_hi:[1,0]
    v_pk_mul_f32 v[180:181], v[92:93], v[16:17] op_sel_hi:[1,0]
    v_pk_mul_f32 v[182:183], v[94:95], v[16:17] op_sel_hi:[1,0]
    v_pk_mul_f32 v[184:185], v[96:97], v[16:17] op_sel_hi:[1,0]
    v_pk_mul_f32 v[186:187], v[98:99], v[16:17] op_sel_hi:[1,0]
    v_pk_mul_f32 v[188:189], v[100:101], v[16:17] op_sel_hi:[1,0]
    v_pk_mul_f32 v[190:191], v[102:103], v[16:17] op_sel_hi:[1,0]
    v_pk_mul_f32 v[192:193], v[104:105], v[16:17] op_sel_hi:[1,0]
    v_pk_mul_f32 v[194:195], v[106:107], v[16:17] op_sel_hi:[1,0]
    v_pk_mul_f32 v[196:197], v[108:109], v[16:17] op_sel_hi:[1,0]
    v_pk_mul_f32 v[198:199], v[110:111], v[16:17] op_sel_hi:[1,0]
    v_pk_mul_f32 v[200:201], v[112:113], v[16:17] op_sel_hi:[1,0]
    v_pk_mul_f32 v[202:203], v[114:115], v[16:17] op_sel_hi:[1,0]
    s_add_u32 s62, s62, 4096
    s_add_u32 s63, s63, 4096
    s_mov_b32 m0, s62
    buffer_load_dwordx4 v8, s[28:31], s63 offen offset:0 lds
    v_pk_fma_f32 v[32:33], v[32:33], v[16:17], v[176:177] op_sel:[0,1,0] op_sel_hi:[1,1,1]
    v_pk_fma_f32 v[34:35], v[34:35], v[16:17], v[178:179] op_sel:[0,1,0] op_sel_hi:[1,1,1]
    v_pk_fma_f32 v[36:37], v[36:37], v[16:17], v[180:181] op_sel:[0,1,0] op_sel_hi:[1,1,1]
    v_pk_fma_f32 v[38:39], v[38:39], v[16:17], v[182:183] op_sel:[0,1,0] op_sel_hi:[1,1,1]
    v_pk_fma_f32 v[40:41], v[40:41], v[16:17], v[184:185] op_sel:[0,1,0] op_sel_hi:[1,1,1]
    v_pk_fma_f32 v[42:43], v[42:43], v[16:17], v[186:187] op_sel:[0,1,0] op_sel_hi:[1,1,1]
    v_pk_fma_f32 v[44:45], v[44:45], v[16:17], v[188:189] op_sel:[0,1,0] op_sel_hi:[1,1,1]
    v_pk_fma_f32 v[46:47], v[46:47], v[16:17], v[190:191] op_sel:[0,1,0] op_sel_hi:[1,1,1]
    v_pk_fma_f32 v[48:49], v[48:49], v[16:17], v[192:193] op_sel:[0,1,0] op_sel_hi:[1,1,1]
    v_pk_fma_f32 v[50:51], v[50:51], v[16:17], v[194:195] op_sel:[0,1,0] op_sel_hi:[1,1,1]
    v_pk_fma_f32 v[52:53], v[52:53], v[16:17], v[196:197] op_sel:[0,1,0] op_sel_hi:[1,1,1]
    v_pk_fma_f32 v[54:55], v[54:55], v[16:17], v[198:199] op_sel:[0,1,0] op_sel_hi:[1,1,1]
    v_pk_fma_f32 v[56:57], v[56:57], v[16:17], v[200:201] op_sel:[0,1,0] op_sel_hi:[1,1,1]
    v_pk_fma_f32 v[58:59], v[58:59], v[16:17], v[202:203] op_sel:[0,1,0] op_sel_hi:[1,1,1]
    v_pk_mul_f32 v[176:177], v[32:33], v[32:33]
    v_pk_mul_f32 v[178:179], v[34:35], v[34:35]
    v_pk_mul_f32 v[180:181], v[36:37], v[36:37]
    v_pk_mul_f32 v[182:183], v[38:39], v[38:39]
    v_pk_mul_f32 v[184:185], v[40:41], v[40:41]
    buffer_load_dwordx4 v8, s[28:31], s63 offen offset:1024 lds
    v_pk_mul_f32 v[186:187], v[42:43], v[42:43]
    v_pk_mul_f32 v[188:189], v[44:45], v[44:45]
    v_pk_mul_f32 v[190:191], v[46:47], v[46:47]
    v_pk_mul_f32 v[192:193], v[48:49], v[48:49]
    v_pk_mul_f32 v[194:195], v[50:51], v[50:51]
    v_pk_mul_f32 v[196:197], v[52:53], v[52:53]
    v_pk_mul_f32 v[198:199], v[54:55], v[54:55]
    v_pk_mul_f32 v[200:201], v[56:57], v[56:57]
    v_pk_mul_f32 v[202:203], v[58:59], v[58:59]
    v_pk_fma_f32 v[176:177], v[176:177], v[30:31], v[30:31] op_sel:[0,0,1] op_sel_hi:[1,0,1]
    v_pk_fma_f32 v[178:179], v[178:179], v[30:31], v[30:31] op_sel:[0,0,1] op_sel_hi:[1,0,1]
    v_pk_fma_f32 v[180:181], v[180:181], v[30:31], v[30:31] op_sel:[0,0,1] op_sel_hi:[1,0,1]
    v_pk_fma_f32 v[182:183], v[182:183], v[30:31], v[30:31] op_sel:[0,0,1] op_sel_hi:[1,0,1]
    v_pk_fma_f32 v[184:185], v[184:185], v[30:31], v[30:31] op_sel:[0,0,1] op_sel_hi:[1,0,1]
    v_pk_fma_f32 v[186:187], v[186:187], v[30:31], v[30:31] op_sel:[0,0,1] op_sel_hi:[1,0,1]
    v_pk_fma_f32 v[188:189], v[188:189], v[30:31], v[30:31] op_sel:[0,0,1] op_sel_hi:[1,0,1]
    v_pk_fma_f32 v[190:191], v[190:191], v[30:31], v[30:31] op_sel:[0,0,1] op_sel_hi:[1,0,1]
    v_pk_fma_f32 v[192:193], v[192:193], v[30:31], v[30:31] op_sel:[0,0,1] op_sel_hi:[1,0,1]
    v_pk_fma_f32 v[194:195], v[194:195], v[30:31], v[30:31] op_sel:[0,0,1] op_sel_hi:[1,0,1]
    buffer_load_dwordx4 v8, s[28:31], s63 offen offset:2048 lds
    v_pk_fma_f32 v[196:197], v[196:197], v[30:31], v[30:31] op_sel:[0,0,1] op_sel_hi:[1,0,1]
    v_pk_fma_f32 v[198:199], v[198:199], v[30:31], v[30:31] op_sel:[0,0,1] op_sel_hi:[1,0,1]
    v_pk_fma_f32 v[200:201], v[200:201], v[30:31], v[30:31] op_sel:[0,0,1] op_sel_hi:[1,0,1]
    v_pk_fma_f32 v[202:203], v[202:203], v[30:31], v[30:31] op_sel:[0,0,1] op_sel_hi:[1,0,1]
    v_pk_mul_f32 v[176:177], v[176:177], v[32:33]
    v_pk_mul_f32 v[178:179], v[178:179], v[34:35]
    v_pk_mul_f32 v[180:181], v[180:181], v[36:37]
    v_pk_mul_f32 v[182:183], v[182:183], v[38:39]
    v_pk_mul_f32 v[184:185], v[184:185], v[40:41]
    v_pk_mul_f32 v[186:187], v[186:187], v[42:43]
    v_pk_mul_f32 v[188:189], v[188:189], v[44:45]
    v_pk_mul_f32 v[190:191], v[190:191], v[46:47]
    v_pk_mul_f32 v[192:193], v[192:193], v[48:49]
    v_pk_mul_f32 v[194:195], v[194:195], v[50:51]
    v_pk_mul_f32 v[196:197], v[196:197], v[52:53]
    v_pk_mul_f32 v[198:199], v[198:199], v[54:55]
    v_pk_mul_f32 v[200:201], v[200:201], v[56:57]
    v_pk_mul_f32 v[202:203], v[202:203], v[58:59]
    v_exp_f32 v176, v176
    buffer_load_dwordx4 v8, s[28:31], s63 offen offset:3072 lds
    v_exp_f32 v177, v177
    v_exp_f32 v178, v178
    v_exp_f32 v179, v179
    v_exp_f32 v180, v180
    v_exp_f32 v181, v181
    v_exp_f32 v182, v182
    v_exp_f32 v183, v183
    v_exp_f32 v184, v184
    v_exp_f32 v185, v185
    v_exp_f32 v186, v186
    s_add_u32 s62, s62, 4096
    s_add_u32 s63, s63, 4096
    s_mov_b32 m0, s62
    buffer_load_dwordx4 v8, s[28:31], s63 offen offset:0 lds
    v_exp_f32 v187, v187
    v_exp_f32 v188, v188
    v_exp_f32 v189, v189
    v_exp_f32 v190, v190
    v_exp_f32 v191, v191
    v_exp_f32 v192, v192
    v_exp_f32 v193, v193
    v_exp_f32 v194, v194
    v_exp_f32 v195, v195
    v_exp_f32 v196, v196
    buffer_load_dwordx4 v8, s[28:31], s63 offen offset:1024 lds
    v_exp_f32 v197, v197
    v_exp_f32 v198, v198
    v_exp_f32 v199, v199
    v_exp_f32 v200, v200
    v_exp_f32 v201, v201
    v_exp_f32 v202, v202
    v_exp_f32 v203, v203
    v_pk_add_f32 v[176:177], v[176:177], 1.0 op_sel_hi:[1,0]
    v_pk_add_f32 v[178:179], v[178:179], 1.0 op_sel_hi:[1,0]
    v_pk_add_f32 v[180:181], v[180:181], 1.0 op_sel_hi:[1,0]
    v_pk_add_f32 v[182:183], v[182:183], 1.0 op_sel_hi:[1,0]
    v_pk_add_f32 v[184:185], v[184:185], 1.0 op_sel_hi:[1,0]
    buffer_load_dwordx4 a[96:99], v8, s[28:31], s55 offen offset:0
    v_pk_add_f32 v[186:187], v[186:187], 1.0 op_sel_hi:[1,0]
    v_pk_add_f32 v[188:189], v[188:189], 1.0 op_sel_hi:[1,0]
    v_pk_add_f32 v[190:191], v[190:191], 1.0 op_sel_hi:[1,0]
    v_pk_add_f32 v[192:193], v[192:193], 1.0 op_sel_hi:[1,0]
    v_pk_add_f32 v[194:195], v[194:195], 1.0 op_sel_hi:[1,0]
    v_pk_add_f32 v[196:197], v[196:197], 1.0 op_sel_hi:[1,0]
    v_pk_add_f32 v[198:199], v[198:199], 1.0 op_sel_hi:[1,0]
    v_pk_add_f32 v[200:201], v[200:201], 1.0 op_sel_hi:[1,0]
    v_pk_add_f32 v[202:203], v[202:203], 1.0 op_sel_hi:[1,0]
    v_rcp_f32 v176, v176
    v_rcp_f32 v177, v177
    v_rcp_f32 v178, v178
    v_rcp_f32 v179, v179
    v_rcp_f32 v180, v180
    buffer_load_dwordx4 a[100:103], v8, s[28:31], s55 offen offset:1024
    v_rcp_f32 v181, v181
    v_rcp_f32 v182, v182
    v_rcp_f32 v183, v183
    v_rcp_f32 v184, v184
    v_rcp_f32 v185, v185
    v_rcp_f32 v186, v186
    v_rcp_f32 v187, v187
    v_rcp_f32 v188, v188
    v_rcp_f32 v189, v189
    v_rcp_f32 v190, v190
    buffer_load_dwordx4 a[104:107], v8, s[28:31], s55 offen offset:2048
    v_rcp_f32 v191, v191
    v_rcp_f32 v192, v192
    v_rcp_f32 v193, v193
    v_rcp_f32 v194, v194
    v_rcp_f32 v195, v195
    v_rcp_f32 v196, v196
    v_rcp_f32 v197, v197
    v_rcp_f32 v198, v198
    v_rcp_f32 v199, v199
    v_rcp_f32 v200, v200
    buffer_load_dwordx4 a[108:111], v8, s[28:31], s55 offen offset:3072
    v_rcp_f32 v201, v201
    v_rcp_f32 v202, v202
    v_rcp_f32 v203, v203
    v_pk_mul_f32 v[32:33], v[32:33], v[176:177]
    v_pk_mul_f32 v[34:35], v[34:35], v[178:179]
    v_pk_mul_f32 v[36:37], v[36:37], v[180:181]
    v_pk_mul_f32 v[38:39], v[38:39], v[182:183]
    v_pk_mul_f32 v[40:41], v[40:41], v[184:185]
    v_pk_mul_f32 v[42:43], v[42:43], v[186:187]
    v_pk_mul_f32 v[44:45], v[44:45], v[188:189]
    v_pk_mul_f32 v[46:47], v[46:47], v[190:191]
    v_pk_mul_f32 v[48:49], v[48:49], v[192:193]
    v_pk_mul_f32 v[50:51], v[50:51], v[194:195]
    v_pk_mul_f32 v[52:53], v[52:53], v[196:197]
    v_pk_mul_f32 v[54:55], v[54:55], v[198:199]
    v_pk_mul_f32 v[56:57], v[56:57], v[200:201]
    s_add_u32 s55, s55, 4096
    buffer_load_dwordx4 a[112:115], v8, s[28:31], s55 offen offset:0
    s_add_u32 s55, s55, 6144
    v_pk_mul_f32 v[58:59], v[58:59], v[202:203]
    v_cvt_pk_bf16_f32 v144, v32, v33
    v_cvt_pk_bf16_f32 v145, v34, v35
    v_cvt_pk_bf16_f32 v146, v36, v37
    v_cvt_pk_bf16_f32 v147, v38, v39
    v_cvt_pk_bf16_f32 v148, v40, v41
    v_cvt_pk_bf16_f32 v149, v42, v43
    v_cvt_pk_bf16_f32 v150, v44, v45
    v_cvt_pk_bf16_f32 v151, v46, v47
    v_cvt_pk_bf16_f32 v152, v48, v49
    v_cvt_pk_bf16_f32 v153, v50, v51
    v_cvt_pk_bf16_f32 v154, v52, v53
    v_cvt_pk_bf16_f32 v155, v54, v55
    v_cvt_pk_bf16_f32 v156, v56, v57
    v_cvt_pk_bf16_f32 v157, v58, v59
    s_nop 1
    v_permlane16_swap_b32 v144, v146
    v_permlane16_swap_b32 v145, v147
    v_permlane16_swap_b32 v148, v150
    v_permlane16_swap_b32 v149, v151
    v_permlane16_swap_b32 v152, v154
    v_permlane16_swap_b32 v153, v155
    s_add_u32 s26, s13, 0
    s_add_u32 s27, s12, 0
    buffer_store_dwordx4 v[144:147], v226, s[28:31], s26 offen sc1
    buffer_store_dwordx2 v[156:157], v227, s[28:31], s27 offen sc1
    s_cmp_eq_u32 s52, 15
    s_cbranch_scc1 chain_kernel_j157
    buffer_store_dwordx4 v[148:151], v226, s[28:31], s26 offen offset:1024 sc1
    buffer_store_dwordx4 v[152:155], v226, s[28:31], s26 offen offset:2048 sc1
chain_kernel_j157:
    v_pk_mul_f32 v[176:177], v[88:89], v[20:21] op_sel_hi:[1,0]
    buffer_load_dwordx4 a[116:119], v8, s[28:31], s55 offen offset:0
    v_pk_mul_f32 v[178:179], v[90:91], v[20:21] op_sel_hi:[1,0]
    v_pk_mul_f32 v[180:181], v[92:93], v[20:21] op_sel_hi:[1,0]
    v_pk_mul_f32 v[182:183], v[94:95], v[20:21] op_sel_hi:[1,0]
    v_pk_mul_f32 v[184:185], v[96:97], v[20:21] op_sel_hi:[1,0]
    v_pk_mul_f32 v[186:187], v[98:99], v[20:21] op_sel_hi:[1,0]
    v_pk_mul_f32 v[188:189], v[100:101], v[20:21] op_sel_hi:[1,0]
    v_pk_mul_f32 v[190:191], v[102:103], v[20:21] op_sel_hi:[1,0]
    v_pk_mul_f32 v[192:193], v[104:105], v[20:21] op_sel_hi:[1,0]
    v_pk_mul_f32 v[194:195], v[106:107], v[20:21] op_sel_hi:[1,0]
    v_pk_mul_f32 v[196:197], v[108:109], v[20:21] op_sel_hi:[1,0]
    v_pk_mul_f32 v[198:199], v[110:111], v[20:21] op_sel_hi:[1,0]
    v_pk_mul_f32 v[200:201], v[112:113], v[20:21] op_sel_hi:[1,0]
    v_pk_mul_f32 v[202:203], v[114:115], v[20:21] op_sel_hi:[1,0]
    v_pk_fma_f32 v[60:61], v[60:61], v[20:21], v[176:177] op_sel:[0,1,0] op_sel_hi:[1,1,1]
    v_pk_fma_f32 v[62:63], v[62:63], v[20:21], v[178:179] op_sel:[0,1,0] op_sel_hi:[1,1,1]
    v_pk_fma_f32 v[64:65], v[64:65], v[20:21], v[180:181] op_sel:[0,1,0] op_sel_hi:[1,1,1]
    v_pk_fma_f32 v[66:67], v[66:67], v[20:21], v[182:183] op_sel:[0,1,0] op_sel_hi:[1,1,1]
    v_pk_fma_f32 v[68:69], v[68:69], v[20:21], v[184:185] op_sel:[0,1,0] op_sel_hi:[1,1,1]
    v_pk_fma_f32 v[70:71], v[70:71], v[20:21], v[186:187] op_sel:[0,1,0] op_sel_hi:[1,1,1]
    buffer_load_dwordx4 a[120:123], v8, s[28:31], s55 offen offset:1024
    v_pk_fma_f32 v[72:73], v[72:73], v[20:21], v[188:189] op_sel:[0,1,0] op_sel_hi:[1,1,1]
    v_pk_fma_f32 v[74:75], v[74:75], v[20:21], v[190:191] op_sel:[0,1,0] op_sel_hi:[1,1,1]
    v_pk_fma_f32 v[76:77], v[76:77], v[20:21], v[192:193] op_sel:[0,1,0] op_sel_hi:[1,1,1]
    v_pk_fma_f32 v[78:79], v[78:79], v[20:21], v[194:195] op_sel:[0,1,0] op_sel_hi:[1,1,1]
    v_pk_fma_f32 v[80:81], v[80:81], v[20:21], v[196:197] op_sel:[0,1,0] op_sel_hi:[1,1,1]
    v_pk_fma_f32 v[82:83], v[82:83], v[20:21], v[198:199] op_sel:[0,1,0] op_sel_hi:[1,1,1]
    v_pk_fma_f32 v[84:85], v[84:85], v[20:21], v[200:201] op_sel:[0,1,0] op_sel_hi:[1,1,1]
    v_pk_fma_f32 v[86:87], v[86:87], v[20:21], v[202:203] op_sel:[0,1,0] op_sel_hi:[1,1,1]
    v_pk_mul_f32 v[176:177], v[60:61], v[60:61]
    v_pk_mul_f32 v[178:179], v[62:63], v[62:63]
    v_pk_mul_f32 v[180:181], v[64:65], v[64:65]
    v_pk_mul_f32 v[182:183], v[66:67], v[66:67]
    v_pk_mul_f32 v[184:185], v[68:69], v[68:69]
    v_pk_mul_f32 v[186:187], v[70:71], v[70:71]
    v_pk_mul_f32 v[188:189], v[72:73], v[72:73]
    v_pk_mul_f32 v[190:191], v[74:75], v[74:75]
    v_pk_mul_f32 v[192:193], v[76:77], v[76:77]
    v_pk_mul_f32 v[194:195], v[78:79], v[78:79]
    v_pk_mul_f32 v[196:197], v[80:81], v[80:81]
    buffer_load_dwordx4 a[124:127], v8, s[28:31], s55 offen offset:2048
    v_pk_mul_f32 v[198:199], v[82:83], v[82:83]
    v_pk_mul_f32 v[200:201], v[84:85], v[84:85]
    v_pk_mul_f32 v[202:203], v[86:87], v[86:87]
    v_pk_fma_f32 v[176:177], v[176:177], v[30:31], v[30:31] op_sel:[0,0,1] op_sel_hi:[1,0,1]
    v_pk_fma_f32 v[178:179], v[178:179], v[30:31], v[30:31] op_sel:[0,0,1] op_sel_hi:[1,0,1]
    v_pk_fma_f32 v[180:181], v[180:181], v[30:31], v[30:31] op_sel:[0,0,1] op_sel_hi:[1,0,1]
    v_pk_fma_f32 v[182:183], v[182:183], v[30:31], v[30:31] op_sel:[0,0,1] op_sel_hi:[1,0,1]
    v_pk_fma_f32 v[184:185], v[184:185], v[30:31], v[30:31] op_sel:[0,0,1] op_sel_hi:[1,0,1]
    v_pk_fma_f32 v[186:187], v[186:187], v[30:31], v[30:31] op_sel:[0,0,1] op_sel_hi:[1,0,1]
    v_pk_fma_f32 v[188:189], v[188:189], v[30:31], v[30:31] op_sel:[0,0,1] op_sel_hi:[1,0,1]
    v_pk_fma_f32 v[190:191], v[190:191], v[30:31], v[30:31] op_sel:[0,0,1] op_sel_hi:[1,0,1]
    v_pk_fma_f32 v[192:193], v[192:193], v[30:31], v[30:31] op_sel:[0,0,1] op_sel_hi:[1,0,1]
    v_pk_fma_f32 v[194:195], v[194:195], v[30:31], v[30:31] op_sel:[0,0,1] op_sel_hi:[1,0,1]
    v_pk_fma_f32 v[196:197], v[196:197], v[30:31], v[30:31] op_sel:[0,0,1] op_sel_hi:[1,0,1]
    v_pk_fma_f32 v[198:199], v[198:199], v[30:31], v[30:31] op_sel:[0,0,1] op_sel_hi:[1,0,1]
    v_pk_fma_f32 v[200:201], v[200:201], v[30:31], v[30:31] op_sel:[0,0,1] op_sel_hi:[1,0,1]
    v_pk_fma_f32 v[202:203], v[202:203], v[30:31], v[30:31] op_sel:[0,0,1] op_sel_hi:[1,0,1]
    v_pk_mul_f32 v[176:177], v[176:177], v[60:61]
    v_pk_mul_f32 v[178:179], v[178:179], v[62:63]
    buffer_load_dwordx4 a[128:131], v8, s[28:31], s55 offen offset:3072
    v_pk_mul_f32 v[180:181], v[180:181], v[64:65]
    v_pk_mul_f32 v[182:183], v[182:183], v[66:67]
    v_pk_mul_f32 v[184:185], v[184:185], v[68:69]
    v_pk_mul_f32 v[186:187], v[186:187], v[70:71]
    v_pk_mul_f32 v[188:189], v[188:189], v[72:73]
    v_pk_mul_f32 v[190:191], v[190:191], v[74:75]
    v_pk_mul_f32 v[192:193], v[192:193], v[76:77]
    v_pk_mul_f32 v[194:195], v[194:195], v[78:79]
    v_pk_mul_f32 v[196:197], v[196:197], v[80:81]
    v_pk_mul_f32 v[198:199], v[198:199], v[82:83]
    v_pk_mul_f32 v[200:201], v[200:201], v[84:85]
    v_pk_mul_f32 v[202:203], v[202:203], v[86:87]
    v_exp_f32 v176, v176
    v_exp_f32 v177, v177
    v_exp_f32 v178, v178
    v_exp_f32 v179, v179
    s_add_u32 s55, s55, 4096
    buffer_load_dwordx4 a[132:135], v8, s[28:31], s55 offen offset:0
    s_add_u32 s55, s55, 6144
    v_exp_f32 v180, v180
    v_exp_f32 v181, v181
    v_exp_f32 v182, v182
    v_exp_f32 v183, v183
    v_exp_f32 v184, v184
    v_exp_f32 v185, v185
    v_exp_f32 v186, v186
    v_exp_f32 v187, v187
    v_exp_f32 v188, v188
    v_exp_f32 v189, v189
    buffer_load_dwordx4 a[136:139], v8, s[28:31], s55 offen offset:0
    v_exp_f32 v190, v190
    v_exp_f32 v191, v191
    v_exp_f32 v192, v192
    v_exp_f32 v193, v193
    v_exp_f32 v194, v194
    v_exp_f32 v195, v195
    v_exp_f32 v196, v196
    v_exp_f32 v197, v197
    v_exp_f32 v198, v198
    v_exp_f32 v199, v199
    buffer_load_dwordx4 a[140:143], v8, s[28:31], s55 offen offset:1024
    v_exp_f32 v200, v200
    v_exp_f32 v201, v201
    v_exp_f32 v202, v202
    v_exp_f32 v203, v203
    v_pk_add_f32 v[176:177], v[176:177], 1.0 op_sel_hi:[1,0]
    v_pk_add_f32 v[178:179], v[178:179], 1.0 op_sel_hi:[1,0]
    v_pk_add_f32 v[180:181], v[180:181], 1.0 op_sel_hi:[1,0]
    v_pk_add_f32 v[182:183], v[182:183], 1.0 op_sel_hi:[1,0]
    v_pk_add_f32 v[184:185], v[184:185], 1.0 op_sel_hi:[1,0]
    v_pk_add_f32 v[186:187], v[186:187], 1.0 op_sel_hi:[1,0]
    v_pk_add_f32 v[188:189], v[188:189], 1.0 op_sel_hi:[1,0]
    v_pk_add_f32 v[190:191], v[190:191], 1.0 op_sel_hi:[1,0]
    v_pk_add_f32 v[192:193], v[192:193], 1.0 op_sel_hi:[1,0]
    v_pk_add_f32 v[194:195], v[194:195], 1.0 op_sel_hi:[1,0]
    v_pk_add_f32 v[196:197], v[196:197], 1.0 op_sel_hi:[1,0]
    buffer_load_dwordx4 a[144:147], v8, s[28:31], s55 offen offset:2048
    v_pk_add_f32 v[198:199], v[198:199], 1.0 op_sel_hi:[1,0]
    v_pk_add_f32 v[200:201], v[200:201], 1.0 op_sel_hi:[1,0]
    v_pk_add_f32 v[202:203], v[202:203], 1.0 op_sel_hi:[1,0]
    v_rcp_f32 v176, v176
    v_rcp_f32 v177, v177
    v_rcp_f32 v178, v178
    v_rcp_f32 v179, v179
    v_rcp_f32 v180, v180
    v_rcp_f32 v181, v181
    v_rcp_f32 v182, v182
    v_rcp_f32 v183, v183
    buffer_load_dwordx4 a[148:151], v8, s[28:31], s55 offen offset:3072
    v_rcp_f32 v184, v184
    v_rcp_f32 v185, v185
    v_rcp_f32 v186, v186
    v_rcp_f32 v187, v187
    v_rcp_f32 v188, v188
    v_rcp_f32 v189, v189
    v_rcp_f32 v190, v190
    v_rcp_f32 v191, v191
    v_rcp_f32 v192, v192
    v_rcp_f32 v193, v193
    s_add_u32 s55, s55, 4096
    buffer_load_dwordx4 a[152:155], v8, s[28:31], s55 offen offset:0
    s_add_u32 s55, s55, 6144
    v_rcp_f32 v194, v194
    v_rcp_f32 v195, v195
    v_rcp_f32 v196, v196
    v_rcp_f32 v197, v197
    v_rcp_f32 v198, v198
    v_rcp_f32 v199, v199
    v_rcp_f32 v200, v200
    v_rcp_f32 v201, v201
    v_rcp_f32 v202, v202
    v_rcp_f32 v203, v203
    buffer_load_dwordx4 a[156:159], v8, s[28:31], s55 offen offset:0
    v_pk_mul_f32 v[60:61], v[60:61], v[176:177]
    v_pk_mul_f32 v[62:63], v[62:63], v[178:179]
    v_pk_mul_f32 v[64:65], v[64:65], v[180:181]
    v_pk_mul_f32 v[66:67], v[66:67], v[182:183]
    v_pk_mul_f32 v[68:69], v[68:69], v[184:185]
    v_pk_mul_f32 v[70:71], v[70:71], v[186:187]
    v_pk_mul_f32 v[72:73], v[72:73], v[188:189]
    v_pk_mul_f32 v[74:75], v[74:75], v[190:191]
    v_pk_mul_f32 v[76:77], v[76:77], v[192:193]
    v_pk_mul_f32 v[78:79], v[78:79], v[194:195]
    v_pk_mul_f32 v[80:81], v[80:81], v[196:197]
    v_pk_mul_f32 v[82:83], v[82:83], v[198:199]
    v_pk_mul_f32 v[84:85], v[84:85], v[200:201]
    v_pk_mul_f32 v[86:87], v[86:87], v[202:203]
    v_cvt_pk_bf16_f32 v160, v60, v61
    v_cvt_pk_bf16_f32 v161, v62, v63
    v_cvt_pk_bf16_f32 v162, v64, v65
    v_cvt_pk_bf16_f32 v163, v66, v67
    v_cvt_pk_bf16_f32 v164, v68, v69
    v_cvt_pk_bf16_f32 v165, v70, v71
    v_cvt_pk_bf16_f32 v166, v72, v73
    v_cvt_pk_bf16_f32 v167, v74, v75
    v_cvt_pk_bf16_f32 v168, v76, v77
    v_cvt_pk_bf16_f32 v169, v78, v79
    v_cvt_pk_bf16_f32 v170, v80, v81
    v_cvt_pk_bf16_f32 v171, v82, v83
    v_cvt_pk_bf16_f32 v172, v84, v85
    v_cvt_pk_bf16_f32 v173, v86, v87
    s_nop 1
    v_permlane16_swap_b32 v160, v162
    v_permlane16_swap_b32 v161, v163
    v_permlane16_swap_b32 v164, v166
    v_permlane16_swap_b32 v165, v167
    v_permlane16_swap_b32 v168, v170
    v_permlane16_swap_b32 v169, v171
    s_add_u32 s26, s13, 55296
    s_add_u32 s27, s12, 55296
    buffer_store_dwordx4 v[160:163], v226, s[28:31], s26 offen sc1
    buffer_store_dwordx2 v[172:173], v227, s[28:31], s27 offen sc1
    s_cmp_eq_u32 s52, 15
    s_cbranch_scc1 chain_kernel_j158
    buffer_store_dwordx4 v[164:167], v226, s[28:31], s26 offen offset:1024 sc1
    buffer_store_dwordx4 v[168:171], v226, s[28:31], s26 offen offset:2048 sc1
chain_kernel_j158:
    s_waitcnt vmcnt(0)
    v_mov_b32 v2, 1
    v_mov_b32 v7, 0
    s_mov_b64 exec, 1
    buffer_store_dword v2, v7, s[28:31], s15 offen sc1
    s_mov_b64 exec, -1
    buffer_load_dwordx4 a[160:163], v8, s[28:31], s55 offen offset:1024
    buffer_load_dwordx4 a[164:167], v8, s[28:31], s55 offen offset:2048
    buffer_load_dwordx4 a[168:171], v8, s[28:31], s55 offen offset:3072
    s_add_u32 s55, s55, 4096
    buffer_load_dwordx4 a[172:175], v8, s[28:31], s55 offen offset:0
    s_add_u32 s55, s55, 6144
    buffer_load_dwordx4 a[176:179], v8, s[28:31], s55 offen offset:0
    buffer_load_dwordx4 a[180:183], v8, s[28:31], s55 offen offset:1024
    buffer_load_dwordx4 a[184:187], v8, s[28:31], s55 offen offset:2048
    buffer_load_dwordx4 a[188:191], v8, s[28:31], s55 offen offset:3072
    s_add_u32 s55, s55, 4096
    buffer_load_dwordx4 a[192:195], v8, s[28:31], s55 offen offset:0
    s_add_u32 s55, s55, 6144
    buffer_load_dwordx4 a[196:199], v8, s[28:31], s55 offen offset:0
    buffer_load_dwordx4 a[200:203], v8, s[28:31], s55 offen offset:1024
    buffer_load_dwordx4 a[204:207], v8, s[28:31], s55 offen offset:2048
    buffer_load_dwordx4 a[208:211], v8, s[28:31], s55 offen offset:3072
    s_add_u32 s55, s55, 4096
    buffer_load_dwordx4 a[212:215], v8, s[28:31], s55 offen offset:0
    s_add_u32 s55, s55, 6144
    buffer_load_dwordx4 a[216:219], v8, s[28:31], s55 offen offset:0
    buffer_load_dwordx4 a[220:223], v8, s[28:31], s55 offen offset:1024
    buffer_load_dwordx4 a[224:227], v8, s[28:31], s55 offen offset:2048
    buffer_load_dwordx4 a[228:231], v8, s[28:31], s55 offen offset:3072
    s_add_u32 s55, s55, 4096
    buffer_load_dwordx4 a[232:235], v8, s[28:31], s55 offen offset:0
    s_add_u32 s55, s55, 6144
    buffer_load_dwordx4 a[236:239], v8, s[28:31], s55 offen offset:0
    buffer_load_dwordx4 a[240:243], v8, s[28:31], s55 offen offset:1024
    buffer_load_dwordx4 a[244:247], v8, s[28:31], s55 offen offset:2048
    buffer_load_dwordx4 a[248:251], v8, s[28:31], s55 offen offset:3072
    s_add_u32 s55, s55, 4096
    buffer_load_dwordx4 a[252:255], v8, s[28:31], s55 offen offset:0
    s_add_u32 s55, s55, 6144
    s_mul_i32 s26, s22, 5120
    v_add_u32 v12, s26, v8
    v_add_u32 v13, 0x10000, v12
    v_add_u32 v14, 0x20000, v12
    s_mov_b32 s47, 0
    s_mov_b64 exec, 511
chain_kernel_poll9:
    buffer_load_dword v2, v234, s[28:31], s48 offen sc1
    s_add_u32 s47, s47, 1
    s_waitcnt vmcnt(0)
    v_cmp_ne_u32 vcc, 1, v2
    s_cmp_ge_u32 s47, 200000
    s_cbranch_scc1 chain_kernel_polld10
    s_cbranch_vccnz chain_kernel_poll9
chain_kernel_polld10:
    s_mov_b64 exec, -1
    buffer_load_dwordx4 a[0:3], v8, s[28:31], s50 offen offset:0 sc1
    buffer_load_dwordx4 a[4:7], v8, s[28:31], s51 offen offset:0 sc1
    buffer_load_dwordx4 a[8:11], v8, s[28:31], s50 offen offset:1024 sc1
    buffer_load_dwordx4 a[12:15], v8, s[28:31], s51 offen offset:1024 sc1
    buffer_load_dwordx4 a[16:19], v8, s[28:31], s50 offen offset:2048 sc1
    buffer_load_dwordx4 a[20:23], v8, s[28:31], s51 offen offset:2048 sc1
    buffer_load_dwordx4 a[24:27], v8, s[28:31], s50 offen offset:3072 sc1
    buffer_load_dwordx4 a[28:31], v8, s[28:31], s51 offen offset:3072 sc1
    s_add_u32 s50, s50, 4096
    s_add_u32 s51, s51, 4096
    buffer_load_dwordx4 a[32:35], v8, s[28:31], s50 offen offset:0 sc1
    buffer_load_dwordx4 a[36:39], v8, s[28:31], s51 offen offset:0 sc1
    s_barrier
    ds_read_b128 v[136:139], v14 offset:12288
    ds_read_b128 v[140:143], v14 offset:13312
    ds_read_b128 v[144:147], v14 offset:14336
    ds_read_b128 v[148:151], v14 offset:15360
    ds_read_b128 v[152:155], v14 offset:16384
    ds_read_b128 v[156:159], v12 offset:0
    ds_read_b128 v[160:163], v12 offset:1024
    ds_read_b128 v[164:167], v12 offset:2048
    ds_read_b128 v[168:171], v12 offset:3072
    ds_read_b128 v[172:175], v12 offset:4096
    ds_read_b128 v[176:179], v12 offset:10240
    s_waitcnt vmcnt(8) lgkmcnt(6)
    v_mfma_f32_16x16x32_bf16 v[32:35], v[136:139], a[0:3], 0
    v_mfma_f32_16x16x32_bf16 v[52:55], v[136:139], a[4:7], 0
    ds_read_b128 v[180:183], v12 offset:11264
    buffer_load_dwordx4 a[40:43], v8, s[28:31], s50 offen offset:1024 sc1
    v_mfma_f32_16x16x32_bf16 v[36:39], v[140:143], a[0:3], 0
    v_mfma_f32_16x16x32_bf16 v[56:59], v[140:143], a[4:7], 0
    ds_read_b128 v[136:139], v12 offset:12288
    v_mfma_f32_16x16x32_bf16 v[40:43], v[144:147], a[0:3], 0
    v_mfma_f32_16x16x32_bf16 v[60:63], v[144:147], a[4:7], 0
    ds_read_b128 v[140:143], v12 offset:13312
    buffer_load_dwordx4 a[44:47], v8, s[28:31], s51 offen offset:1024 sc1
    v_mfma_f32_16x16x32_bf16 v[44:47], v[148:151], a[0:3], 0
    v_mfma_f32_16x16x32_bf16 v[64:67], v[148:151], a[4:7], 0
    ds_read_b128 v[144:147], v12 offset:14336
    v_mfma_f32_16x16x32_bf16 v[48:51], v[152:155], a[0:3], 0
    v_mfma_f32_16x16x32_bf16 v[68:71], v[152:155], a[4:7], 0
    ds_read_b128 v[148:151], v12 offset:20480
    buffer_load_dwordx4 a[48:51], v8, s[28:31], s50 offen offset:2048 sc1
    s_waitcnt vmcnt(9) lgkmcnt(6)
    v_mfma_f32_16x16x32_bf16 v[32:35], v[156:159], a[8:11], v[32:35]
    v_mfma_f32_16x16x32_bf16 v[52:55], v[156:159], a[12:15], v[52:55]
    ds_read_b128 v[152:155], v12 offset:21504
    v_mfma_f32_16x16x32_bf16 v[36:39], v[160:163], a[8:11], v[36:39]
    v_mfma_f32_16x16x32_bf16 v[56:59], v[160:163], a[12:15], v[56:59]
    ds_read_b128 v[156:159], v12 offset:22528
    buffer_load_dwordx4 a[52:55], v8, s[28:31], s51 offen offset:2048 sc1
    v_mfma_f32_16x16x32_bf16 v[40:43], v[164:167], a[8:11], v[40:43]
    v_mfma_f32_16x16x32_bf16 v[60:63], v[164:167], a[12:15], v[60:63]
    ds_read_b128 v[160:163], v12 offset:23552
    v_mfma_f32_16x16x32_bf16 v[44:47], v[168:171], a[8:11], v[44:47]
    v_mfma_f32_16x16x32_bf16 v[64:67], v[168:171], a[12:15], v[64:67]
    ds_read_b128 v[164:167], v12 offset:24576
    buffer_load_dwordx4 a[56:59], v8, s[28:31], s50 offen offset:3072 sc1
    v_mfma_f32_16x16x32_bf16 v[48:51], v[172:175], a[8:11], v[48:51]
    v_mfma_f32_16x16x32_bf16 v[68:71], v[172:175], a[12:15], v[68:71]
    s_waitcnt lgkmcnt(5)
    s_barrier
    ds_read_b128 v[168:171], v12 offset:30720
    s_mul_i32 s25, s20, 3
    s_min_u32 s25, s25, 7
    s_lshl_b32 s25, s25, 10
    s_add_u32 s62, s25, 143360
    s_add_u32 s63, s25, s59
    s_add_u32 s63, s63, 163840
    s_mov_b32 m0, s62
    buffer_load_dwordx4 v8, s[28:31], s63 offen offset:0 lds
    s_waitcnt vmcnt(10) lgkmcnt(6)
    v_mfma_f32_16x16x32_bf16 v[32:35], v[176:179], a[16:19], v[32:35]
    v_mfma_f32_16x16x32_bf16 v[52:55], v[176:179], a[20:23], v[52:55]
    ds_read_b128 v[172:175], v12 offset:31744
    buffer_load_dwordx4 v8, s[28:31], s63 offen offset:1024 lds
    v_mfma_f32_16x16x32_bf16 v[36:39], v[180:183], a[16:19], v[36:39]
    v_mfma_f32_16x16x32_bf16 v[56:59], v[180:183], a[20:23], v[56:59]
    ds_read_b128 v[176:179], v12 offset:32768
    buffer_load_dwordx4 v8, s[28:31], s63 offen offset:2048 lds
    v_mfma_f32_16x16x32_bf16 v[40:43], v[136:139], a[16:19], v[40:43]
    v_mfma_f32_16x16x32_bf16 v[60:63], v[136:139], a[20:23], v[60:63]
    ds_read_b128 v[180:183], v12 offset:33792
    s_mul_i32 s25, s20, 5
    s_lshl_b32 s25, s25, 10
    s_add_u32 s62, s25, 0
    s_add_u32 s63, s25, s59
    s_add_u32 s63, s63, 174080
    s_mov_b32 m0, s62
    buffer_load_dwordx4 v8, s[28:31], s63 offen offset:0 lds
    v_mfma_f32_16x16x32_bf16 v[44:47], v[140:143], a[16:19], v[44:47]
    v_mfma_f32_16x16x32_bf16 v[64:67], v[140:143], a[20:23], v[64:67]
    ds_read_b128 v[136:139], v12 offset:34816
    buffer_load_dwordx4 v8, s[28:31], s63 offen offset:1024 lds
    v_mfma_f32_16x16x32_bf16 v[48:51], v[144:147], a[16:19], v[48:51]
    v_mfma_f32_16x16x32_bf16 v[68:71], v[144:147], a[20:23], v[68:71]
    ds_read_b128 v[140:143], v12 offset:40960
    buffer_load_dwordx4 v8, s[28:31], s63 offen offset:2048 lds
    s_waitcnt vmcnt(13) lgkmcnt(6)
    v_mfma_f32_16x16x32_bf16 v[32:35], v[148:151], a[24:27], v[32:35]
    v_mfma_f32_16x16x32_bf16 v[52:55], v[148:151], a[28:31], v[52:55]
    ds_read_b128 v[144:147], v12 offset:41984
    buffer_load_dwordx4 v8, s[28:31], s63 offen offset:3072 lds
    v_mfma_f32_16x16x32_bf16 v[36:39], v[152:155], a[24:27], v[36:39]
    v_mfma_f32_16x16x32_bf16 v[56:59], v[152:155], a[28:31], v[56:59]
    ds_read_b128 v[148:151], v12 offset:43008
    s_add_u32 s62, s62, 4096
    s_add_u32 s63, s63, 4096
    s_mov_b32 m0, s62
    buffer_load_dwordx4 v8, s[28:31], s63 offen offset:0 lds
    v_mfma_f32_16x16x32_bf16 v[40:43], v[156:159], a[24:27], v[40:43]
    v_mfma_f32_16x16x32_bf16 v[60:63], v[156:159], a[28:31], v[60:63]
    ds_read_b128 v[152:155], v12 offset:44032
    v_mfma_f32_16x16x32_bf16 v[44:47], v[160:163], a[24:27], v[44:47]
    v_mfma_f32_16x16x32_bf16 v[64:67], v[160:163], a[28:31], v[64:67]
    ds_read_b128 v[156:159], v12 offset:45056
    buffer_load_dwordx4 a[60:63], v8, s[28:31], s51 offen offset:3072 sc1
    v_mfma_f32_16x16x32_bf16 v[48:51], v[164:167], a[24:27], v[48:51]
    v_mfma_f32_16x16x32_bf16 v[68:71], v[164:167], a[28:31], v[68:71]
    ds_read_b128 v[160:163], v12 offset:51200
    s_waitcnt vmcnt(14) lgkmcnt(6)
    v_mfma_f32_16x16x32_bf16 v[32:35], v[168:171], a[32:35], v[32:35]
    v_mfma_f32_16x16x32_bf16 v[52:55], v[168:171], a[36:39], v[52:55]
    ds_read_b128 v[164:167], v12 offset:52224
    s_add_u32 s50, s50, 4096
    s_add_u32 s51, s51, 4096
    buffer_load_dwordx4 a[64:67], v8, s[28:31], s50 offen offset:0 sc1
    v_mfma_f32_16x16x32_bf16 v[36:39], v[172:175], a[32:35], v[36:39]
    v_mfma_f32_16x16x32_bf16 v[56:59], v[172:175], a[36:39], v[56:59]
    ds_read_b128 v[168:171], v12 offset:53248
    v_mfma_f32_16x16x32_bf16 v[40:43], v[176:179], a[32:35], v[40:43]
    v_mfma_f32_16x16x32_bf16 v[60:63], v[176:179], a[36:39], v[60:63]
    ds_read_b128 v[172:175], v12 offset:54272
    buffer_load_dwordx4 a[68:71], v8, s[28:31], s51 offen offset:0 sc1
    v_mfma_f32_16x16x32_bf16 v[44:47], v[180:183], a[32:35], v[44:47]
    v_mfma_f32_16x16x32_bf16 v[64:67], v[180:183], a[36:39], v[64:67]
    ds_read_b128 v[176:179], v12 offset:55296
    v_mfma_f32_16x16x32_bf16 v[48:51], v[136:139], a[32:35], v[48:51]
    v_mfma_f32_16x16x32_bf16 v[68:71], v[136:139], a[36:39], v[68:71]
    ds_read_b128 v[180:183], v12 offset:61440
    buffer_load_dwordx4 a[72:75], v8, s[28:31], s50 offen offset:1024 sc1
    s_waitcnt vmcnt(15) lgkmcnt(6)
    v_mfma_f32_16x16x32_bf16 v[32:35], v[140:143], a[40:43], v[32:35]
    v_mfma_f32_16x16x32_bf16 v[52:55], v[140:143], a[44:47], v[52:55]
    ds_read_b128 v[136:139], v12 offset:62464
    v_mfma_f32_16x16x32_bf16 v[36:39], v[144:147], a[40:43], v[36:39]
    v_mfma_f32_16x16x32_bf16 v[56:59], v[144:147], a[44:47], v[56:59]
    ds_read_b128 v[140:143], v12 offset:63488
    buffer_load_dwordx4 a[76:79], v8, s[28:31], s51 offen offset:1024 sc1
    v_mfma_f32_16x16x32_bf16 v[40:43], v[148:151], a[40:43], v[40:43]
    v_mfma_f32_16x16x32_bf16 v[60:63], v[148:151], a[44:47], v[60:63]
    ds_read_b128 v[144:147], v12 offset:64512
    v_mfma_f32_16x16x32_bf16 v[44:47], v[152:155], a[40:43], v[44:47]
    v_mfma_f32_16x16x32_bf16 v[64:67], v[152:155], a[44:47], v[64:67]
    ds_read_b128 v[148:151], v13 offset:0
    buffer_load_dwordx4 a[80:83], v8, s[28:31], s50 offen offset:2048 sc1
    v_mfma_f32_16x16x32_bf16 v[48:51], v[156:159], a[40:43], v[48:51]
    v_mfma_f32_16x16x32_bf16 v[68:71], v[156:159], a[44:47], v[68:71]
    ds_read_b128 v[152:155], v13 offset:6144
    s_waitcnt vmcnt(15) lgkmcnt(6)
    v_mfma_f32_16x16x32_bf16 v[32:35], v[160:163], a[48:51], v[32:35]
    v_mfma_f32_16x16x32_bf16 v[52:55], v[160:163], a[52:55], v[52:55]
    ds_read_b128 v[156:159], v13 offset:7168
    buffer_load_dwordx4 a[84:87], v8, s[28:31], s51 offen offset:2048 sc1
    v_mfma_f32_16x16x32_bf16 v[36:39], v[164:167], a[48:51], v[36:39]
    v_mfma_f32_16x16x32_bf16 v[56:59], v[164:167], a[52:55], v[56:59]
    ds_read_b128 v[160:163], v13 offset:8192
    v_mfma_f32_16x16x32_bf16 v[40:43], v[168:171], a[48:51], v[40:43]
    v_mfma_f32_16x16x32_bf16 v[60:63], v[168:171], a[52:55], v[60:63]
    ds_read_b128 v[164:167], v13 offset:9216
    buffer_load_dwordx4 a[88:91], v8, s[28:31], s50 offen offset:3072 sc1
    v_mfma_f32_16x16x32_bf16 v[44:47], v[172:175], a[48:51], v[44:47]
    v_mfma_f32_16x16x32_bf16 v[64:67], v[172:175], a[52:55], v[64:67]
    ds_read_b128 v[168:171], v13 offset:10240
    v_mfma_f32_16x16x32_bf16 v[48:51], v[176:179], a[48:51], v[48:51]
    v_mfma_f32_16x16x32_bf16 v[68:71], v[176:179], a[52:55], v[68:71]
    ds_read_b128 v[172:175], v14 offset:22528
    buffer_load_dwordx4 a[92:95], v8, s[28:31], s51 offen offset:3072 sc1
    s_waitcnt vmcnt(8) lgkmcnt(6)
    v_mfma_f32_16x16x32_bf16 v[32:35], v[180:183], a[56:59], v[32:35]
    v_mfma_f32_16x16x32_bf16 v[52:55], v[180:183], a[60:63], v[52:55]
    ds_read_b128 v[176:179], v14 offset:23552
    v_mfma_f32_16x16x32_bf16 v[36:39], v[136:139], a[56:59], v[36:39]
    v_mfma_f32_16x16x32_bf16 v[56:59], v[136:139], a[60:63], v[56:59]
    ds_read_b128 v[180:183], v14 offset:24576
    s_add_u32 s50, s50, 4096
    s_add_u32 s51, s51, 4096
    buffer_load_dwordx4 a[0:3], v8, s[28:31], s50 offen offset:0 sc1
    v_mfma_f32_16x16x32_bf16 v[40:43], v[140:143], a[56:59], v[40:43]
    v_mfma_f32_16x16x32_bf16 v[60:63], v[140:143], a[60:63], v[60:63]
    ds_read_b128 v[136:139], v14 offset:25600
    v_mfma_f32_16x16x32_bf16 v[44:47], v[144:147], a[56:59], v[44:47]
    v_mfma_f32_16x16x32_bf16 v[64:67], v[144:147], a[60:63], v[64:67]
    ds_read_b128 v[140:143], v14 offset:26624
    buffer_load_dwordx4 a[4:7], v8, s[28:31], s51 offen offset:0 sc1
    v_mfma_f32_16x16x32_bf16 v[48:51], v[148:151], a[56:59], v[48:51]
    v_mfma_f32_16x16x32_bf16 v[68:71], v[148:151], a[60:63], v[68:71]
    ds_read_b128 v[144:147], v13 offset:57344
    s_waitcnt vmcnt(8) lgkmcnt(6)
    v_mfma_f32_16x16x32_bf16 v[32:35], v[152:155], a[64:67], v[32:35]
    v_mfma_f32_16x16x32_bf16 v[52:55], v[152:155], a[68:71], v[52:55]
    ds_read_b128 v[148:151], v13 offset:58368
    buffer_load_dwordx4 a[8:11], v8, s[28:31], s50 offen offset:1024 sc1
    v_mfma_f32_16x16x32_bf16 v[36:39], v[156:159], a[64:67], v[36:39]
    v_mfma_f32_16x16x32_bf16 v[56:59], v[156:159], a[68:71], v[56:59]
    ds_read_b128 v[152:155], v13 offset:59392
    buffer_load_dwordx4 a[12:15], v8, s[28:31], s51 offen offset:1024 sc1
    v_mfma_f32_16x16x32_bf16 v[40:43], v[160:163], a[64:67], v[40:43]
    v_mfma_f32_16x16x32_bf16 v[60:63], v[160:163], a[68:71], v[60:63]
    ds_read_b128 v[156:159], v13 offset:60416
    buffer_load_dwordx4 a[16:19], v8, s[28:31], s50 offen offset:2048 sc1
    v_mfma_f32_16x16x32_bf16 v[44:47], v[164:167], a[64:67], v[44:47]
    v_mfma_f32_16x16x32_bf16 v[64:67], v[164:167], a[68:71], v[64:67]
    ds_read_b128 v[160:163], v13 offset:61440
    v_mfma_f32_16x16x32_bf16 v[48:51], v[168:171], a[64:67], v[48:51]
    v_mfma_f32_16x16x32_bf16 v[68:71], v[168:171], a[68:71], v[68:71]
    ds_read_b128 v[164:167], v14 offset:2048
    buffer_load_dwordx4 a[20:23], v8, s[28:31], s51 offen offset:2048 sc1
    s_waitcnt vmcnt(10) lgkmcnt(6)
    v_mfma_f32_16x16x32_bf16 v[32:35], v[172:175], a[72:75], v[32:35]
    v_mfma_f32_16x16x32_bf16 v[52:55], v[172:175], a[76:79], v[52:55]
    ds_read_b128 v[168:171], v14 offset:3072
    s_add_u32 s26, s44, 13406208
    buffer_load_dwordx2 v[96:97], v230, s[28:31], s26 offen sc1
    v_mfma_f32_16x16x32_bf16 v[36:39], v[176:179], a[72:75], v[36:39]
    v_mfma_f32_16x16x32_bf16 v[56:59], v[176:179], a[76:79], v[56:59]
    ds_read_b128 v[172:175], v14 offset:4096
    s_add_u32 s26, s44, 13406720
    buffer_load_dwordx2 v[98:99], v230, s[28:31], s26 offen sc1
    v_mfma_f32_16x16x32_bf16 v[40:43], v[180:183], a[72:75], v[40:43]
    v_mfma_f32_16x16x32_bf16 v[60:63], v[180:183], a[76:79], v[60:63]
    ds_read_b128 v[176:179], v14 offset:5120
    v_mfma_f32_16x16x32_bf16 v[44:47], v[136:139], a[72:75], v[44:47]
    v_mfma_f32_16x16x32_bf16 v[64:67], v[136:139], a[76:79], v[64:67]
    ds_read_b128 v[180:183], v14 offset:6144
    s_add_u32 s26, s44, 13407232
    buffer_load_dwordx2 v[100:101], v230, s[28:31], s26 offen sc1
    v_mfma_f32_16x16x32_bf16 v[48:51], v[140:143], a[72:75], v[48:51]
    v_mfma_f32_16x16x32_bf16 v[68:71], v[140:143], a[76:79], v[68:71]
    ds_read_b128 v[136:139], v13 offset:16384
    s_waitcnt vmcnt(11) lgkmcnt(6)
    v_mfma_f32_16x16x32_bf16 v[32:35], v[144:147], a[80:83], v[32:35]
    v_mfma_f32_16x16x32_bf16 v[52:55], v[144:147], a[84:87], v[52:55]
    ds_read_b128 v[140:143], v13 offset:17408
    s_add_u32 s26, s44, 13407744
    buffer_load_dwordx2 v[102:103], v230, s[28:31], s26 offen sc1
    v_mfma_f32_16x16x32_bf16 v[36:39], v[148:151], a[80:83], v[36:39]
    v_mfma_f32_16x16x32_bf16 v[56:59], v[148:151], a[84:87], v[56:59]
    ds_read_b128 v[144:147], v13 offset:18432
    v_mfma_f32_16x16x32_bf16 v[40:43], v[152:155], a[80:83], v[40:43]
    v_mfma_f32_16x16x32_bf16 v[60:63], v[152:155], a[84:87], v[60:63]
    ds_read_b128 v[148:151], v13 offset:19456
    s_add_u32 s26, s45, 13406208
    buffer_load_dwordx2 v[104:105], v230, s[28:31], s26 offen sc1
    v_mfma_f32_16x16x32_bf16 v[44:47], v[156:159], a[80:83], v[44:47]
    v_mfma_f32_16x16x32_bf16 v[64:67], v[156:159], a[84:87], v[64:67]
    ds_read_b128 v[152:155], v13 offset:20480
    v_mfma_f32_16x16x32_bf16 v[48:51], v[160:163], a[80:83], v[48:51]
    v_mfma_f32_16x16x32_bf16 v[68:71], v[160:163], a[84:87], v[68:71]
    ds_read_b128 v[156:159], v13 offset:26624
    buffer_load_dwordx4 a[24:27], v8, s[28:31], s50 offen offset:3072 sc1
    s_waitcnt vmcnt(12) lgkmcnt(6)
    v_mfma_f32_16x16x32_bf16 v[32:35], v[164:167], a[88:91], v[32:35]
    v_mfma_f32_16x16x32_bf16 v[52:55], v[164:167], a[92:95], v[52:55]
    ds_read_b128 v[160:163], v13 offset:27648
    v_mfma_f32_16x16x32_bf16 v[36:39], v[168:171], a[88:91], v[36:39]
    v_mfma_f32_16x16x32_bf16 v[56:59], v[168:171], a[92:95], v[56:59]
    ds_read_b128 v[164:167], v13 offset:28672
    buffer_load_dwordx4 a[28:31], v8, s[28:31], s51 offen offset:3072 sc1
    v_mfma_f32_16x16x32_bf16 v[40:43], v[172:175], a[88:91], v[40:43]
    v_mfma_f32_16x16x32_bf16 v[60:63], v[172:175], a[92:95], v[60:63]
    ds_read_b128 v[168:171], v13 offset:29696
    v_mfma_f32_16x16x32_bf16 v[44:47], v[176:179], a[88:91], v[44:47]
    v_mfma_f32_16x16x32_bf16 v[64:67], v[176:179], a[92:95], v[64:67]
    ds_read_b128 v[172:175], v13 offset:30720
    s_add_u32 s50, s50, 4096
    s_add_u32 s51, s51, 4096
    buffer_load_dwordx4 a[32:35], v8, s[28:31], s50 offen offset:0 sc1
    v_mfma_f32_16x16x32_bf16 v[48:51], v[180:183], a[88:91], v[48:51]
    v_mfma_f32_16x16x32_bf16 v[68:71], v[180:183], a[92:95], v[68:71]
    ds_read_b128 v[176:179], v13 offset:36864
    s_waitcnt vmcnt(12) lgkmcnt(6)
    v_mfma_f32_16x16x32_bf16 v[32:35], v[136:139], a[0:3], v[32:35]
    v_mfma_f32_16x16x32_bf16 v[52:55], v[136:139], a[4:7], v[52:55]
    ds_read_b128 v[180:183], v13 offset:37888
    buffer_load_dwordx4 a[36:39], v8, s[28:31], s51 offen offset:0 sc1
    v_mfma_f32_16x16x32_bf16 v[36:39], v[140:143], a[0:3], v[36:39]
    v_mfma_f32_16x16x32_bf16 v[56:59], v[140:143], a[4:7], v[56:59]
    ds_read_b128 v[136:139], v13 offset:38912
    v_mfma_f32_16x16x32_bf16 v[40:43], v[144:147], a[0:3], v[40:43]
    v_mfma_f32_16x16x32_bf16 v[60:63], v[144:147], a[4:7], v[60:63]
    ds_read_b128 v[140:143], v13 offset:39936
    buffer_load_dwordx4 a[40:43], v8, s[28:31], s50 offen offset:1024 sc1
    v_mfma_f32_16x16x32_bf16 v[44:47], v[148:151], a[0:3], v[44:47]
    v_mfma_f32_16x16x32_bf16 v[64:67], v[148:151], a[4:7], v[64:67]
    ds_read_b128 v[144:147], v13 offset:40960
    v_mfma_f32_16x16x32_bf16 v[48:51], v[152:155], a[0:3], v[48:51]
    v_mfma_f32_16x16x32_bf16 v[68:71], v[152:155], a[4:7], v[68:71]
    ds_read_b128 v[148:151], v13 offset:47104
    buffer_load_dwordx4 a[44:47], v8, s[28:31], s51 offen offset:1024 sc1
    s_waitcnt vmcnt(13) lgkmcnt(6)
    v_mfma_f32_16x16x32_bf16 v[32:35], v[156:159], a[8:11], v[32:35]
    v_mfma_f32_16x16x32_bf16 v[52:55], v[156:159], a[12:15], v[52:55]
    ds_read_b128 v[152:155], v13 offset:48128
    v_mfma_f32_16x16x32_bf16 v[36:39], v[160:163], a[8:11], v[36:39]
    v_mfma_f32_16x16x32_bf16 v[56:59], v[160:163], a[12:15], v[56:59]
    ds_read_b128 v[156:159], v13 offset:49152
    buffer_load_dwordx4 a[48:51], v8, s[28:31], s50 offen offset:2048 sc1
    v_mfma_f32_16x16x32_bf16 v[40:43], v[164:167], a[8:11], v[40:43]
    v_mfma_f32_16x16x32_bf16 v[60:63], v[164:167], a[12:15], v[60:63]
    ds_read_b128 v[160:163], v13 offset:50176
    v_mfma_f32_16x16x32_bf16 v[44:47], v[168:171], a[8:11], v[44:47]
    v_mfma_f32_16x16x32_bf16 v[64:67], v[168:171], a[12:15], v[64:67]
    ds_read_b128 v[164:167], v13 offset:51200
    buffer_load_dwordx4 a[52:55], v8, s[28:31], s51 offen offset:2048 sc1
    v_mfma_f32_16x16x32_bf16 v[48:51], v[172:175], a[8:11], v[48:51]
    v_mfma_f32_16x16x32_bf16 v[68:71], v[172:175], a[12:15], v[68:71]
    s_barrier
    ds_read_b128 v[168:171], v14 offset:12288
    s_waitcnt vmcnt(13) lgkmcnt(6)
    v_mfma_f32_16x16x32_bf16 v[32:35], v[176:179], a[16:19], v[32:35]
    v_mfma_f32_16x16x32_bf16 v[52:55], v[176:179], a[20:23], v[52:55]
    ds_read_b128 v[172:175], v14 offset:13312
    buffer_load_dwordx4 a[56:59], v8, s[28:31], s50 offen offset:3072 sc1
    v_mfma_f32_16x16x32_bf16 v[36:39], v[180:183], a[16:19], v[36:39]
    v_mfma_f32_16x16x32_bf16 v[56:59], v[180:183], a[20:23], v[56:59]
    ds_read_b128 v[176:179], v14 offset:14336
    v_mfma_f32_16x16x32_bf16 v[40:43], v[136:139], a[16:19], v[40:43]
    v_mfma_f32_16x16x32_bf16 v[60:63], v[136:139], a[20:23], v[60:63]
    ds_read_b128 v[180:183], v14 offset:15360
    buffer_load_dwordx4 a[60:63], v8, s[28:31], s51 offen offset:3072 sc1
    v_mfma_f32_16x16x32_bf16 v[44:47], v[140:143], a[16:19], v[44:47]
    v_mfma_f32_16x16x32_bf16 v[64:67], v[140:143], a[20:23], v[64:67]
    ds_read_b128 v[136:139], v14 offset:16384
    v_mfma_f32_16x16x32_bf16 v[48:51], v[144:147], a[16:19], v[48:51]
    v_mfma_f32_16x16x32_bf16 v[68:71], v[144:147], a[20:23], v[68:71]
    ds_read_b128 v[140:143], v12 offset:0
    s_add_u32 s50, s50, 4096
    s_add_u32 s51, s51, 4096
    buffer_load_dwordx4 a[64:67], v8, s[28:31], s50 offen offset:0 sc1
    s_waitcnt vmcnt(9) lgkmcnt(6)
    v_mfma_f32_16x16x32_bf16 v[32:35], v[148:151], a[24:27], v[32:35]
    v_mfma_f32_16x16x32_bf16 v[52:55], v[148:151], a[28:31], v[52:55]
    ds_read_b128 v[144:147], v12 offset:1024
    v_mfma_f32_16x16x32_bf16 v[36:39], v[152:155], a[24:27], v[36:39]
    v_mfma_f32_16x16x32_bf16 v[56:59], v[152:155], a[28:31], v[56:59]
    ds_read_b128 v[148:151], v12 offset:2048
    buffer_load_dwordx4 a[68:71], v8, s[28:31], s51 offen offset:0 sc1
    v_mfma_f32_16x16x32_bf16 v[40:43], v[156:159], a[24:27], v[40:43]
    v_mfma_f32_16x16x32_bf16 v[60:63], v[156:159], a[28:31], v[60:63]
    ds_read_b128 v[152:155], v12 offset:3072
    v_mfma_f32_16x16x32_bf16 v[44:47], v[160:163], a[24:27], v[44:47]
    v_mfma_f32_16x16x32_bf16 v[64:67], v[160:163], a[28:31], v[64:67]
    ds_read_b128 v[156:159], v12 offset:4096
    buffer_load_dwordx4 a[72:75], v8, s[28:31], s50 offen offset:1024 sc1
    v_mfma_f32_16x16x32_bf16 v[48:51], v[164:167], a[24:27], v[48:51]
    v_mfma_f32_16x16x32_bf16 v[68:71], v[164:167], a[28:31], v[68:71]
    ds_read_b128 v[160:163], v12 offset:10240
    s_waitcnt vmcnt(9) lgkmcnt(6)
    v_mfma_f32_16x16x32_bf16 v[32:35], v[168:171], a[32:35], v[32:35]
    v_mfma_f32_16x16x32_bf16 v[52:55], v[168:171], a[36:39], v[52:55]
    ds_read_b128 v[164:167], v12 offset:11264
    buffer_load_dwordx4 a[76:79], v8, s[28:31], s51 offen offset:1024 sc1
    v_mfma_f32_16x16x32_bf16 v[36:39], v[172:175], a[32:35], v[36:39]
    v_mfma_f32_16x16x32_bf16 v[56:59], v[172:175], a[36:39], v[56:59]
    ds_read_b128 v[168:171], v12 offset:12288
    v_mfma_f32_16x16x32_bf16 v[40:43], v[176:179], a[32:35], v[40:43]
    v_mfma_f32_16x16x32_bf16 v[60:63], v[176:179], a[36:39], v[60:63]
    ds_read_b128 v[172:175], v12 offset:13312
    buffer_load_dwordx4 a[80:83], v8, s[28:31], s50 offen offset:2048 sc1
    v_mfma_f32_16x16x32_bf16 v[44:47], v[180:183], a[32:35], v[44:47]
    v_mfma_f32_16x16x32_bf16 v[64:67], v[180:183], a[36:39], v[64:67]
    ds_read_b128 v[176:179], v12 offset:14336
    v_mfma_f32_16x16x32_bf16 v[48:51], v[136:139], a[32:35], v[48:51]
    v_mfma_f32_16x16x32_bf16 v[68:71], v[136:139], a[36:39], v[68:71]
    buffer_load_dwordx4 a[84:87], v8, s[28:31], s51 offen offset:2048 sc1
    s_waitcnt vmcnt(10) lgkmcnt(5)
    v_mfma_f32_16x16x32_bf16 v[32:35], v[140:143], a[40:43], v[32:35]
    v_mfma_f32_16x16x32_bf16 v[52:55], v[140:143], a[44:47], v[52:55]
    v_mfma_f32_16x16x32_bf16 v[36:39], v[144:147], a[40:43], v[36:39]
    v_mfma_f32_16x16x32_bf16 v[56:59], v[144:147], a[44:47], v[56:59]
    buffer_load_dwordx4 a[88:91], v8, s[28:31], s50 offen offset:3072 sc1
    v_mfma_f32_16x16x32_bf16 v[40:43], v[148:151], a[40:43], v[40:43]
    v_mfma_f32_16x16x32_bf16 v[60:63], v[148:151], a[44:47], v[60:63]
    v_mfma_f32_16x16x32_bf16 v[44:47], v[152:155], a[40:43], v[44:47]
    v_mfma_f32_16x16x32_bf16 v[64:67], v[152:155], a[44:47], v[64:67]
    buffer_load_dwordx4 a[92:95], v8, s[28:31], s51 offen offset:3072 sc1
    v_mfma_f32_16x16x32_bf16 v[48:51], v[156:159], a[40:43], v[48:51]
    v_mfma_f32_16x16x32_bf16 v[68:71], v[156:159], a[44:47], v[68:71]
    s_waitcnt vmcnt(10) lgkmcnt(0)
    v_mfma_f32_16x16x32_bf16 v[32:35], v[160:163], a[48:51], v[32:35]
    v_mfma_f32_16x16x32_bf16 v[52:55], v[160:163], a[52:55], v[52:55]
    s_add_u32 s50, s50, 4096
    s_add_u32 s51, s51, 4096
    buffer_load_dwordx4 a[0:3], v8, s[28:31], s50 offen offset:0 sc1
    v_mfma_f32_16x16x32_bf16 v[36:39], v[164:167], a[48:51], v[36:39]
    v_mfma_f32_16x16x32_bf16 v[56:59], v[164:167], a[52:55], v[56:59]
    v_mfma_f32_16x16x32_bf16 v[40:43], v[168:171], a[48:51], v[40:43]
    v_mfma_f32_16x16x32_bf16 v[60:63], v[168:171], a[52:55], v[60:63]
    buffer_load_dwordx4 a[4:7], v8, s[28:31], s51 offen offset:0 sc1
    v_mfma_f32_16x16x32_bf16 v[44:47], v[172:175], a[48:51], v[44:47]
    v_mfma_f32_16x16x32_bf16 v[64:67], v[172:175], a[52:55], v[64:67]
    v_mfma_f32_16x16x32_bf16 v[48:51], v[176:179], a[48:51], v[48:51]
    v_mfma_f32_16x16x32_bf16 v[68:71], v[176:179], a[52:55], v[68:71]
    s_waitcnt vmcnt(10)
    v_mfma_f32_16x16x32_bf16 v[32:35], a[96:99], a[56:59], v[32:35]
    v_mfma_f32_16x16x32_bf16 v[52:55], a[96:99], a[60:63], v[52:55]
    v_mfma_f32_16x16x32_bf16 v[36:39], a[100:103], a[56:59], v[36:39]
    v_mfma_f32_16x16x32_bf16 v[56:59], a[100:103], a[60:63], v[56:59]
    buffer_load_dwordx4 a[8:11], v8, s[28:31], s50 offen offset:1024 sc1
    v_mfma_f32_16x16x32_bf16 v[40:43], a[104:107], a[56:59], v[40:43]
    v_mfma_f32_16x16x32_bf16 v[60:63], a[104:107], a[60:63], v[60:63]
    v_mfma_f32_16x16x32_bf16 v[44:47], a[108:111], a[56:59], v[44:47]
    v_mfma_f32_16x16x32_bf16 v[64:67], a[108:111], a[60:63], v[64:67]
    buffer_load_dwordx4 a[12:15], v8, s[28:31], s51 offen offset:1024 sc1
    v_mfma_f32_16x16x32_bf16 v[48:51], a[112:115], a[56:59], v[48:51]
    v_mfma_f32_16x16x32_bf16 v[68:71], a[112:115], a[60:63], v[68:71]
    s_waitcnt vmcnt(10)
    v_mfma_f32_16x16x32_bf16 v[32:35], a[116:119], a[64:67], v[32:35]
    v_mfma_f32_16x16x32_bf16 v[52:55], a[116:119], a[68:71], v[52:55]
    buffer_load_dwordx4 a[16:19], v8, s[28:31], s50 offen offset:2048 sc1
    v_mfma_f32_16x16x32_bf16 v[36:39], a[120:123], a[64:67], v[36:39]
    v_mfma_f32_16x16x32_bf16 v[56:59], a[120:123], a[68:71], v[56:59]
    v_mfma_f32_16x16x32_bf16 v[40:43], a[124:127], a[64:67], v[40:43]
    v_mfma_f32_16x16x32_bf16 v[60:63], a[124:127], a[68:71], v[60:63]
    buffer_load_dwordx4 a[20:23], v8, s[28:31], s51 offen offset:2048 sc1
    v_mfma_f32_16x16x32_bf16 v[44:47], a[128:131], a[64:67], v[44:47]
    v_mfma_f32_16x16x32_bf16 v[64:67], a[128:131], a[68:71], v[64:67]
    v_mfma_f32_16x16x32_bf16 v[48:51], a[132:135], a[64:67], v[48:51]
    v_mfma_f32_16x16x32_bf16 v[68:71], a[132:135], a[68:71], v[68:71]
    s_waitcnt vmcnt(10)
    v_mfma_f32_16x16x32_bf16 v[32:35], a[136:139], a[72:75], v[32:35]
    v_mfma_f32_16x16x32_bf16 v[52:55], a[136:139], a[76:79], v[52:55]
    v_mfma_f32_16x16x32_bf16 v[36:39], a[140:143], a[72:75], v[36:39]
    v_mfma_f32_16x16x32_bf16 v[56:59], a[140:143], a[76:79], v[56:59]
    v_mfma_f32_16x16x32_bf16 v[40:43], a[144:147], a[72:75], v[40:43]
    v_mfma_f32_16x16x32_bf16 v[60:63], a[144:147], a[76:79], v[60:63]
    v_mfma_f32_16x16x32_bf16 v[44:47], a[148:151], a[72:75], v[44:47]
    v_mfma_f32_16x16x32_bf16 v[64:67], a[148:151], a[76:79], v[64:67]
    v_mfma_f32_16x16x32_bf16 v[48:51], a[152:155], a[72:75], v[48:51]
    v_mfma_f32_16x16x32_bf16 v[68:71], a[152:155], a[76:79], v[68:71]
    s_waitcnt vmcnt(8)
    v_mfma_f32_16x16x32_bf16 v[32:35], a[156:159], a[80:83], v[32:35]
    v_mfma_f32_16x16x32_bf16 v[52:55], a[156:159], a[84:87], v[52:55]
    v_mfma_f32_16x16x32_bf16 v[36:39], a[160:163], a[80:83], v[36:39]
    v_mfma_f32_16x16x32_bf16 v[56:59], a[160:163], a[84:87], v[56:59]
    v_mfma_f32_16x16x32_bf16 v[40:43], a[164:167], a[80:83], v[40:43]
    v_mfma_f32_16x16x32_bf16 v[60:63], a[164:167], a[84:87], v[60:63]
    v_mfma_f32_16x16x32_bf16 v[44:47], a[168:171], a[80:83], v[44:47]
    v_mfma_f32_16x16x32_bf16 v[64:67], a[168:171], a[84:87], v[64:67]
    v_mfma_f32_16x16x32_bf16 v[48:51], a[172:175], a[80:83], v[48:51]
    v_mfma_f32_16x16x32_bf16 v[68:71], a[172:175], a[84:87], v[68:71]
    s_waitcnt vmcnt(6)
    v_mfma_f32_16x16x32_bf16 v[32:35], a[176:179], a[88:91], v[32:35]
    v_mfma_f32_16x16x32_bf16 v[52:55], a[176:179], a[92:95], v[52:55]
    v_mfma_f32_16x16x32_bf16 v[36:39], a[180:183], a[88:91], v[36:39]
    v_mfma_f32_16x16x32_bf16 v[56:59], a[180:183], a[92:95], v[56:59]
    v_mfma_f32_16x16x32_bf16 v[40:43], a[184:187], a[88:91], v[40:43]
    v_mfma_f32_16x16x32_bf16 v[60:63], a[184:187], a[92:95], v[60:63]
    v_mfma_f32_16x16x32_bf16 v[44:47], a[188:191], a[88:91], v[44:47]
    v_mfma_f32_16x16x32_bf16 v[64:67], a[188:191], a[92:95], v[64:67]
    v_mfma_f32_16x16x32_bf16 v[48:51], a[192:195], a[88:91], v[48:51]
    v_mfma_f32_16x16x32_bf16 v[68:71], a[192:195], a[92:95], v[68:71]
    s_waitcnt vmcnt(4)
    v_mfma_f32_16x16x32_bf16 v[32:35], a[196:199], a[0:3], v[32:35]
    v_mfma_f32_16x16x32_bf16 v[52:55], a[196:199], a[4:7], v[52:55]
    v_mfma_f32_16x16x32_bf16 v[36:39], a[200:203], a[0:3], v[36:39]
    v_mfma_f32_16x16x32_bf16 v[56:59], a[200:203], a[4:7], v[56:59]
    v_mfma_f32_16x16x32_bf16 v[40:43], a[204:207], a[0:3], v[40:43]
    v_mfma_f32_16x16x32_bf16 v[60:63], a[204:207], a[4:7], v[60:63]
    v_mfma_f32_16x16x32_bf16 v[44:47], a[208:211], a[0:3], v[44:47]
    v_mfma_f32_16x16x32_bf16 v[64:67], a[208:211], a[4:7], v[64:67]
    v_mfma_f32_16x16x32_bf16 v[48:51], a[212:215], a[0:3], v[48:51]
    v_mfma_f32_16x16x32_bf16 v[68:71], a[212:215], a[4:7], v[68:71]
    s_waitcnt vmcnt(2)
    v_mfma_f32_16x16x32_bf16 v[32:35], a[216:219], a[8:11], v[32:35]
    v_mfma_f32_16x16x32_bf16 v[52:55], a[216:219], a[12:15], v[52:55]
    v_mfma_f32_16x16x32_bf16 v[36:39], a[220:223], a[8:11], v[36:39]
    v_mfma_f32_16x16x32_bf16 v[56:59], a[220:223], a[12:15], v[56:59]
    v_mfma_f32_16x16x32_bf16 v[40:43], a[224:227], a[8:11], v[40:43]
    v_mfma_f32_16x16x32_bf16 v[60:63], a[224:227], a[12:15], v[60:63]
    v_mfma_f32_16x16x32_bf16 v[44:47], a[228:231], a[8:11], v[44:47]
    v_mfma_f32_16x16x32_bf16 v[64:67], a[228:231], a[12:15], v[64:67]
    v_mfma_f32_16x16x32_bf16 v[48:51], a[232:235], a[8:11], v[48:51]
    v_mfma_f32_16x16x32_bf16 v[68:71], a[232:235], a[12:15], v[68:71]
    s_waitcnt vmcnt(0)
    v_mfma_f32_16x16x32_bf16 v[32:35], a[236:239], a[16:19], v[32:35]
    v_mfma_f32_16x16x32_bf16 v[52:55], a[236:239], a[20:23], v[52:55]
    v_mfma_f32_16x16x32_bf16 v[36:39], a[240:243], a[16:19], v[36:39]
    v_mfma_f32_16x16x32_bf16 v[56:59], a[240:243], a[20:23], v[56:59]
    v_mfma_f32_16x16x32_bf16 v[40:43], a[244:247], a[16:19], v[40:43]
    v_mfma_f32_16x16x32_bf16 v[60:63], a[244:247], a[20:23], v[60:63]
    v_mfma_f32_16x16x32_bf16 v[44:47], a[248:251], a[16:19], v[44:47]
    v_mfma_f32_16x16x32_bf16 v[64:67], a[248:251], a[20:23], v[64:67]
    v_mfma_f32_16x16x32_bf16 v[48:51], a[252:255], a[16:19], v[48:51]
    v_mfma_f32_16x16x32_bf16 v[68:71], a[252:255], a[20:23], v[68:71]
    s_barrier
    s_nop 4
    ds_write_b128 v246, v[52:55] offset:0
    ds_write_b128 v246, v[56:59] offset:1024
    ds_write_b128 v246, v[60:63] offset:2048
    ds_write_b128 v246, v[64:67] offset:3072
    ds_write_b128 v246, v[68:71] offset:4096
    v_lshlrev_b32 v136, 16, v96
    v_and_b32 v137, 0xffff0000, v96
    v_lshlrev_b32 v138, 16, v97
    v_and_b32 v139, 0xffff0000, v97
    v_lshlrev_b32 v156, 16, v116
    v_and_b32 v157, 0xffff0000, v116
    v_lshlrev_b32 v158, 16, v117
    v_and_b32 v159, 0xffff0000, v117
    v_lshlrev_b32 v140, 16, v98
    v_and_b32 v141, 0xffff0000, v98
    v_lshlrev_b32 v142, 16, v99
    v_and_b32 v143, 0xffff0000, v99
    v_lshlrev_b32 v160, 16, v118
    v_and_b32 v161, 0xffff0000, v118
    v_lshlrev_b32 v162, 16, v119
    v_and_b32 v163, 0xffff0000, v119
    v_lshlrev_b32 v144, 16, v100
    v_and_b32 v145, 0xffff0000, v100
    v_lshlrev_b32 v146, 16, v101
    v_and_b32 v147, 0xffff0000, v101
    v_lshlrev_b32 v164, 16, v120
    v_and_b32 v165, 0xffff0000, v120
    v_lshlrev_b32 v166, 16, v121
    v_and_b32 v167, 0xffff0000, v121
    v_lshlrev_b32 v148, 16, v102
    v_and_b32 v149, 0xffff0000, v102
    v_lshlrev_b32 v150, 16, v103
    v_and_b32 v151, 0xffff0000, v103
    v_lshlrev_b32 v168, 16, v122
    v_and_b32 v169, 0xffff0000, v122
    v_lshlrev_b32 v170, 16, v123
    v_and_b32 v171, 0xffff0000, v123
    v_lshlrev_b32 v152, 16, v104
    v_and_b32 v153, 0xffff0000, v104
    v_lshlrev_b32 v154, 16, v105
    v_and_b32 v155, 0xffff0000, v105
    v_lshlrev_b32 v172, 16, v124
    v_and_b32 v173, 0xffff0000, v124
    v_lshlrev_b32 v174, 16, v125
    v_and_b32 v175, 0xffff0000, v125
    v_pk_add_f32 v[32:33], v[32:33], v[136:137]
    v_pk_add_f32 v[34:35], v[34:35], v[138:139]
    v_pk_add_f32 v[36:37], v[36:37], v[140:141]
    v_pk_add_f32 v[38:39], v[38:39], v[142:143]
    v_pk_add_f32 v[40:41], v[40:41], v[144:145]
    v_pk_add_f32 v[42:43], v[42:43], v[146:147]
    v_pk_add_f32 v[44:45], v[44:45], v[148:149]
    v_pk_add_f32 v[46:47], v[46:47], v[150:151]
    v_pk_add_f32 v[48:49], v[48:49], v[152:153]
    v_pk_add_f32 v[50:51], v[50:51], v[154:155]
    s_waitcnt lgkmcnt(0)
    s_barrier
    ds_read_b128 v[72:75], v247 offset:0
    ds_read_b128 v[76:79], v247 offset:1024
    ds_read_b128 v[80:83], v247 offset:2048
    ds_read_b128 v[84:87], v247 offset:3072
    ds_read_b128 v[88:91], v247 offset:4096
    s_waitcnt lgkmcnt(4)
    v_pk_add_f32 v[32:33], v[32:33], v[72:73]
    v_pk_add_f32 v[34:35], v[34:35], v[74:75]
    v_pk_fma_f32 v[32:33], v[32:33], v[204:205], v[156:157]
    v_pk_fma_f32 v[34:35], v[34:35], v[206:207], v[158:159]
    v_cvt_pk_bf16_f32 v180, v32, v33
    v_cvt_pk_bf16_f32 v181, v34, v35
    s_waitcnt lgkmcnt(3)
    v_pk_add_f32 v[36:37], v[36:37], v[76:77]
    v_pk_add_f32 v[38:39], v[38:39], v[78:79]
    v_pk_fma_f32 v[36:37], v[36:37], v[208:209], v[160:161]
    v_pk_fma_f32 v[38:39], v[38:39], v[210:211], v[162:163]
    v_cvt_pk_bf16_f32 v182, v36, v37
    v_cvt_pk_bf16_f32 v183, v38, v39
    s_waitcnt lgkmcnt(2)
    v_pk_add_f32 v[40:41], v[40:41], v[80:81]
    v_pk_add_f32 v[42:43], v[42:43], v[82:83]
    v_pk_fma_f32 v[40:41], v[40:41], v[212:213], v[164:165]
    v_pk_fma_f32 v[42:43], v[42:43], v[214:215], v[166:167]
    v_cvt_pk_bf16_f32 v184, v40, v41
    v_cvt_pk_bf16_f32 v185, v42, v43
    s_waitcnt lgkmcnt(1)
    v_pk_add_f32 v[44:45], v[44:45], v[84:85]
    v_pk_add_f32 v[46:47], v[46:47], v[86:87]
    v_pk_fma_f32 v[44:45], v[44:45], v[216:217], v[168:169]
    v_pk_fma_f32 v[46:47], v[46:47], v[218:219], v[170:171]
    v_cvt_pk_bf16_f32 v186, v44, v45
    v_cvt_pk_bf16_f32 v187, v46, v47
    s_waitcnt lgkmcnt(0)
    v_pk_add_f32 v[48:49], v[48:49], v[88:89]
    v_pk_add_f32 v[50:51], v[50:51], v[90:91]
    v_pk_fma_f32 v[48:49], v[48:49], v[220:221], v[172:173]
    v_pk_fma_f32 v[50:51], v[50:51], v[222:223], v[174:175]
    v_cvt_pk_bf16_f32 v188, v48, v49
    v_cvt_pk_bf16_f32 v189, v50, v51
    s_nop 1
    v_permlane16_swap_b32 v180, v182
    v_permlane16_swap_b32 v181, v183
    v_permlane16_swap_b32 v184, v186
    v_permlane16_swap_b32 v185, v187
    buffer_store_dwordx4 v[180:183], v231, s[32:35], s46 offen sc1
    buffer_store_dwordx4 v[184:187], v231, s[32:35], s46 offen offset:64 sc1
    buffer_store_dwordx2 v[188:189], v232, s[32:35], s49 offen sc1
    s_endpgm
chain_end:
    s_endpgm
.section .rodata,"a"
.p2align 6
.amdhsa_kernel prep_kernel
  .amdhsa_next_free_vgpr 256
  .amdhsa_next_free_sgpr 100
  .amdhsa_accum_offset 256
  .amdhsa_group_segment_fixed_size 0
  .amdhsa_kernarg_size 128
  .amdhsa_user_sgpr_count 2
  .amdhsa_user_sgpr_kernarg_segment_ptr 1
  .amdhsa_system_sgpr_workgroup_id_x 1
  .amdhsa_float_denorm_mode_32 3
.end_amdhsa_kernel
.p2align 6
.amdhsa_kernel chain_kernel
  .amdhsa_next_free_vgpr 512
  .amdhsa_next_free_sgpr 100
  .amdhsa_accum_offset 256
  .amdhsa_group_segment_fixed_size 0
  .amdhsa_kernarg_size 128
  .amdhsa_user_sgpr_count 2
  .amdhsa_user_sgpr_kernarg_segment_ptr 1
  .amdhsa_system_sgpr_workgroup_id_x 1
  .amdhsa_float_denorm_mode_32 3
.end_amdhsa_kernel
```

```asm
; @launch kernel=prep_kernel grid=(512,1,1) block=(512,1,1) lds=104512
; @launch kernel=chain_kernel grid=(256,1,1) block=(256,1,1) lds=163840
.amdgcn_target "amdgcn-amd-amdhsa--gfx950"
.text
.globl prep_kernel
.p2align 8
.type prep_kernel,@function
prep_kernel:
    s_cmp_ge_u32 s2, 512
    s_cbranch_scc1 prep_end
    s_load_dwordx4 s[4:7], s[0:1], 8
    s_load_dwordx2 s[8:9], s[0:1], 24
    s_load_dwordx2 s[10:11], s[0:1], 120
    s_load_dwordx8 s[12:19], s[0:1], 56
    s_load_dwordx2 s[60:61], s[0:1], 0
    s_load_dwordx2 s[62:63], s[0:1], 96
    s_load_dwordx2 s[52:53], s[0:1], 88
    s_load_dwordx2 s[54:55], s[0:1], 112
    s_load_dwordx4 s[56:59], s[0:1], 32
    s_memrealtime s[64:65]
    v_lshrrev_b32 v2, 6, v0
    v_and_b32 v1, 63, v0
    v_readfirstlane_b32 s20, v2
    s_waitcnt lgkmcnt(0)
    s_mov_b32 s28, s10
    s_mov_b32 s29, s11
    s_mov_b32 s30, 268435456
    s_mov_b32 s31, 0x00020000
    s_mov_b32 s48, s54
    s_mov_b32 s49, s55
    s_mov_b32 s50, 256
    s_mov_b32 s51, 0x00020000
    s_cmp_ge_u32 s2, 416
    s_cbranch_scc1 p_pack
    s_cmp_ge_u32 s2, 256
    s_cbranch_scc1 p_conv
    s_cmp_ge_u32 s2, 160
    s_cbranch_scc1 p_aux
    s_or_b32 s21, s2, s20
    s_cmp_lg_u32 s21, 0
    s_cbranch_scc1 prep_kernel_n01
    s_or_b32 s64, s64, 1
    v_mov_b32 v3, s64
    v_mov_b32 v4, 0
    s_mov_b64 exec, 1
    buffer_store_dword v3, v4, s[48:51], 0 offen sc1
    s_mov_b64 exec, -1
prep_kernel_n01:
    s_mov_b32 s45, s20
    s_mov_b32 s16, s4
    s_mov_b32 s17, s5
    s_mov_b32 s18, 2621440
    s_mov_b32 s19, 0x00020000
    s_mov_b32 s20, s6
    s_mov_b32 s21, s7
    s_mov_b32 s22, 2621440
    s_mov_b32 s23, 0x00020000
    s_mov_b32 s24, s8
    s_mov_b32 s25, s9
    s_mov_b32 s26, 5120
    s_mov_b32 s27, 0x00020000
    s_lshr_b32 s47, s45, 2
    s_lshl_b32 s46, s2, 1
    s_add_u32 s46, s46, s47
    v_and_b32 v0, 255, v0
    s_mul_i32 s32, s46, 52429
    s_lshr_b32 s32, s32, 19
    s_mul_i32 s33, s32, 10
    s_sub_u32 s33, s46, s33
    s_lshl_b32 s43, s47, 13
    v_and_b32 v1, 15, v0
    v_lshrrev_b32 v2, 4, v0
    s_lshl_b32 s34, s32, 6
    v_lshl_add_u32 v3, v2, 2, s34
    v_mul_u32_u24 v4, 1280, v3
    s_lshl_b32 s35, s33, 7
    v_lshl_add_u32 v5, v1, 3, s35
    v_add_u32 v4, v4, v5
    v_subrev_u32 v6, 3840, v4
    v_subrev_u32 v7, 2560, v4
    v_subrev_u32 v8, 1280, v4
    buffer_load_dwordx2 v[10:11], v6, s[16:19], 0 offen nt
    buffer_load_dwordx2 v[12:13], v7, s[16:19], 0 offen nt
    buffer_load_dwordx2 v[14:15], v8, s[16:19], 0 offen nt
    buffer_load_dwordx2 v[16:17], v4, s[16:19], 0 offen offset:0 nt
    buffer_load_dwordx2 v[18:19], v4, s[16:19], 0 offen offset:1280 nt
    buffer_load_dwordx2 v[20:21], v4, s[16:19], 0 offen offset:2560 nt
    buffer_load_dwordx2 v[22:23], v4, s[16:19], 0 offen offset:3840 nt
    v_lshlrev_b32 v100, 2, v5
    buffer_load_dwordx4 v[32:35], v100, s[24:27], 0 offen
    buffer_load_dwordx4 v[36:39], v100, s[24:27], 0 offen offset:16
    buffer_load_dwordx2 v[24:25], v4, s[20:23], 0 offen offset:0 nt
    buffer_load_dwordx2 v[26:27], v4, s[20:23], 0 offen offset:1280 nt
    buffer_load_dwordx2 v[28:29], v4, s[20:23], 0 offen offset:2560 nt
    buffer_load_dwordx2 v[30:31], v4, s[20:23], 0 offen offset:3840 nt
    v_lshlrev_b32 v100, 9, v1
    v_sub_u32 v101, 15, v2
    v_lshl_add_u32 v100, v101, 3, v100
    v_add_u32 v100, s43, v100
    v_lshrrev_b32 v101, 3, v0
    v_mul_u32_u24 v101, 4352, v101
    v_and_b32 v102, 7, v0
    v_lshl_add_u32 v103, v102, 4, v101
    v_lshlrev_b32 v104, 4, v0
    v_add_u32 v104, s43, v104
    s_mul_i32 s36, s33, 278528
    s_lshr_b32 s37, s32, 1
    s_mul_i32 s37, s37, 272
    s_add_u32 s36, s36, s37
    s_add_u32 s36, s36, 0
    s_and_b32 s37, s32, 1
    s_lshl_b32 s38, s37, 7
    s_sub_u32 s38, 128, s38
    s_add_u32 s38, s38, s36
    s_lshl_b32 s44, s33, 5
    s_add_u32 s44, s44, s32
    s_lshl_b32 s44, s44, 7
    s_add_u32 s44, s44, 29642752
    s_waitcnt vmcnt(4)
    v_mov_b32 v123, 0
    buffer_load_dword v122, v123, s[48:51], 0 offen sc1
    v_lshlrev_b32 v40, 16, v32
    v_and_b32 v44, 0xffff0000, v32
    v_lshlrev_b32 v48, 16, v33
    v_and_b32 v52, 0xffff0000, v33
    v_lshlrev_b32 v41, 16, v34
    v_and_b32 v45, 0xffff0000, v34
    v_lshlrev_b32 v49, 16, v35
    v_and_b32 v53, 0xffff0000, v35
    v_lshlrev_b32 v42, 16, v36
    v_and_b32 v46, 0xffff0000, v36
    v_lshlrev_b32 v50, 16, v37
    v_and_b32 v54, 0xffff0000, v37
    v_lshlrev_b32 v43, 16, v38
    v_and_b32 v47, 0xffff0000, v38
    v_lshlrev_b32 v51, 16, v39
    v_and_b32 v55, 0xffff0000, v39
    v_lshlrev_b32 v56, 16, v10
    v_and_b32 v57, 0xffff0000, v10
    v_lshlrev_b32 v58, 16, v11
    v_and_b32 v59, 0xffff0000, v11
    v_lshlrev_b32 v60, 16, v12
    v_and_b32 v61, 0xffff0000, v12
    v_lshlrev_b32 v62, 16, v13
    v_and_b32 v63, 0xffff0000, v13
    v_lshlrev_b32 v64, 16, v14
    v_and_b32 v65, 0xffff0000, v14
    v_lshlrev_b32 v66, 16, v15
    v_and_b32 v67, 0xffff0000, v15
    v_lshlrev_b32 v68, 16, v16
    v_and_b32 v69, 0xffff0000, v16
    v_lshlrev_b32 v70, 16, v17
    v_and_b32 v71, 0xffff0000, v17
    v_lshlrev_b32 v72, 16, v18
    v_and_b32 v73, 0xffff0000, v18
    v_lshlrev_b32 v74, 16, v19
    v_and_b32 v75, 0xffff0000, v19
    v_lshlrev_b32 v76, 16, v20
    v_and_b32 v77, 0xffff0000, v20
    v_lshlrev_b32 v78, 16, v21
    v_and_b32 v79, 0xffff0000, v21
    v_lshlrev_b32 v80, 16, v22
    v_and_b32 v81, 0xffff0000, v22
    v_lshlrev_b32 v82, 16, v23
    v_and_b32 v83, 0xffff0000, v23
    v_pk_mul_f32 v[84:85], v[56:57], v[52:53]
    v_pk_mul_f32 v[86:87], v[58:59], v[54:55]
    v_pk_mul_f32 v[88:89], v[60:61], v[52:53]
    v_pk_mul_f32 v[90:91], v[62:63], v[54:55]
    v_pk_mul_f32 v[92:93], v[64:65], v[52:53]
    v_pk_mul_f32 v[94:95], v[66:67], v[54:55]
    v_pk_mul_f32 v[96:97], v[68:69], v[52:53]
    v_pk_mul_f32 v[98:99], v[70:71], v[54:55]
    v_pk_fma_f32 v[84:85], v[60:61], v[48:49], v[84:85]
    v_pk_fma_f32 v[86:87], v[62:63], v[50:51], v[86:87]
    v_pk_fma_f32 v[88:89], v[64:65], v[48:49], v[88:89]
    v_pk_fma_f32 v[90:91], v[66:67], v[50:51], v[90:91]
    v_pk_fma_f32 v[92:93], v[68:69], v[48:49], v[92:93]
    v_pk_fma_f32 v[94:95], v[70:71], v[50:51], v[94:95]
    v_pk_fma_f32 v[96:97], v[72:73], v[48:49], v[96:97]
    v_pk_fma_f32 v[98:99], v[74:75], v[50:51], v[98:99]
    v_pk_fma_f32 v[84:85], v[64:65], v[44:45], v[84:85]
    v_pk_fma_f32 v[86:87], v[66:67], v[46:47], v[86:87]
    v_pk_fma_f32 v[88:89], v[68:69], v[44:45], v[88:89]
    v_pk_fma_f32 v[90:91], v[70:71], v[46:47], v[90:91]
    v_pk_fma_f32 v[92:93], v[72:73], v[44:45], v[92:93]
    v_pk_fma_f32 v[94:95], v[74:75], v[46:47], v[94:95]
    v_pk_fma_f32 v[96:97], v[76:77], v[44:45], v[96:97]
    v_pk_fma_f32 v[98:99], v[78:79], v[46:47], v[98:99]
    v_pk_fma_f32 v[84:85], v[68:69], v[40:41], v[84:85]
    v_pk_fma_f32 v[86:87], v[70:71], v[42:43], v[86:87]
    v_pk_fma_f32 v[88:89], v[72:73], v[40:41], v[88:89]
    v_pk_fma_f32 v[90:91], v[74:75], v[42:43], v[90:91]
    v_pk_fma_f32 v[92:93], v[76:77], v[40:41], v[92:93]
    v_pk_fma_f32 v[94:95], v[78:79], v[42:43], v[94:95]
    v_pk_fma_f32 v[96:97], v[80:81], v[40:41], v[96:97]
    v_pk_fma_f32 v[98:99], v[82:83], v[42:43], v[98:99]
    v_cvt_pk_bf16_f32 v56, v84, v85
    v_cvt_pk_bf16_f32 v57, v86, v87
    v_cvt_pk_bf16_f32 v58, v88, v89
    v_cvt_pk_bf16_f32 v59, v90, v91
    v_cvt_pk_bf16_f32 v60, v92, v93
    v_cvt_pk_bf16_f32 v61, v94, v95
    v_cvt_pk_bf16_f32 v62, v96, v97
    v_cvt_pk_bf16_f32 v63, v98, v99
    s_waitcnt vmcnt(1)
    v_lshlrev_b32 v84, 16, v56
    v_and_b32 v85, 0xffff0000, v56
    v_lshlrev_b32 v86, 16, v57
    v_and_b32 v87, 0xffff0000, v57
    v_lshlrev_b32 v88, 16, v58
    v_and_b32 v89, 0xffff0000, v58
    v_lshlrev_b32 v90, 16, v59
    v_and_b32 v91, 0xffff0000, v59
    v_lshlrev_b32 v92, 16, v60
    v_and_b32 v93, 0xffff0000, v60
    v_lshlrev_b32 v94, 16, v61
    v_and_b32 v95, 0xffff0000, v61
    v_lshlrev_b32 v96, 16, v62
    v_and_b32 v97, 0xffff0000, v62
    v_lshlrev_b32 v98, 16, v63
    v_and_b32 v99, 0xffff0000, v63
    v_lshlrev_b32 v64, 16, v24
    v_and_b32 v65, 0xffff0000, v24
    v_pk_mul_f32 v[84:85], v[84:85], v[64:65]
    v_lshlrev_b32 v66, 16, v25
    v_and_b32 v67, 0xffff0000, v25
    v_pk_mul_f32 v[86:87], v[86:87], v[66:67]
    v_lshlrev_b32 v68, 16, v26
    v_and_b32 v69, 0xffff0000, v26
    v_pk_mul_f32 v[88:89], v[88:89], v[68:69]
    v_lshlrev_b32 v70, 16, v27
    v_and_b32 v71, 0xffff0000, v27
    v_pk_mul_f32 v[90:91], v[90:91], v[70:71]
    v_lshlrev_b32 v64, 16, v28
    v_and_b32 v65, 0xffff0000, v28
    v_pk_mul_f32 v[92:93], v[92:93], v[64:65]
    v_lshlrev_b32 v66, 16, v29
    v_and_b32 v67, 0xffff0000, v29
    v_pk_mul_f32 v[94:95], v[94:95], v[66:67]
    v_lshlrev_b32 v68, 16, v30
    v_and_b32 v69, 0xffff0000, v30
    v_pk_mul_f32 v[96:97], v[96:97], v[68:69]
    v_lshlrev_b32 v70, 16, v31
    v_and_b32 v71, 0xffff0000, v31
    v_pk_mul_f32 v[98:99], v[98:99], v[70:71]
    v_cvt_pk_bf16_f32 v64, v96, v92
    v_cvt_pk_bf16_f32 v65, v88, v84
    v_cvt_pk_bf16_f32 v66, v97, v93
    v_cvt_pk_bf16_f32 v67, v89, v85
    v_cvt_pk_bf16_f32 v68, v98, v94
    v_cvt_pk_bf16_f32 v69, v90, v86
    v_cvt_pk_bf16_f32 v70, v99, v95
    v_cvt_pk_bf16_f32 v71, v91, v87
    ds_write_b64 v100, v[64:65] offset:0
    ds_write_b64 v100, v[66:67] offset:128
    ds_write_b64 v100, v[68:69] offset:256
    ds_write_b64 v100, v[70:71] offset:384
    s_waitcnt lgkmcnt(0)
    s_barrier
    ds_read_b128 v[10:13], v104 offset:0
    ds_read_b128 v[14:17], v104 offset:4096
    s_waitcnt lgkmcnt(1)
    buffer_store_dwordx4 v[10:13], v103, s[28:31], s38 offen sc1
    s_add_u32 s38, s38, 139264
    s_waitcnt lgkmcnt(0)
    buffer_store_dwordx4 v[14:17], v103, s[28:31], s38 offen sc1
    s_add_u32 s38, s38, 139264
    v_cmp_eq_u32 vcc, 0, v102
    s_and_saveexec_b64 s[66:67], vcc
    s_cmp_eq_u32 s37, 0
    s_cbranch_scc1 prep_kernel_L2
    s_cmp_eq_u32 s32, 31
    s_cbranch_scc1 prep_kernel_L3
    buffer_store_dwordx4 v[10:13], v101, s[28:31], s36 offen offset:528 sc1
    s_add_u32 s36, s36, 139264
    buffer_store_dwordx4 v[14:17], v101, s[28:31], s36 offen offset:528 sc1
    s_add_u32 s36, s36, 139264
    s_branch prep_kernel_L3
prep_kernel_L2:
    s_cmp_lg_u32 s32, 0
    s_cbranch_scc1 prep_kernel_L3
    v_mov_b32 v108, 0
    v_mov_b32 v109, 0
    v_mov_b32 v110, 0
    v_mov_b32 v111, 0
    buffer_store_dwordx4 v[108:111], v101, s[28:31], s36 offen offset:256 sc1
    s_add_u32 s36, s36, 139264
    buffer_store_dwordx4 v[108:111], v101, s[28:31], s36 offen offset:256 sc1
    s_add_u32 s36, s36, 139264
prep_kernel_L3:
    s_mov_b64 exec, -1
    s_waitcnt vmcnt(0)
    s_barrier
    s_and_b32 s45, s45, 3
    s_cmp_lg_u32 s45, 0
    s_cbranch_scc1 prep_end
    s_mov_b32 s47, 0
prep_kernel_nn4:
    v_readfirstlane_b32 s46, v122
    s_add_u32 s47, s47, 1
    s_cmp_lg_u32 s46, 0
    s_cbranch_scc1 prep_kernel_nd5
    s_cmp_ge_u32 s47, 200000
    s_cbranch_scc1 prep_kernel_nd5
    buffer_load_dword v122, v123, s[48:51], 0 offen sc1
    s_waitcnt vmcnt(0)
    s_branch prep_kernel_nn4
prep_kernel_nd5:
    v_mov_b32 v124, s46
    v_mov_b32 v125, 0
    s_mov_b64 exec, 1
    buffer_store_dword v124, v125, s[28:31], s44 offen sc1
    s_endpgm
prep_end:
    s_endpgm
p_aux:
    v_mov_b32 v251, 0
    buffer_load_dword v250, v251, s[48:51], 0 offen sc1
    s_waitcnt vmcnt(0)
    s_mov_b32 s47, 0
prep_kernel_nn6:
    v_readfirstlane_b32 s46, v250
    s_add_u32 s47, s47, 1
    s_cmp_lg_u32 s46, 0
    s_cbranch_scc1 prep_kernel_nd7
    s_cmp_ge_u32 s47, 200000
    s_cbranch_scc1 prep_kernel_nd7
    buffer_load_dword v250, v251, s[48:51], 0 offen sc1
    s_waitcnt vmcnt(0)
    s_branch prep_kernel_nn6
prep_kernel_nd7:
    s_sub_u32 s21, s2, 160
    s_cmp_ge_u32 s20, 6
    s_cbranch_scc1 prep_end
    s_cmp_ge_u32 s20, 3
    s_cbranch_scc1 p_misc
    s_cmp_eq_u32 s20, 0
    s_cbranch_scc1 p_st
    s_cmp_eq_u32 s20, 2
    s_cbranch_scc1 p_aux2
    s_add_u32 s21, s21, 96
    s_cmp_lt_u32 s21, 128
    s_cbranch_scc1 p_st
    s_sub_u32 s21, s21, 128
    s_branch p_mod
p_aux2:
    s_cmp_ge_u32 s21, 56
    s_cbranch_scc1 prep_end
    s_add_u32 s21, s21, 64
p_mod:
    s_lshr_b32 s32, s21, 2
    s_and_b32 s33, s21, 3
    v_lshrrev_b32 v4, 3, v1
    v_and_b32 v3, 7, v1
    s_mul_i32 s34, s33, 160
    v_add_u32 v4, s34, v4
    v_lshlrev_b32 v5, 1, v4
    v_mul_u32_u24 v6, 7680, v4
    s_lshl_b32 s36, s32, 7
    v_lshl_add_u32 v7, v3, 4, s36
    v_add_u32 v6, v6, v7
    s_mov_b32 s16, s52
    s_mov_b32 s17, s53
    s_mov_b32 s18, 1280
    s_mov_b32 s19, 0x00020000
    s_mov_b32 s24, s62
    s_mov_b32 s25, s63
    s_mov_b32 s26, 4915200
    s_mov_b32 s27, 0x00020000
    s_mul_i32 s35, s33, 320
    v_lshlrev_b32 v5, 3, v1
    buffer_load_dwordx2 v[30:31], v5, s[16:19], s35 offen
    s_mov_b32 s37, 0
    buffer_load_dwordx4 v[32:35], v6, s[24:27], s37 offen nt
    s_add_u32 s37, s37, 61440
    buffer_load_dwordx4 v[36:39], v6, s[24:27], s37 offen nt
    s_add_u32 s37, s37, 61440
    buffer_load_dwordx4 v[40:43], v6, s[24:27], s37 offen nt
    s_add_u32 s37, s37, 61440
    buffer_load_dwordx4 v[44:47], v6, s[24:27], s37 offen nt
    s_add_u32 s37, s37, 61440
    buffer_load_dwordx4 v[48:51], v6, s[24:27], s37 offen nt
    s_add_u32 s37, s37, 61440
    buffer_load_dwordx4 v[52:55], v6, s[24:27], s37 offen nt
    s_add_u32 s37, s37, 61440
    buffer_load_dwordx4 v[56:59], v6, s[24:27], s37 offen nt
    s_add_u32 s37, s37, 61440
    buffer_load_dwordx4 v[60:63], v6, s[24:27], s37 offen nt
    s_add_u32 s37, s37, 61440
    buffer_load_dwordx4 v[64:67], v6, s[24:27], s37 offen nt
    s_add_u32 s37, s37, 61440
    buffer_load_dwordx4 v[68:71], v6, s[24:27], s37 offen nt
    s_add_u32 s37, s37, 61440
    buffer_load_dwordx4 v[72:75], v6, s[24:27], s37 offen nt
    s_add_u32 s37, s37, 61440
    buffer_load_dwordx4 v[76:79], v6, s[24:27], s37 offen nt
    s_add_u32 s37, s37, 61440
    buffer_load_dwordx4 v[80:83], v6, s[24:27], s37 offen nt
    s_add_u32 s37, s37, 61440
    buffer_load_dwordx4 v[84:87], v6, s[24:27], s37 offen nt
    s_add_u32 s37, s37, 61440
    buffer_load_dwordx4 v[88:91], v6, s[24:27], s37 offen nt
    s_add_u32 s37, s37, 61440
    buffer_load_dwordx4 v[92:95], v6, s[24:27], s37 offen nt
    s_add_u32 s37, s37, 61440
    buffer_load_dwordx4 v[96:99], v6, s[24:27], s37 offen nt
    s_add_u32 s37, s37, 61440
    buffer_load_dwordx4 v[100:103], v6, s[24:27], s37 offen nt
    s_add_u32 s37, s37, 61440
    buffer_load_dwordx4 v[104:107], v6, s[24:27], s37 offen nt
    s_add_u32 s37, s37, 61440
    buffer_load_dwordx4 v[108:111], v6, s[24:27], s37 offen nt
    s_mul_i32 s35, s20, 13824
    v_lshlrev_b32 v5, 4, v1
    v_add_u32 v5, s35, v5
    v_lshrrev_b32 v29, 3, v1
    v_lshlrev_b32 v29, 2, v29
    v_add_u32 v29, s35, v29
    s_waitcnt vmcnt(20)
    v_lshlrev_b32 v8, 16, v30
    v_and_b32 v9, 0xffff0000, v30
    v_lshlrev_b32 v10, 16, v31
    v_and_b32 v11, 0xffff0000, v31
    v_mul_f32 v120, 0xbfb8aa3b, v8
    v_mul_f32 v121, 0xbfb8aa3b, v9
    v_mul_f32 v122, 0xbfb8aa3b, v10
    v_mul_f32 v123, 0xbfb8aa3b, v11
    v_exp_f32 v120, v120
    v_exp_f32 v121, v121
    v_exp_f32 v122, v122
    v_exp_f32 v123, v123
    v_add_f32 v120, 1.0, v120
    v_add_f32 v121, 1.0, v121
    v_add_f32 v122, 1.0, v122
    v_add_f32 v123, 1.0, v123
    v_rcp_f32 v120, v120
    v_rcp_f32 v121, v121
    v_rcp_f32 v122, v122
    v_rcp_f32 v123, v123
    s_nop 0
    v_mul_f32 v8, v8, v120
    v_mul_f32 v9, v9, v121
    v_mul_f32 v10, v10, v122
    v_mul_f32 v11, v11, v123
    v_cvt_pk_bf16_f32 v120, v8, v9
    v_lshlrev_b32 v8, 16, v120
    v_and_b32 v9, 0xffff0000, v120
    v_cvt_pk_bf16_f32 v120, v10, v11
    v_lshlrev_b32 v10, 16, v120
    v_and_b32 v11, 0xffff0000, v120
    ds_write_b128 v5, v[8:11]
    s_waitcnt lgkmcnt(0)
    ds_read_b32 v8, v29 offset:0
    ds_read_b32 v9, v29 offset:32
    ds_read_b32 v10, v29 offset:64
    ds_read_b32 v11, v29 offset:96
    ds_read_b32 v12, v29 offset:128
    ds_read_b32 v13, v29 offset:160
    ds_read_b32 v14, v29 offset:192
    ds_read_b32 v15, v29 offset:224
    ds_read_b32 v16, v29 offset:256
    ds_read_b32 v17, v29 offset:288
    ds_read_b32 v18, v29 offset:320
    ds_read_b32 v19, v29 offset:352
    ds_read_b32 v20, v29 offset:384
    ds_read_b32 v21, v29 offset:416
    ds_read_b32 v22, v29 offset:448
    ds_read_b32 v23, v29 offset:480
    ds_read_b32 v24, v29 offset:512
    ds_read_b32 v25, v29 offset:544
    ds_read_b32 v26, v29 offset:576
    ds_read_b32 v27, v29 offset:608
    s_waitcnt lgkmcnt(0)
    v_mov_b32 v112, 0
    v_mov_b32 v113, 0
    v_mov_b32 v114, 0
    v_mov_b32 v115, 0
    v_mov_b32 v116, 0
    v_mov_b32 v117, 0
    v_mov_b32 v118, 0
    v_mov_b32 v119, 0
    s_waitcnt vmcnt(19)
    v_lshlrev_b32 v120, 16, v32
    v_and_b32 v121, 0xffff0000, v32
    v_lshlrev_b32 v122, 16, v33
    v_and_b32 v123, 0xffff0000, v33
    v_lshlrev_b32 v124, 16, v34
    v_and_b32 v125, 0xffff0000, v34
    v_lshlrev_b32 v126, 16, v35
    v_and_b32 v127, 0xffff0000, v35
    v_pk_fma_f32 v[112:113], v[120:121], v[8:9], v[112:113] op_sel:[0,0,0] op_sel_hi:[1,0,1]
    v_pk_fma_f32 v[114:115], v[122:123], v[8:9], v[114:115] op_sel:[0,0,0] op_sel_hi:[1,0,1]
    v_pk_fma_f32 v[116:117], v[124:125], v[8:9], v[116:117] op_sel:[0,0,0] op_sel_hi:[1,0,1]
    v_pk_fma_f32 v[118:119], v[126:127], v[8:9], v[118:119] op_sel:[0,0,0] op_sel_hi:[1,0,1]
    s_waitcnt vmcnt(18)
    v_lshlrev_b32 v120, 16, v36
    v_and_b32 v121, 0xffff0000, v36
    v_lshlrev_b32 v122, 16, v37
    v_and_b32 v123, 0xffff0000, v37
    v_lshlrev_b32 v124, 16, v38
    v_and_b32 v125, 0xffff0000, v38
    v_lshlrev_b32 v126, 16, v39
    v_and_b32 v127, 0xffff0000, v39
    v_pk_fma_f32 v[112:113], v[120:121], v[8:9], v[112:113] op_sel:[0,1,0] op_sel_hi:[1,1,1]
    v_pk_fma_f32 v[114:115], v[122:123], v[8:9], v[114:115] op_sel:[0,1,0] op_sel_hi:[1,1,1]
    v_pk_fma_f32 v[116:117], v[124:125], v[8:9], v[116:117] op_sel:[0,1,0] op_sel_hi:[1,1,1]
    v_pk_fma_f32 v[118:119], v[126:127], v[8:9], v[118:119] op_sel:[0,1,0] op_sel_hi:[1,1,1]
    s_waitcnt vmcnt(17)
    v_lshlrev_b32 v120, 16, v40
    v_and_b32 v121, 0xffff0000, v40
    v_lshlrev_b32 v122, 16, v41
    v_and_b32 v123, 0xffff0000, v41
    v_lshlrev_b32 v124, 16, v42
    v_and_b32 v125, 0xffff0000, v42
    v_lshlrev_b32 v126, 16, v43
    v_and_b32 v127, 0xffff0000, v43
    v_pk_fma_f32 v[112:113], v[120:121], v[10:11], v[112:113] op_sel:[0,0,0] op_sel_hi:[1,0,1]
    v_pk_fma_f32 v[114:115], v[122:123], v[10:11], v[114:115] op_sel:[0,0,0] op_sel_hi:[1,0,1]
    v_pk_fma_f32 v[116:117], v[124:125], v[10:11], v[116:117] op_sel:[0,0,0] op_sel_hi:[1,0,1]
    v_pk_fma_f32 v[118:119], v[126:127], v[10:11], v[118:119] op_sel:[0,0,0] op_sel_hi:[1,0,1]
    s_waitcnt vmcnt(16)
    v_lshlrev_b32 v120, 16, v44
    v_and_b32 v121, 0xffff0000, v44
    v_lshlrev_b32 v122, 16, v45
    v_and_b32 v123, 0xffff0000, v45
    v_lshlrev_b32 v124, 16, v46
    v_and_b32 v125, 0xffff0000, v46
    v_lshlrev_b32 v126, 16, v47
    v_and_b32 v127, 0xffff0000, v47
    v_pk_fma_f32 v[112:113], v[120:121], v[10:11], v[112:113] op_sel:[0,1,0] op_sel_hi:[1,1,1]
    v_pk_fma_f32 v[114:115], v[122:123], v[10:11], v[114:115] op_sel:[0,1,0] op_sel_hi:[1,1,1]
    v_pk_fma_f32 v[116:117], v[124:125], v[10:11], v[116:117] op_sel:[0,1,0] op_sel_hi:[1,1,1]
    v_pk_fma_f32 v[118:119], v[126:127], v[10:11], v[118:119] op_sel:[0,1,0] op_sel_hi:[1,1,1]
    s_waitcnt vmcnt(15)
    v_lshlrev_b32 v120, 16, v48
    v_and_b32 v121, 0xffff0000, v48
    v_lshlrev_b32 v122, 16, v49
    v_and_b32 v123, 0xffff0000, v49
    v_lshlrev_b32 v124, 16, v50
    v_and_b32 v125, 0xffff0000, v50
    v_lshlrev_b32 v126, 16, v51
    v_and_b32 v127, 0xffff0000, v51
    v_pk_fma_f32 v[112:113], v[120:121], v[12:13], v[112:113] op_sel:[0,0,0] op_sel_hi:[1,0,1]
    v_pk_fma_f32 v[114:115], v[122:123], v[12:13], v[114:115] op_sel:[0,0,0] op_sel_hi:[1,0,1]
    v_pk_fma_f32 v[116:117], v[124:125], v[12:13], v[116:117] op_sel:[0,0,0] op_sel_hi:[1,0,1]
    v_pk_fma_f32 v[118:119], v[126:127], v[12:13], v[118:119] op_sel:[0,0,0] op_sel_hi:[1,0,1]
    s_waitcnt vmcnt(14)
    v_lshlrev_b32 v120, 16, v52
    v_and_b32 v121, 0xffff0000, v52
    v_lshlrev_b32 v122, 16, v53
    v_and_b32 v123, 0xffff0000, v53
    v_lshlrev_b32 v124, 16, v54
    v_and_b32 v125, 0xffff0000, v54
    v_lshlrev_b32 v126, 16, v55
    v_and_b32 v127, 0xffff0000, v55
    v_pk_fma_f32 v[112:113], v[120:121], v[12:13], v[112:113] op_sel:[0,1,0] op_sel_hi:[1,1,1]
    v_pk_fma_f32 v[114:115], v[122:123], v[12:13], v[114:115] op_sel:[0,1,0] op_sel_hi:[1,1,1]
    v_pk_fma_f32 v[116:117], v[124:125], v[12:13], v[116:117] op_sel:[0,1,0] op_sel_hi:[1,1,1]
    v_pk_fma_f32 v[118:119], v[126:127], v[12:13], v[118:119] op_sel:[0,1,0] op_sel_hi:[1,1,1]
    s_waitcnt vmcnt(13)
    v_lshlrev_b32 v120, 16, v56
    v_and_b32 v121, 0xffff0000, v56
    v_lshlrev_b32 v122, 16, v57
    v_and_b32 v123, 0xffff0000, v57
    v_lshlrev_b32 v124, 16, v58
    v_and_b32 v125, 0xffff0000, v58
    v_lshlrev_b32 v126, 16, v59
    v_and_b32 v127, 0xffff0000, v59
    v_pk_fma_f32 v[112:113], v[120:121], v[14:15], v[112:113] op_sel:[0,0,0] op_sel_hi:[1,0,1]
    v_pk_fma_f32 v[114:115], v[122:123], v[14:15], v[114:115] op_sel:[0,0,0] op_sel_hi:[1,0,1]
    v_pk_fma_f32 v[116:117], v[124:125], v[14:15], v[116:117] op_sel:[0,0,0] op_sel_hi:[1,0,1]
    v_pk_fma_f32 v[118:119], v[126:127], v[14:15], v[118:119] op_sel:[0,0,0] op_sel_hi:[1,0,1]
    s_waitcnt vmcnt(12)
    v_lshlrev_b32 v120, 16, v60
    v_and_b32 v121, 0xffff0000, v60
    v_lshlrev_b32 v122, 16, v61
    v_and_b32 v123, 0xffff0000, v61
    v_lshlrev_b32 v124, 16, v62
    v_and_b32 v125, 0xffff0000, v62
    v_lshlrev_b32 v126, 16, v63
    v_and_b32 v127, 0xffff0000, v63
    v_pk_fma_f32 v[112:113], v[120:121], v[14:15], v[112:113] op_sel:[0,1,0] op_sel_hi:[1,1,1]
    v_pk_fma_f32 v[114:115], v[122:123], v[14:15], v[114:115] op_sel:[0,1,0] op_sel_hi:[1,1,1]
    v_pk_fma_f32 v[116:117], v[124:125], v[14:15], v[116:117] op_sel:[0,1,0] op_sel_hi:[1,1,1]
    v_pk_fma_f32 v[118:119], v[126:127], v[14:15], v[118:119] op_sel:[0,1,0] op_sel_hi:[1,1,1]
    s_waitcnt vmcnt(11)
    v_lshlrev_b32 v120, 16, v64
    v_and_b32 v121, 0xffff0000, v64
    v_lshlrev_b32 v122, 16, v65
    v_and_b32 v123, 0xffff0000, v65
    v_lshlrev_b32 v124, 16, v66
    v_and_b32 v125, 0xffff0000, v66
    v_lshlrev_b32 v126, 16, v67
    v_and_b32 v127, 0xffff0000, v67
    v_pk_fma_f32 v[112:113], v[120:121], v[16:17], v[112:113] op_sel:[0,0,0] op_sel_hi:[1,0,1]
    v_pk_fma_f32 v[114:115], v[122:123], v[16:17], v[114:115] op_sel:[0,0,0] op_sel_hi:[1,0,1]
    v_pk_fma_f32 v[116:117], v[124:125], v[16:17], v[116:117] op_sel:[0,0,0] op_sel_hi:[1,0,1]
    v_pk_fma_f32 v[118:119], v[126:127], v[16:17], v[118:119] op_sel:[0,0,0] op_sel_hi:[1,0,1]
    s_waitcnt vmcnt(10)
    v_lshlrev_b32 v120, 16, v68
    v_and_b32 v121, 0xffff0000, v68
    v_lshlrev_b32 v122, 16, v69
    v_and_b32 v123, 0xffff0000, v69
    v_lshlrev_b32 v124, 16, v70
    v_and_b32 v125, 0xffff0000, v70
    v_lshlrev_b32 v126, 16, v71
    v_and_b32 v127, 0xffff0000, v71
    v_pk_fma_f32 v[112:113], v[120:121], v[16:17], v[112:113] op_sel:[0,1,0] op_sel_hi:[1,1,1]
    v_pk_fma_f32 v[114:115], v[122:123], v[16:17], v[114:115] op_sel:[0,1,0] op_sel_hi:[1,1,1]
    v_pk_fma_f32 v[116:117], v[124:125], v[16:17], v[116:117] op_sel:[0,1,0] op_sel_hi:[1,1,1]
    v_pk_fma_f32 v[118:119], v[126:127], v[16:17], v[118:119] op_sel:[0,1,0] op_sel_hi:[1,1,1]
    s_waitcnt vmcnt(9)
    v_lshlrev_b32 v120, 16, v72
    v_and_b32 v121, 0xffff0000, v72
    v_lshlrev_b32 v122, 16, v73
    v_and_b32 v123, 0xffff0000, v73
    v_lshlrev_b32 v124, 16, v74
    v_and_b32 v125, 0xffff0000, v74
    v_lshlrev_b32 v126, 16, v75
    v_and_b32 v127, 0xffff0000, v75
    v_pk_fma_f32 v[112:113], v[120:121], v[18:19], v[112:113] op_sel:[0,0,0] op_sel_hi:[1,0,1]
    v_pk_fma_f32 v[114:115], v[122:123], v[18:19], v[114:115] op_sel:[0,0,0] op_sel_hi:[1,0,1]
    v_pk_fma_f32 v[116:117], v[124:125], v[18:19], v[116:117] op_sel:[0,0,0] op_sel_hi:[1,0,1]
    v_pk_fma_f32 v[118:119], v[126:127], v[18:19], v[118:119] op_sel:[0,0,0] op_sel_hi:[1,0,1]
    s_waitcnt vmcnt(8)
    v_lshlrev_b32 v120, 16, v76
    v_and_b32 v121, 0xffff0000, v76
    v_lshlrev_b32 v122, 16, v77
    v_and_b32 v123, 0xffff0000, v77
    v_lshlrev_b32 v124, 16, v78
    v_and_b32 v125, 0xffff0000, v78
    v_lshlrev_b32 v126, 16, v79
    v_and_b32 v127, 0xffff0000, v79
    v_pk_fma_f32 v[112:113], v[120:121], v[18:19], v[112:113] op_sel:[0,1,0] op_sel_hi:[1,1,1]
    v_pk_fma_f32 v[114:115], v[122:123], v[18:19], v[114:115] op_sel:[0,1,0] op_sel_hi:[1,1,1]
    v_pk_fma_f32 v[116:117], v[124:125], v[18:19], v[116:117] op_sel:[0,1,0] op_sel_hi:[1,1,1]
    v_pk_fma_f32 v[118:119], v[126:127], v[18:19], v[118:119] op_sel:[0,1,0] op_sel_hi:[1,1,1]
    s_waitcnt vmcnt(7)
    v_lshlrev_b32 v120, 16, v80
    v_and_b32 v121, 0xffff0000, v80
    v_lshlrev_b32 v122, 16, v81
    v_and_b32 v123, 0xffff0000, v81
    v_lshlrev_b32 v124, 16, v82
    v_and_b32 v125, 0xffff0000, v82
    v_lshlrev_b32 v126, 16, v83
    v_and_b32 v127, 0xffff0000, v83
    v_pk_fma_f32 v[112:113], v[120:121], v[20:21], v[112:113] op_sel:[0,0,0] op_sel_hi:[1,0,1]
    v_pk_fma_f32 v[114:115], v[122:123], v[20:21], v[114:115] op_sel:[0,0,0] op_sel_hi:[1,0,1]
    v_pk_fma_f32 v[116:117], v[124:125], v[20:21], v[116:117] op_sel:[0,0,0] op_sel_hi:[1,0,1]
    v_pk_fma_f32 v[118:119], v[126:127], v[20:21], v[118:119] op_sel:[0,0,0] op_sel_hi:[1,0,1]
    s_waitcnt vmcnt(6)
    v_lshlrev_b32 v120, 16, v84
    v_and_b32 v121, 0xffff0000, v84
    v_lshlrev_b32 v122, 16, v85
    v_and_b32 v123, 0xffff0000, v85
    v_lshlrev_b32 v124, 16, v86
    v_and_b32 v125, 0xffff0000, v86
    v_lshlrev_b32 v126, 16, v87
    v_and_b32 v127, 0xffff0000, v87
    v_pk_fma_f32 v[112:113], v[120:121], v[20:21], v[112:113] op_sel:[0,1,0] op_sel_hi:[1,1,1]
    v_pk_fma_f32 v[114:115], v[122:123], v[20:21], v[114:115] op_sel:[0,1,0] op_sel_hi:[1,1,1]
    v_pk_fma_f32 v[116:117], v[124:125], v[20:21], v[116:117] op_sel:[0,1,0] op_sel_hi:[1,1,1]
    v_pk_fma_f32 v[118:119], v[126:127], v[20:21], v[118:119] op_sel:[0,1,0] op_sel_hi:[1,1,1]
    s_waitcnt vmcnt(5)
    v_lshlrev_b32 v120, 16, v88
    v_and_b32 v121, 0xffff0000, v88
    v_lshlrev_b32 v122, 16, v89
    v_and_b32 v123, 0xffff0000, v89
    v_lshlrev_b32 v124, 16, v90
    v_and_b32 v125, 0xffff0000, v90
    v_lshlrev_b32 v126, 16, v91
    v_and_b32 v127, 0xffff0000, v91
    v_pk_fma_f32 v[112:113], v[120:121], v[22:23], v[112:113] op_sel:[0,0,0] op_sel_hi:[1,0,1]
    v_pk_fma_f32 v[114:115], v[122:123], v[22:23], v[114:115] op_sel:[0,0,0] op_sel_hi:[1,0,1]
    v_pk_fma_f32 v[116:117], v[124:125], v[22:23], v[116:117] op_sel:[0,0,0] op_sel_hi:[1,0,1]
    v_pk_fma_f32 v[118:119], v[126:127], v[22:23], v[118:119] op_sel:[0,0,0] op_sel_hi:[1,0,1]
    s_waitcnt vmcnt(4)
    v_lshlrev_b32 v120, 16, v92
    v_and_b32 v121, 0xffff0000, v92
    v_lshlrev_b32 v122, 16, v93
    v_and_b32 v123, 0xffff0000, v93
    v_lshlrev_b32 v124, 16, v94
    v_and_b32 v125, 0xffff0000, v94
    v_lshlrev_b32 v126, 16, v95
    v_and_b32 v127, 0xffff0000, v95
    v_pk_fma_f32 v[112:113], v[120:121], v[22:23], v[112:113] op_sel:[0,1,0] op_sel_hi:[1,1,1]
    v_pk_fma_f32 v[114:115], v[122:123], v[22:23], v[114:115] op_sel:[0,1,0] op_sel_hi:[1,1,1]
    v_pk_fma_f32 v[116:117], v[124:125], v[22:23], v[116:117] op_sel:[0,1,0] op_sel_hi:[1,1,1]
    v_pk_fma_f32 v[118:119], v[126:127], v[22:23], v[118:119] op_sel:[0,1,0] op_sel_hi:[1,1,1]
    s_waitcnt vmcnt(3)
    v_lshlrev_b32 v120, 16, v96
    v_and_b32 v121, 0xffff0000, v96
    v_lshlrev_b32 v122, 16, v97
    v_and_b32 v123, 0xffff0000, v97
    v_lshlrev_b32 v124, 16, v98
    v_and_b32 v125, 0xffff0000, v98
    v_lshlrev_b32 v126, 16, v99
    v_and_b32 v127, 0xffff0000, v99
    v_pk_fma_f32 v[112:113], v[120:121], v[24:25], v[112:113] op_sel:[0,0,0] op_sel_hi:[1,0,1]
    v_pk_fma_f32 v[114:115], v[122:123], v[24:25], v[114:115] op_sel:[0,0,0] op_sel_hi:[1,0,1]
    v_pk_fma_f32 v[116:117], v[124:125], v[24:25], v[116:117] op_sel:[0,0,0] op_sel_hi:[1,0,1]
    v_pk_fma_f32 v[118:119], v[126:127], v[24:25], v[118:119] op_sel:[0,0,0] op_sel_hi:[1,0,1]
    s_waitcnt vmcnt(2)
    v_lshlrev_b32 v120, 16, v100
    v_and_b32 v121, 0xffff0000, v100
    v_lshlrev_b32 v122, 16, v101
    v_and_b32 v123, 0xffff0000, v101
    v_lshlrev_b32 v124, 16, v102
    v_and_b32 v125, 0xffff0000, v102
    v_lshlrev_b32 v126, 16, v103
    v_and_b32 v127, 0xffff0000, v103
    v_pk_fma_f32 v[112:113], v[120:121], v[24:25], v[112:113] op_sel:[0,1,0] op_sel_hi:[1,1,1]
    v_pk_fma_f32 v[114:115], v[122:123], v[24:25], v[114:115] op_sel:[0,1,0] op_sel_hi:[1,1,1]
    v_pk_fma_f32 v[116:117], v[124:125], v[24:25], v[116:117] op_sel:[0,1,0] op_sel_hi:[1,1,1]
    v_pk_fma_f32 v[118:119], v[126:127], v[24:25], v[118:119] op_sel:[0,1,0] op_sel_hi:[1,1,1]
    s_waitcnt vmcnt(1)
    v_lshlrev_b32 v120, 16, v104
    v_and_b32 v121, 0xffff0000, v104
    v_lshlrev_b32 v122, 16, v105
    v_and_b32 v123, 0xffff0000, v105
    v_lshlrev_b32 v124, 16, v106
    v_and_b32 v125, 0xffff0000, v106
    v_lshlrev_b32 v126, 16, v107
    v_and_b32 v127, 0xffff0000, v107
    v_pk_fma_f32 v[112:113], v[120:121], v[26:27], v[112:113] op_sel:[0,0,0] op_sel_hi:[1,0,1]
    v_pk_fma_f32 v[114:115], v[122:123], v[26:27], v[114:115] op_sel:[0,0,0] op_sel_hi:[1,0,1]
    v_pk_fma_f32 v[116:117], v[124:125], v[26:27], v[116:117] op_sel:[0,0,0] op_sel_hi:[1,0,1]
    v_pk_fma_f32 v[118:119], v[126:127], v[26:27], v[118:119] op_sel:[0,0,0] op_sel_hi:[1,0,1]
    s_waitcnt vmcnt(0)
    v_lshlrev_b32 v120, 16, v108
    v_and_b32 v121, 0xffff0000, v108
    v_lshlrev_b32 v122, 16, v109
    v_and_b32 v123, 0xffff0000, v109
    v_lshlrev_b32 v124, 16, v110
    v_and_b32 v125, 0xffff0000, v110
    v_lshlrev_b32 v126, 16, v111
    v_and_b32 v127, 0xffff0000, v111
    v_pk_fma_f32 v[112:113], v[120:121], v[26:27], v[112:113] op_sel:[0,1,0] op_sel_hi:[1,1,1]
    v_pk_fma_f32 v[114:115], v[122:123], v[26:27], v[114:115] op_sel:[0,1,0] op_sel_hi:[1,1,1]
    v_pk_fma_f32 v[116:117], v[124:125], v[26:27], v[116:117] op_sel:[0,1,0] op_sel_hi:[1,1,1]
    v_pk_fma_f32 v[118:119], v[126:127], v[26:27], v[118:119] op_sel:[0,1,0] op_sel_hi:[1,1,1]
    s_nop 1
    v_add_f32_dpp v112, v112, v112 row_ror:8 row_mask:0xf bank_mask:0xf
    v_add_f32_dpp v113, v113, v113 row_ror:8 row_mask:0xf bank_mask:0xf
    v_add_f32_dpp v114, v114, v114 row_ror:8 row_mask:0xf bank_mask:0xf
    v_add_f32_dpp v115, v115, v115 row_ror:8 row_mask:0xf bank_mask:0xf
    v_add_f32_dpp v116, v116, v116 row_ror:8 row_mask:0xf bank_mask:0xf
    v_add_f32_dpp v117, v117, v117 row_ror:8 row_mask:0xf bank_mask:0xf
    v_add_f32_dpp v118, v118, v118 row_ror:8 row_mask:0xf bank_mask:0xf
    v_add_f32_dpp v119, v119, v119 row_ror:8 row_mask:0xf bank_mask:0xf
    v_mov_b32 v120, v112
    v_mov_b32 v121, v113
    v_mov_b32 v122, v114
    v_mov_b32 v123, v115
    v_mov_b32 v124, v116
    v_mov_b32 v125, v117
    v_mov_b32 v126, v118
    v_mov_b32 v127, v119
    s_nop 1
    v_permlane32_swap_b32 v120, v112
    v_permlane32_swap_b32 v121, v113
    v_permlane32_swap_b32 v122, v114
    v_permlane32_swap_b32 v123, v115
    v_permlane32_swap_b32 v124, v116
    v_permlane32_swap_b32 v125, v117
    v_permlane32_swap_b32 v126, v118
    v_permlane32_swap_b32 v127, v119
    s_nop 1
    v_add_f32 v112, v112, v120
    v_add_f32 v113, v113, v121
    v_add_f32 v114, v114, v122
    v_add_f32 v115, v115, v123
    v_add_f32 v116, v116, v124
    v_add_f32 v117, v117, v125
    v_add_f32 v118, v118, v126
    v_add_f32 v119, v119, v127
    v_mov_b32 v120, v112
    v_mov_b32 v121, v113
    v_mov_b32 v122, v114
    v_mov_b32 v123, v115
    v_mov_b32 v124, v116
    v_mov_b32 v125, v117
    v_mov_b32 v126, v118
    v_mov_b32 v127, v119
    s_nop 1
    v_permlane16_swap_b32 v120, v112
    v_permlane16_swap_b32 v121, v113
    v_permlane16_swap_b32 v122, v114
    v_permlane16_swap_b32 v123, v115
    v_permlane16_swap_b32 v124, v116
    v_permlane16_swap_b32 v125, v117
    v_permlane16_swap_b32 v126, v118
    v_permlane16_swap_b32 v127, v119
    s_nop 1
    v_add_f32 v112, v112, v120
    v_add_f32 v113, v113, v121
    v_add_f32 v114, v114, v122
    v_add_f32 v115, v115, v123
    v_add_f32 v116, v116, v124
    v_add_f32 v117, v117, v125
    v_add_f32 v118, v118, v126
    v_add_f32 v119, v119, v127
    v_lshlrev_b32 v7, 5, v3
    s_mul_i32 s36, s33, 15360
    s_lshl_b32 s37, s32, 8
    s_add_u32 s37, s37, s36
    s_add_u32 s37, s37, 2793472
    s_lshl_b32 s44, s21, 7
    s_add_u32 s44, s44, 29700096
    s_mov_b64 exec, 0xff
    buffer_store_dwordx4 v[112:115], v7, s[28:31], s37 offen sc1
    buffer_store_dwordx4 v[116:119], v7, s[28:31], s37 offen offset:16 sc1
    s_mov_b64 exec, -1
    s_waitcnt vmcnt(0)
    s_mov_b32 s47, 0
prep_kernel_nn8:
    v_readfirstlane_b32 s46, v250
    s_add_u32 s47, s47, 1
    s_cmp_lg_u32 s46, 0
    s_cbranch_scc1 prep_kernel_nd9
    s_cmp_ge_u32 s47, 200000
    s_cbranch_scc1 prep_kernel_nd9
    buffer_load_dword v250, v251, s[48:51], 0 offen sc1
    s_waitcnt vmcnt(0)
    s_branch prep_kernel_nn8
prep_kernel_nd9:
    v_mov_b32 v132, s46
    v_mov_b32 v133, 0
    s_mov_b64 exec, 1
    buffer_store_dword v132, v133, s[28:31], s44 offen sc1
    s_endpgm
p_st:
    s_mov_b32 s16, s60
    s_mov_b32 s17, s61
    s_mov_b32 s18, 2621440
    s_mov_b32 s19, 0x00020000
    v_lshrrev_b32 v5, 3, v1
    v_and_b32 v6, 7, v1
    s_lshl_b32 s23, s21, 4
    v_add_u32 v7, s23, v5
    v_mul_u32_u24 v9, 1280, v7
    v_lshl_add_u32 v9, v6, 4, v9
    v_mov_b32 v20, 0x3f803f80
    s_mov_b32 s24, 0
    buffer_load_dwordx4 v[32:35], v9, s[16:19], s24 offen offset:0 nt
    buffer_load_dwordx4 v[36:39], v9, s[16:19], s24 offen offset:128 nt
    buffer_load_dwordx4 v[40:43], v9, s[16:19], s24 offen offset:256 nt
    buffer_load_dwordx4 v[44:47], v9, s[16:19], s24 offen offset:384 nt
    buffer_load_dwordx4 v[48:51], v9, s[16:19], s24 offen offset:512 nt
    buffer_load_dwordx4 v[52:55], v9, s[16:19], s24 offen offset:640 nt
    buffer_load_dwordx4 v[56:59], v9, s[16:19], s24 offen offset:768 nt
    buffer_load_dwordx4 v[60:63], v9, s[16:19], s24 offen offset:896 nt
    buffer_load_dwordx4 v[64:67], v9, s[16:19], s24 offen offset:1024 nt
    buffer_load_dwordx4 v[68:71], v9, s[16:19], s24 offen offset:1152 nt
    s_add_u32 s24, s24, 10240
    buffer_load_dwordx4 v[72:75], v9, s[16:19], s24 offen offset:0 nt
    buffer_load_dwordx4 v[76:79], v9, s[16:19], s24 offen offset:128 nt
    buffer_load_dwordx4 v[80:83], v9, s[16:19], s24 offen offset:256 nt
    buffer_load_dwordx4 v[84:87], v9, s[16:19], s24 offen offset:384 nt
    buffer_load_dwordx4 v[88:91], v9, s[16:19], s24 offen offset:512 nt
    buffer_load_dwordx4 v[92:95], v9, s[16:19], s24 offen offset:640 nt
    buffer_load_dwordx4 v[96:99], v9, s[16:19], s24 offen offset:768 nt
    buffer_load_dwordx4 v[100:103], v9, s[16:19], s24 offen offset:896 nt
    buffer_load_dwordx4 v[104:107], v9, s[16:19], s24 offen offset:1024 nt
    buffer_load_dwordx4 v[108:111], v9, s[16:19], s24 offen offset:1152 nt
    v_and_b32 v21, 1, v5
    v_lshl_add_u32 v21, v6, 1, v21
    v_lshlrev_b32 v21, 7, v21
    v_lshrrev_b32 v22, 1, v5
    v_xor_b32 v22, v22, v6
    v_lshl_add_u32 v21, v22, 4, v21
    v_xor_b32 v23, 64, v21
    s_mul_i32 s25, s21, 20480
    s_add_u32 s25, s25, 2854912
    v_mov_b32 v10, 0
    v_mov_b32 v11, 0
    v_mov_b32 v12, 0
    v_mov_b32 v13, 0
    s_waitcnt vmcnt(19)
    v_dot2_f32_bf16 v10, v32, v20, v10
    v_dot2_f32_bf16 v11, v32, v32, v11
    v_dot2_f32_bf16 v10, v33, v20, v10
    v_dot2_f32_bf16 v11, v33, v33, v11
    v_dot2_f32_bf16 v10, v34, v20, v10
    v_dot2_f32_bf16 v11, v34, v34, v11
    v_dot2_f32_bf16 v10, v35, v20, v10
    v_dot2_f32_bf16 v11, v35, v35, v11
    v_mov_b32 v120, v32
    v_mov_b32 v121, v33
    v_mov_b32 v122, v34
    v_mov_b32 v123, v35
    v_mov_b32_dpp v120, v34 row_ror:8 row_mask:0xf bank_mask:0xc
    v_mov_b32_dpp v121, v35 row_ror:8 row_mask:0xf bank_mask:0xc
    v_mov_b32_dpp v122, v32 row_ror:8 row_mask:0xf bank_mask:0x3
    v_mov_b32_dpp v123, v33 row_ror:8 row_mask:0xf bank_mask:0x3
    s_add_u32 s26, s25, 0
    buffer_store_dwordx4 v[120:123], v21, s[28:31], s26 offen sc1
    s_waitcnt vmcnt(19)
    v_dot2_f32_bf16 v10, v36, v20, v10
    v_dot2_f32_bf16 v11, v36, v36, v11
    v_dot2_f32_bf16 v10, v37, v20, v10
    v_dot2_f32_bf16 v11, v37, v37, v11
    v_dot2_f32_bf16 v10, v38, v20, v10
    v_dot2_f32_bf16 v11, v38, v38, v11
    v_dot2_f32_bf16 v10, v39, v20, v10
    v_dot2_f32_bf16 v11, v39, v39, v11
    v_mov_b32 v124, v36
    v_mov_b32 v125, v37
    v_mov_b32 v126, v38
    v_mov_b32 v127, v39
    v_mov_b32_dpp v124, v38 row_ror:8 row_mask:0xf bank_mask:0xc
    v_mov_b32_dpp v125, v39 row_ror:8 row_mask:0xf bank_mask:0xc
    v_mov_b32_dpp v126, v36 row_ror:8 row_mask:0xf bank_mask:0x3
    v_mov_b32_dpp v127, v37 row_ror:8 row_mask:0xf bank_mask:0x3
    s_add_u32 s26, s25, 2048
    buffer_store_dwordx4 v[124:127], v21, s[28:31], s26 offen sc1
    s_waitcnt vmcnt(19)
    v_dot2_f32_bf16 v10, v40, v20, v10
    v_dot2_f32_bf16 v11, v40, v40, v11
    v_dot2_f32_bf16 v10, v41, v20, v10
    v_dot2_f32_bf16 v11, v41, v41, v11
    v_dot2_f32_bf16 v10, v42, v20, v10
    v_dot2_f32_bf16 v11, v42, v42, v11
    v_dot2_f32_bf16 v10, v43, v20, v10
    v_dot2_f32_bf16 v11, v43, v43, v11
    v_mov_b32 v120, v40
    v_mov_b32 v121, v41
    v_mov_b32 v122, v42
    v_mov_b32 v123, v43
    v_mov_b32_dpp v120, v42 row_ror:8 row_mask:0xf bank_mask:0xc
    v_mov_b32_dpp v121, v43 row_ror:8 row_mask:0xf bank_mask:0xc
    v_mov_b32_dpp v122, v40 row_ror:8 row_mask:0xf bank_mask:0x3
    v_mov_b32_dpp v123, v41 row_ror:8 row_mask:0xf bank_mask:0x3
    s_add_u32 s26, s25, 4096
    buffer_store_dwordx4 v[120:123], v21, s[28:31], s26 offen sc1
    s_waitcnt vmcnt(19)
    v_dot2_f32_bf16 v10, v44, v20, v10
    v_dot2_f32_bf16 v11, v44, v44, v11
    v_dot2_f32_bf16 v10, v45, v20, v10
    v_dot2_f32_bf16 v11, v45, v45, v11
    v_dot2_f32_bf16 v10, v46, v20, v10
    v_dot2_f32_bf16 v11, v46, v46, v11
    v_dot2_f32_bf16 v10, v47, v20, v10
    v_dot2_f32_bf16 v11, v47, v47, v11
    v_mov_b32 v124, v44
    v_mov_b32 v125, v45
    v_mov_b32 v126, v46
    v_mov_b32 v127, v47
    v_mov_b32_dpp v124, v46 row_ror:8 row_mask:0xf bank_mask:0xc
    v_mov_b32_dpp v125, v47 row_ror:8 row_mask:0xf bank_mask:0xc
    v_mov_b32_dpp v126, v44 row_ror:8 row_mask:0xf bank_mask:0x3
    v_mov_b32_dpp v127, v45 row_ror:8 row_mask:0xf bank_mask:0x3
    s_add_u32 s26, s25, 6144
    buffer_store_dwordx4 v[124:127], v21, s[28:31], s26 offen sc1
    s_waitcnt vmcnt(19)
    v_dot2_f32_bf16 v10, v48, v20, v10
    v_dot2_f32_bf16 v11, v48, v48, v11
    v_dot2_f32_bf16 v10, v49, v20, v10
    v_dot2_f32_bf16 v11, v49, v49, v11
    v_dot2_f32_bf16 v10, v50, v20, v10
    v_dot2_f32_bf16 v11, v50, v50, v11
    v_dot2_f32_bf16 v10, v51, v20, v10
    v_dot2_f32_bf16 v11, v51, v51, v11
    v_mov_b32 v120, v48
    v_mov_b32 v121, v49
    v_mov_b32 v122, v50
    v_mov_b32 v123, v51
    v_mov_b32_dpp v120, v50 row_ror:8 row_mask:0xf bank_mask:0xc
    v_mov_b32_dpp v121, v51 row_ror:8 row_mask:0xf bank_mask:0xc
    v_mov_b32_dpp v122, v48 row_ror:8 row_mask:0xf bank_mask:0x3
    v_mov_b32_dpp v123, v49 row_ror:8 row_mask:0xf bank_mask:0x3
    s_add_u32 s26, s25, 8192
    buffer_store_dwordx4 v[120:123], v21, s[28:31], s26 offen sc1
    s_waitcnt vmcnt(19)
    v_dot2_f32_bf16 v10, v52, v20, v10
    v_dot2_f32_bf16 v11, v52, v52, v11
    v_dot2_f32_bf16 v10, v53, v20, v10
    v_dot2_f32_bf16 v11, v53, v53, v11
    v_dot2_f32_bf16 v10, v54, v20, v10
    v_dot2_f32_bf16 v11, v54, v54, v11
    v_dot2_f32_bf16 v10, v55, v20, v10
    v_dot2_f32_bf16 v11, v55, v55, v11
    v_mov_b32 v124, v52
    v_mov_b32 v125, v53
    v_mov_b32 v126, v54
    v_mov_b32 v127, v55
    v_mov_b32_dpp v124, v54 row_ror:8 row_mask:0xf bank_mask:0xc
    v_mov_b32_dpp v125, v55 row_ror:8 row_mask:0xf bank_mask:0xc
    v_mov_b32_dpp v126, v52 row_ror:8 row_mask:0xf bank_mask:0x3
    v_mov_b32_dpp v127, v53 row_ror:8 row_mask:0xf bank_mask:0x3
    s_add_u32 s26, s25, 10240
    buffer_store_dwordx4 v[124:127], v21, s[28:31], s26 offen sc1
    s_waitcnt vmcnt(19)
    v_dot2_f32_bf16 v10, v56, v20, v10
    v_dot2_f32_bf16 v11, v56, v56, v11
    v_dot2_f32_bf16 v10, v57, v20, v10
    v_dot2_f32_bf16 v11, v57, v57, v11
    v_dot2_f32_bf16 v10, v58, v20, v10
    v_dot2_f32_bf16 v11, v58, v58, v11
    v_dot2_f32_bf16 v10, v59, v20, v10
    v_dot2_f32_bf16 v11, v59, v59, v11
    v_mov_b32 v120, v56
    v_mov_b32 v121, v57
    v_mov_b32 v122, v58
    v_mov_b32 v123, v59
    v_mov_b32_dpp v120, v58 row_ror:8 row_mask:0xf bank_mask:0xc
    v_mov_b32_dpp v121, v59 row_ror:8 row_mask:0xf bank_mask:0xc
    v_mov_b32_dpp v122, v56 row_ror:8 row_mask:0xf bank_mask:0x3
    v_mov_b32_dpp v123, v57 row_ror:8 row_mask:0xf bank_mask:0x3
    s_add_u32 s26, s25, 12288
    buffer_store_dwordx4 v[120:123], v21, s[28:31], s26 offen sc1
    s_waitcnt vmcnt(19)
    v_dot2_f32_bf16 v10, v60, v20, v10
    v_dot2_f32_bf16 v11, v60, v60, v11
    v_dot2_f32_bf16 v10, v61, v20, v10
    v_dot2_f32_bf16 v11, v61, v61, v11
    v_dot2_f32_bf16 v10, v62, v20, v10
    v_dot2_f32_bf16 v11, v62, v62, v11
    v_dot2_f32_bf16 v10, v63, v20, v10
    v_dot2_f32_bf16 v11, v63, v63, v11
    v_mov_b32 v124, v60
    v_mov_b32 v125, v61
    v_mov_b32 v126, v62
    v_mov_b32 v127, v63
    v_mov_b32_dpp v124, v62 row_ror:8 row_mask:0xf bank_mask:0xc
    v_mov_b32_dpp v125, v63 row_ror:8 row_mask:0xf bank_mask:0xc
    v_mov_b32_dpp v126, v60 row_ror:8 row_mask:0xf bank_mask:0x3
    v_mov_b32_dpp v127, v61 row_ror:8 row_mask:0xf bank_mask:0x3
    s_add_u32 s26, s25, 14336
    buffer_store_dwordx4 v[124:127], v21, s[28:31], s26 offen sc1
    s_waitcnt vmcnt(19)
    v_dot2_f32_bf16 v10, v64, v20, v10
    v_dot2_f32_bf16 v11, v64, v64, v11
    v_dot2_f32_bf16 v10, v65, v20, v10
    v_dot2_f32_bf16 v11, v65, v65, v11
    v_dot2_f32_bf16 v10, v66, v20, v10
    v_dot2_f32_bf16 v11, v66, v66, v11
    v_dot2_f32_bf16 v10, v67, v20, v10
    v_dot2_f32_bf16 v11, v67, v67, v11
    v_mov_b32 v120, v64
    v_mov_b32 v121, v65
    v_mov_b32 v122, v66
    v_mov_b32 v123, v67
    v_mov_b32_dpp v120, v66 row_ror:8 row_mask:0xf bank_mask:0xc
    v_mov_b32_dpp v121, v67 row_ror:8 row_mask:0xf bank_mask:0xc
    v_mov_b32_dpp v122, v64 row_ror:8 row_mask:0xf bank_mask:0x3
    v_mov_b32_dpp v123, v65 row_ror:8 row_mask:0xf bank_mask:0x3
    s_add_u32 s26, s25, 16384
    buffer_store_dwordx4 v[120:123], v21, s[28:31], s26 offen sc1
    s_waitcnt vmcnt(19)
    v_dot2_f32_bf16 v10, v68, v20, v10
    v_dot2_f32_bf16 v11, v68, v68, v11
    v_dot2_f32_bf16 v10, v69, v20, v10
    v_dot2_f32_bf16 v11, v69, v69, v11
    v_dot2_f32_bf16 v10, v70, v20, v10
    v_dot2_f32_bf16 v11, v70, v70, v11
    v_dot2_f32_bf16 v10, v71, v20, v10
    v_dot2_f32_bf16 v11, v71, v71, v11
    v_mov_b32 v124, v68
    v_mov_b32 v125, v69
    v_mov_b32 v126, v70
    v_mov_b32 v127, v71
    v_mov_b32_dpp v124, v70 row_ror:8 row_mask:0xf bank_mask:0xc
    v_mov_b32_dpp v125, v71 row_ror:8 row_mask:0xf bank_mask:0xc
    v_mov_b32_dpp v126, v68 row_ror:8 row_mask:0xf bank_mask:0x3
    v_mov_b32_dpp v127, v69 row_ror:8 row_mask:0xf bank_mask:0x3
    s_add_u32 s26, s25, 18432
    buffer_store_dwordx4 v[124:127], v21, s[28:31], s26 offen sc1
    s_waitcnt vmcnt(19)
    v_dot2_f32_bf16 v12, v72, v20, v12
    v_dot2_f32_bf16 v13, v72, v72, v13
    v_dot2_f32_bf16 v12, v73, v20, v12
    v_dot2_f32_bf16 v13, v73, v73, v13
    v_dot2_f32_bf16 v12, v74, v20, v12
    v_dot2_f32_bf16 v13, v74, v74, v13
    v_dot2_f32_bf16 v12, v75, v20, v12
    v_dot2_f32_bf16 v13, v75, v75, v13
    v_mov_b32 v120, v72
    v_mov_b32 v121, v73
    v_mov_b32 v122, v74
    v_mov_b32 v123, v75
    v_mov_b32_dpp v120, v74 row_ror:8 row_mask:0xf bank_mask:0xc
    v_mov_b32_dpp v121, v75 row_ror:8 row_mask:0xf bank_mask:0xc
    v_mov_b32_dpp v122, v72 row_ror:8 row_mask:0xf bank_mask:0x3
    v_mov_b32_dpp v123, v73 row_ror:8 row_mask:0xf bank_mask:0x3
    s_add_u32 s26, s25, 0
    buffer_store_dwordx4 v[120:123], v23, s[28:31], s26 offen sc1
    s_waitcnt vmcnt(19)
    v_dot2_f32_bf16 v12, v76, v20, v12
    v_dot2_f32_bf16 v13, v76, v76, v13
    v_dot2_f32_bf16 v12, v77, v20, v12
    v_dot2_f32_bf16 v13, v77, v77, v13
    v_dot2_f32_bf16 v12, v78, v20, v12
    v_dot2_f32_bf16 v13, v78, v78, v13
    v_dot2_f32_bf16 v12, v79, v20, v12
    v_dot2_f32_bf16 v13, v79, v79, v13
    v_mov_b32 v124, v76
    v_mov_b32 v125, v77
    v_mov_b32 v126, v78
    v_mov_b32 v127, v79
    v_mov_b32_dpp v124, v78 row_ror:8 row_mask:0xf bank_mask:0xc
    v_mov_b32_dpp v125, v79 row_ror:8 row_mask:0xf bank_mask:0xc
    v_mov_b32_dpp v126, v76 row_ror:8 row_mask:0xf bank_mask:0x3
    v_mov_b32_dpp v127, v77 row_ror:8 row_mask:0xf bank_mask:0x3
    s_add_u32 s26, s25, 2048
    buffer_store_dwordx4 v[124:127], v23, s[28:31], s26 offen sc1
    s_waitcnt vmcnt(19)
    v_dot2_f32_bf16 v12, v80, v20, v12
    v_dot2_f32_bf16 v13, v80, v80, v13
    v_dot2_f32_bf16 v12, v81, v20, v12
    v_dot2_f32_bf16 v13, v81, v81, v13
    v_dot2_f32_bf16 v12, v82, v20, v12
    v_dot2_f32_bf16 v13, v82, v82, v13
    v_dot2_f32_bf16 v12, v83, v20, v12
    v_dot2_f32_bf16 v13, v83, v83, v13
    v_mov_b32 v120, v80
    v_mov_b32 v121, v81
    v_mov_b32 v122, v82
    v_mov_b32 v123, v83
    v_mov_b32_dpp v120, v82 row_ror:8 row_mask:0xf bank_mask:0xc
    v_mov_b32_dpp v121, v83 row_ror:8 row_mask:0xf bank_mask:0xc
    v_mov_b32_dpp v122, v80 row_ror:8 row_mask:0xf bank_mask:0x3
    v_mov_b32_dpp v123, v81 row_ror:8 row_mask:0xf bank_mask:0x3
    s_add_u32 s26, s25, 4096
    buffer_store_dwordx4 v[120:123], v23, s[28:31], s26 offen sc1
    s_waitcnt vmcnt(19)
    v_dot2_f32_bf16 v12, v84, v20, v12
    v_dot2_f32_bf16 v13, v84, v84, v13
    v_dot2_f32_bf16 v12, v85, v20, v12
    v_dot2_f32_bf16 v13, v85, v85, v13
    v_dot2_f32_bf16 v12, v86, v20, v12
    v_dot2_f32_bf16 v13, v86, v86, v13
    v_dot2_f32_bf16 v12, v87, v20, v12
    v_dot2_f32_bf16 v13, v87, v87, v13
    v_mov_b32 v124, v84
    v_mov_b32 v125, v85
    v_mov_b32 v126, v86
    v_mov_b32 v127, v87
    v_mov_b32_dpp v124, v86 row_ror:8 row_mask:0xf bank_mask:0xc
    v_mov_b32_dpp v125, v87 row_ror:8 row_mask:0xf bank_mask:0xc
    v_mov_b32_dpp v126, v84 row_ror:8 row_mask:0xf bank_mask:0x3
    v_mov_b32_dpp v127, v85 row_ror:8 row_mask:0xf bank_mask:0x3
    s_add_u32 s26, s25, 6144
    buffer_store_dwordx4 v[124:127], v23, s[28:31], s26 offen sc1
    s_waitcnt vmcnt(19)
    v_dot2_f32_bf16 v12, v88, v20, v12
    v_dot2_f32_bf16 v13, v88, v88, v13
    v_dot2_f32_bf16 v12, v89, v20, v12
    v_dot2_f32_bf16 v13, v89, v89, v13
    v_dot2_f32_bf16 v12, v90, v20, v12
    v_dot2_f32_bf16 v13, v90, v90, v13
    v_dot2_f32_bf16 v12, v91, v20, v12
    v_dot2_f32_bf16 v13, v91, v91, v13
    v_mov_b32 v120, v88
    v_mov_b32 v121, v89
    v_mov_b32 v122, v90
    v_mov_b32 v123, v91
    v_mov_b32_dpp v120, v90 row_ror:8 row_mask:0xf bank_mask:0xc
    v_mov_b32_dpp v121, v91 row_ror:8 row_mask:0xf bank_mask:0xc
    v_mov_b32_dpp v122, v88 row_ror:8 row_mask:0xf bank_mask:0x3
    v_mov_b32_dpp v123, v89 row_ror:8 row_mask:0xf bank_mask:0x3
    s_add_u32 s26, s25, 8192
    buffer_store_dwordx4 v[120:123], v23, s[28:31], s26 offen sc1
    s_waitcnt vmcnt(19)
    v_dot2_f32_bf16 v12, v92, v20, v12
    v_dot2_f32_bf16 v13, v92, v92, v13
    v_dot2_f32_bf16 v12, v93, v20, v12
    v_dot2_f32_bf16 v13, v93, v93, v13
    v_dot2_f32_bf16 v12, v94, v20, v12
    v_dot2_f32_bf16 v13, v94, v94, v13
    v_dot2_f32_bf16 v12, v95, v20, v12
    v_dot2_f32_bf16 v13, v95, v95, v13
    v_mov_b32 v124, v92
    v_mov_b32 v125, v93
    v_mov_b32 v126, v94
    v_mov_b32 v127, v95
    v_mov_b32_dpp v124, v94 row_ror:8 row_mask:0xf bank_mask:0xc
    v_mov_b32_dpp v125, v95 row_ror:8 row_mask:0xf bank_mask:0xc
    v_mov_b32_dpp v126, v92 row_ror:8 row_mask:0xf bank_mask:0x3
    v_mov_b32_dpp v127, v93 row_ror:8 row_mask:0xf bank_mask:0x3
    s_add_u32 s26, s25, 10240
    buffer_store_dwordx4 v[124:127], v23, s[28:31], s26 offen sc1
    s_waitcnt vmcnt(19)
    v_dot2_f32_bf16 v12, v96, v20, v12
    v_dot2_f32_bf16 v13, v96, v96, v13
    v_dot2_f32_bf16 v12, v97, v20, v12
    v_dot2_f32_bf16 v13, v97, v97, v13
    v_dot2_f32_bf16 v12, v98, v20, v12
    v_dot2_f32_bf16 v13, v98, v98, v13
    v_dot2_f32_bf16 v12, v99, v20, v12
    v_dot2_f32_bf16 v13, v99, v99, v13
    v_mov_b32 v120, v96
    v_mov_b32 v121, v97
    v_mov_b32 v122, v98
    v_mov_b32 v123, v99
    v_mov_b32_dpp v120, v98 row_ror:8 row_mask:0xf bank_mask:0xc
    v_mov_b32_dpp v121, v99 row_ror:8 row_mask:0xf bank_mask:0xc
    v_mov_b32_dpp v122, v96 row_ror:8 row_mask:0xf bank_mask:0x3
    v_mov_b32_dpp v123, v97 row_ror:8 row_mask:0xf bank_mask:0x3
    s_add_u32 s26, s25, 12288
    buffer_store_dwordx4 v[120:123], v23, s[28:31], s26 offen sc1
    s_waitcnt vmcnt(19)
    v_dot2_f32_bf16 v12, v100, v20, v12
    v_dot2_f32_bf16 v13, v100, v100, v13
    v_dot2_f32_bf16 v12, v101, v20, v12
    v_dot2_f32_bf16 v13, v101, v101, v13
    v_dot2_f32_bf16 v12, v102, v20, v12
    v_dot2_f32_bf16 v13, v102, v102, v13
    v_dot2_f32_bf16 v12, v103, v20, v12
    v_dot2_f32_bf16 v13, v103, v103, v13
    v_mov_b32 v124, v100
    v_mov_b32 v125, v101
    v_mov_b32 v126, v102
    v_mov_b32 v127, v103
    v_mov_b32_dpp v124, v102 row_ror:8 row_mask:0xf bank_mask:0xc
    v_mov_b32_dpp v125, v103 row_ror:8 row_mask:0xf bank_mask:0xc
    v_mov_b32_dpp v126, v100 row_ror:8 row_mask:0xf bank_mask:0x3
    v_mov_b32_dpp v127, v101 row_ror:8 row_mask:0xf bank_mask:0x3
    s_add_u32 s26, s25, 14336
    buffer_store_dwordx4 v[124:127], v23, s[28:31], s26 offen sc1
    s_waitcnt vmcnt(19)
    v_dot2_f32_bf16 v12, v104, v20, v12
    v_dot2_f32_bf16 v13, v104, v104, v13
    v_dot2_f32_bf16 v12, v105, v20, v12
    v_dot2_f32_bf16 v13, v105, v105, v13
    v_dot2_f32_bf16 v12, v106, v20, v12
    v_dot2_f32_bf16 v13, v106, v106, v13
    v_dot2_f32_bf16 v12, v107, v20, v12
    v_dot2_f32_bf16 v13, v107, v107, v13
    v_mov_b32 v120, v104
    v_mov_b32 v121, v105
    v_mov_b32 v122, v106
    v_mov_b32 v123, v107
    v_mov_b32_dpp v120, v106 row_ror:8 row_mask:0xf bank_mask:0xc
    v_mov_b32_dpp v121, v107 row_ror:8 row_mask:0xf bank_mask:0xc
    v_mov_b32_dpp v122, v104 row_ror:8 row_mask:0xf bank_mask:0x3
    v_mov_b32_dpp v123, v105 row_ror:8 row_mask:0xf bank_mask:0x3
    s_add_u32 s26, s25, 16384
    buffer_store_dwordx4 v[120:123], v23, s[28:31], s26 offen sc1
    s_waitcnt vmcnt(19)
    v_dot2_f32_bf16 v12, v108, v20, v12
    v_dot2_f32_bf16 v13, v108, v108, v13
    v_dot2_f32_bf16 v12, v109, v20, v12
    v_dot2_f32_bf16 v13, v109, v109, v13
    v_dot2_f32_bf16 v12, v110, v20, v12
    v_dot2_f32_bf16 v13, v110, v110, v13
    v_dot2_f32_bf16 v12, v111, v20, v12
    v_dot2_f32_bf16 v13, v111, v111, v13
    v_mov_b32 v124, v108
    v_mov_b32 v125, v109
    v_mov_b32 v126, v110
    v_mov_b32 v127, v111
    v_mov_b32_dpp v124, v110 row_ror:8 row_mask:0xf bank_mask:0xc
    v_mov_b32_dpp v125, v111 row_ror:8 row_mask:0xf bank_mask:0xc
    v_mov_b32_dpp v126, v108 row_ror:8 row_mask:0xf bank_mask:0x3
    v_mov_b32_dpp v127, v109 row_ror:8 row_mask:0xf bank_mask:0x3
    s_add_u32 s26, s25, 18432
    buffer_store_dwordx4 v[124:127], v23, s[28:31], s26 offen sc1
    s_nop 2
    v_add_f32_dpp v10, v10, v10 quad_perm:[1,0,3,2] row_mask:0xf bank_mask:0xf
    v_add_f32_dpp v11, v11, v11 quad_perm:[1,0,3,2] row_mask:0xf bank_mask:0xf
    v_add_f32_dpp v12, v12, v12 quad_perm:[1,0,3,2] row_mask:0xf bank_mask:0xf
    v_add_f32_dpp v13, v13, v13 quad_perm:[1,0,3,2] row_mask:0xf bank_mask:0xf
    v_add_f32_dpp v10, v10, v10 quad_perm:[2,3,0,1] row_mask:0xf bank_mask:0xf
    v_add_f32_dpp v11, v11, v11 quad_perm:[2,3,0,1] row_mask:0xf bank_mask:0xf
    v_add_f32_dpp v12, v12, v12 quad_perm:[2,3,0,1] row_mask:0xf bank_mask:0xf
    v_add_f32_dpp v13, v13, v13 quad_perm:[2,3,0,1] row_mask:0xf bank_mask:0xf
    v_add_f32_dpp v10, v10, v10 row_half_mirror row_mask:0xf bank_mask:0xf
    v_add_f32_dpp v11, v11, v11 row_half_mirror row_mask:0xf bank_mask:0xf
    v_add_f32_dpp v12, v12, v12 row_half_mirror row_mask:0xf bank_mask:0xf
    v_add_f32_dpp v13, v13, v13 row_half_mirror row_mask:0xf bank_mask:0xf
    v_mul_f32 v10, 0x3acccccd, v10
    v_mul_f32 v12, 0x3acccccd, v12
    v_mul_f32 v11, 0x3acccccd, v11
    v_mul_f32 v13, 0x3acccccd, v13
    v_fma_f32 v11, -v10, v10, v11
    v_fma_f32 v13, -v12, v12, v13
    v_max_f32 v11, 0, v11
    v_max_f32 v13, 0, v13
    v_cvt_pk_bf16_f32 v24, v10, v11
    v_cvt_pk_bf16_f32 v25, v12, v13
    v_lshlrev_b32 v10, 16, v24
    v_lshlrev_b32 v12, 16, v25
    v_and_b32 v11, 0xffff0000, v24
    v_and_b32 v13, 0xffff0000, v25
    v_add_f32 v11, 0x3727c5ac, v11
    v_add_f32 v13, 0x3727c5ac, v13
    v_cvt_pk_bf16_f32 v24, v11, v11
    v_cvt_pk_bf16_f32 v25, v13, v13
    v_lshlrev_b32 v11, 16, v24
    v_lshlrev_b32 v13, 16, v25
    v_sqrt_f32 v11, v11
    v_sqrt_f32 v13, v13
    s_nop 0
    s_nop 0
    v_cvt_pk_bf16_f32 v24, v11, v11
    v_cvt_pk_bf16_f32 v25, v13, v13
    v_lshlrev_b32 v11, 16, v24
    v_lshlrev_b32 v13, 16, v25
    v_rcp_f32 v11, v11
    v_rcp_f32 v13, v13
    s_nop 0
    s_nop 0
    v_mul_f32 v10, v10, v11
    v_mul_f32 v12, v12, v13
    v_sub_f32 v10, 0, v10
    v_sub_f32 v12, 0, v12
    v_lshlrev_b32 v7, 3, v7
    v_cmp_eq_u32 vcc, 0, v6
    s_lshl_b32 s44, s21, 7
    s_add_u32 s44, s44, 29683712
    s_mov_b32 s23, 5476352
    s_and_saveexec_b64 s[66:67], vcc
    buffer_store_dwordx2 v[10:11], v7, s[28:31], s23 offen offset:0 sc1
    buffer_store_dwordx2 v[12:13], v7, s[28:31], s23 offen offset:64 sc1
    s_mov_b64 exec, -1
    s_waitcnt vmcnt(0)
    s_mov_b32 s47, 0
prep_kernel_nn10:
    v_readfirstlane_b32 s46, v250
    s_add_u32 s47, s47, 1
    s_cmp_lg_u32 s46, 0
    s_cbranch_scc1 prep_kernel_nd11
    s_cmp_ge_u32 s47, 200000
    s_cbranch_scc1 prep_kernel_nd11
    buffer_load_dword v250, v251, s[48:51], 0 offen sc1
    s_waitcnt vmcnt(0)
    s_branch prep_kernel_nn10
prep_kernel_nd11:
    v_mov_b32 v30, s46
    v_mov_b32 v31, 0
    s_mov_b64 exec, 1
    buffer_store_dword v30, v31, s[28:31], s44 offen sc1
    s_endpgm
p_misc:
    s_sub_u32 s24, s20, 3
    s_mul_i32 s23, s24, 96
    s_add_u32 s23, s23, s21
    s_cmp_ge_u32 s23, 256
    s_cbranch_scc1 prep_end
    s_mul_i32 s22, s24, 12
    s_lshr_b32 s25, s21, 3
    s_add_u32 s22, s22, s25
    v_lshlrev_b32 v1, 4, v1
    v_mov_b32 v60, 0
    v_mov_b32 v61, 0
    v_mov_b32 v62, 0
    v_mov_b32 v63, 0
    s_lshl_b32 s24, s23, 10
    s_add_u32 s25, s24, 29380608
    s_add_u32 s26, s24, 10784768
    s_add_u32 s27, s24, 13365248
    s_cmp_ge_u32 s23, 20
    s_cselect_b32 s26, s27, s26
    s_cmp_ge_u32 s23, 256
    s_cbranch_scc1 prep_kernel_nz12
    buffer_store_dwordx4 v[60:63], v1, s[28:31], s25 offen sc1
prep_kernel_nz12:
    s_cmp_ge_u32 s23, 40
    s_cbranch_scc1 prep_kernel_nz13
    buffer_store_dwordx4 v[60:63], v1, s[28:31], s26 offen sc1
prep_kernel_nz13:
    s_getpc_b64 s[24:25]
p_pcref:
    s_sub_u32 s24, s24, p_pcref-prep_kernel
    s_subb_u32 s25, s25, 0
    s_lshl_b32 s23, s22, 11
    s_add_u32 s26, s23, 0
    s_min_u32 s26, s26, (chain_end-prep_kernel-1020)&0xfffffff0
    v_add_u32 v64, s26, v1
    v_mov_b32 v5, s25
    v_add_co_u32 v4, vcc, s24, v64
    v_addc_co_u32 v5, vcc, 0, v5, vcc
    global_load_dwordx4 v[72:75], v[4:5], off
    s_add_u32 s26, s23, 1024
    s_min_u32 s26, s26, (chain_end-prep_kernel-1020)&0xfffffff0
    v_add_u32 v64, s26, v1
    v_mov_b32 v5, s25
    v_add_co_u32 v4, vcc, s24, v64
    v_addc_co_u32 v5, vcc, 0, v5, vcc
    global_load_dwordx4 v[76:79], v[4:5], off
    s_waitcnt vmcnt(0)
    s_endpgm
p_conv:
    s_and_b32 s21, s2, 7
    s_mul_i32 s21, s21, 20
    s_sub_u32 s2, s2, 256
    s_lshr_b32 s2, s2, 3
    s_add_u32 s2, s2, s21
    s_and_b32 s19, s20, 3
    s_mov_b32 s24, s56
    s_mov_b32 s25, s57
    s_mov_b32 s26, 2621440
    s_mov_b32 s27, 0x00020000
    s_lshl_b32 s21, s2, 3
    s_add_u32 s22, s58, s21
    s_addc_u32 s23, s59, 0
    s_load_dwordx2 s[32:33], s[22:23], 0
    s_lshl_b32 s21, s2, 2
    s_add_u32 s21, s21, s19
    s_mul_i32 s34, s19, 13824
    v_lshlrev_b32 v3, 4, v1
    s_lshl_b32 s35, s21, 12
    s_mul_i32 s37, s21, 4352
    s_add_u32 s37, s37, 0
    v_lshrrev_b32 v4, 3, v0
    v_mul_u32_u24 v4, 20480, v4
    s_lshr_b32 s38, s2, 1
    s_and_b32 s38, s38, 7
    v_and_b32 v5, 7, v0
    v_xor_b32 v5, s38, v5
    v_lshl_add_u32 v4, v5, 4, v4
    s_lshl_b32 s38, s2, 7
    v_lshl_add_u32 v5, v1, 2, s34
    v_mov_b32 v6, 0
    v_and_b32 v7, 15, v1
    v_bfe_u32 v8, v1, 4, 1
    v_lshrrev_b32 v9, 5, v1
    v_and_b32 v14, 31, v1
    v_lshlrev_b32 v14, 3, v14
    v_lshl_add_u32 v14, v9, 4, v14
    v_add_u32 v14, s34, v14
    v_and_b32 v17, 1, v1
    v_mul_u32_u24 v17, 9464, v17
    v_sub_u32 v17, 9472, v17
    v_add_u32 v14, v17, v14
    s_cmp_ge_u32 s20, 4
    s_cbranch_scc1 p_convP
    s_add_u32 s36, s34, 256
    s_mov_b32 m0, s36
    ds_write_b32 v5, v6
    buffer_load_dwordx4 v3, s[24:27], s35 offen offset:0 nt lds
    buffer_load_dwordx4 v3, s[24:27], s35 offen offset:1024 nt lds
    buffer_load_dwordx4 v3, s[24:27], s35 offen offset:2048 nt lds
    buffer_load_dwordx4 v3, s[24:27], s35 offen offset:3072 nt lds
    v_mul_u32_u24 v10, 272, v7
    v_lshl_add_u32 v10, v9, 4, v10
    v_add_u32 v10, s34, v10
    v_add_u32 v10, 4356, v10
    v_lshlrev_b32 v11, 2, v8
    v_sub_u32 v10, v10, v11
    s_cmp_lg_u32 s20, 0
    s_cbranch_scc1 prep_kernel_w014
    v_mov_b32 v16, 0
    buffer_load_dword v17, v16, s[48:51], 0 offen sc1
    s_waitcnt vmcnt(0)
    s_mov_b32 s47, 0
prep_kernel_nn15:
    v_readfirstlane_b32 s46, v17
    s_add_u32 s47, s47, 1
    s_cmp_lg_u32 s46, 0
    s_cbranch_scc1 prep_kernel_nd16
    s_cmp_ge_u32 s47, 200000
    s_cbranch_scc1 prep_kernel_nd16
    buffer_load_dword v17, v16, s[48:51], 0 offen sc1
    s_waitcnt vmcnt(0)
    s_branch prep_kernel_nn15
prep_kernel_nd16:
    s_lshr_b32 s40, s2, 4
    s_lshl_b32 s40, s40, 12
    s_add_u32 s40, s40, 29642752
    v_lshlrev_b32 v16, 7, v1
    s_mov_b32 s47, 0
    s_mov_b32 exec_lo, -1
    s_mov_b32 exec_hi, 0
prep_kernel_pl17:
    buffer_load_dword v17, v16, s[28:31], s40 offen sc1
    s_add_u32 s47, s47, 1
    s_waitcnt vmcnt(0)
    v_cmp_ne_u32 vcc, s46, v17
    s_cmp_ge_u32 s47, 200000
    s_cbranch_scc1 prep_kernel_pd18
    s_cbranch_vccz prep_kernel_pd18
    s_sleep 14
    s_branch prep_kernel_pl17
prep_kernel_pd18:
    s_mov_b64 exec, -1
prep_kernel_w014:
    s_barrier
    s_add_u32 s36, s34, 4352
    s_mov_b32 m0, s36
    s_nop 0
    buffer_load_dwordx4 v3, s[28:31], s37 offen offset:0 sc1 lds
    buffer_load_dwordx4 v3, s[28:31], s37 offen offset:1024 sc1 lds
    buffer_load_dwordx4 v3, s[28:31], s37 offen offset:2048 sc1 lds
    buffer_load_dwordx4 v3, s[28:31], s37 offen offset:3072 sc1 lds
    s_add_u32 s36, s34, 8448
    s_mov_b32 m0, s36
    s_add_u32 s37, s37, 4096
    buffer_load_dwordx4 v3, s[28:31], s37 offen sc1 lds
    s_waitcnt vmcnt(0) lgkmcnt(0)
    s_barrier
    ds_read2_b32 v[64:65], v10 offset0:0 offset1:1
    ds_read2_b32 v[66:67], v10 offset0:2 offset1:3
    ds_read2_b32 v[68:69], v10 offset0:8 offset1:9
    ds_read2_b32 v[70:71], v10 offset0:10 offset1:11
    ds_read2_b32 v[72:73], v10 offset0:16 offset1:17
    ds_read2_b32 v[74:75], v10 offset0:18 offset1:19
    ds_read2_b32 v[76:77], v10 offset0:24 offset1:25
    ds_read2_b32 v[78:79], v10 offset0:26 offset1:27
    ds_read2_b32 v[80:81], v10 offset0:32 offset1:33
    ds_read2_b32 v[82:83], v10 offset0:34 offset1:35
    ds_read2_b32 v[84:85], v10 offset0:40 offset1:41
    ds_read2_b32 v[86:87], v10 offset0:42 offset1:43
    ds_read2_b32 v[88:89], v10 offset0:48 offset1:49
    ds_read2_b32 v[90:91], v10 offset0:50 offset1:51
    ds_read2_b32 v[92:93], v10 offset0:56 offset1:57
    ds_read2_b32 v[94:95], v10 offset0:58 offset1:59
    ds_read_b32 v16, v10 offset:16
    ds_read_b32 v17, v10 offset:48
    ds_read_b32 v18, v10 offset:80
    ds_read_b32 v19, v10 offset:112
    ds_read_b32 v20, v10 offset:144
    ds_read_b32 v21, v10 offset:176
    ds_read_b32 v22, v10 offset:208
    ds_read_b32 v23, v10 offset:240
    s_waitcnt lgkmcnt(8)
    ds_read_b128 v[208:211], v14 offset:1792
    ds_read_b128 v[212:215], v14 offset:1824
    ds_read_b128 v[216:219], v14 offset:1856
    ds_read_b128 v[220:223], v14 offset:1888
    ds_read_b128 v[224:227], v14 offset:1920
    ds_read_b128 v[228:231], v14 offset:1952
    ds_read_b128 v[232:235], v14 offset:1984
    ds_read_b128 v[236:239], v14 offset:2016
    s_waitcnt lgkmcnt(0)
    v_mfma_f32_32x32x16_bf16 v[144:159], v[208:211], v[64:67], 0
    v_alignbit_b32 v32, v65, v64, 16
    v_alignbit_b32 v33, v66, v65, 16
    v_alignbit_b32 v34, v67, v66, 16
    v_alignbit_b32 v35, v16, v67, 16
    v_mfma_f32_32x32x16_bf16 v[144:159], v[212:215], v[68:71], v[144:159]
    v_alignbit_b32 v36, v69, v68, 16
    v_alignbit_b32 v37, v70, v69, 16
    v_alignbit_b32 v38, v71, v70, 16
    v_alignbit_b32 v39, v17, v71, 16
    v_mfma_f32_32x32x16_bf16 v[144:159], v[216:219], v[72:75], v[144:159]
    v_alignbit_b32 v40, v73, v72, 16
    v_alignbit_b32 v41, v74, v73, 16
    v_alignbit_b32 v42, v75, v74, 16
    v_alignbit_b32 v43, v18, v75, 16
    v_mfma_f32_32x32x16_bf16 v[144:159], v[220:223], v[76:79], v[144:159]
    v_alignbit_b32 v44, v77, v76, 16
    v_alignbit_b32 v45, v78, v77, 16
    v_alignbit_b32 v46, v79, v78, 16
    v_alignbit_b32 v47, v19, v79, 16
    v_mfma_f32_32x32x16_bf16 v[144:159], v[224:227], v[80:83], v[144:159]
    v_alignbit_b32 v48, v81, v80, 16
    v_alignbit_b32 v49, v82, v81, 16
    v_alignbit_b32 v50, v83, v82, 16
    v_alignbit_b32 v51, v20, v83, 16
    v_mfma_f32_32x32x16_bf16 v[144:159], v[228:231], v[84:87], v[144:159]
    v_alignbit_b32 v52, v85, v84, 16
    v_alignbit_b32 v53, v86, v85, 16
    v_alignbit_b32 v54, v87, v86, 16
    v_alignbit_b32 v55, v21, v87, 16
    v_mfma_f32_32x32x16_bf16 v[144:159], v[232:235], v[88:91], v[144:159]
    v_alignbit_b32 v56, v89, v88, 16
    v_alignbit_b32 v57, v90, v89, 16
    v_alignbit_b32 v58, v91, v90, 16
    v_alignbit_b32 v59, v22, v91, 16
    v_mfma_f32_32x32x16_bf16 v[144:159], v[236:239], v[92:95], v[144:159]
    v_alignbit_b32 v60, v93, v92, 16
    v_alignbit_b32 v61, v94, v93, 16
    v_alignbit_b32 v62, v95, v94, 16
    v_alignbit_b32 v63, v23, v95, 16
    s_nop 1
    v_mfma_f32_32x32x16_bf16 v[128:143], v[208:211], v[32:35], 0
    ds_read_b128 v[176:179], v14 offset:1536
    ds_read_b128 v[180:183], v14 offset:1568
    s_nop 2
    v_mfma_f32_32x32x16_bf16 v[128:143], v[212:215], v[36:39], v[128:143]
    ds_read_b128 v[184:187], v14 offset:1600
    ds_read_b128 v[188:191], v14 offset:1632
    s_nop 2
    v_mfma_f32_32x32x16_bf16 v[128:143], v[216:219], v[40:43], v[128:143]
    ds_read_b128 v[192:195], v14 offset:1664
    v_mov_b32_dpp v144, v144 row_shr:1 row_mask:0xf bank_mask:0xf bound_ctrl:0
    v_mov_b32_dpp v145, v145 row_shr:1 row_mask:0xf bank_mask:0xf bound_ctrl:0
    v_mov_b32_dpp v146, v146 row_shr:1 row_mask:0xf bank_mask:0xf bound_ctrl:0
    v_mfma_f32_32x32x16_bf16 v[128:143], v[220:223], v[44:47], v[128:143]
    ds_read_b128 v[196:199], v14 offset:1696
    v_mov_b32_dpp v147, v147 row_shr:1 row_mask:0xf bank_mask:0xf bound_ctrl:0
    v_mov_b32_dpp v148, v148 row_shr:1 row_mask:0xf bank_mask:0xf bound_ctrl:0
    v_mov_b32_dpp v149, v149 row_shr:1 row_mask:0xf bank_mask:0xf bound_ctrl:0
    v_mfma_f32_32x32x16_bf16 v[128:143], v[224:227], v[48:51], v[128:143]
    ds_read_b128 v[200:203], v14 offset:1728
    v_mov_b32_dpp v150, v150 row_shr:1 row_mask:0xf bank_mask:0xf bound_ctrl:0
    v_mov_b32_dpp v151, v151 row_shr:1 row_mask:0xf bank_mask:0xf bound_ctrl:0
    v_mov_b32_dpp v152, v152 row_shr:1 row_mask:0xf bank_mask:0xf bound_ctrl:0
    v_mfma_f32_32x32x16_bf16 v[128:143], v[228:231], v[52:55], v[128:143]
    ds_read_b128 v[204:207], v14 offset:1760
    v_mov_b32_dpp v153, v153 row_shr:1 row_mask:0xf bank_mask:0xf bound_ctrl:0
    v_mov_b32_dpp v154, v154 row_shr:1 row_mask:0xf bank_mask:0xf bound_ctrl:0
    v_mov_b32_dpp v155, v155 row_shr:1 row_mask:0xf bank_mask:0xf bound_ctrl:0
    v_mfma_f32_32x32x16_bf16 v[128:143], v[232:235], v[56:59], v[128:143]
    v_mov_b32_dpp v156, v156 row_shr:1 row_mask:0xf bank_mask:0xf bound_ctrl:0
    v_mov_b32_dpp v157, v157 row_shr:1 row_mask:0xf bank_mask:0xf bound_ctrl:0
    v_mfma_f32_32x32x16_bf16 v[128:143], v[236:239], v[60:63], v[128:143]
    v_mov_b32_dpp v158, v158 row_shr:1 row_mask:0xf bank_mask:0xf bound_ctrl:0
    v_mov_b32_dpp v159, v159 row_shr:1 row_mask:0xf bank_mask:0xf bound_ctrl:0
    s_waitcnt lgkmcnt(0)
    s_nop 0
    v_mfma_f32_32x32x16_bf16 v[144:159], v[176:179], v[64:67], v[144:159]
    s_nop 4
    v_mfma_f32_32x32x16_bf16 v[144:159], v[180:183], v[68:71], v[144:159]
    s_nop 4
    v_mfma_f32_32x32x16_bf16 v[144:159], v[184:187], v[72:75], v[144:159]
    v_mov_b32_dpp v128, v128 row_shr:1 row_mask:0xf bank_mask:0xf bound_ctrl:0
    v_mov_b32_dpp v129, v129 row_shr:1 row_mask:0xf bank_mask:0xf bound_ctrl:0
    v_mov_b32_dpp v130, v130 row_shr:1 row_mask:0xf bank_mask:0xf bound_ctrl:0
    v_mfma_f32_32x32x16_bf16 v[144:159], v[188:191], v[76:79], v[144:159]
    v_mov_b32_dpp v131, v131 row_shr:1 row_mask:0xf bank_mask:0xf bound_ctrl:0
    v_mov_b32_dpp v132, v132 row_shr:1 row_mask:0xf bank_mask:0xf bound_ctrl:0
    v_mov_b32_dpp v133, v133 row_shr:1 row_mask:0xf bank_mask:0xf bound_ctrl:0
    v_mfma_f32_32x32x16_bf16 v[144:159], v[192:195], v[80:83], v[144:159]
    v_mov_b32_dpp v134, v134 row_shr:1 row_mask:0xf bank_mask:0xf bound_ctrl:0
    v_mov_b32_dpp v135, v135 row_shr:1 row_mask:0xf bank_mask:0xf bound_ctrl:0
    v_mov_b32_dpp v136, v136 row_shr:1 row_mask:0xf bank_mask:0xf bound_ctrl:0
    v_mfma_f32_32x32x16_bf16 v[144:159], v[196:199], v[84:87], v[144:159]
    v_mov_b32_dpp v137, v137 row_shr:1 row_mask:0xf bank_mask:0xf bound_ctrl:0
    v_mov_b32_dpp v138, v138 row_shr:1 row_mask:0xf bank_mask:0xf bound_ctrl:0
    v_mov_b32_dpp v139, v139 row_shr:1 row_mask:0xf bank_mask:0xf bound_ctrl:0
    v_mfma_f32_32x32x16_bf16 v[144:159], v[200:203], v[88:91], v[144:159]
    v_mov_b32_dpp v140, v140 row_shr:1 row_mask:0xf bank_mask:0xf bound_ctrl:0
    v_mov_b32_dpp v141, v141 row_shr:1 row_mask:0xf bank_mask:0xf bound_ctrl:0
    v_mfma_f32_32x32x16_bf16 v[144:159], v[204:207], v[92:95], v[144:159]
    v_mov_b32_dpp v142, v142 row_shr:1 row_mask:0xf bank_mask:0xf bound_ctrl:0
    v_mov_b32_dpp v143, v143 row_shr:1 row_mask:0xf bank_mask:0xf bound_ctrl:0
    s_nop 1
    v_mfma_f32_32x32x16_bf16 v[128:143], v[176:179], v[32:35], v[128:143]
    ds_read_b128 v[208:211], v14 offset:1280
    ds_read_b128 v[212:215], v14 offset:1312
    s_nop 2
    v_mfma_f32_32x32x16_bf16 v[128:143], v[180:183], v[36:39], v[128:143]
    ds_read_b128 v[216:219], v14 offset:1344
    ds_read_b128 v[220:223], v14 offset:1376
    s_nop 2
    v_mfma_f32_32x32x16_bf16 v[128:143], v[184:187], v[40:43], v[128:143]
    ds_read_b128 v[224:227], v14 offset:1408
    v_mov_b32_dpp v144, v144 row_shr:1 row_mask:0xf bank_mask:0xf bound_ctrl:0
    v_mov_b32_dpp v145, v145 row_shr:1 row_mask:0xf bank_mask:0xf bound_ctrl:0
    v_mov_b32_dpp v146, v146 row_shr:1 row_mask:0xf bank_mask:0xf bound_ctrl:0
    v_mfma_f32_32x32x16_bf16 v[128:143], v[188:191], v[44:47], v[128:143]
    ds_read_b128 v[228:231], v14 offset:1440
    v_mov_b32_dpp v147, v147 row_shr:1 row_mask:0xf bank_mask:0xf bound_ctrl:0
    v_mov_b32_dpp v148, v148 row_shr:1 row_mask:0xf bank_mask:0xf bound_ctrl:0
    v_mov_b32_dpp v149, v149 row_shr:1 row_mask:0xf bank_mask:0xf bound_ctrl:0
    v_mfma_f32_32x32x16_bf16 v[128:143], v[192:195], v[48:51], v[128:143]
    ds_read_b128 v[232:235], v14 offset:1472
    v_mov_b32_dpp v150, v150 row_shr:1 row_mask:0xf bank_mask:0xf bound_ctrl:0
    v_mov_b32_dpp v151, v151 row_shr:1 row_mask:0xf bank_mask:0xf bound_ctrl:0
    v_mov_b32_dpp v152, v152 row_shr:1 row_mask:0xf bank_mask:0xf bound_ctrl:0
    v_mfma_f32_32x32x16_bf16 v[128:143], v[196:199], v[52:55], v[128:143]
    ds_read_b128 v[236:239], v14 offset:1504
    v_mov_b32_dpp v153, v153 row_shr:1 row_mask:0xf bank_mask:0xf bound_ctrl:0
    v_mov_b32_dpp v154, v154 row_shr:1 row_mask:0xf bank_mask:0xf bound_ctrl:0
    v_mov_b32_dpp v155, v155 row_shr:1 row_mask:0xf bank_mask:0xf bound_ctrl:0
    v_mfma_f32_32x32x16_bf16 v[128:143], v[200:203], v[56:59], v[128:143]
    v_mov_b32_dpp v156, v156 row_shr:1 row_mask:0xf bank_mask:0xf bound_ctrl:0
    v_mov_b32_dpp v157, v157 row_shr:1 row_mask:0xf bank_mask:0xf bound_ctrl:0
    v_mfma_f32_32x32x16_bf16 v[128:143], v[204:207], v[60:63], v[128:143]
    v_mov_b32_dpp v158, v158 row_shr:1 row_mask:0xf bank_mask:0xf bound_ctrl:0
    v_mov_b32_dpp v159, v159 row_shr:1 row_mask:0xf bank_mask:0xf bound_ctrl:0
    s_waitcnt lgkmcnt(0)
    s_nop 0
    v_mfma_f32_32x32x16_bf16 v[144:159], v[208:211], v[64:67], v[144:159]
    s_nop 4
    v_mfma_f32_32x32x16_bf16 v[144:159], v[212:215], v[68:71], v[144:159]
    s_nop 4
    v_mfma_f32_32x32x16_bf16 v[144:159], v[216:219], v[72:75], v[144:159]
    v_mov_b32_dpp v128, v128 row_shr:1 row_mask:0xf bank_mask:0xf bound_ctrl:0
    v_mov_b32_dpp v129, v129 row_shr:1 row_mask:0xf bank_mask:0xf bound_ctrl:0
    v_mov_b32_dpp v130, v130 row_shr:1 row_mask:0xf bank_mask:0xf bound_ctrl:0
    v_mfma_f32_32x32x16_bf16 v[144:159], v[220:223], v[76:79], v[144:159]
    v_mov_b32_dpp v131, v131 row_shr:1 row_mask:0xf bank_mask:0xf bound_ctrl:0
    v_mov_b32_dpp v132, v132 row_shr:1 row_mask:0xf bank_mask:0xf bound_ctrl:0
    v_mov_b32_dpp v133, v133 row_shr:1 row_mask:0xf bank_mask:0xf bound_ctrl:0
    v_mfma_f32_32x32x16_bf16 v[144:159], v[224:227], v[80:83], v[144:159]
    v_mov_b32_dpp v134, v134 row_shr:1 row_mask:0xf bank_mask:0xf bound_ctrl:0
    v_mov_b32_dpp v135, v135 row_shr:1 row_mask:0xf bank_mask:0xf bound_ctrl:0
    v_mov_b32_dpp v136, v136 row_shr:1 row_mask:0xf bank_mask:0xf bound_ctrl:0
    v_mfma_f32_32x32x16_bf16 v[144:159], v[228:231], v[84:87], v[144:159]
    v_mov_b32_dpp v137, v137 row_shr:1 row_mask:0xf bank_mask:0xf bound_ctrl:0
    v_mov_b32_dpp v138, v138 row_shr:1 row_mask:0xf bank_mask:0xf bound_ctrl:0
    v_mov_b32_dpp v139, v139 row_shr:1 row_mask:0xf bank_mask:0xf bound_ctrl:0
    v_mfma_f32_32x32x16_bf16 v[144:159], v[232:235], v[88:91], v[144:159]
    v_mov_b32_dpp v140, v140 row_shr:1 row_mask:0xf bank_mask:0xf bound_ctrl:0
    v_mov_b32_dpp v141, v141 row_shr:1 row_mask:0xf bank_mask:0xf bound_ctrl:0
    v_mfma_f32_32x32x16_bf16 v[144:159], v[236:239], v[92:95], v[144:159]
    v_mov_b32_dpp v142, v142 row_shr:1 row_mask:0xf bank_mask:0xf bound_ctrl:0
    v_mov_b32_dpp v143, v143 row_shr:1 row_mask:0xf bank_mask:0xf bound_ctrl:0
    s_nop 1
    v_mfma_f32_32x32x16_bf16 v[128:143], v[208:211], v[32:35], v[128:143]
    ds_read_b128 v[176:179], v14 offset:1024
    ds_read_b128 v[180:183], v14 offset:1056
    s_nop 2
    v_mfma_f32_32x32x16_bf16 v[128:143], v[212:215], v[36:39], v[128:143]
    ds_read_b128 v[184:187], v14 offset:1088
    ds_read_b128 v[188:191], v14 offset:1120
    s_nop 2
    v_mfma_f32_32x32x16_bf16 v[128:143], v[216:219], v[40:43], v[128:143]
    ds_read_b128 v[192:195], v14 offset:1152
    v_mov_b32_dpp v144, v144 row_shr:1 row_mask:0xf bank_mask:0xf bound_ctrl:0
    v_mov_b32_dpp v145, v145 row_shr:1 row_mask:0xf bank_mask:0xf bound_ctrl:0
    v_mov_b32_dpp v146, v146 row_shr:1 row_mask:0xf bank_mask:0xf bound_ctrl:0
    v_mfma_f32_32x32x16_bf16 v[128:143], v[220:223], v[44:47], v[128:143]
    ds_read_b128 v[196:199], v14 offset:1184
    v_mov_b32_dpp v147, v147 row_shr:1 row_mask:0xf bank_mask:0xf bound_ctrl:0
    v_mov_b32_dpp v148, v148 row_shr:1 row_mask:0xf bank_mask:0xf bound_ctrl:0
    v_mov_b32_dpp v149, v149 row_shr:1 row_mask:0xf bank_mask:0xf bound_ctrl:0
    v_mfma_f32_32x32x16_bf16 v[128:143], v[224:227], v[48:51], v[128:143]
    ds_read_b128 v[200:203], v14 offset:1216
    v_mov_b32_dpp v150, v150 row_shr:1 row_mask:0xf bank_mask:0xf bound_ctrl:0
    v_mov_b32_dpp v151, v151 row_shr:1 row_mask:0xf bank_mask:0xf bound_ctrl:0
    v_mov_b32_dpp v152, v152 row_shr:1 row_mask:0xf bank_mask:0xf bound_ctrl:0
    v_mfma_f32_32x32x16_bf16 v[128:143], v[228:231], v[52:55], v[128:143]
    ds_read_b128 v[204:207], v14 offset:1248
    v_mov_b32_dpp v153, v153 row_shr:1 row_mask:0xf bank_mask:0xf bound_ctrl:0
    v_mov_b32_dpp v154, v154 row_shr:1 row_mask:0xf bank_mask:0xf bound_ctrl:0
    v_mov_b32_dpp v155, v155 row_shr:1 row_mask:0xf bank_mask:0xf bound_ctrl:0
    v_mfma_f32_32x32x16_bf16 v[128:143], v[232:235], v[56:59], v[128:143]
    v_mov_b32_dpp v156, v156 row_shr:1 row_mask:0xf bank_mask:0xf bound_ctrl:0
    v_mov_b32_dpp v157, v157 row_shr:1 row_mask:0xf bank_mask:0xf bound_ctrl:0
    v_mfma_f32_32x32x16_bf16 v[128:143], v[236:239], v[60:63], v[128:143]
    v_mov_b32_dpp v158, v158 row_shr:1 row_mask:0xf bank_mask:0xf bound_ctrl:0
    v_mov_b32_dpp v159, v159 row_shr:1 row_mask:0xf bank_mask:0xf bound_ctrl:0
    s_waitcnt lgkmcnt(0)
    s_nop 0
    v_mfma_f32_32x32x16_bf16 v[144:159], v[176:179], v[64:67], v[144:159]
    s_nop 4
    v_mfma_f32_32x32x16_bf16 v[144:159], v[180:183], v[68:71], v[144:159]
    s_nop 4
    v_mfma_f32_32x32x16_bf16 v[144:159], v[184:187], v[72:75], v[144:159]
    v_mov_b32_dpp v128, v128 row_shr:1 row_mask:0xf bank_mask:0xf bound_ctrl:0
    v_mov_b32_dpp v129, v129 row_shr:1 row_mask:0xf bank_mask:0xf bound_ctrl:0
    v_mov_b32_dpp v130, v130 row_shr:1 row_mask:0xf bank_mask:0xf bound_ctrl:0
    v_mfma_f32_32x32x16_bf16 v[144:159], v[188:191], v[76:79], v[144:159]
    v_mov_b32_dpp v131, v131 row_shr:1 row_mask:0xf bank_mask:0xf bound_ctrl:0
    v_mov_b32_dpp v132, v132 row_shr:1 row_mask:0xf bank_mask:0xf bound_ctrl:0
    v_mov_b32_dpp v133, v133 row_shr:1 row_mask:0xf bank_mask:0xf bound_ctrl:0
    v_mfma_f32_32x32x16_bf16 v[144:159], v[192:195], v[80:83], v[144:159]
    v_mov_b32_dpp v134, v134 row_shr:1 row_mask:0xf bank_mask:0xf bound_ctrl:0
    v_mov_b32_dpp v135, v135 row_shr:1 row_mask:0xf bank_mask:0xf bound_ctrl:0
    v_mov_b32_dpp v136, v136 row_shr:1 row_mask:0xf bank_mask:0xf bound_ctrl:0
    v_mfma_f32_32x32x16_bf16 v[144:159], v[196:199], v[84:87], v[144:159]
    v_mov_b32_dpp v137, v137 row_shr:1 row_mask:0xf bank_mask:0xf bound_ctrl:0
    v_mov_b32_dpp v138, v138 row_shr:1 row_mask:0xf bank_mask:0xf bound_ctrl:0
    v_mov_b32_dpp v139, v139 row_shr:1 row_mask:0xf bank_mask:0xf bound_ctrl:0
    v_mfma_f32_32x32x16_bf16 v[144:159], v[200:203], v[88:91], v[144:159]
    v_mov_b32_dpp v140, v140 row_shr:1 row_mask:0xf bank_mask:0xf bound_ctrl:0
    v_mov_b32_dpp v141, v141 row_shr:1 row_mask:0xf bank_mask:0xf bound_ctrl:0
    v_mfma_f32_32x32x16_bf16 v[144:159], v[204:207], v[92:95], v[144:159]
    v_mov_b32_dpp v142, v142 row_shr:1 row_mask:0xf bank_mask:0xf bound_ctrl:0
    v_mov_b32_dpp v143, v143 row_shr:1 row_mask:0xf bank_mask:0xf bound_ctrl:0
    s_nop 1
    v_mfma_f32_32x32x16_bf16 v[128:143], v[176:179], v[32:35], v[128:143]
    ds_read_b128 v[208:211], v14 offset:768
    ds_read_b128 v[212:215], v14 offset:800
    s_nop 2
    v_mfma_f32_32x32x16_bf16 v[128:143], v[180:183], v[36:39], v[128:143]
    ds_read_b128 v[216:219], v14 offset:832
    ds_read_b128 v[220:223], v14 offset:864
    s_nop 2
    v_mfma_f32_32x32x16_bf16 v[128:143], v[184:187], v[40:43], v[128:143]
    ds_read_b128 v[224:227], v14 offset:896
    v_mov_b32_dpp v144, v144 row_shr:1 row_mask:0xf bank_mask:0xf bound_ctrl:0
    v_mov_b32_dpp v145, v145 row_shr:1 row_mask:0xf bank_mask:0xf bound_ctrl:0
    v_mov_b32_dpp v146, v146 row_shr:1 row_mask:0xf bank_mask:0xf bound_ctrl:0
    v_mfma_f32_32x32x16_bf16 v[128:143], v[188:191], v[44:47], v[128:143]
    ds_read_b128 v[228:231], v14 offset:928
    v_mov_b32_dpp v147, v147 row_shr:1 row_mask:0xf bank_mask:0xf bound_ctrl:0
    v_mov_b32_dpp v148, v148 row_shr:1 row_mask:0xf bank_mask:0xf bound_ctrl:0
    v_mov_b32_dpp v149, v149 row_shr:1 row_mask:0xf bank_mask:0xf bound_ctrl:0
    v_mfma_f32_32x32x16_bf16 v[128:143], v[192:195], v[48:51], v[128:143]
    ds_read_b128 v[232:235], v14 offset:960
    v_mov_b32_dpp v150, v150 row_shr:1 row_mask:0xf bank_mask:0xf bound_ctrl:0
    v_mov_b32_dpp v151, v151 row_shr:1 row_mask:0xf bank_mask:0xf bound_ctrl:0
    v_mov_b32_dpp v152, v152 row_shr:1 row_mask:0xf bank_mask:0xf bound_ctrl:0
    v_mfma_f32_32x32x16_bf16 v[128:143], v[196:199], v[52:55], v[128:143]
    ds_read_b128 v[236:239], v14 offset:992
    v_mov_b32_dpp v153, v153 row_shr:1 row_mask:0xf bank_mask:0xf bound_ctrl:0
    v_mov_b32_dpp v154, v154 row_shr:1 row_mask:0xf bank_mask:0xf bound_ctrl:0
    v_mov_b32_dpp v155, v155 row_shr:1 row_mask:0xf bank_mask:0xf bound_ctrl:0
    v_mfma_f32_32x32x16_bf16 v[128:143], v[200:203], v[56:59], v[128:143]
    v_mov_b32_dpp v156, v156 row_shr:1 row_mask:0xf bank_mask:0xf bound_ctrl:0
    v_mov_b32_dpp v157, v157 row_shr:1 row_mask:0xf bank_mask:0xf bound_ctrl:0
    v_mfma_f32_32x32x16_bf16 v[128:143], v[204:207], v[60:63], v[128:143]
    v_mov_b32_dpp v158, v158 row_shr:1 row_mask:0xf bank_mask:0xf bound_ctrl:0
    v_mov_b32_dpp v159, v159 row_shr:1 row_mask:0xf bank_mask:0xf bound_ctrl:0
    s_waitcnt lgkmcnt(0)
    s_nop 0
    v_mfma_f32_32x32x16_bf16 v[144:159], v[208:211], v[64:67], v[144:159]
    s_nop 4
    v_mfma_f32_32x32x16_bf16 v[144:159], v[212:215], v[68:71], v[144:159]
    s_nop 4
    v_mfma_f32_32x32x16_bf16 v[144:159], v[216:219], v[72:75], v[144:159]
    v_mov_b32_dpp v128, v128 row_shr:1 row_mask:0xf bank_mask:0xf bound_ctrl:0
    v_mov_b32_dpp v129, v129 row_shr:1 row_mask:0xf bank_mask:0xf bound_ctrl:0
    v_mov_b32_dpp v130, v130 row_shr:1 row_mask:0xf bank_mask:0xf bound_ctrl:0
    v_mfma_f32_32x32x16_bf16 v[144:159], v[220:223], v[76:79], v[144:159]
    v_mov_b32_dpp v131, v131 row_shr:1 row_mask:0xf bank_mask:0xf bound_ctrl:0
    v_mov_b32_dpp v132, v132 row_shr:1 row_mask:0xf bank_mask:0xf bound_ctrl:0
    v_mov_b32_dpp v133, v133 row_shr:1 row_mask:0xf bank_mask:0xf bound_ctrl:0
    v_mfma_f32_32x32x16_bf16 v[144:159], v[224:227], v[80:83], v[144:159]
    v_mov_b32_dpp v134, v134 row_shr:1 row_mask:0xf bank_mask:0xf bound_ctrl:0
    v_mov_b32_dpp v135, v135 row_shr:1 row_mask:0xf bank_mask:0xf bound_ctrl:0
    v_mov_b32_dpp v136, v136 row_shr:1 row_mask:0xf bank_mask:0xf bound_ctrl:0
    v_mfma_f32_32x32x16_bf16 v[144:159], v[228:231], v[84:87], v[144:159]
    v_mov_b32_dpp v137, v137 row_shr:1 row_mask:0xf bank_mask:0xf bound_ctrl:0
    v_mov_b32_dpp v138, v138 row_shr:1 row_mask:0xf bank_mask:0xf bound_ctrl:0
    v_mov_b32_dpp v139, v139 row_shr:1 row_mask:0xf bank_mask:0xf bound_ctrl:0
    v_mfma_f32_32x32x16_bf16 v[144:159], v[232:235], v[88:91], v[144:159]
    v_mov_b32_dpp v140, v140 row_shr:1 row_mask:0xf bank_mask:0xf bound_ctrl:0
    v_mov_b32_dpp v141, v141 row_shr:1 row_mask:0xf bank_mask:0xf bound_ctrl:0
    v_mfma_f32_32x32x16_bf16 v[144:159], v[236:239], v[92:95], v[144:159]
    v_mov_b32_dpp v142, v142 row_shr:1 row_mask:0xf bank_mask:0xf bound_ctrl:0
    v_mov_b32_dpp v143, v143 row_shr:1 row_mask:0xf bank_mask:0xf bound_ctrl:0
    s_nop 1
    v_mfma_f32_32x32x16_bf16 v[128:143], v[208:211], v[32:35], v[128:143]
    ds_read_b128 v[176:179], v14 offset:512
    ds_read_b128 v[180:183], v14 offset:544
    s_nop 2
    v_mfma_f32_32x32x16_bf16 v[128:143], v[212:215], v[36:39], v[128:143]
    ds_read_b128 v[184:187], v14 offset:576
    ds_read_b128 v[188:191], v14 offset:608
    s_nop 2
    v_mfma_f32_32x32x16_bf16 v[128:143], v[216:219], v[40:43], v[128:143]
    ds_read_b128 v[192:195], v14 offset:640
    v_mov_b32_dpp v144, v144 row_shr:1 row_mask:0xf bank_mask:0xf bound_ctrl:0
    v_mov_b32_dpp v145, v145 row_shr:1 row_mask:0xf bank_mask:0xf bound_ctrl:0
    v_mov_b32_dpp v146, v146 row_shr:1 row_mask:0xf bank_mask:0xf bound_ctrl:0
    v_mfma_f32_32x32x16_bf16 v[128:143], v[220:223], v[44:47], v[128:143]
    ds_read_b128 v[196:199], v14 offset:672
    v_mov_b32_dpp v147, v147 row_shr:1 row_mask:0xf bank_mask:0xf bound_ctrl:0
    v_mov_b32_dpp v148, v148 row_shr:1 row_mask:0xf bank_mask:0xf bound_ctrl:0
    v_mov_b32_dpp v149, v149 row_shr:1 row_mask:0xf bank_mask:0xf bound_ctrl:0
    v_mfma_f32_32x32x16_bf16 v[128:143], v[224:227], v[48:51], v[128:143]
    ds_read_b128 v[200:203], v14 offset:704
    v_mov_b32_dpp v150, v150 row_shr:1 row_mask:0xf bank_mask:0xf bound_ctrl:0
    v_mov_b32_dpp v151, v151 row_shr:1 row_mask:0xf bank_mask:0xf bound_ctrl:0
    v_mov_b32_dpp v152, v152 row_shr:1 row_mask:0xf bank_mask:0xf bound_ctrl:0
    v_mfma_f32_32x32x16_bf16 v[128:143], v[228:231], v[52:55], v[128:143]
    ds_read_b128 v[204:207], v14 offset:736
    v_mov_b32_dpp v153, v153 row_shr:1 row_mask:0xf bank_mask:0xf bound_ctrl:0
    v_mov_b32_dpp v154, v154 row_shr:1 row_mask:0xf bank_mask:0xf bound_ctrl:0
    v_mov_b32_dpp v155, v155 row_shr:1 row_mask:0xf bank_mask:0xf bound_ctrl:0
    v_mfma_f32_32x32x16_bf16 v[128:143], v[232:235], v[56:59], v[128:143]
    v_mov_b32_dpp v156, v156 row_shr:1 row_mask:0xf bank_mask:0xf bound_ctrl:0
    v_mov_b32_dpp v157, v157 row_shr:1 row_mask:0xf bank_mask:0xf bound_ctrl:0
    v_mfma_f32_32x32x16_bf16 v[128:143], v[236:239], v[60:63], v[128:143]
    v_mov_b32_dpp v158, v158 row_shr:1 row_mask:0xf bank_mask:0xf bound_ctrl:0
    v_mov_b32_dpp v159, v159 row_shr:1 row_mask:0xf bank_mask:0xf bound_ctrl:0
    s_waitcnt lgkmcnt(0)
    s_nop 0
    v_mfma_f32_32x32x16_bf16 v[144:159], v[176:179], v[64:67], v[144:159]
    s_nop 4
    v_mfma_f32_32x32x16_bf16 v[144:159], v[180:183], v[68:71], v[144:159]
    s_nop 4
    v_mfma_f32_32x32x16_bf16 v[144:159], v[184:187], v[72:75], v[144:159]
    v_mov_b32_dpp v128, v128 row_shr:1 row_mask:0xf bank_mask:0xf bound_ctrl:0
    v_mov_b32_dpp v129, v129 row_shr:1 row_mask:0xf bank_mask:0xf bound_ctrl:0
    v_mov_b32_dpp v130, v130 row_shr:1 row_mask:0xf bank_mask:0xf bound_ctrl:0
    v_mfma_f32_32x32x16_bf16 v[144:159], v[188:191], v[76:79], v[144:159]
    v_mov_b32_dpp v131, v131 row_shr:1 row_mask:0xf bank_mask:0xf bound_ctrl:0
    v_mov_b32_dpp v132, v132 row_shr:1 row_mask:0xf bank_mask:0xf bound_ctrl:0
    v_mov_b32_dpp v133, v133 row_shr:1 row_mask:0xf bank_mask:0xf bound_ctrl:0
    v_mfma_f32_32x32x16_bf16 v[144:159], v[192:195], v[80:83], v[144:159]
    v_mov_b32_dpp v134, v134 row_shr:1 row_mask:0xf bank_mask:0xf bound_ctrl:0
    v_mov_b32_dpp v135, v135 row_shr:1 row_mask:0xf bank_mask:0xf bound_ctrl:0
    v_mov_b32_dpp v136, v136 row_shr:1 row_mask:0xf bank_mask:0xf bound_ctrl:0
    v_mfma_f32_32x32x16_bf16 v[144:159], v[196:199], v[84:87], v[144:159]
    v_mov_b32_dpp v137, v137 row_shr:1 row_mask:0xf bank_mask:0xf bound_ctrl:0
    v_mov_b32_dpp v138, v138 row_shr:1 row_mask:0xf bank_mask:0xf bound_ctrl:0
    v_mov_b32_dpp v139, v139 row_shr:1 row_mask:0xf bank_mask:0xf bound_ctrl:0
    v_mfma_f32_32x32x16_bf16 v[144:159], v[200:203], v[88:91], v[144:159]
    v_mov_b32_dpp v140, v140 row_shr:1 row_mask:0xf bank_mask:0xf bound_ctrl:0
    v_mov_b32_dpp v141, v141 row_shr:1 row_mask:0xf bank_mask:0xf bound_ctrl:0
    v_mfma_f32_32x32x16_bf16 v[144:159], v[204:207], v[92:95], v[144:159]
    v_mov_b32_dpp v142, v142 row_shr:1 row_mask:0xf bank_mask:0xf bound_ctrl:0
    v_mov_b32_dpp v143, v143 row_shr:1 row_mask:0xf bank_mask:0xf bound_ctrl:0
    s_nop 1
    v_mfma_f32_32x32x16_bf16 v[128:143], v[176:179], v[32:35], v[128:143]
    ds_read_b128 v[208:211], v14 offset:256
    ds_read_b128 v[212:215], v14 offset:288
    s_nop 2
    v_mfma_f32_32x32x16_bf16 v[128:143], v[180:183], v[36:39], v[128:143]
    ds_read_b128 v[216:219], v14 offset:320
    ds_read_b128 v[220:223], v14 offset:352
    s_nop 2
    v_mfma_f32_32x32x16_bf16 v[128:143], v[184:187], v[40:43], v[128:143]
    ds_read_b128 v[224:227], v14 offset:384
    v_mov_b32_dpp v144, v144 row_shr:1 row_mask:0xf bank_mask:0xf bound_ctrl:0
    v_mov_b32_dpp v145, v145 row_shr:1 row_mask:0xf bank_mask:0xf bound_ctrl:0
    v_mov_b32_dpp v146, v146 row_shr:1 row_mask:0xf bank_mask:0xf bound_ctrl:0
    v_mfma_f32_32x32x16_bf16 v[128:143], v[188:191], v[44:47], v[128:143]
    ds_read_b128 v[228:231], v14 offset:416
    v_mov_b32_dpp v147, v147 row_shr:1 row_mask:0xf bank_mask:0xf bound_ctrl:0
    v_mov_b32_dpp v148, v148 row_shr:1 row_mask:0xf bank_mask:0xf bound_ctrl:0
    v_mov_b32_dpp v149, v149 row_shr:1 row_mask:0xf bank_mask:0xf bound_ctrl:0
    v_mfma_f32_32x32x16_bf16 v[128:143], v[192:195], v[48:51], v[128:143]
    ds_read_b128 v[232:235], v14 offset:448
    v_mov_b32_dpp v150, v150 row_shr:1 row_mask:0xf bank_mask:0xf bound_ctrl:0
    v_mov_b32_dpp v151, v151 row_shr:1 row_mask:0xf bank_mask:0xf bound_ctrl:0
    v_mov_b32_dpp v152, v152 row_shr:1 row_mask:0xf bank_mask:0xf bound_ctrl:0
    v_mfma_f32_32x32x16_bf16 v[128:143], v[196:199], v[52:55], v[128:143]
    ds_read_b128 v[236:239], v14 offset:480
    v_mov_b32_dpp v153, v153 row_shr:1 row_mask:0xf bank_mask:0xf bound_ctrl:0
    v_mov_b32_dpp v154, v154 row_shr:1 row_mask:0xf bank_mask:0xf bound_ctrl:0
    v_mov_b32_dpp v155, v155 row_shr:1 row_mask:0xf bank_mask:0xf bound_ctrl:0
    v_mfma_f32_32x32x16_bf16 v[128:143], v[200:203], v[56:59], v[128:143]
    v_mov_b32_dpp v156, v156 row_shr:1 row_mask:0xf bank_mask:0xf bound_ctrl:0
    v_mov_b32_dpp v157, v157 row_shr:1 row_mask:0xf bank_mask:0xf bound_ctrl:0
    v_mfma_f32_32x32x16_bf16 v[128:143], v[204:207], v[60:63], v[128:143]
    v_mov_b32_dpp v158, v158 row_shr:1 row_mask:0xf bank_mask:0xf bound_ctrl:0
    v_mov_b32_dpp v159, v159 row_shr:1 row_mask:0xf bank_mask:0xf bound_ctrl:0
    s_waitcnt lgkmcnt(0)
    s_nop 0
    v_mfma_f32_32x32x16_bf16 v[144:159], v[208:211], v[64:67], v[144:159]
    s_nop 4
    v_mfma_f32_32x32x16_bf16 v[144:159], v[212:215], v[68:71], v[144:159]
    s_nop 4
    v_mfma_f32_32x32x16_bf16 v[144:159], v[216:219], v[72:75], v[144:159]
    v_mov_b32_dpp v128, v128 row_shr:1 row_mask:0xf bank_mask:0xf bound_ctrl:0
    v_mov_b32_dpp v129, v129 row_shr:1 row_mask:0xf bank_mask:0xf bound_ctrl:0
    v_mov_b32_dpp v130, v130 row_shr:1 row_mask:0xf bank_mask:0xf bound_ctrl:0
    v_mfma_f32_32x32x16_bf16 v[144:159], v[220:223], v[76:79], v[144:159]
    v_mov_b32_dpp v131, v131 row_shr:1 row_mask:0xf bank_mask:0xf bound_ctrl:0
    v_mov_b32_dpp v132, v132 row_shr:1 row_mask:0xf bank_mask:0xf bound_ctrl:0
    v_mov_b32_dpp v133, v133 row_shr:1 row_mask:0xf bank_mask:0xf bound_ctrl:0
    v_mfma_f32_32x32x16_bf16 v[144:159], v[224:227], v[80:83], v[144:159]
    v_mov_b32_dpp v134, v134 row_shr:1 row_mask:0xf bank_mask:0xf bound_ctrl:0
    v_mov_b32_dpp v135, v135 row_shr:1 row_mask:0xf bank_mask:0xf bound_ctrl:0
    v_mov_b32_dpp v136, v136 row_shr:1 row_mask:0xf bank_mask:0xf bound_ctrl:0
    v_mfma_f32_32x32x16_bf16 v[144:159], v[228:231], v[84:87], v[144:159]
    v_mov_b32_dpp v137, v137 row_shr:1 row_mask:0xf bank_mask:0xf bound_ctrl:0
    v_mov_b32_dpp v138, v138 row_shr:1 row_mask:0xf bank_mask:0xf bound_ctrl:0
    v_mov_b32_dpp v139, v139 row_shr:1 row_mask:0xf bank_mask:0xf bound_ctrl:0
    v_mfma_f32_32x32x16_bf16 v[144:159], v[232:235], v[88:91], v[144:159]
    v_mov_b32_dpp v140, v140 row_shr:1 row_mask:0xf bank_mask:0xf bound_ctrl:0
    v_mov_b32_dpp v141, v141 row_shr:1 row_mask:0xf bank_mask:0xf bound_ctrl:0
    v_mfma_f32_32x32x16_bf16 v[144:159], v[236:239], v[92:95], v[144:159]
    v_mov_b32_dpp v142, v142 row_shr:1 row_mask:0xf bank_mask:0xf bound_ctrl:0
    v_mov_b32_dpp v143, v143 row_shr:1 row_mask:0xf bank_mask:0xf bound_ctrl:0
    s_nop 1
    v_mfma_f32_32x32x16_bf16 v[128:143], v[208:211], v[32:35], v[128:143]
    ds_read_b128 v[176:179], v14 offset:0
    ds_read_b128 v[180:183], v14 offset:32
    s_nop 2
    v_mfma_f32_32x32x16_bf16 v[128:143], v[212:215], v[36:39], v[128:143]
    ds_read_b128 v[184:187], v14 offset:64
    ds_read_b128 v[188:191], v14 offset:96
    s_nop 2
    v_mfma_f32_32x32x16_bf16 v[128:143], v[216:219], v[40:43], v[128:143]
    ds_read_b128 v[192:195], v14 offset:128
    v_mov_b32_dpp v144, v144 row_shr:1 row_mask:0xf bank_mask:0xf bound_ctrl:0
    v_mov_b32_dpp v145, v145 row_shr:1 row_mask:0xf bank_mask:0xf bound_ctrl:0
    v_mov_b32_dpp v146, v146 row_shr:1 row_mask:0xf bank_mask:0xf bound_ctrl:0
    v_mfma_f32_32x32x16_bf16 v[128:143], v[220:223], v[44:47], v[128:143]
    ds_read_b128 v[196:199], v14 offset:160
    v_mov_b32_dpp v147, v147 row_shr:1 row_mask:0xf bank_mask:0xf bound_ctrl:0
    v_mov_b32_dpp v148, v148 row_shr:1 row_mask:0xf bank_mask:0xf bound_ctrl:0
    v_mov_b32_dpp v149, v149 row_shr:1 row_mask:0xf bank_mask:0xf bound_ctrl:0
    v_mfma_f32_32x32x16_bf16 v[128:143], v[224:227], v[48:51], v[128:143]
    ds_read_b128 v[200:203], v14 offset:192
    v_mov_b32_dpp v150, v150 row_shr:1 row_mask:0xf bank_mask:0xf bound_ctrl:0
    v_mov_b32_dpp v151, v151 row_shr:1 row_mask:0xf bank_mask:0xf bound_ctrl:0
    v_mov_b32_dpp v152, v152 row_shr:1 row_mask:0xf bank_mask:0xf bound_ctrl:0
    v_mfma_f32_32x32x16_bf16 v[128:143], v[228:231], v[52:55], v[128:143]
    ds_read_b128 v[204:207], v14 offset:224
    v_mov_b32_dpp v153, v153 row_shr:1 row_mask:0xf bank_mask:0xf bound_ctrl:0
    v_mov_b32_dpp v154, v154 row_shr:1 row_mask:0xf bank_mask:0xf bound_ctrl:0
    v_mov_b32_dpp v155, v155 row_shr:1 row_mask:0xf bank_mask:0xf bound_ctrl:0
    v_mfma_f32_32x32x16_bf16 v[128:143], v[232:235], v[56:59], v[128:143]
    v_mov_b32_dpp v156, v156 row_shr:1 row_mask:0xf bank_mask:0xf bound_ctrl:0
    v_mov_b32_dpp v157, v157 row_shr:1 row_mask:0xf bank_mask:0xf bound_ctrl:0
    v_mfma_f32_32x32x16_bf16 v[128:143], v[236:239], v[60:63], v[128:143]
    v_mov_b32_dpp v158, v158 row_shr:1 row_mask:0xf bank_mask:0xf bound_ctrl:0
    v_mov_b32_dpp v159, v159 row_shr:1 row_mask:0xf bank_mask:0xf bound_ctrl:0
    s_waitcnt lgkmcnt(0)
    s_nop 0
    v_mfma_f32_32x32x16_bf16 v[144:159], v[176:179], v[64:67], v[144:159]
    s_nop 4
    v_mfma_f32_32x32x16_bf16 v[144:159], v[180:183], v[68:71], v[144:159]
    s_nop 4
    v_mfma_f32_32x32x16_bf16 v[144:159], v[184:187], v[72:75], v[144:159]
    v_mov_b32_dpp v128, v128 row_shr:1 row_mask:0xf bank_mask:0xf bound_ctrl:0
    v_mov_b32_dpp v129, v129 row_shr:1 row_mask:0xf bank_mask:0xf bound_ctrl:0
    v_mov_b32_dpp v130, v130 row_shr:1 row_mask:0xf bank_mask:0xf bound_ctrl:0
    v_mfma_f32_32x32x16_bf16 v[144:159], v[188:191], v[76:79], v[144:159]
    v_mov_b32_dpp v131, v131 row_shr:1 row_mask:0xf bank_mask:0xf bound_ctrl:0
    v_mov_b32_dpp v132, v132 row_shr:1 row_mask:0xf bank_mask:0xf bound_ctrl:0
    v_mov_b32_dpp v133, v133 row_shr:1 row_mask:0xf bank_mask:0xf bound_ctrl:0
    v_mfma_f32_32x32x16_bf16 v[144:159], v[192:195], v[80:83], v[144:159]
    v_mov_b32_dpp v134, v134 row_shr:1 row_mask:0xf bank_mask:0xf bound_ctrl:0
    v_mov_b32_dpp v135, v135 row_shr:1 row_mask:0xf bank_mask:0xf bound_ctrl:0
    v_mov_b32_dpp v136, v136 row_shr:1 row_mask:0xf bank_mask:0xf bound_ctrl:0
    v_mfma_f32_32x32x16_bf16 v[144:159], v[196:199], v[84:87], v[144:159]
    v_mov_b32_dpp v137, v137 row_shr:1 row_mask:0xf bank_mask:0xf bound_ctrl:0
    v_mov_b32_dpp v138, v138 row_shr:1 row_mask:0xf bank_mask:0xf bound_ctrl:0
    v_mov_b32_dpp v139, v139 row_shr:1 row_mask:0xf bank_mask:0xf bound_ctrl:0
    v_mfma_f32_32x32x16_bf16 v[144:159], v[200:203], v[88:91], v[144:159]
    v_mov_b32_dpp v140, v140 row_shr:1 row_mask:0xf bank_mask:0xf bound_ctrl:0
    v_mov_b32_dpp v141, v141 row_shr:1 row_mask:0xf bank_mask:0xf bound_ctrl:0
    v_mfma_f32_32x32x16_bf16 v[144:159], v[204:207], v[92:95], v[144:159]
    v_mov_b32_dpp v142, v142 row_shr:1 row_mask:0xf bank_mask:0xf bound_ctrl:0
    v_mov_b32_dpp v143, v143 row_shr:1 row_mask:0xf bank_mask:0xf bound_ctrl:0
    s_nop 1
    v_mfma_f32_32x32x16_bf16 v[128:143], v[176:179], v[32:35], v[128:143]
    v_mfma_f32_32x32x16_bf16 v[128:143], v[180:183], v[36:39], v[128:143]
    v_mfma_f32_32x32x16_bf16 v[128:143], v[184:187], v[40:43], v[128:143]
    v_mfma_f32_32x32x16_bf16 v[128:143], v[188:191], v[44:47], v[128:143]
    v_mfma_f32_32x32x16_bf16 v[128:143], v[192:195], v[48:51], v[128:143]
    v_mfma_f32_32x32x16_bf16 v[128:143], v[196:199], v[52:55], v[128:143]
    v_mfma_f32_32x32x16_bf16 v[128:143], v[200:203], v[56:59], v[128:143]
    v_mfma_f32_32x32x16_bf16 v[128:143], v[204:207], v[60:63], v[128:143]
    s_nop 7
    s_barrier
    s_mul_i32 s36, s19, 4096
    s_add_u32 s36, s36, 88064
    v_lshlrev_b32 v16, 4, v1
    v_add_u32 v16, s36, v16
    ds_read_b128 v[160:163], v16 offset:0
    ds_read_b128 v[164:167], v16 offset:1024
    ds_read_b128 v[168:171], v16 offset:2048
    ds_read_b128 v[172:175], v16 offset:3072
    v_mul_u32_u24 v16, 264, v7
    v_lshl_add_u32 v16, v9, 5, v16
    v_lshl_add_u32 v16, v8, 2, v16
    v_add_u32 v16, s34, v16
    s_mov_b32 s42, 0xff00ff00
    s_mov_b32 s43, 0xff00ff00
    s_waitcnt lgkmcnt(0)
    v_add_f32_dpp v128, v160, v128 row_shr:8 row_mask:0xf bank_mask:0xf bound_ctrl:0
    v_add_f32_dpp v129, v161, v129 row_shr:8 row_mask:0xf bank_mask:0xf bound_ctrl:0
    v_add_f32_dpp v130, v162, v130 row_shr:8 row_mask:0xf bank_mask:0xf bound_ctrl:0
    v_add_f32_dpp v131, v163, v131 row_shr:8 row_mask:0xf bank_mask:0xf bound_ctrl:0
    v_add_f32_dpp v132, v164, v132 row_shr:8 row_mask:0xf bank_mask:0xf bound_ctrl:0
    v_add_f32_dpp v133, v165, v133 row_shr:8 row_mask:0xf bank_mask:0xf bound_ctrl:0
    v_add_f32_dpp v134, v166, v134 row_shr:8 row_mask:0xf bank_mask:0xf bound_ctrl:0
    v_add_f32_dpp v135, v167, v135 row_shr:8 row_mask:0xf bank_mask:0xf bound_ctrl:0
    v_add_f32_dpp v136, v168, v136 row_shr:8 row_mask:0xf bank_mask:0xf bound_ctrl:0
    v_add_f32_dpp v137, v169, v137 row_shr:8 row_mask:0xf bank_mask:0xf bound_ctrl:0
    v_add_f32_dpp v138, v170, v138 row_shr:8 row_mask:0xf bank_mask:0xf bound_ctrl:0
    v_add_f32_dpp v139, v171, v139 row_shr:8 row_mask:0xf bank_mask:0xf bound_ctrl:0
    v_add_f32_dpp v140, v172, v140 row_shr:8 row_mask:0xf bank_mask:0xf bound_ctrl:0
    v_add_f32_dpp v141, v173, v141 row_shr:8 row_mask:0xf bank_mask:0xf bound_ctrl:0
    v_add_f32_dpp v142, v174, v142 row_shr:8 row_mask:0xf bank_mask:0xf bound_ctrl:0
    v_add_f32_dpp v143, v175, v143 row_shr:8 row_mask:0xf bank_mask:0xf bound_ctrl:0
    s_mov_b64 exec, s[42:43]
    v_add_f32 v144, v160, v144
    v_add_f32 v145, v161, v145
    v_add_f32 v146, v162, v146
    v_add_f32 v147, v163, v147
    v_add_f32 v148, v164, v148
    v_add_f32 v149, v165, v149
    v_add_f32 v150, v166, v150
    v_add_f32 v151, v167, v151
    v_add_f32 v152, v168, v152
    v_add_f32 v153, v169, v153
    v_add_f32 v154, v170, v154
    v_add_f32 v155, v171, v155
    v_add_f32 v156, v172, v156
    v_add_f32 v157, v173, v157
    v_add_f32 v158, v174, v158
    v_add_f32 v159, v175, v159
    s_mov_b64 exec, -1
    v_cvt_pk_bf16_f32 v32, v128, v144
    v_cvt_pk_bf16_f32 v33, v129, v145
    v_cvt_pk_bf16_f32 v34, v130, v146
    v_cvt_pk_bf16_f32 v35, v131, v147
    v_cvt_pk_bf16_f32 v36, v132, v148
    v_cvt_pk_bf16_f32 v37, v133, v149
    v_cvt_pk_bf16_f32 v38, v134, v150
    v_cvt_pk_bf16_f32 v39, v135, v151
    v_cvt_pk_bf16_f32 v40, v136, v152
    v_cvt_pk_bf16_f32 v41, v137, v153
    v_cvt_pk_bf16_f32 v42, v138, v154
    v_cvt_pk_bf16_f32 v43, v139, v155
    v_cvt_pk_bf16_f32 v44, v140, v156
    v_cvt_pk_bf16_f32 v45, v141, v157
    v_cvt_pk_bf16_f32 v46, v142, v158
    v_cvt_pk_bf16_f32 v47, v143, v159
    ds_write_b32 v16, v32 offset:0
    ds_write_b32 v16, v33 offset:8
    ds_write_b32 v16, v34 offset:16
    ds_write_b32 v16, v35 offset:24
    ds_write_b32 v16, v36 offset:64
    ds_write_b32 v16, v37 offset:72
    ds_write_b32 v16, v38 offset:80
    ds_write_b32 v16, v39 offset:88
    ds_write_b32 v16, v40 offset:128
    ds_write_b32 v16, v41 offset:136
    ds_write_b32 v16, v42 offset:144
    ds_write_b32 v16, v43 offset:152
    ds_write_b32 v16, v44 offset:192
    ds_write_b32 v16, v45 offset:200
    ds_write_b32 v16, v46 offset:208
    ds_write_b32 v16, v47 offset:216
    s_branch p_convE
p_convP:
    s_add_u32 s36, s34, 9728
    s_mov_b32 m0, s36
    s_add_u32 s40, s35, 8
    v_mov_b32 v16, 0
    ds_write_b32 v5, v6 offset:9472
    buffer_load_dwordx4 v3, s[24:27], s40 offen offset:0 lds
    buffer_load_dwordx4 v3, s[24:27], s40 offen offset:1024 lds
    buffer_load_dwordx4 v3, s[24:27], s40 offen offset:2048 lds
    buffer_load_dwordx4 v3, s[24:27], s40 offen offset:3072 lds
    buffer_load_dwordx2 v[252:253], v16, s[24:27], s35 offen
    v_mov_b32 v251, 0
    buffer_load_dword v250, v251, s[48:51], 0 offen sc1
    v_lshlrev_b32 v11, 2, v8
    v_and_b32 v12, 7, v1
    v_mul_u32_u24 v13, 272, v12
    v_lshl_add_u32 v13, v9, 4, v13
    v_add_u32 v13, s34, v13
    v_add_u32 v13, 4356, v13
    v_sub_u32 v13, v13, v11
    v_bfe_u32 v11, v1, 3, 1
    v_lshlrev_b32 v11, 4, v11
    v_sub_u32 v11, 16, v11
    v_cmp_ne_u32 vcc, 0, v12
    v_mov_b32 v16, 0
    s_add_u32 s36, s34, 9720
    v_cndmask_b32 v15, v16, -1, vcc
    v_mov_b32 v17, s36
    s_waitcnt vmcnt(0) lgkmcnt(0)
    s_mov_b64 exec, 1
    ds_write_b64 v17, v[252:253]
    s_mov_b64 exec, -1
    s_barrier
    s_waitcnt lgkmcnt(0)
    s_barrier
    ds_read2_b32 v[96:97], v13 offset0:0 offset1:1
    ds_read2_b32 v[98:99], v13 offset0:2 offset1:3
    ds_read2_b32 v[100:101], v13 offset0:8 offset1:9
    ds_read2_b32 v[102:103], v13 offset0:10 offset1:11
    ds_read2_b32 v[104:105], v13 offset0:16 offset1:17
    ds_read2_b32 v[106:107], v13 offset0:18 offset1:19
    ds_read2_b32 v[108:109], v13 offset0:24 offset1:25
    ds_read2_b32 v[110:111], v13 offset0:26 offset1:27
    ds_read2_b32 v[112:113], v13 offset0:32 offset1:33
    ds_read2_b32 v[114:115], v13 offset0:34 offset1:35
    ds_read2_b32 v[116:117], v13 offset0:40 offset1:41
    ds_read2_b32 v[118:119], v13 offset0:42 offset1:43
    ds_read2_b32 v[120:121], v13 offset0:48 offset1:49
    ds_read2_b32 v[122:123], v13 offset0:50 offset1:51
    ds_read2_b32 v[124:125], v13 offset0:56 offset1:57
    ds_read2_b32 v[126:127], v13 offset0:58 offset1:59
    s_waitcnt lgkmcnt(6)
    ds_read_b32 v24, v13 offset:16
    ds_read_b32 v25, v13 offset:48
    ds_read_b32 v26, v13 offset:80
    ds_read_b32 v27, v13 offset:112
    ds_read_b32 v28, v13 offset:144
    ds_read_b32 v29, v13 offset:176
    ds_read_b32 v30, v13 offset:208
    ds_read_b32 v31, v13 offset:240
    s_waitcnt lgkmcnt(7)
    ds_read_b128 v[208:211], v14 offset:3840
    ds_read_b128 v[212:215], v14 offset:3872
    ds_read_b128 v[216:219], v14 offset:3904
    ds_read_b128 v[220:223], v14 offset:3936
    ds_read_b128 v[224:227], v14 offset:3968
    ds_read_b128 v[228:231], v14 offset:4000
    ds_read_b128 v[232:235], v14 offset:4032
    ds_read_b128 v[236:239], v14 offset:4064
    s_waitcnt lgkmcnt(8)
    v_alignbit_b32 v96, v97, v96, v11
    v_alignbit_b32 v97, v98, v97, v11
    v_alignbit_b32 v98, v99, v98, v11
    v_alignbit_b32 v99, v24, v99, v11
    v_alignbit_b32 v100, v101, v100, v11
    v_alignbit_b32 v101, v102, v101, v11
    v_alignbit_b32 v102, v103, v102, v11
    v_alignbit_b32 v103, v25, v103, v11
    v_alignbit_b32 v104, v105, v104, v11
    v_alignbit_b32 v105, v106, v105, v11
    v_alignbit_b32 v106, v107, v106, v11
    v_alignbit_b32 v107, v26, v107, v11
    v_alignbit_b32 v108, v109, v108, v11
    v_alignbit_b32 v109, v110, v109, v11
    v_alignbit_b32 v110, v111, v110, v11
    v_alignbit_b32 v111, v27, v111, v11
    v_alignbit_b32 v112, v113, v112, v11
    v_alignbit_b32 v113, v114, v113, v11
    v_alignbit_b32 v114, v115, v114, v11
    v_alignbit_b32 v115, v28, v115, v11
    v_alignbit_b32 v116, v117, v116, v11
    v_alignbit_b32 v117, v118, v117, v11
    v_alignbit_b32 v118, v119, v118, v11
    v_alignbit_b32 v119, v29, v119, v11
    v_alignbit_b32 v120, v121, v120, v11
    v_alignbit_b32 v121, v122, v121, v11
    v_alignbit_b32 v122, v123, v122, v11
    v_alignbit_b32 v123, v30, v123, v11
    v_alignbit_b32 v124, v125, v124, v11
    v_alignbit_b32 v125, v126, v125, v11
    v_alignbit_b32 v126, v127, v126, v11
    v_alignbit_b32 v127, v31, v127, v11
    s_setprio 3
    s_waitcnt lgkmcnt(0)
    s_nop 1
    v_mfma_f32_32x32x16_bf16 v[160:175], v[208:211], v[96:99], 0
    ds_read_b128 v[176:179], v14 offset:3584
    ds_read_b128 v[180:183], v14 offset:3616
    v_mfma_f32_32x32x16_bf16 v[160:175], v[212:215], v[100:103], v[160:175]
    ds_read_b128 v[184:187], v14 offset:3648
    ds_read_b128 v[188:191], v14 offset:3680
    v_mfma_f32_32x32x16_bf16 v[160:175], v[216:219], v[104:107], v[160:175]
    ds_read_b128 v[192:195], v14 offset:3712
    v_mfma_f32_32x32x16_bf16 v[160:175], v[220:223], v[108:111], v[160:175]
    ds_read_b128 v[196:199], v14 offset:3744
    v_mfma_f32_32x32x16_bf16 v[160:175], v[224:227], v[112:115], v[160:175]
    ds_read_b128 v[200:203], v14 offset:3776
    v_mfma_f32_32x32x16_bf16 v[160:175], v[228:231], v[116:119], v[160:175]
    ds_read_b128 v[204:207], v14 offset:3808
    v_mfma_f32_32x32x16_bf16 v[160:175], v[232:235], v[120:123], v[160:175]
    v_mfma_f32_32x32x16_bf16 v[160:175], v[236:239], v[124:127], v[160:175]
    s_waitcnt lgkmcnt(0)
    s_nop 11
    v_and_b32_dpp v160, v160, v15 row_shr:1 row_mask:0xf bank_mask:0xf bound_ctrl:0
    v_and_b32_dpp v161, v161, v15 row_shr:1 row_mask:0xf bank_mask:0xf bound_ctrl:0
    v_and_b32_dpp v162, v162, v15 row_shr:1 row_mask:0xf bank_mask:0xf bound_ctrl:0
    v_and_b32_dpp v163, v163, v15 row_shr:1 row_mask:0xf bank_mask:0xf bound_ctrl:0
    v_and_b32_dpp v164, v164, v15 row_shr:1 row_mask:0xf bank_mask:0xf bound_ctrl:0
    v_and_b32_dpp v165, v165, v15 row_shr:1 row_mask:0xf bank_mask:0xf bound_ctrl:0
    v_and_b32_dpp v166, v166, v15 row_shr:1 row_mask:0xf bank_mask:0xf bound_ctrl:0
    v_and_b32_dpp v167, v167, v15 row_shr:1 row_mask:0xf bank_mask:0xf bound_ctrl:0
    v_and_b32_dpp v168, v168, v15 row_shr:1 row_mask:0xf bank_mask:0xf bound_ctrl:0
    v_and_b32_dpp v169, v169, v15 row_shr:1 row_mask:0xf bank_mask:0xf bound_ctrl:0
    v_and_b32_dpp v170, v170, v15 row_shr:1 row_mask:0xf bank_mask:0xf bound_ctrl:0
    v_and_b32_dpp v171, v171, v15 row_shr:1 row_mask:0xf bank_mask:0xf bound_ctrl:0
    v_and_b32_dpp v172, v172, v15 row_shr:1 row_mask:0xf bank_mask:0xf bound_ctrl:0
    v_and_b32_dpp v173, v173, v15 row_shr:1 row_mask:0xf bank_mask:0xf bound_ctrl:0
    v_and_b32_dpp v174, v174, v15 row_shr:1 row_mask:0xf bank_mask:0xf bound_ctrl:0
    v_and_b32_dpp v175, v175, v15 row_shr:1 row_mask:0xf bank_mask:0xf bound_ctrl:0
    s_nop 1
    v_mfma_f32_32x32x16_bf16 v[160:175], v[176:179], v[96:99], v[160:175]
    ds_read_b128 v[208:211], v14 offset:3328
    ds_read_b128 v[212:215], v14 offset:3360
    v_mfma_f32_32x32x16_bf16 v[160:175], v[180:183], v[100:103], v[160:175]
    ds_read_b128 v[216:219], v14 offset:3392
    ds_read_b128 v[220:223], v14 offset:3424
    v_mfma_f32_32x32x16_bf16 v[160:175], v[184:187], v[104:107], v[160:175]
    ds_read_b128 v[224:227], v14 offset:3456
    v_mfma_f32_32x32x16_bf16 v[160:175], v[188:191], v[108:111], v[160:175]
    ds_read_b128 v[228:231], v14 offset:3488
    v_mfma_f32_32x32x16_bf16 v[160:175], v[192:195], v[112:115], v[160:175]
    ds_read_b128 v[232:235], v14 offset:3520
    v_mfma_f32_32x32x16_bf16 v[160:175], v[196:199], v[116:119], v[160:175]
    ds_read_b128 v[236:239], v14 offset:3552
    v_mfma_f32_32x32x16_bf16 v[160:175], v[200:203], v[120:123], v[160:175]
    v_mfma_f32_32x32x16_bf16 v[160:175], v[204:207], v[124:127], v[160:175]
    s_waitcnt lgkmcnt(0)
    s_nop 11
    v_and_b32_dpp v160, v160, v15 row_shr:1 row_mask:0xf bank_mask:0xf bound_ctrl:0
    v_and_b32_dpp v161, v161, v15 row_shr:1 row_mask:0xf bank_mask:0xf bound_ctrl:0
    v_and_b32_dpp v162, v162, v15 row_shr:1 row_mask:0xf bank_mask:0xf bound_ctrl:0
    v_and_b32_dpp v163, v163, v15 row_shr:1 row_mask:0xf bank_mask:0xf bound_ctrl:0
    v_and_b32_dpp v164, v164, v15 row_shr:1 row_mask:0xf bank_mask:0xf bound_ctrl:0
    v_and_b32_dpp v165, v165, v15 row_shr:1 row_mask:0xf bank_mask:0xf bound_ctrl:0
    v_and_b32_dpp v166, v166, v15 row_shr:1 row_mask:0xf bank_mask:0xf bound_ctrl:0
    v_and_b32_dpp v167, v167, v15 row_shr:1 row_mask:0xf bank_mask:0xf bound_ctrl:0
    v_and_b32_dpp v168, v168, v15 row_shr:1 row_mask:0xf bank_mask:0xf bound_ctrl:0
    v_and_b32_dpp v169, v169, v15 row_shr:1 row_mask:0xf bank_mask:0xf bound_ctrl:0
    v_and_b32_dpp v170, v170, v15 row_shr:1 row_mask:0xf bank_mask:0xf bound_ctrl:0
    v_and_b32_dpp v171, v171, v15 row_shr:1 row_mask:0xf bank_mask:0xf bound_ctrl:0
    v_and_b32_dpp v172, v172, v15 row_shr:1 row_mask:0xf bank_mask:0xf bound_ctrl:0
    v_and_b32_dpp v173, v173, v15 row_shr:1 row_mask:0xf bank_mask:0xf bound_ctrl:0
    v_and_b32_dpp v174, v174, v15 row_shr:1 row_mask:0xf bank_mask:0xf bound_ctrl:0
    v_and_b32_dpp v175, v175, v15 row_shr:1 row_mask:0xf bank_mask:0xf bound_ctrl:0
    s_nop 1
    v_mfma_f32_32x32x16_bf16 v[160:175], v[208:211], v[96:99], v[160:175]
    ds_read_b128 v[176:179], v14 offset:3072
    ds_read_b128 v[180:183], v14 offset:3104
    v_mfma_f32_32x32x16_bf16 v[160:175], v[212:215], v[100:103], v[160:175]
    ds_read_b128 v[184:187], v14 offset:3136
    ds_read_b128 v[188:191], v14 offset:3168
    v_mfma_f32_32x32x16_bf16 v[160:175], v[216:219], v[104:107], v[160:175]
    ds_read_b128 v[192:195], v14 offset:3200
    v_mfma_f32_32x32x16_bf16 v[160:175], v[220:223], v[108:111], v[160:175]
    ds_read_b128 v[196:199], v14 offset:3232
    v_mfma_f32_32x32x16_bf16 v[160:175], v[224:227], v[112:115], v[160:175]
    ds_read_b128 v[200:203], v14 offset:3264
    v_mfma_f32_32x32x16_bf16 v[160:175], v[228:231], v[116:119], v[160:175]
    ds_read_b128 v[204:207], v14 offset:3296
    v_mfma_f32_32x32x16_bf16 v[160:175], v[232:235], v[120:123], v[160:175]
    v_mfma_f32_32x32x16_bf16 v[160:175], v[236:239], v[124:127], v[160:175]
    s_waitcnt lgkmcnt(0)
    s_nop 11
    v_and_b32_dpp v160, v160, v15 row_shr:1 row_mask:0xf bank_mask:0xf bound_ctrl:0
    v_and_b32_dpp v161, v161, v15 row_shr:1 row_mask:0xf bank_mask:0xf bound_ctrl:0
    v_and_b32_dpp v162, v162, v15 row_shr:1 row_mask:0xf bank_mask:0xf bound_ctrl:0
    v_and_b32_dpp v163, v163, v15 row_shr:1 row_mask:0xf bank_mask:0xf bound_ctrl:0
    v_and_b32_dpp v164, v164, v15 row_shr:1 row_mask:0xf bank_mask:0xf bound_ctrl:0
    v_and_b32_dpp v165, v165, v15 row_shr:1 row_mask:0xf bank_mask:0xf bound_ctrl:0
    v_and_b32_dpp v166, v166, v15 row_shr:1 row_mask:0xf bank_mask:0xf bound_ctrl:0
    v_and_b32_dpp v167, v167, v15 row_shr:1 row_mask:0xf bank_mask:0xf bound_ctrl:0
    v_and_b32_dpp v168, v168, v15 row_shr:1 row_mask:0xf bank_mask:0xf bound_ctrl:0
    v_and_b32_dpp v169, v169, v15 row_shr:1 row_mask:0xf bank_mask:0xf bound_ctrl:0
    v_and_b32_dpp v170, v170, v15 row_shr:1 row_mask:0xf bank_mask:0xf bound_ctrl:0
    v_and_b32_dpp v171, v171, v15 row_shr:1 row_mask:0xf bank_mask:0xf bound_ctrl:0
    v_and_b32_dpp v172, v172, v15 row_shr:1 row_mask:0xf bank_mask:0xf bound_ctrl:0
    v_and_b32_dpp v173, v173, v15 row_shr:1 row_mask:0xf bank_mask:0xf bound_ctrl:0
    v_and_b32_dpp v174, v174, v15 row_shr:1 row_mask:0xf bank_mask:0xf bound_ctrl:0
    v_and_b32_dpp v175, v175, v15 row_shr:1 row_mask:0xf bank_mask:0xf bound_ctrl:0
    s_nop 1
    v_mfma_f32_32x32x16_bf16 v[160:175], v[176:179], v[96:99], v[160:175]
    ds_read_b128 v[208:211], v14 offset:2816
    ds_read_b128 v[212:215], v14 offset:2848
    v_mfma_f32_32x32x16_bf16 v[160:175], v[180:183], v[100:103], v[160:175]
    ds_read_b128 v[216:219], v14 offset:2880
    ds_read_b128 v[220:223], v14 offset:2912
    v_mfma_f32_32x32x16_bf16 v[160:175], v[184:187], v[104:107], v[160:175]
    ds_read_b128 v[224:227], v14 offset:2944
    v_mfma_f32_32x32x16_bf16 v[160:175], v[188:191], v[108:111], v[160:175]
    ds_read_b128 v[228:231], v14 offset:2976
    v_mfma_f32_32x32x16_bf16 v[160:175], v[192:195], v[112:115], v[160:175]
    ds_read_b128 v[232:235], v14 offset:3008
    v_mfma_f32_32x32x16_bf16 v[160:175], v[196:199], v[116:119], v[160:175]
    ds_read_b128 v[236:239], v14 offset:3040
    v_mfma_f32_32x32x16_bf16 v[160:175], v[200:203], v[120:123], v[160:175]
    v_mfma_f32_32x32x16_bf16 v[160:175], v[204:207], v[124:127], v[160:175]
    s_waitcnt lgkmcnt(0)
    s_nop 11
    v_and_b32_dpp v160, v160, v15 row_shr:1 row_mask:0xf bank_mask:0xf bound_ctrl:0
    v_and_b32_dpp v161, v161, v15 row_shr:1 row_mask:0xf bank_mask:0xf bound_ctrl:0
    v_and_b32_dpp v162, v162, v15 row_shr:1 row_mask:0xf bank_mask:0xf bound_ctrl:0
    v_and_b32_dpp v163, v163, v15 row_shr:1 row_mask:0xf bank_mask:0xf bound_ctrl:0
    v_and_b32_dpp v164, v164, v15 row_shr:1 row_mask:0xf bank_mask:0xf bound_ctrl:0
    v_and_b32_dpp v165, v165, v15 row_shr:1 row_mask:0xf bank_mask:0xf bound_ctrl:0
    v_and_b32_dpp v166, v166, v15 row_shr:1 row_mask:0xf bank_mask:0xf bound_ctrl:0
    v_and_b32_dpp v167, v167, v15 row_shr:1 row_mask:0xf bank_mask:0xf bound_ctrl:0
    v_and_b32_dpp v168, v168, v15 row_shr:1 row_mask:0xf bank_mask:0xf bound_ctrl:0
    v_and_b32_dpp v169, v169, v15 row_shr:1 row_mask:0xf bank_mask:0xf bound_ctrl:0
    v_and_b32_dpp v170, v170, v15 row_shr:1 row_mask:0xf bank_mask:0xf bound_ctrl:0
    v_and_b32_dpp v171, v171, v15 row_shr:1 row_mask:0xf bank_mask:0xf bound_ctrl:0
    v_and_b32_dpp v172, v172, v15 row_shr:1 row_mask:0xf bank_mask:0xf bound_ctrl:0
    v_and_b32_dpp v173, v173, v15 row_shr:1 row_mask:0xf bank_mask:0xf bound_ctrl:0
    v_and_b32_dpp v174, v174, v15 row_shr:1 row_mask:0xf bank_mask:0xf bound_ctrl:0
    v_and_b32_dpp v175, v175, v15 row_shr:1 row_mask:0xf bank_mask:0xf bound_ctrl:0
    s_nop 1
    v_mfma_f32_32x32x16_bf16 v[160:175], v[208:211], v[96:99], v[160:175]
    ds_read_b128 v[176:179], v14 offset:2560
    ds_read_b128 v[180:183], v14 offset:2592
    v_mfma_f32_32x32x16_bf16 v[160:175], v[212:215], v[100:103], v[160:175]
    ds_read_b128 v[184:187], v14 offset:2624
    ds_read_b128 v[188:191], v14 offset:2656
    v_mfma_f32_32x32x16_bf16 v[160:175], v[216:219], v[104:107], v[160:175]
    ds_read_b128 v[192:195], v14 offset:2688
    v_mfma_f32_32x32x16_bf16 v[160:175], v[220:223], v[108:111], v[160:175]
    ds_read_b128 v[196:199], v14 offset:2720
    v_mfma_f32_32x32x16_bf16 v[160:175], v[224:227], v[112:115], v[160:175]
    ds_read_b128 v[200:203], v14 offset:2752
    v_mfma_f32_32x32x16_bf16 v[160:175], v[228:231], v[116:119], v[160:175]
    ds_read_b128 v[204:207], v14 offset:2784
    v_mfma_f32_32x32x16_bf16 v[160:175], v[232:235], v[120:123], v[160:175]
    v_mfma_f32_32x32x16_bf16 v[160:175], v[236:239], v[124:127], v[160:175]
    s_waitcnt lgkmcnt(0)
    s_nop 11
    v_and_b32_dpp v160, v160, v15 row_shr:1 row_mask:0xf bank_mask:0xf bound_ctrl:0
    v_and_b32_dpp v161, v161, v15 row_shr:1 row_mask:0xf bank_mask:0xf bound_ctrl:0
    v_and_b32_dpp v162, v162, v15 row_shr:1 row_mask:0xf bank_mask:0xf bound_ctrl:0
    v_and_b32_dpp v163, v163, v15 row_shr:1 row_mask:0xf bank_mask:0xf bound_ctrl:0
    v_and_b32_dpp v164, v164, v15 row_shr:1 row_mask:0xf bank_mask:0xf bound_ctrl:0
    v_and_b32_dpp v165, v165, v15 row_shr:1 row_mask:0xf bank_mask:0xf bound_ctrl:0
    v_and_b32_dpp v166, v166, v15 row_shr:1 row_mask:0xf bank_mask:0xf bound_ctrl:0
    v_and_b32_dpp v167, v167, v15 row_shr:1 row_mask:0xf bank_mask:0xf bound_ctrl:0
    v_and_b32_dpp v168, v168, v15 row_shr:1 row_mask:0xf bank_mask:0xf bound_ctrl:0
    v_and_b32_dpp v169, v169, v15 row_shr:1 row_mask:0xf bank_mask:0xf bound_ctrl:0
    v_and_b32_dpp v170, v170, v15 row_shr:1 row_mask:0xf bank_mask:0xf bound_ctrl:0
    v_and_b32_dpp v171, v171, v15 row_shr:1 row_mask:0xf bank_mask:0xf bound_ctrl:0
    v_and_b32_dpp v172, v172, v15 row_shr:1 row_mask:0xf bank_mask:0xf bound_ctrl:0
    v_and_b32_dpp v173, v173, v15 row_shr:1 row_mask:0xf bank_mask:0xf bound_ctrl:0
    v_and_b32_dpp v174, v174, v15 row_shr:1 row_mask:0xf bank_mask:0xf bound_ctrl:0
    v_and_b32_dpp v175, v175, v15 row_shr:1 row_mask:0xf bank_mask:0xf bound_ctrl:0
    s_nop 1
    v_mfma_f32_32x32x16_bf16 v[160:175], v[176:179], v[96:99], v[160:175]
    ds_read_b128 v[208:211], v14 offset:2304
    ds_read_b128 v[212:215], v14 offset:2336
    v_mfma_f32_32x32x16_bf16 v[160:175], v[180:183], v[100:103], v[160:175]
    ds_read_b128 v[216:219], v14 offset:2368
    ds_read_b128 v[220:223], v14 offset:2400
    v_mfma_f32_32x32x16_bf16 v[160:175], v[184:187], v[104:107], v[160:175]
    ds_read_b128 v[224:227], v14 offset:2432
    v_mfma_f32_32x32x16_bf16 v[160:175], v[188:191], v[108:111], v[160:175]
    ds_read_b128 v[228:231], v14 offset:2464
    v_mfma_f32_32x32x16_bf16 v[160:175], v[192:195], v[112:115], v[160:175]
    ds_read_b128 v[232:235], v14 offset:2496
    v_mfma_f32_32x32x16_bf16 v[160:175], v[196:199], v[116:119], v[160:175]
    ds_read_b128 v[236:239], v14 offset:2528
    v_mfma_f32_32x32x16_bf16 v[160:175], v[200:203], v[120:123], v[160:175]
    v_mfma_f32_32x32x16_bf16 v[160:175], v[204:207], v[124:127], v[160:175]
    s_waitcnt lgkmcnt(0)
    s_nop 11
    v_and_b32_dpp v160, v160, v15 row_shr:1 row_mask:0xf bank_mask:0xf bound_ctrl:0
    v_and_b32_dpp v161, v161, v15 row_shr:1 row_mask:0xf bank_mask:0xf bound_ctrl:0
    v_and_b32_dpp v162, v162, v15 row_shr:1 row_mask:0xf bank_mask:0xf bound_ctrl:0
    v_and_b32_dpp v163, v163, v15 row_shr:1 row_mask:0xf bank_mask:0xf bound_ctrl:0
    v_and_b32_dpp v164, v164, v15 row_shr:1 row_mask:0xf bank_mask:0xf bound_ctrl:0
    v_and_b32_dpp v165, v165, v15 row_shr:1 row_mask:0xf bank_mask:0xf bound_ctrl:0
    v_and_b32_dpp v166, v166, v15 row_shr:1 row_mask:0xf bank_mask:0xf bound_ctrl:0
    v_and_b32_dpp v167, v167, v15 row_shr:1 row_mask:0xf bank_mask:0xf bound_ctrl:0
    v_and_b32_dpp v168, v168, v15 row_shr:1 row_mask:0xf bank_mask:0xf bound_ctrl:0
    v_and_b32_dpp v169, v169, v15 row_shr:1 row_mask:0xf bank_mask:0xf bound_ctrl:0
    v_and_b32_dpp v170, v170, v15 row_shr:1 row_mask:0xf bank_mask:0xf bound_ctrl:0
    v_and_b32_dpp v171, v171, v15 row_shr:1 row_mask:0xf bank_mask:0xf bound_ctrl:0
    v_and_b32_dpp v172, v172, v15 row_shr:1 row_mask:0xf bank_mask:0xf bound_ctrl:0
    v_and_b32_dpp v173, v173, v15 row_shr:1 row_mask:0xf bank_mask:0xf bound_ctrl:0
    v_and_b32_dpp v174, v174, v15 row_shr:1 row_mask:0xf bank_mask:0xf bound_ctrl:0
    v_and_b32_dpp v175, v175, v15 row_shr:1 row_mask:0xf bank_mask:0xf bound_ctrl:0
    s_nop 1
    v_mfma_f32_32x32x16_bf16 v[160:175], v[208:211], v[96:99], v[160:175]
    ds_read_b128 v[176:179], v14 offset:2048
    ds_read_b128 v[180:183], v14 offset:2080
    v_mfma_f32_32x32x16_bf16 v[160:175], v[212:215], v[100:103], v[160:175]
    ds_read_b128 v[184:187], v14 offset:2112
    ds_read_b128 v[188:191], v14 offset:2144
    v_mfma_f32_32x32x16_bf16 v[160:175], v[216:219], v[104:107], v[160:175]
    ds_read_b128 v[192:195], v14 offset:2176
    v_mfma_f32_32x32x16_bf16 v[160:175], v[220:223], v[108:111], v[160:175]
    ds_read_b128 v[196:199], v14 offset:2208
    v_mfma_f32_32x32x16_bf16 v[160:175], v[224:227], v[112:115], v[160:175]
    ds_read_b128 v[200:203], v14 offset:2240
    v_mfma_f32_32x32x16_bf16 v[160:175], v[228:231], v[116:119], v[160:175]
    ds_read_b128 v[204:207], v14 offset:2272
    v_mfma_f32_32x32x16_bf16 v[160:175], v[232:235], v[120:123], v[160:175]
    v_mfma_f32_32x32x16_bf16 v[160:175], v[236:239], v[124:127], v[160:175]
    s_waitcnt lgkmcnt(0)
    s_nop 11
    v_and_b32_dpp v160, v160, v15 row_shr:1 row_mask:0xf bank_mask:0xf bound_ctrl:0
    v_and_b32_dpp v161, v161, v15 row_shr:1 row_mask:0xf bank_mask:0xf bound_ctrl:0
    v_and_b32_dpp v162, v162, v15 row_shr:1 row_mask:0xf bank_mask:0xf bound_ctrl:0
    v_and_b32_dpp v163, v163, v15 row_shr:1 row_mask:0xf bank_mask:0xf bound_ctrl:0
    v_and_b32_dpp v164, v164, v15 row_shr:1 row_mask:0xf bank_mask:0xf bound_ctrl:0
    v_and_b32_dpp v165, v165, v15 row_shr:1 row_mask:0xf bank_mask:0xf bound_ctrl:0
    v_and_b32_dpp v166, v166, v15 row_shr:1 row_mask:0xf bank_mask:0xf bound_ctrl:0
    v_and_b32_dpp v167, v167, v15 row_shr:1 row_mask:0xf bank_mask:0xf bound_ctrl:0
    v_and_b32_dpp v168, v168, v15 row_shr:1 row_mask:0xf bank_mask:0xf bound_ctrl:0
    v_and_b32_dpp v169, v169, v15 row_shr:1 row_mask:0xf bank_mask:0xf bound_ctrl:0
    v_and_b32_dpp v170, v170, v15 row_shr:1 row_mask:0xf bank_mask:0xf bound_ctrl:0
    v_and_b32_dpp v171, v171, v15 row_shr:1 row_mask:0xf bank_mask:0xf bound_ctrl:0
    v_and_b32_dpp v172, v172, v15 row_shr:1 row_mask:0xf bank_mask:0xf bound_ctrl:0
    v_and_b32_dpp v173, v173, v15 row_shr:1 row_mask:0xf bank_mask:0xf bound_ctrl:0
    v_and_b32_dpp v174, v174, v15 row_shr:1 row_mask:0xf bank_mask:0xf bound_ctrl:0
    v_and_b32_dpp v175, v175, v15 row_shr:1 row_mask:0xf bank_mask:0xf bound_ctrl:0
    s_nop 1
    v_mfma_f32_32x32x16_bf16 v[160:175], v[176:179], v[96:99], v[160:175]
    v_mfma_f32_32x32x16_bf16 v[160:175], v[180:183], v[100:103], v[160:175]
    v_mfma_f32_32x32x16_bf16 v[160:175], v[184:187], v[104:107], v[160:175]
    v_mfma_f32_32x32x16_bf16 v[160:175], v[188:191], v[108:111], v[160:175]
    v_mfma_f32_32x32x16_bf16 v[160:175], v[192:195], v[112:115], v[160:175]
    v_mfma_f32_32x32x16_bf16 v[160:175], v[196:199], v[116:119], v[160:175]
    v_mfma_f32_32x32x16_bf16 v[160:175], v[200:203], v[120:123], v[160:175]
    v_mfma_f32_32x32x16_bf16 v[160:175], v[204:207], v[124:127], v[160:175]
    s_setprio 0
    s_mov_b32 s47, 0
prep_kernel_nn19:
    v_readfirstlane_b32 s46, v250
    s_add_u32 s47, s47, 1
    s_cmp_lg_u32 s46, 0
    s_cbranch_scc1 prep_kernel_nd20
    s_cmp_ge_u32 s47, 200000
    s_cbranch_scc1 prep_kernel_nd20
    buffer_load_dword v250, v251, s[48:51], 0 offen sc1
    s_waitcnt vmcnt(0)
    s_branch prep_kernel_nn19
prep_kernel_nd20:
    s_lshr_b32 s40, s2, 4
    s_lshl_b32 s40, s40, 9
    s_add_u32 s40, s40, 29700096
    s_mov_b32 s41, 29683712
    v_lshrrev_b32 v16, 2, v1
    v_mul_u32_u24 v16, 5120, v16
    v_and_b32 v17, 3, v1
    v_lshl_add_u32 v16, v17, 7, v16
    v_lshlrev_b32 v18, 7, v1
    v_mov_b32 v17, s46
    s_add_u32 s42, s41, 8192
    s_mov_b32 s47, 0
prep_kernel_mp21:
    buffer_load_dword v19, v18, s[28:31], s41 offen sc1
    buffer_load_dword v28, v18, s[28:31], s42 offen sc1
    s_mov_b64 exec, 0xfff
    buffer_load_dword v17, v16, s[28:31], s40 offen sc1
    s_mov_b64 exec, -1
    s_waitcnt vmcnt(0)
    v_cmp_ne_u32 vcc, s46, v17
    v_cmp_ne_u32 s[66:67], s46, v19
    v_cmp_ne_u32 s[68:69], s46, v28
    s_add_u32 s47, s47, 1
    s_nop 2
    s_or_b64 vcc, vcc, s[66:67]
    s_or_b64 vcc, vcc, s[68:69]
    s_cmp_ge_u32 s47, 200000
    s_cbranch_scc1 prep_kernel_md22
    s_cbranch_vccz prep_kernel_md22
    s_sleep 8
    s_branch prep_kernel_mp21
prep_kernel_md22:
    s_lshl_b32 s40, s2, 4
    s_add_u32 s40, s40, 2793472
    v_lshrrev_b32 v16, 2, v1
    v_mul_u32_u24 v16, 2560, v16
    v_and_b32 v17, 3, v1
    v_mul_u32_u24 v17, 15360, v17
    v_add_u32 v16, v16, v17
    s_mov_b64 exec, 0xfff
    buffer_load_dwordx4 v[20:23], v16, s[28:31], s40 offen sc1
    s_mov_b64 exec, -1
    v_lshlrev_b32 v18, 4, v1
    v_subrev_u32 v19, 655360, v4
    s_lshl_b32 s43, s20, 10
    s_sub_u32 s44, s43, 4096
    s_add_u32 m0, s43, 55296
    s_add_u32 s39, s38, 2854912
    buffer_load_dwordx4 v4, s[28:31], s39 offen sc1 lds
    s_add_u32 m0, s43, 71680
    s_add_u32 s39, s43, 5476352
    buffer_load_dwordx4 v18, s[28:31], s39 offen sc1 lds
    s_add_u32 m0, s44, 55296
    s_add_u32 s39, s38, 2854912
    buffer_load_dwordx4 v19, s[28:31], s39 offen sc1 lds
    s_add_u32 m0, s44, 71680
    s_add_u32 s39, s44, 5476352
    buffer_load_dwordx4 v18, s[28:31], s39 offen sc1 lds
    s_add_u32 m0, s43, 63488
    s_add_u32 s39, s38, 4165632
    buffer_load_dwordx4 v4, s[28:31], s39 offen sc1 lds
    s_add_u32 m0, s43, 79872
    s_add_u32 s39, s43, 5484544
    buffer_load_dwordx4 v18, s[28:31], s39 offen sc1 lds
    s_add_u32 m0, s44, 63488
    s_add_u32 s39, s38, 4165632
    buffer_load_dwordx4 v19, s[28:31], s39 offen sc1 lds
    s_add_u32 m0, s44, 79872
    s_add_u32 s39, s44, 5484544
    buffer_load_dwordx4 v18, s[28:31], s39 offen sc1 lds
    s_mul_i32 s36, s19, 4096
    s_add_u32 s36, s36, 88064
    v_lshlrev_b32 v16, 4, v1
    v_add_u32 v16, s36, v16
    s_nop 4
    ds_write_b128 v16, v[160:163] offset:0
    ds_write_b128 v16, v[164:167] offset:1024
    ds_write_b128 v16, v[168:171] offset:2048
    ds_write_b128 v16, v[172:175] offset:3072
    s_waitcnt vmcnt(8)
    s_nop 1
    v_add_f32_dpp v20, v20, v20 quad_perm:[1,0,3,2] row_mask:0xf bank_mask:0xf
    v_add_f32_dpp v21, v21, v21 quad_perm:[1,0,3,2] row_mask:0xf bank_mask:0xf
    v_add_f32_dpp v22, v22, v22 quad_perm:[1,0,3,2] row_mask:0xf bank_mask:0xf
    v_add_f32_dpp v23, v23, v23 quad_perm:[1,0,3,2] row_mask:0xf bank_mask:0xf
    s_nop 1
    v_add_f32_dpp v20, v20, v20 quad_perm:[2,3,0,1] row_mask:0xf bank_mask:0xf
    v_add_f32_dpp v21, v21, v21 quad_perm:[2,3,0,1] row_mask:0xf bank_mask:0xf
    v_add_f32_dpp v22, v22, v22 quad_perm:[2,3,0,1] row_mask:0xf bank_mask:0xf
    v_add_f32_dpp v23, v23, v23 quad_perm:[2,3,0,1] row_mask:0xf bank_mask:0xf
    s_nop 1
    v_cvt_pk_bf16_f32 v24, v20, v21
    v_lshlrev_b32 v20, 16, v24
    v_and_b32 v21, 0xffff0000, v24
    v_cvt_pk_bf16_f32 v24, v22, v23
    v_lshlrev_b32 v22, 16, v24
    v_and_b32 v23, 0xffff0000, v24
    v_add_f32 v24, 1.0, v20
    v_add_f32 v25, 1.0, v21
    v_add_f32 v26, 1.0, v22
    v_add_f32 v27, 1.0, v23
    v_cvt_pk_bf16_f32 v10, v24, v25
    v_lshlrev_b32 v24, 16, v10
    v_and_b32 v25, 0xffff0000, v10
    v_cvt_pk_bf16_f32 v10, v26, v27
    v_lshlrev_b32 v26, 16, v10
    v_and_b32 v27, 0xffff0000, v10
    s_nop 1
    v_readlane_b32 s68, v20, 0
    v_readlane_b32 s72, v24, 4
    v_readlane_b32 s76, v20, 8
    v_readlane_b32 s69, v21, 0
    v_readlane_b32 s73, v25, 4
    v_readlane_b32 s77, v21, 8
    v_readlane_b32 s70, v22, 0
    v_readlane_b32 s74, v26, 4
    v_readlane_b32 s78, v22, 8
    v_readlane_b32 s71, v23, 0
    v_readlane_b32 s75, v27, 4
    v_readlane_b32 s79, v23, 8
    s_nop 1
    v_mov_b32 v10, s76
    v_mov_b32 v11, s77
    v_mov_b32 v12, s78
    v_mov_b32 v13, s79
    v_mul_f32 v20, s72, v10
    v_mul_f32 v24, s68, v10
    v_mul_f32 v21, s73, v11
    v_mul_f32 v25, s69, v11
    v_mul_f32 v22, s74, v12
    v_mul_f32 v26, s70, v12
    v_mul_f32 v23, s75, v13
    v_mul_f32 v27, s71, v13
    v_mov_b32 v16, 104448
    s_mov_b64 exec, 1
    ds_write_b128 v16, v[20:23]
    ds_write_b128 v16, v[24:27] offset:16
    s_mov_b64 exec, -1
    s_waitcnt vmcnt(0) lgkmcnt(0)
    s_barrier
p_convE:
    v_lshrrev_b32 v2, 6, v0
    s_lshl_b32 s44, s32, 16
    s_and_b32 s45, s32, 0xffff0000
    s_lshl_b32 s46, s33, 16
    s_and_b32 s47, s33, 0xffff0000
    v_mul_u32_u24 v17, 264, v2
    v_lshl_add_u32 v17, v1, 2, v17
    v_mul_u32_u24 v19, 272, v2
    v_lshlrev_b32 v18, 2, v1
    v_sub_u32 v19, v19, v18
    v_add_u32 v19, 4604, v19
    v_lshlrev_b32 v18, 4, v0
    v_add_u32 v18, 55296, v18
    v_mov_b32 v16, 104448
    ds_read_b32 v224, v19 offset:0
    ds_read_b32 v225, v19 offset:13824
    ds_read_b32 v226, v19 offset:27648
    ds_read_b32 v227, v19 offset:41472
    ds_read_b32 v228, v19 offset:2176
    ds_read_b32 v229, v19 offset:16000
    ds_read_b32 v230, v19 offset:29824
    ds_read_b32 v231, v19 offset:43648
    ds_read_b128 v[176:179], v18 offset:0
    ds_read_b128 v[144:147], v18 offset:16384
    ds_read_b128 v[180:183], v18 offset:8192
    ds_read_b128 v[148:151], v18 offset:24576
    ds_read_b128 v[160:163], v16
    ds_read_b128 v[164:167], v16 offset:16
    v_mov_b32 v28, s44
    v_mov_b32 v29, s45
    v_mov_b32 v30, s46
    v_mov_b32 v31, s47
    s_waitcnt lgkmcnt(0)
    s_barrier
    ds_read_b32 v48, v17 offset:0
    ds_read_b32 v49, v17 offset:13824
    ds_read_b32 v50, v17 offset:27648
    ds_read_b32 v51, v17 offset:41472
    ds_read_b32 v52, v17 offset:2112
    ds_read_b32 v53, v17 offset:15936
    ds_read_b32 v54, v17 offset:29760
    ds_read_b32 v55, v17 offset:43584
    v_lshlrev_b32 v68, 16, v224
    v_and_b32 v64, 0xffff0000, v224
    v_lshlrev_b32 v69, 16, v225
    v_and_b32 v65, 0xffff0000, v225
    v_lshlrev_b32 v70, 16, v226
    v_and_b32 v66, 0xffff0000, v226
    v_lshlrev_b32 v71, 16, v227
    v_and_b32 v67, 0xffff0000, v227
    v_lshlrev_b32 v112, 16, v176
    v_and_b32 v113, 0xffff0000, v176
    v_lshlrev_b32 v114, 16, v177
    v_and_b32 v115, 0xffff0000, v177
    v_lshlrev_b32 v116, 16, v178
    v_and_b32 v117, 0xffff0000, v178
    v_lshlrev_b32 v118, 16, v179
    v_and_b32 v119, 0xffff0000, v179
    v_pk_fma_f32 v[120:121], v[112:113], v[144:145], v[144:145] op_sel:[0,1,0] op_sel_hi:[1,1,0]
    v_pk_fma_f32 v[122:123], v[114:115], v[144:145], v[144:145] op_sel:[0,1,0] op_sel_hi:[1,1,0]
    v_pk_fma_f32 v[124:125], v[116:117], v[146:147], v[146:147] op_sel:[0,1,0] op_sel_hi:[1,1,0]
    v_pk_fma_f32 v[126:127], v[118:119], v[146:147], v[146:147] op_sel:[0,1,0] op_sel_hi:[1,1,0]
    v_pk_fma_f32 v[120:121], v[120:121], v[160:161], v[164:165]
    v_pk_fma_f32 v[122:123], v[122:123], v[162:163], v[166:167]
    v_pk_fma_f32 v[124:125], v[124:125], v[160:161], v[164:165]
    v_pk_fma_f32 v[126:127], v[126:127], v[162:163], v[166:167]
    v_lshlrev_b32 v88, 16, v228
    v_and_b32 v84, 0xffff0000, v228
    v_lshlrev_b32 v89, 16, v229
    v_and_b32 v85, 0xffff0000, v229
    v_lshlrev_b32 v90, 16, v230
    v_and_b32 v86, 0xffff0000, v230
    v_lshlrev_b32 v91, 16, v231
    v_and_b32 v87, 0xffff0000, v231
    v_lshlrev_b32 v128, 16, v180
    v_and_b32 v129, 0xffff0000, v180
    v_lshlrev_b32 v130, 16, v181
    v_and_b32 v131, 0xffff0000, v181
    v_lshlrev_b32 v132, 16, v182
    v_and_b32 v133, 0xffff0000, v182
    v_lshlrev_b32 v134, 16, v183
    v_and_b32 v135, 0xffff0000, v183
    v_pk_fma_f32 v[136:137], v[128:129], v[148:149], v[148:149] op_sel:[0,1,0] op_sel_hi:[1,1,0]
    v_pk_fma_f32 v[138:139], v[130:131], v[148:149], v[148:149] op_sel:[0,1,0] op_sel_hi:[1,1,0]
    v_pk_fma_f32 v[140:141], v[132:133], v[150:151], v[150:151] op_sel:[0,1,0] op_sel_hi:[1,1,0]
    v_pk_fma_f32 v[142:143], v[134:135], v[150:151], v[150:151] op_sel:[0,1,0] op_sel_hi:[1,1,0]
    v_pk_fma_f32 v[136:137], v[136:137], v[160:161], v[164:165]
    v_pk_fma_f32 v[138:139], v[138:139], v[162:163], v[166:167]
    v_pk_fma_f32 v[140:141], v[140:141], v[160:161], v[164:165]
    v_pk_fma_f32 v[142:143], v[142:143], v[162:163], v[166:167]
    s_waitcnt lgkmcnt(0)
    v_lshlrev_b32 v74, 16, v48
    v_and_b32 v78, 0xffff0000, v48
    v_lshlrev_b32 v75, 16, v49
    v_and_b32 v79, 0xffff0000, v49
    v_lshlrev_b32 v76, 16, v50
    v_and_b32 v80, 0xffff0000, v50
    v_lshlrev_b32 v77, 16, v51
    v_and_b32 v81, 0xffff0000, v51
    v_pk_fma_f32 v[64:65], v[64:65], v[28:29], v[74:75]
    v_pk_fma_f32 v[66:67], v[66:67], v[30:31], v[76:77]
    v_pk_fma_f32 v[68:69], v[68:69], v[28:29], v[78:79]
    v_pk_fma_f32 v[70:71], v[70:71], v[30:31], v[80:81]
    v_pk_fma_f32 v[64:65], v[64:65], v[120:121], v[112:113]
    v_pk_fma_f32 v[66:67], v[66:67], v[122:123], v[114:115]
    v_pk_fma_f32 v[68:69], v[68:69], v[124:125], v[116:117]
    v_pk_fma_f32 v[70:71], v[70:71], v[126:127], v[118:119]
    v_cvt_pk_bf16_f32 v208, v64, v65
    v_cvt_pk_bf16_f32 v209, v66, v67
    v_cvt_pk_bf16_f32 v210, v68, v69
    v_cvt_pk_bf16_f32 v211, v70, v71
    s_add_u32 s39, s38, 5492736
    buffer_store_dwordx4 v[208:211], v4, s[28:31], s39 offen sc1
    v_lshlrev_b32 v94, 16, v52
    v_and_b32 v98, 0xffff0000, v52
    v_lshlrev_b32 v95, 16, v53
    v_and_b32 v99, 0xffff0000, v53
    v_lshlrev_b32 v96, 16, v54
    v_and_b32 v100, 0xffff0000, v54
    v_lshlrev_b32 v97, 16, v55
    v_and_b32 v101, 0xffff0000, v55
    v_pk_fma_f32 v[84:85], v[84:85], v[28:29], v[94:95]
    v_pk_fma_f32 v[86:87], v[86:87], v[30:31], v[96:97]
    v_pk_fma_f32 v[88:89], v[88:89], v[28:29], v[98:99]
    v_pk_fma_f32 v[90:91], v[90:91], v[30:31], v[100:101]
    v_pk_fma_f32 v[84:85], v[84:85], v[136:137], v[128:129]
    v_pk_fma_f32 v[86:87], v[86:87], v[138:139], v[130:131]
    v_pk_fma_f32 v[88:89], v[88:89], v[140:141], v[132:133]
    v_pk_fma_f32 v[90:91], v[90:91], v[142:143], v[134:135]
    v_cvt_pk_bf16_f32 v212, v84, v85
    v_cvt_pk_bf16_f32 v213, v86, v87
    v_cvt_pk_bf16_f32 v214, v88, v89
    v_cvt_pk_bf16_f32 v215, v90, v91
    s_add_u32 s39, s38, 6803456
    buffer_store_dwordx4 v[212:215], v4, s[28:31], s39 offen sc1
    s_waitcnt vmcnt(0)
    s_endpgm
p_pack:
    s_sub_u32 s21, s2, 416
    s_mul_i32 s34, s20, 13824
    s_cmp_ge_u32 s20, 4
    s_cbranch_scc1 prep_end
    s_cmp_eq_u32 s20, 0
    s_cbranch_scc1 k1_pack
    s_cmp_eq_u32 s20, 1
    s_cbranch_scc0 p_pk2
    s_cmp_lt_u32 s21, 58
    s_cbranch_scc0 p_pk1
    s_add_u32 s21, s21, 96
    s_branch k1_pack
p_pk1:
    s_sub_u32 s21, s21, 58
    s_cmp_ge_u32 s21, 30
    s_cbranch_scc1 prep_end
    s_branch p_fin
p_pk2:
    s_sub_u32 s22, s20, 2
    s_mul_i32 s22, s22, 96
    s_add_u32 s21, s21, s22
    s_cmp_ge_u32 s21, 120
    s_cbranch_scc1 prep_end
    s_add_u32 s21, s21, 120
    v_mov_b32 v251, 0
    buffer_load_dword v250, v251, s[48:51], 0 offen sc1
    s_branch p_mod
p_fin:
    s_add_u32 s21, s21, 30
    v_mov_b32 v16, 0
    buffer_load_dword v17, v16, s[48:51], 0 offen sc1
    s_waitcnt vmcnt(0)
    s_mov_b32 s47, 0
prep_kernel_nn23:
    v_readfirstlane_b32 s46, v17
    s_add_u32 s47, s47, 1
    s_cmp_lg_u32 s46, 0
    s_cbranch_scc1 prep_kernel_nd24
    s_cmp_ge_u32 s47, 200000
    s_cbranch_scc1 prep_kernel_nd24
    buffer_load_dword v17, v16, s[48:51], 0 offen sc1
    s_waitcnt vmcnt(0)
    s_branch prep_kernel_nn23
prep_kernel_nd24:
    s_lshl_b32 s40, s21, 9
    s_add_u32 s40, s40, 29700096
    v_lshlrev_b32 v16, 7, v1
    s_mov_b32 s47, 0
    s_mov_b64 exec, 15
prep_kernel_pl25:
    buffer_load_dword v17, v16, s[28:31], s40 offen sc1
    s_add_u32 s47, s47, 1
    s_waitcnt vmcnt(0)
    v_cmp_ne_u32 vcc, s46, v17
    s_cmp_ge_u32 s47, 200000
    s_cbranch_scc1 prep_kernel_pd26
    s_cbranch_vccz prep_kernel_pd26
    s_sleep 14
    s_branch prep_kernel_pl25
prep_kernel_pd26:
    s_mov_b64 exec, -1
    v_lshlrev_b32 v7, 2, v1
    s_lshl_b32 s22, s21, 8
    s_add_u32 s23, s22, 2793472
    buffer_load_dword v10, v7, s[28:31], s23 offen sc1
    s_add_u32 s23, s23, 15360
    buffer_load_dword v11, v7, s[28:31], s23 offen sc1
    s_add_u32 s23, s23, 15360
    buffer_load_dword v12, v7, s[28:31], s23 offen sc1
    s_add_u32 s23, s23, 15360
    buffer_load_dword v13, v7, s[28:31], s23 offen sc1
    s_waitcnt vmcnt(0)
    v_add_f32 v10, v10, v11
    v_add_f32 v12, v12, v13
    s_nop 0
    v_add_f32 v10, v10, v12
    s_nop 0
    v_cvt_pk_bf16_f32 v10, v10, v10
    s_nop 0
    v_lshlrev_b32 v10, 16, v10
    s_sub_u32 s24, s21, 10
    s_cmp_lt_u32 s24, 10
    s_cbranch_scc1 prep_kernel_f127
    s_sub_u32 s24, s21, 40
    s_cmp_lt_u32 s24, 10
    s_cbranch_scc0 prep_kernel_f228
prep_kernel_f127:
    v_add_f32 v10, 1.0, v10
    s_nop 0
    v_cvt_pk_bf16_f32 v10, v10, v10
    s_nop 0
    v_lshlrev_b32 v10, 16, v10
prep_kernel_f228:
    s_add_u32 s22, s22, 8114176
    buffer_store_dword v10, v7, s[28:31], s22 offen sc1
    s_endpgm
k1_pack:
    v_lshrrev_b32 v3, 3, v1
    v_and_b32 v4, 7, v1
    v_mul_u32_u24 v5, 144, v3
    v_lshl_add_u32 v5, v4, 4, v5
    v_add_u32 v5, s34, v5
    v_and_b32 v6, 15, v1
    v_lshrrev_b32 v7, 4, v1
    v_lshrrev_b32 v8, 2, v6
    v_lshl_add_u32 v8, v7, 3, v8
    v_mul_u32_u24 v8, 144, v8
    v_and_b32 v9, 3, v6
    v_lshl_add_u32 v8, v9, 3, v8
    v_add_u32 v8, s34, v8
    v_lshlrev_b32 v9, 4, v1
    s_cmp_lt_u32 s21, 20
    s_cbranch_scc1 prep_kernel_pk29
    s_cmp_lt_u32 s21, 40
    s_cbranch_scc1 prep_kernel_pk30
    s_cmp_lt_u32 s21, 94
    s_cbranch_scc1 prep_kernel_pk31
    s_branch prep_kernel_pk32
prep_kernel_pk29:
    s_mov_b32 s24, s12
    s_mov_b32 s25, s13
    s_mov_b32 s26, 819200
    s_mov_b32 s27, 0x00020000
    s_sub_u32 s32, s21, 0
    s_mul_i32 s33, s32, 52429
    s_lshr_b32 s33, s33, 19
    s_mul_i32 s35, s33, 10
    s_sub_u32 s35, s32, s35
    v_mul_u32_u24 v10, 1280, v3
    v_lshl_add_u32 v10, v4, 4, v10
    s_mul_i32 s36, s33, 409600
    s_lshl_b32 s37, s35, 7
    s_add_u32 s36, s36, s37
    buffer_load_dwordx4 v[32:35], v10, s[24:27], s36 offen nt
    s_add_u32 s36, s36, 10240
    buffer_load_dwordx4 v[36:39], v10, s[24:27], s36 offen nt
    s_add_u32 s36, s36, 10240
    buffer_load_dwordx4 v[40:43], v10, s[24:27], s36 offen nt
    s_add_u32 s36, s36, 10240
    buffer_load_dwordx4 v[44:47], v10, s[24:27], s36 offen nt
    s_add_u32 s36, s36, 10240
    buffer_load_dwordx4 v[48:51], v10, s[24:27], s36 offen nt
    s_add_u32 s36, s36, 10240
    buffer_load_dwordx4 v[52:55], v10, s[24:27], s36 offen nt
    s_add_u32 s36, s36, 10240
    buffer_load_dwordx4 v[56:59], v10, s[24:27], s36 offen nt
    s_add_u32 s36, s36, 10240
    buffer_load_dwordx4 v[60:63], v10, s[24:27], s36 offen nt
    s_add_u32 s36, s36, 10240
    buffer_load_dwordx4 v[64:67], v10, s[24:27], s36 offen nt
    s_add_u32 s36, s36, 10240
    buffer_load_dwordx4 v[68:71], v10, s[24:27], s36 offen nt
    s_add_u32 s36, s36, 10240
    buffer_load_dwordx4 v[72:75], v10, s[24:27], s36 offen nt
    s_add_u32 s36, s36, 10240
    buffer_load_dwordx4 v[76:79], v10, s[24:27], s36 offen nt
    s_add_u32 s36, s36, 10240
    buffer_load_dwordx4 v[80:83], v10, s[24:27], s36 offen nt
    s_add_u32 s36, s36, 10240
    buffer_load_dwordx4 v[84:87], v10, s[24:27], s36 offen nt
    s_add_u32 s36, s36, 10240
    buffer_load_dwordx4 v[88:91], v10, s[24:27], s36 offen nt
    s_add_u32 s36, s36, 10240
    buffer_load_dwordx4 v[92:95], v10, s[24:27], s36 offen nt
    s_add_u32 s36, s36, 10240
    buffer_load_dwordx4 v[96:99], v10, s[24:27], s36 offen nt
    s_add_u32 s36, s36, 10240
    buffer_load_dwordx4 v[100:103], v10, s[24:27], s36 offen nt
    s_add_u32 s36, s36, 10240
    buffer_load_dwordx4 v[104:107], v10, s[24:27], s36 offen nt
    s_add_u32 s36, s36, 10240
    buffer_load_dwordx4 v[108:111], v10, s[24:27], s36 offen nt
    s_add_u32 s36, s36, 10240
    buffer_load_dwordx4 v[112:115], v10, s[24:27], s36 offen nt
    s_add_u32 s36, s36, 10240
    buffer_load_dwordx4 v[116:119], v10, s[24:27], s36 offen nt
    s_add_u32 s36, s36, 10240
    buffer_load_dwordx4 v[120:123], v10, s[24:27], s36 offen nt
    s_add_u32 s36, s36, 10240
    buffer_load_dwordx4 v[124:127], v10, s[24:27], s36 offen nt
    s_add_u32 s36, s36, 10240
    buffer_load_dwordx4 v[128:131], v10, s[24:27], s36 offen nt
    s_add_u32 s36, s36, 10240
    buffer_load_dwordx4 v[132:135], v10, s[24:27], s36 offen nt
    s_add_u32 s36, s36, 10240
    buffer_load_dwordx4 v[136:139], v10, s[24:27], s36 offen nt
    s_add_u32 s36, s36, 10240
    buffer_load_dwordx4 v[140:143], v10, s[24:27], s36 offen nt
    s_add_u32 s36, s36, 10240
    buffer_load_dwordx4 v[144:147], v10, s[24:27], s36 offen nt
    s_add_u32 s36, s36, 10240
    buffer_load_dwordx4 v[148:151], v10, s[24:27], s36 offen nt
    s_add_u32 s36, s36, 10240
    buffer_load_dwordx4 v[152:155], v10, s[24:27], s36 offen nt
    s_add_u32 s36, s36, 10240
    buffer_load_dwordx4 v[156:159], v10, s[24:27], s36 offen nt
    s_add_u32 s36, s36, 10240
    buffer_load_dwordx4 v[160:163], v10, s[24:27], s36 offen nt
    s_add_u32 s36, s36, 10240
    buffer_load_dwordx4 v[164:167], v10, s[24:27], s36 offen nt
    s_add_u32 s36, s36, 10240
    buffer_load_dwordx4 v[168:171], v10, s[24:27], s36 offen nt
    s_add_u32 s36, s36, 10240
    buffer_load_dwordx4 v[172:175], v10, s[24:27], s36 offen nt
    s_add_u32 s36, s36, 10240
    buffer_load_dwordx4 v[176:179], v10, s[24:27], s36 offen nt
    s_add_u32 s36, s36, 10240
    buffer_load_dwordx4 v[180:183], v10, s[24:27], s36 offen nt
    s_add_u32 s36, s36, 10240
    buffer_load_dwordx4 v[184:187], v10, s[24:27], s36 offen nt
    s_add_u32 s36, s36, 10240
    buffer_load_dwordx4 v[188:191], v10, s[24:27], s36 offen nt
    s_lshl_b32 s36, s35, 2
    s_add_u32 s36, s36, 0
    s_mul_i32 s38, s36, 6554
    s_lshr_b32 s38, s38, 16
    s_mul_i32 s39, s38, 10
    s_sub_u32 s39, s36, s39
    s_cmp_ge_u32 s39, 5
    s_cselect_b32 s40, 1, 0
    s_sub_u32 s41, s39, 6
    s_cmp_eq_u32 s39, 5
    s_cselect_b32 s41, 4, s41
    s_cmp_eq_u32 s40, 1
    s_cselect_b32 s39, s41, s39
    s_mul_i32 s37, s38, 200
    s_mul_i32 s40, s40, 100
    s_add_u32 s37, s37, s40
    s_mul_i32 s40, s33, 50
    s_add_u32 s37, s37, s40
    s_add_u32 s37, s37, s39
    s_lshl_b32 s37, s37, 10
    s_add_u32 s44, s37, 23236608
    s_movk_i32 s48, 5120
    s_lshl_b32 s36, s35, 2
    s_add_u32 s36, s36, 1
    s_mul_i32 s38, s36, 6554
    s_lshr_b32 s38, s38, 16
    s_mul_i32 s39, s38, 10
    s_sub_u32 s39, s36, s39
    s_cmp_ge_u32 s39, 5
    s_cselect_b32 s40, 1, 0
    s_sub_u32 s41, s39, 6
    s_cmp_eq_u32 s39, 5
    s_cselect_b32 s41, 4, s41
    s_cmp_eq_u32 s40, 1
    s_cselect_b32 s39, s41, s39
    s_mul_i32 s37, s38, 200
    s_mul_i32 s40, s40, 100
    s_add_u32 s37, s37, s40
    s_mul_i32 s40, s33, 50
    s_add_u32 s37, s37, s40
    s_add_u32 s37, s37, s39
    s_lshl_b32 s37, s37, 10
    s_add_u32 s45, s37, 23236608
    s_movk_i32 s49, 5120
    s_lshl_b32 s36, s35, 2
    s_add_u32 s36, s36, 2
    s_mul_i32 s38, s36, 6554
    s_lshr_b32 s38, s38, 16
    s_mul_i32 s39, s38, 10
    s_sub_u32 s39, s36, s39
    s_cmp_ge_u32 s39, 5
    s_cselect_b32 s40, 1, 0
    s_sub_u32 s41, s39, 6
    s_cmp_eq_u32 s39, 5
    s_cselect_b32 s41, 4, s41
    s_cmp_eq_u32 s40, 1
    s_cselect_b32 s39, s41, s39
    s_mul_i32 s37, s38, 200
    s_mul_i32 s40, s40, 100
    s_add_u32 s37, s37, s40
    s_mul_i32 s40, s33, 50
    s_add_u32 s37, s37, s40
    s_add_u32 s37, s37, s39
    s_lshl_b32 s37, s37, 10
    s_add_u32 s46, s37, 23236608
    s_movk_i32 s50, 5120
    s_lshl_b32 s36, s35, 2
    s_add_u32 s36, s36, 3
    s_mul_i32 s38, s36, 6554
    s_lshr_b32 s38, s38, 16
    s_mul_i32 s39, s38, 10
    s_sub_u32 s39, s36, s39
    s_cmp_ge_u32 s39, 5
    s_cselect_b32 s40, 1, 0
    s_sub_u32 s41, s39, 6
    s_cmp_eq_u32 s39, 5
    s_cselect_b32 s41, 4, s41
    s_cmp_eq_u32 s40, 1
    s_cselect_b32 s39, s41, s39
    s_mul_i32 s37, s38, 200
    s_mul_i32 s40, s40, 100
    s_add_u32 s37, s37, s40
    s_mul_i32 s40, s33, 50
    s_add_u32 s37, s37, s40
    s_add_u32 s37, s37, s39
    s_lshl_b32 s37, s37, 10
    s_add_u32 s47, s37, 23236608
    s_movk_i32 s51, 5120
    v_mov_b32 v12, 0
    v_mov_b32 v13, 0
    v_mov_b32 v14, 0
    v_mov_b32 v15, 0
    v_mov_b32 v16, 0x3f803f80
    s_waitcnt vmcnt(36)
    ds_write_b128 v5, v[32:35] offset:0
    ds_write_b128 v5, v[36:39] offset:1152
    ds_write_b128 v5, v[40:43] offset:2304
    ds_write_b128 v5, v[44:47] offset:3456
    s_waitcnt lgkmcnt(0)
    ds_read_b64_tr_b16 v[200:201], v8 offset:0
    ds_read_b64_tr_b16 v[202:203], v8 offset:576
    ds_read_b64_tr_b16 v[204:205], v8 offset:32
    ds_read_b64_tr_b16 v[206:207], v8 offset:608
    ds_read_b64_tr_b16 v[208:209], v8 offset:64
    ds_read_b64_tr_b16 v[210:211], v8 offset:640
    ds_read_b64_tr_b16 v[212:213], v8 offset:96
    ds_read_b64_tr_b16 v[214:215], v8 offset:672
    s_waitcnt vmcnt(32)
    ds_write_b128 v5, v[48:51] offset:4608
    ds_write_b128 v5, v[52:55] offset:5760
    ds_write_b128 v5, v[56:59] offset:6912
    ds_write_b128 v5, v[60:63] offset:8064
    s_waitcnt lgkmcnt(4)
    buffer_store_dwordx4 v[200:203], v9, s[28:31], s44 offen sc1
    s_add_u32 s44, s44, s48
    v_dot2_f32_bf16 v12, v200, v16, v12
    v_dot2_f32_bf16 v12, v201, v16, v12
    v_dot2_f32_bf16 v12, v202, v16, v12
    v_dot2_f32_bf16 v12, v203, v16, v12
    buffer_store_dwordx4 v[204:207], v9, s[28:31], s45 offen sc1
    s_add_u32 s45, s45, s49
    v_dot2_f32_bf16 v13, v204, v16, v13
    v_dot2_f32_bf16 v13, v205, v16, v13
    v_dot2_f32_bf16 v13, v206, v16, v13
    v_dot2_f32_bf16 v13, v207, v16, v13
    buffer_store_dwordx4 v[208:211], v9, s[28:31], s46 offen sc1
    s_add_u32 s46, s46, s50
    v_dot2_f32_bf16 v14, v208, v16, v14
    v_dot2_f32_bf16 v14, v209, v16, v14
    v_dot2_f32_bf16 v14, v210, v16, v14
    v_dot2_f32_bf16 v14, v211, v16, v14
    buffer_store_dwordx4 v[212:215], v9, s[28:31], s47 offen sc1
    s_add_u32 s47, s47, s51
    v_dot2_f32_bf16 v15, v212, v16, v15
    v_dot2_f32_bf16 v15, v213, v16, v15
    v_dot2_f32_bf16 v15, v214, v16, v15
    v_dot2_f32_bf16 v15, v215, v16, v15
    s_waitcnt lgkmcnt(0)
    ds_read_b64_tr_b16 v[216:217], v8 offset:4608
    ds_read_b64_tr_b16 v[218:219], v8 offset:5184
    ds_read_b64_tr_b16 v[220:221], v8 offset:4640
    ds_read_b64_tr_b16 v[222:223], v8 offset:5216
    ds_read_b64_tr_b16 v[224:225], v8 offset:4672
    ds_read_b64_tr_b16 v[226:227], v8 offset:5248
    ds_read_b64_tr_b16 v[228:229], v8 offset:4704
    ds_read_b64_tr_b16 v[230:231], v8 offset:5280
    s_waitcnt vmcnt(32)
    ds_write_b128 v5, v[64:67] offset:0
    ds_write_b128 v5, v[68:71] offset:1152
    ds_write_b128 v5, v[72:75] offset:2304
    ds_write_b128 v5, v[76:79] offset:3456
    s_waitcnt lgkmcnt(4)
    buffer_store_dwordx4 v[216:219], v9, s[28:31], s44 offen sc1
    s_add_u32 s44, s44, s48
    v_dot2_f32_bf16 v12, v216, v16, v12
    v_dot2_f32_bf16 v12, v217, v16, v12
    v_dot2_f32_bf16 v12, v218, v16, v12
    v_dot2_f32_bf16 v12, v219, v16, v12
    buffer_store_dwordx4 v[220:223], v9, s[28:31], s45 offen sc1
    s_add_u32 s45, s45, s49
    v_dot2_f32_bf16 v13, v220, v16, v13
    v_dot2_f32_bf16 v13, v221, v16, v13
    v_dot2_f32_bf16 v13, v222, v16, v13
    v_dot2_f32_bf16 v13, v223, v16, v13
    buffer_store_dwordx4 v[224:227], v9, s[28:31], s46 offen sc1
    s_add_u32 s46, s46, s50
    v_dot2_f32_bf16 v14, v224, v16, v14
    v_dot2_f32_bf16 v14, v225, v16, v14
    v_dot2_f32_bf16 v14, v226, v16, v14
    v_dot2_f32_bf16 v14, v227, v16, v14
    buffer_store_dwordx4 v[228:231], v9, s[28:31], s47 offen sc1
    s_add_u32 s47, s47, s51
    v_dot2_f32_bf16 v15, v228, v16, v15
    v_dot2_f32_bf16 v15, v229, v16, v15
    v_dot2_f32_bf16 v15, v230, v16, v15
    v_dot2_f32_bf16 v15, v231, v16, v15
    s_waitcnt lgkmcnt(0)
    ds_read_b64_tr_b16 v[200:201], v8 offset:0
    ds_read_b64_tr_b16 v[202:203], v8 offset:576
    ds_read_b64_tr_b16 v[204:205], v8 offset:32
    ds_read_b64_tr_b16 v[206:207], v8 offset:608
    ds_read_b64_tr_b16 v[208:209], v8 offset:64
    ds_read_b64_tr_b16 v[210:211], v8 offset:640
    ds_read_b64_tr_b16 v[212:213], v8 offset:96
    ds_read_b64_tr_b16 v[214:215], v8 offset:672
    s_waitcnt vmcnt(32)
    ds_write_b128 v5, v[80:83] offset:4608
    ds_write_b128 v5, v[84:87] offset:5760
    ds_write_b128 v5, v[88:91] offset:6912
    ds_write_b128 v5, v[92:95] offset:8064
    s_waitcnt lgkmcnt(4)
    buffer_store_dwordx4 v[200:203], v9, s[28:31], s44 offen sc1
    s_add_u32 s44, s44, s48
    v_dot2_f32_bf16 v12, v200, v16, v12
    v_dot2_f32_bf16 v12, v201, v16, v12
    v_dot2_f32_bf16 v12, v202, v16, v12
    v_dot2_f32_bf16 v12, v203, v16, v12
    buffer_store_dwordx4 v[204:207], v9, s[28:31], s45 offen sc1
    s_add_u32 s45, s45, s49
    v_dot2_f32_bf16 v13, v204, v16, v13
    v_dot2_f32_bf16 v13, v205, v16, v13
    v_dot2_f32_bf16 v13, v206, v16, v13
    v_dot2_f32_bf16 v13, v207, v16, v13
    buffer_store_dwordx4 v[208:211], v9, s[28:31], s46 offen sc1
    s_add_u32 s46, s46, s50
    v_dot2_f32_bf16 v14, v208, v16, v14
    v_dot2_f32_bf16 v14, v209, v16, v14
    v_dot2_f32_bf16 v14, v210, v16, v14
    v_dot2_f32_bf16 v14, v211, v16, v14
    buffer_store_dwordx4 v[212:215], v9, s[28:31], s47 offen sc1
    s_add_u32 s47, s47, s51
    v_dot2_f32_bf16 v15, v212, v16, v15
    v_dot2_f32_bf16 v15, v213, v16, v15
    v_dot2_f32_bf16 v15, v214, v16, v15
    v_dot2_f32_bf16 v15, v215, v16, v15
    s_waitcnt lgkmcnt(0)
    ds_read_b64_tr_b16 v[216:217], v8 offset:4608
    ds_read_b64_tr_b16 v[218:219], v8 offset:5184
    ds_read_b64_tr_b16 v[220:221], v8 offset:4640
    ds_read_b64_tr_b16 v[222:223], v8 offset:5216
    ds_read_b64_tr_b16 v[224:225], v8 offset:4672
    ds_read_b64_tr_b16 v[226:227], v8 offset:5248
    ds_read_b64_tr_b16 v[228:229], v8 offset:4704
    ds_read_b64_tr_b16 v[230:231], v8 offset:5280
    s_waitcnt vmcnt(32)
    ds_write_b128 v5, v[96:99] offset:0
    ds_write_b128 v5, v[100:103] offset:1152
    ds_write_b128 v5, v[104:107] offset:2304
    ds_write_b128 v5, v[108:111] offset:3456
    s_waitcnt lgkmcnt(4)
    buffer_store_dwordx4 v[216:219], v9, s[28:31], s44 offen sc1
    s_add_u32 s44, s44, s48
    v_dot2_f32_bf16 v12, v216, v16, v12
    v_dot2_f32_bf16 v12, v217, v16, v12
    v_dot2_f32_bf16 v12, v218, v16, v12
    v_dot2_f32_bf16 v12, v219, v16, v12
    buffer_store_dwordx4 v[220:223], v9, s[28:31], s45 offen sc1
    s_add_u32 s45, s45, s49
    v_dot2_f32_bf16 v13, v220, v16, v13
    v_dot2_f32_bf16 v13, v221, v16, v13
    v_dot2_f32_bf16 v13, v222, v16, v13
    v_dot2_f32_bf16 v13, v223, v16, v13
    buffer_store_dwordx4 v[224:227], v9, s[28:31], s46 offen sc1
    s_add_u32 s46, s46, s50
    v_dot2_f32_bf16 v14, v224, v16, v14
    v_dot2_f32_bf16 v14, v225, v16, v14
    v_dot2_f32_bf16 v14, v226, v16, v14
    v_dot2_f32_bf16 v14, v227, v16, v14
    buffer_store_dwordx4 v[228:231], v9, s[28:31], s47 offen sc1
    s_add_u32 s47, s47, s51
    v_dot2_f32_bf16 v15, v228, v16, v15
    v_dot2_f32_bf16 v15, v229, v16, v15
    v_dot2_f32_bf16 v15, v230, v16, v15
    v_dot2_f32_bf16 v15, v231, v16, v15
    s_waitcnt lgkmcnt(0)
    ds_read_b64_tr_b16 v[200:201], v8 offset:0
    ds_read_b64_tr_b16 v[202:203], v8 offset:576
    ds_read_b64_tr_b16 v[204:205], v8 offset:32
    ds_read_b64_tr_b16 v[206:207], v8 offset:608
    ds_read_b64_tr_b16 v[208:209], v8 offset:64
    ds_read_b64_tr_b16 v[210:211], v8 offset:640
    ds_read_b64_tr_b16 v[212:213], v8 offset:96
    ds_read_b64_tr_b16 v[214:215], v8 offset:672
    s_waitcnt vmcnt(32)
    ds_write_b128 v5, v[112:115] offset:4608
    ds_write_b128 v5, v[116:119] offset:5760
    ds_write_b128 v5, v[120:123] offset:6912
    ds_write_b128 v5, v[124:127] offset:8064
    s_waitcnt lgkmcnt(4)
    buffer_store_dwordx4 v[200:203], v9, s[28:31], s44 offen sc1
    s_add_u32 s44, s44, s48
    v_dot2_f32_bf16 v12, v200, v16, v12
    v_dot2_f32_bf16 v12, v201, v16, v12
    v_dot2_f32_bf16 v12, v202, v16, v12
    v_dot2_f32_bf16 v12, v203, v16, v12
    buffer_store_dwordx4 v[204:207], v9, s[28:31], s45 offen sc1
    s_add_u32 s45, s45, s49
    v_dot2_f32_bf16 v13, v204, v16, v13
    v_dot2_f32_bf16 v13, v205, v16, v13
    v_dot2_f32_bf16 v13, v206, v16, v13
    v_dot2_f32_bf16 v13, v207, v16, v13
    buffer_store_dwordx4 v[208:211], v9, s[28:31], s46 offen sc1
    s_add_u32 s46, s46, s50
    v_dot2_f32_bf16 v14, v208, v16, v14
    v_dot2_f32_bf16 v14, v209, v16, v14
    v_dot2_f32_bf16 v14, v210, v16, v14
    v_dot2_f32_bf16 v14, v211, v16, v14
    buffer_store_dwordx4 v[212:215], v9, s[28:31], s47 offen sc1
    s_add_u32 s47, s47, s51
    v_dot2_f32_bf16 v15, v212, v16, v15
    v_dot2_f32_bf16 v15, v213, v16, v15
    v_dot2_f32_bf16 v15, v214, v16, v15
    v_dot2_f32_bf16 v15, v215, v16, v15
    s_waitcnt lgkmcnt(0)
    ds_read_b64_tr_b16 v[216:217], v8 offset:4608
    ds_read_b64_tr_b16 v[218:219], v8 offset:5184
    ds_read_b64_tr_b16 v[220:221], v8 offset:4640
    ds_read_b64_tr_b16 v[222:223], v8 offset:5216
    ds_read_b64_tr_b16 v[224:225], v8 offset:4672
    ds_read_b64_tr_b16 v[226:227], v8 offset:5248
    ds_read_b64_tr_b16 v[228:229], v8 offset:4704
    ds_read_b64_tr_b16 v[230:231], v8 offset:5280
    s_waitcnt vmcnt(32)
    ds_write_b128 v5, v[128:131] offset:0
    ds_write_b128 v5, v[132:135] offset:1152
    ds_write_b128 v5, v[136:139] offset:2304
    ds_write_b128 v5, v[140:143] offset:3456
    s_waitcnt lgkmcnt(4)
    buffer_store_dwordx4 v[216:219], v9, s[28:31], s44 offen sc1
    s_add_u32 s44, s44, s48
    v_dot2_f32_bf16 v12, v216, v16, v12
    v_dot2_f32_bf16 v12, v217, v16, v12
    v_dot2_f32_bf16 v12, v218, v16, v12
    v_dot2_f32_bf16 v12, v219, v16, v12
    buffer_store_dwordx4 v[220:223], v9, s[28:31], s45 offen sc1
    s_add_u32 s45, s45, s49
    v_dot2_f32_bf16 v13, v220, v16, v13
    v_dot2_f32_bf16 v13, v221, v16, v13
    v_dot2_f32_bf16 v13, v222, v16, v13
    v_dot2_f32_bf16 v13, v223, v16, v13
    buffer_store_dwordx4 v[224:227], v9, s[28:31], s46 offen sc1
    s_add_u32 s46, s46, s50
    v_dot2_f32_bf16 v14, v224, v16, v14
    v_dot2_f32_bf16 v14, v225, v16, v14
    v_dot2_f32_bf16 v14, v226, v16, v14
    v_dot2_f32_bf16 v14, v227, v16, v14
    buffer_store_dwordx4 v[228:231], v9, s[28:31], s47 offen sc1
    s_add_u32 s47, s47, s51
    v_dot2_f32_bf16 v15, v228, v16, v15
    v_dot2_f32_bf16 v15, v229, v16, v15
    v_dot2_f32_bf16 v15, v230, v16, v15
    v_dot2_f32_bf16 v15, v231, v16, v15
    s_waitcnt lgkmcnt(0)
    ds_read_b64_tr_b16 v[200:201], v8 offset:0
    ds_read_b64_tr_b16 v[202:203], v8 offset:576
    ds_read_b64_tr_b16 v[204:205], v8 offset:32
    ds_read_b64_tr_b16 v[206:207], v8 offset:608
    ds_read_b64_tr_b16 v[208:209], v8 offset:64
    ds_read_b64_tr_b16 v[210:211], v8 offset:640
    ds_read_b64_tr_b16 v[212:213], v8 offset:96
    ds_read_b64_tr_b16 v[214:215], v8 offset:672
    s_waitcnt vmcnt(32)
    ds_write_b128 v5, v[144:147] offset:4608
    ds_write_b128 v5, v[148:151] offset:5760
    ds_write_b128 v5, v[152:155] offset:6912
    ds_write_b128 v5, v[156:159] offset:8064
    s_waitcnt lgkmcnt(4)
    buffer_store_dwordx4 v[200:203], v9, s[28:31], s44 offen sc1
    s_add_u32 s44, s44, s48
    v_dot2_f32_bf16 v12, v200, v16, v12
    v_dot2_f32_bf16 v12, v201, v16, v12
    v_dot2_f32_bf16 v12, v202, v16, v12
    v_dot2_f32_bf16 v12, v203, v16, v12
    buffer_store_dwordx4 v[204:207], v9, s[28:31], s45 offen sc1
    s_add_u32 s45, s45, s49
    v_dot2_f32_bf16 v13, v204, v16, v13
    v_dot2_f32_bf16 v13, v205, v16, v13
    v_dot2_f32_bf16 v13, v206, v16, v13
    v_dot2_f32_bf16 v13, v207, v16, v13
    buffer_store_dwordx4 v[208:211], v9, s[28:31], s46 offen sc1
    s_add_u32 s46, s46, s50
    v_dot2_f32_bf16 v14, v208, v16, v14
    v_dot2_f32_bf16 v14, v209, v16, v14
    v_dot2_f32_bf16 v14, v210, v16, v14
    v_dot2_f32_bf16 v14, v211, v16, v14
    buffer_store_dwordx4 v[212:215], v9, s[28:31], s47 offen sc1
    s_add_u32 s47, s47, s51
    v_dot2_f32_bf16 v15, v212, v16, v15
    v_dot2_f32_bf16 v15, v213, v16, v15
    v_dot2_f32_bf16 v15, v214, v16, v15
    v_dot2_f32_bf16 v15, v215, v16, v15
    s_waitcnt lgkmcnt(0)
    ds_read_b64_tr_b16 v[216:217], v8 offset:4608
    ds_read_b64_tr_b16 v[218:219], v8 offset:5184
    ds_read_b64_tr_b16 v[220:221], v8 offset:4640
    ds_read_b64_tr_b16 v[222:223], v8 offset:5216
    ds_read_b64_tr_b16 v[224:225], v8 offset:4672
    ds_read_b64_tr_b16 v[226:227], v8 offset:5248
    ds_read_b64_tr_b16 v[228:229], v8 offset:4704
    ds_read_b64_tr_b16 v[230:231], v8 offset:5280
    s_waitcnt vmcnt(32)
    ds_write_b128 v5, v[160:163] offset:0
    ds_write_b128 v5, v[164:167] offset:1152
    ds_write_b128 v5, v[168:171] offset:2304
    ds_write_b128 v5, v[172:175] offset:3456
    s_waitcnt lgkmcnt(4)
    buffer_store_dwordx4 v[216:219], v9, s[28:31], s44 offen sc1
    s_add_u32 s44, s44, s48
    v_dot2_f32_bf16 v12, v216, v16, v12
    v_dot2_f32_bf16 v12, v217, v16, v12
    v_dot2_f32_bf16 v12, v218, v16, v12
    v_dot2_f32_bf16 v12, v219, v16, v12
    buffer_store_dwordx4 v[220:223], v9, s[28:31], s45 offen sc1
    s_add_u32 s45, s45, s49
    v_dot2_f32_bf16 v13, v220, v16, v13
    v_dot2_f32_bf16 v13, v221, v16, v13
    v_dot2_f32_bf16 v13, v222, v16, v13
    v_dot2_f32_bf16 v13, v223, v16, v13
    buffer_store_dwordx4 v[224:227], v9, s[28:31], s46 offen sc1
    s_add_u32 s46, s46, s50
    v_dot2_f32_bf16 v14, v224, v16, v14
    v_dot2_f32_bf16 v14, v225, v16, v14
    v_dot2_f32_bf16 v14, v226, v16, v14
    v_dot2_f32_bf16 v14, v227, v16, v14
    buffer_store_dwordx4 v[228:231], v9, s[28:31], s47 offen sc1
    s_add_u32 s47, s47, s51
    v_dot2_f32_bf16 v15, v228, v16, v15
    v_dot2_f32_bf16 v15, v229, v16, v15
    v_dot2_f32_bf16 v15, v230, v16, v15
    v_dot2_f32_bf16 v15, v231, v16, v15
    s_waitcnt lgkmcnt(0)
    ds_read_b64_tr_b16 v[200:201], v8 offset:0
    ds_read_b64_tr_b16 v[202:203], v8 offset:576
    ds_read_b64_tr_b16 v[204:205], v8 offset:32
    ds_read_b64_tr_b16 v[206:207], v8 offset:608
    ds_read_b64_tr_b16 v[208:209], v8 offset:64
    ds_read_b64_tr_b16 v[210:211], v8 offset:640
    ds_read_b64_tr_b16 v[212:213], v8 offset:96
    ds_read_b64_tr_b16 v[214:215], v8 offset:672
    s_waitcnt vmcnt(32)
    ds_write_b128 v5, v[176:179] offset:4608
    ds_write_b128 v5, v[180:183] offset:5760
    ds_write_b128 v5, v[184:187] offset:6912
    ds_write_b128 v5, v[188:191] offset:8064
    s_waitcnt lgkmcnt(4)
    buffer_store_dwordx4 v[200:203], v9, s[28:31], s44 offen sc1
    s_add_u32 s44, s44, s48
    v_dot2_f32_bf16 v12, v200, v16, v12
    v_dot2_f32_bf16 v12, v201, v16, v12
    v_dot2_f32_bf16 v12, v202, v16, v12
    v_dot2_f32_bf16 v12, v203, v16, v12
    buffer_store_dwordx4 v[204:207], v9, s[28:31], s45 offen sc1
    s_add_u32 s45, s45, s49
    v_dot2_f32_bf16 v13, v204, v16, v13
    v_dot2_f32_bf16 v13, v205, v16, v13
    v_dot2_f32_bf16 v13, v206, v16, v13
    v_dot2_f32_bf16 v13, v207, v16, v13
    buffer_store_dwordx4 v[208:211], v9, s[28:31], s46 offen sc1
    s_add_u32 s46, s46, s50
    v_dot2_f32_bf16 v14, v208, v16, v14
    v_dot2_f32_bf16 v14, v209, v16, v14
    v_dot2_f32_bf16 v14, v210, v16, v14
    v_dot2_f32_bf16 v14, v211, v16, v14
    buffer_store_dwordx4 v[212:215], v9, s[28:31], s47 offen sc1
    s_add_u32 s47, s47, s51
    v_dot2_f32_bf16 v15, v212, v16, v15
    v_dot2_f32_bf16 v15, v213, v16, v15
    v_dot2_f32_bf16 v15, v214, v16, v15
    v_dot2_f32_bf16 v15, v215, v16, v15
    s_waitcnt lgkmcnt(0)
    ds_read_b64_tr_b16 v[216:217], v8 offset:4608
    ds_read_b64_tr_b16 v[218:219], v8 offset:5184
    ds_read_b64_tr_b16 v[220:221], v8 offset:4640
    ds_read_b64_tr_b16 v[222:223], v8 offset:5216
    ds_read_b64_tr_b16 v[224:225], v8 offset:4672
    ds_read_b64_tr_b16 v[226:227], v8 offset:5248
    ds_read_b64_tr_b16 v[228:229], v8 offset:4704
    ds_read_b64_tr_b16 v[230:231], v8 offset:5280
    s_waitcnt lgkmcnt(0)
    buffer_store_dwordx4 v[216:219], v9, s[28:31], s44 offen sc1
    s_add_u32 s44, s44, s48
    v_dot2_f32_bf16 v12, v216, v16, v12
    v_dot2_f32_bf16 v12, v217, v16, v12
    v_dot2_f32_bf16 v12, v218, v16, v12
    v_dot2_f32_bf16 v12, v219, v16, v12
    buffer_store_dwordx4 v[220:223], v9, s[28:31], s45 offen sc1
    s_add_u32 s45, s45, s49
    v_dot2_f32_bf16 v13, v220, v16, v13
    v_dot2_f32_bf16 v13, v221, v16, v13
    v_dot2_f32_bf16 v13, v222, v16, v13
    v_dot2_f32_bf16 v13, v223, v16, v13
    buffer_store_dwordx4 v[224:227], v9, s[28:31], s46 offen sc1
    s_add_u32 s46, s46, s50
    v_dot2_f32_bf16 v14, v224, v16, v14
    v_dot2_f32_bf16 v14, v225, v16, v14
    v_dot2_f32_bf16 v14, v226, v16, v14
    v_dot2_f32_bf16 v14, v227, v16, v14
    buffer_store_dwordx4 v[228:231], v9, s[28:31], s47 offen sc1
    s_add_u32 s47, s47, s51
    v_dot2_f32_bf16 v15, v228, v16, v15
    v_dot2_f32_bf16 v15, v229, v16, v15
    v_dot2_f32_bf16 v15, v230, v16, v15
    v_dot2_f32_bf16 v15, v231, v16, v15
    s_nop 2
    v_mov_b32 v20, v12
    v_mov_b32 v21, v13
    v_mov_b32 v22, v14
    v_mov_b32 v23, v15
    s_nop 1
    v_permlane32_swap_b32 v20, v12
    v_permlane32_swap_b32 v21, v13
    v_permlane32_swap_b32 v22, v14
    v_permlane32_swap_b32 v23, v15
    s_nop 1
    v_add_f32 v12, v12, v20
    v_add_f32 v13, v13, v21
    v_add_f32 v14, v14, v22
    v_add_f32 v15, v15, v23
    v_mov_b32 v20, v12
    v_mov_b32 v21, v13
    v_mov_b32 v22, v14
    v_mov_b32 v23, v15
    s_nop 1
    v_permlane16_swap_b32 v20, v12
    v_permlane16_swap_b32 v21, v13
    v_permlane16_swap_b32 v22, v14
    v_permlane16_swap_b32 v23, v15
    s_nop 1
    v_add_f32 v12, v12, v20
    v_add_f32 v13, v13, v21
    v_add_f32 v14, v14, v22
    v_add_f32 v15, v15, v23
    s_mul_i32 s38, s33, 7168
    s_lshl_b32 s39, s35, 8
    s_add_u32 s38, s38, s39
    s_add_u32 s38, s38, 8146944
    v_lshlrev_b32 v17, 2, v1
    s_mov_b64 exec, 0xffff
    buffer_store_dword v12, v17, s[28:31], s38 offen offset:0 sc1
    buffer_store_dword v13, v17, s[28:31], s38 offen offset:64 sc1
    buffer_store_dword v14, v17, s[28:31], s38 offen offset:128 sc1
    buffer_store_dword v15, v17, s[28:31], s38 offen offset:192 sc1
    s_endpgm
prep_kernel_pk30:
    s_mov_b32 s24, s14
    s_mov_b32 s25, s15
    s_mov_b32 s26, 819200
    s_mov_b32 s27, 0x00020000
    s_sub_u32 s32, s21, 20
    s_mul_i32 s33, s32, 52429
    s_lshr_b32 s33, s33, 19
    s_mul_i32 s35, s33, 10
    s_sub_u32 s35, s32, s35
    v_mul_u32_u24 v10, 1280, v3
    v_lshl_add_u32 v10, v4, 4, v10
    s_mul_i32 s36, s33, 409600
    s_lshl_b32 s37, s35, 7
    s_add_u32 s36, s36, s37
    buffer_load_dwordx4 v[32:35], v10, s[24:27], s36 offen nt
    s_add_u32 s36, s36, 10240
    buffer_load_dwordx4 v[36:39], v10, s[24:27], s36 offen nt
    s_add_u32 s36, s36, 10240
    buffer_load_dwordx4 v[40:43], v10, s[24:27], s36 offen nt
    s_add_u32 s36, s36, 10240
    buffer_load_dwordx4 v[44:47], v10, s[24:27], s36 offen nt
    s_add_u32 s36, s36, 10240
    buffer_load_dwordx4 v[48:51], v10, s[24:27], s36 offen nt
    s_add_u32 s36, s36, 10240
    buffer_load_dwordx4 v[52:55], v10, s[24:27], s36 offen nt
    s_add_u32 s36, s36, 10240
    buffer_load_dwordx4 v[56:59], v10, s[24:27], s36 offen nt
    s_add_u32 s36, s36, 10240
    buffer_load_dwordx4 v[60:63], v10, s[24:27], s36 offen nt
    s_add_u32 s36, s36, 10240
    buffer_load_dwordx4 v[64:67], v10, s[24:27], s36 offen nt
    s_add_u32 s36, s36, 10240
    buffer_load_dwordx4 v[68:71], v10, s[24:27], s36 offen nt
    s_add_u32 s36, s36, 10240
    buffer_load_dwordx4 v[72:75], v10, s[24:27], s36 offen nt
    s_add_u32 s36, s36, 10240
    buffer_load_dwordx4 v[76:79], v10, s[24:27], s36 offen nt
    s_add_u32 s36, s36, 10240
    buffer_load_dwordx4 v[80:83], v10, s[24:27], s36 offen nt
    s_add_u32 s36, s36, 10240
    buffer_load_dwordx4 v[84:87], v10, s[24:27], s36 offen nt
    s_add_u32 s36, s36, 10240
    buffer_load_dwordx4 v[88:91], v10, s[24:27], s36 offen nt
    s_add_u32 s36, s36, 10240
    buffer_load_dwordx4 v[92:95], v10, s[24:27], s36 offen nt
    s_add_u32 s36, s36, 10240
    buffer_load_dwordx4 v[96:99], v10, s[24:27], s36 offen nt
    s_add_u32 s36, s36, 10240
    buffer_load_dwordx4 v[100:103], v10, s[24:27], s36 offen nt
    s_add_u32 s36, s36, 10240
    buffer_load_dwordx4 v[104:107], v10, s[24:27], s36 offen nt
    s_add_u32 s36, s36, 10240
    buffer_load_dwordx4 v[108:111], v10, s[24:27], s36 offen nt
    s_add_u32 s36, s36, 10240
    buffer_load_dwordx4 v[112:115], v10, s[24:27], s36 offen nt
    s_add_u32 s36, s36, 10240
    buffer_load_dwordx4 v[116:119], v10, s[24:27], s36 offen nt
    s_add_u32 s36, s36, 10240
    buffer_load_dwordx4 v[120:123], v10, s[24:27], s36 offen nt
    s_add_u32 s36, s36, 10240
    buffer_load_dwordx4 v[124:127], v10, s[24:27], s36 offen nt
    s_add_u32 s36, s36, 10240
    buffer_load_dwordx4 v[128:131], v10, s[24:27], s36 offen nt
    s_add_u32 s36, s36, 10240
    buffer_load_dwordx4 v[132:135], v10, s[24:27], s36 offen nt
    s_add_u32 s36, s36, 10240
    buffer_load_dwordx4 v[136:139], v10, s[24:27], s36 offen nt
    s_add_u32 s36, s36, 10240
    buffer_load_dwordx4 v[140:143], v10, s[24:27], s36 offen nt
    s_add_u32 s36, s36, 10240
    buffer_load_dwordx4 v[144:147], v10, s[24:27], s36 offen nt
    s_add_u32 s36, s36, 10240
    buffer_load_dwordx4 v[148:151], v10, s[24:27], s36 offen nt
    s_add_u32 s36, s36, 10240
    buffer_load_dwordx4 v[152:155], v10, s[24:27], s36 offen nt
    s_add_u32 s36, s36, 10240
    buffer_load_dwordx4 v[156:159], v10, s[24:27], s36 offen nt
    s_add_u32 s36, s36, 10240
    buffer_load_dwordx4 v[160:163], v10, s[24:27], s36 offen nt
    s_add_u32 s36, s36, 10240
    buffer_load_dwordx4 v[164:167], v10, s[24:27], s36 offen nt
    s_add_u32 s36, s36, 10240
    buffer_load_dwordx4 v[168:171], v10, s[24:27], s36 offen nt
    s_add_u32 s36, s36, 10240
    buffer_load_dwordx4 v[172:175], v10, s[24:27], s36 offen nt
    s_add_u32 s36, s36, 10240
    buffer_load_dwordx4 v[176:179], v10, s[24:27], s36 offen nt
    s_add_u32 s36, s36, 10240
    buffer_load_dwordx4 v[180:183], v10, s[24:27], s36 offen nt
    s_add_u32 s36, s36, 10240
    buffer_load_dwordx4 v[184:187], v10, s[24:27], s36 offen nt
    s_add_u32 s36, s36, 10240
    buffer_load_dwordx4 v[188:191], v10, s[24:27], s36 offen nt
    s_lshl_b32 s36, s35, 2
    s_add_u32 s36, s36, 0
    s_mul_i32 s38, s36, 6554
    s_lshr_b32 s38, s38, 16
    s_mul_i32 s39, s38, 10
    s_sub_u32 s39, s36, s39
    s_cmp_ge_u32 s39, 5
    s_cselect_b32 s40, 1, 0
    s_sub_u32 s41, s39, 6
    s_cmp_eq_u32 s39, 5
    s_cselect_b32 s41, 4, s41
    s_cmp_eq_u32 s40, 1
    s_cselect_b32 s39, s41, s39
    s_mul_i32 s37, s38, 200
    s_mul_i32 s40, s40, 100
    s_add_u32 s37, s37, s40
    s_mul_i32 s40, s33, 50
    s_add_u32 s37, s37, s40
    s_add_u32 s37, s37, s39
    s_lshl_b32 s37, s37, 10
    s_add_u32 s44, s37, 24055808
    s_movk_i32 s48, 5120
    s_lshl_b32 s36, s35, 2
    s_add_u32 s36, s36, 1
    s_mul_i32 s38, s36, 6554
    s_lshr_b32 s38, s38, 16
    s_mul_i32 s39, s38, 10
    s_sub_u32 s39, s36, s39
    s_cmp_ge_u32 s39, 5
    s_cselect_b32 s40, 1, 0
    s_sub_u32 s41, s39, 6
    s_cmp_eq_u32 s39, 5
    s_cselect_b32 s41, 4, s41
    s_cmp_eq_u32 s40, 1
    s_cselect_b32 s39, s41, s39
    s_mul_i32 s37, s38, 200
    s_mul_i32 s40, s40, 100
    s_add_u32 s37, s37, s40
    s_mul_i32 s40, s33, 50
    s_add_u32 s37, s37, s40
    s_add_u32 s37, s37, s39
    s_lshl_b32 s37, s37, 10
    s_add_u32 s45, s37, 24055808
    s_movk_i32 s49, 5120
    s_lshl_b32 s36, s35, 2
    s_add_u32 s36, s36, 2
    s_mul_i32 s38, s36, 6554
    s_lshr_b32 s38, s38, 16
    s_mul_i32 s39, s38, 10
    s_sub_u32 s39, s36, s39
    s_cmp_ge_u32 s39, 5
    s_cselect_b32 s40, 1, 0
    s_sub_u32 s41, s39, 6
    s_cmp_eq_u32 s39, 5
    s_cselect_b32 s41, 4, s41
    s_cmp_eq_u32 s40, 1
    s_cselect_b32 s39, s41, s39
    s_mul_i32 s37, s38, 200
    s_mul_i32 s40, s40, 100
    s_add_u32 s37, s37, s40
    s_mul_i32 s40, s33, 50
    s_add_u32 s37, s37, s40
    s_add_u32 s37, s37, s39
    s_lshl_b32 s37, s37, 10
    s_add_u32 s46, s37, 24055808
    s_movk_i32 s50, 5120
    s_lshl_b32 s36, s35, 2
    s_add_u32 s36, s36, 3
    s_mul_i32 s38, s36, 6554
    s_lshr_b32 s38, s38, 16
    s_mul_i32 s39, s38, 10
    s_sub_u32 s39, s36, s39
    s_cmp_ge_u32 s39, 5
    s_cselect_b32 s40, 1, 0
    s_sub_u32 s41, s39, 6
    s_cmp_eq_u32 s39, 5
    s_cselect_b32 s41, 4, s41
    s_cmp_eq_u32 s40, 1
    s_cselect_b32 s39, s41, s39
    s_mul_i32 s37, s38, 200
    s_mul_i32 s40, s40, 100
    s_add_u32 s37, s37, s40
    s_mul_i32 s40, s33, 50
    s_add_u32 s37, s37, s40
    s_add_u32 s37, s37, s39
    s_lshl_b32 s37, s37, 10
    s_add_u32 s47, s37, 24055808
    s_movk_i32 s51, 5120
    s_waitcnt vmcnt(36)
    ds_write_b128 v5, v[32:35] offset:0
    ds_write_b128 v5, v[36:39] offset:1152
    ds_write_b128 v5, v[40:43] offset:2304
    ds_write_b128 v5, v[44:47] offset:3456
    s_waitcnt lgkmcnt(0)
    ds_read_b64_tr_b16 v[200:201], v8 offset:0
    ds_read_b64_tr_b16 v[202:203], v8 offset:576
    ds_read_b64_tr_b16 v[204:205], v8 offset:32
    ds_read_b64_tr_b16 v[206:207], v8 offset:608
    ds_read_b64_tr_b16 v[208:209], v8 offset:64
    ds_read_b64_tr_b16 v[210:211], v8 offset:640
    ds_read_b64_tr_b16 v[212:213], v8 offset:96
    ds_read_b64_tr_b16 v[214:215], v8 offset:672
    s_waitcnt vmcnt(32)
    ds_write_b128 v5, v[48:51] offset:4608
    ds_write_b128 v5, v[52:55] offset:5760
    ds_write_b128 v5, v[56:59] offset:6912
    ds_write_b128 v5, v[60:63] offset:8064
    s_waitcnt lgkmcnt(4)
    buffer_store_dwordx4 v[200:203], v9, s[28:31], s44 offen sc1
    s_add_u32 s44, s44, s48
    buffer_store_dwordx4 v[204:207], v9, s[28:31], s45 offen sc1
    s_add_u32 s45, s45, s49
    buffer_store_dwordx4 v[208:211], v9, s[28:31], s46 offen sc1
    s_add_u32 s46, s46, s50
    buffer_store_dwordx4 v[212:215], v9, s[28:31], s47 offen sc1
    s_add_u32 s47, s47, s51
    s_waitcnt lgkmcnt(0)
    ds_read_b64_tr_b16 v[216:217], v8 offset:4608
    ds_read_b64_tr_b16 v[218:219], v8 offset:5184
    ds_read_b64_tr_b16 v[220:221], v8 offset:4640
    ds_read_b64_tr_b16 v[222:223], v8 offset:5216
    ds_read_b64_tr_b16 v[224:225], v8 offset:4672
    ds_read_b64_tr_b16 v[226:227], v8 offset:5248
    ds_read_b64_tr_b16 v[228:229], v8 offset:4704
    ds_read_b64_tr_b16 v[230:231], v8 offset:5280
    s_waitcnt vmcnt(32)
    ds_write_b128 v5, v[64:67] offset:0
    ds_write_b128 v5, v[68:71] offset:1152
    ds_write_b128 v5, v[72:75] offset:2304
    ds_write_b128 v5, v[76:79] offset:3456
    s_waitcnt lgkmcnt(4)
    buffer_store_dwordx4 v[216:219], v9, s[28:31], s44 offen sc1
    s_add_u32 s44, s44, s48
    buffer_store_dwordx4 v[220:223], v9, s[28:31], s45 offen sc1
    s_add_u32 s45, s45, s49
    buffer_store_dwordx4 v[224:227], v9, s[28:31], s46 offen sc1
    s_add_u32 s46, s46, s50
    buffer_store_dwordx4 v[228:231], v9, s[28:31], s47 offen sc1
    s_add_u32 s47, s47, s51
    s_waitcnt lgkmcnt(0)
    ds_read_b64_tr_b16 v[200:201], v8 offset:0
    ds_read_b64_tr_b16 v[202:203], v8 offset:576
    ds_read_b64_tr_b16 v[204:205], v8 offset:32
    ds_read_b64_tr_b16 v[206:207], v8 offset:608
    ds_read_b64_tr_b16 v[208:209], v8 offset:64
    ds_read_b64_tr_b16 v[210:211], v8 offset:640
    ds_read_b64_tr_b16 v[212:213], v8 offset:96
    ds_read_b64_tr_b16 v[214:215], v8 offset:672
    s_waitcnt vmcnt(32)
    ds_write_b128 v5, v[80:83] offset:4608
    ds_write_b128 v5, v[84:87] offset:5760
    ds_write_b128 v5, v[88:91] offset:6912
    ds_write_b128 v5, v[92:95] offset:8064
    s_waitcnt lgkmcnt(4)
    buffer_store_dwordx4 v[200:203], v9, s[28:31], s44 offen sc1
    s_add_u32 s44, s44, s48
    buffer_store_dwordx4 v[204:207], v9, s[28:31], s45 offen sc1
    s_add_u32 s45, s45, s49
    buffer_store_dwordx4 v[208:211], v9, s[28:31], s46 offen sc1
    s_add_u32 s46, s46, s50
    buffer_store_dwordx4 v[212:215], v9, s[28:31], s47 offen sc1
    s_add_u32 s47, s47, s51
    s_waitcnt lgkmcnt(0)
    ds_read_b64_tr_b16 v[216:217], v8 offset:4608
    ds_read_b64_tr_b16 v[218:219], v8 offset:5184
    ds_read_b64_tr_b16 v[220:221], v8 offset:4640
    ds_read_b64_tr_b16 v[222:223], v8 offset:5216
    ds_read_b64_tr_b16 v[224:225], v8 offset:4672
    ds_read_b64_tr_b16 v[226:227], v8 offset:5248
    ds_read_b64_tr_b16 v[228:229], v8 offset:4704
    ds_read_b64_tr_b16 v[230:231], v8 offset:5280
    s_waitcnt vmcnt(32)
    ds_write_b128 v5, v[96:99] offset:0
    ds_write_b128 v5, v[100:103] offset:1152
    ds_write_b128 v5, v[104:107] offset:2304
    ds_write_b128 v5, v[108:111] offset:3456
    s_waitcnt lgkmcnt(4)
    buffer_store_dwordx4 v[216:219], v9, s[28:31], s44 offen sc1
    s_add_u32 s44, s44, s48
    buffer_store_dwordx4 v[220:223], v9, s[28:31], s45 offen sc1
    s_add_u32 s45, s45, s49
    buffer_store_dwordx4 v[224:227], v9, s[28:31], s46 offen sc1
    s_add_u32 s46, s46, s50
    buffer_store_dwordx4 v[228:231], v9, s[28:31], s47 offen sc1
    s_add_u32 s47, s47, s51
    s_waitcnt lgkmcnt(0)
    ds_read_b64_tr_b16 v[200:201], v8 offset:0
    ds_read_b64_tr_b16 v[202:203], v8 offset:576
    ds_read_b64_tr_b16 v[204:205], v8 offset:32
    ds_read_b64_tr_b16 v[206:207], v8 offset:608
    ds_read_b64_tr_b16 v[208:209], v8 offset:64
    ds_read_b64_tr_b16 v[210:211], v8 offset:640
    ds_read_b64_tr_b16 v[212:213], v8 offset:96
    ds_read_b64_tr_b16 v[214:215], v8 offset:672
    s_waitcnt vmcnt(32)
    ds_write_b128 v5, v[112:115] offset:4608
    ds_write_b128 v5, v[116:119] offset:5760
    ds_write_b128 v5, v[120:123] offset:6912
    ds_write_b128 v5, v[124:127] offset:8064
    s_waitcnt lgkmcnt(4)
    buffer_store_dwordx4 v[200:203], v9, s[28:31], s44 offen sc1
    s_add_u32 s44, s44, s48
    buffer_store_dwordx4 v[204:207], v9, s[28:31], s45 offen sc1
    s_add_u32 s45, s45, s49
    buffer_store_dwordx4 v[208:211], v9, s[28:31], s46 offen sc1
    s_add_u32 s46, s46, s50
    buffer_store_dwordx4 v[212:215], v9, s[28:31], s47 offen sc1
    s_add_u32 s47, s47, s51
    s_waitcnt lgkmcnt(0)
    ds_read_b64_tr_b16 v[216:217], v8 offset:4608
    ds_read_b64_tr_b16 v[218:219], v8 offset:5184
    ds_read_b64_tr_b16 v[220:221], v8 offset:4640
    ds_read_b64_tr_b16 v[222:223], v8 offset:5216
    ds_read_b64_tr_b16 v[224:225], v8 offset:4672
    ds_read_b64_tr_b16 v[226:227], v8 offset:5248
    ds_read_b64_tr_b16 v[228:229], v8 offset:4704
    ds_read_b64_tr_b16 v[230:231], v8 offset:5280
    s_waitcnt vmcnt(32)
    ds_write_b128 v5, v[128:131] offset:0
    ds_write_b128 v5, v[132:135] offset:1152
    ds_write_b128 v5, v[136:139] offset:2304
    ds_write_b128 v5, v[140:143] offset:3456
    s_waitcnt lgkmcnt(4)
    buffer_store_dwordx4 v[216:219], v9, s[28:31], s44 offen sc1
    s_add_u32 s44, s44, s48
    buffer_store_dwordx4 v[220:223], v9, s[28:31], s45 offen sc1
    s_add_u32 s45, s45, s49
    buffer_store_dwordx4 v[224:227], v9, s[28:31], s46 offen sc1
    s_add_u32 s46, s46, s50
    buffer_store_dwordx4 v[228:231], v9, s[28:31], s47 offen sc1
    s_add_u32 s47, s47, s51
    s_waitcnt lgkmcnt(0)
    ds_read_b64_tr_b16 v[200:201], v8 offset:0
    ds_read_b64_tr_b16 v[202:203], v8 offset:576
    ds_read_b64_tr_b16 v[204:205], v8 offset:32
    ds_read_b64_tr_b16 v[206:207], v8 offset:608
    ds_read_b64_tr_b16 v[208:209], v8 offset:64
    ds_read_b64_tr_b16 v[210:211], v8 offset:640
    ds_read_b64_tr_b16 v[212:213], v8 offset:96
    ds_read_b64_tr_b16 v[214:215], v8 offset:672
    s_waitcnt vmcnt(32)
    ds_write_b128 v5, v[144:147] offset:4608
    ds_write_b128 v5, v[148:151] offset:5760
    ds_write_b128 v5, v[152:155] offset:6912
    ds_write_b128 v5, v[156:159] offset:8064
    s_waitcnt lgkmcnt(4)
    buffer_store_dwordx4 v[200:203], v9, s[28:31], s44 offen sc1
    s_add_u32 s44, s44, s48
    buffer_store_dwordx4 v[204:207], v9, s[28:31], s45 offen sc1
    s_add_u32 s45, s45, s49
    buffer_store_dwordx4 v[208:211], v9, s[28:31], s46 offen sc1
    s_add_u32 s46, s46, s50
    buffer_store_dwordx4 v[212:215], v9, s[28:31], s47 offen sc1
    s_add_u32 s47, s47, s51
    s_waitcnt lgkmcnt(0)
    ds_read_b64_tr_b16 v[216:217], v8 offset:4608
    ds_read_b64_tr_b16 v[218:219], v8 offset:5184
    ds_read_b64_tr_b16 v[220:221], v8 offset:4640
    ds_read_b64_tr_b16 v[222:223], v8 offset:5216
    ds_read_b64_tr_b16 v[224:225], v8 offset:4672
    ds_read_b64_tr_b16 v[226:227], v8 offset:5248
    ds_read_b64_tr_b16 v[228:229], v8 offset:4704
    ds_read_b64_tr_b16 v[230:231], v8 offset:5280
    s_waitcnt vmcnt(32)
    ds_write_b128 v5, v[160:163] offset:0
    ds_write_b128 v5, v[164:167] offset:1152
    ds_write_b128 v5, v[168:171] offset:2304
    ds_write_b128 v5, v[172:175] offset:3456
    s_waitcnt lgkmcnt(4)
    buffer_store_dwordx4 v[216:219], v9, s[28:31], s44 offen sc1
    s_add_u32 s44, s44, s48
    buffer_store_dwordx4 v[220:223], v9, s[28:31], s45 offen sc1
    s_add_u32 s45, s45, s49
    buffer_store_dwordx4 v[224:227], v9, s[28:31], s46 offen sc1
    s_add_u32 s46, s46, s50
    buffer_store_dwordx4 v[228:231], v9, s[28:31], s47 offen sc1
    s_add_u32 s47, s47, s51
    s_waitcnt lgkmcnt(0)
    ds_read_b64_tr_b16 v[200:201], v8 offset:0
    ds_read_b64_tr_b16 v[202:203], v8 offset:576
    ds_read_b64_tr_b16 v[204:205], v8 offset:32
    ds_read_b64_tr_b16 v[206:207], v8 offset:608
    ds_read_b64_tr_b16 v[208:209], v8 offset:64
    ds_read_b64_tr_b16 v[210:211], v8 offset:640
    ds_read_b64_tr_b16 v[212:213], v8 offset:96
    ds_read_b64_tr_b16 v[214:215], v8 offset:672
    s_waitcnt vmcnt(32)
    ds_write_b128 v5, v[176:179] offset:4608
    ds_write_b128 v5, v[180:183] offset:5760
    ds_write_b128 v5, v[184:187] offset:6912
    ds_write_b128 v5, v[188:191] offset:8064
    s_waitcnt lgkmcnt(4)
    buffer_store_dwordx4 v[200:203], v9, s[28:31], s44 offen sc1
    s_add_u32 s44, s44, s48
    buffer_store_dwordx4 v[204:207], v9, s[28:31], s45 offen sc1
    s_add_u32 s45, s45, s49
    buffer_store_dwordx4 v[208:211], v9, s[28:31], s46 offen sc1
    s_add_u32 s46, s46, s50
    buffer_store_dwordx4 v[212:215], v9, s[28:31], s47 offen sc1
    s_add_u32 s47, s47, s51
    s_waitcnt lgkmcnt(0)
    ds_read_b64_tr_b16 v[216:217], v8 offset:4608
    ds_read_b64_tr_b16 v[218:219], v8 offset:5184
    ds_read_b64_tr_b16 v[220:221], v8 offset:4640
    ds_read_b64_tr_b16 v[222:223], v8 offset:5216
    ds_read_b64_tr_b16 v[224:225], v8 offset:4672
    ds_read_b64_tr_b16 v[226:227], v8 offset:5248
    ds_read_b64_tr_b16 v[228:229], v8 offset:4704
    ds_read_b64_tr_b16 v[230:231], v8 offset:5280
    s_waitcnt lgkmcnt(0)
    buffer_store_dwordx4 v[216:219], v9, s[28:31], s44 offen sc1
    s_add_u32 s44, s44, s48
    buffer_store_dwordx4 v[220:223], v9, s[28:31], s45 offen sc1
    s_add_u32 s45, s45, s49
    buffer_store_dwordx4 v[224:227], v9, s[28:31], s46 offen sc1
    s_add_u32 s46, s46, s50
    buffer_store_dwordx4 v[228:231], v9, s[28:31], s47 offen sc1
    s_add_u32 s47, s47, s51
    s_endpgm
prep_kernel_pk31:
    s_mov_b32 s24, s16
    s_mov_b32 s25, s17
    s_mov_b32 s26, 2211840
    s_mov_b32 s27, 0x00020000
    s_sub_u32 s32, s21, 40
    s_mul_i32 s33, s32, 2428
    s_lshr_b32 s33, s33, 16
    s_mul_i32 s35, s33, 27
    s_sub_u32 s35, s32, s35
    v_mul_u32_u24 v10, 3456, v3
    v_lshl_add_u32 v10, v4, 4, v10
    s_mul_i32 s36, s33, 1105920
    s_lshl_b32 s37, s35, 7
    s_add_u32 s36, s36, s37
    buffer_load_dwordx4 v[32:35], v10, s[24:27], s36 offen nt
    s_add_u32 s36, s36, 27648
    buffer_load_dwordx4 v[36:39], v10, s[24:27], s36 offen nt
    s_add_u32 s36, s36, 27648
    buffer_load_dwordx4 v[40:43], v10, s[24:27], s36 offen nt
    s_add_u32 s36, s36, 27648
    buffer_load_dwordx4 v[44:47], v10, s[24:27], s36 offen nt
    s_add_u32 s36, s36, 27648
    buffer_load_dwordx4 v[48:51], v10, s[24:27], s36 offen nt
    s_add_u32 s36, s36, 27648
    buffer_load_dwordx4 v[52:55], v10, s[24:27], s36 offen nt
    s_add_u32 s36, s36, 27648
    buffer_load_dwordx4 v[56:59], v10, s[24:27], s36 offen nt
    s_add_u32 s36, s36, 27648
    buffer_load_dwordx4 v[60:63], v10, s[24:27], s36 offen nt
    s_add_u32 s36, s36, 27648
    buffer_load_dwordx4 v[64:67], v10, s[24:27], s36 offen nt
    s_add_u32 s36, s36, 27648
    buffer_load_dwordx4 v[68:71], v10, s[24:27], s36 offen nt
    s_add_u32 s36, s36, 27648
    buffer_load_dwordx4 v[72:75], v10, s[24:27], s36 offen nt
    s_add_u32 s36, s36, 27648
    buffer_load_dwordx4 v[76:79], v10, s[24:27], s36 offen nt
    s_add_u32 s36, s36, 27648
    buffer_load_dwordx4 v[80:83], v10, s[24:27], s36 offen nt
    s_add_u32 s36, s36, 27648
    buffer_load_dwordx4 v[84:87], v10, s[24:27], s36 offen nt
    s_add_u32 s36, s36, 27648
    buffer_load_dwordx4 v[88:91], v10, s[24:27], s36 offen nt
    s_add_u32 s36, s36, 27648
    buffer_load_dwordx4 v[92:95], v10, s[24:27], s36 offen nt
    s_add_u32 s36, s36, 27648
    buffer_load_dwordx4 v[96:99], v10, s[24:27], s36 offen nt
    s_add_u32 s36, s36, 27648
    buffer_load_dwordx4 v[100:103], v10, s[24:27], s36 offen nt
    s_add_u32 s36, s36, 27648
    buffer_load_dwordx4 v[104:107], v10, s[24:27], s36 offen nt
    s_add_u32 s36, s36, 27648
    buffer_load_dwordx4 v[108:111], v10, s[24:27], s36 offen nt
    s_add_u32 s36, s36, 27648
    buffer_load_dwordx4 v[112:115], v10, s[24:27], s36 offen nt
    s_add_u32 s36, s36, 27648
    buffer_load_dwordx4 v[116:119], v10, s[24:27], s36 offen nt
    s_add_u32 s36, s36, 27648
    buffer_load_dwordx4 v[120:123], v10, s[24:27], s36 offen nt
    s_add_u32 s36, s36, 27648
    buffer_load_dwordx4 v[124:127], v10, s[24:27], s36 offen nt
    s_add_u32 s36, s36, 27648
    buffer_load_dwordx4 v[128:131], v10, s[24:27], s36 offen nt
    s_add_u32 s36, s36, 27648
    buffer_load_dwordx4 v[132:135], v10, s[24:27], s36 offen nt
    s_add_u32 s36, s36, 27648
    buffer_load_dwordx4 v[136:139], v10, s[24:27], s36 offen nt
    s_add_u32 s36, s36, 27648
    buffer_load_dwordx4 v[140:143], v10, s[24:27], s36 offen nt
    s_add_u32 s36, s36, 27648
    buffer_load_dwordx4 v[144:147], v10, s[24:27], s36 offen nt
    s_add_u32 s36, s36, 27648
    buffer_load_dwordx4 v[148:151], v10, s[24:27], s36 offen nt
    s_add_u32 s36, s36, 27648
    buffer_load_dwordx4 v[152:155], v10, s[24:27], s36 offen nt
    s_add_u32 s36, s36, 27648
    buffer_load_dwordx4 v[156:159], v10, s[24:27], s36 offen nt
    s_add_u32 s36, s36, 27648
    buffer_load_dwordx4 v[160:163], v10, s[24:27], s36 offen nt
    s_add_u32 s36, s36, 27648
    buffer_load_dwordx4 v[164:167], v10, s[24:27], s36 offen nt
    s_add_u32 s36, s36, 27648
    buffer_load_dwordx4 v[168:171], v10, s[24:27], s36 offen nt
    s_add_u32 s36, s36, 27648
    buffer_load_dwordx4 v[172:175], v10, s[24:27], s36 offen nt
    s_add_u32 s36, s36, 27648
    buffer_load_dwordx4 v[176:179], v10, s[24:27], s36 offen nt
    s_add_u32 s36, s36, 27648
    buffer_load_dwordx4 v[180:183], v10, s[24:27], s36 offen nt
    s_add_u32 s36, s36, 27648
    buffer_load_dwordx4 v[184:187], v10, s[24:27], s36 offen nt
    s_add_u32 s36, s36, 27648
    buffer_load_dwordx4 v[188:191], v10, s[24:27], s36 offen nt
    s_lshl_b32 s36, s35, 2
    s_add_u32 s36, s36, 0
    s_mul_i32 s38, s36, 9363
    s_lshr_b32 s38, s38, 16
    s_mul_i32 s39, s38, 7
    s_sub_u32 s39, s36, s39
    s_sub_u32 s41, s39, 1
    s_cmp_eq_u32 s39, 0
    s_cselect_b32 s41, 6, s41
    s_and_b32 s40, s38, 1
    s_cmp_eq_u32 s40, 1
    s_cselect_b32 s39, s41, s39
    s_mov_b32 s41, 4
    s_mov_b32 s40, s39
    s_cmp_ge_u32 s39, 4
    s_cselect_b32 s41, 2, s41
    s_add_u32 s42, s39, 76
    s_cmp_ge_u32 s39, 4
    s_cselect_b32 s40, s42, s40
    s_cmp_eq_u32 s39, 6
    s_cselect_b32 s41, 1, s41
    s_cselect_b32 s40, 120, s40
    s_mul_i32 s42, s33, 10
    s_mul_i32 s42, s42, s41
    s_add_u32 s40, s40, s42
    s_mul_i32 s37, s38, 140
    s_add_u32 s37, s37, s40
    s_lshl_b32 s37, s37, 10
    s_add_u32 s44, s37, 24875008
    s_lshl_b32 s48, s41, 10
    s_lshl_b32 s36, s35, 2
    s_add_u32 s36, s36, 1
    s_mul_i32 s38, s36, 9363
    s_lshr_b32 s38, s38, 16
    s_mul_i32 s39, s38, 7
    s_sub_u32 s39, s36, s39
    s_sub_u32 s41, s39, 1
    s_cmp_eq_u32 s39, 0
    s_cselect_b32 s41, 6, s41
    s_and_b32 s40, s38, 1
    s_cmp_eq_u32 s40, 1
    s_cselect_b32 s39, s41, s39
    s_mov_b32 s41, 4
    s_mov_b32 s40, s39
    s_cmp_ge_u32 s39, 4
    s_cselect_b32 s41, 2, s41
    s_add_u32 s42, s39, 76
    s_cmp_ge_u32 s39, 4
    s_cselect_b32 s40, s42, s40
    s_cmp_eq_u32 s39, 6
    s_cselect_b32 s41, 1, s41
    s_cselect_b32 s40, 120, s40
    s_mul_i32 s42, s33, 10
    s_mul_i32 s42, s42, s41
    s_add_u32 s40, s40, s42
    s_mul_i32 s37, s38, 140
    s_add_u32 s37, s37, s40
    s_lshl_b32 s37, s37, 10
    s_add_u32 s45, s37, 24875008
    s_lshl_b32 s49, s41, 10
    s_lshl_b32 s36, s35, 2
    s_add_u32 s36, s36, 2
    s_mul_i32 s38, s36, 9363
    s_lshr_b32 s38, s38, 16
    s_mul_i32 s39, s38, 7
    s_sub_u32 s39, s36, s39
    s_sub_u32 s41, s39, 1
    s_cmp_eq_u32 s39, 0
    s_cselect_b32 s41, 6, s41
    s_and_b32 s40, s38, 1
    s_cmp_eq_u32 s40, 1
    s_cselect_b32 s39, s41, s39
    s_mov_b32 s41, 4
    s_mov_b32 s40, s39
    s_cmp_ge_u32 s39, 4
    s_cselect_b32 s41, 2, s41
    s_add_u32 s42, s39, 76
    s_cmp_ge_u32 s39, 4
    s_cselect_b32 s40, s42, s40
    s_cmp_eq_u32 s39, 6
    s_cselect_b32 s41, 1, s41
    s_cselect_b32 s40, 120, s40
    s_mul_i32 s42, s33, 10
    s_mul_i32 s42, s42, s41
    s_add_u32 s40, s40, s42
    s_mul_i32 s37, s38, 140
    s_add_u32 s37, s37, s40
    s_lshl_b32 s37, s37, 10
    s_add_u32 s46, s37, 24875008
    s_lshl_b32 s50, s41, 10
    s_lshl_b32 s36, s35, 2
    s_add_u32 s36, s36, 3
    s_mul_i32 s38, s36, 9363
    s_lshr_b32 s38, s38, 16
    s_mul_i32 s39, s38, 7
    s_sub_u32 s39, s36, s39
    s_sub_u32 s41, s39, 1
    s_cmp_eq_u32 s39, 0
    s_cselect_b32 s41, 6, s41
    s_and_b32 s40, s38, 1
    s_cmp_eq_u32 s40, 1
    s_cselect_b32 s39, s41, s39
    s_mov_b32 s41, 4
    s_mov_b32 s40, s39
    s_cmp_ge_u32 s39, 4
    s_cselect_b32 s41, 2, s41
    s_add_u32 s42, s39, 76
    s_cmp_ge_u32 s39, 4
    s_cselect_b32 s40, s42, s40
    s_cmp_eq_u32 s39, 6
    s_cselect_b32 s41, 1, s41
    s_cselect_b32 s40, 120, s40
    s_mul_i32 s42, s33, 10
    s_mul_i32 s42, s42, s41
    s_add_u32 s40, s40, s42
    s_mul_i32 s37, s38, 140
    s_add_u32 s37, s37, s40
    s_lshl_b32 s37, s37, 10
    s_add_u32 s47, s37, 24875008
    s_lshl_b32 s51, s41, 10
    v_mov_b32 v12, 0
    v_mov_b32 v13, 0
    v_mov_b32 v14, 0
    v_mov_b32 v15, 0
    v_mov_b32 v16, 0x3f803f80
    s_waitcnt vmcnt(36)
    ds_write_b128 v5, v[32:35] offset:0
    ds_write_b128 v5, v[36:39] offset:1152
    ds_write_b128 v5, v[40:43] offset:2304
    ds_write_b128 v5, v[44:47] offset:3456
    s_waitcnt lgkmcnt(0)
    ds_read_b64_tr_b16 v[200:201], v8 offset:0
    ds_read_b64_tr_b16 v[202:203], v8 offset:576
    ds_read_b64_tr_b16 v[204:205], v8 offset:32
    ds_read_b64_tr_b16 v[206:207], v8 offset:608
    ds_read_b64_tr_b16 v[208:209], v8 offset:64
    ds_read_b64_tr_b16 v[210:211], v8 offset:640
    ds_read_b64_tr_b16 v[212:213], v8 offset:96
    ds_read_b64_tr_b16 v[214:215], v8 offset:672
    s_waitcnt vmcnt(32)
    ds_write_b128 v5, v[48:51] offset:4608
    ds_write_b128 v5, v[52:55] offset:5760
    ds_write_b128 v5, v[56:59] offset:6912
    ds_write_b128 v5, v[60:63] offset:8064
    s_waitcnt lgkmcnt(4)
    buffer_store_dwordx4 v[200:203], v9, s[28:31], s44 offen sc1
    s_add_u32 s44, s44, s48
    v_dot2_f32_bf16 v12, v200, v16, v12
    v_dot2_f32_bf16 v12, v201, v16, v12
    v_dot2_f32_bf16 v12, v202, v16, v12
    v_dot2_f32_bf16 v12, v203, v16, v12
    buffer_store_dwordx4 v[204:207], v9, s[28:31], s45 offen sc1
    s_add_u32 s45, s45, s49
    v_dot2_f32_bf16 v13, v204, v16, v13
    v_dot2_f32_bf16 v13, v205, v16, v13
    v_dot2_f32_bf16 v13, v206, v16, v13
    v_dot2_f32_bf16 v13, v207, v16, v13
    buffer_store_dwordx4 v[208:211], v9, s[28:31], s46 offen sc1
    s_add_u32 s46, s46, s50
    v_dot2_f32_bf16 v14, v208, v16, v14
    v_dot2_f32_bf16 v14, v209, v16, v14
    v_dot2_f32_bf16 v14, v210, v16, v14
    v_dot2_f32_bf16 v14, v211, v16, v14
    buffer_store_dwordx4 v[212:215], v9, s[28:31], s47 offen sc1
    s_add_u32 s47, s47, s51
    v_dot2_f32_bf16 v15, v212, v16, v15
    v_dot2_f32_bf16 v15, v213, v16, v15
    v_dot2_f32_bf16 v15, v214, v16, v15
    v_dot2_f32_bf16 v15, v215, v16, v15
    s_waitcnt lgkmcnt(0)
    ds_read_b64_tr_b16 v[216:217], v8 offset:4608
    ds_read_b64_tr_b16 v[218:219], v8 offset:5184
    ds_read_b64_tr_b16 v[220:221], v8 offset:4640
    ds_read_b64_tr_b16 v[222:223], v8 offset:5216
    ds_read_b64_tr_b16 v[224:225], v8 offset:4672
    ds_read_b64_tr_b16 v[226:227], v8 offset:5248
    ds_read_b64_tr_b16 v[228:229], v8 offset:4704
    ds_read_b64_tr_b16 v[230:231], v8 offset:5280
    s_waitcnt vmcnt(32)
    ds_write_b128 v5, v[64:67] offset:0
    ds_write_b128 v5, v[68:71] offset:1152
    ds_write_b128 v5, v[72:75] offset:2304
    ds_write_b128 v5, v[76:79] offset:3456
    s_waitcnt lgkmcnt(4)
    buffer_store_dwordx4 v[216:219], v9, s[28:31], s44 offen sc1
    s_add_u32 s44, s44, s48
    v_dot2_f32_bf16 v12, v216, v16, v12
    v_dot2_f32_bf16 v12, v217, v16, v12
    v_dot2_f32_bf16 v12, v218, v16, v12
    v_dot2_f32_bf16 v12, v219, v16, v12
    buffer_store_dwordx4 v[220:223], v9, s[28:31], s45 offen sc1
    s_add_u32 s45, s45, s49
    v_dot2_f32_bf16 v13, v220, v16, v13
    v_dot2_f32_bf16 v13, v221, v16, v13
    v_dot2_f32_bf16 v13, v222, v16, v13
    v_dot2_f32_bf16 v13, v223, v16, v13
    buffer_store_dwordx4 v[224:227], v9, s[28:31], s46 offen sc1
    s_add_u32 s46, s46, s50
    v_dot2_f32_bf16 v14, v224, v16, v14
    v_dot2_f32_bf16 v14, v225, v16, v14
    v_dot2_f32_bf16 v14, v226, v16, v14
    v_dot2_f32_bf16 v14, v227, v16, v14
    buffer_store_dwordx4 v[228:231], v9, s[28:31], s47 offen sc1
    s_add_u32 s47, s47, s51
    v_dot2_f32_bf16 v15, v228, v16, v15
    v_dot2_f32_bf16 v15, v229, v16, v15
    v_dot2_f32_bf16 v15, v230, v16, v15
    v_dot2_f32_bf16 v15, v231, v16, v15
    s_waitcnt lgkmcnt(0)
    ds_read_b64_tr_b16 v[200:201], v8 offset:0
    ds_read_b64_tr_b16 v[202:203], v8 offset:576
    ds_read_b64_tr_b16 v[204:205], v8 offset:32
    ds_read_b64_tr_b16 v[206:207], v8 offset:608
    ds_read_b64_tr_b16 v[208:209], v8 offset:64
    ds_read_b64_tr_b16 v[210:211], v8 offset:640
    ds_read_b64_tr_b16 v[212:213], v8 offset:96
    ds_read_b64_tr_b16 v[214:215], v8 offset:672
    s_waitcnt vmcnt(32)
    ds_write_b128 v5, v[80:83] offset:4608
    ds_write_b128 v5, v[84:87] offset:5760
    ds_write_b128 v5, v[88:91] offset:6912
    ds_write_b128 v5, v[92:95] offset:8064
    s_waitcnt lgkmcnt(4)
    buffer_store_dwordx4 v[200:203], v9, s[28:31], s44 offen sc1
    s_add_u32 s44, s44, s48
    v_dot2_f32_bf16 v12, v200, v16, v12
    v_dot2_f32_bf16 v12, v201, v16, v12
    v_dot2_f32_bf16 v12, v202, v16, v12
    v_dot2_f32_bf16 v12, v203, v16, v12
    buffer_store_dwordx4 v[204:207], v9, s[28:31], s45 offen sc1
    s_add_u32 s45, s45, s49
    v_dot2_f32_bf16 v13, v204, v16, v13
    v_dot2_f32_bf16 v13, v205, v16, v13
    v_dot2_f32_bf16 v13, v206, v16, v13
    v_dot2_f32_bf16 v13, v207, v16, v13
    buffer_store_dwordx4 v[208:211], v9, s[28:31], s46 offen sc1
    s_add_u32 s46, s46, s50
    v_dot2_f32_bf16 v14, v208, v16, v14
    v_dot2_f32_bf16 v14, v209, v16, v14
    v_dot2_f32_bf16 v14, v210, v16, v14
    v_dot2_f32_bf16 v14, v211, v16, v14
    buffer_store_dwordx4 v[212:215], v9, s[28:31], s47 offen sc1
    s_add_u32 s47, s47, s51
    v_dot2_f32_bf16 v15, v212, v16, v15
    v_dot2_f32_bf16 v15, v213, v16, v15
    v_dot2_f32_bf16 v15, v214, v16, v15
    v_dot2_f32_bf16 v15, v215, v16, v15
    s_waitcnt lgkmcnt(0)
    ds_read_b64_tr_b16 v[216:217], v8 offset:4608
    ds_read_b64_tr_b16 v[218:219], v8 offset:5184
    ds_read_b64_tr_b16 v[220:221], v8 offset:4640
    ds_read_b64_tr_b16 v[222:223], v8 offset:5216
    ds_read_b64_tr_b16 v[224:225], v8 offset:4672
    ds_read_b64_tr_b16 v[226:227], v8 offset:5248
    ds_read_b64_tr_b16 v[228:229], v8 offset:4704
    ds_read_b64_tr_b16 v[230:231], v8 offset:5280
    s_waitcnt vmcnt(32)
    ds_write_b128 v5, v[96:99] offset:0
    ds_write_b128 v5, v[100:103] offset:1152
    ds_write_b128 v5, v[104:107] offset:2304
    ds_write_b128 v5, v[108:111] offset:3456
    s_waitcnt lgkmcnt(4)
    buffer_store_dwordx4 v[216:219], v9, s[28:31], s44 offen sc1
    s_add_u32 s44, s44, s48
    v_dot2_f32_bf16 v12, v216, v16, v12
    v_dot2_f32_bf16 v12, v217, v16, v12
    v_dot2_f32_bf16 v12, v218, v16, v12
    v_dot2_f32_bf16 v12, v219, v16, v12
    buffer_store_dwordx4 v[220:223], v9, s[28:31], s45 offen sc1
    s_add_u32 s45, s45, s49
    v_dot2_f32_bf16 v13, v220, v16, v13
    v_dot2_f32_bf16 v13, v221, v16, v13
    v_dot2_f32_bf16 v13, v222, v16, v13
    v_dot2_f32_bf16 v13, v223, v16, v13
    buffer_store_dwordx4 v[224:227], v9, s[28:31], s46 offen sc1
    s_add_u32 s46, s46, s50
    v_dot2_f32_bf16 v14, v224, v16, v14
    v_dot2_f32_bf16 v14, v225, v16, v14
    v_dot2_f32_bf16 v14, v226, v16, v14
    v_dot2_f32_bf16 v14, v227, v16, v14
    buffer_store_dwordx4 v[228:231], v9, s[28:31], s47 offen sc1
    s_add_u32 s47, s47, s51
    v_dot2_f32_bf16 v15, v228, v16, v15
    v_dot2_f32_bf16 v15, v229, v16, v15
    v_dot2_f32_bf16 v15, v230, v16, v15
    v_dot2_f32_bf16 v15, v231, v16, v15
    s_waitcnt lgkmcnt(0)
    ds_read_b64_tr_b16 v[200:201], v8 offset:0
    ds_read_b64_tr_b16 v[202:203], v8 offset:576
    ds_read_b64_tr_b16 v[204:205], v8 offset:32
    ds_read_b64_tr_b16 v[206:207], v8 offset:608
    ds_read_b64_tr_b16 v[208:209], v8 offset:64
    ds_read_b64_tr_b16 v[210:211], v8 offset:640
    ds_read_b64_tr_b16 v[212:213], v8 offset:96
    ds_read_b64_tr_b16 v[214:215], v8 offset:672
    s_waitcnt vmcnt(32)
    ds_write_b128 v5, v[112:115] offset:4608
    ds_write_b128 v5, v[116:119] offset:5760
    ds_write_b128 v5, v[120:123] offset:6912
    ds_write_b128 v5, v[124:127] offset:8064
    s_waitcnt lgkmcnt(4)
    buffer_store_dwordx4 v[200:203], v9, s[28:31], s44 offen sc1
    s_add_u32 s44, s44, s48
    v_dot2_f32_bf16 v12, v200, v16, v12
    v_dot2_f32_bf16 v12, v201, v16, v12
    v_dot2_f32_bf16 v12, v202, v16, v12
    v_dot2_f32_bf16 v12, v203, v16, v12
    buffer_store_dwordx4 v[204:207], v9, s[28:31], s45 offen sc1
    s_add_u32 s45, s45, s49
    v_dot2_f32_bf16 v13, v204, v16, v13
    v_dot2_f32_bf16 v13, v205, v16, v13
    v_dot2_f32_bf16 v13, v206, v16, v13
    v_dot2_f32_bf16 v13, v207, v16, v13
    buffer_store_dwordx4 v[208:211], v9, s[28:31], s46 offen sc1
    s_add_u32 s46, s46, s50
    v_dot2_f32_bf16 v14, v208, v16, v14
    v_dot2_f32_bf16 v14, v209, v16, v14
    v_dot2_f32_bf16 v14, v210, v16, v14
    v_dot2_f32_bf16 v14, v211, v16, v14
    buffer_store_dwordx4 v[212:215], v9, s[28:31], s47 offen sc1
    s_add_u32 s47, s47, s51
    v_dot2_f32_bf16 v15, v212, v16, v15
    v_dot2_f32_bf16 v15, v213, v16, v15
    v_dot2_f32_bf16 v15, v214, v16, v15
    v_dot2_f32_bf16 v15, v215, v16, v15
    s_waitcnt lgkmcnt(0)
    ds_read_b64_tr_b16 v[216:217], v8 offset:4608
    ds_read_b64_tr_b16 v[218:219], v8 offset:5184
    ds_read_b64_tr_b16 v[220:221], v8 offset:4640
    ds_read_b64_tr_b16 v[222:223], v8 offset:5216
    ds_read_b64_tr_b16 v[224:225], v8 offset:4672
    ds_read_b64_tr_b16 v[226:227], v8 offset:5248
    ds_read_b64_tr_b16 v[228:229], v8 offset:4704
    ds_read_b64_tr_b16 v[230:231], v8 offset:5280
    s_waitcnt vmcnt(32)
    ds_write_b128 v5, v[128:131] offset:0
    ds_write_b128 v5, v[132:135] offset:1152
    ds_write_b128 v5, v[136:139] offset:2304
    ds_write_b128 v5, v[140:143] offset:3456
    s_waitcnt lgkmcnt(4)
    buffer_store_dwordx4 v[216:219], v9, s[28:31], s44 offen sc1
    s_add_u32 s44, s44, s48
    v_dot2_f32_bf16 v12, v216, v16, v12
    v_dot2_f32_bf16 v12, v217, v16, v12
    v_dot2_f32_bf16 v12, v218, v16, v12
    v_dot2_f32_bf16 v12, v219, v16, v12
    buffer_store_dwordx4 v[220:223], v9, s[28:31], s45 offen sc1
    s_add_u32 s45, s45, s49
    v_dot2_f32_bf16 v13, v220, v16, v13
    v_dot2_f32_bf16 v13, v221, v16, v13
    v_dot2_f32_bf16 v13, v222, v16, v13
    v_dot2_f32_bf16 v13, v223, v16, v13
    buffer_store_dwordx4 v[224:227], v9, s[28:31], s46 offen sc1
    s_add_u32 s46, s46, s50
    v_dot2_f32_bf16 v14, v224, v16, v14
    v_dot2_f32_bf16 v14, v225, v16, v14
    v_dot2_f32_bf16 v14, v226, v16, v14
    v_dot2_f32_bf16 v14, v227, v16, v14
    buffer_store_dwordx4 v[228:231], v9, s[28:31], s47 offen sc1
    s_add_u32 s47, s47, s51
    v_dot2_f32_bf16 v15, v228, v16, v15
    v_dot2_f32_bf16 v15, v229, v16, v15
    v_dot2_f32_bf16 v15, v230, v16, v15
    v_dot2_f32_bf16 v15, v231, v16, v15
    s_waitcnt lgkmcnt(0)
    ds_read_b64_tr_b16 v[200:201], v8 offset:0
    ds_read_b64_tr_b16 v[202:203], v8 offset:576
    ds_read_b64_tr_b16 v[204:205], v8 offset:32
    ds_read_b64_tr_b16 v[206:207], v8 offset:608
    ds_read_b64_tr_b16 v[208:209], v8 offset:64
    ds_read_b64_tr_b16 v[210:211], v8 offset:640
    ds_read_b64_tr_b16 v[212:213], v8 offset:96
    ds_read_b64_tr_b16 v[214:215], v8 offset:672
    s_waitcnt vmcnt(32)
    ds_write_b128 v5, v[144:147] offset:4608
    ds_write_b128 v5, v[148:151] offset:5760
    ds_write_b128 v5, v[152:155] offset:6912
    ds_write_b128 v5, v[156:159] offset:8064
    s_waitcnt lgkmcnt(4)
    buffer_store_dwordx4 v[200:203], v9, s[28:31], s44 offen sc1
    s_add_u32 s44, s44, s48
    v_dot2_f32_bf16 v12, v200, v16, v12
    v_dot2_f32_bf16 v12, v201, v16, v12
    v_dot2_f32_bf16 v12, v202, v16, v12
    v_dot2_f32_bf16 v12, v203, v16, v12
    buffer_store_dwordx4 v[204:207], v9, s[28:31], s45 offen sc1
    s_add_u32 s45, s45, s49
    v_dot2_f32_bf16 v13, v204, v16, v13
    v_dot2_f32_bf16 v13, v205, v16, v13
    v_dot2_f32_bf16 v13, v206, v16, v13
    v_dot2_f32_bf16 v13, v207, v16, v13
    buffer_store_dwordx4 v[208:211], v9, s[28:31], s46 offen sc1
    s_add_u32 s46, s46, s50
    v_dot2_f32_bf16 v14, v208, v16, v14
    v_dot2_f32_bf16 v14, v209, v16, v14
    v_dot2_f32_bf16 v14, v210, v16, v14
    v_dot2_f32_bf16 v14, v211, v16, v14
    buffer_store_dwordx4 v[212:215], v9, s[28:31], s47 offen sc1
    s_add_u32 s47, s47, s51
    v_dot2_f32_bf16 v15, v212, v16, v15
    v_dot2_f32_bf16 v15, v213, v16, v15
    v_dot2_f32_bf16 v15, v214, v16, v15
    v_dot2_f32_bf16 v15, v215, v16, v15
    s_waitcnt lgkmcnt(0)
    ds_read_b64_tr_b16 v[216:217], v8 offset:4608
    ds_read_b64_tr_b16 v[218:219], v8 offset:5184
    ds_read_b64_tr_b16 v[220:221], v8 offset:4640
    ds_read_b64_tr_b16 v[222:223], v8 offset:5216
    ds_read_b64_tr_b16 v[224:225], v8 offset:4672
    ds_read_b64_tr_b16 v[226:227], v8 offset:5248
    ds_read_b64_tr_b16 v[228:229], v8 offset:4704
    ds_read_b64_tr_b16 v[230:231], v8 offset:5280
    s_waitcnt vmcnt(32)
    ds_write_b128 v5, v[160:163] offset:0
    ds_write_b128 v5, v[164:167] offset:1152
    ds_write_b128 v5, v[168:171] offset:2304
    ds_write_b128 v5, v[172:175] offset:3456
    s_waitcnt lgkmcnt(4)
    buffer_store_dwordx4 v[216:219], v9, s[28:31], s44 offen sc1
    s_add_u32 s44, s44, s48
    v_dot2_f32_bf16 v12, v216, v16, v12
    v_dot2_f32_bf16 v12, v217, v16, v12
    v_dot2_f32_bf16 v12, v218, v16, v12
    v_dot2_f32_bf16 v12, v219, v16, v12
    buffer_store_dwordx4 v[220:223], v9, s[28:31], s45 offen sc1
    s_add_u32 s45, s45, s49
    v_dot2_f32_bf16 v13, v220, v16, v13
    v_dot2_f32_bf16 v13, v221, v16, v13
    v_dot2_f32_bf16 v13, v222, v16, v13
    v_dot2_f32_bf16 v13, v223, v16, v13
    buffer_store_dwordx4 v[224:227], v9, s[28:31], s46 offen sc1
    s_add_u32 s46, s46, s50
    v_dot2_f32_bf16 v14, v224, v16, v14
    v_dot2_f32_bf16 v14, v225, v16, v14
    v_dot2_f32_bf16 v14, v226, v16, v14
    v_dot2_f32_bf16 v14, v227, v16, v14
    buffer_store_dwordx4 v[228:231], v9, s[28:31], s47 offen sc1
    s_add_u32 s47, s47, s51
    v_dot2_f32_bf16 v15, v228, v16, v15
    v_dot2_f32_bf16 v15, v229, v16, v15
    v_dot2_f32_bf16 v15, v230, v16, v15
    v_dot2_f32_bf16 v15, v231, v16, v15
    s_waitcnt lgkmcnt(0)
    ds_read_b64_tr_b16 v[200:201], v8 offset:0
    ds_read_b64_tr_b16 v[202:203], v8 offset:576
    ds_read_b64_tr_b16 v[204:205], v8 offset:32
    ds_read_b64_tr_b16 v[206:207], v8 offset:608
    ds_read_b64_tr_b16 v[208:209], v8 offset:64
    ds_read_b64_tr_b16 v[210:211], v8 offset:640
    ds_read_b64_tr_b16 v[212:213], v8 offset:96
    ds_read_b64_tr_b16 v[214:215], v8 offset:672
    s_waitcnt vmcnt(32)
    ds_write_b128 v5, v[176:179] offset:4608
    ds_write_b128 v5, v[180:183] offset:5760
    ds_write_b128 v5, v[184:187] offset:6912
    ds_write_b128 v5, v[188:191] offset:8064
    s_waitcnt lgkmcnt(4)
    buffer_store_dwordx4 v[200:203], v9, s[28:31], s44 offen sc1
    s_add_u32 s44, s44, s48
    v_dot2_f32_bf16 v12, v200, v16, v12
    v_dot2_f32_bf16 v12, v201, v16, v12
    v_dot2_f32_bf16 v12, v202, v16, v12
    v_dot2_f32_bf16 v12, v203, v16, v12
    buffer_store_dwordx4 v[204:207], v9, s[28:31], s45 offen sc1
    s_add_u32 s45, s45, s49
    v_dot2_f32_bf16 v13, v204, v16, v13
    v_dot2_f32_bf16 v13, v205, v16, v13
    v_dot2_f32_bf16 v13, v206, v16, v13
    v_dot2_f32_bf16 v13, v207, v16, v13
    buffer_store_dwordx4 v[208:211], v9, s[28:31], s46 offen sc1
    s_add_u32 s46, s46, s50
    v_dot2_f32_bf16 v14, v208, v16, v14
    v_dot2_f32_bf16 v14, v209, v16, v14
    v_dot2_f32_bf16 v14, v210, v16, v14
    v_dot2_f32_bf16 v14, v211, v16, v14
    buffer_store_dwordx4 v[212:215], v9, s[28:31], s47 offen sc1
    s_add_u32 s47, s47, s51
    v_dot2_f32_bf16 v15, v212, v16, v15
    v_dot2_f32_bf16 v15, v213, v16, v15
    v_dot2_f32_bf16 v15, v214, v16, v15
    v_dot2_f32_bf16 v15, v215, v16, v15
    s_waitcnt lgkmcnt(0)
    ds_read_b64_tr_b16 v[216:217], v8 offset:4608
    ds_read_b64_tr_b16 v[218:219], v8 offset:5184
    ds_read_b64_tr_b16 v[220:221], v8 offset:4640
    ds_read_b64_tr_b16 v[222:223], v8 offset:5216
    ds_read_b64_tr_b16 v[224:225], v8 offset:4672
    ds_read_b64_tr_b16 v[226:227], v8 offset:5248
    ds_read_b64_tr_b16 v[228:229], v8 offset:4704
    ds_read_b64_tr_b16 v[230:231], v8 offset:5280
    s_waitcnt lgkmcnt(0)
    buffer_store_dwordx4 v[216:219], v9, s[28:31], s44 offen sc1
    s_add_u32 s44, s44, s48
    v_dot2_f32_bf16 v12, v216, v16, v12
    v_dot2_f32_bf16 v12, v217, v16, v12
    v_dot2_f32_bf16 v12, v218, v16, v12
    v_dot2_f32_bf16 v12, v219, v16, v12
    buffer_store_dwordx4 v[220:223], v9, s[28:31], s45 offen sc1
    s_add_u32 s45, s45, s49
    v_dot2_f32_bf16 v13, v220, v16, v13
    v_dot2_f32_bf16 v13, v221, v16, v13
    v_dot2_f32_bf16 v13, v222, v16, v13
    v_dot2_f32_bf16 v13, v223, v16, v13
    buffer_store_dwordx4 v[224:227], v9, s[28:31], s46 offen sc1
    s_add_u32 s46, s46, s50
    v_dot2_f32_bf16 v14, v224, v16, v14
    v_dot2_f32_bf16 v14, v225, v16, v14
    v_dot2_f32_bf16 v14, v226, v16, v14
    v_dot2_f32_bf16 v14, v227, v16, v14
    buffer_store_dwordx4 v[228:231], v9, s[28:31], s47 offen sc1
    s_add_u32 s47, s47, s51
    v_dot2_f32_bf16 v15, v228, v16, v15
    v_dot2_f32_bf16 v15, v229, v16, v15
    v_dot2_f32_bf16 v15, v230, v16, v15
    v_dot2_f32_bf16 v15, v231, v16, v15
    s_nop 2
    v_mov_b32 v20, v12
    v_mov_b32 v21, v13
    v_mov_b32 v22, v14
    v_mov_b32 v23, v15
    s_nop 1
    v_permlane32_swap_b32 v20, v12
    v_permlane32_swap_b32 v21, v13
    v_permlane32_swap_b32 v22, v14
    v_permlane32_swap_b32 v23, v15
    s_nop 1
    v_add_f32 v12, v12, v20
    v_add_f32 v13, v13, v21
    v_add_f32 v14, v14, v22
    v_add_f32 v15, v15, v23
    v_mov_b32 v20, v12
    v_mov_b32 v21, v13
    v_mov_b32 v22, v14
    v_mov_b32 v23, v15
    s_nop 1
    v_permlane16_swap_b32 v20, v12
    v_permlane16_swap_b32 v21, v13
    v_permlane16_swap_b32 v22, v14
    v_permlane16_swap_b32 v23, v15
    s_nop 1
    v_add_f32 v12, v12, v20
    v_add_f32 v13, v13, v21
    v_add_f32 v14, v14, v22
    v_add_f32 v15, v15, v23
    s_mul_i32 s38, s33, 7168
    s_lshl_b32 s39, s35, 8
    s_add_u32 s38, s38, s39
    s_add_u32 s38, s38, 8130560
    v_lshlrev_b32 v17, 2, v1
    s_mov_b64 exec, 0xffff
    buffer_store_dword v12, v17, s[28:31], s38 offen offset:0 sc1
    buffer_store_dword v13, v17, s[28:31], s38 offen offset:64 sc1
    buffer_store_dword v14, v17, s[28:31], s38 offen offset:128 sc1
    buffer_store_dword v15, v17, s[28:31], s38 offen offset:192 sc1
    s_endpgm
prep_kernel_pk32:
    s_mov_b32 s24, s18
    s_mov_b32 s25, s19
    s_mov_b32 s26, 2211840
    s_mov_b32 s27, 0x00020000
    s_sub_u32 s32, s21, 94
    s_mul_i32 s33, s32, 52429
    s_lshr_b32 s33, s33, 19
    s_mul_i32 s35, s33, 10
    s_sub_u32 s35, s32, s35
    v_mul_u32_u24 v10, 1280, v3
    v_lshl_add_u32 v10, v4, 4, v10
    s_mul_i32 s36, s33, 368640
    s_lshl_b32 s37, s35, 7
    s_add_u32 s36, s36, s37
    buffer_load_dwordx4 v[32:35], v10, s[24:27], s36 offen nt
    s_add_u32 s36, s36, 10240
    buffer_load_dwordx4 v[36:39], v10, s[24:27], s36 offen nt
    s_add_u32 s36, s36, 10240
    buffer_load_dwordx4 v[40:43], v10, s[24:27], s36 offen nt
    s_add_u32 s36, s36, 10240
    buffer_load_dwordx4 v[44:47], v10, s[24:27], s36 offen nt
    s_add_u32 s36, s36, 10240
    buffer_load_dwordx4 v[48:51], v10, s[24:27], s36 offen nt
    s_add_u32 s36, s36, 10240
    buffer_load_dwordx4 v[52:55], v10, s[24:27], s36 offen nt
    s_add_u32 s36, s36, 10240
    buffer_load_dwordx4 v[56:59], v10, s[24:27], s36 offen nt
    s_add_u32 s36, s36, 10240
    buffer_load_dwordx4 v[60:63], v10, s[24:27], s36 offen nt
    s_add_u32 s36, s36, 10240
    buffer_load_dwordx4 v[64:67], v10, s[24:27], s36 offen nt
    s_add_u32 s36, s36, 10240
    buffer_load_dwordx4 v[68:71], v10, s[24:27], s36 offen nt
    s_add_u32 s36, s36, 10240
    buffer_load_dwordx4 v[72:75], v10, s[24:27], s36 offen nt
    s_add_u32 s36, s36, 10240
    buffer_load_dwordx4 v[76:79], v10, s[24:27], s36 offen nt
    s_add_u32 s36, s36, 10240
    buffer_load_dwordx4 v[80:83], v10, s[24:27], s36 offen nt
    s_add_u32 s36, s36, 10240
    buffer_load_dwordx4 v[84:87], v10, s[24:27], s36 offen nt
    s_add_u32 s36, s36, 10240
    buffer_load_dwordx4 v[88:91], v10, s[24:27], s36 offen nt
    s_add_u32 s36, s36, 10240
    buffer_load_dwordx4 v[92:95], v10, s[24:27], s36 offen nt
    s_add_u32 s36, s36, 10240
    buffer_load_dwordx4 v[96:99], v10, s[24:27], s36 offen nt
    s_add_u32 s36, s36, 10240
    buffer_load_dwordx4 v[100:103], v10, s[24:27], s36 offen nt
    s_add_u32 s36, s36, 10240
    buffer_load_dwordx4 v[104:107], v10, s[24:27], s36 offen nt
    s_add_u32 s36, s36, 10240
    buffer_load_dwordx4 v[108:111], v10, s[24:27], s36 offen nt
    s_add_u32 s36, s36, 10240
    buffer_load_dwordx4 v[112:115], v10, s[24:27], s36 offen nt
    s_add_u32 s36, s36, 10240
    buffer_load_dwordx4 v[116:119], v10, s[24:27], s36 offen nt
    s_add_u32 s36, s36, 10240
    buffer_load_dwordx4 v[120:123], v10, s[24:27], s36 offen nt
    s_add_u32 s36, s36, 10240
    buffer_load_dwordx4 v[124:127], v10, s[24:27], s36 offen nt
    s_add_u32 s36, s36, 10240
    buffer_load_dwordx4 v[128:131], v10, s[24:27], s36 offen nt
    s_add_u32 s36, s36, 10240
    buffer_load_dwordx4 v[132:135], v10, s[24:27], s36 offen nt
    s_add_u32 s36, s36, 10240
    buffer_load_dwordx4 v[136:139], v10, s[24:27], s36 offen nt
    s_add_u32 s36, s36, 10240
    buffer_load_dwordx4 v[140:143], v10, s[24:27], s36 offen nt
    s_add_u32 s36, s36, 10240
    buffer_load_dwordx4 v[144:147], v10, s[24:27], s36 offen nt
    s_add_u32 s36, s36, 10240
    buffer_load_dwordx4 v[148:151], v10, s[24:27], s36 offen nt
    s_add_u32 s36, s36, 10240
    buffer_load_dwordx4 v[152:155], v10, s[24:27], s36 offen nt
    s_add_u32 s36, s36, 10240
    buffer_load_dwordx4 v[156:159], v10, s[24:27], s36 offen nt
    s_add_u32 s36, s36, 10240
    buffer_load_dwordx4 v[160:163], v10, s[24:27], s36 offen nt
    s_add_u32 s36, s36, 10240
    buffer_load_dwordx4 v[164:167], v10, s[24:27], s36 offen nt
    s_add_u32 s36, s36, 10240
    buffer_load_dwordx4 v[168:171], v10, s[24:27], s36 offen nt
    s_add_u32 s36, s36, 10240
    buffer_load_dwordx4 v[172:175], v10, s[24:27], s36 offen nt
    s_lshl_b32 s36, s35, 2
    s_add_u32 s36, s36, 0
    s_mul_i32 s38, s36, 13108
    s_lshr_b32 s38, s38, 16
    s_mul_i32 s39, s38, 5
    s_sub_u32 s39, s36, s39
    s_sub_u32 s41, s39, 1
    s_cmp_eq_u32 s39, 0
    s_cselect_b32 s41, 4, s41
    s_and_b32 s40, s38, 1
    s_cmp_eq_u32 s40, 1
    s_cselect_b32 s39, s41, s39
    s_mul_i32 s40, s33, 21846
    s_lshr_b32 s40, s40, 16
    s_mul_i32 s41, s40, 3
    s_sub_u32 s41, s33, s41
    s_mul_i32 s37, s38, 270
    s_mul_i32 s41, s41, 90
    s_add_u32 s37, s37, s41
    s_mul_i32 s40, s40, 5
    s_add_u32 s37, s37, s40
    s_add_u32 s37, s37, s39
    s_lshl_b32 s37, s37, 10
    s_add_u32 s44, s37, 27168768
    s_movk_i32 s48, 10240
    s_lshl_b32 s36, s35, 2
    s_add_u32 s36, s36, 1
    s_mul_i32 s38, s36, 13108
    s_lshr_b32 s38, s38, 16
    s_mul_i32 s39, s38, 5
    s_sub_u32 s39, s36, s39
    s_sub_u32 s41, s39, 1
    s_cmp_eq_u32 s39, 0
    s_cselect_b32 s41, 4, s41
    s_and_b32 s40, s38, 1
    s_cmp_eq_u32 s40, 1
    s_cselect_b32 s39, s41, s39
    s_mul_i32 s40, s33, 21846
    s_lshr_b32 s40, s40, 16
    s_mul_i32 s41, s40, 3
    s_sub_u32 s41, s33, s41
    s_mul_i32 s37, s38, 270
    s_mul_i32 s41, s41, 90
    s_add_u32 s37, s37, s41
    s_mul_i32 s40, s40, 5
    s_add_u32 s37, s37, s40
    s_add_u32 s37, s37, s39
    s_lshl_b32 s37, s37, 10
    s_add_u32 s45, s37, 27168768
    s_movk_i32 s49, 10240
    s_lshl_b32 s36, s35, 2
    s_add_u32 s36, s36, 2
    s_mul_i32 s38, s36, 13108
    s_lshr_b32 s38, s38, 16
    s_mul_i32 s39, s38, 5
    s_sub_u32 s39, s36, s39
    s_sub_u32 s41, s39, 1
    s_cmp_eq_u32 s39, 0
    s_cselect_b32 s41, 4, s41
    s_and_b32 s40, s38, 1
    s_cmp_eq_u32 s40, 1
    s_cselect_b32 s39, s41, s39
    s_mul_i32 s40, s33, 21846
    s_lshr_b32 s40, s40, 16
    s_mul_i32 s41, s40, 3
    s_sub_u32 s41, s33, s41
    s_mul_i32 s37, s38, 270
    s_mul_i32 s41, s41, 90
    s_add_u32 s37, s37, s41
    s_mul_i32 s40, s40, 5
    s_add_u32 s37, s37, s40
    s_add_u32 s37, s37, s39
    s_lshl_b32 s37, s37, 10
    s_add_u32 s46, s37, 27168768
    s_movk_i32 s50, 10240
    s_lshl_b32 s36, s35, 2
    s_add_u32 s36, s36, 3
    s_mul_i32 s38, s36, 13108
    s_lshr_b32 s38, s38, 16
    s_mul_i32 s39, s38, 5
    s_sub_u32 s39, s36, s39
    s_sub_u32 s41, s39, 1
    s_cmp_eq_u32 s39, 0
    s_cselect_b32 s41, 4, s41
    s_and_b32 s40, s38, 1
    s_cmp_eq_u32 s40, 1
    s_cselect_b32 s39, s41, s39
    s_mul_i32 s40, s33, 21846
    s_lshr_b32 s40, s40, 16
    s_mul_i32 s41, s40, 3
    s_sub_u32 s41, s33, s41
    s_mul_i32 s37, s38, 270
    s_mul_i32 s41, s41, 90
    s_add_u32 s37, s37, s41
    s_mul_i32 s40, s40, 5
    s_add_u32 s37, s37, s40
    s_add_u32 s37, s37, s39
    s_lshl_b32 s37, s37, 10
    s_add_u32 s47, s37, 27168768
    s_movk_i32 s51, 10240
    s_waitcnt vmcnt(32)
    ds_write_b128 v5, v[32:35] offset:0
    ds_write_b128 v5, v[36:39] offset:1152
    ds_write_b128 v5, v[40:43] offset:2304
    ds_write_b128 v5, v[44:47] offset:3456
    s_waitcnt lgkmcnt(0)
    ds_read_b64_tr_b16 v[200:201], v8 offset:0
    ds_read_b64_tr_b16 v[202:203], v8 offset:576
    ds_read_b64_tr_b16 v[204:205], v8 offset:32
    ds_read_b64_tr_b16 v[206:207], v8 offset:608
    ds_read_b64_tr_b16 v[208:209], v8 offset:64
    ds_read_b64_tr_b16 v[210:211], v8 offset:640
    ds_read_b64_tr_b16 v[212:213], v8 offset:96
    ds_read_b64_tr_b16 v[214:215], v8 offset:672
    s_waitcnt vmcnt(28)
    ds_write_b128 v5, v[48:51] offset:4608
    ds_write_b128 v5, v[52:55] offset:5760
    ds_write_b128 v5, v[56:59] offset:6912
    ds_write_b128 v5, v[60:63] offset:8064
    s_waitcnt lgkmcnt(4)
    buffer_store_dwordx4 v[200:203], v9, s[28:31], s44 offen sc1
    s_add_u32 s44, s44, s48
    buffer_store_dwordx4 v[204:207], v9, s[28:31], s45 offen sc1
    s_add_u32 s45, s45, s49
    buffer_store_dwordx4 v[208:211], v9, s[28:31], s46 offen sc1
    s_add_u32 s46, s46, s50
    buffer_store_dwordx4 v[212:215], v9, s[28:31], s47 offen sc1
    s_add_u32 s47, s47, s51
    s_waitcnt lgkmcnt(0)
    ds_read_b64_tr_b16 v[216:217], v8 offset:4608
    ds_read_b64_tr_b16 v[218:219], v8 offset:5184
    ds_read_b64_tr_b16 v[220:221], v8 offset:4640
    ds_read_b64_tr_b16 v[222:223], v8 offset:5216
    ds_read_b64_tr_b16 v[224:225], v8 offset:4672
    ds_read_b64_tr_b16 v[226:227], v8 offset:5248
    ds_read_b64_tr_b16 v[228:229], v8 offset:4704
    ds_read_b64_tr_b16 v[230:231], v8 offset:5280
    s_waitcnt vmcnt(28)
    ds_write_b128 v5, v[64:67] offset:0
    ds_write_b128 v5, v[68:71] offset:1152
    ds_write_b128 v5, v[72:75] offset:2304
    ds_write_b128 v5, v[76:79] offset:3456
    s_waitcnt lgkmcnt(4)
    buffer_store_dwordx4 v[216:219], v9, s[28:31], s44 offen sc1
    s_add_u32 s44, s44, s48
    buffer_store_dwordx4 v[220:223], v9, s[28:31], s45 offen sc1
    s_add_u32 s45, s45, s49
    buffer_store_dwordx4 v[224:227], v9, s[28:31], s46 offen sc1
    s_add_u32 s46, s46, s50
    buffer_store_dwordx4 v[228:231], v9, s[28:31], s47 offen sc1
    s_add_u32 s47, s47, s51
    s_waitcnt lgkmcnt(0)
    ds_read_b64_tr_b16 v[200:201], v8 offset:0
    ds_read_b64_tr_b16 v[202:203], v8 offset:576
    ds_read_b64_tr_b16 v[204:205], v8 offset:32
    ds_read_b64_tr_b16 v[206:207], v8 offset:608
    ds_read_b64_tr_b16 v[208:209], v8 offset:64
    ds_read_b64_tr_b16 v[210:211], v8 offset:640
    ds_read_b64_tr_b16 v[212:213], v8 offset:96
    ds_read_b64_tr_b16 v[214:215], v8 offset:672
    s_waitcnt vmcnt(28)
    ds_write_b128 v5, v[80:83] offset:4608
    ds_write_b128 v5, v[84:87] offset:5760
    ds_write_b128 v5, v[88:91] offset:6912
    ds_write_b128 v5, v[92:95] offset:8064
    s_waitcnt lgkmcnt(4)
    buffer_store_dwordx4 v[200:203], v9, s[28:31], s44 offen sc1
    s_add_u32 s44, s44, s48
    buffer_store_dwordx4 v[204:207], v9, s[28:31], s45 offen sc1
    s_add_u32 s45, s45, s49
    buffer_store_dwordx4 v[208:211], v9, s[28:31], s46 offen sc1
    s_add_u32 s46, s46, s50
    buffer_store_dwordx4 v[212:215], v9, s[28:31], s47 offen sc1
    s_add_u32 s47, s47, s51
    s_waitcnt lgkmcnt(0)
    ds_read_b64_tr_b16 v[216:217], v8 offset:4608
    ds_read_b64_tr_b16 v[218:219], v8 offset:5184
    ds_read_b64_tr_b16 v[220:221], v8 offset:4640
    ds_read_b64_tr_b16 v[222:223], v8 offset:5216
    ds_read_b64_tr_b16 v[224:225], v8 offset:4672
    ds_read_b64_tr_b16 v[226:227], v8 offset:5248
    ds_read_b64_tr_b16 v[228:229], v8 offset:4704
    ds_read_b64_tr_b16 v[230:231], v8 offset:5280
    s_waitcnt vmcnt(28)
    ds_write_b128 v5, v[96:99] offset:0
    ds_write_b128 v5, v[100:103] offset:1152
    ds_write_b128 v5, v[104:107] offset:2304
    ds_write_b128 v5, v[108:111] offset:3456
    s_waitcnt lgkmcnt(4)
    buffer_store_dwordx4 v[216:219], v9, s[28:31], s44 offen sc1
    s_add_u32 s44, s44, s48
    buffer_store_dwordx4 v[220:223], v9, s[28:31], s45 offen sc1
    s_add_u32 s45, s45, s49
    buffer_store_dwordx4 v[224:227], v9, s[28:31], s46 offen sc1
    s_add_u32 s46, s46, s50
    buffer_store_dwordx4 v[228:231], v9, s[28:31], s47 offen sc1
    s_add_u32 s47, s47, s51
    s_waitcnt lgkmcnt(0)
    ds_read_b64_tr_b16 v[200:201], v8 offset:0
    ds_read_b64_tr_b16 v[202:203], v8 offset:576
    ds_read_b64_tr_b16 v[204:205], v8 offset:32
    ds_read_b64_tr_b16 v[206:207], v8 offset:608
    ds_read_b64_tr_b16 v[208:209], v8 offset:64
    ds_read_b64_tr_b16 v[210:211], v8 offset:640
    ds_read_b64_tr_b16 v[212:213], v8 offset:96
    ds_read_b64_tr_b16 v[214:215], v8 offset:672
    s_waitcnt vmcnt(28)
    ds_write_b128 v5, v[112:115] offset:4608
    ds_write_b128 v5, v[116:119] offset:5760
    ds_write_b128 v5, v[120:123] offset:6912
    ds_write_b128 v5, v[124:127] offset:8064
    s_waitcnt lgkmcnt(4)
    buffer_store_dwordx4 v[200:203], v9, s[28:31], s44 offen sc1
    s_add_u32 s44, s44, s48
    buffer_store_dwordx4 v[204:207], v9, s[28:31], s45 offen sc1
    s_add_u32 s45, s45, s49
    buffer_store_dwordx4 v[208:211], v9, s[28:31], s46 offen sc1
    s_add_u32 s46, s46, s50
    buffer_store_dwordx4 v[212:215], v9, s[28:31], s47 offen sc1
    s_add_u32 s47, s47, s51
    s_waitcnt lgkmcnt(0)
    ds_read_b64_tr_b16 v[216:217], v8 offset:4608
    ds_read_b64_tr_b16 v[218:219], v8 offset:5184
    ds_read_b64_tr_b16 v[220:221], v8 offset:4640
    ds_read_b64_tr_b16 v[222:223], v8 offset:5216
    ds_read_b64_tr_b16 v[224:225], v8 offset:4672
    ds_read_b64_tr_b16 v[226:227], v8 offset:5248
    ds_read_b64_tr_b16 v[228:229], v8 offset:4704
    ds_read_b64_tr_b16 v[230:231], v8 offset:5280
    s_waitcnt vmcnt(28)
    ds_write_b128 v5, v[128:131] offset:0
    ds_write_b128 v5, v[132:135] offset:1152
    ds_write_b128 v5, v[136:139] offset:2304
    ds_write_b128 v5, v[140:143] offset:3456
    s_waitcnt lgkmcnt(4)
    buffer_store_dwordx4 v[216:219], v9, s[28:31], s44 offen sc1
    s_add_u32 s44, s44, s48
    buffer_store_dwordx4 v[220:223], v9, s[28:31], s45 offen sc1
    s_add_u32 s45, s45, s49
    buffer_store_dwordx4 v[224:227], v9, s[28:31], s46 offen sc1
    s_add_u32 s46, s46, s50
    buffer_store_dwordx4 v[228:231], v9, s[28:31], s47 offen sc1
    s_add_u32 s47, s47, s51
    s_waitcnt lgkmcnt(0)
    ds_read_b64_tr_b16 v[200:201], v8 offset:0
    ds_read_b64_tr_b16 v[202:203], v8 offset:576
    ds_read_b64_tr_b16 v[204:205], v8 offset:32
    ds_read_b64_tr_b16 v[206:207], v8 offset:608
    ds_read_b64_tr_b16 v[208:209], v8 offset:64
    ds_read_b64_tr_b16 v[210:211], v8 offset:640
    ds_read_b64_tr_b16 v[212:213], v8 offset:96
    ds_read_b64_tr_b16 v[214:215], v8 offset:672
    s_waitcnt vmcnt(28)
    ds_write_b128 v5, v[144:147] offset:4608
    ds_write_b128 v5, v[148:151] offset:5760
    ds_write_b128 v5, v[152:155] offset:6912
    ds_write_b128 v5, v[156:159] offset:8064
    s_waitcnt lgkmcnt(4)
    buffer_store_dwordx4 v[200:203], v9, s[28:31], s44 offen sc1
    s_add_u32 s44, s44, s48
    buffer_store_dwordx4 v[204:207], v9, s[28:31], s45 offen sc1
    s_add_u32 s45, s45, s49
    buffer_store_dwordx4 v[208:211], v9, s[28:31], s46 offen sc1
    s_add_u32 s46, s46, s50
    buffer_store_dwordx4 v[212:215], v9, s[28:31], s47 offen sc1
    s_add_u32 s47, s47, s51
    s_waitcnt lgkmcnt(0)
    ds_read_b64_tr_b16 v[216:217], v8 offset:4608
    ds_read_b64_tr_b16 v[218:219], v8 offset:5184
    ds_read_b64_tr_b16 v[220:221], v8 offset:4640
    ds_read_b64_tr_b16 v[222:223], v8 offset:5216
    ds_read_b64_tr_b16 v[224:225], v8 offset:4672
    ds_read_b64_tr_b16 v[226:227], v8 offset:5248
    ds_read_b64_tr_b16 v[228:229], v8 offset:4704
    ds_read_b64_tr_b16 v[230:231], v8 offset:5280
    s_waitcnt vmcnt(28)
    ds_write_b128 v5, v[160:163] offset:0
    ds_write_b128 v5, v[164:167] offset:1152
    ds_write_b128 v5, v[168:171] offset:2304
    ds_write_b128 v5, v[172:175] offset:3456
    s_waitcnt lgkmcnt(4)
    buffer_store_dwordx4 v[216:219], v9, s[28:31], s44 offen sc1
    s_add_u32 s44, s44, s48
    buffer_store_dwordx4 v[220:223], v9, s[28:31], s45 offen sc1
    s_add_u32 s45, s45, s49
    buffer_store_dwordx4 v[224:227], v9, s[28:31], s46 offen sc1
    s_add_u32 s46, s46, s50
    buffer_store_dwordx4 v[228:231], v9, s[28:31], s47 offen sc1
    s_add_u32 s47, s47, s51
    s_waitcnt lgkmcnt(0)
    ds_read_b64_tr_b16 v[200:201], v8 offset:0
    ds_read_b64_tr_b16 v[202:203], v8 offset:576
    ds_read_b64_tr_b16 v[204:205], v8 offset:32
    ds_read_b64_tr_b16 v[206:207], v8 offset:608
    ds_read_b64_tr_b16 v[208:209], v8 offset:64
    ds_read_b64_tr_b16 v[210:211], v8 offset:640
    ds_read_b64_tr_b16 v[212:213], v8 offset:96
    ds_read_b64_tr_b16 v[214:215], v8 offset:672
    s_waitcnt lgkmcnt(0)
    buffer_store_dwordx4 v[200:203], v9, s[28:31], s44 offen sc1
    s_add_u32 s44, s44, s48
    buffer_store_dwordx4 v[204:207], v9, s[28:31], s45 offen sc1
    s_add_u32 s45, s45, s49
    buffer_store_dwordx4 v[208:211], v9, s[28:31], s46 offen sc1
    s_add_u32 s46, s46, s50
    buffer_store_dwordx4 v[212:215], v9, s[28:31], s47 offen sc1
    s_add_u32 s47, s47, s51
    s_endpgm
.globl chain_kernel
.p2align 8
.type chain_kernel,@function
chain_kernel:
    s_cmp_ge_u32 s2, 256
    s_cbranch_scc1 chain_end
    s_load_dwordx2 s[4:5], s[0:1], 0
    s_load_dwordx2 s[6:7], s[0:1], 104
    s_load_dwordx2 s[10:11], s[0:1], 120
    v_lshrrev_b32 v2, 6, v0
    v_and_b32 v1, 63, v0
    v_readfirstlane_b32 s20, v2
    s_and_b32 s25, s2, 7
    s_lshr_b32 s26, s2, 3
    s_lshl_b32 s23, s25, 3
    s_lshr_b32 s27, s26, 2
    s_add_u32 s23, s23, s27
    s_and_b32 s24, s26, 3
    s_and_b32 s21, s20, 1
    s_lshr_b32 s22, s20, 1
    v_lshrrev_b32 v3, 4, v1
    v_and_b32 v4, 15, v1
    v_lshlrev_b32 v8, 4, v1
    s_waitcnt lgkmcnt(0)
    s_mov_b32 s28, s10
    s_mov_b32 s29, s11
    s_mov_b32 s30, 268435456
    s_mov_b32 s31, 0x00020000
    s_mul_i32 s25, s20, 10240
    s_add_u32 s10, s25, 0
    s_mul_i32 s11, s23, 40960
    s_add_u32 s11, s11, s25
    s_add_u32 s11, s11, 5492736
    s_lshl_b32 s12, s20, 10
    s_add_u32 s13, s12, 8121856
    s_add_u32 s12, s12, 130560
    s_lshl_b32 s14, s21, 10
    s_add_u32 s14, s14, 139264
    s_mul_i32 s15, s21, 7168
    s_mul_i32 s25, s24, 640
    s_add_u32 s15, s15, s25
    s_add_u32 s15, s15, 8146944
    s_mov_b32 m0, s10
    s_add_u32 s10, s10, 4096
    buffer_load_dwordx4 v8, s[28:31], s11 offen offset:0 lds
    buffer_load_dwordx4 v8, s[28:31], s11 offen offset:1024 lds
    buffer_load_dwordx4 v8, s[28:31], s11 offen offset:2048 lds
    buffer_load_dwordx4 v8, s[28:31], s11 offen offset:3072 lds
    s_add_u32 s11, s11, 4096
    s_mov_b32 m0, s10
    s_add_u32 s10, s10, 4096
    buffer_load_dwordx4 v8, s[28:31], s11 offen offset:0 lds
    buffer_load_dwordx4 v8, s[28:31], s11 offen offset:1024 lds
    buffer_load_dwordx4 v8, s[28:31], s11 offen offset:2048 lds
    buffer_load_dwordx4 v8, s[28:31], s11 offen offset:3072 lds
    s_add_u32 s11, s11, 4096
    s_mov_b32 m0, s10
    s_add_u32 s10, s10, 4096
    buffer_load_dwordx4 v8, s[28:31], s11 offen offset:0 lds
    buffer_load_dwordx4 v8, s[28:31], s11 offen offset:1024 lds
    s_mov_b32 m0, s12
    s_nop 0
    buffer_load_dwordx4 v8, s[28:31], s13 offen lds
    s_mov_b32 m0, 134656
    s_mov_b32 s13, 8125952
    buffer_load_dwordx4 v8, s[28:31], s13 offen lds
    s_mov_b32 m0, s14
    s_nop 0
    buffer_load_dwordx4 v8, s[28:31], s15 offen lds
    s_mov_b32 s32, s6
    s_mov_b32 s33, s7
    s_mov_b32 s34, 2621440
    s_mov_b32 s35, 0x00020000
    s_mul_i32 s36, s24, 200
    s_mul_i32 s37, s21, 100
    s_add_u32 s36, s36, s37
    s_mul_i32 s37, s22, 50
    s_add_u32 s36, s36, s37
    s_lshl_b32 s36, s36, 10
    s_add_u32 s37, s36, 24055808
    s_add_u32 s36, s36, 23236608
    v_lshrrev_b32 v2, 1, v3
    s_lshl_b32 s26, s21, 2
    v_add_u32 v2, s26, v2
    v_and_b32 v7, 7, v4
    buffer_load_dwordx4 a[0:3], v8, s[28:31], s36 offen offset:0
    v_xor_b32 v2, v2, v7
    v_lshlrev_b32 v2, 4, v2
    v_lshl_add_u32 v226, v4, 8, v2
    v_and_b32 v2, 1, v3
    v_lshl_add_u32 v226, v2, 3, v226
    s_mul_i32 s26, s22, 20480
    s_add_u32 s27, s26, 0
    v_add_u32 v226, s27, v226
    v_lshlrev_b32 v227, 5, v4
    v_add_u32 v227, 122880, v227
    s_lshl_b32 s27, s21, 3
    v_add_u32 v2, s27, v3
    v_xor_b32 v2, v2, v7
    v_lshlrev_b32 v2, 4, v2
    v_and_b32 v7, 3, v4
    v_lshl_add_u32 v2, v7, 8, v2
    v_lshrrev_b32 v7, 2, v4
    buffer_load_dwordx4 a[4:7], v8, s[28:31], s36 offen offset:1024
    v_lshl_add_u32 v2, v7, 10, v2
    s_add_u32 s27, s26, 40960
    v_add_u32 v228, s27, v2
    v_xor_b32 v2, v4, v3
    v_lshlrev_b32 v2, 4, v2
    v_lshl_add_u32 v2, v3, 8, v2
    v_xor_b32 v7, 64, v2
    s_mul_i32 s26, s22, 30720
    s_add_u32 s26, s26, 40960
    s_mul_i32 s27, s22, 10240
    s_sub_u32 s27, 61440, s27
    v_add_u32 v229, s26, v2
    v_add_u32 v230, s26, v7
    v_add_u32 v231, s27, v2
    v_add_u32 v232, s27, v7
    v_lshlrev_b32 v2, 4, v3
    s_mul_i32 s26, s21, 384
    buffer_load_dwordx4 a[8:11], v8, s[28:31], s36 offen offset:2048
    s_add_u32 s26, s26, 139264
    v_add_u32 v233, s26, v2
    s_mul_i32 s26, s21, 64
    s_add_u32 s26, s26, 139520
    v_add_u32 v234, s26, v2
    s_lshl_b32 s26, s22, 7
    s_add_u32 s26, s26, 138240
    v_lshl_add_u32 v235, v4, 3, s26
    s_mul_i32 s39, s24, 5
    s_mul_i32 s40, s21, 3
    s_add_u32 s40, s40, s39
    s_add_u32 s41, s39, 2
    v_lshrrev_b32 v12, 1, v3
    v_and_b32 v13, 1, v3
    v_lshlrev_b32 v13, 3, v13
    s_add_u32 s26, s40, 0
    buffer_load_dwordx4 a[12:15], v8, s[28:31], s36 offen offset:3072
    v_add_u32 v14, 0, v12
    s_and_b32 s27, s26, 1
    s_lshl_b32 s27, s27, 2
    v_add_u32 v15, s27, v14
    v_xor_b32 v15, v15, v4
    v_lshlrev_b32 v15, 4, v15
    v_lshl_add_u32 v15, v14, 8, v15
    v_add_u32 v15, v15, v13
    s_mul_i32 s27, s22, 20
    s_add_u32 s27, s27, s26
    s_lshl_b32 s27, s27, 10
    s_add_u32 s27, s27, 40960
    v_add_u32 v236, s27, v15
    s_add_u32 s26, s40, 0
    v_add_u32 v14, 2, v12
    s_and_b32 s27, s26, 1
    s_lshl_b32 s27, s27, 2
    s_add_u32 s36, s36, 4096
    buffer_load_dwordx4 a[16:19], v8, s[28:31], s36 offen offset:0
    v_add_u32 v15, s27, v14
    v_xor_b32 v15, v15, v4
    v_lshlrev_b32 v15, 4, v15
    v_lshl_add_u32 v15, v14, 8, v15
    v_add_u32 v15, v15, v13
    s_mul_i32 s27, s22, 20
    s_add_u32 s27, s27, s26
    s_lshl_b32 s27, s27, 10
    s_add_u32 s27, s27, 40960
    v_add_u32 v237, s27, v15
    s_add_u32 s26, s40, 1
    v_add_u32 v14, 0, v12
    s_and_b32 s27, s26, 1
    s_lshl_b32 s27, s27, 2
    v_add_u32 v15, s27, v14
    v_xor_b32 v15, v15, v4
    v_lshlrev_b32 v15, 4, v15
    buffer_load_dwordx4 a[20:23], v8, s[28:31], s36 offen offset:1024
    v_lshl_add_u32 v15, v14, 8, v15
    v_add_u32 v15, v15, v13
    s_mul_i32 s27, s22, 20
    s_add_u32 s27, s27, s26
    s_lshl_b32 s27, s27, 10
    s_add_u32 s27, s27, 40960
    v_add_u32 v238, s27, v15
    s_add_u32 s26, s40, 1
    v_add_u32 v14, 2, v12
    s_and_b32 s27, s26, 1
    s_lshl_b32 s27, s27, 2
    v_add_u32 v15, s27, v14
    v_xor_b32 v15, v15, v4
    v_lshlrev_b32 v15, 4, v15
    v_lshl_add_u32 v15, v14, 8, v15
    v_add_u32 v15, v15, v13
    s_mul_i32 s27, s22, 20
    buffer_load_dwordx4 a[24:27], v8, s[28:31], s36 offen offset:2048
    s_add_u32 s27, s27, s26
    s_lshl_b32 s27, s27, 10
    s_add_u32 s27, s27, 40960
    v_add_u32 v239, s27, v15
    s_mov_b32 s26, s41
    s_lshl_b32 s27, s21, 1
    v_add_u32 v14, s27, v12
    s_and_b32 s27, s26, 1
    s_lshl_b32 s27, s27, 2
    v_add_u32 v15, s27, v14
    v_xor_b32 v15, v15, v4
    v_lshlrev_b32 v15, 4, v15
    v_lshl_add_u32 v15, v14, 8, v15
    v_add_u32 v15, v15, v13
    s_mul_i32 s27, s22, 20
    s_add_u32 s27, s27, s26
    s_lshl_b32 s27, s27, 10
    buffer_load_dwordx4 a[28:31], v8, s[28:31], s36 offen offset:3072
    s_add_u32 s27, s27, 40960
    v_add_u32 v240, s27, v15
    s_lshr_b32 s26, s24, 1
    s_add_u32 s26, s26, 1
    s_sub_u32 s27, 0, s26
    s_and_b32 s42, s24, 1
    s_cmp_eq_u32 s42, 1
    s_cselect_b32 s42, s27, s26
    s_lshl_b32 s43, s23, 5
    s_lshl_b32 s26, s22, 4
    s_add_u32 s43, s43, s26
    v_add_u32 v241, s43, v4
    v_add_u32 v241, s42, v241
    s_movk_i32 s27, 2048
    v_cmp_gt_u32 s[60:61], s27, v241
    v_lshrrev_b32 v242, 4, v241
    s_add_u32 s36, s36, 4096
    buffer_load_dwordx4 a[32:35], v8, s[28:31], s36 offen offset:0
    v_and_b32 v241, 15, v241
    s_mov_b32 s27, 20480
    v_mul_lo_u32 v242, v242, s27
    v_lshl_add_u32 v242, v241, 4, v242
    v_and_b32 v241, 1, v3
    v_lshlrev_b32 v241, 9, v241
    v_lshrrev_b32 v2, 1, v3
    v_lshl_add_u32 v241, v2, 8, v241
    v_add_u32 v241, v241, v242
    s_lshl_b32 s27, s21, 9
    v_lshl_add_u32 v242, v2, 8, v242
    v_add_u32 v242, s27, v242
    v_and_b32 v2, 1, v3
    v_lshl_add_u32 v242, v2, 3, v242
    v_add_u32 v243, s43, v4
    v_lshrrev_b32 v244, 4, v243
    v_and_b32 v243, 15, v243
    buffer_load_dwordx4 a[36:39], v8, s[28:31], s36 offen offset:1024
    s_mov_b32 s27, 20480
    v_mul_lo_u32 v244, v244, s27
    v_lshl_add_u32 v244, v243, 4, v244
    v_and_b32 v243, 1, v3
    v_lshlrev_b32 v243, 9, v243
    v_lshrrev_b32 v2, 1, v3
    v_lshl_add_u32 v243, v2, 8, v243
    v_add_u32 v243, v243, v244
    s_lshl_b32 s27, s21, 9
    v_lshl_add_u32 v244, v2, 8, v244
    v_add_u32 v244, s27, v244
    v_and_b32 v2, 1, v3
    v_lshl_add_u32 v244, v2, 3, v244
    s_lshl_b32 s44, s40, 10
    s_add_u32 s38, s44, 13406208
    s_add_u32 s44, s44, 10784768
    s_lshl_b32 s45, s41, 10
    buffer_load_dwordx4 a[40:43], v8, s[28:31], s36 offen offset:2048
    s_add_u32 s39, s45, 13406208
    s_add_u32 s45, s45, 10784768
    s_lshl_b32 s46, s23, 2
    s_add_u32 s46, s46, s24
    s_lshl_b32 s46, s46, 7
    s_add_u32 s49, s46, 29413376
    s_add_u32 s46, s46, 29380608
    v_add_u32 v7, 1, v1
    v_lshrrev_b32 v7, 1, v7
    v_add_u32 v7, s23, v7
    v_subrev_u32 v7, 1, v7
    v_max_i32 v7, 0, v7
    v_min_i32 v7, 63, v7
    v_lshrrev_b32 v2, 1, v1
    s_lshl_b32 s26, s22, 1
    v_add_u32 v2, s26, v2
    v_lshl_add_u32 v7, v7, 2, v2
    buffer_load_dwordx4 a[44:47], v8, s[28:31], s36 offen offset:3072
    v_lshlrev_b32 v245, 7, v7
    s_lshl_b32 s26, s23, 1
    s_add_u32 s27, s26, s22
    s_mul_i32 s27, s27, 20
    s_mul_i32 s3, s22, 10
    s_add_u32 s27, s27, s3
    s_lshl_b32 s27, s27, 10
    s_add_u32 s50, s27, 10784768
    s_add_u32 s27, s26, 1
    s_sub_u32 s27, s27, s22
    s_mul_i32 s27, s27, 20
    s_add_u32 s27, s27, s3
    s_lshl_b32 s27, s27, 10
    s_add_u32 s51, s27, 10784768
    s_mul_i32 s26, s20, 5120
    s_add_u32 s26, s26, 143360
    s_add_u32 s36, s36, 4096
    buffer_load_dwordx4 a[48:51], v8, s[28:31], s36 offen offset:0
    v_add_u32 v246, s26, v8
    s_xor_b32 s27, s20, 2
    s_mul_i32 s27, s27, 5120
    s_add_u32 s27, s27, 143360
    v_add_u32 v247, s27, v8
    s_lshr_b32 s26, s2, 3
    s_and_b32 s3, s2, 7
    s_and_b32 s4, s3, 1
    s_lshr_b32 s3, s3, 1
    s_and_b32 s52, s26, 7
    s_lshl_b32 s27, s4, 3
    s_add_u32 s52, s52, s27
    s_lshr_b32 s27, s26, 3
    s_lshl_b32 s53, s3, 2
    s_add_u32 s53, s53, s27
    s_and_b32 s57, s26, 3
    buffer_load_dwordx4 a[52:55], v8, s[28:31], s36 offen offset:1024
    s_lshl_b32 s27, s4, 2
    s_add_u32 s57, s57, s27
    s_lshr_b32 s27, s26, 2
    s_lshl_b32 s58, s3, 3
    s_add_u32 s58, s58, s27
    s_and_b32 s57, s26, 7
    s_lshr_b32 s27, s26, 3
    s_and_b32 s58, s2, 7
    s_lshl_b32 s58, s58, 2
    s_add_u32 s58, s58, s27
    s_mul_i32 s54, s52, 143360
    s_add_u32 s54, s54, 24875008
    s_mul_i32 s59, s57, 276480
    s_add_u32 s59, s59, 27168768
    v_mov_b32 v224, 0x3f803f80
    v_mov_b32 v216, 0
    buffer_load_dwordx4 a[56:59], v8, s[28:31], s36 offen offset:2048
    v_mov_b32 v217, 0
    v_mov_b32 v220, 0
    v_mov_b32 v221, 0
    v_mov_b32 v218, 0
    v_mov_b32 v219, 0
    v_mov_b32 v222, 0
    v_mov_b32 v223, 0
    buffer_load_dwordx4 a[60:63], v8, s[28:31], s36 offen offset:3072
    s_add_u32 s36, s36, 4096
    buffer_load_dwordx4 a[64:67], v8, s[28:31], s36 offen offset:0
    s_waitcnt vmcnt(17)
    s_barrier
    buffer_load_dwordx4 a[68:71], v8, s[28:31], s36 offen offset:1024
    v_xor_b32 v12, 32, v226
    ds_read_b64 v[32:33], v226 offset:0
    ds_read_b64 v[34:35], v226 offset:128
    ds_read_b64 v[36:37], v12 offset:0
    ds_read_b64 v[38:39], v12 offset:128
    ds_read_b64 v[40:41], v226 offset:4096
    ds_read_b64 v[42:43], v226 offset:4224
    buffer_load_dwordx4 a[72:75], v8, s[28:31], s36 offen offset:2048
    s_waitcnt lgkmcnt(4)
    v_dot2_f32_bf16 v220, v32, v224, v220
    v_lshlrev_b32 v72, 16, v32
    v_dot2_f32_bf16 v221, v32, v32, v221
    v_and_b32 v73, 0xffff0000, v32
    v_dot2_f32_bf16 v220, v33, v224, v220
    ds_read_b64 v[44:45], v12 offset:4096
    v_lshlrev_b32 v74, 16, v33
    v_dot2_f32_bf16 v221, v33, v33, v221
    v_and_b32 v75, 0xffff0000, v33
    v_dot2_f32_bf16 v220, v34, v224, v220
    ds_read_b64 v[46:47], v12 offset:4224
    v_lshlrev_b32 v76, 16, v34
    buffer_load_dwordx4 a[76:79], v8, s[28:31], s36 offen offset:3072
    v_dot2_f32_bf16 v221, v34, v34, v221
    v_and_b32 v77, 0xffff0000, v34
    v_dot2_f32_bf16 v220, v35, v224, v220
    v_lshlrev_b32 v78, 16, v35
    v_dot2_f32_bf16 v221, v35, v35, v221
    v_and_b32 v79, 0xffff0000, v35
    s_waitcnt lgkmcnt(4)
    v_dot2_f32_bf16 v222, v36, v224, v222
    v_lshlrev_b32 v80, 16, v36
    v_dot2_f32_bf16 v223, v36, v36, v223
    v_and_b32 v81, 0xffff0000, v36
    v_dot2_f32_bf16 v222, v37, v224, v222
    ds_read_b64 v[48:49], v226 offset:8192
    v_lshlrev_b32 v82, 16, v37
    v_dot2_f32_bf16 v223, v37, v37, v223
    s_add_u32 s36, s36, 4096
    buffer_load_dwordx4 a[80:83], v8, s[28:31], s36 offen offset:0
    v_and_b32 v83, 0xffff0000, v37
    v_dot2_f32_bf16 v222, v38, v224, v222
    ds_read_b64 v[50:51], v226 offset:8320
    v_lshlrev_b32 v84, 16, v38
    v_dot2_f32_bf16 v223, v38, v38, v223
    v_and_b32 v85, 0xffff0000, v38
    v_dot2_f32_bf16 v222, v39, v224, v222
    v_lshlrev_b32 v86, 16, v39
    v_dot2_f32_bf16 v223, v39, v39, v223
    v_and_b32 v87, 0xffff0000, v39
    s_waitcnt lgkmcnt(4)
    v_dot2_f32_bf16 v220, v40, v224, v220
    v_lshlrev_b32 v88, 16, v40
    v_dot2_f32_bf16 v221, v40, v40, v221
    v_and_b32 v89, 0xffff0000, v40
    buffer_load_dwordx4 a[84:87], v8, s[28:31], s36 offen offset:1024
    v_dot2_f32_bf16 v220, v41, v224, v220
    ds_read_b64 v[52:53], v12 offset:8192
    v_lshlrev_b32 v90, 16, v41
    v_dot2_f32_bf16 v221, v41, v41, v221
    v_and_b32 v91, 0xffff0000, v41
    v_dot2_f32_bf16 v220, v42, v224, v220
    ds_read_b64 v[54:55], v12 offset:8320
    v_lshlrev_b32 v92, 16, v42
    v_dot2_f32_bf16 v221, v42, v42, v221
    v_and_b32 v93, 0xffff0000, v42
    v_dot2_f32_bf16 v220, v43, v224, v220
    v_lshlrev_b32 v94, 16, v43
    v_dot2_f32_bf16 v221, v43, v43, v221
    buffer_load_dwordx4 a[88:91], v8, s[28:31], s36 offen offset:2048
    v_and_b32 v95, 0xffff0000, v43
    s_waitcnt lgkmcnt(4)
    v_dot2_f32_bf16 v222, v44, v224, v222
    v_lshlrev_b32 v96, 16, v44
    v_dot2_f32_bf16 v223, v44, v44, v223
    v_and_b32 v97, 0xffff0000, v44
    v_dot2_f32_bf16 v222, v45, v224, v222
    ds_read_b64 v[56:57], v226 offset:12288
    v_lshlrev_b32 v98, 16, v45
    v_dot2_f32_bf16 v223, v45, v45, v223
    v_and_b32 v99, 0xffff0000, v45
    v_dot2_f32_bf16 v222, v46, v224, v222
    ds_read_b64 v[58:59], v226 offset:12416
    buffer_load_dwordx4 a[92:95], v8, s[28:31], s36 offen offset:3072
    v_lshlrev_b32 v100, 16, v46
    v_dot2_f32_bf16 v223, v46, v46, v223
    v_and_b32 v101, 0xffff0000, v46
    v_dot2_f32_bf16 v222, v47, v224, v222
    v_lshlrev_b32 v102, 16, v47
    v_dot2_f32_bf16 v223, v47, v47, v223
    v_and_b32 v103, 0xffff0000, v47
    s_waitcnt lgkmcnt(4)
    v_dot2_f32_bf16 v220, v48, v224, v220
    v_lshlrev_b32 v104, 16, v48
    v_dot2_f32_bf16 v221, v48, v48, v221
    v_and_b32 v105, 0xffff0000, v48
    v_dot2_f32_bf16 v220, v49, v224, v220
    ds_read_b64 v[60:61], v12 offset:12288
    v_lshlrev_b32 v106, 16, v49
    s_add_u32 s36, s36, 4096
    buffer_load_dwordx4 a[96:99], v8, s[28:31], s36 offen offset:0
    v_dot2_f32_bf16 v221, v49, v49, v221
    v_and_b32 v107, 0xffff0000, v49
    v_dot2_f32_bf16 v220, v50, v224, v220
    ds_read_b64 v[62:63], v12 offset:12416
    v_lshlrev_b32 v108, 16, v50
    v_dot2_f32_bf16 v221, v50, v50, v221
    v_and_b32 v109, 0xffff0000, v50
    v_dot2_f32_bf16 v220, v51, v224, v220
    v_lshlrev_b32 v110, 16, v51
    v_dot2_f32_bf16 v221, v51, v51, v221
    v_and_b32 v111, 0xffff0000, v51
    s_waitcnt lgkmcnt(4)
    v_dot2_f32_bf16 v222, v52, v224, v222
    v_lshlrev_b32 v112, 16, v52
    v_dot2_f32_bf16 v223, v52, v52, v223
    buffer_load_dwordx4 a[100:103], v8, s[28:31], s36 offen offset:1024
    v_and_b32 v113, 0xffff0000, v52
    v_dot2_f32_bf16 v222, v53, v224, v222
    ds_read_b64 v[64:65], v226 offset:16384
    v_lshlrev_b32 v114, 16, v53
    v_dot2_f32_bf16 v223, v53, v53, v223
    v_and_b32 v115, 0xffff0000, v53
    v_dot2_f32_bf16 v222, v54, v224, v222
    ds_read_b64 v[66:67], v226 offset:16512
    v_lshlrev_b32 v116, 16, v54
    v_dot2_f32_bf16 v223, v54, v54, v223
    v_and_b32 v117, 0xffff0000, v54
    v_dot2_f32_bf16 v222, v55, v224, v222
    v_lshlrev_b32 v118, 16, v55
    buffer_load_dwordx4 a[104:107], v8, s[28:31], s36 offen offset:2048
    v_dot2_f32_bf16 v223, v55, v55, v223
    v_and_b32 v119, 0xffff0000, v55
    s_waitcnt lgkmcnt(4)
    v_dot2_f32_bf16 v220, v56, v224, v220
    v_lshlrev_b32 v120, 16, v56
    v_dot2_f32_bf16 v221, v56, v56, v221
    v_and_b32 v121, 0xffff0000, v56
    v_dot2_f32_bf16 v220, v57, v224, v220
    ds_read_b64 v[68:69], v12 offset:16384
    v_lshlrev_b32 v122, 16, v57
    v_dot2_f32_bf16 v221, v57, v57, v221
    v_and_b32 v123, 0xffff0000, v57
    v_dot2_f32_bf16 v220, v58, v224, v220
    ds_read_b64 v[70:71], v12 offset:16512
    buffer_load_dwordx4 a[108:111], v8, s[28:31], s36 offen offset:3072
    v_lshlrev_b32 v124, 16, v58
    v_dot2_f32_bf16 v221, v58, v58, v221
    v_and_b32 v125, 0xffff0000, v58
    v_dot2_f32_bf16 v220, v59, v224, v220
    v_lshlrev_b32 v126, 16, v59
    v_dot2_f32_bf16 v221, v59, v59, v221
    v_and_b32 v127, 0xffff0000, v59
    s_waitcnt lgkmcnt(4)
    v_dot2_f32_bf16 v222, v60, v224, v222
    v_lshlrev_b32 v128, 16, v60
    v_dot2_f32_bf16 v223, v60, v60, v223
    v_and_b32 v129, 0xffff0000, v60
    v_dot2_f32_bf16 v222, v61, v224, v222
    v_lshlrev_b32 v130, 16, v61
    v_dot2_f32_bf16 v223, v61, v61, v223
    v_and_b32 v131, 0xffff0000, v61
    v_dot2_f32_bf16 v222, v62, v224, v222
    s_add_u32 s36, s36, 4096
    buffer_load_dwordx4 a[112:115], v8, s[28:31], s36 offen offset:0
    v_lshlrev_b32 v132, 16, v62
    v_dot2_f32_bf16 v223, v62, v62, v223
    v_and_b32 v133, 0xffff0000, v62
    v_dot2_f32_bf16 v222, v63, v224, v222
    v_lshlrev_b32 v134, 16, v63
    v_dot2_f32_bf16 v223, v63, v63, v223
    v_and_b32 v135, 0xffff0000, v63
    s_waitcnt lgkmcnt(2)
    v_dot2_f32_bf16 v220, v64, v224, v220
    v_lshlrev_b32 v136, 16, v64
    v_dot2_f32_bf16 v221, v64, v64, v221
    v_and_b32 v137, 0xffff0000, v64
    v_dot2_f32_bf16 v220, v65, v224, v220
    v_lshlrev_b32 v138, 16, v65
    v_dot2_f32_bf16 v221, v65, v65, v221
    v_and_b32 v139, 0xffff0000, v65
    v_dot2_f32_bf16 v220, v66, v224, v220
    buffer_load_dwordx4 a[116:119], v8, s[28:31], s36 offen offset:1024
    v_lshlrev_b32 v140, 16, v66
    v_dot2_f32_bf16 v221, v66, v66, v221
    v_and_b32 v141, 0xffff0000, v66
    v_dot2_f32_bf16 v220, v67, v224, v220
    v_lshlrev_b32 v142, 16, v67
    v_dot2_f32_bf16 v221, v67, v67, v221
    v_and_b32 v143, 0xffff0000, v67
    s_waitcnt lgkmcnt(0)
    v_dot2_f32_bf16 v222, v68, v224, v222
    v_lshlrev_b32 v144, 16, v68
    v_dot2_f32_bf16 v223, v68, v68, v223
    v_and_b32 v145, 0xffff0000, v68
    v_dot2_f32_bf16 v222, v69, v224, v222
    v_lshlrev_b32 v146, 16, v69
    v_dot2_f32_bf16 v223, v69, v69, v223
    v_and_b32 v147, 0xffff0000, v69
    v_dot2_f32_bf16 v222, v70, v224, v222
    buffer_load_dwordx4 a[120:123], v8, s[28:31], s36 offen offset:2048
    v_lshlrev_b32 v148, 16, v70
    v_dot2_f32_bf16 v223, v70, v70, v223
    v_and_b32 v149, 0xffff0000, v70
    v_dot2_f32_bf16 v222, v71, v224, v222
    v_lshlrev_b32 v150, 16, v71
    v_dot2_f32_bf16 v223, v71, v71, v223
    v_and_b32 v151, 0xffff0000, v71
    s_nop 2
    s_nop 1
    v_add_f32_dpp v220, v220, v220 quad_perm:[1,0,3,2] row_mask:0xf bank_mask:0xf
    v_add_f32_dpp v221, v221, v221 quad_perm:[1,0,3,2] row_mask:0xf bank_mask:0xf
    v_add_f32_dpp v222, v222, v222 quad_perm:[1,0,3,2] row_mask:0xf bank_mask:0xf
    v_add_f32_dpp v223, v223, v223 quad_perm:[1,0,3,2] row_mask:0xf bank_mask:0xf
    v_add_f32_dpp v220, v220, v220 quad_perm:[2,3,0,1] row_mask:0xf bank_mask:0xf
    v_add_f32_dpp v221, v221, v221 quad_perm:[2,3,0,1] row_mask:0xf bank_mask:0xf
    v_add_f32_dpp v222, v222, v222 quad_perm:[2,3,0,1] row_mask:0xf bank_mask:0xf
    v_add_f32_dpp v223, v223, v223 quad_perm:[2,3,0,1] row_mask:0xf bank_mask:0xf
    buffer_load_dwordx4 a[124:127], v8, s[28:31], s36 offen offset:3072
    v_add_f32_dpp v220, v220, v220 row_half_mirror row_mask:0xf bank_mask:0xf
    v_add_f32_dpp v221, v221, v221 row_half_mirror row_mask:0xf bank_mask:0xf
    v_add_f32_dpp v222, v222, v222 row_half_mirror row_mask:0xf bank_mask:0xf
    v_add_f32_dpp v223, v223, v223 row_half_mirror row_mask:0xf bank_mask:0xf
    v_add_f32_dpp v220, v220, v220 row_mirror row_mask:0xf bank_mask:0xf
    v_add_f32_dpp v221, v221, v221 row_mirror row_mask:0xf bank_mask:0xf
    v_add_f32_dpp v222, v222, v222 row_mirror row_mask:0xf bank_mask:0xf
    v_add_f32_dpp v223, v223, v223 row_mirror row_mask:0xf bank_mask:0xf
    v_mul_f32 v220, 0x3acccccd, v220
    v_mul_f32 v222, 0x3acccccd, v222
    v_mul_f32 v221, 0x3acccccd, v221
    v_mul_f32 v223, 0x3acccccd, v223
    v_fma_f32 v221, -v220, v220, v221
    v_fma_f32 v223, -v222, v222, v223
    v_max_f32 v221, 0, v221
    v_max_f32 v223, 0, v223
    v_cvt_pk_bf16_f32 v192, v220, v221
    s_add_u32 s36, s36, 4096
    buffer_load_dwordx4 a[128:131], v8, s[28:31], s36 offen offset:0
    v_cvt_pk_bf16_f32 v193, v222, v223
    v_lshlrev_b32 v220, 16, v192
    v_lshlrev_b32 v222, 16, v193
    v_and_b32 v221, 0xffff0000, v192
    v_and_b32 v223, 0xffff0000, v193
    v_add_f32 v221, 0x3727c5ac, v221
    v_add_f32 v223, 0x3727c5ac, v223
    v_cvt_pk_bf16_f32 v192, v221, v221
    v_cvt_pk_bf16_f32 v193, v223, v223
    v_lshlrev_b32 v221, 16, v192
    v_lshlrev_b32 v223, 16, v193
    v_sqrt_f32 v221, v221
    v_sqrt_f32 v223, v223
    s_nop 0
    s_nop 0
    v_cvt_pk_bf16_f32 v192, v221, v221
    buffer_load_dwordx4 a[132:135], v8, s[28:31], s36 offen offset:1024
    v_cvt_pk_bf16_f32 v193, v223, v223
    v_lshlrev_b32 v221, 16, v192
    v_lshlrev_b32 v223, 16, v193
    v_rcp_f32 v221, v221
    v_rcp_f32 v223, v223
    s_nop 0
    s_nop 0
    v_mul_f32 v220, v220, v221
    v_mul_f32 v222, v222, v223
    v_sub_f32 v220, 0, v220
    v_sub_f32 v222, 0, v222
    v_mov_b32 v216, 0
    v_mov_b32 v217, 0
    v_mov_b32 v218, 0
    v_mov_b32 v219, 0
    buffer_load_dwordx4 a[136:139], v8, s[28:31], s36 offen offset:2048
    v_xor_b32 v12, 64, v228
    ds_read_b128 v[152:155], v227 offset:10240
    ds_read_b128 v[156:159], v227 offset:10256
    ds_read_b128 v[160:163], v227 offset:7680
    ds_read_b128 v[164:167], v227 offset:7696
    s_waitcnt lgkmcnt(0)
    v_pk_fma_f32 v[72:73], v[72:73], v[220:221], v[220:221] op_sel:[0,1,0] op_sel_hi:[1,1,0]
    v_pk_fma_f32 v[74:75], v[74:75], v[220:221], v[220:221] op_sel:[0,1,0] op_sel_hi:[1,1,0]
    v_pk_fma_f32 v[76:77], v[76:77], v[220:221], v[220:221] op_sel:[0,1,0] op_sel_hi:[1,1,0]
    buffer_load_dwordx4 a[140:143], v8, s[28:31], s36 offen offset:3072
    ds_read_b128 v[168:171], v227 offset:10752
    v_pk_fma_f32 v[78:79], v[78:79], v[220:221], v[220:221] op_sel:[0,1,0] op_sel_hi:[1,1,0]
    v_pk_fma_f32 v[72:73], v[72:73], v[152:153], v[160:161]
    v_pk_fma_f32 v[74:75], v[74:75], v[154:155], v[162:163]
    ds_read_b128 v[172:175], v227 offset:10768
    v_pk_fma_f32 v[76:77], v[76:77], v[156:157], v[164:165]
    v_pk_fma_f32 v[78:79], v[78:79], v[158:159], v[166:167]
    v_cvt_pk_bf16_f32 v32, v72, v73
    ds_read_b128 v[176:179], v227 offset:8192
    v_cvt_pk_bf16_f32 v33, v74, v75
    v_cvt_pk_bf16_f32 v34, v76, v77
    s_add_u32 s36, s36, 4096
    buffer_load_dwordx4 a[144:147], v8, s[28:31], s36 offen offset:0
    v_cvt_pk_bf16_f32 v35, v78, v79
    ds_read_b128 v[180:183], v227 offset:8208
    v_dot2_f32_bf16 v216, v32, v224, v216
    v_dot2_f32_bf16 v217, v32, v32, v217
    v_dot2_f32_bf16 v216, v33, v224, v216
    v_dot2_f32_bf16 v217, v33, v33, v217
    v_dot2_f32_bf16 v216, v34, v224, v216
    v_dot2_f32_bf16 v217, v34, v34, v217
    v_dot2_f32_bf16 v216, v35, v224, v216
    v_dot2_f32_bf16 v217, v35, v35, v217
    ds_write_b128 v228, v[32:35] offset:0
    buffer_load_dwordx4 a[148:151], v8, s[28:31], s36 offen offset:1024
    v_pk_fma_f32 v[80:81], v[80:81], v[222:223], v[222:223] op_sel:[0,1,0] op_sel_hi:[1,1,0]
    v_pk_fma_f32 v[82:83], v[82:83], v[222:223], v[222:223] op_sel:[0,1,0] op_sel_hi:[1,1,0]
    v_pk_fma_f32 v[84:85], v[84:85], v[222:223], v[222:223] op_sel:[0,1,0] op_sel_hi:[1,1,0]
    v_pk_fma_f32 v[86:87], v[86:87], v[222:223], v[222:223] op_sel:[0,1,0] op_sel_hi:[1,1,0]
    v_pk_fma_f32 v[80:81], v[80:81], v[152:153], v[160:161]
    v_pk_fma_f32 v[82:83], v[82:83], v[154:155], v[162:163]
    v_pk_fma_f32 v[84:85], v[84:85], v[156:157], v[164:165]
    v_pk_fma_f32 v[86:87], v[86:87], v[158:159], v[166:167]
    v_cvt_pk_bf16_f32 v36, v80, v81
    v_cvt_pk_bf16_f32 v37, v82, v83
    v_cvt_pk_bf16_f32 v38, v84, v85
    v_cvt_pk_bf16_f32 v39, v86, v87
    v_dot2_f32_bf16 v218, v36, v224, v218
    v_dot2_f32_bf16 v219, v36, v36, v219
    v_dot2_f32_bf16 v218, v37, v224, v218
    v_dot2_f32_bf16 v219, v37, v37, v219
    v_dot2_f32_bf16 v218, v38, v224, v218
    buffer_load_dwordx4 a[152:155], v8, s[28:31], s36 offen offset:2048
    v_dot2_f32_bf16 v219, v38, v38, v219
    v_dot2_f32_bf16 v218, v39, v224, v218
    v_dot2_f32_bf16 v219, v39, v39, v219
    ds_write_b128 v12, v[36:39] offset:0
    s_waitcnt lgkmcnt(1)
    v_pk_fma_f32 v[88:89], v[88:89], v[220:221], v[220:221] op_sel:[0,1,0] op_sel_hi:[1,1,0]
    v_pk_fma_f32 v[90:91], v[90:91], v[220:221], v[220:221] op_sel:[0,1,0] op_sel_hi:[1,1,0]
    v_pk_fma_f32 v[92:93], v[92:93], v[220:221], v[220:221] op_sel:[0,1,0] op_sel_hi:[1,1,0]
    ds_read_b128 v[152:155], v227 offset:11264
    buffer_load_dwordx4 a[156:159], v8, s[28:31], s36 offen offset:3072
    v_pk_fma_f32 v[94:95], v[94:95], v[220:221], v[220:221] op_sel:[0,1,0] op_sel_hi:[1,1,0]
    v_pk_fma_f32 v[88:89], v[88:89], v[168:169], v[176:177]
    v_pk_fma_f32 v[90:91], v[90:91], v[170:171], v[178:179]
    ds_read_b128 v[156:159], v227 offset:11280
    v_pk_fma_f32 v[92:93], v[92:93], v[172:173], v[180:181]
    v_pk_fma_f32 v[94:95], v[94:95], v[174:175], v[182:183]
    v_cvt_pk_bf16_f32 v40, v88, v89
    ds_read_b128 v[160:163], v227 offset:8704
    v_cvt_pk_bf16_f32 v41, v90, v91
    v_cvt_pk_bf16_f32 v42, v92, v93
    v_cvt_pk_bf16_f32 v43, v94, v95
    ds_read_b128 v[164:167], v227 offset:8720
    s_add_u32 s36, s36, 4096
    buffer_load_dwordx4 a[160:163], v8, s[28:31], s36 offen offset:0
    v_dot2_f32_bf16 v216, v40, v224, v216
    v_dot2_f32_bf16 v217, v40, v40, v217
    v_dot2_f32_bf16 v216, v41, v224, v216
    v_dot2_f32_bf16 v217, v41, v41, v217
    v_dot2_f32_bf16 v216, v42, v224, v216
    v_dot2_f32_bf16 v217, v42, v42, v217
    v_dot2_f32_bf16 v216, v43, v224, v216
    v_dot2_f32_bf16 v217, v43, v43, v217
    ds_write_b128 v228, v[40:43] offset:4096
    v_pk_fma_f32 v[96:97], v[96:97], v[222:223], v[222:223] op_sel:[0,1,0] op_sel_hi:[1,1,0]
    buffer_load_dwordx4 a[164:167], v8, s[28:31], s36 offen offset:1024
    v_pk_fma_f32 v[98:99], v[98:99], v[222:223], v[222:223] op_sel:[0,1,0] op_sel_hi:[1,1,0]
    v_pk_fma_f32 v[100:101], v[100:101], v[222:223], v[222:223] op_sel:[0,1,0] op_sel_hi:[1,1,0]
    v_pk_fma_f32 v[102:103], v[102:103], v[222:223], v[222:223] op_sel:[0,1,0] op_sel_hi:[1,1,0]
    v_pk_fma_f32 v[96:97], v[96:97], v[168:169], v[176:177]
    v_pk_fma_f32 v[98:99], v[98:99], v[170:171], v[178:179]
    v_pk_fma_f32 v[100:101], v[100:101], v[172:173], v[180:181]
    v_pk_fma_f32 v[102:103], v[102:103], v[174:175], v[182:183]
    v_cvt_pk_bf16_f32 v44, v96, v97
    v_cvt_pk_bf16_f32 v45, v98, v99
    v_cvt_pk_bf16_f32 v46, v100, v101
    v_cvt_pk_bf16_f32 v47, v102, v103
    v_dot2_f32_bf16 v218, v44, v224, v218
    v_dot2_f32_bf16 v219, v44, v44, v219
    v_dot2_f32_bf16 v218, v45, v224, v218
    v_dot2_f32_bf16 v219, v45, v45, v219
    v_dot2_f32_bf16 v218, v46, v224, v218
    v_dot2_f32_bf16 v219, v46, v46, v219
    buffer_load_dwordx4 a[168:171], v8, s[28:31], s36 offen offset:2048
    v_dot2_f32_bf16 v218, v47, v224, v218
    v_dot2_f32_bf16 v219, v47, v47, v219
    ds_write_b128 v12, v[44:47] offset:4096
    s_waitcnt lgkmcnt(1)
    v_pk_fma_f32 v[104:105], v[104:105], v[220:221], v[220:221] op_sel:[0,1,0] op_sel_hi:[1,1,0]
    v_pk_fma_f32 v[106:107], v[106:107], v[220:221], v[220:221] op_sel:[0,1,0] op_sel_hi:[1,1,0]
    v_pk_fma_f32 v[108:109], v[108:109], v[220:221], v[220:221] op_sel:[0,1,0] op_sel_hi:[1,1,0]
    ds_read_b128 v[168:171], v227 offset:11776
    buffer_load_dwordx4 a[172:175], v8, s[28:31], s36 offen offset:3072
    v_pk_fma_f32 v[110:111], v[110:111], v[220:221], v[220:221] op_sel:[0,1,0] op_sel_hi:[1,1,0]
    v_pk_fma_f32 v[104:105], v[104:105], v[152:153], v[160:161]
    v_pk_fma_f32 v[106:107], v[106:107], v[154:155], v[162:163]
    ds_read_b128 v[172:175], v227 offset:11792
    v_pk_fma_f32 v[108:109], v[108:109], v[156:157], v[164:165]
    v_pk_fma_f32 v[110:111], v[110:111], v[158:159], v[166:167]
    v_cvt_pk_bf16_f32 v48, v104, v105
    ds_read_b128 v[176:179], v227 offset:9216
    v_cvt_pk_bf16_f32 v49, v106, v107
    v_cvt_pk_bf16_f32 v50, v108, v109
    v_cvt_pk_bf16_f32 v51, v110, v111
    ds_read_b128 v[180:183], v227 offset:9232
    s_add_u32 s36, s36, 4096
    buffer_load_dwordx4 a[176:179], v8, s[28:31], s36 offen offset:0
    v_dot2_f32_bf16 v216, v48, v224, v216
    v_dot2_f32_bf16 v217, v48, v48, v217
    v_dot2_f32_bf16 v216, v49, v224, v216
    v_dot2_f32_bf16 v217, v49, v49, v217
    v_dot2_f32_bf16 v216, v50, v224, v216
    v_dot2_f32_bf16 v217, v50, v50, v217
    v_dot2_f32_bf16 v216, v51, v224, v216
    v_dot2_f32_bf16 v217, v51, v51, v217
    ds_write_b128 v228, v[48:51] offset:8192
    v_pk_fma_f32 v[112:113], v[112:113], v[222:223], v[222:223] op_sel:[0,1,0] op_sel_hi:[1,1,0]
    buffer_load_dwordx4 a[180:183], v8, s[28:31], s36 offen offset:1024
    v_pk_fma_f32 v[114:115], v[114:115], v[222:223], v[222:223] op_sel:[0,1,0] op_sel_hi:[1,1,0]
    v_pk_fma_f32 v[116:117], v[116:117], v[222:223], v[222:223] op_sel:[0,1,0] op_sel_hi:[1,1,0]
    v_pk_fma_f32 v[118:119], v[118:119], v[222:223], v[222:223] op_sel:[0,1,0] op_sel_hi:[1,1,0]
    v_pk_fma_f32 v[112:113], v[112:113], v[152:153], v[160:161]
    v_pk_fma_f32 v[114:115], v[114:115], v[154:155], v[162:163]
    v_pk_fma_f32 v[116:117], v[116:117], v[156:157], v[164:165]
    v_pk_fma_f32 v[118:119], v[118:119], v[158:159], v[166:167]
    v_cvt_pk_bf16_f32 v52, v112, v113
    v_cvt_pk_bf16_f32 v53, v114, v115
    v_cvt_pk_bf16_f32 v54, v116, v117
    v_cvt_pk_bf16_f32 v55, v118, v119
    v_dot2_f32_bf16 v218, v52, v224, v218
    v_dot2_f32_bf16 v219, v52, v52, v219
    v_dot2_f32_bf16 v218, v53, v224, v218
    v_dot2_f32_bf16 v219, v53, v53, v219
    v_dot2_f32_bf16 v218, v54, v224, v218
    v_dot2_f32_bf16 v219, v54, v54, v219
    buffer_load_dwordx4 a[184:187], v8, s[28:31], s36 offen offset:2048
    v_dot2_f32_bf16 v218, v55, v224, v218
    v_dot2_f32_bf16 v219, v55, v55, v219
    ds_write_b128 v12, v[52:55] offset:8192
    s_waitcnt lgkmcnt(1)
    v_pk_fma_f32 v[120:121], v[120:121], v[220:221], v[220:221] op_sel:[0,1,0] op_sel_hi:[1,1,0]
    v_pk_fma_f32 v[122:123], v[122:123], v[220:221], v[220:221] op_sel:[0,1,0] op_sel_hi:[1,1,0]
    v_pk_fma_f32 v[124:125], v[124:125], v[220:221], v[220:221] op_sel:[0,1,0] op_sel_hi:[1,1,0]
    ds_read_b128 v[152:155], v227 offset:12288
    buffer_load_dwordx4 a[188:191], v8, s[28:31], s36 offen offset:3072
    v_pk_fma_f32 v[126:127], v[126:127], v[220:221], v[220:221] op_sel:[0,1,0] op_sel_hi:[1,1,0]
    v_pk_fma_f32 v[120:121], v[120:121], v[168:169], v[176:177]
    v_pk_fma_f32 v[122:123], v[122:123], v[170:171], v[178:179]
    ds_read_b128 v[156:159], v227 offset:12304
    v_pk_fma_f32 v[124:125], v[124:125], v[172:173], v[180:181]
    v_pk_fma_f32 v[126:127], v[126:127], v[174:175], v[182:183]
    v_cvt_pk_bf16_f32 v56, v120, v121
    ds_read_b128 v[160:163], v227 offset:9728
    v_cvt_pk_bf16_f32 v57, v122, v123
    v_cvt_pk_bf16_f32 v58, v124, v125
    v_cvt_pk_bf16_f32 v59, v126, v127
    ds_read_b128 v[164:167], v227 offset:9744
    s_add_u32 s36, s36, 4096
    buffer_load_dwordx4 a[192:195], v8, s[28:31], s36 offen offset:0
    v_dot2_f32_bf16 v216, v56, v224, v216
    v_dot2_f32_bf16 v217, v56, v56, v217
    v_dot2_f32_bf16 v216, v57, v224, v216
    v_dot2_f32_bf16 v217, v57, v57, v217
    v_dot2_f32_bf16 v216, v58, v224, v216
    v_dot2_f32_bf16 v217, v58, v58, v217
    v_dot2_f32_bf16 v216, v59, v224, v216
    v_dot2_f32_bf16 v217, v59, v59, v217
    ds_write_b128 v228, v[56:59] offset:12288
    v_pk_fma_f32 v[128:129], v[128:129], v[222:223], v[222:223] op_sel:[0,1,0] op_sel_hi:[1,1,0]
    buffer_load_dwordx4 a[196:199], v8, s[28:31], s36 offen offset:1024
    v_pk_fma_f32 v[130:131], v[130:131], v[222:223], v[222:223] op_sel:[0,1,0] op_sel_hi:[1,1,0]
    v_pk_fma_f32 v[132:133], v[132:133], v[222:223], v[222:223] op_sel:[0,1,0] op_sel_hi:[1,1,0]
    v_pk_fma_f32 v[134:135], v[134:135], v[222:223], v[222:223] op_sel:[0,1,0] op_sel_hi:[1,1,0]
    v_pk_fma_f32 v[128:129], v[128:129], v[168:169], v[176:177]
    v_pk_fma_f32 v[130:131], v[130:131], v[170:171], v[178:179]
    v_pk_fma_f32 v[132:133], v[132:133], v[172:173], v[180:181]
    v_pk_fma_f32 v[134:135], v[134:135], v[174:175], v[182:183]
    v_cvt_pk_bf16_f32 v60, v128, v129
    v_cvt_pk_bf16_f32 v61, v130, v131
    v_cvt_pk_bf16_f32 v62, v132, v133
    v_cvt_pk_bf16_f32 v63, v134, v135
    v_dot2_f32_bf16 v218, v60, v224, v218
    v_dot2_f32_bf16 v219, v60, v60, v219
    v_dot2_f32_bf16 v218, v61, v224, v218
    v_dot2_f32_bf16 v219, v61, v61, v219
    v_dot2_f32_bf16 v218, v62, v224, v218
    v_dot2_f32_bf16 v219, v62, v62, v219
    buffer_load_dwordx4 a[200:203], v8, s[28:31], s37 offen offset:0
    v_dot2_f32_bf16 v218, v63, v224, v218
    v_dot2_f32_bf16 v219, v63, v63, v219
    ds_write_b128 v12, v[60:63] offset:12288
    s_waitcnt lgkmcnt(1)
    v_pk_fma_f32 v[136:137], v[136:137], v[220:221], v[220:221] op_sel:[0,1,0] op_sel_hi:[1,1,0]
    v_pk_fma_f32 v[138:139], v[138:139], v[220:221], v[220:221] op_sel:[0,1,0] op_sel_hi:[1,1,0]
    v_pk_fma_f32 v[140:141], v[140:141], v[220:221], v[220:221] op_sel:[0,1,0] op_sel_hi:[1,1,0]
    v_pk_fma_f32 v[142:143], v[142:143], v[220:221], v[220:221] op_sel:[0,1,0] op_sel_hi:[1,1,0]
    v_pk_fma_f32 v[136:137], v[136:137], v[152:153], v[160:161]
    v_pk_fma_f32 v[138:139], v[138:139], v[154:155], v[162:163]
    buffer_load_dwordx4 a[204:207], v8, s[28:31], s37 offen offset:1024
    v_pk_fma_f32 v[140:141], v[140:141], v[156:157], v[164:165]
    v_pk_fma_f32 v[142:143], v[142:143], v[158:159], v[166:167]
    v_cvt_pk_bf16_f32 v64, v136, v137
    v_cvt_pk_bf16_f32 v65, v138, v139
    v_cvt_pk_bf16_f32 v66, v140, v141
    v_cvt_pk_bf16_f32 v67, v142, v143
    v_dot2_f32_bf16 v216, v64, v224, v216
    v_dot2_f32_bf16 v217, v64, v64, v217
    v_dot2_f32_bf16 v216, v65, v224, v216
    v_dot2_f32_bf16 v217, v65, v65, v217
    v_dot2_f32_bf16 v216, v66, v224, v216
    v_dot2_f32_bf16 v217, v66, v66, v217
    v_dot2_f32_bf16 v216, v67, v224, v216
    v_dot2_f32_bf16 v217, v67, v67, v217
    ds_write_b128 v228, v[64:67] offset:16384
    buffer_load_dwordx4 a[208:211], v8, s[28:31], s37 offen offset:2048
    v_pk_fma_f32 v[144:145], v[144:145], v[222:223], v[222:223] op_sel:[0,1,0] op_sel_hi:[1,1,0]
    v_pk_fma_f32 v[146:147], v[146:147], v[222:223], v[222:223] op_sel:[0,1,0] op_sel_hi:[1,1,0]
    v_pk_fma_f32 v[148:149], v[148:149], v[222:223], v[222:223] op_sel:[0,1,0] op_sel_hi:[1,1,0]
    v_pk_fma_f32 v[150:151], v[150:151], v[222:223], v[222:223] op_sel:[0,1,0] op_sel_hi:[1,1,0]
    v_pk_fma_f32 v[144:145], v[144:145], v[152:153], v[160:161]
    v_pk_fma_f32 v[146:147], v[146:147], v[154:155], v[162:163]
    v_pk_fma_f32 v[148:149], v[148:149], v[156:157], v[164:165]
    v_pk_fma_f32 v[150:151], v[150:151], v[158:159], v[166:167]
    v_cvt_pk_bf16_f32 v68, v144, v145
    v_cvt_pk_bf16_f32 v69, v146, v147
    v_cvt_pk_bf16_f32 v70, v148, v149
    v_cvt_pk_bf16_f32 v71, v150, v151
    v_dot2_f32_bf16 v218, v68, v224, v218
    v_dot2_f32_bf16 v219, v68, v68, v219
    v_dot2_f32_bf16 v218, v69, v224, v218
    v_dot2_f32_bf16 v219, v69, v69, v219
    v_dot2_f32_bf16 v218, v70, v224, v218
    buffer_load_dwordx4 a[212:215], v8, s[28:31], s37 offen offset:3072
    v_dot2_f32_bf16 v219, v70, v70, v219
    v_dot2_f32_bf16 v218, v71, v224, v218
    v_dot2_f32_bf16 v219, v71, v71, v219
    ds_write_b128 v12, v[68:71] offset:16384
    s_waitcnt lgkmcnt(0)
    s_barrier
    ds_read_b128 v[72:75], v229 offset:0
    ds_read_b128 v[76:79], v231 offset:0
    s_add_u32 s37, s37, 4096
    buffer_load_dwordx4 a[216:219], v8, s[28:31], s37 offen offset:0
    s_waitcnt vmcnt(50) lgkmcnt(0)
    v_mfma_f32_16x16x32_bf16 v[32:35], a[0:3], v[72:75], 0
    v_mfma_f32_16x16x32_bf16 v[52:55], a[0:3], v[76:79], 0
    ds_read_b128 v[80:83], v230 offset:1024
    v_mfma_f32_16x16x32_bf16 v[36:39], a[4:7], v[72:75], 0
    v_mfma_f32_16x16x32_bf16 v[56:59], a[4:7], v[76:79], 0
    buffer_load_dwordx4 a[220:223], v8, s[28:31], s37 offen offset:1024
    ds_read_b128 v[84:87], v232 offset:1024
    v_mfma_f32_16x16x32_bf16 v[40:43], a[8:11], v[72:75], 0
    v_mfma_f32_16x16x32_bf16 v[60:63], a[8:11], v[76:79], 0
    ds_read_b128 v[112:115], v233 offset:0
    v_mfma_f32_16x16x32_bf16 v[44:47], a[12:15], v[72:75], 0
    buffer_load_dwordx4 a[224:227], v8, s[28:31], s37 offen offset:2048
    v_mfma_f32_16x16x32_bf16 v[64:67], a[12:15], v[76:79], 0
    ds_read_b128 v[132:135], v233 offset:1024
    v_mfma_f32_16x16x32_bf16 v[48:51], a[16:19], v[72:75], 0
    v_mfma_f32_16x16x32_bf16 v[68:71], a[16:19], v[76:79], 0
    s_waitcnt vmcnt(47) lgkmcnt(0)
    v_mfma_f32_16x16x32_bf16 v[32:35], a[20:23], v[80:83], v[32:35]
    buffer_load_dwordx4 a[228:231], v8, s[28:31], s37 offen offset:3072
    v_add_f32_dpp v216, v216, v216 quad_perm:[1,0,3,2] row_mask:0xf bank_mask:0xf
    v_mfma_f32_16x16x32_bf16 v[52:55], a[20:23], v[84:87], v[52:55]
    ds_read_b128 v[72:75], v229 offset:2048
    v_mfma_f32_16x16x32_bf16 v[36:39], a[24:27], v[80:83], v[36:39]
    v_add_f32_dpp v217, v217, v217 quad_perm:[1,0,3,2] row_mask:0xf bank_mask:0xf
    v_mfma_f32_16x16x32_bf16 v[56:59], a[24:27], v[84:87], v[56:59]
    ds_read_b128 v[76:79], v231 offset:2048
    s_add_u32 s37, s37, 4096
    buffer_load_dwordx4 a[232:235], v8, s[28:31], s37 offen offset:0
    v_mfma_f32_16x16x32_bf16 v[40:43], a[28:31], v[80:83], v[40:43]
    v_add_f32_dpp v218, v218, v218 quad_perm:[1,0,3,2] row_mask:0xf bank_mask:0xf
    v_mfma_f32_16x16x32_bf16 v[60:63], a[28:31], v[84:87], v[60:63]
    ds_read_b128 v[116:119], v233 offset:64
    v_mfma_f32_16x16x32_bf16 v[44:47], a[32:35], v[80:83], v[44:47]
    v_add_f32_dpp v219, v219, v219 quad_perm:[1,0,3,2] row_mask:0xf bank_mask:0xf
    v_mfma_f32_16x16x32_bf16 v[64:67], a[32:35], v[84:87], v[64:67]
    buffer_load_dwordx4 a[236:239], v8, s[28:31], s37 offen offset:1024
    ds_read_b128 v[136:139], v233 offset:1088
    v_mfma_f32_16x16x32_bf16 v[48:51], a[36:39], v[80:83], v[48:51]
    v_add_f32_dpp v216, v216, v216 quad_perm:[2,3,0,1] row_mask:0xf bank_mask:0xf
    v_mfma_f32_16x16x32_bf16 v[68:71], a[36:39], v[84:87], v[68:71]
    v_add_f32_dpp v217, v217, v217 quad_perm:[2,3,0,1] row_mask:0xf bank_mask:0xf
    s_waitcnt vmcnt(45) lgkmcnt(0)
    v_mfma_f32_16x16x32_bf16 v[32:35], a[40:43], v[72:75], v[32:35]
    buffer_load_dwordx4 a[240:243], v8, s[28:31], s37 offen offset:2048
    v_add_f32_dpp v218, v218, v218 quad_perm:[2,3,0,1] row_mask:0xf bank_mask:0xf
    v_mfma_f32_16x16x32_bf16 v[52:55], a[40:43], v[76:79], v[52:55]
    ds_read_b128 v[80:83], v230 offset:3072
    v_mfma_f32_16x16x32_bf16 v[36:39], a[44:47], v[72:75], v[36:39]
    v_add_f32_dpp v219, v219, v219 quad_perm:[2,3,0,1] row_mask:0xf bank_mask:0xf
    v_mfma_f32_16x16x32_bf16 v[56:59], a[44:47], v[76:79], v[56:59]
    ds_read_b128 v[84:87], v232 offset:3072
    buffer_load_dwordx4 a[244:247], v8, s[28:31], s37 offen offset:3072
    v_mfma_f32_16x16x32_bf16 v[40:43], a[48:51], v[72:75], v[40:43]
    v_add_f32_dpp v216, v216, v216 row_half_mirror row_mask:0xf bank_mask:0xf
    v_mfma_f32_16x16x32_bf16 v[60:63], a[48:51], v[76:79], v[60:63]
    ds_read_b128 v[120:123], v233 offset:128
    v_mfma_f32_16x16x32_bf16 v[44:47], a[52:55], v[72:75], v[44:47]
    v_add_f32_dpp v217, v217, v217 row_half_mirror row_mask:0xf bank_mask:0xf
    v_mfma_f32_16x16x32_bf16 v[64:67], a[52:55], v[76:79], v[64:67]
    s_add_u32 s37, s37, 4096
    buffer_load_dwordx4 a[248:251], v8, s[28:31], s37 offen offset:0
    ds_read_b128 v[140:143], v233 offset:1152
    v_mfma_f32_16x16x32_bf16 v[48:51], a[56:59], v[72:75], v[48:51]
    v_add_f32_dpp v218, v218, v218 row_half_mirror row_mask:0xf bank_mask:0xf
    v_mfma_f32_16x16x32_bf16 v[68:71], a[56:59], v[76:79], v[68:71]
    v_add_f32_dpp v219, v219, v219 row_half_mirror row_mask:0xf bank_mask:0xf
    s_waitcnt vmcnt(43) lgkmcnt(0)
    v_mfma_f32_16x16x32_bf16 v[32:35], a[60:63], v[80:83], v[32:35]
    buffer_load_dwordx4 a[252:255], v8, s[28:31], s37 offen offset:1024
    v_add_f32_dpp v216, v216, v216 row_mirror row_mask:0xf bank_mask:0xf
    v_mfma_f32_16x16x32_bf16 v[52:55], a[60:63], v[84:87], v[52:55]
    ds_read_b128 v[72:75], v229 offset:4096
    v_mfma_f32_16x16x32_bf16 v[36:39], a[64:67], v[80:83], v[36:39]
    v_add_f32_dpp v217, v217, v217 row_mirror row_mask:0xf bank_mask:0xf
    v_mfma_f32_16x16x32_bf16 v[56:59], a[64:67], v[84:87], v[56:59]
    ds_read_b128 v[76:79], v231 offset:4096
    buffer_load_dwordx4 a[0:3], v8, s[28:31], s37 offen offset:2048
    v_mfma_f32_16x16x32_bf16 v[40:43], a[68:71], v[80:83], v[40:43]
    v_add_f32_dpp v218, v218, v218 row_mirror row_mask:0xf bank_mask:0xf
    v_mfma_f32_16x16x32_bf16 v[60:63], a[68:71], v[84:87], v[60:63]
    ds_read_b128 v[124:127], v233 offset:192
    v_mfma_f32_16x16x32_bf16 v[44:47], a[72:75], v[80:83], v[44:47]
    v_add_f32_dpp v219, v219, v219 row_mirror row_mask:0xf bank_mask:0xf
    v_mfma_f32_16x16x32_bf16 v[64:67], a[72:75], v[84:87], v[64:67]
    buffer_load_dwordx4 a[4:7], v8, s[28:31], s37 offen offset:3072
    ds_read_b128 v[144:147], v233 offset:1216
    v_mfma_f32_16x16x32_bf16 v[48:51], a[76:79], v[80:83], v[48:51]
    v_mul_f32 v216, 0x3acccccd, v216
    v_mfma_f32_16x16x32_bf16 v[68:71], a[76:79], v[84:87], v[68:71]
    v_mul_f32 v218, 0x3acccccd, v218
    s_waitcnt vmcnt(41) lgkmcnt(0)
    v_mfma_f32_16x16x32_bf16 v[32:35], a[80:83], v[72:75], v[32:35]
    s_add_u32 s37, s37, 4096
    buffer_load_dwordx4 a[8:11], v8, s[28:31], s37 offen offset:0
    v_mul_f32 v217, 0x3acccccd, v217
    v_mfma_f32_16x16x32_bf16 v[52:55], a[80:83], v[76:79], v[52:55]
    ds_read_b128 v[80:83], v230 offset:5120
    v_mfma_f32_16x16x32_bf16 v[36:39], a[84:87], v[72:75], v[36:39]
    v_mul_f32 v219, 0x3acccccd, v219
    v_mfma_f32_16x16x32_bf16 v[56:59], a[84:87], v[76:79], v[56:59]
    ds_read_b128 v[84:87], v232 offset:5120
    buffer_load_dwordx4 a[12:15], v8, s[28:31], s37 offen offset:1024
    v_mfma_f32_16x16x32_bf16 v[40:43], a[88:91], v[72:75], v[40:43]
    v_fma_f32 v217, -v216, v216, v217
    v_mfma_f32_16x16x32_bf16 v[60:63], a[88:91], v[76:79], v[60:63]
    ds_read_b128 v[128:131], v234
    v_mfma_f32_16x16x32_bf16 v[44:47], a[92:95], v[72:75], v[44:47]
    v_fma_f32 v219, -v218, v218, v219
    v_mfma_f32_16x16x32_bf16 v[64:67], a[92:95], v[76:79], v[64:67]
    buffer_load_dwordx4 a[16:19], v8, s[28:31], s37 offen offset:2048
    ds_read_b128 v[148:151], v234 offset:1024
    v_mfma_f32_16x16x32_bf16 v[48:51], a[96:99], v[72:75], v[48:51]
    v_max_f32 v217, 0, v217
    v_mfma_f32_16x16x32_bf16 v[68:71], a[96:99], v[76:79], v[68:71]
    v_max_f32 v219, 0, v219
    s_waitcnt vmcnt(39) lgkmcnt(0)
    v_mfma_f32_16x16x32_bf16 v[32:35], a[100:103], v[80:83], v[32:35]
    buffer_load_dwordx4 a[20:23], v8, s[28:31], s37 offen offset:3072
    v_cvt_pk_bf16_f32 v192, v216, v217
    v_mfma_f32_16x16x32_bf16 v[52:55], a[100:103], v[84:87], v[52:55]
    ds_read_b128 v[72:75], v229 offset:6144
    v_mfma_f32_16x16x32_bf16 v[36:39], a[104:107], v[80:83], v[36:39]
    v_cvt_pk_bf16_f32 v193, v218, v219
    v_mfma_f32_16x16x32_bf16 v[56:59], a[104:107], v[84:87], v[56:59]
    ds_read_b128 v[76:79], v231 offset:6144
    s_add_u32 s37, s37, 4096
    buffer_load_dwordx4 a[24:27], v8, s[28:31], s37 offen offset:0
    v_mfma_f32_16x16x32_bf16 v[40:43], a[108:111], v[80:83], v[40:43]
    v_lshlrev_b32 v216, 16, v192
    v_mfma_f32_16x16x32_bf16 v[60:63], a[108:111], v[84:87], v[60:63]
    ds_read_b64 v[16:17], v236
    v_mfma_f32_16x16x32_bf16 v[44:47], a[112:115], v[80:83], v[44:47]
    v_lshlrev_b32 v218, 16, v193
    v_mfma_f32_16x16x32_bf16 v[64:67], a[112:115], v[84:87], v[64:67]
    buffer_load_dwordx4 a[28:31], v8, s[28:31], s37 offen offset:1024
    ds_read_b64 v[18:19], v237
    v_mfma_f32_16x16x32_bf16 v[48:51], a[116:119], v[80:83], v[48:51]
    v_and_b32 v217, 0xffff0000, v192
    v_mfma_f32_16x16x32_bf16 v[68:71], a[116:119], v[84:87], v[68:71]
    v_and_b32 v219, 0xffff0000, v193
    s_waitcnt vmcnt(37) lgkmcnt(0)
    v_mfma_f32_16x16x32_bf16 v[32:35], a[120:123], v[72:75], v[32:35]
    buffer_load_dwordx4 a[32:35], v8, s[28:31], s37 offen offset:2048
    v_add_f32 v217, 0x3727c5ac, v217
    v_mfma_f32_16x16x32_bf16 v[52:55], a[120:123], v[76:79], v[52:55]
    ds_read_b128 v[80:83], v230 offset:7168
    v_mfma_f32_16x16x32_bf16 v[36:39], a[124:127], v[72:75], v[36:39]
    v_add_f32 v219, 0x3727c5ac, v219
    v_mfma_f32_16x16x32_bf16 v[56:59], a[124:127], v[76:79], v[56:59]
    ds_read_b128 v[84:87], v232 offset:7168
    buffer_load_dwordx4 a[36:39], v8, s[28:31], s37 offen offset:3072
    v_mfma_f32_16x16x32_bf16 v[40:43], a[128:131], v[72:75], v[40:43]
    v_cvt_pk_bf16_f32 v192, v217, v217
    v_mfma_f32_16x16x32_bf16 v[60:63], a[128:131], v[76:79], v[60:63]
    ds_read_b64 v[20:21], v238
    v_mfma_f32_16x16x32_bf16 v[44:47], a[132:135], v[72:75], v[44:47]
    v_cvt_pk_bf16_f32 v193, v219, v219
    v_mfma_f32_16x16x32_bf16 v[64:67], a[132:135], v[76:79], v[64:67]
    s_add_u32 s37, s37, 4096
    buffer_load_dwordx4 a[40:43], v8, s[28:31], s37 offen offset:0
    ds_read_b64 v[22:23], v239
    v_mfma_f32_16x16x32_bf16 v[48:51], a[136:139], v[72:75], v[48:51]
    v_lshlrev_b32 v217, 16, v192
    v_mfma_f32_16x16x32_bf16 v[68:71], a[136:139], v[76:79], v[68:71]
    v_lshlrev_b32 v219, 16, v193
    s_waitcnt vmcnt(35) lgkmcnt(0)
    v_mfma_f32_16x16x32_bf16 v[32:35], a[140:143], v[80:83], v[32:35]
    buffer_load_dwordx4 a[44:47], v8, s[28:31], s37 offen offset:1024
    v_sqrt_f32 v217, v217
    v_mfma_f32_16x16x32_bf16 v[52:55], a[140:143], v[84:87], v[52:55]
    ds_read_b128 v[72:75], v229 offset:8192
    v_mfma_f32_16x16x32_bf16 v[36:39], a[144:147], v[80:83], v[36:39]
    v_sqrt_f32 v219, v219
    v_mfma_f32_16x16x32_bf16 v[56:59], a[144:147], v[84:87], v[56:59]
    buffer_load_dwordx4 a[48:51], v8, s[28:31], s37 offen offset:2048
    ds_read_b128 v[76:79], v231 offset:8192
    v_mfma_f32_16x16x32_bf16 v[40:43], a[148:151], v[80:83], v[40:43]
    v_cvt_pk_bf16_f32 v192, v217, v217
    v_mfma_f32_16x16x32_bf16 v[60:63], a[148:151], v[84:87], v[60:63]
    ds_read_b64 v[24:25], v240
    v_mfma_f32_16x16x32_bf16 v[44:47], a[152:155], v[80:83], v[44:47]
    buffer_load_dwordx4 a[52:55], v8, s[28:31], s37 offen offset:3072
    v_cvt_pk_bf16_f32 v193, v219, v219
    v_mfma_f32_16x16x32_bf16 v[64:67], a[152:155], v[84:87], v[64:67]
    v_lshlrev_b32 v217, 16, v192
    v_mfma_f32_16x16x32_bf16 v[48:51], a[156:159], v[80:83], v[48:51]
    v_lshlrev_b32 v219, 16, v193
    v_mfma_f32_16x16x32_bf16 v[68:71], a[156:159], v[84:87], v[68:71]
    v_rcp_f32 v217, v217
    s_waitcnt vmcnt(33) lgkmcnt(0)
    s_add_u32 s37, s37, 4096
    buffer_load_dwordx4 a[56:59], v8, s[28:31], s37 offen offset:0
    v_mfma_f32_16x16x32_bf16 v[32:35], a[160:163], v[72:75], v[32:35]
    v_rcp_f32 v219, v219
    v_mfma_f32_16x16x32_bf16 v[52:55], a[160:163], v[76:79], v[52:55]
    ds_read_b128 v[80:83], v230 offset:9216
    v_mfma_f32_16x16x32_bf16 v[36:39], a[164:167], v[72:75], v[36:39]
    v_mul_f32 v216, v216, v217
    buffer_load_dwordx4 a[60:63], v8, s[28:31], s37 offen offset:1024
    v_mfma_f32_16x16x32_bf16 v[56:59], a[164:167], v[76:79], v[56:59]
    ds_read_b128 v[84:87], v232 offset:9216
    v_mfma_f32_16x16x32_bf16 v[40:43], a[168:171], v[72:75], v[40:43]
    v_mul_f32 v218, v218, v219
    v_mfma_f32_16x16x32_bf16 v[60:63], a[168:171], v[76:79], v[60:63]
    v_sub_f32 v216, 0, v216
    v_mfma_f32_16x16x32_bf16 v[44:47], a[172:175], v[72:75], v[44:47]
    buffer_load_dwordx4 a[64:67], v8, s[28:31], s37 offen offset:2048
    v_sub_f32 v218, 0, v218
    v_mfma_f32_16x16x32_bf16 v[64:67], a[172:175], v[76:79], v[64:67]
    s_lshl_b32 s26, s20, 6
    v_mfma_f32_16x16x32_bf16 v[48:51], a[176:179], v[72:75], v[48:51]
    v_lshl_add_u32 v2, v3, 3, s26
    v_mfma_f32_16x16x32_bf16 v[68:71], a[176:179], v[76:79], v[68:71]
    v_add_u32 v2, 138240, v2
    s_waitcnt vmcnt(31) lgkmcnt(0)
    v_mfma_f32_16x16x32_bf16 v[32:35], a[180:183], v[80:83], v[32:35]
    buffer_load_dwordx4 a[68:71], v8, s[28:31], s37 offen offset:3072
    ds_write_b64 v2, v[216:217]
    v_mfma_f32_16x16x32_bf16 v[52:55], a[180:183], v[84:87], v[52:55]
    ds_write_b64 v2, v[218:219] offset:32
    s_add_u32 s37, s37, 4096
    buffer_load_dwordx4 a[72:75], v8, s[28:31], s37 offen offset:0
    v_mfma_f32_16x16x32_bf16 v[36:39], a[184:187], v[80:83], v[36:39]
    v_mfma_f32_16x16x32_bf16 v[56:59], a[184:187], v[84:87], v[56:59]
    v_mfma_f32_16x16x32_bf16 v[40:43], a[188:191], v[80:83], v[40:43]
    v_mfma_f32_16x16x32_bf16 v[60:63], a[188:191], v[84:87], v[60:63]
    v_mfma_f32_16x16x32_bf16 v[44:47], a[192:195], v[80:83], v[44:47]
    buffer_load_dwordx4 a[76:79], v8, s[28:31], s37 offen offset:1024
    v_mfma_f32_16x16x32_bf16 v[64:67], a[192:195], v[84:87], v[64:67]
    v_mfma_f32_16x16x32_bf16 v[48:51], a[196:199], v[80:83], v[48:51]
    v_mfma_f32_16x16x32_bf16 v[68:71], a[196:199], v[84:87], v[68:71]
    s_waitcnt lgkmcnt(0)
    s_nop 4
    ds_write_b128 v246, v[52:55] offset:0
    buffer_load_dwordx4 a[80:83], v8, s[28:31], s37 offen offset:2048
    ds_write_b128 v246, v[56:59] offset:1024
    ds_write_b128 v246, v[60:63] offset:2048
    buffer_load_dwordx4 a[84:87], v8, s[28:31], s37 offen offset:3072
    ds_write_b128 v246, v[64:67] offset:3072
    ds_write_b128 v246, v[68:71] offset:4096
    s_add_u32 s37, s37, 4096
    buffer_load_dwordx4 a[88:91], v8, s[28:31], s37 offen offset:0
    v_pk_add_f32 v[112:113], v[112:113], v[132:133]
    v_pk_add_f32 v[114:115], v[114:115], v[134:135]
    v_pk_add_f32 v[116:117], v[116:117], v[136:137]
    v_pk_add_f32 v[118:119], v[118:119], v[138:139]
    v_pk_add_f32 v[120:121], v[120:121], v[140:141]
    v_pk_add_f32 v[122:123], v[122:123], v[142:143]
    v_pk_add_f32 v[124:125], v[124:125], v[144:145]
    v_pk_add_f32 v[126:127], v[126:127], v[146:147]
    v_pk_add_f32 v[128:129], v[128:129], v[148:149]
    v_pk_add_f32 v[130:131], v[130:131], v[150:151]
    v_mov_b32 v30, 0xbdd2d3e8
    v_mov_b32 v31, 0xc0135761
    s_waitcnt lgkmcnt(0)
    s_barrier
    ds_read_b64 v[152:153], v235
    buffer_load_dwordx4 a[92:95], v8, s[28:31], s37 offen offset:1024
    ds_read_b128 v[88:91], v247 offset:0
    ds_read_b128 v[92:95], v247 offset:1024
    ds_read_b128 v[96:99], v247 offset:2048
    ds_read_b128 v[100:103], v247 offset:3072
    ds_read_b128 v[104:107], v247 offset:4096
    s_waitcnt lgkmcnt(5)
    v_pk_mul_f32 v[112:113], v[112:113], v[152:153] op_sel_hi:[1,0]
    buffer_load_dwordx4 a[96:99], v8, s[28:31], s37 offen offset:2048
    v_pk_mul_f32 v[114:115], v[114:115], v[152:153] op_sel_hi:[1,0]
    v_pk_mul_f32 v[116:117], v[116:117], v[152:153] op_sel_hi:[1,0]
    v_pk_mul_f32 v[118:119], v[118:119], v[152:153] op_sel_hi:[1,0]
    v_pk_mul_f32 v[120:121], v[120:121], v[152:153] op_sel_hi:[1,0]
    v_pk_mul_f32 v[122:123], v[122:123], v[152:153] op_sel_hi:[1,0]
    v_pk_mul_f32 v[124:125], v[124:125], v[152:153] op_sel_hi:[1,0]
    v_pk_mul_f32 v[126:127], v[126:127], v[152:153] op_sel_hi:[1,0]
    v_pk_mul_f32 v[128:129], v[128:129], v[152:153] op_sel_hi:[1,0]
    v_pk_mul_f32 v[130:131], v[130:131], v[152:153] op_sel_hi:[1,0]
    s_waitcnt lgkmcnt(4)
    v_pk_add_f32 v[32:33], v[32:33], v[88:89]
    v_pk_add_f32 v[34:35], v[34:35], v[90:91]
    s_waitcnt lgkmcnt(3)
    v_pk_add_f32 v[36:37], v[36:37], v[92:93]
    v_pk_add_f32 v[38:39], v[38:39], v[94:95]
    s_waitcnt lgkmcnt(2)
    v_pk_add_f32 v[40:41], v[40:41], v[96:97]
    buffer_load_dwordx4 a[100:103], v8, s[28:31], s37 offen offset:3072
    v_pk_add_f32 v[42:43], v[42:43], v[98:99]
    s_waitcnt lgkmcnt(1)
    v_pk_add_f32 v[44:45], v[44:45], v[100:101]
    v_pk_add_f32 v[46:47], v[46:47], v[102:103]
    s_waitcnt lgkmcnt(0)
    v_pk_add_f32 v[48:49], v[48:49], v[104:105]
    v_pk_add_f32 v[50:51], v[50:51], v[106:107]
    v_pk_fma_f32 v[32:33], v[32:33], v[152:153], v[112:113] op_sel:[0,1,0] op_sel_hi:[1,1,1]
    v_pk_fma_f32 v[34:35], v[34:35], v[152:153], v[114:115] op_sel:[0,1,0] op_sel_hi:[1,1,1]
    v_pk_fma_f32 v[36:37], v[36:37], v[152:153], v[116:117] op_sel:[0,1,0] op_sel_hi:[1,1,1]
    v_pk_fma_f32 v[38:39], v[38:39], v[152:153], v[118:119] op_sel:[0,1,0] op_sel_hi:[1,1,1]
    v_pk_fma_f32 v[40:41], v[40:41], v[152:153], v[120:121] op_sel:[0,1,0] op_sel_hi:[1,1,1]
    v_pk_fma_f32 v[42:43], v[42:43], v[152:153], v[122:123] op_sel:[0,1,0] op_sel_hi:[1,1,1]
    v_pk_fma_f32 v[44:45], v[44:45], v[152:153], v[124:125] op_sel:[0,1,0] op_sel_hi:[1,1,1]
    v_pk_fma_f32 v[46:47], v[46:47], v[152:153], v[126:127] op_sel:[0,1,0] op_sel_hi:[1,1,1]
    v_pk_fma_f32 v[48:49], v[48:49], v[152:153], v[128:129] op_sel:[0,1,0] op_sel_hi:[1,1,1]
    v_pk_fma_f32 v[50:51], v[50:51], v[152:153], v[130:131] op_sel:[0,1,0] op_sel_hi:[1,1,1]
    s_add_u32 s37, s37, 4096
    buffer_load_dwordx4 a[104:107], v8, s[28:31], s37 offen offset:0
    v_pk_mul_f32 v[192:193], v[32:33], v[32:33]
    v_pk_mul_f32 v[194:195], v[34:35], v[34:35]
    v_pk_mul_f32 v[196:197], v[36:37], v[36:37]
    v_pk_mul_f32 v[198:199], v[38:39], v[38:39]
    v_pk_mul_f32 v[200:201], v[40:41], v[40:41]
    v_pk_mul_f32 v[202:203], v[42:43], v[42:43]
    v_pk_mul_f32 v[204:205], v[44:45], v[44:45]
    v_pk_mul_f32 v[206:207], v[46:47], v[46:47]
    v_pk_mul_f32 v[208:209], v[48:49], v[48:49]
    v_pk_mul_f32 v[210:211], v[50:51], v[50:51]
    v_pk_fma_f32 v[192:193], v[192:193], v[30:31], v[30:31] op_sel:[0,0,1] op_sel_hi:[1,0,1]
    v_pk_fma_f32 v[194:195], v[194:195], v[30:31], v[30:31] op_sel:[0,0,1] op_sel_hi:[1,0,1]
    v_pk_fma_f32 v[196:197], v[196:197], v[30:31], v[30:31] op_sel:[0,0,1] op_sel_hi:[1,0,1]
    v_pk_fma_f32 v[198:199], v[198:199], v[30:31], v[30:31] op_sel:[0,0,1] op_sel_hi:[1,0,1]
    v_pk_fma_f32 v[200:201], v[200:201], v[30:31], v[30:31] op_sel:[0,0,1] op_sel_hi:[1,0,1]
    v_pk_fma_f32 v[202:203], v[202:203], v[30:31], v[30:31] op_sel:[0,0,1] op_sel_hi:[1,0,1]
    v_pk_fma_f32 v[204:205], v[204:205], v[30:31], v[30:31] op_sel:[0,0,1] op_sel_hi:[1,0,1]
    buffer_load_dwordx4 a[108:111], v8, s[28:31], s37 offen offset:1024
    v_pk_fma_f32 v[206:207], v[206:207], v[30:31], v[30:31] op_sel:[0,0,1] op_sel_hi:[1,0,1]
    v_pk_fma_f32 v[208:209], v[208:209], v[30:31], v[30:31] op_sel:[0,0,1] op_sel_hi:[1,0,1]
    v_pk_fma_f32 v[210:211], v[210:211], v[30:31], v[30:31] op_sel:[0,0,1] op_sel_hi:[1,0,1]
    v_pk_mul_f32 v[192:193], v[192:193], v[32:33]
    v_pk_mul_f32 v[194:195], v[194:195], v[34:35]
    v_pk_mul_f32 v[196:197], v[196:197], v[36:37]
    v_pk_mul_f32 v[198:199], v[198:199], v[38:39]
    v_pk_mul_f32 v[200:201], v[200:201], v[40:41]
    v_pk_mul_f32 v[202:203], v[202:203], v[42:43]
    v_pk_mul_f32 v[204:205], v[204:205], v[44:45]
    v_pk_mul_f32 v[206:207], v[206:207], v[46:47]
    v_pk_mul_f32 v[208:209], v[208:209], v[48:49]
    v_pk_mul_f32 v[210:211], v[210:211], v[50:51]
    v_exp_f32 v192, v192
    v_exp_f32 v193, v193
    buffer_load_dwordx4 a[112:115], v8, s[28:31], s37 offen offset:2048
    v_exp_f32 v194, v194
    v_exp_f32 v195, v195
    v_exp_f32 v196, v196
    v_exp_f32 v197, v197
    v_exp_f32 v198, v198
    v_exp_f32 v199, v199
    v_exp_f32 v200, v200
    v_exp_f32 v201, v201
    v_exp_f32 v202, v202
    buffer_load_dwordx4 a[116:119], v8, s[28:31], s37 offen offset:3072
    v_exp_f32 v203, v203
    v_exp_f32 v204, v204
    v_exp_f32 v205, v205
    v_exp_f32 v206, v206
    v_exp_f32 v207, v207
    v_exp_f32 v208, v208
    v_exp_f32 v209, v209
    v_exp_f32 v210, v210
    v_exp_f32 v211, v211
    s_add_u32 s37, s37, 4096
    buffer_load_dwordx4 a[120:123], v8, s[28:31], s37 offen offset:0
    v_pk_add_f32 v[192:193], v[192:193], 1.0 op_sel_hi:[1,0]
    v_pk_add_f32 v[194:195], v[194:195], 1.0 op_sel_hi:[1,0]
    v_pk_add_f32 v[196:197], v[196:197], 1.0 op_sel_hi:[1,0]
    v_pk_add_f32 v[198:199], v[198:199], 1.0 op_sel_hi:[1,0]
    v_pk_add_f32 v[200:201], v[200:201], 1.0 op_sel_hi:[1,0]
    v_pk_add_f32 v[202:203], v[202:203], 1.0 op_sel_hi:[1,0]
    v_pk_add_f32 v[204:205], v[204:205], 1.0 op_sel_hi:[1,0]
    v_pk_add_f32 v[206:207], v[206:207], 1.0 op_sel_hi:[1,0]
    v_pk_add_f32 v[208:209], v[208:209], 1.0 op_sel_hi:[1,0]
    v_pk_add_f32 v[210:211], v[210:211], 1.0 op_sel_hi:[1,0]
    v_rcp_f32 v192, v192
    v_rcp_f32 v193, v193
    v_rcp_f32 v194, v194
    v_rcp_f32 v195, v195
    buffer_load_dwordx4 a[124:127], v8, s[28:31], s37 offen offset:1024
    v_rcp_f32 v196, v196
    v_rcp_f32 v197, v197
    v_rcp_f32 v198, v198
    v_rcp_f32 v199, v199
    v_rcp_f32 v200, v200
    v_rcp_f32 v201, v201
    v_rcp_f32 v202, v202
    v_rcp_f32 v203, v203
    v_rcp_f32 v204, v204
    buffer_load_dwordx4 a[128:131], v8, s[28:31], s37 offen offset:2048
    v_rcp_f32 v205, v205
    v_rcp_f32 v206, v206
    v_rcp_f32 v207, v207
    v_rcp_f32 v208, v208
    v_rcp_f32 v209, v209
    v_rcp_f32 v210, v210
    v_rcp_f32 v211, v211
    v_pk_mul_f32 v[32:33], v[32:33], v[192:193]
    v_pk_mul_f32 v[34:35], v[34:35], v[194:195]
    v_pk_mul_f32 v[36:37], v[36:37], v[196:197]
    buffer_load_dwordx4 a[132:135], v8, s[28:31], s37 offen offset:3072
    v_pk_mul_f32 v[38:39], v[38:39], v[198:199]
    v_pk_mul_f32 v[40:41], v[40:41], v[200:201]
    v_pk_mul_f32 v[42:43], v[42:43], v[202:203]
    v_pk_mul_f32 v[44:45], v[44:45], v[204:205]
    v_pk_mul_f32 v[46:47], v[46:47], v[206:207]
    v_pk_mul_f32 v[48:49], v[48:49], v[208:209]
    v_pk_mul_f32 v[50:51], v[50:51], v[210:211]
    v_cvt_pk_bf16_f32 v180, v32, v33
    v_cvt_pk_bf16_f32 v181, v34, v35
    v_cvt_pk_bf16_f32 v182, v36, v37
    v_cvt_pk_bf16_f32 v183, v38, v39
    v_cvt_pk_bf16_f32 v184, v40, v41
    v_cvt_pk_bf16_f32 v185, v42, v43
    v_cvt_pk_bf16_f32 v186, v44, v45
    v_cvt_pk_bf16_f32 v187, v46, v47
    v_cvt_pk_bf16_f32 v188, v48, v49
    v_cvt_pk_bf16_f32 v189, v50, v51
    s_nop 1
    v_permlane16_swap_b32 v180, v182
    v_permlane16_swap_b32 v181, v183
    v_permlane16_swap_b32 v184, v186
    v_permlane16_swap_b32 v185, v187
    s_mov_b64 exec, s[60:61]
    buffer_store_dwordx4 v[180:183], v241, s[28:31], s44 offen sc1
    buffer_store_dwordx4 v[184:187], v241, s[28:31], s44 offen offset:1024 sc1
    buffer_store_dwordx2 v[188:189], v242, s[28:31], s45 offen sc1
    s_mov_b64 exec, -1
    s_waitcnt vmcnt(0)
    s_barrier
    s_cmp_lg_u32 s20, 0
    s_cbranch_scc1 chain_kernel_sig1
    v_mov_b32 v2, 1
    v_mov_b32 v7, 0
    s_mov_b64 exec, 1
    buffer_store_dword v2, v7, s[28:31], s46 offen sc1
    s_mov_b64 exec, -1
chain_kernel_sig1:
    s_add_u32 s37, s37, 4096
    buffer_load_dwordx4 a[136:139], v8, s[28:31], s37 offen offset:0
    buffer_load_dwordx4 a[140:143], v8, s[28:31], s37 offen offset:1024
    s_mul_i32 s25, s20, 10
    s_lshl_b32 s25, s25, 10
    s_add_u32 s62, s25, 0
    s_add_u32 s63, s25, s54
    s_add_u32 s63, s63, 0
    s_mov_b32 m0, s62
    buffer_load_dwordx4 v8, s[28:31], s63 offen offset:0 lds
    buffer_load_dwordx4 v8, s[28:31], s63 offen offset:1024 lds
    buffer_load_dwordx4 v8, s[28:31], s63 offen offset:2048 lds
    buffer_load_dwordx4 v8, s[28:31], s63 offen offset:3072 lds
    s_add_u32 s62, s62, 4096
    s_add_u32 s63, s63, 4096
    s_mov_b32 m0, s62
    buffer_load_dwordx4 v8, s[28:31], s63 offen offset:0 lds
    buffer_load_dwordx4 v8, s[28:31], s63 offen offset:1024 lds
    buffer_load_dwordx4 v8, s[28:31], s63 offen offset:2048 lds
    buffer_load_dwordx4 v8, s[28:31], s63 offen offset:3072 lds
    s_add_u32 s62, s62, 4096
    s_add_u32 s63, s63, 4096
    s_mov_b32 m0, s62
    buffer_load_dwordx4 v8, s[28:31], s63 offen offset:0 lds
    buffer_load_dwordx4 v8, s[28:31], s63 offen offset:1024 lds
    s_lshl_b32 s26, s53, 3
    s_lshl_b32 s27, s20, 1
    s_add_u32 s56, s26, s27
    s_mul_i32 s6, s56, 20480
    s_add_u32 s6, s6, 13406208
    s_add_u32 s7, s6, 20480
    s_lshl_b32 s26, s53, 2
    s_add_u32 s26, s26, s20
    s_lshl_b32 s26, s26, 9
    s_add_u32 s8, s26, 29413376
    v_lshlrev_b32 v228, 3, v4
    v_lshl_add_u32 v228, v3, 8, v228
    s_lshl_b32 s9, s56, 10
    s_add_u32 s9, s9, 23105536
    s_and_b32 s42, s52, 1
    s_mul_i32 s12, s52, 7
    s_add_u32 s13, s12, 1
    s_lshr_b32 s13, s13, 1
    s_add_u32 s26, s13, 3
    s_sub_u32 s27, s13, 1
    s_cmp_eq_u32 s42, 1
    s_cselect_b32 s12, s27, s26
    s_lshl_b32 s13, s13, 10
    s_add_u32 s13, s13, 16027648
    s_lshl_b32 s12, s12, 10
    s_add_u32 s12, s12, 16027648
    s_lshl_b32 s14, s56, 4
    s_lshl_b32 s15, s53, 4
    s_add_u32 s15, s15, s52
    s_lshl_b32 s15, s15, 2
    s_add_u32 s15, s15, s20
    s_lshl_b32 s15, s15, 7
    s_add_u32 s15, s15, 29446144
    s_lshr_b32 s26, s43, 4
    s_lshl_b32 s26, s26, 3
    s_lshl_b32 s27, s24, 1
    s_add_u32 s26, s26, s27
    s_add_u32 s26, s26, s21
    s_lshl_b32 s26, s26, 7
    s_add_u32 s19, s26, 23105536
    v_add_u32 v226, s14, v4
    v_lshrrev_b32 v227, 4, v226
    v_and_b32 v226, 15, v226
    s_mov_b32 s27, 55296
    v_mul_lo_u32 v227, v227, s27
    v_lshl_add_u32 v227, v226, 4, v227
    v_and_b32 v226, 1, v3
    v_lshlrev_b32 v226, 9, v226
    v_lshrrev_b32 v2, 1, v3
    v_lshl_add_u32 v226, v2, 8, v226
    v_add_u32 v226, v226, v227
    s_lshl_b32 s27, s42, 9
    v_lshl_add_u32 v227, v2, 8, v227
    v_add_u32 v227, s27, v227
    v_and_b32 v2, 1, v3
    v_lshl_add_u32 v227, v2, 3, v227
    s_mov_b32 s48, 29380608
    s_mov_b32 s47, 0
    s_mov_b64 exec, 15
chain_kernel_poll2:
    buffer_load_dword v2, v245, s[28:31], s48 offen sc1
    s_add_u32 s47, s47, 1
    s_waitcnt vmcnt(0)
    v_cmp_ne_u32 vcc, 1, v2
    s_cmp_ge_u32 s47, 200000
    s_cbranch_scc1 chain_kernel_polld3
    s_cbranch_vccnz chain_kernel_poll2
chain_kernel_polld3:
    s_mov_b64 exec, -1
    buffer_load_dwordx4 v[72:75], v8, s[28:31], s50 offen offset:0 sc1
    buffer_load_dwordx4 v[76:79], v8, s[28:31], s51 offen offset:0 sc1
    buffer_load_dwordx4 v[80:83], v8, s[28:31], s50 offen offset:1024 sc1
    buffer_load_dwordx4 v[84:87], v8, s[28:31], s51 offen offset:1024 sc1
    buffer_load_dwordx4 v[88:91], v8, s[28:31], s50 offen offset:2048 sc1
    buffer_load_dwordx4 v[92:95], v8, s[28:31], s51 offen offset:2048 sc1
    buffer_load_dwordx4 v[96:99], v8, s[28:31], s50 offen offset:3072 sc1
    buffer_load_dwordx4 v[100:103], v8, s[28:31], s51 offen offset:3072 sc1
    s_add_u32 s50, s50, 4096
    s_add_u32 s51, s51, 4096
    buffer_load_dwordx4 v[104:107], v8, s[28:31], s50 offen offset:0 sc1
    buffer_load_dwordx4 v[108:111], v8, s[28:31], s51 offen offset:0 sc1
    s_waitcnt vmcnt(8)
    v_mfma_f32_16x16x32_bf16 v[32:35], a[200:203], v[72:75], 0
    v_mfma_f32_16x16x32_bf16 v[52:55], a[200:203], v[76:79], 0
    buffer_load_dwordx4 v[112:115], v8, s[28:31], s50 offen offset:1024 sc1
    v_mfma_f32_16x16x32_bf16 v[36:39], a[204:207], v[72:75], 0
    v_mfma_f32_16x16x32_bf16 v[56:59], a[204:207], v[76:79], 0
    v_mfma_f32_16x16x32_bf16 v[40:43], a[208:211], v[72:75], 0
    v_mfma_f32_16x16x32_bf16 v[60:63], a[208:211], v[76:79], 0
    buffer_load_dwordx4 v[116:119], v8, s[28:31], s51 offen offset:1024 sc1
    v_mfma_f32_16x16x32_bf16 v[44:47], a[212:215], v[72:75], 0
    v_mfma_f32_16x16x32_bf16 v[64:67], a[212:215], v[76:79], 0
    v_mfma_f32_16x16x32_bf16 v[48:51], a[216:219], v[72:75], 0
    v_mfma_f32_16x16x32_bf16 v[68:71], a[216:219], v[76:79], 0
    s_waitcnt vmcnt(8)
    v_mfma_f32_16x16x32_bf16 v[32:35], a[220:223], v[80:83], v[32:35]
    v_mfma_f32_16x16x32_bf16 v[52:55], a[220:223], v[84:87], v[52:55]
    buffer_load_dwordx4 v[120:123], v8, s[28:31], s50 offen offset:2048 sc1
    v_mfma_f32_16x16x32_bf16 v[36:39], a[224:227], v[80:83], v[36:39]
    v_mfma_f32_16x16x32_bf16 v[56:59], a[224:227], v[84:87], v[56:59]
    v_mfma_f32_16x16x32_bf16 v[40:43], a[228:231], v[80:83], v[40:43]
    v_mfma_f32_16x16x32_bf16 v[60:63], a[228:231], v[84:87], v[60:63]
    buffer_load_dwordx4 v[124:127], v8, s[28:31], s51 offen offset:2048 sc1
    v_mfma_f32_16x16x32_bf16 v[44:47], a[232:235], v[80:83], v[44:47]
    v_mfma_f32_16x16x32_bf16 v[64:67], a[232:235], v[84:87], v[64:67]
    v_mfma_f32_16x16x32_bf16 v[48:51], a[236:239], v[80:83], v[48:51]
    v_mfma_f32_16x16x32_bf16 v[68:71], a[236:239], v[84:87], v[68:71]
    s_waitcnt vmcnt(8)
    v_mfma_f32_16x16x32_bf16 v[32:35], a[240:243], v[88:91], v[32:35]
    v_mfma_f32_16x16x32_bf16 v[52:55], a[240:243], v[92:95], v[52:55]
    buffer_load_dwordx4 v[128:131], v8, s[28:31], s50 offen offset:3072 sc1
    v_mfma_f32_16x16x32_bf16 v[36:39], a[244:247], v[88:91], v[36:39]
    v_mfma_f32_16x16x32_bf16 v[56:59], a[244:247], v[92:95], v[56:59]
    v_mfma_f32_16x16x32_bf16 v[40:43], a[248:251], v[88:91], v[40:43]
    v_mfma_f32_16x16x32_bf16 v[60:63], a[248:251], v[92:95], v[60:63]
    buffer_load_dwordx4 v[132:135], v8, s[28:31], s51 offen offset:3072 sc1
    v_mfma_f32_16x16x32_bf16 v[44:47], a[252:255], v[88:91], v[44:47]
    v_mfma_f32_16x16x32_bf16 v[64:67], a[252:255], v[92:95], v[64:67]
    v_mfma_f32_16x16x32_bf16 v[48:51], a[0:3], v[88:91], v[48:51]
    v_mfma_f32_16x16x32_bf16 v[68:71], a[0:3], v[92:95], v[68:71]
    s_waitcnt vmcnt(8)
    v_mfma_f32_16x16x32_bf16 v[32:35], a[4:7], v[96:99], v[32:35]
    v_mfma_f32_16x16x32_bf16 v[52:55], a[4:7], v[100:103], v[52:55]
    s_add_u32 s50, s50, 4096
    s_add_u32 s51, s51, 4096
    buffer_load_dwordx4 v[136:139], v8, s[28:31], s50 offen offset:0 sc1
    v_mfma_f32_16x16x32_bf16 v[36:39], a[8:11], v[96:99], v[36:39]
    v_mfma_f32_16x16x32_bf16 v[56:59], a[8:11], v[100:103], v[56:59]
    v_mfma_f32_16x16x32_bf16 v[40:43], a[12:15], v[96:99], v[40:43]
    v_mfma_f32_16x16x32_bf16 v[60:63], a[12:15], v[100:103], v[60:63]
    buffer_load_dwordx4 v[140:143], v8, s[28:31], s51 offen offset:0 sc1
    v_mfma_f32_16x16x32_bf16 v[44:47], a[16:19], v[96:99], v[44:47]
    v_mfma_f32_16x16x32_bf16 v[64:67], a[16:19], v[100:103], v[64:67]
    v_mfma_f32_16x16x32_bf16 v[48:51], a[20:23], v[96:99], v[48:51]
    v_mfma_f32_16x16x32_bf16 v[68:71], a[20:23], v[100:103], v[68:71]
    s_waitcnt vmcnt(8)
    v_mfma_f32_16x16x32_bf16 v[32:35], a[24:27], v[104:107], v[32:35]
    v_mfma_f32_16x16x32_bf16 v[52:55], a[24:27], v[108:111], v[52:55]
    buffer_load_dwordx4 v[144:147], v8, s[28:31], s50 offen offset:1024 sc1
    v_mfma_f32_16x16x32_bf16 v[36:39], a[28:31], v[104:107], v[36:39]
    v_mfma_f32_16x16x32_bf16 v[56:59], a[28:31], v[108:111], v[56:59]
    v_mfma_f32_16x16x32_bf16 v[40:43], a[32:35], v[104:107], v[40:43]
    v_mfma_f32_16x16x32_bf16 v[60:63], a[32:35], v[108:111], v[60:63]
    buffer_load_dwordx4 v[148:151], v8, s[28:31], s51 offen offset:1024 sc1
    v_mfma_f32_16x16x32_bf16 v[44:47], a[36:39], v[104:107], v[44:47]
    v_mfma_f32_16x16x32_bf16 v[64:67], a[36:39], v[108:111], v[64:67]
    s_mul_i32 s25, s20, 20
    s_lshl_b32 s25, s25, 10
    s_add_u32 s62, s25, 40960
    s_add_u32 s63, s25, s54
    s_add_u32 s63, s63, 40960
    s_mov_b32 m0, s62
    buffer_load_dwordx4 v8, s[28:31], s63 offen offset:0 lds
    v_mfma_f32_16x16x32_bf16 v[48:51], a[40:43], v[104:107], v[48:51]
    v_mfma_f32_16x16x32_bf16 v[68:71], a[40:43], v[108:111], v[68:71]
    s_waitcnt vmcnt(9)
    v_mfma_f32_16x16x32_bf16 v[32:35], a[44:47], v[112:115], v[32:35]
    v_mfma_f32_16x16x32_bf16 v[52:55], a[44:47], v[116:119], v[52:55]
    buffer_load_dwordx4 v8, s[28:31], s63 offen offset:1024 lds
    v_mfma_f32_16x16x32_bf16 v[36:39], a[48:51], v[112:115], v[36:39]
    v_mfma_f32_16x16x32_bf16 v[56:59], a[48:51], v[116:119], v[56:59]
    buffer_load_dwordx4 v8, s[28:31], s63 offen offset:2048 lds
    v_mfma_f32_16x16x32_bf16 v[40:43], a[52:55], v[112:115], v[40:43]
    v_mfma_f32_16x16x32_bf16 v[60:63], a[52:55], v[116:119], v[60:63]
    v_mfma_f32_16x16x32_bf16 v[44:47], a[56:59], v[112:115], v[44:47]
    v_mfma_f32_16x16x32_bf16 v[64:67], a[56:59], v[116:119], v[64:67]
    buffer_load_dwordx4 v8, s[28:31], s63 offen offset:3072 lds
    v_mfma_f32_16x16x32_bf16 v[48:51], a[60:63], v[112:115], v[48:51]
    v_mfma_f32_16x16x32_bf16 v[68:71], a[60:63], v[116:119], v[68:71]
    s_waitcnt vmcnt(10)
    v_mfma_f32_16x16x32_bf16 v[32:35], a[64:67], v[120:123], v[32:35]
    v_mfma_f32_16x16x32_bf16 v[52:55], a[64:67], v[124:127], v[52:55]
    s_add_u32 s62, s62, 4096
    s_add_u32 s63, s63, 4096
    s_mov_b32 m0, s62
    buffer_load_dwordx4 v8, s[28:31], s63 offen offset:0 lds
    v_mfma_f32_16x16x32_bf16 v[36:39], a[68:71], v[120:123], v[36:39]
    v_mfma_f32_16x16x32_bf16 v[56:59], a[68:71], v[124:127], v[56:59]
    buffer_load_dwordx4 v8, s[28:31], s63 offen offset:1024 lds
    v_mfma_f32_16x16x32_bf16 v[40:43], a[72:75], v[120:123], v[40:43]
    v_mfma_f32_16x16x32_bf16 v[60:63], a[72:75], v[124:127], v[60:63]
    v_mfma_f32_16x16x32_bf16 v[44:47], a[76:79], v[120:123], v[44:47]
    v_mfma_f32_16x16x32_bf16 v[64:67], a[76:79], v[124:127], v[64:67]
    buffer_load_dwordx4 v8, s[28:31], s63 offen offset:2048 lds
    v_mfma_f32_16x16x32_bf16 v[48:51], a[80:83], v[120:123], v[48:51]
    v_mfma_f32_16x16x32_bf16 v[68:71], a[80:83], v[124:127], v[68:71]
    s_waitcnt vmcnt(11)
    v_mfma_f32_16x16x32_bf16 v[32:35], a[84:87], v[128:131], v[32:35]
    v_mfma_f32_16x16x32_bf16 v[52:55], a[84:87], v[132:135], v[52:55]
    buffer_load_dwordx4 v8, s[28:31], s63 offen offset:3072 lds
    v_mfma_f32_16x16x32_bf16 v[36:39], a[88:91], v[128:131], v[36:39]
    v_mfma_f32_16x16x32_bf16 v[56:59], a[88:91], v[132:135], v[56:59]
    s_add_u32 s62, s62, 4096
    s_add_u32 s63, s63, 4096
    s_mov_b32 m0, s62
    buffer_load_dwordx4 v8, s[28:31], s63 offen offset:0 lds
    v_mfma_f32_16x16x32_bf16 v[40:43], a[92:95], v[128:131], v[40:43]
    v_mfma_f32_16x16x32_bf16 v[60:63], a[92:95], v[132:135], v[60:63]
    v_mfma_f32_16x16x32_bf16 v[44:47], a[96:99], v[128:131], v[44:47]
    v_mfma_f32_16x16x32_bf16 v[64:67], a[96:99], v[132:135], v[64:67]
    buffer_load_dwordx4 v8, s[28:31], s63 offen offset:1024 lds
    v_mfma_f32_16x16x32_bf16 v[48:51], a[100:103], v[128:131], v[48:51]
    v_mfma_f32_16x16x32_bf16 v[68:71], a[100:103], v[132:135], v[68:71]
    s_waitcnt vmcnt(12)
    v_mfma_f32_16x16x32_bf16 v[32:35], a[104:107], v[136:139], v[32:35]
    v_mfma_f32_16x16x32_bf16 v[52:55], a[104:107], v[140:143], v[52:55]
    buffer_load_dwordx4 v8, s[28:31], s63 offen offset:2048 lds
    v_mfma_f32_16x16x32_bf16 v[36:39], a[108:111], v[136:139], v[36:39]
    v_mfma_f32_16x16x32_bf16 v[56:59], a[108:111], v[140:143], v[56:59]
    buffer_load_dwordx4 v8, s[28:31], s63 offen offset:3072 lds
    v_mfma_f32_16x16x32_bf16 v[40:43], a[112:115], v[136:139], v[40:43]
    v_mfma_f32_16x16x32_bf16 v[60:63], a[112:115], v[140:143], v[60:63]
    v_mfma_f32_16x16x32_bf16 v[44:47], a[116:119], v[136:139], v[44:47]
    v_mfma_f32_16x16x32_bf16 v[64:67], a[116:119], v[140:143], v[64:67]
    s_add_u32 s62, s62, 4096
    s_add_u32 s63, s63, 4096
    s_mov_b32 m0, s62
    buffer_load_dwordx4 v8, s[28:31], s63 offen offset:0 lds
    v_mfma_f32_16x16x32_bf16 v[48:51], a[120:123], v[136:139], v[48:51]
    v_mfma_f32_16x16x32_bf16 v[68:71], a[120:123], v[140:143], v[68:71]
    s_waitcnt vmcnt(13)
    v_mfma_f32_16x16x32_bf16 v[32:35], a[124:127], v[144:147], v[32:35]
    v_mfma_f32_16x16x32_bf16 v[52:55], a[124:127], v[148:151], v[52:55]
    buffer_load_dwordx4 v8, s[28:31], s63 offen offset:1024 lds
    v_mfma_f32_16x16x32_bf16 v[36:39], a[128:131], v[144:147], v[36:39]
    v_mfma_f32_16x16x32_bf16 v[56:59], a[128:131], v[148:151], v[56:59]
    buffer_load_dwordx4 v8, s[28:31], s63 offen offset:2048 lds
    v_mfma_f32_16x16x32_bf16 v[40:43], a[132:135], v[144:147], v[40:43]
    v_mfma_f32_16x16x32_bf16 v[60:63], a[132:135], v[148:151], v[60:63]
    v_mfma_f32_16x16x32_bf16 v[44:47], a[136:139], v[144:147], v[44:47]
    v_mfma_f32_16x16x32_bf16 v[64:67], a[136:139], v[148:151], v[64:67]
    buffer_load_dwordx4 v8, s[28:31], s63 offen offset:3072 lds
    v_mfma_f32_16x16x32_bf16 v[48:51], a[140:143], v[144:147], v[48:51]
    v_mfma_f32_16x16x32_bf16 v[68:71], a[140:143], v[148:151], v[68:71]
    s_nop 4
    ds_write_b128 v246, v[52:55] offset:0
    ds_write_b128 v246, v[56:59] offset:1024
    ds_write_b128 v246, v[60:63] offset:2048
    ds_write_b128 v246, v[64:67] offset:3072
    ds_write_b128 v246, v[68:71] offset:4096
    v_lshlrev_b32 v112, 16, v16
    v_and_b32 v113, 0xffff0000, v16
    v_lshlrev_b32 v114, 16, v17
    v_and_b32 v115, 0xffff0000, v17
    v_lshlrev_b32 v116, 16, v18
    v_and_b32 v117, 0xffff0000, v18
    v_lshlrev_b32 v118, 16, v19
    v_and_b32 v119, 0xffff0000, v19
    v_lshlrev_b32 v120, 16, v20
    v_and_b32 v121, 0xffff0000, v20
    v_lshlrev_b32 v122, 16, v21
    v_and_b32 v123, 0xffff0000, v21
    v_lshlrev_b32 v124, 16, v22
    v_and_b32 v125, 0xffff0000, v22
    v_lshlrev_b32 v126, 16, v23
    v_and_b32 v127, 0xffff0000, v23
    v_lshlrev_b32 v128, 16, v24
    v_and_b32 v129, 0xffff0000, v24
    v_lshlrev_b32 v130, 16, v25
    v_and_b32 v131, 0xffff0000, v25
    v_pk_add_f32 v[32:33], v[32:33], v[112:113]
    v_pk_add_f32 v[34:35], v[34:35], v[114:115]
    v_pk_add_f32 v[36:37], v[36:37], v[116:117]
    v_pk_add_f32 v[38:39], v[38:39], v[118:119]
    v_pk_add_f32 v[40:41], v[40:41], v[120:121]
    v_pk_add_f32 v[42:43], v[42:43], v[122:123]
    v_pk_add_f32 v[44:45], v[44:45], v[124:125]
    v_pk_add_f32 v[46:47], v[46:47], v[126:127]
    v_pk_add_f32 v[48:49], v[48:49], v[128:129]
    v_pk_add_f32 v[50:51], v[50:51], v[130:131]
    v_mov_b32 v28, 0
    v_mov_b32 v29, 0
    s_add_u32 s62, s62, 4096
    s_add_u32 s63, s63, 4096
    s_mov_b32 m0, s62
    buffer_load_dwordx4 v8, s[28:31], s63 offen offset:0 lds
    buffer_load_dwordx4 v8, s[28:31], s63 offen offset:1024 lds
    buffer_load_dwordx4 v8, s[28:31], s63 offen offset:2048 lds
    buffer_load_dwordx4 v8, s[28:31], s63 offen offset:3072 lds
    s_mul_i32 s25, s20, 5
    s_lshl_b32 s25, s25, 10
    s_add_u32 s62, s25, 122880
    s_add_u32 s63, s25, s54
    s_add_u32 s63, s63, 122880
    s_mov_b32 m0, s62
    buffer_load_dwordx4 v8, s[28:31], s63 offen offset:0 lds
    buffer_load_dwordx4 v8, s[28:31], s63 offen offset:1024 lds
    buffer_load_dwordx4 v8, s[28:31], s63 offen offset:2048 lds
    buffer_load_dwordx4 v8, s[28:31], s63 offen offset:3072 lds
    s_add_u32 s62, s62, 4096
    s_add_u32 s63, s63, 4096
    s_mov_b32 m0, s62
    buffer_load_dwordx4 v8, s[28:31], s63 offen offset:0 lds
    s_waitcnt lgkmcnt(0)
    s_barrier
    ds_read_b128 v[88:91], v247 offset:0
    ds_read_b128 v[92:95], v247 offset:1024
    ds_read_b128 v[96:99], v247 offset:2048
    ds_read_b128 v[100:103], v247 offset:3072
    ds_read_b128 v[104:107], v247 offset:4096
    s_waitcnt lgkmcnt(4)
    v_pk_add_f32 v[32:33], v[32:33], v[88:89]
    v_pk_add_f32 v[34:35], v[34:35], v[90:91]
    v_cvt_pk_bf16_f32 v180, v32, v33
    v_cvt_pk_bf16_f32 v181, v34, v35
    s_waitcnt lgkmcnt(3)
    v_pk_add_f32 v[36:37], v[36:37], v[92:93]
    v_pk_add_f32 v[38:39], v[38:39], v[94:95]
    v_cvt_pk_bf16_f32 v182, v36, v37
    v_cvt_pk_bf16_f32 v183, v38, v39
    s_waitcnt lgkmcnt(2)
    v_pk_add_f32 v[40:41], v[40:41], v[96:97]
    v_pk_add_f32 v[42:43], v[42:43], v[98:99]
    v_cvt_pk_bf16_f32 v184, v40, v41
    v_cvt_pk_bf16_f32 v185, v42, v43
    s_waitcnt lgkmcnt(1)
    v_pk_add_f32 v[44:45], v[44:45], v[100:101]
    v_pk_add_f32 v[46:47], v[46:47], v[102:103]
    v_cvt_pk_bf16_f32 v186, v44, v45
    v_cvt_pk_bf16_f32 v187, v46, v47
    s_waitcnt lgkmcnt(0)
    v_pk_add_f32 v[48:49], v[48:49], v[104:105]
    v_pk_add_f32 v[50:51], v[50:51], v[106:107]
    v_cvt_pk_bf16_f32 v188, v48, v49
    v_cvt_pk_bf16_f32 v189, v50, v51
    v_dot2_f32_bf16 v28, v180, v224, v28
    v_dot2_f32_bf16 v29, v180, v180, v29
    v_dot2_f32_bf16 v28, v181, v224, v28
    v_dot2_f32_bf16 v29, v181, v181, v29
    v_dot2_f32_bf16 v28, v182, v224, v28
    v_dot2_f32_bf16 v29, v182, v182, v29
    v_dot2_f32_bf16 v28, v183, v224, v28
    v_dot2_f32_bf16 v29, v183, v183, v29
    v_dot2_f32_bf16 v28, v184, v224, v28
    v_dot2_f32_bf16 v29, v184, v184, v29
    v_dot2_f32_bf16 v28, v185, v224, v28
    v_dot2_f32_bf16 v29, v185, v185, v29
    v_dot2_f32_bf16 v28, v186, v224, v28
    v_dot2_f32_bf16 v29, v186, v186, v29
    v_dot2_f32_bf16 v28, v187, v224, v28
    v_dot2_f32_bf16 v29, v187, v187, v29
    v_dot2_f32_bf16 v28, v188, v224, v28
    v_dot2_f32_bf16 v29, v188, v188, v29
    v_dot2_f32_bf16 v28, v189, v224, v28
    v_dot2_f32_bf16 v29, v189, v189, v29
    s_nop 1
    v_permlane16_swap_b32 v180, v182
    v_permlane16_swap_b32 v181, v183
    v_permlane16_swap_b32 v184, v186
    v_permlane16_swap_b32 v185, v187
    buffer_store_dwordx4 v[180:183], v243, s[28:31], s38 offen sc1
    buffer_store_dwordx4 v[184:187], v243, s[28:31], s38 offen offset:1024 sc1
    buffer_store_dwordx2 v[188:189], v244, s[28:31], s39 offen sc1
    v_mov_b32 v160, v28
    v_mov_b32 v161, v29
    s_nop 1
    v_permlane32_swap_b32 v160, v28
    v_permlane32_swap_b32 v161, v29
    s_nop 1
    v_add_f32 v28, v28, v160
    v_add_f32 v29, v29, v161
    v_mov_b32 v160, v28
    v_mov_b32 v161, v29
    s_nop 1
    v_permlane16_swap_b32 v160, v28
    v_permlane16_swap_b32 v161, v29
    s_nop 1
    v_add_f32 v28, v28, v160
    v_add_f32 v29, v29, v161
    v_lshlrev_b32 v2, 3, v4
    s_mov_b64 exec, 0xffff
    buffer_store_dwordx2 v[28:29], v2, s[28:31], s19 offen sc1
    s_mov_b64 exec, -1
    s_waitcnt vmcnt(0)
    s_barrier
    s_cmp_lg_u32 s20, 0
    s_cbranch_scc1 chain_kernel_sig4
    v_mov_b32 v2, 1
    v_mov_b32 v7, 0
    s_mov_b64 exec, 1
    buffer_store_dword v2, v7, s[28:31], s49 offen sc1
    s_mov_b64 exec, -1
chain_kernel_sig4:
    v_and_b32 v2, 31, v1
    v_lshlrev_b32 v2, 4, v2
    v_lshrrev_b32 v7, 5, v1
    v_mul_u32_u24 v7, 7168, v7
    v_add_u32 v2, v2, v7
    s_mul_i32 s26, s52, 448
    s_add_u32 s26, s26, 8130560
    s_mov_b32 m0, 162816
    s_nop 0
    buffer_load_dwordx4 v2, s[28:31], s26 offen lds
    s_and_b32 s36, s57, 1
    s_lshl_b32 s43, s58, 6
    s_lshl_b32 s26, s21, 5
    s_add_u32 s43, s43, s26
    s_lshl_b32 s26, s22, 4
    s_add_u32 s43, s43, s26
    s_mul_i32 s40, s57, 5
    s_add_u32 s41, s40, 1
    s_lshr_b32 s41, s41, 1
    s_add_u32 s26, s41, 2
    s_sub_u32 s27, s41, 1
    s_cmp_eq_u32 s36, 1
    s_cselect_b32 s40, s27, s26
    s_lshl_b32 s44, s41, 10
    s_lshl_b32 s45, s40, 10
    s_lshl_b32 s26, s36, 9
    s_add_u32 s45, s45, s26
    s_lshr_b32 s26, s58, 1
    s_lshl_b32 s26, s26, 4
    s_mul_i32 s27, s22, 7
    s_add_u32 s26, s26, s27
    s_lshl_b32 s26, s26, 2
    s_and_b32 s27, s58, 1
    s_lshl_b32 s27, s27, 1
    s_add_u32 s26, s26, s27
    s_add_u32 s26, s26, s21
    s_lshl_b32 s26, s26, 7
    s_add_u32 s48, s26, 29446144
    v_lshlrev_b32 v234, 9, v1
    s_lshl_b32 s26, s58, 2
    s_lshl_b32 s27, s21, 1
    s_add_u32 s26, s26, s27
    s_add_u32 s27, s26, s22
    s_mul_i32 s27, s27, 54
    s_mul_i32 s39, s22, 27
    s_add_u32 s27, s27, s39
    s_lshl_b32 s27, s27, 10
    s_add_u32 s50, s27, 16027648
    s_add_u32 s27, s26, 1
    s_sub_u32 s27, s27, s22
    s_mul_i32 s27, s27, 54
    s_add_u32 s27, s27, s39
    s_lshl_b32 s27, s27, 10
    s_add_u32 s51, s27, 16027648
    v_add_u32 v9, s43, v4
    v_lshrrev_b32 v11, 4, v9
    v_and_b32 v10, 15, v9
    v_mul_u32_u24 v11, 20480, v11
    v_lshl_add_u32 v11, v10, 4, v11
    v_lshrrev_b32 v2, 1, v3
    v_lshl_add_u32 v11, v2, 8, v11
    v_and_b32 v7, 1, v3
    v_lshl_add_u32 v230, v7, 3, v11
    v_mul_u32_u24 v9, 1280, v9
    v_lshlrev_b32 v7, 5, v7
    v_lshl_add_u32 v7, v2, 4, v7
    v_add_u32 v231, v9, v7
    v_lshl_add_u32 v232, v3, 3, v9
    v_lshlrev_b32 v233, 4, v3
    v_add_u32 v9, s43, v4
    v_lshrrev_b32 v10, 4, v9
    v_mul_u32_u24 v10, 20480, v10
    v_and_b32 v11, 1, v9
    v_lshl_add_u32 v10, v11, 3, v10
    v_lshl_add_u32 v10, v3, 7, v10
    v_bfe_u32 v11, v9, 1, 3
    s_mul_i32 s26, s57, 20
    s_lshl_b32 s27, s36, 2
    s_add_u32 s27, s27, s26
    s_mul_i32 s3, s36, 16
    s_sub_u32 s3, 16, s3
    s_add_u32 s3, s3, s26
    s_add_u32 s4, s27, 0
    v_add_u32 v2, s4, v3
    v_bfe_u32 v2, v2, 1, 3
    v_xor_b32 v2, v2, v11
    v_lshl_add_u32 v2, v2, 4, v10
    s_lshl_b32 s4, s4, 7
    v_add_u32 v235, s4, v2
    s_add_u32 s4, s27, 4
    v_add_u32 v2, s4, v3
    v_bfe_u32 v2, v2, 1, 3
    v_xor_b32 v2, v2, v11
    v_lshl_add_u32 v2, v2, 4, v10
    s_lshl_b32 s4, s4, 7
    v_add_u32 v236, s4, v2
    s_add_u32 s4, s27, 8
    v_add_u32 v2, s4, v3
    v_bfe_u32 v2, v2, 1, 3
    v_xor_b32 v2, v2, v11
    v_lshl_add_u32 v2, v2, 4, v10
    s_lshl_b32 s4, s4, 7
    v_add_u32 v237, s4, v2
    s_add_u32 s4, s27, 12
    v_add_u32 v2, s4, v3
    v_bfe_u32 v2, v2, 1, 3
    v_xor_b32 v2, v2, v11
    v_lshl_add_u32 v2, v2, 4, v10
    s_lshl_b32 s4, s4, 7
    v_add_u32 v238, s4, v2
    s_mov_b32 s4, s3
    v_add_u32 v2, s4, v3
    v_bfe_u32 v2, v2, 1, 3
    v_xor_b32 v2, v2, v11
    v_lshl_add_u32 v2, v2, 4, v10
    s_lshl_b32 s4, s4, 7
    v_add_u32 v239, s4, v2
    s_mul_i32 s37, s57, 320
    s_add_u32 s37, s37, 8126976
    s_mul_i32 s26, s36, 256
    s_sub_u32 s26, 256, s26
    s_add_u32 s38, s37, s26
    s_lshl_b32 s26, s36, 6
    s_add_u32 s37, s37, s26
    s_mul_i32 s26, s57, 160
    s_lshl_b32 s27, s36, 5
    s_add_u32 s46, s26, s27
    s_mul_i32 s27, s36, 128
    s_sub_u32 s27, 128, s27
    s_add_u32 s49, s26, s27
    s_waitcnt vmcnt(0)
    s_lshl_b32 s26, s42, 6
    v_lshlrev_b32 v2, 4, v3
    v_add_u32 v7, 162816, v2
    v_add_u32 v2, s26, v7
    s_mul_i32 s26, s42, 384
    s_sub_u32 s26, 384, s26
    v_add_u32 v7, s26, v7
    ds_read_b128 v[88:91], v2 offset:0
    ds_read_b128 v[116:119], v2 offset:512
    ds_read_b128 v[92:95], v2 offset:64
    ds_read_b128 v[120:123], v2 offset:576
    ds_read_b128 v[96:99], v2 offset:128
    ds_read_b128 v[124:127], v2 offset:640
    ds_read_b128 v[100:103], v2 offset:192
    ds_read_b128 v[128:131], v2 offset:704
    ds_read_b128 v[104:107], v2 offset:256
    ds_read_b128 v[132:135], v2 offset:768
    ds_read_b128 v[108:111], v2 offset:320
    ds_read_b128 v[136:139], v2 offset:832
    ds_read_b128 v[112:115], v7
    ds_read_b128 v[140:143], v7 offset:512
    s_waitcnt lgkmcnt(0)
    v_pk_add_f32 v[88:89], v[88:89], v[116:117]
    v_pk_add_f32 v[90:91], v[90:91], v[118:119]
    v_pk_add_f32 v[92:93], v[92:93], v[120:121]
    v_pk_add_f32 v[94:95], v[94:95], v[122:123]
    v_pk_add_f32 v[96:97], v[96:97], v[124:125]
    v_pk_add_f32 v[98:99], v[98:99], v[126:127]
    v_pk_add_f32 v[100:101], v[100:101], v[128:129]
    v_pk_add_f32 v[102:103], v[102:103], v[130:131]
    v_pk_add_f32 v[104:105], v[104:105], v[132:133]
    v_pk_add_f32 v[106:107], v[106:107], v[134:135]
    v_pk_add_f32 v[108:109], v[108:109], v[136:137]
    v_pk_add_f32 v[110:111], v[110:111], v[138:139]
    v_pk_add_f32 v[112:113], v[112:113], v[140:141]
    v_pk_add_f32 v[114:115], v[114:115], v[142:143]
    v_mov_b32 v12, v8
    v_add_u32 v13, 0x10000, v8
    v_add_u32 v14, 0x20000, v8
    ds_read_b128 a[160:163], v12 offset:0
    ds_read_b128 a[164:167], v12 offset:1024
    ds_read_b128 a[168:171], v12 offset:2048
    ds_read_b128 a[172:175], v12 offset:3072
    ds_read_b128 a[176:179], v13 offset:57344
    ds_read_b128 a[180:183], v12 offset:4096
    ds_read_b128 a[184:187], v12 offset:5120
    ds_read_b128 a[188:191], v12 offset:6144
    ds_read_b128 a[192:195], v12 offset:7168
    ds_read_b128 a[196:199], v13 offset:58368
    ds_read_b128 a[200:203], v12 offset:8192
    v_lshlrev_b32 v7, 7, v1
    s_mov_b32 s47, 0
    s_mov_b64 exec, 15
chain_kernel_poll5:
    buffer_load_dword v2, v7, s[28:31], s8 offen sc1
    s_add_u32 s47, s47, 1
    s_waitcnt vmcnt(0)
    v_cmp_ne_u32 vcc, 1, v2
    s_cmp_ge_u32 s47, 200000
    s_cbranch_scc1 chain_kernel_polld6
    s_cbranch_vccnz chain_kernel_poll5
chain_kernel_polld6:
    s_mov_b64 exec, -1
    buffer_load_dwordx4 a[0:3], v8, s[28:31], s6 offen offset:0 sc1
    buffer_load_dwordx4 a[4:7], v8, s[28:31], s7 offen offset:0 sc1
    buffer_load_dwordx4 a[8:11], v8, s[28:31], s6 offen offset:1024 sc1
    buffer_load_dwordx4 a[12:15], v8, s[28:31], s7 offen offset:1024 sc1
    buffer_load_dwordx4 a[16:19], v8, s[28:31], s6 offen offset:2048 sc1
    buffer_load_dwordx4 a[20:23], v8, s[28:31], s7 offen offset:2048 sc1
    buffer_load_dwordx4 a[24:27], v8, s[28:31], s6 offen offset:3072 sc1
    buffer_load_dwordx4 a[28:31], v8, s[28:31], s7 offen offset:3072 sc1
    s_add_u32 s6, s6, 4096
    s_add_u32 s7, s7, 4096
    buffer_load_dwordx4 a[32:35], v8, s[28:31], s6 offen offset:0 sc1
    buffer_load_dwordx4 a[36:39], v8, s[28:31], s7 offen offset:0 sc1
    s_waitcnt vmcnt(8) lgkmcnt(6)
    v_mfma_f32_16x16x32_bf16 v[32:35], a[160:163], a[0:3], 0
    v_mfma_f32_16x16x32_bf16 v[60:63], a[160:163], a[4:7], 0
    ds_read_b128 a[204:207], v12 offset:9216
    buffer_load_dwordx4 a[40:43], v8, s[28:31], s6 offen offset:1024 sc1
    v_mfma_f32_16x16x32_bf16 v[36:39], a[164:167], a[0:3], 0
    v_mfma_f32_16x16x32_bf16 v[64:67], a[164:167], a[4:7], 0
    ds_read_b128 a[160:163], v12 offset:10240
    v_mfma_f32_16x16x32_bf16 v[40:43], a[168:171], a[0:3], 0
    v_mfma_f32_16x16x32_bf16 v[68:71], a[168:171], a[4:7], 0
    ds_read_b128 a[164:167], v12 offset:11264
    buffer_load_dwordx4 a[44:47], v8, s[28:31], s7 offen offset:1024 sc1
    v_mfma_f32_16x16x32_bf16 v[44:47], a[172:175], a[0:3], 0
    v_mfma_f32_16x16x32_bf16 v[72:75], a[172:175], a[4:7], 0
    ds_read_b128 a[168:171], v13 offset:59392
    v_mfma_f32_16x16x32_bf16 v[56:59], a[176:179], a[0:3], 0
    v_mfma_f32_16x16x32_bf16 v[84:87], a[176:179], a[4:7], 0
    ds_read_b128 a[172:175], v12 offset:12288
    s_waitcnt vmcnt(8) lgkmcnt(6)
    v_mfma_f32_16x16x32_bf16 v[32:35], a[180:183], a[8:11], v[32:35]
    v_mfma_f32_16x16x32_bf16 v[60:63], a[180:183], a[12:15], v[60:63]
    ds_read_b128 a[176:179], v12 offset:13312
    buffer_load_dwordx4 a[48:51], v8, s[28:31], s6 offen offset:2048 sc1
    v_mfma_f32_16x16x32_bf16 v[36:39], a[184:187], a[8:11], v[36:39]
    v_mfma_f32_16x16x32_bf16 v[64:67], a[184:187], a[12:15], v[64:67]
    ds_read_b128 a[180:183], v12 offset:14336
    v_mfma_f32_16x16x32_bf16 v[40:43], a[188:191], a[8:11], v[40:43]
    v_mfma_f32_16x16x32_bf16 v[68:71], a[188:191], a[12:15], v[68:71]
    ds_read_b128 a[184:187], v12 offset:15360
    buffer_load_dwordx4 a[52:55], v8, s[28:31], s7 offen offset:2048 sc1
    v_mfma_f32_16x16x32_bf16 v[44:47], a[192:195], a[8:11], v[44:47]
    v_mfma_f32_16x16x32_bf16 v[72:75], a[192:195], a[12:15], v[72:75]
    ds_read_b128 a[188:191], v13 offset:60416
    v_mfma_f32_16x16x32_bf16 v[56:59], a[196:199], a[8:11], v[56:59]
    v_mfma_f32_16x16x32_bf16 v[84:87], a[196:199], a[12:15], v[84:87]
    ds_read_b128 a[192:195], v12 offset:16384
    s_waitcnt vmcnt(8) lgkmcnt(6)
    v_mfma_f32_16x16x32_bf16 v[32:35], a[200:203], a[16:19], v[32:35]
    v_mfma_f32_16x16x32_bf16 v[60:63], a[200:203], a[20:23], v[60:63]
    ds_read_b128 a[196:199], v12 offset:17408
    buffer_load_dwordx4 a[56:59], v8, s[28:31], s6 offen offset:3072 sc1
    v_mfma_f32_16x16x32_bf16 v[36:39], a[204:207], a[16:19], v[36:39]
    v_mfma_f32_16x16x32_bf16 v[64:67], a[204:207], a[20:23], v[64:67]
    ds_read_b128 a[200:203], v12 offset:18432
    v_mfma_f32_16x16x32_bf16 v[40:43], a[160:163], a[16:19], v[40:43]
    v_mfma_f32_16x16x32_bf16 v[68:71], a[160:163], a[20:23], v[68:71]
    ds_read_b128 a[204:207], v12 offset:19456
    buffer_load_dwordx4 a[60:63], v8, s[28:31], s7 offen offset:3072 sc1
    v_mfma_f32_16x16x32_bf16 v[44:47], a[164:167], a[16:19], v[44:47]
    v_mfma_f32_16x16x32_bf16 v[72:75], a[164:167], a[20:23], v[72:75]
    ds_read_b128 a[160:163], v13 offset:61440
    v_mfma_f32_16x16x32_bf16 v[56:59], a[168:171], a[16:19], v[56:59]
    v_mfma_f32_16x16x32_bf16 v[84:87], a[168:171], a[20:23], v[84:87]
    ds_read_b128 a[164:167], v12 offset:20480
    s_waitcnt vmcnt(8) lgkmcnt(6)
    v_mfma_f32_16x16x32_bf16 v[32:35], a[172:175], a[24:27], v[32:35]
    v_mfma_f32_16x16x32_bf16 v[60:63], a[172:175], a[28:31], v[60:63]
    ds_read_b128 a[168:171], v12 offset:21504
    s_add_u32 s6, s6, 4096
    s_add_u32 s7, s7, 4096
    buffer_load_dwordx4 a[64:67], v8, s[28:31], s6 offen offset:0 sc1
    v_mfma_f32_16x16x32_bf16 v[36:39], a[176:179], a[24:27], v[36:39]
    v_mfma_f32_16x16x32_bf16 v[64:67], a[176:179], a[28:31], v[64:67]
    ds_read_b128 a[172:175], v12 offset:22528
    v_mfma_f32_16x16x32_bf16 v[40:43], a[180:183], a[24:27], v[40:43]
    v_mfma_f32_16x16x32_bf16 v[68:71], a[180:183], a[28:31], v[68:71]
    ds_read_b128 a[176:179], v12 offset:23552
    buffer_load_dwordx4 a[68:71], v8, s[28:31], s7 offen offset:0 sc1
    v_mfma_f32_16x16x32_bf16 v[44:47], a[184:187], a[24:27], v[44:47]
    v_mfma_f32_16x16x32_bf16 v[72:75], a[184:187], a[28:31], v[72:75]
    ds_read_b128 a[180:183], v13 offset:62464
    v_mfma_f32_16x16x32_bf16 v[56:59], a[188:191], a[24:27], v[56:59]
    v_mfma_f32_16x16x32_bf16 v[84:87], a[188:191], a[28:31], v[84:87]
    ds_read_b128 a[184:187], v12 offset:24576
    s_waitcnt vmcnt(8) lgkmcnt(6)
    v_mfma_f32_16x16x32_bf16 v[32:35], a[192:195], a[32:35], v[32:35]
    v_mfma_f32_16x16x32_bf16 v[60:63], a[192:195], a[36:39], v[60:63]
    ds_read_b128 a[188:191], v12 offset:25600
    buffer_load_dwordx4 a[72:75], v8, s[28:31], s6 offen offset:1024 sc1
    v_mfma_f32_16x16x32_bf16 v[36:39], a[196:199], a[32:35], v[36:39]
    v_mfma_f32_16x16x32_bf16 v[64:67], a[196:199], a[36:39], v[64:67]
    ds_read_b128 a[192:195], v12 offset:26624
    v_mfma_f32_16x16x32_bf16 v[40:43], a[200:203], a[32:35], v[40:43]
    v_mfma_f32_16x16x32_bf16 v[68:71], a[200:203], a[36:39], v[68:71]
    ds_read_b128 a[196:199], v12 offset:27648
    buffer_load_dwordx4 a[76:79], v8, s[28:31], s7 offen offset:1024 sc1
    v_mfma_f32_16x16x32_bf16 v[44:47], a[204:207], a[32:35], v[44:47]
    v_mfma_f32_16x16x32_bf16 v[72:75], a[204:207], a[36:39], v[72:75]
    ds_read_b128 a[200:203], v13 offset:63488
    v_mfma_f32_16x16x32_bf16 v[56:59], a[160:163], a[32:35], v[56:59]
    v_mfma_f32_16x16x32_bf16 v[84:87], a[160:163], a[36:39], v[84:87]
    ds_read_b128 a[204:207], v12 offset:28672
    s_waitcnt vmcnt(8) lgkmcnt(6)
    v_mfma_f32_16x16x32_bf16 v[32:35], a[164:167], a[40:43], v[32:35]
    v_mfma_f32_16x16x32_bf16 v[60:63], a[164:167], a[44:47], v[60:63]
    ds_read_b128 a[160:163], v12 offset:29696
    buffer_load_dwordx4 a[80:83], v8, s[28:31], s6 offen offset:2048 sc1
    v_mfma_f32_16x16x32_bf16 v[36:39], a[168:171], a[40:43], v[36:39]
    v_mfma_f32_16x16x32_bf16 v[64:67], a[168:171], a[44:47], v[64:67]
    ds_read_b128 a[164:167], v12 offset:30720
    v_mfma_f32_16x16x32_bf16 v[40:43], a[172:175], a[40:43], v[40:43]
    v_mfma_f32_16x16x32_bf16 v[68:71], a[172:175], a[44:47], v[68:71]
    ds_read_b128 a[168:171], v12 offset:31744
    buffer_load_dwordx4 a[84:87], v8, s[28:31], s7 offen offset:2048 sc1
    v_mfma_f32_16x16x32_bf16 v[44:47], a[176:179], a[40:43], v[44:47]
    v_mfma_f32_16x16x32_bf16 v[72:75], a[176:179], a[44:47], v[72:75]
    ds_read_b128 a[172:175], v13 offset:64512
    v_mfma_f32_16x16x32_bf16 v[56:59], a[180:183], a[40:43], v[56:59]
    v_mfma_f32_16x16x32_bf16 v[84:87], a[180:183], a[44:47], v[84:87]
    ds_read_b128 a[176:179], v12 offset:32768
    s_waitcnt vmcnt(8) lgkmcnt(6)
    v_mfma_f32_16x16x32_bf16 v[32:35], a[184:187], a[48:51], v[32:35]
    v_mfma_f32_16x16x32_bf16 v[60:63], a[184:187], a[52:55], v[60:63]
    ds_read_b128 a[180:183], v12 offset:33792
    buffer_load_dwordx4 a[88:91], v8, s[28:31], s6 offen offset:3072 sc1
    v_mfma_f32_16x16x32_bf16 v[36:39], a[188:191], a[48:51], v[36:39]
    v_mfma_f32_16x16x32_bf16 v[64:67], a[188:191], a[52:55], v[64:67]
    ds_read_b128 a[184:187], v12 offset:34816
    v_mfma_f32_16x16x32_bf16 v[40:43], a[192:195], a[48:51], v[40:43]
    v_mfma_f32_16x16x32_bf16 v[68:71], a[192:195], a[52:55], v[68:71]
    ds_read_b128 a[188:191], v12 offset:35840
    buffer_load_dwordx4 a[92:95], v8, s[28:31], s7 offen offset:3072 sc1
    v_mfma_f32_16x16x32_bf16 v[44:47], a[196:199], a[48:51], v[44:47]
    v_mfma_f32_16x16x32_bf16 v[72:75], a[196:199], a[52:55], v[72:75]
    ds_read_b128 a[192:195], v14 offset:0
    v_mfma_f32_16x16x32_bf16 v[56:59], a[200:203], a[48:51], v[56:59]
    v_mfma_f32_16x16x32_bf16 v[84:87], a[200:203], a[52:55], v[84:87]
    ds_read_b128 a[196:199], v12 offset:36864
    s_waitcnt vmcnt(8) lgkmcnt(6)
    v_mfma_f32_16x16x32_bf16 v[32:35], a[204:207], a[56:59], v[32:35]
    v_mfma_f32_16x16x32_bf16 v[60:63], a[204:207], a[60:63], v[60:63]
    ds_read_b128 a[200:203], v12 offset:37888
    s_add_u32 s6, s6, 4096
    s_add_u32 s7, s7, 4096
    buffer_load_dwordx4 a[96:99], v8, s[28:31], s6 offen offset:0 sc1
    v_mfma_f32_16x16x32_bf16 v[36:39], a[160:163], a[56:59], v[36:39]
    v_mfma_f32_16x16x32_bf16 v[64:67], a[160:163], a[60:63], v[64:67]
    ds_read_b128 a[204:207], v12 offset:38912
    v_mfma_f32_16x16x32_bf16 v[40:43], a[164:167], a[56:59], v[40:43]
    v_mfma_f32_16x16x32_bf16 v[68:71], a[164:167], a[60:63], v[68:71]
    ds_read_b128 a[160:163], v12 offset:39936
    buffer_load_dwordx4 a[100:103], v8, s[28:31], s7 offen offset:0 sc1
    v_mfma_f32_16x16x32_bf16 v[44:47], a[168:171], a[56:59], v[44:47]
    v_mfma_f32_16x16x32_bf16 v[72:75], a[168:171], a[60:63], v[72:75]
    ds_read_b128 a[164:167], v14 offset:1024
    v_mfma_f32_16x16x32_bf16 v[56:59], a[172:175], a[56:59], v[56:59]
    v_mfma_f32_16x16x32_bf16 v[84:87], a[172:175], a[60:63], v[84:87]
    ds_read_b128 a[168:171], v12 offset:40960
    s_waitcnt vmcnt(8) lgkmcnt(6)
    v_mfma_f32_16x16x32_bf16 v[32:35], a[176:179], a[64:67], v[32:35]
    v_mfma_f32_16x16x32_bf16 v[60:63], a[176:179], a[68:71], v[60:63]
    ds_read_b128 a[172:175], v12 offset:41984
    buffer_load_dwordx4 a[104:107], v8, s[28:31], s6 offen offset:1024 sc1
    v_mfma_f32_16x16x32_bf16 v[36:39], a[180:183], a[64:67], v[36:39]
    v_mfma_f32_16x16x32_bf16 v[64:67], a[180:183], a[68:71], v[64:67]
    ds_read_b128 a[176:179], v12 offset:43008
    v_mfma_f32_16x16x32_bf16 v[40:43], a[184:187], a[64:67], v[40:43]
    v_mfma_f32_16x16x32_bf16 v[68:71], a[184:187], a[68:71], v[68:71]
    ds_read_b128 a[180:183], v12 offset:44032
    buffer_load_dwordx4 a[108:111], v8, s[28:31], s7 offen offset:1024 sc1
    v_mfma_f32_16x16x32_bf16 v[44:47], a[188:191], a[64:67], v[44:47]
    v_mfma_f32_16x16x32_bf16 v[72:75], a[188:191], a[68:71], v[72:75]
    ds_read_b128 a[184:187], v14 offset:2048
    v_mfma_f32_16x16x32_bf16 v[56:59], a[192:195], a[64:67], v[56:59]
    v_mfma_f32_16x16x32_bf16 v[84:87], a[192:195], a[68:71], v[84:87]
    ds_read_b128 a[188:191], v12 offset:45056
    buffer_load_dwordx4 a[112:115], v8, s[28:31], s6 offen offset:2048 sc1
    s_waitcnt vmcnt(9) lgkmcnt(6)
    v_mfma_f32_16x16x32_bf16 v[32:35], a[196:199], a[72:75], v[32:35]
    v_mfma_f32_16x16x32_bf16 v[60:63], a[196:199], a[76:79], v[60:63]
    ds_read_b128 a[192:195], v12 offset:46080
    buffer_load_dwordx4 a[116:119], v8, s[28:31], s7 offen offset:2048 sc1
    v_mfma_f32_16x16x32_bf16 v[36:39], a[200:203], a[72:75], v[36:39]
    v_mfma_f32_16x16x32_bf16 v[64:67], a[200:203], a[76:79], v[64:67]
    ds_read_b128 a[196:199], v12 offset:47104
    v_mfma_f32_16x16x32_bf16 v[40:43], a[204:207], a[72:75], v[40:43]
    v_mfma_f32_16x16x32_bf16 v[68:71], a[204:207], a[76:79], v[68:71]
    ds_read_b128 a[200:203], v12 offset:48128
    buffer_load_dwordx4 a[120:123], v8, s[28:31], s6 offen offset:3072 sc1
    v_mfma_f32_16x16x32_bf16 v[44:47], a[160:163], a[72:75], v[44:47]
    v_mfma_f32_16x16x32_bf16 v[72:75], a[160:163], a[76:79], v[72:75]
    ds_read_b128 a[204:207], v14 offset:3072
    v_mfma_f32_16x16x32_bf16 v[56:59], a[164:167], a[72:75], v[56:59]
    v_mfma_f32_16x16x32_bf16 v[84:87], a[164:167], a[76:79], v[84:87]
    ds_read_b128 a[160:163], v12 offset:49152
    buffer_load_dwordx4 a[124:127], v8, s[28:31], s7 offen offset:3072 sc1
    s_waitcnt vmcnt(10) lgkmcnt(6)
    v_mfma_f32_16x16x32_bf16 v[32:35], a[168:171], a[80:83], v[32:35]
    v_mfma_f32_16x16x32_bf16 v[60:63], a[168:171], a[84:87], v[60:63]
    ds_read_b128 a[164:167], v12 offset:50176
    s_add_u32 s6, s6, 4096
    s_add_u32 s7, s7, 4096
    buffer_load_dwordx4 a[128:131], v8, s[28:31], s6 offen offset:0 sc1
    v_mfma_f32_16x16x32_bf16 v[36:39], a[172:175], a[80:83], v[36:39]
    v_mfma_f32_16x16x32_bf16 v[64:67], a[172:175], a[84:87], v[64:67]
    ds_read_b128 a[168:171], v12 offset:51200
    v_mfma_f32_16x16x32_bf16 v[40:43], a[176:179], a[80:83], v[40:43]
    v_mfma_f32_16x16x32_bf16 v[68:71], a[176:179], a[84:87], v[68:71]
    ds_read_b128 a[172:175], v12 offset:52224
    buffer_load_dwordx4 a[132:135], v8, s[28:31], s7 offen offset:0 sc1
    v_mfma_f32_16x16x32_bf16 v[44:47], a[180:183], a[80:83], v[44:47]
    v_mfma_f32_16x16x32_bf16 v[72:75], a[180:183], a[84:87], v[72:75]
    ds_read_b128 a[176:179], v14 offset:4096
    v_mfma_f32_16x16x32_bf16 v[56:59], a[184:187], a[80:83], v[56:59]
    v_mfma_f32_16x16x32_bf16 v[84:87], a[184:187], a[84:87], v[84:87]
    ds_read_b128 a[180:183], v12 offset:53248
    buffer_load_dwordx4 a[136:139], v8, s[28:31], s6 offen offset:1024 sc1
    s_waitcnt vmcnt(11) lgkmcnt(6)
    v_mfma_f32_16x16x32_bf16 v[32:35], a[188:191], a[88:91], v[32:35]
    v_mfma_f32_16x16x32_bf16 v[60:63], a[188:191], a[92:95], v[60:63]
    ds_read_b128 a[184:187], v12 offset:54272
    buffer_load_dwordx4 a[140:143], v8, s[28:31], s7 offen offset:1024 sc1
    v_mfma_f32_16x16x32_bf16 v[36:39], a[192:195], a[88:91], v[36:39]
    v_mfma_f32_16x16x32_bf16 v[64:67], a[192:195], a[92:95], v[64:67]
    ds_read_b128 a[188:191], v12 offset:55296
    v_mfma_f32_16x16x32_bf16 v[40:43], a[196:199], a[88:91], v[40:43]
    v_mfma_f32_16x16x32_bf16 v[68:71], a[196:199], a[92:95], v[68:71]
    ds_read_b128 a[192:195], v12 offset:56320
    buffer_load_dwordx4 a[144:147], v8, s[28:31], s6 offen offset:2048 sc1
    v_mfma_f32_16x16x32_bf16 v[44:47], a[200:203], a[88:91], v[44:47]
    v_mfma_f32_16x16x32_bf16 v[72:75], a[200:203], a[92:95], v[72:75]
    ds_read_b128 a[196:199], v14 offset:5120
    v_mfma_f32_16x16x32_bf16 v[56:59], a[204:207], a[88:91], v[56:59]
    v_mfma_f32_16x16x32_bf16 v[84:87], a[204:207], a[92:95], v[84:87]
    ds_read_b128 a[200:203], v12 offset:57344
    buffer_load_dwordx4 a[148:151], v8, s[28:31], s7 offen offset:2048 sc1
    s_waitcnt vmcnt(12) lgkmcnt(6)
    v_mfma_f32_16x16x32_bf16 v[32:35], a[160:163], a[96:99], v[32:35]
    v_mfma_f32_16x16x32_bf16 v[60:63], a[160:163], a[100:103], v[60:63]
    ds_read_b128 a[204:207], v12 offset:58368
    buffer_load_dwordx4 a[152:155], v8, s[28:31], s6 offen offset:3072 sc1
    v_mfma_f32_16x16x32_bf16 v[36:39], a[164:167], a[96:99], v[36:39]
    v_mfma_f32_16x16x32_bf16 v[64:67], a[164:167], a[100:103], v[64:67]
    ds_read_b128 a[160:163], v12 offset:59392
    v_mfma_f32_16x16x32_bf16 v[40:43], a[168:171], a[96:99], v[40:43]
    v_mfma_f32_16x16x32_bf16 v[68:71], a[168:171], a[100:103], v[68:71]
    ds_read_b128 a[164:167], v12 offset:60416
    buffer_load_dwordx4 a[156:159], v8, s[28:31], s7 offen offset:3072 sc1
    v_mfma_f32_16x16x32_bf16 v[44:47], a[172:175], a[96:99], v[44:47]
    v_mfma_f32_16x16x32_bf16 v[72:75], a[172:175], a[100:103], v[72:75]
    ds_read_b128 a[168:171], v14 offset:6144
    v_mfma_f32_16x16x32_bf16 v[56:59], a[176:179], a[96:99], v[56:59]
    v_mfma_f32_16x16x32_bf16 v[84:87], a[176:179], a[100:103], v[84:87]
    ds_read_b128 a[172:175], v12 offset:61440
    buffer_load_dwordx2 v[16:17], v228, s[28:31], s9 offen offset:0 sc1
    s_waitcnt vmcnt(13) lgkmcnt(6)
    v_mfma_f32_16x16x32_bf16 v[32:35], a[180:183], a[104:107], v[32:35]
    v_mfma_f32_16x16x32_bf16 v[60:63], a[180:183], a[108:111], v[60:63]
    ds_read_b128 a[176:179], v12 offset:62464
    buffer_load_dwordx2 v[18:19], v228, s[28:31], s9 offen offset:128 sc1
    v_mfma_f32_16x16x32_bf16 v[36:39], a[184:187], a[104:107], v[36:39]
    v_mfma_f32_16x16x32_bf16 v[64:67], a[184:187], a[108:111], v[64:67]
    ds_read_b128 a[180:183], v12 offset:63488
    v_mfma_f32_16x16x32_bf16 v[40:43], a[188:191], a[104:107], v[40:43]
    v_mfma_f32_16x16x32_bf16 v[68:71], a[188:191], a[108:111], v[68:71]
    ds_read_b128 a[184:187], v12 offset:64512
    buffer_load_dwordx2 v[20:21], v228, s[28:31], s9 offen offset:1024 sc1
    v_mfma_f32_16x16x32_bf16 v[44:47], a[192:195], a[104:107], v[44:47]
    v_mfma_f32_16x16x32_bf16 v[72:75], a[192:195], a[108:111], v[72:75]
    ds_read_b128 a[188:191], v14 offset:7168
    v_mfma_f32_16x16x32_bf16 v[56:59], a[196:199], a[104:107], v[56:59]
    v_mfma_f32_16x16x32_bf16 v[84:87], a[196:199], a[108:111], v[84:87]
    ds_read_b128 a[192:195], v13 offset:0
    buffer_load_dwordx2 v[22:23], v228, s[28:31], s9 offen offset:1152 sc1
    s_waitcnt vmcnt(14) lgkmcnt(6)
    v_mfma_f32_16x16x32_bf16 v[32:35], a[200:203], a[112:115], v[32:35]
    v_mfma_f32_16x16x32_bf16 v[60:63], a[200:203], a[116:119], v[60:63]
    ds_read_b128 a[196:199], v13 offset:1024
    s_mov_b32 s26, 5492736
    buffer_load_dwordx2 v[116:117], v235, s[28:31], s26 offen
    v_mfma_f32_16x16x32_bf16 v[36:39], a[204:207], a[112:115], v[36:39]
    v_mfma_f32_16x16x32_bf16 v[64:67], a[204:207], a[116:119], v[64:67]
    ds_read_b128 a[200:203], v13 offset:2048
    v_mfma_f32_16x16x32_bf16 v[40:43], a[160:163], a[112:115], v[40:43]
    v_mfma_f32_16x16x32_bf16 v[68:71], a[160:163], a[116:119], v[68:71]
    ds_read_b128 a[204:207], v13 offset:3072
    s_mov_b32 s26, 5492736
    buffer_load_dwordx2 v[118:119], v236, s[28:31], s26 offen
    v_mfma_f32_16x16x32_bf16 v[44:47], a[164:167], a[112:115], v[44:47]
    v_mfma_f32_16x16x32_bf16 v[72:75], a[164:167], a[116:119], v[72:75]
    ds_read_b128 a[160:163], v14 offset:8192
    v_mfma_f32_16x16x32_bf16 v[56:59], a[168:171], a[112:115], v[56:59]
    v_mfma_f32_16x16x32_bf16 v[84:87], a[168:171], a[116:119], v[84:87]
    ds_read_b128 a[164:167], v13 offset:4096
    s_mov_b32 s26, 5492736
    buffer_load_dwordx2 v[120:121], v237, s[28:31], s26 offen
    s_waitcnt vmcnt(15) lgkmcnt(6)
    v_mfma_f32_16x16x32_bf16 v[32:35], a[172:175], a[120:123], v[32:35]
    v_mfma_f32_16x16x32_bf16 v[60:63], a[172:175], a[124:127], v[60:63]
    ds_read_b128 a[168:171], v13 offset:5120
    s_mov_b32 s26, 5492736
    buffer_load_dwordx2 v[122:123], v238, s[28:31], s26 offen
    v_mfma_f32_16x16x32_bf16 v[36:39], a[176:179], a[120:123], v[36:39]
    v_mfma_f32_16x16x32_bf16 v[64:67], a[176:179], a[124:127], v[64:67]
    ds_read_b128 a[172:175], v13 offset:6144
    v_mfma_f32_16x16x32_bf16 v[40:43], a[180:183], a[120:123], v[40:43]
    v_mfma_f32_16x16x32_bf16 v[68:71], a[180:183], a[124:127], v[68:71]
    ds_read_b128 a[176:179], v13 offset:7168
    s_mov_b32 s26, 5492736
    buffer_load_dwordx2 v[124:125], v239, s[28:31], s26 offen
    v_mfma_f32_16x16x32_bf16 v[44:47], a[184:187], a[120:123], v[44:47]
    v_mfma_f32_16x16x32_bf16 v[72:75], a[184:187], a[124:127], v[72:75]
    ds_read_b128 a[180:183], v14 offset:9216
    v_mfma_f32_16x16x32_bf16 v[56:59], a[188:191], a[120:123], v[56:59]
    v_mfma_f32_16x16x32_bf16 v[84:87], a[188:191], a[124:127], v[84:87]
    ds_read_b128 a[184:187], v13 offset:8192
    buffer_load_dwordx4 v[204:207], v233, s[28:31], s37 offen offset:0
    s_waitcnt vmcnt(16) lgkmcnt(6)
    v_mfma_f32_16x16x32_bf16 v[32:35], a[192:195], a[128:131], v[32:35]
    v_mfma_f32_16x16x32_bf16 v[60:63], a[192:195], a[132:135], v[60:63]
    ds_read_b128 a[188:191], v13 offset:9216
    buffer_load_dwordx4 v[208:211], v233, s[28:31], s37 offen offset:64
    v_mfma_f32_16x16x32_bf16 v[36:39], a[196:199], a[128:131], v[36:39]
    v_mfma_f32_16x16x32_bf16 v[64:67], a[196:199], a[132:135], v[64:67]
    ds_read_b128 a[192:195], v13 offset:10240
    v_mfma_f32_16x16x32_bf16 v[40:43], a[200:203], a[128:131], v[40:43]
    v_mfma_f32_16x16x32_bf16 v[68:71], a[200:203], a[132:135], v[68:71]
    ds_read_b128 a[196:199], v13 offset:11264
    buffer_load_dwordx4 v[212:215], v233, s[28:31], s37 offen offset:128
    v_mfma_f32_16x16x32_bf16 v[44:47], a[204:207], a[128:131], v[44:47]
    v_mfma_f32_16x16x32_bf16 v[72:75], a[204:207], a[132:135], v[72:75]
    ds_read_b128 a[200:203], v14 offset:10240
    v_mfma_f32_16x16x32_bf16 v[56:59], a[160:163], a[128:131], v[56:59]
    v_mfma_f32_16x16x32_bf16 v[84:87], a[160:163], a[132:135], v[84:87]
    ds_read_b128 a[204:207], v13 offset:12288
    buffer_load_dwordx4 v[216:219], v233, s[28:31], s37 offen offset:192
    s_waitcnt vmcnt(17) lgkmcnt(6)
    v_mfma_f32_16x16x32_bf16 v[32:35], a[164:167], a[136:139], v[32:35]
    v_mfma_f32_16x16x32_bf16 v[60:63], a[164:167], a[140:143], v[60:63]
    ds_read_b128 a[160:163], v13 offset:13312
    buffer_load_dwordx4 v[220:223], v233, s[28:31], s38 offen
    v_mfma_f32_16x16x32_bf16 v[36:39], a[168:171], a[136:139], v[36:39]
    v_mfma_f32_16x16x32_bf16 v[64:67], a[168:171], a[140:143], v[64:67]
    ds_read_b128 a[164:167], v13 offset:14336
    s_mul_i32 s25, s20, 3
    s_min_u32 s25, s25, 7
    s_lshl_b32 s25, s25, 10
    s_add_u32 s62, s25, 143360
    s_add_u32 s63, s25, s59
    s_add_u32 s63, s63, 0
    s_mov_b32 m0, s62
    buffer_load_dwordx4 v8, s[28:31], s63 offen offset:0 lds
    v_mfma_f32_16x16x32_bf16 v[40:43], a[172:175], a[136:139], v[40:43]
    v_mfma_f32_16x16x32_bf16 v[68:71], a[172:175], a[140:143], v[68:71]
    ds_read_b128 a[168:171], v13 offset:15360
    v_mfma_f32_16x16x32_bf16 v[44:47], a[176:179], a[136:139], v[44:47]
    v_mfma_f32_16x16x32_bf16 v[72:75], a[176:179], a[140:143], v[72:75]
    ds_read_b128 a[172:175], v14 offset:11264
    buffer_load_dwordx4 v8, s[28:31], s63 offen offset:1024 lds
    v_mfma_f32_16x16x32_bf16 v[56:59], a[180:183], a[136:139], v[56:59]
    v_mfma_f32_16x16x32_bf16 v[84:87], a[180:183], a[140:143], v[84:87]
    ds_read_b128 a[176:179], v13 offset:16384
    s_waitcnt vmcnt(18) lgkmcnt(6)
    v_mfma_f32_16x16x32_bf16 v[32:35], a[184:187], a[144:147], v[32:35]
    v_mfma_f32_16x16x32_bf16 v[60:63], a[184:187], a[148:151], v[60:63]
    ds_read_b128 a[180:183], v13 offset:17408
    v_mfma_f32_16x16x32_bf16 v[36:39], a[188:191], a[144:147], v[36:39]
    v_mfma_f32_16x16x32_bf16 v[64:67], a[188:191], a[148:151], v[64:67]
    ds_read_b128 a[184:187], v13 offset:18432
    buffer_load_dwordx4 v8, s[28:31], s63 offen offset:2048 lds
    v_mfma_f32_16x16x32_bf16 v[40:43], a[192:195], a[144:147], v[40:43]
    v_mfma_f32_16x16x32_bf16 v[68:71], a[192:195], a[148:151], v[68:71]
    ds_read_b128 a[188:191], v13 offset:19456
    v_mfma_f32_16x16x32_bf16 v[44:47], a[196:199], a[144:147], v[44:47]
    v_mfma_f32_16x16x32_bf16 v[72:75], a[196:199], a[148:151], v[72:75]
    ds_read_b128 a[192:195], v13 offset:20480
    v_mfma_f32_16x16x32_bf16 v[56:59], a[200:203], a[144:147], v[56:59]
    v_mfma_f32_16x16x32_bf16 v[84:87], a[200:203], a[148:151], v[84:87]
    ds_read_b128 a[196:199], v13 offset:21504
    s_waitcnt vmcnt(17) lgkmcnt(6)
    v_mfma_f32_16x16x32_bf16 v[32:35], a[204:207], a[152:155], v[32:35]
    v_mfma_f32_16x16x32_bf16 v[60:63], a[204:207], a[156:159], v[60:63]
    ds_read_b128 a[200:203], v13 offset:22528
    v_mfma_f32_16x16x32_bf16 v[36:39], a[160:163], a[152:155], v[36:39]
    v_mfma_f32_16x16x32_bf16 v[64:67], a[160:163], a[156:159], v[64:67]
    ds_read_b128 a[204:207], v13 offset:23552
    v_mfma_f32_16x16x32_bf16 v[40:43], a[164:167], a[152:155], v[40:43]
    v_mfma_f32_16x16x32_bf16 v[68:71], a[164:167], a[156:159], v[68:71]
    ds_read_b128 a[160:163], v13 offset:24576
    v_mfma_f32_16x16x32_bf16 v[44:47], a[168:171], a[152:155], v[44:47]
    v_mfma_f32_16x16x32_bf16 v[72:75], a[168:171], a[156:159], v[72:75]
    ds_read_b128 a[164:167], v13 offset:25600
    v_mfma_f32_16x16x32_bf16 v[56:59], a[172:175], a[152:155], v[56:59]
    v_mfma_f32_16x16x32_bf16 v[84:87], a[172:175], a[156:159], v[84:87]
    ds_read_b128 a[168:171], v13 offset:26624
    s_waitcnt lgkmcnt(7)
    v_mfma_f32_16x16x32_bf16 v[48:51], a[176:179], a[0:3], 0
    v_mfma_f32_16x16x32_bf16 v[76:79], a[176:179], a[4:7], 0
    ds_read_b128 a[172:175], v13 offset:27648
    v_mfma_f32_16x16x32_bf16 v[52:55], a[180:183], a[0:3], 0
    v_mfma_f32_16x16x32_bf16 v[80:83], a[180:183], a[4:7], 0
    ds_read_b128 a[176:179], v13 offset:28672
    v_mfma_f32_16x16x32_bf16 v[48:51], a[184:187], a[8:11], v[48:51]
    v_mfma_f32_16x16x32_bf16 v[76:79], a[184:187], a[12:15], v[76:79]
    ds_read_b128 a[180:183], v13 offset:29696
    v_mfma_f32_16x16x32_bf16 v[52:55], a[188:191], a[8:11], v[52:55]
    v_mfma_f32_16x16x32_bf16 v[80:83], a[188:191], a[12:15], v[80:83]
    ds_read_b128 a[184:187], v13 offset:30720
    s_barrier
    s_waitcnt lgkmcnt(7)
    v_mfma_f32_16x16x32_bf16 v[48:51], a[192:195], a[16:19], v[48:51]
    v_mfma_f32_16x16x32_bf16 v[76:79], a[192:195], a[20:23], v[76:79]
    ds_read_b128 a[188:191], v13 offset:31744
    s_mul_i32 s25, s20, 20
    s_lshl_b32 s25, s25, 10
    s_add_u32 s62, s25, 0
    s_add_u32 s63, s25, s59
    s_add_u32 s63, s63, 10240
    s_mov_b32 m0, s62
    buffer_load_dwordx4 v8, s[28:31], s63 offen offset:0 lds
    v_mfma_f32_16x16x32_bf16 v[52:55], a[196:199], a[16:19], v[52:55]
    v_mfma_f32_16x16x32_bf16 v[80:83], a[196:199], a[20:23], v[80:83]
    ds_read_b128 a[192:195], v13 offset:32768
    buffer_load_dwordx4 v8, s[28:31], s63 offen offset:1024 lds
    v_mfma_f32_16x16x32_bf16 v[48:51], a[200:203], a[24:27], v[48:51]
    v_mfma_f32_16x16x32_bf16 v[76:79], a[200:203], a[28:31], v[76:79]
    ds_read_b128 a[196:199], v13 offset:33792
    buffer_load_dwordx4 v8, s[28:31], s63 offen offset:2048 lds
    v_mfma_f32_16x16x32_bf16 v[52:55], a[204:207], a[24:27], v[52:55]
    v_mfma_f32_16x16x32_bf16 v[80:83], a[204:207], a[28:31], v[80:83]
    ds_read_b128 a[200:203], v13 offset:34816
    buffer_load_dwordx4 v8, s[28:31], s63 offen offset:3072 lds
    s_waitcnt lgkmcnt(7)
    v_mfma_f32_16x16x32_bf16 v[48:51], a[160:163], a[32:35], v[48:51]
    v_mfma_f32_16x16x32_bf16 v[76:79], a[160:163], a[36:39], v[76:79]
    ds_read_b128 a[204:207], v13 offset:35840
    s_add_u32 s62, s62, 4096
    s_add_u32 s63, s63, 4096
    s_mov_b32 m0, s62
    buffer_load_dwordx4 v8, s[28:31], s63 offen offset:0 lds
    v_mfma_f32_16x16x32_bf16 v[52:55], a[164:167], a[32:35], v[52:55]
    v_mfma_f32_16x16x32_bf16 v[80:83], a[164:167], a[36:39], v[80:83]
    ds_read_b128 a[160:163], v13 offset:36864
    buffer_load_dwordx4 v8, s[28:31], s63 offen offset:1024 lds
    v_mfma_f32_16x16x32_bf16 v[48:51], a[168:171], a[40:43], v[48:51]
    v_mfma_f32_16x16x32_bf16 v[76:79], a[168:171], a[44:47], v[76:79]
    ds_read_b128 a[164:167], v13 offset:37888
    buffer_load_dwordx4 v8, s[28:31], s63 offen offset:2048 lds
    v_mfma_f32_16x16x32_bf16 v[52:55], a[172:175], a[40:43], v[52:55]
    v_mfma_f32_16x16x32_bf16 v[80:83], a[172:175], a[44:47], v[80:83]
    ds_read_b128 a[168:171], v13 offset:38912
    buffer_load_dwordx4 v8, s[28:31], s63 offen offset:3072 lds
    s_waitcnt lgkmcnt(7)
    v_mfma_f32_16x16x32_bf16 v[48:51], a[176:179], a[48:51], v[48:51]
    v_mfma_f32_16x16x32_bf16 v[76:79], a[176:179], a[52:55], v[76:79]
    ds_read_b128 a[172:175], v13 offset:39936
    s_add_u32 s62, s62, 4096
    s_add_u32 s63, s63, 4096
    s_mov_b32 m0, s62
    buffer_load_dwordx4 v8, s[28:31], s63 offen offset:0 lds
    v_mfma_f32_16x16x32_bf16 v[52:55], a[180:183], a[48:51], v[52:55]
    v_mfma_f32_16x16x32_bf16 v[80:83], a[180:183], a[52:55], v[80:83]
    ds_read_b128 a[176:179], v13 offset:40960
    buffer_load_dwordx4 v8, s[28:31], s63 offen offset:1024 lds
    v_mfma_f32_16x16x32_bf16 v[48:51], a[184:187], a[56:59], v[48:51]
    v_mfma_f32_16x16x32_bf16 v[76:79], a[184:187], a[60:63], v[76:79]
    ds_read_b128 a[180:183], v13 offset:41984
    buffer_load_dwordx4 v8, s[28:31], s63 offen offset:2048 lds
    v_mfma_f32_16x16x32_bf16 v[52:55], a[188:191], a[56:59], v[52:55]
    v_mfma_f32_16x16x32_bf16 v[80:83], a[188:191], a[60:63], v[80:83]
    ds_read_b128 a[184:187], v13 offset:43008
    buffer_load_dwordx4 v8, s[28:31], s63 offen offset:3072 lds
    s_waitcnt lgkmcnt(7)
    v_mfma_f32_16x16x32_bf16 v[48:51], a[192:195], a[64:67], v[48:51]
    v_mfma_f32_16x16x32_bf16 v[76:79], a[192:195], a[68:71], v[76:79]
    ds_read_b128 a[188:191], v13 offset:44032
    s_add_u32 s62, s62, 4096
    s_add_u32 s63, s63, 4096
    s_mov_b32 m0, s62
    buffer_load_dwordx4 v8, s[28:31], s63 offen offset:0 lds
    v_mfma_f32_16x16x32_bf16 v[52:55], a[196:199], a[64:67], v[52:55]
    v_mfma_f32_16x16x32_bf16 v[80:83], a[196:199], a[68:71], v[80:83]
    ds_read_b128 a[192:195], v13 offset:45056
    buffer_load_dwordx4 v8, s[28:31], s63 offen offset:1024 lds
    v_mfma_f32_16x16x32_bf16 v[48:51], a[200:203], a[72:75], v[48:51]
    v_mfma_f32_16x16x32_bf16 v[76:79], a[200:203], a[76:79], v[76:79]
    ds_read_b128 a[196:199], v13 offset:46080
    buffer_load_dwordx4 v8, s[28:31], s63 offen offset:2048 lds
    v_mfma_f32_16x16x32_bf16 v[52:55], a[204:207], a[72:75], v[52:55]
    v_mfma_f32_16x16x32_bf16 v[80:83], a[204:207], a[76:79], v[80:83]
    ds_read_b128 a[200:203], v13 offset:47104
    buffer_load_dwordx4 v8, s[28:31], s63 offen offset:3072 lds
    s_waitcnt lgkmcnt(7)
    v_mfma_f32_16x16x32_bf16 v[48:51], a[160:163], a[80:83], v[48:51]
    v_mfma_f32_16x16x32_bf16 v[76:79], a[160:163], a[84:87], v[76:79]
    ds_read_b128 a[204:207], v13 offset:48128
    s_add_u32 s62, s62, 4096
    s_add_u32 s63, s63, 4096
    s_mov_b32 m0, s62
    buffer_load_dwordx4 v8, s[28:31], s63 offen offset:0 lds
    v_mfma_f32_16x16x32_bf16 v[52:55], a[164:167], a[80:83], v[52:55]
    v_mfma_f32_16x16x32_bf16 v[80:83], a[164:167], a[84:87], v[80:83]
    ds_read_b128 a[160:163], v13 offset:49152
    buffer_load_dwordx4 v8, s[28:31], s63 offen offset:1024 lds
    v_mfma_f32_16x16x32_bf16 v[48:51], a[168:171], a[88:91], v[48:51]
    v_mfma_f32_16x16x32_bf16 v[76:79], a[168:171], a[92:95], v[76:79]
    ds_read_b128 a[164:167], v13 offset:50176
    buffer_load_dwordx4 v8, s[28:31], s63 offen offset:2048 lds
    v_mfma_f32_16x16x32_bf16 v[52:55], a[172:175], a[88:91], v[52:55]
    v_mfma_f32_16x16x32_bf16 v[80:83], a[172:175], a[92:95], v[80:83]
    ds_read_b128 a[168:171], v13 offset:51200
    buffer_load_dwordx4 v8, s[28:31], s63 offen offset:3072 lds
    s_waitcnt lgkmcnt(7)
    v_mfma_f32_16x16x32_bf16 v[48:51], a[176:179], a[96:99], v[48:51]
    v_mfma_f32_16x16x32_bf16 v[76:79], a[176:179], a[100:103], v[76:79]
    ds_read_b128 a[172:175], v13 offset:52224
    s_mul_i32 s25, s20, 3
    s_min_u32 s25, s25, 7
    s_lshl_b32 s25, s25, 10
    s_add_u32 s62, s25, 153600
    s_add_u32 s63, s25, s59
    s_add_u32 s63, s63, 92160
    s_mov_b32 m0, s62
    buffer_load_dwordx4 v8, s[28:31], s63 offen offset:0 lds
    v_mfma_f32_16x16x32_bf16 v[52:55], a[180:183], a[96:99], v[52:55]
    v_mfma_f32_16x16x32_bf16 v[80:83], a[180:183], a[100:103], v[80:83]
    ds_read_b128 a[176:179], v13 offset:53248
    buffer_load_dwordx4 v8, s[28:31], s63 offen offset:1024 lds
    v_mfma_f32_16x16x32_bf16 v[48:51], a[184:187], a[104:107], v[48:51]
    v_mfma_f32_16x16x32_bf16 v[76:79], a[184:187], a[108:111], v[76:79]
    ds_read_b128 a[180:183], v13 offset:54272
    buffer_load_dwordx4 v8, s[28:31], s63 offen offset:2048 lds
    v_mfma_f32_16x16x32_bf16 v[52:55], a[188:191], a[104:107], v[52:55]
    v_mfma_f32_16x16x32_bf16 v[80:83], a[188:191], a[108:111], v[80:83]
    ds_read_b128 a[184:187], v13 offset:55296
    s_mul_i32 s25, s20, 5
    s_lshl_b32 s25, s25, 10
    s_add_u32 s62, s25, 122880
    s_add_u32 s63, s25, s59
    s_add_u32 s63, s63, 102400
    s_mov_b32 m0, s62
    buffer_load_dwordx4 v8, s[28:31], s63 offen offset:0 lds
    s_waitcnt lgkmcnt(7)
    v_mfma_f32_16x16x32_bf16 v[48:51], a[192:195], a[112:115], v[48:51]
    v_mfma_f32_16x16x32_bf16 v[76:79], a[192:195], a[116:119], v[76:79]
    ds_read_b128 a[188:191], v13 offset:56320
    buffer_load_dwordx4 v8, s[28:31], s63 offen offset:1024 lds
    v_mfma_f32_16x16x32_bf16 v[52:55], a[196:199], a[112:115], v[52:55]
    v_mfma_f32_16x16x32_bf16 v[80:83], a[196:199], a[116:119], v[80:83]
    buffer_load_dwordx4 v8, s[28:31], s63 offen offset:2048 lds
    v_mfma_f32_16x16x32_bf16 v[48:51], a[200:203], a[120:123], v[48:51]
    v_mfma_f32_16x16x32_bf16 v[76:79], a[200:203], a[124:127], v[76:79]
    buffer_load_dwordx4 v8, s[28:31], s63 offen offset:3072 lds
    v_mfma_f32_16x16x32_bf16 v[52:55], a[204:207], a[120:123], v[52:55]
    v_mfma_f32_16x16x32_bf16 v[80:83], a[204:207], a[124:127], v[80:83]
    s_add_u32 s62, s62, 4096
    s_add_u32 s63, s63, 4096
    s_mov_b32 m0, s62
    buffer_load_dwordx4 v8, s[28:31], s63 offen offset:0 lds
    s_waitcnt lgkmcnt(4)
    v_mfma_f32_16x16x32_bf16 v[48:51], a[160:163], a[128:131], v[48:51]
    v_mfma_f32_16x16x32_bf16 v[76:79], a[160:163], a[132:135], v[76:79]
    v_mfma_f32_16x16x32_bf16 v[52:55], a[164:167], a[128:131], v[52:55]
    v_mfma_f32_16x16x32_bf16 v[80:83], a[164:167], a[132:135], v[80:83]
    v_mfma_f32_16x16x32_bf16 v[48:51], a[168:171], a[136:139], v[48:51]
    v_mfma_f32_16x16x32_bf16 v[76:79], a[168:171], a[140:143], v[76:79]
    v_mfma_f32_16x16x32_bf16 v[52:55], a[172:175], a[136:139], v[52:55]
    v_mfma_f32_16x16x32_bf16 v[80:83], a[172:175], a[140:143], v[80:83]
    s_waitcnt lgkmcnt(0)
    v_mfma_f32_16x16x32_bf16 v[48:51], a[176:179], a[144:147], v[48:51]
    v_mfma_f32_16x16x32_bf16 v[76:79], a[176:179], a[148:151], v[76:79]
    v_mfma_f32_16x16x32_bf16 v[52:55], a[180:183], a[144:147], v[52:55]
    v_mfma_f32_16x16x32_bf16 v[80:83], a[180:183], a[148:151], v[80:83]
    v_mfma_f32_16x16x32_bf16 v[48:51], a[184:187], a[152:155], v[48:51]
    v_mfma_f32_16x16x32_bf16 v[76:79], a[184:187], a[156:159], v[76:79]
    v_mfma_f32_16x16x32_bf16 v[52:55], a[188:191], a[152:155], v[52:55]
    v_mfma_f32_16x16x32_bf16 v[80:83], a[188:191], a[156:159], v[80:83]
    s_barrier
    s_mul_i32 s26, s22, 5120
    s_add_u32 s55, s59, s26
    s_add_u32 s55, s55, 194560
    s_waitcnt vmcnt(41)
    v_add_f32 v16, v16, v18
    v_add_f32 v17, v17, v19
    v_add_f32 v20, v20, v22
    v_add_f32 v21, v21, v23
    s_nop 0
    v_mov_b32 v24, v16
    v_mov_b32 v25, v17
    v_mov_b32 v26, v20
    v_mov_b32 v27, v21
    s_nop 1
    v_permlane32_swap_b32 v24, v16
    v_permlane32_swap_b32 v25, v17
    v_permlane32_swap_b32 v26, v20
    v_permlane32_swap_b32 v27, v21
    s_mul_i32 s25, s20, 10
    s_lshl_b32 s25, s25, 10
    s_add_u32 s62, s25, 81920
    s_add_u32 s63, s25, s59
    s_add_u32 s63, s63, 122880
    s_mov_b32 m0, s62
    buffer_load_dwordx4 v8, s[28:31], s63 offen offset:0 lds
    s_nop 1
    v_add_f32 v16, v16, v24
    v_add_f32 v17, v17, v25
    v_add_f32 v20, v20, v26
    v_add_f32 v21, v21, v27
    v_mov_b32 v24, v16
    v_mov_b32 v25, v17
    v_mov_b32 v26, v20
    v_mov_b32 v27, v21
    s_nop 1
    v_permlane16_swap_b32 v24, v16
    v_permlane16_swap_b32 v25, v17
    v_permlane16_swap_b32 v26, v20
    v_permlane16_swap_b32 v27, v21
    s_nop 1
    v_add_f32 v16, v16, v24
    buffer_load_dwordx4 v8, s[28:31], s63 offen offset:1024 lds
    v_add_f32 v17, v17, v25
    v_add_f32 v20, v20, v26
    v_add_f32 v21, v21, v27
    v_mul_f32 v16, 0x3acccccd, v16
    v_mul_f32 v20, 0x3acccccd, v20
    v_mul_f32 v17, 0x3acccccd, v17
    v_mul_f32 v21, 0x3acccccd, v21
    v_fma_f32 v17, -v16, v16, v17
    v_fma_f32 v21, -v20, v20, v21
    v_max_f32 v17, 0, v17
    v_max_f32 v21, 0, v21
    v_cvt_pk_bf16_f32 v18, v16, v17
    v_cvt_pk_bf16_f32 v22, v20, v21
    v_lshlrev_b32 v16, 16, v18
    v_lshlrev_b32 v20, 16, v22
    v_and_b32 v17, 0xffff0000, v18
    v_and_b32 v21, 0xffff0000, v22
    v_add_f32 v17, 0x3727c5ac, v17
    v_add_f32 v21, 0x3727c5ac, v21
    buffer_load_dwordx4 v8, s[28:31], s63 offen offset:2048 lds
    v_cvt_pk_bf16_f32 v18, v17, v17
    v_cvt_pk_bf16_f32 v22, v21, v21
    v_lshlrev_b32 v17, 16, v18
    v_lshlrev_b32 v21, 16, v22
    v_sqrt_f32 v17, v17
    v_sqrt_f32 v21, v21
    s_nop 0
    s_nop 0
    v_cvt_pk_bf16_f32 v18, v17, v17
    v_cvt_pk_bf16_f32 v22, v21, v21
    v_lshlrev_b32 v17, 16, v18
    v_lshlrev_b32 v21, 16, v22
    v_rcp_f32 v17, v17
    v_rcp_f32 v21, v21
    s_nop 0
    s_nop 0
    v_mul_f32 v16, v16, v17
    buffer_load_dwordx4 v8, s[28:31], s63 offen offset:3072 lds
    v_mul_f32 v20, v20, v21
    v_sub_f32 v16, 0, v16
    v_sub_f32 v20, 0, v20
    v_mov_b32 v30, 0xbdd2d3e8
    v_mov_b32 v31, 0xc0135761
    v_pk_mul_f32 v[176:177], v[88:89], v[16:17] op_sel_hi:[1,0]
    v_pk_mul_f32 v[178:179], v[90:91], v[16:17] op_sel_hi:[1,0]
    v_pk_mul_f32 v[180:181], v[92:93], v[16:17] op_sel_hi:[1,0]
    v_pk_mul_f32 v[182:183], v[94:95], v[16:17] op_sel_hi:[1,0]
    v_pk_mul_f32 v[184:185], v[96:97], v[16:17] op_sel_hi:[1,0]
    v_pk_mul_f32 v[186:187], v[98:99], v[16:17] op_sel_hi:[1,0]
    v_pk_mul_f32 v[188:189], v[100:101], v[16:17] op_sel_hi:[1,0]
    v_pk_mul_f32 v[190:191], v[102:103], v[16:17] op_sel_hi:[1,0]
    v_pk_mul_f32 v[192:193], v[104:105], v[16:17] op_sel_hi:[1,0]
    v_pk_mul_f32 v[194:195], v[106:107], v[16:17] op_sel_hi:[1,0]
    v_pk_mul_f32 v[196:197], v[108:109], v[16:17] op_sel_hi:[1,0]
    v_pk_mul_f32 v[198:199], v[110:111], v[16:17] op_sel_hi:[1,0]
    v_pk_mul_f32 v[200:201], v[112:113], v[16:17] op_sel_hi:[1,0]
    v_pk_mul_f32 v[202:203], v[114:115], v[16:17] op_sel_hi:[1,0]
    s_add_u32 s62, s62, 4096
    s_add_u32 s63, s63, 4096
    s_mov_b32 m0, s62
    buffer_load_dwordx4 v8, s[28:31], s63 offen offset:0 lds
    v_pk_fma_f32 v[32:33], v[32:33], v[16:17], v[176:177] op_sel:[0,1,0] op_sel_hi:[1,1,1]
    v_pk_fma_f32 v[34:35], v[34:35], v[16:17], v[178:179] op_sel:[0,1,0] op_sel_hi:[1,1,1]
    v_pk_fma_f32 v[36:37], v[36:37], v[16:17], v[180:181] op_sel:[0,1,0] op_sel_hi:[1,1,1]
    v_pk_fma_f32 v[38:39], v[38:39], v[16:17], v[182:183] op_sel:[0,1,0] op_sel_hi:[1,1,1]
    v_pk_fma_f32 v[40:41], v[40:41], v[16:17], v[184:185] op_sel:[0,1,0] op_sel_hi:[1,1,1]
    v_pk_fma_f32 v[42:43], v[42:43], v[16:17], v[186:187] op_sel:[0,1,0] op_sel_hi:[1,1,1]
    v_pk_fma_f32 v[44:45], v[44:45], v[16:17], v[188:189] op_sel:[0,1,0] op_sel_hi:[1,1,1]
    v_pk_fma_f32 v[46:47], v[46:47], v[16:17], v[190:191] op_sel:[0,1,0] op_sel_hi:[1,1,1]
    v_pk_fma_f32 v[48:49], v[48:49], v[16:17], v[192:193] op_sel:[0,1,0] op_sel_hi:[1,1,1]
    v_pk_fma_f32 v[50:51], v[50:51], v[16:17], v[194:195] op_sel:[0,1,0] op_sel_hi:[1,1,1]
    v_pk_fma_f32 v[52:53], v[52:53], v[16:17], v[196:197] op_sel:[0,1,0] op_sel_hi:[1,1,1]
    v_pk_fma_f32 v[54:55], v[54:55], v[16:17], v[198:199] op_sel:[0,1,0] op_sel_hi:[1,1,1]
    v_pk_fma_f32 v[56:57], v[56:57], v[16:17], v[200:201] op_sel:[0,1,0] op_sel_hi:[1,1,1]
    v_pk_fma_f32 v[58:59], v[58:59], v[16:17], v[202:203] op_sel:[0,1,0] op_sel_hi:[1,1,1]
    v_pk_mul_f32 v[176:177], v[32:33], v[32:33]
    v_pk_mul_f32 v[178:179], v[34:35], v[34:35]
    v_pk_mul_f32 v[180:181], v[36:37], v[36:37]
    v_pk_mul_f32 v[182:183], v[38:39], v[38:39]
    v_pk_mul_f32 v[184:185], v[40:41], v[40:41]
    buffer_load_dwordx4 v8, s[28:31], s63 offen offset:1024 lds
    v_pk_mul_f32 v[186:187], v[42:43], v[42:43]
    v_pk_mul_f32 v[188:189], v[44:45], v[44:45]
    v_pk_mul_f32 v[190:191], v[46:47], v[46:47]
    v_pk_mul_f32 v[192:193], v[48:49], v[48:49]
    v_pk_mul_f32 v[194:195], v[50:51], v[50:51]
    v_pk_mul_f32 v[196:197], v[52:53], v[52:53]
    v_pk_mul_f32 v[198:199], v[54:55], v[54:55]
    v_pk_mul_f32 v[200:201], v[56:57], v[56:57]
    v_pk_mul_f32 v[202:203], v[58:59], v[58:59]
    v_pk_fma_f32 v[176:177], v[176:177], v[30:31], v[30:31] op_sel:[0,0,1] op_sel_hi:[1,0,1]
    v_pk_fma_f32 v[178:179], v[178:179], v[30:31], v[30:31] op_sel:[0,0,1] op_sel_hi:[1,0,1]
    v_pk_fma_f32 v[180:181], v[180:181], v[30:31], v[30:31] op_sel:[0,0,1] op_sel_hi:[1,0,1]
    v_pk_fma_f32 v[182:183], v[182:183], v[30:31], v[30:31] op_sel:[0,0,1] op_sel_hi:[1,0,1]
    v_pk_fma_f32 v[184:185], v[184:185], v[30:31], v[30:31] op_sel:[0,0,1] op_sel_hi:[1,0,1]
    v_pk_fma_f32 v[186:187], v[186:187], v[30:31], v[30:31] op_sel:[0,0,1] op_sel_hi:[1,0,1]
    v_pk_fma_f32 v[188:189], v[188:189], v[30:31], v[30:31] op_sel:[0,0,1] op_sel_hi:[1,0,1]
    v_pk_fma_f32 v[190:191], v[190:191], v[30:31], v[30:31] op_sel:[0,0,1] op_sel_hi:[1,0,1]
    v_pk_fma_f32 v[192:193], v[192:193], v[30:31], v[30:31] op_sel:[0,0,1] op_sel_hi:[1,0,1]
    v_pk_fma_f32 v[194:195], v[194:195], v[30:31], v[30:31] op_sel:[0,0,1] op_sel_hi:[1,0,1]
    buffer_load_dwordx4 v8, s[28:31], s63 offen offset:2048 lds
    v_pk_fma_f32 v[196:197], v[196:197], v[30:31], v[30:31] op_sel:[0,0,1] op_sel_hi:[1,0,1]
    v_pk_fma_f32 v[198:199], v[198:199], v[30:31], v[30:31] op_sel:[0,0,1] op_sel_hi:[1,0,1]
    v_pk_fma_f32 v[200:201], v[200:201], v[30:31], v[30:31] op_sel:[0,0,1] op_sel_hi:[1,0,1]
    v_pk_fma_f32 v[202:203], v[202:203], v[30:31], v[30:31] op_sel:[0,0,1] op_sel_hi:[1,0,1]
    v_pk_mul_f32 v[176:177], v[176:177], v[32:33]
    v_pk_mul_f32 v[178:179], v[178:179], v[34:35]
    v_pk_mul_f32 v[180:181], v[180:181], v[36:37]
    v_pk_mul_f32 v[182:183], v[182:183], v[38:39]
    v_pk_mul_f32 v[184:185], v[184:185], v[40:41]
    v_pk_mul_f32 v[186:187], v[186:187], v[42:43]
    v_pk_mul_f32 v[188:189], v[188:189], v[44:45]
    v_pk_mul_f32 v[190:191], v[190:191], v[46:47]
    v_pk_mul_f32 v[192:193], v[192:193], v[48:49]
    v_pk_mul_f32 v[194:195], v[194:195], v[50:51]
    v_pk_mul_f32 v[196:197], v[196:197], v[52:53]
    v_pk_mul_f32 v[198:199], v[198:199], v[54:55]
    v_pk_mul_f32 v[200:201], v[200:201], v[56:57]
    v_pk_mul_f32 v[202:203], v[202:203], v[58:59]
    v_exp_f32 v176, v176
    buffer_load_dwordx4 v8, s[28:31], s63 offen offset:3072 lds
    v_exp_f32 v177, v177
    v_exp_f32 v178, v178
    v_exp_f32 v179, v179
    v_exp_f32 v180, v180
    v_exp_f32 v181, v181
    v_exp_f32 v182, v182
    v_exp_f32 v183, v183
    v_exp_f32 v184, v184
    v_exp_f32 v185, v185
    v_exp_f32 v186, v186
    s_add_u32 s62, s62, 4096
    s_add_u32 s63, s63, 4096
    s_mov_b32 m0, s62
    buffer_load_dwordx4 v8, s[28:31], s63 offen offset:0 lds
    v_exp_f32 v187, v187
    v_exp_f32 v188, v188
    v_exp_f32 v189, v189
    v_exp_f32 v190, v190
    v_exp_f32 v191, v191
    v_exp_f32 v192, v192
    v_exp_f32 v193, v193
    v_exp_f32 v194, v194
    v_exp_f32 v195, v195
    v_exp_f32 v196, v196
    buffer_load_dwordx4 v8, s[28:31], s63 offen offset:1024 lds
    v_exp_f32 v197, v197
    v_exp_f32 v198, v198
    v_exp_f32 v199, v199
    v_exp_f32 v200, v200
    v_exp_f32 v201, v201
    v_exp_f32 v202, v202
    v_exp_f32 v203, v203
    v_pk_add_f32 v[176:177], v[176:177], 1.0 op_sel_hi:[1,0]
    v_pk_add_f32 v[178:179], v[178:179], 1.0 op_sel_hi:[1,0]
    v_pk_add_f32 v[180:181], v[180:181], 1.0 op_sel_hi:[1,0]
    v_pk_add_f32 v[182:183], v[182:183], 1.0 op_sel_hi:[1,0]
    v_pk_add_f32 v[184:185], v[184:185], 1.0 op_sel_hi:[1,0]
    buffer_load_dwordx4 a[96:99], v8, s[28:31], s55 offen offset:0
    v_pk_add_f32 v[186:187], v[186:187], 1.0 op_sel_hi:[1,0]
    v_pk_add_f32 v[188:189], v[188:189], 1.0 op_sel_hi:[1,0]
    v_pk_add_f32 v[190:191], v[190:191], 1.0 op_sel_hi:[1,0]
    v_pk_add_f32 v[192:193], v[192:193], 1.0 op_sel_hi:[1,0]
    v_pk_add_f32 v[194:195], v[194:195], 1.0 op_sel_hi:[1,0]
    v_pk_add_f32 v[196:197], v[196:197], 1.0 op_sel_hi:[1,0]
    v_pk_add_f32 v[198:199], v[198:199], 1.0 op_sel_hi:[1,0]
    v_pk_add_f32 v[200:201], v[200:201], 1.0 op_sel_hi:[1,0]
    v_pk_add_f32 v[202:203], v[202:203], 1.0 op_sel_hi:[1,0]
    v_rcp_f32 v176, v176
    v_rcp_f32 v177, v177
    v_rcp_f32 v178, v178
    v_rcp_f32 v179, v179
    v_rcp_f32 v180, v180
    buffer_load_dwordx4 a[100:103], v8, s[28:31], s55 offen offset:1024
    v_rcp_f32 v181, v181
    v_rcp_f32 v182, v182
    v_rcp_f32 v183, v183
    v_rcp_f32 v184, v184
    v_rcp_f32 v185, v185
    v_rcp_f32 v186, v186
    v_rcp_f32 v187, v187
    v_rcp_f32 v188, v188
    v_rcp_f32 v189, v189
    v_rcp_f32 v190, v190
    buffer_load_dwordx4 a[104:107], v8, s[28:31], s55 offen offset:2048
    v_rcp_f32 v191, v191
    v_rcp_f32 v192, v192
    v_rcp_f32 v193, v193
    v_rcp_f32 v194, v194
    v_rcp_f32 v195, v195
    v_rcp_f32 v196, v196
    v_rcp_f32 v197, v197
    v_rcp_f32 v198, v198
    v_rcp_f32 v199, v199
    v_rcp_f32 v200, v200
    buffer_load_dwordx4 a[108:111], v8, s[28:31], s55 offen offset:3072
    v_rcp_f32 v201, v201
    v_rcp_f32 v202, v202
    v_rcp_f32 v203, v203
    v_pk_mul_f32 v[32:33], v[32:33], v[176:177]
    v_pk_mul_f32 v[34:35], v[34:35], v[178:179]
    v_pk_mul_f32 v[36:37], v[36:37], v[180:181]
    v_pk_mul_f32 v[38:39], v[38:39], v[182:183]
    v_pk_mul_f32 v[40:41], v[40:41], v[184:185]
    v_pk_mul_f32 v[42:43], v[42:43], v[186:187]
    v_pk_mul_f32 v[44:45], v[44:45], v[188:189]
    v_pk_mul_f32 v[46:47], v[46:47], v[190:191]
    v_pk_mul_f32 v[48:49], v[48:49], v[192:193]
    v_pk_mul_f32 v[50:51], v[50:51], v[194:195]
    v_pk_mul_f32 v[52:53], v[52:53], v[196:197]
    v_pk_mul_f32 v[54:55], v[54:55], v[198:199]
    v_pk_mul_f32 v[56:57], v[56:57], v[200:201]
    s_add_u32 s55, s55, 4096
    buffer_load_dwordx4 a[112:115], v8, s[28:31], s55 offen offset:0
    s_add_u32 s55, s55, 6144
    v_pk_mul_f32 v[58:59], v[58:59], v[202:203]
    v_cvt_pk_bf16_f32 v144, v32, v33
    v_cvt_pk_bf16_f32 v145, v34, v35
    v_cvt_pk_bf16_f32 v146, v36, v37
    v_cvt_pk_bf16_f32 v147, v38, v39
    v_cvt_pk_bf16_f32 v148, v40, v41
    v_cvt_pk_bf16_f32 v149, v42, v43
    v_cvt_pk_bf16_f32 v150, v44, v45
    v_cvt_pk_bf16_f32 v151, v46, v47
    v_cvt_pk_bf16_f32 v152, v48, v49
    v_cvt_pk_bf16_f32 v153, v50, v51
    v_cvt_pk_bf16_f32 v154, v52, v53
    v_cvt_pk_bf16_f32 v155, v54, v55
    v_cvt_pk_bf16_f32 v156, v56, v57
    v_cvt_pk_bf16_f32 v157, v58, v59
    s_nop 1
    v_permlane16_swap_b32 v144, v146
    v_permlane16_swap_b32 v145, v147
    v_permlane16_swap_b32 v148, v150
    v_permlane16_swap_b32 v149, v151
    v_permlane16_swap_b32 v152, v154
    v_permlane16_swap_b32 v153, v155
    s_add_u32 s26, s13, 0
    s_add_u32 s27, s12, 0
    buffer_store_dwordx4 v[144:147], v226, s[28:31], s26 offen sc1
    buffer_store_dwordx2 v[156:157], v227, s[28:31], s27 offen sc1
    s_cmp_eq_u32 s52, 15
    s_cbranch_scc1 chain_kernel_j157
    buffer_store_dwordx4 v[148:151], v226, s[28:31], s26 offen offset:1024 sc1
    buffer_store_dwordx4 v[152:155], v226, s[28:31], s26 offen offset:2048 sc1
chain_kernel_j157:
    v_pk_mul_f32 v[176:177], v[88:89], v[20:21] op_sel_hi:[1,0]
    buffer_load_dwordx4 a[116:119], v8, s[28:31], s55 offen offset:0
    v_pk_mul_f32 v[178:179], v[90:91], v[20:21] op_sel_hi:[1,0]
    v_pk_mul_f32 v[180:181], v[92:93], v[20:21] op_sel_hi:[1,0]
    v_pk_mul_f32 v[182:183], v[94:95], v[20:21] op_sel_hi:[1,0]
    v_pk_mul_f32 v[184:185], v[96:97], v[20:21] op_sel_hi:[1,0]
    v_pk_mul_f32 v[186:187], v[98:99], v[20:21] op_sel_hi:[1,0]
    v_pk_mul_f32 v[188:189], v[100:101], v[20:21] op_sel_hi:[1,0]
    v_pk_mul_f32 v[190:191], v[102:103], v[20:21] op_sel_hi:[1,0]
    v_pk_mul_f32 v[192:193], v[104:105], v[20:21] op_sel_hi:[1,0]
    v_pk_mul_f32 v[194:195], v[106:107], v[20:21] op_sel_hi:[1,0]
    v_pk_mul_f32 v[196:197], v[108:109], v[20:21] op_sel_hi:[1,0]
    v_pk_mul_f32 v[198:199], v[110:111], v[20:21] op_sel_hi:[1,0]
    v_pk_mul_f32 v[200:201], v[112:113], v[20:21] op_sel_hi:[1,0]
    v_pk_mul_f32 v[202:203], v[114:115], v[20:21] op_sel_hi:[1,0]
    v_pk_fma_f32 v[60:61], v[60:61], v[20:21], v[176:177] op_sel:[0,1,0] op_sel_hi:[1,1,1]
    v_pk_fma_f32 v[62:63], v[62:63], v[20:21], v[178:179] op_sel:[0,1,0] op_sel_hi:[1,1,1]
    v_pk_fma_f32 v[64:65], v[64:65], v[20:21], v[180:181] op_sel:[0,1,0] op_sel_hi:[1,1,1]
    v_pk_fma_f32 v[66:67], v[66:67], v[20:21], v[182:183] op_sel:[0,1,0] op_sel_hi:[1,1,1]
    v_pk_fma_f32 v[68:69], v[68:69], v[20:21], v[184:185] op_sel:[0,1,0] op_sel_hi:[1,1,1]
    v_pk_fma_f32 v[70:71], v[70:71], v[20:21], v[186:187] op_sel:[0,1,0] op_sel_hi:[1,1,1]
    buffer_load_dwordx4 a[120:123], v8, s[28:31], s55 offen offset:1024
    v_pk_fma_f32 v[72:73], v[72:73], v[20:21], v[188:189] op_sel:[0,1,0] op_sel_hi:[1,1,1]
    v_pk_fma_f32 v[74:75], v[74:75], v[20:21], v[190:191] op_sel:[0,1,0] op_sel_hi:[1,1,1]
    v_pk_fma_f32 v[76:77], v[76:77], v[20:21], v[192:193] op_sel:[0,1,0] op_sel_hi:[1,1,1]
    v_pk_fma_f32 v[78:79], v[78:79], v[20:21], v[194:195] op_sel:[0,1,0] op_sel_hi:[1,1,1]
    v_pk_fma_f32 v[80:81], v[80:81], v[20:21], v[196:197] op_sel:[0,1,0] op_sel_hi:[1,1,1]
    v_pk_fma_f32 v[82:83], v[82:83], v[20:21], v[198:199] op_sel:[0,1,0] op_sel_hi:[1,1,1]
    v_pk_fma_f32 v[84:85], v[84:85], v[20:21], v[200:201] op_sel:[0,1,0] op_sel_hi:[1,1,1]
    v_pk_fma_f32 v[86:87], v[86:87], v[20:21], v[202:203] op_sel:[0,1,0] op_sel_hi:[1,1,1]
    v_pk_mul_f32 v[176:177], v[60:61], v[60:61]
    v_pk_mul_f32 v[178:179], v[62:63], v[62:63]
    v_pk_mul_f32 v[180:181], v[64:65], v[64:65]
    v_pk_mul_f32 v[182:183], v[66:67], v[66:67]
    v_pk_mul_f32 v[184:185], v[68:69], v[68:69]
    v_pk_mul_f32 v[186:187], v[70:71], v[70:71]
    v_pk_mul_f32 v[188:189], v[72:73], v[72:73]
    v_pk_mul_f32 v[190:191], v[74:75], v[74:75]
    v_pk_mul_f32 v[192:193], v[76:77], v[76:77]
    v_pk_mul_f32 v[194:195], v[78:79], v[78:79]
    v_pk_mul_f32 v[196:197], v[80:81], v[80:81]
    buffer_load_dwordx4 a[124:127], v8, s[28:31], s55 offen offset:2048
    v_pk_mul_f32 v[198:199], v[82:83], v[82:83]
    v_pk_mul_f32 v[200:201], v[84:85], v[84:85]
    v_pk_mul_f32 v[202:203], v[86:87], v[86:87]
    v_pk_fma_f32 v[176:177], v[176:177], v[30:31], v[30:31] op_sel:[0,0,1] op_sel_hi:[1,0,1]
    v_pk_fma_f32 v[178:179], v[178:179], v[30:31], v[30:31] op_sel:[0,0,1] op_sel_hi:[1,0,1]
    v_pk_fma_f32 v[180:181], v[180:181], v[30:31], v[30:31] op_sel:[0,0,1] op_sel_hi:[1,0,1]
    v_pk_fma_f32 v[182:183], v[182:183], v[30:31], v[30:31] op_sel:[0,0,1] op_sel_hi:[1,0,1]
    v_pk_fma_f32 v[184:185], v[184:185], v[30:31], v[30:31] op_sel:[0,0,1] op_sel_hi:[1,0,1]
    v_pk_fma_f32 v[186:187], v[186:187], v[30:31], v[30:31] op_sel:[0,0,1] op_sel_hi:[1,0,1]
    v_pk_fma_f32 v[188:189], v[188:189], v[30:31], v[30:31] op_sel:[0,0,1] op_sel_hi:[1,0,1]
    v_pk_fma_f32 v[190:191], v[190:191], v[30:31], v[30:31] op_sel:[0,0,1] op_sel_hi:[1,0,1]
    v_pk_fma_f32 v[192:193], v[192:193], v[30:31], v[30:31] op_sel:[0,0,1] op_sel_hi:[1,0,1]
    v_pk_fma_f32 v[194:195], v[194:195], v[30:31], v[30:31] op_sel:[0,0,1] op_sel_hi:[1,0,1]
    v_pk_fma_f32 v[196:197], v[196:197], v[30:31], v[30:31] op_sel:[0,0,1] op_sel_hi:[1,0,1]
    v_pk_fma_f32 v[198:199], v[198:199], v[30:31], v[30:31] op_sel:[0,0,1] op_sel_hi:[1,0,1]
    v_pk_fma_f32 v[200:201], v[200:201], v[30:31], v[30:31] op_sel:[0,0,1] op_sel_hi:[1,0,1]
    v_pk_fma_f32 v[202:203], v[202:203], v[30:31], v[30:31] op_sel:[0,0,1] op_sel_hi:[1,0,1]
    v_pk_mul_f32 v[176:177], v[176:177], v[60:61]
    v_pk_mul_f32 v[178:179], v[178:179], v[62:63]
    buffer_load_dwordx4 a[128:131], v8, s[28:31], s55 offen offset:3072
    v_pk_mul_f32 v[180:181], v[180:181], v[64:65]
    v_pk_mul_f32 v[182:183], v[182:183], v[66:67]
    v_pk_mul_f32 v[184:185], v[184:185], v[68:69]
    v_pk_mul_f32 v[186:187], v[186:187], v[70:71]
    v_pk_mul_f32 v[188:189], v[188:189], v[72:73]
    v_pk_mul_f32 v[190:191], v[190:191], v[74:75]
    v_pk_mul_f32 v[192:193], v[192:193], v[76:77]
    v_pk_mul_f32 v[194:195], v[194:195], v[78:79]
    v_pk_mul_f32 v[196:197], v[196:197], v[80:81]
    v_pk_mul_f32 v[198:199], v[198:199], v[82:83]
    v_pk_mul_f32 v[200:201], v[200:201], v[84:85]
    v_pk_mul_f32 v[202:203], v[202:203], v[86:87]
    v_exp_f32 v176, v176
    v_exp_f32 v177, v177
    v_exp_f32 v178, v178
    v_exp_f32 v179, v179
    s_add_u32 s55, s55, 4096
    buffer_load_dwordx4 a[132:135], v8, s[28:31], s55 offen offset:0
    s_add_u32 s55, s55, 6144
    v_exp_f32 v180, v180
    v_exp_f32 v181, v181
    v_exp_f32 v182, v182
    v_exp_f32 v183, v183
    v_exp_f32 v184, v184
    v_exp_f32 v185, v185
    v_exp_f32 v186, v186
    v_exp_f32 v187, v187
    v_exp_f32 v188, v188
    v_exp_f32 v189, v189
    buffer_load_dwordx4 a[136:139], v8, s[28:31], s55 offen offset:0
    v_exp_f32 v190, v190
    v_exp_f32 v191, v191
    v_exp_f32 v192, v192
    v_exp_f32 v193, v193
    v_exp_f32 v194, v194
    v_exp_f32 v195, v195
    v_exp_f32 v196, v196
    v_exp_f32 v197, v197
    v_exp_f32 v198, v198
    v_exp_f32 v199, v199
    buffer_load_dwordx4 a[140:143], v8, s[28:31], s55 offen offset:1024
    v_exp_f32 v200, v200
    v_exp_f32 v201, v201
    v_exp_f32 v202, v202
    v_exp_f32 v203, v203
    v_pk_add_f32 v[176:177], v[176:177], 1.0 op_sel_hi:[1,0]
    v_pk_add_f32 v[178:179], v[178:179], 1.0 op_sel_hi:[1,0]
    v_pk_add_f32 v[180:181], v[180:181], 1.0 op_sel_hi:[1,0]
    v_pk_add_f32 v[182:183], v[182:183], 1.0 op_sel_hi:[1,0]
    v_pk_add_f32 v[184:185], v[184:185], 1.0 op_sel_hi:[1,0]
    v_pk_add_f32 v[186:187], v[186:187], 1.0 op_sel_hi:[1,0]
    v_pk_add_f32 v[188:189], v[188:189], 1.0 op_sel_hi:[1,0]
    v_pk_add_f32 v[190:191], v[190:191], 1.0 op_sel_hi:[1,0]
    v_pk_add_f32 v[192:193], v[192:193], 1.0 op_sel_hi:[1,0]
    v_pk_add_f32 v[194:195], v[194:195], 1.0 op_sel_hi:[1,0]
    v_pk_add_f32 v[196:197], v[196:197], 1.0 op_sel_hi:[1,0]
    buffer_load_dwordx4 a[144:147], v8, s[28:31], s55 offen offset:2048
    v_pk_add_f32 v[198:199], v[198:199], 1.0 op_sel_hi:[1,0]
    v_pk_add_f32 v[200:201], v[200:201], 1.0 op_sel_hi:[1,0]
    v_pk_add_f32 v[202:203], v[202:203], 1.0 op_sel_hi:[1,0]
    v_rcp_f32 v176, v176
    v_rcp_f32 v177, v177
    v_rcp_f32 v178, v178
    v_rcp_f32 v179, v179
    v_rcp_f32 v180, v180
    v_rcp_f32 v181, v181
    v_rcp_f32 v182, v182
    v_rcp_f32 v183, v183
    buffer_load_dwordx4 a[148:151], v8, s[28:31], s55 offen offset:3072
    v_rcp_f32 v184, v184
    v_rcp_f32 v185, v185
    v_rcp_f32 v186, v186
    v_rcp_f32 v187, v187
    v_rcp_f32 v188, v188
    v_rcp_f32 v189, v189
    v_rcp_f32 v190, v190
    v_rcp_f32 v191, v191
    v_rcp_f32 v192, v192
    v_rcp_f32 v193, v193
    s_add_u32 s55, s55, 4096
    buffer_load_dwordx4 a[152:155], v8, s[28:31], s55 offen offset:0
    s_add_u32 s55, s55, 6144
    v_rcp_f32 v194, v194
    v_rcp_f32 v195, v195
    v_rcp_f32 v196, v196
    v_rcp_f32 v197, v197
    v_rcp_f32 v198, v198
    v_rcp_f32 v199, v199
    v_rcp_f32 v200, v200
    v_rcp_f32 v201, v201
    v_rcp_f32 v202, v202
    v_rcp_f32 v203, v203
    buffer_load_dwordx4 a[156:159], v8, s[28:31], s55 offen offset:0
    v_pk_mul_f32 v[60:61], v[60:61], v[176:177]
    v_pk_mul_f32 v[62:63], v[62:63], v[178:179]
    v_pk_mul_f32 v[64:65], v[64:65], v[180:181]
    v_pk_mul_f32 v[66:67], v[66:67], v[182:183]
    v_pk_mul_f32 v[68:69], v[68:69], v[184:185]
    v_pk_mul_f32 v[70:71], v[70:71], v[186:187]
    v_pk_mul_f32 v[72:73], v[72:73], v[188:189]
    v_pk_mul_f32 v[74:75], v[74:75], v[190:191]
    v_pk_mul_f32 v[76:77], v[76:77], v[192:193]
    v_pk_mul_f32 v[78:79], v[78:79], v[194:195]
    v_pk_mul_f32 v[80:81], v[80:81], v[196:197]
    v_pk_mul_f32 v[82:83], v[82:83], v[198:199]
    v_pk_mul_f32 v[84:85], v[84:85], v[200:201]
    v_pk_mul_f32 v[86:87], v[86:87], v[202:203]
    v_cvt_pk_bf16_f32 v160, v60, v61
    v_cvt_pk_bf16_f32 v161, v62, v63
    v_cvt_pk_bf16_f32 v162, v64, v65
    v_cvt_pk_bf16_f32 v163, v66, v67
    v_cvt_pk_bf16_f32 v164, v68, v69
    v_cvt_pk_bf16_f32 v165, v70, v71
    v_cvt_pk_bf16_f32 v166, v72, v73
    v_cvt_pk_bf16_f32 v167, v74, v75
    v_cvt_pk_bf16_f32 v168, v76, v77
    v_cvt_pk_bf16_f32 v169, v78, v79
    v_cvt_pk_bf16_f32 v170, v80, v81
    v_cvt_pk_bf16_f32 v171, v82, v83
    v_cvt_pk_bf16_f32 v172, v84, v85
    v_cvt_pk_bf16_f32 v173, v86, v87
    s_nop 1
    v_permlane16_swap_b32 v160, v162
    v_permlane16_swap_b32 v161, v163
    v_permlane16_swap_b32 v164, v166
    v_permlane16_swap_b32 v165, v167
    v_permlane16_swap_b32 v168, v170
    v_permlane16_swap_b32 v169, v171
    s_add_u32 s26, s13, 55296
    s_add_u32 s27, s12, 55296
    buffer_store_dwordx4 v[160:163], v226, s[28:31], s26 offen sc1
    buffer_store_dwordx2 v[172:173], v227, s[28:31], s27 offen sc1
    s_cmp_eq_u32 s52, 15
    s_cbranch_scc1 chain_kernel_j158
    buffer_store_dwordx4 v[164:167], v226, s[28:31], s26 offen offset:1024 sc1
    buffer_store_dwordx4 v[168:171], v226, s[28:31], s26 offen offset:2048 sc1
chain_kernel_j158:
    s_waitcnt vmcnt(0)
    v_mov_b32 v2, 1
    v_mov_b32 v7, 0
    s_mov_b64 exec, 1
    buffer_store_dword v2, v7, s[28:31], s15 offen sc1
    s_mov_b64 exec, -1
    buffer_load_dwordx4 a[160:163], v8, s[28:31], s55 offen offset:1024
    buffer_load_dwordx4 a[164:167], v8, s[28:31], s55 offen offset:2048
    buffer_load_dwordx4 a[168:171], v8, s[28:31], s55 offen offset:3072
    s_add_u32 s55, s55, 4096
    buffer_load_dwordx4 a[172:175], v8, s[28:31], s55 offen offset:0
    s_add_u32 s55, s55, 6144
    buffer_load_dwordx4 a[176:179], v8, s[28:31], s55 offen offset:0
    buffer_load_dwordx4 a[180:183], v8, s[28:31], s55 offen offset:1024
    buffer_load_dwordx4 a[184:187], v8, s[28:31], s55 offen offset:2048
    buffer_load_dwordx4 a[188:191], v8, s[28:31], s55 offen offset:3072
    s_add_u32 s55, s55, 4096
    buffer_load_dwordx4 a[192:195], v8, s[28:31], s55 offen offset:0
    s_add_u32 s55, s55, 6144
    buffer_load_dwordx4 a[196:199], v8, s[28:31], s55 offen offset:0
    buffer_load_dwordx4 a[200:203], v8, s[28:31], s55 offen offset:1024
    buffer_load_dwordx4 a[204:207], v8, s[28:31], s55 offen offset:2048
    buffer_load_dwordx4 a[208:211], v8, s[28:31], s55 offen offset:3072
    s_add_u32 s55, s55, 4096
    buffer_load_dwordx4 a[212:215], v8, s[28:31], s55 offen offset:0
    s_add_u32 s55, s55, 6144
    buffer_load_dwordx4 a[216:219], v8, s[28:31], s55 offen offset:0
    buffer_load_dwordx4 a[220:223], v8, s[28:31], s55 offen offset:1024
    buffer_load_dwordx4 a[224:227], v8, s[28:31], s55 offen offset:2048
    buffer_load_dwordx4 a[228:231], v8, s[28:31], s55 offen offset:3072
    s_add_u32 s55, s55, 4096
    buffer_load_dwordx4 a[232:235], v8, s[28:31], s55 offen offset:0
    s_add_u32 s55, s55, 6144
    buffer_load_dwordx4 a[236:239], v8, s[28:31], s55 offen offset:0
    buffer_load_dwordx4 a[240:243], v8, s[28:31], s55 offen offset:1024
    buffer_load_dwordx4 a[244:247], v8, s[28:31], s55 offen offset:2048
    buffer_load_dwordx4 a[248:251], v8, s[28:31], s55 offen offset:3072
    s_add_u32 s55, s55, 4096
    buffer_load_dwordx4 a[252:255], v8, s[28:31], s55 offen offset:0
    s_add_u32 s55, s55, 6144
    s_mul_i32 s26, s22, 5120
    v_add_u32 v12, s26, v8
    v_add_u32 v13, 0x10000, v12
    v_add_u32 v14, 0x20000, v12
    s_mov_b32 s47, 0
    s_mov_b64 exec, 511
chain_kernel_poll9:
    buffer_load_dword v2, v234, s[28:31], s48 offen sc1
    s_add_u32 s47, s47, 1
    s_waitcnt vmcnt(0)
    v_cmp_ne_u32 vcc, 1, v2
    s_cmp_ge_u32 s47, 200000
    s_cbranch_scc1 chain_kernel_polld10
    s_cbranch_vccnz chain_kernel_poll9
chain_kernel_polld10:
    s_mov_b64 exec, -1
    buffer_load_dwordx4 a[0:3], v8, s[28:31], s50 offen offset:0 sc1
    buffer_load_dwordx4 a[4:7], v8, s[28:31], s51 offen offset:0 sc1
    buffer_load_dwordx4 a[8:11], v8, s[28:31], s50 offen offset:1024 sc1
    buffer_load_dwordx4 a[12:15], v8, s[28:31], s51 offen offset:1024 sc1
    buffer_load_dwordx4 a[16:19], v8, s[28:31], s50 offen offset:2048 sc1
    buffer_load_dwordx4 a[20:23], v8, s[28:31], s51 offen offset:2048 sc1
    buffer_load_dwordx4 a[24:27], v8, s[28:31], s50 offen offset:3072 sc1
    buffer_load_dwordx4 a[28:31], v8, s[28:31], s51 offen offset:3072 sc1
    s_add_u32 s50, s50, 4096
    s_add_u32 s51, s51, 4096
    buffer_load_dwordx4 a[32:35], v8, s[28:31], s50 offen offset:0 sc1
    buffer_load_dwordx4 a[36:39], v8, s[28:31], s51 offen offset:0 sc1
    s_barrier
    ds_read_b128 v[136:139], v14 offset:12288
    ds_read_b128 v[140:143], v14 offset:13312
    ds_read_b128 v[144:147], v14 offset:14336
    ds_read_b128 v[148:151], v14 offset:15360
    ds_read_b128 v[152:155], v14 offset:16384
    ds_read_b128 v[156:159], v12 offset:0
    ds_read_b128 v[160:163], v12 offset:1024
    ds_read_b128 v[164:167], v12 offset:2048
    ds_read_b128 v[168:171], v12 offset:3072
    ds_read_b128 v[172:175], v12 offset:4096
    ds_read_b128 v[176:179], v12 offset:10240
    s_waitcnt vmcnt(8) lgkmcnt(6)
    v_mfma_f32_16x16x32_bf16 v[32:35], v[136:139], a[0:3], 0
    v_mfma_f32_16x16x32_bf16 v[52:55], v[136:139], a[4:7], 0
    ds_read_b128 v[180:183], v12 offset:11264
    buffer_load_dwordx4 a[40:43], v8, s[28:31], s50 offen offset:1024 sc1
    v_mfma_f32_16x16x32_bf16 v[36:39], v[140:143], a[0:3], 0
    v_mfma_f32_16x16x32_bf16 v[56:59], v[140:143], a[4:7], 0
    ds_read_b128 v[136:139], v12 offset:12288
    v_mfma_f32_16x16x32_bf16 v[40:43], v[144:147], a[0:3], 0
    v_mfma_f32_16x16x32_bf16 v[60:63], v[144:147], a[4:7], 0
    ds_read_b128 v[140:143], v12 offset:13312
    buffer_load_dwordx4 a[44:47], v8, s[28:31], s51 offen offset:1024 sc1
    v_mfma_f32_16x16x32_bf16 v[44:47], v[148:151], a[0:3], 0
    v_mfma_f32_16x16x32_bf16 v[64:67], v[148:151], a[4:7], 0
    ds_read_b128 v[144:147], v12 offset:14336
    v_mfma_f32_16x16x32_bf16 v[48:51], v[152:155], a[0:3], 0
    v_mfma_f32_16x16x32_bf16 v[68:71], v[152:155], a[4:7], 0
    ds_read_b128 v[148:151], v12 offset:20480
    buffer_load_dwordx4 a[48:51], v8, s[28:31], s50 offen offset:2048 sc1
    s_waitcnt vmcnt(9) lgkmcnt(6)
    v_mfma_f32_16x16x32_bf16 v[32:35], v[156:159], a[8:11], v[32:35]
    v_mfma_f32_16x16x32_bf16 v[52:55], v[156:159], a[12:15], v[52:55]
    ds_read_b128 v[152:155], v12 offset:21504
    v_mfma_f32_16x16x32_bf16 v[36:39], v[160:163], a[8:11], v[36:39]
    v_mfma_f32_16x16x32_bf16 v[56:59], v[160:163], a[12:15], v[56:59]
    ds_read_b128 v[156:159], v12 offset:22528
    buffer_load_dwordx4 a[52:55], v8, s[28:31], s51 offen offset:2048 sc1
    v_mfma_f32_16x16x32_bf16 v[40:43], v[164:167], a[8:11], v[40:43]
    v_mfma_f32_16x16x32_bf16 v[60:63], v[164:167], a[12:15], v[60:63]
    ds_read_b128 v[160:163], v12 offset:23552
    v_mfma_f32_16x16x32_bf16 v[44:47], v[168:171], a[8:11], v[44:47]
    v_mfma_f32_16x16x32_bf16 v[64:67], v[168:171], a[12:15], v[64:67]
    ds_read_b128 v[164:167], v12 offset:24576
    buffer_load_dwordx4 a[56:59], v8, s[28:31], s50 offen offset:3072 sc1
    v_mfma_f32_16x16x32_bf16 v[48:51], v[172:175], a[8:11], v[48:51]
    v_mfma_f32_16x16x32_bf16 v[68:71], v[172:175], a[12:15], v[68:71]
    s_waitcnt lgkmcnt(5)
    s_barrier
    ds_read_b128 v[168:171], v12 offset:30720
    s_mul_i32 s25, s20, 3
    s_min_u32 s25, s25, 7
    s_lshl_b32 s25, s25, 10
    s_add_u32 s62, s25, 143360
    s_add_u32 s63, s25, s59
    s_add_u32 s63, s63, 163840
    s_mov_b32 m0, s62
    buffer_load_dwordx4 v8, s[28:31], s63 offen offset:0 lds
    s_waitcnt vmcnt(10) lgkmcnt(6)
    v_mfma_f32_16x16x32_bf16 v[32:35], v[176:179], a[16:19], v[32:35]
    v_mfma_f32_16x16x32_bf16 v[52:55], v[176:179], a[20:23], v[52:55]
    ds_read_b128 v[172:175], v12 offset:31744
    buffer_load_dwordx4 v8, s[28:31], s63 offen offset:1024 lds
    v_mfma_f32_16x16x32_bf16 v[36:39], v[180:183], a[16:19], v[36:39]
    v_mfma_f32_16x16x32_bf16 v[56:59], v[180:183], a[20:23], v[56:59]
    ds_read_b128 v[176:179], v12 offset:32768
    buffer_load_dwordx4 v8, s[28:31], s63 offen offset:2048 lds
    v_mfma_f32_16x16x32_bf16 v[40:43], v[136:139], a[16:19], v[40:43]
    v_mfma_f32_16x16x32_bf16 v[60:63], v[136:139], a[20:23], v[60:63]
    ds_read_b128 v[180:183], v12 offset:33792
    s_mul_i32 s25, s20, 5
    s_lshl_b32 s25, s25, 10
    s_add_u32 s62, s25, 0
    s_add_u32 s63, s25, s59
    s_add_u32 s63, s63, 174080
    s_mov_b32 m0, s62
    buffer_load_dwordx4 v8, s[28:31], s63 offen offset:0 lds
    v_mfma_f32_16x16x32_bf16 v[44:47], v[140:143], a[16:19], v[44:47]
    v_mfma_f32_16x16x32_bf16 v[64:67], v[140:143], a[20:23], v[64:67]
    ds_read_b128 v[136:139], v12 offset:34816
    buffer_load_dwordx4 v8, s[28:31], s63 offen offset:1024 lds
    v_mfma_f32_16x16x32_bf16 v[48:51], v[144:147], a[16:19], v[48:51]
    v_mfma_f32_16x16x32_bf16 v[68:71], v[144:147], a[20:23], v[68:71]
    ds_read_b128 v[140:143], v12 offset:40960
    buffer_load_dwordx4 v8, s[28:31], s63 offen offset:2048 lds
    s_waitcnt vmcnt(13) lgkmcnt(6)
    v_mfma_f32_16x16x32_bf16 v[32:35], v[148:151], a[24:27], v[32:35]
    v_mfma_f32_16x16x32_bf16 v[52:55], v[148:151], a[28:31], v[52:55]
    ds_read_b128 v[144:147], v12 offset:41984
    buffer_load_dwordx4 v8, s[28:31], s63 offen offset:3072 lds
    v_mfma_f32_16x16x32_bf16 v[36:39], v[152:155], a[24:27], v[36:39]
    v_mfma_f32_16x16x32_bf16 v[56:59], v[152:155], a[28:31], v[56:59]
    ds_read_b128 v[148:151], v12 offset:43008
    s_add_u32 s62, s62, 4096
    s_add_u32 s63, s63, 4096
    s_mov_b32 m0, s62
    buffer_load_dwordx4 v8, s[28:31], s63 offen offset:0 lds
    v_mfma_f32_16x16x32_bf16 v[40:43], v[156:159], a[24:27], v[40:43]
    v_mfma_f32_16x16x32_bf16 v[60:63], v[156:159], a[28:31], v[60:63]
    ds_read_b128 v[152:155], v12 offset:44032
    v_mfma_f32_16x16x32_bf16 v[44:47], v[160:163], a[24:27], v[44:47]
    v_mfma_f32_16x16x32_bf16 v[64:67], v[160:163], a[28:31], v[64:67]
    ds_read_b128 v[156:159], v12 offset:45056
    buffer_load_dwordx4 a[60:63], v8, s[28:31], s51 offen offset:3072 sc1
    v_mfma_f32_16x16x32_bf16 v[48:51], v[164:167], a[24:27], v[48:51]
    v_mfma_f32_16x16x32_bf16 v[68:71], v[164:167], a[28:31], v[68:71]
    ds_read_b128 v[160:163], v12 offset:51200
    s_waitcnt vmcnt(14) lgkmcnt(6)
    v_mfma_f32_16x16x32_bf16 v[32:35], v[168:171], a[32:35], v[32:35]
    v_mfma_f32_16x16x32_bf16 v[52:55], v[168:171], a[36:39], v[52:55]
    ds_read_b128 v[164:167], v12 offset:52224
    s_add_u32 s50, s50, 4096
    s_add_u32 s51, s51, 4096
    buffer_load_dwordx4 a[64:67], v8, s[28:31], s50 offen offset:0 sc1
    v_mfma_f32_16x16x32_bf16 v[36:39], v[172:175], a[32:35], v[36:39]
    v_mfma_f32_16x16x32_bf16 v[56:59], v[172:175], a[36:39], v[56:59]
    ds_read_b128 v[168:171], v12 offset:53248
    v_mfma_f32_16x16x32_bf16 v[40:43], v[176:179], a[32:35], v[40:43]
    v_mfma_f32_16x16x32_bf16 v[60:63], v[176:179], a[36:39], v[60:63]
    ds_read_b128 v[172:175], v12 offset:54272
    buffer_load_dwordx4 a[68:71], v8, s[28:31], s51 offen offset:0 sc1
    v_mfma_f32_16x16x32_bf16 v[44:47], v[180:183], a[32:35], v[44:47]
    v_mfma_f32_16x16x32_bf16 v[64:67], v[180:183], a[36:39], v[64:67]
    ds_read_b128 v[176:179], v12 offset:55296
    v_mfma_f32_16x16x32_bf16 v[48:51], v[136:139], a[32:35], v[48:51]
    v_mfma_f32_16x16x32_bf16 v[68:71], v[136:139], a[36:39], v[68:71]
    ds_read_b128 v[180:183], v12 offset:61440
    buffer_load_dwordx4 a[72:75], v8, s[28:31], s50 offen offset:1024 sc1
    s_waitcnt vmcnt(15) lgkmcnt(6)
    v_mfma_f32_16x16x32_bf16 v[32:35], v[140:143], a[40:43], v[32:35]
    v_mfma_f32_16x16x32_bf16 v[52:55], v[140:143], a[44:47], v[52:55]
    ds_read_b128 v[136:139], v12 offset:62464
    v_mfma_f32_16x16x32_bf16 v[36:39], v[144:147], a[40:43], v[36:39]
    v_mfma_f32_16x16x32_bf16 v[56:59], v[144:147], a[44:47], v[56:59]
    ds_read_b128 v[140:143], v12 offset:63488
    buffer_load_dwordx4 a[76:79], v8, s[28:31], s51 offen offset:1024 sc1
    v_mfma_f32_16x16x32_bf16 v[40:43], v[148:151], a[40:43], v[40:43]
    v_mfma_f32_16x16x32_bf16 v[60:63], v[148:151], a[44:47], v[60:63]
    ds_read_b128 v[144:147], v12 offset:64512
    v_mfma_f32_16x16x32_bf16 v[44:47], v[152:155], a[40:43], v[44:47]
    v_mfma_f32_16x16x32_bf16 v[64:67], v[152:155], a[44:47], v[64:67]
    ds_read_b128 v[148:151], v13 offset:0
    buffer_load_dwordx4 a[80:83], v8, s[28:31], s50 offen offset:2048 sc1
    v_mfma_f32_16x16x32_bf16 v[48:51], v[156:159], a[40:43], v[48:51]
    v_mfma_f32_16x16x32_bf16 v[68:71], v[156:159], a[44:47], v[68:71]
    ds_read_b128 v[152:155], v13 offset:6144
    s_waitcnt vmcnt(15) lgkmcnt(6)
    v_mfma_f32_16x16x32_bf16 v[32:35], v[160:163], a[48:51], v[32:35]
    v_mfma_f32_16x16x32_bf16 v[52:55], v[160:163], a[52:55], v[52:55]
    ds_read_b128 v[156:159], v13 offset:7168
    buffer_load_dwordx4 a[84:87], v8, s[28:31], s51 offen offset:2048 sc1
    v_mfma_f32_16x16x32_bf16 v[36:39], v[164:167], a[48:51], v[36:39]
    v_mfma_f32_16x16x32_bf16 v[56:59], v[164:167], a[52:55], v[56:59]
    ds_read_b128 v[160:163], v13 offset:8192
    v_mfma_f32_16x16x32_bf16 v[40:43], v[168:171], a[48:51], v[40:43]
    v_mfma_f32_16x16x32_bf16 v[60:63], v[168:171], a[52:55], v[60:63]
    ds_read_b128 v[164:167], v13 offset:9216
    buffer_load_dwordx4 a[88:91], v8, s[28:31], s50 offen offset:3072 sc1
    v_mfma_f32_16x16x32_bf16 v[44:47], v[172:175], a[48:51], v[44:47]
    v_mfma_f32_16x16x32_bf16 v[64:67], v[172:175], a[52:55], v[64:67]
    ds_read_b128 v[168:171], v13 offset:10240
    v_mfma_f32_16x16x32_bf16 v[48:51], v[176:179], a[48:51], v[48:51]
    v_mfma_f32_16x16x32_bf16 v[68:71], v[176:179], a[52:55], v[68:71]
    ds_read_b128 v[172:175], v14 offset:22528
    buffer_load_dwordx4 a[92:95], v8, s[28:31], s51 offen offset:3072 sc1
    s_waitcnt vmcnt(8) lgkmcnt(6)
    v_mfma_f32_16x16x32_bf16 v[32:35], v[180:183], a[56:59], v[32:35]
    v_mfma_f32_16x16x32_bf16 v[52:55], v[180:183], a[60:63], v[52:55]
    ds_read_b128 v[176:179], v14 offset:23552
    v_mfma_f32_16x16x32_bf16 v[36:39], v[136:139], a[56:59], v[36:39]
    v_mfma_f32_16x16x32_bf16 v[56:59], v[136:139], a[60:63], v[56:59]
    ds_read_b128 v[180:183], v14 offset:24576
    s_add_u32 s50, s50, 4096
    s_add_u32 s51, s51, 4096
    buffer_load_dwordx4 a[0:3], v8, s[28:31], s50 offen offset:0 sc1
    v_mfma_f32_16x16x32_bf16 v[40:43], v[140:143], a[56:59], v[40:43]
    v_mfma_f32_16x16x32_bf16 v[60:63], v[140:143], a[60:63], v[60:63]
    ds_read_b128 v[136:139], v14 offset:25600
    v_mfma_f32_16x16x32_bf16 v[44:47], v[144:147], a[56:59], v[44:47]
    v_mfma_f32_16x16x32_bf16 v[64:67], v[144:147], a[60:63], v[64:67]
    ds_read_b128 v[140:143], v14 offset:26624
    buffer_load_dwordx4 a[4:7], v8, s[28:31], s51 offen offset:0 sc1
    v_mfma_f32_16x16x32_bf16 v[48:51], v[148:151], a[56:59], v[48:51]
    v_mfma_f32_16x16x32_bf16 v[68:71], v[148:151], a[60:63], v[68:71]
    ds_read_b128 v[144:147], v13 offset:57344
    s_waitcnt vmcnt(8) lgkmcnt(6)
    v_mfma_f32_16x16x32_bf16 v[32:35], v[152:155], a[64:67], v[32:35]
    v_mfma_f32_16x16x32_bf16 v[52:55], v[152:155], a[68:71], v[52:55]
    ds_read_b128 v[148:151], v13 offset:58368
    buffer_load_dwordx4 a[8:11], v8, s[28:31], s50 offen offset:1024 sc1
    v_mfma_f32_16x16x32_bf16 v[36:39], v[156:159], a[64:67], v[36:39]
    v_mfma_f32_16x16x32_bf16 v[56:59], v[156:159], a[68:71], v[56:59]
    ds_read_b128 v[152:155], v13 offset:59392
    buffer_load_dwordx4 a[12:15], v8, s[28:31], s51 offen offset:1024 sc1
    v_mfma_f32_16x16x32_bf16 v[40:43], v[160:163], a[64:67], v[40:43]
    v_mfma_f32_16x16x32_bf16 v[60:63], v[160:163], a[68:71], v[60:63]
    ds_read_b128 v[156:159], v13 offset:60416
    buffer_load_dwordx4 a[16:19], v8, s[28:31], s50 offen offset:2048 sc1
    v_mfma_f32_16x16x32_bf16 v[44:47], v[164:167], a[64:67], v[44:47]
    v_mfma_f32_16x16x32_bf16 v[64:67], v[164:167], a[68:71], v[64:67]
    ds_read_b128 v[160:163], v13 offset:61440
    v_mfma_f32_16x16x32_bf16 v[48:51], v[168:171], a[64:67], v[48:51]
    v_mfma_f32_16x16x32_bf16 v[68:71], v[168:171], a[68:71], v[68:71]
    ds_read_b128 v[164:167], v14 offset:2048
    buffer_load_dwordx4 a[20:23], v8, s[28:31], s51 offen offset:2048 sc1
    s_waitcnt vmcnt(10) lgkmcnt(6)
    v_mfma_f32_16x16x32_bf16 v[32:35], v[172:175], a[72:75], v[32:35]
    v_mfma_f32_16x16x32_bf16 v[52:55], v[172:175], a[76:79], v[52:55]
    ds_read_b128 v[168:171], v14 offset:3072
    s_add_u32 s26, s44, 13406208
    buffer_load_dwordx2 v[96:97], v230, s[28:31], s26 offen sc1
    v_mfma_f32_16x16x32_bf16 v[36:39], v[176:179], a[72:75], v[36:39]
    v_mfma_f32_16x16x32_bf16 v[56:59], v[176:179], a[76:79], v[56:59]
    ds_read_b128 v[172:175], v14 offset:4096
    s_add_u32 s26, s44, 13406720
    buffer_load_dwordx2 v[98:99], v230, s[28:31], s26 offen sc1
    v_mfma_f32_16x16x32_bf16 v[40:43], v[180:183], a[72:75], v[40:43]
    v_mfma_f32_16x16x32_bf16 v[60:63], v[180:183], a[76:79], v[60:63]
    ds_read_b128 v[176:179], v14 offset:5120
    v_mfma_f32_16x16x32_bf16 v[44:47], v[136:139], a[72:75], v[44:47]
    v_mfma_f32_16x16x32_bf16 v[64:67], v[136:139], a[76:79], v[64:67]
    ds_read_b128 v[180:183], v14 offset:6144
    s_add_u32 s26, s44, 13407232
    buffer_load_dwordx2 v[100:101], v230, s[28:31], s26 offen sc1
    v_mfma_f32_16x16x32_bf16 v[48:51], v[140:143], a[72:75], v[48:51]
    v_mfma_f32_16x16x32_bf16 v[68:71], v[140:143], a[76:79], v[68:71]
    ds_read_b128 v[136:139], v13 offset:16384
    s_waitcnt vmcnt(11) lgkmcnt(6)
    v_mfma_f32_16x16x32_bf16 v[32:35], v[144:147], a[80:83], v[32:35]
    v_mfma_f32_16x16x32_bf16 v[52:55], v[144:147], a[84:87], v[52:55]
    ds_read_b128 v[140:143], v13 offset:17408
    s_add_u32 s26, s44, 13407744
    buffer_load_dwordx2 v[102:103], v230, s[28:31], s26 offen sc1
    v_mfma_f32_16x16x32_bf16 v[36:39], v[148:151], a[80:83], v[36:39]
    v_mfma_f32_16x16x32_bf16 v[56:59], v[148:151], a[84:87], v[56:59]
    ds_read_b128 v[144:147], v13 offset:18432
    v_mfma_f32_16x16x32_bf16 v[40:43], v[152:155], a[80:83], v[40:43]
    v_mfma_f32_16x16x32_bf16 v[60:63], v[152:155], a[84:87], v[60:63]
    ds_read_b128 v[148:151], v13 offset:19456
    s_add_u32 s26, s45, 13406208
    buffer_load_dwordx2 v[104:105], v230, s[28:31], s26 offen sc1
    v_mfma_f32_16x16x32_bf16 v[44:47], v[156:159], a[80:83], v[44:47]
    v_mfma_f32_16x16x32_bf16 v[64:67], v[156:159], a[84:87], v[64:67]
    ds_read_b128 v[152:155], v13 offset:20480
    v_mfma_f32_16x16x32_bf16 v[48:51], v[160:163], a[80:83], v[48:51]
    v_mfma_f32_16x16x32_bf16 v[68:71], v[160:163], a[84:87], v[68:71]
    ds_read_b128 v[156:159], v13 offset:26624
    buffer_load_dwordx4 a[24:27], v8, s[28:31], s50 offen offset:3072 sc1
    s_waitcnt vmcnt(12) lgkmcnt(6)
    v_mfma_f32_16x16x32_bf16 v[32:35], v[164:167], a[88:91], v[32:35]
    v_mfma_f32_16x16x32_bf16 v[52:55], v[164:167], a[92:95], v[52:55]
    ds_read_b128 v[160:163], v13 offset:27648
    v_mfma_f32_16x16x32_bf16 v[36:39], v[168:171], a[88:91], v[36:39]
    v_mfma_f32_16x16x32_bf16 v[56:59], v[168:171], a[92:95], v[56:59]
    ds_read_b128 v[164:167], v13 offset:28672
    buffer_load_dwordx4 a[28:31], v8, s[28:31], s51 offen offset:3072 sc1
    v_mfma_f32_16x16x32_bf16 v[40:43], v[172:175], a[88:91], v[40:43]
    v_mfma_f32_16x16x32_bf16 v[60:63], v[172:175], a[92:95], v[60:63]
    ds_read_b128 v[168:171], v13 offset:29696
    v_mfma_f32_16x16x32_bf16 v[44:47], v[176:179], a[88:91], v[44:47]
    v_mfma_f32_16x16x32_bf16 v[64:67], v[176:179], a[92:95], v[64:67]
    ds_read_b128 v[172:175], v13 offset:30720
    s_add_u32 s50, s50, 4096
    s_add_u32 s51, s51, 4096
    buffer_load_dwordx4 a[32:35], v8, s[28:31], s50 offen offset:0 sc1
    v_mfma_f32_16x16x32_bf16 v[48:51], v[180:183], a[88:91], v[48:51]
    v_mfma_f32_16x16x32_bf16 v[68:71], v[180:183], a[92:95], v[68:71]
    ds_read_b128 v[176:179], v13 offset:36864
    s_waitcnt vmcnt(12) lgkmcnt(6)
    v_mfma_f32_16x16x32_bf16 v[32:35], v[136:139], a[0:3], v[32:35]
    v_mfma_f32_16x16x32_bf16 v[52:55], v[136:139], a[4:7], v[52:55]
    ds_read_b128 v[180:183], v13 offset:37888
    buffer_load_dwordx4 a[36:39], v8, s[28:31], s51 offen offset:0 sc1
    v_mfma_f32_16x16x32_bf16 v[36:39], v[140:143], a[0:3], v[36:39]
    v_mfma_f32_16x16x32_bf16 v[56:59], v[140:143], a[4:7], v[56:59]
    ds_read_b128 v[136:139], v13 offset:38912
    v_mfma_f32_16x16x32_bf16 v[40:43], v[144:147], a[0:3], v[40:43]
    v_mfma_f32_16x16x32_bf16 v[60:63], v[144:147], a[4:7], v[60:63]
    ds_read_b128 v[140:143], v13 offset:39936
    buffer_load_dwordx4 a[40:43], v8, s[28:31], s50 offen offset:1024 sc1
    v_mfma_f32_16x16x32_bf16 v[44:47], v[148:151], a[0:3], v[44:47]
    v_mfma_f32_16x16x32_bf16 v[64:67], v[148:151], a[4:7], v[64:67]
    ds_read_b128 v[144:147], v13 offset:40960
    v_mfma_f32_16x16x32_bf16 v[48:51], v[152:155], a[0:3], v[48:51]
    v_mfma_f32_16x16x32_bf16 v[68:71], v[152:155], a[4:7], v[68:71]
    ds_read_b128 v[148:151], v13 offset:47104
    buffer_load_dwordx4 a[44:47], v8, s[28:31], s51 offen offset:1024 sc1
    s_waitcnt vmcnt(13) lgkmcnt(6)
    v_mfma_f32_16x16x32_bf16 v[32:35], v[156:159], a[8:11], v[32:35]
    v_mfma_f32_16x16x32_bf16 v[52:55], v[156:159], a[12:15], v[52:55]
    ds_read_b128 v[152:155], v13 offset:48128
    v_mfma_f32_16x16x32_bf16 v[36:39], v[160:163], a[8:11], v[36:39]
    v_mfma_f32_16x16x32_bf16 v[56:59], v[160:163], a[12:15], v[56:59]
    ds_read_b128 v[156:159], v13 offset:49152
    buffer_load_dwordx4 a[48:51], v8, s[28:31], s50 offen offset:2048 sc1
    v_mfma_f32_16x16x32_bf16 v[40:43], v[164:167], a[8:11], v[40:43]
    v_mfma_f32_16x16x32_bf16 v[60:63], v[164:167], a[12:15], v[60:63]
    ds_read_b128 v[160:163], v13 offset:50176
    v_mfma_f32_16x16x32_bf16 v[44:47], v[168:171], a[8:11], v[44:47]
    v_mfma_f32_16x16x32_bf16 v[64:67], v[168:171], a[12:15], v[64:67]
    ds_read_b128 v[164:167], v13 offset:51200
    buffer_load_dwordx4 a[52:55], v8, s[28:31], s51 offen offset:2048 sc1
    v_mfma_f32_16x16x32_bf16 v[48:51], v[172:175], a[8:11], v[48:51]
    v_mfma_f32_16x16x32_bf16 v[68:71], v[172:175], a[12:15], v[68:71]
    s_barrier
    ds_read_b128 v[168:171], v14 offset:12288
    s_waitcnt vmcnt(13) lgkmcnt(6)
    v_mfma_f32_16x16x32_bf16 v[32:35], v[176:179], a[16:19], v[32:35]
    v_mfma_f32_16x16x32_bf16 v[52:55], v[176:179], a[20:23], v[52:55]
    ds_read_b128 v[172:175], v14 offset:13312
    buffer_load_dwordx4 a[56:59], v8, s[28:31], s50 offen offset:3072 sc1
    v_mfma_f32_16x16x32_bf16 v[36:39], v[180:183], a[16:19], v[36:39]
    v_mfma_f32_16x16x32_bf16 v[56:59], v[180:183], a[20:23], v[56:59]
    ds_read_b128 v[176:179], v14 offset:14336
    v_mfma_f32_16x16x32_bf16 v[40:43], v[136:139], a[16:19], v[40:43]
    v_mfma_f32_16x16x32_bf16 v[60:63], v[136:139], a[20:23], v[60:63]
    ds_read_b128 v[180:183], v14 offset:15360
    buffer_load_dwordx4 a[60:63], v8, s[28:31], s51 offen offset:3072 sc1
    v_mfma_f32_16x16x32_bf16 v[44:47], v[140:143], a[16:19], v[44:47]
    v_mfma_f32_16x16x32_bf16 v[64:67], v[140:143], a[20:23], v[64:67]
    ds_read_b128 v[136:139], v14 offset:16384
    v_mfma_f32_16x16x32_bf16 v[48:51], v[144:147], a[16:19], v[48:51]
    v_mfma_f32_16x16x32_bf16 v[68:71], v[144:147], a[20:23], v[68:71]
    ds_read_b128 v[140:143], v12 offset:0
    s_add_u32 s50, s50, 4096
    s_add_u32 s51, s51, 4096
    buffer_load_dwordx4 a[64:67], v8, s[28:31], s50 offen offset:0 sc1
    s_waitcnt vmcnt(9) lgkmcnt(6)
    v_mfma_f32_16x16x32_bf16 v[32:35], v[148:151], a[24:27], v[32:35]
    v_mfma_f32_16x16x32_bf16 v[52:55], v[148:151], a[28:31], v[52:55]
    ds_read_b128 v[144:147], v12 offset:1024
    v_mfma_f32_16x16x32_bf16 v[36:39], v[152:155], a[24:27], v[36:39]
    v_mfma_f32_16x16x32_bf16 v[56:59], v[152:155], a[28:31], v[56:59]
    ds_read_b128 v[148:151], v12 offset:2048
    buffer_load_dwordx4 a[68:71], v8, s[28:31], s51 offen offset:0 sc1
    v_mfma_f32_16x16x32_bf16 v[40:43], v[156:159], a[24:27], v[40:43]
    v_mfma_f32_16x16x32_bf16 v[60:63], v[156:159], a[28:31], v[60:63]
    ds_read_b128 v[152:155], v12 offset:3072
    v_mfma_f32_16x16x32_bf16 v[44:47], v[160:163], a[24:27], v[44:47]
    v_mfma_f32_16x16x32_bf16 v[64:67], v[160:163], a[28:31], v[64:67]
    ds_read_b128 v[156:159], v12 offset:4096
    buffer_load_dwordx4 a[72:75], v8, s[28:31], s50 offen offset:1024 sc1
    v_mfma_f32_16x16x32_bf16 v[48:51], v[164:167], a[24:27], v[48:51]
    v_mfma_f32_16x16x32_bf16 v[68:71], v[164:167], a[28:31], v[68:71]
    ds_read_b128 v[160:163], v12 offset:10240
    s_waitcnt vmcnt(9) lgkmcnt(6)
    v_mfma_f32_16x16x32_bf16 v[32:35], v[168:171], a[32:35], v[32:35]
    v_mfma_f32_16x16x32_bf16 v[52:55], v[168:171], a[36:39], v[52:55]
    ds_read_b128 v[164:167], v12 offset:11264
    buffer_load_dwordx4 a[76:79], v8, s[28:31], s51 offen offset:1024 sc1
    v_mfma_f32_16x16x32_bf16 v[36:39], v[172:175], a[32:35], v[36:39]
    v_mfma_f32_16x16x32_bf16 v[56:59], v[172:175], a[36:39], v[56:59]
    ds_read_b128 v[168:171], v12 offset:12288
    v_mfma_f32_16x16x32_bf16 v[40:43], v[176:179], a[32:35], v[40:43]
    v_mfma_f32_16x16x32_bf16 v[60:63], v[176:179], a[36:39], v[60:63]
    ds_read_b128 v[172:175], v12 offset:13312
    buffer_load_dwordx4 a[80:83], v8, s[28:31], s50 offen offset:2048 sc1
    v_mfma_f32_16x16x32_bf16 v[44:47], v[180:183], a[32:35], v[44:47]
    v_mfma_f32_16x16x32_bf16 v[64:67], v[180:183], a[36:39], v[64:67]
    ds_read_b128 v[176:179], v12 offset:14336
    v_mfma_f32_16x16x32_bf16 v[48:51], v[136:139], a[32:35], v[48:51]
    v_mfma_f32_16x16x32_bf16 v[68:71], v[136:139], a[36:39], v[68:71]
    buffer_load_dwordx4 a[84:87], v8, s[28:31], s51 offen offset:2048 sc1
    s_waitcnt vmcnt(10) lgkmcnt(5)
    v_mfma_f32_16x16x32_bf16 v[32:35], v[140:143], a[40:43], v[32:35]
    v_mfma_f32_16x16x32_bf16 v[52:55], v[140:143], a[44:47], v[52:55]
    v_mfma_f32_16x16x32_bf16 v[36:39], v[144:147], a[40:43], v[36:39]
    v_mfma_f32_16x16x32_bf16 v[56:59], v[144:147], a[44:47], v[56:59]
    buffer_load_dwordx4 a[88:91], v8, s[28:31], s50 offen offset:3072 sc1
    v_mfma_f32_16x16x32_bf16 v[40:43], v[148:151], a[40:43], v[40:43]
    v_mfma_f32_16x16x32_bf16 v[60:63], v[148:151], a[44:47], v[60:63]
    v_mfma_f32_16x16x32_bf16 v[44:47], v[152:155], a[40:43], v[44:47]
    v_mfma_f32_16x16x32_bf16 v[64:67], v[152:155], a[44:47], v[64:67]
    buffer_load_dwordx4 a[92:95], v8, s[28:31], s51 offen offset:3072 sc1
    v_mfma_f32_16x16x32_bf16 v[48:51], v[156:159], a[40:43], v[48:51]
    v_mfma_f32_16x16x32_bf16 v[68:71], v[156:159], a[44:47], v[68:71]
    s_waitcnt vmcnt(10) lgkmcnt(0)
    v_mfma_f32_16x16x32_bf16 v[32:35], v[160:163], a[48:51], v[32:35]
    v_mfma_f32_16x16x32_bf16 v[52:55], v[160:163], a[52:55], v[52:55]
    s_add_u32 s50, s50, 4096
    s_add_u32 s51, s51, 4096
    buffer_load_dwordx4 a[0:3], v8, s[28:31], s50 offen offset:0 sc1
    v_mfma_f32_16x16x32_bf16 v[36:39], v[164:167], a[48:51], v[36:39]
    v_mfma_f32_16x16x32_bf16 v[56:59], v[164:167], a[52:55], v[56:59]
    v_mfma_f32_16x16x32_bf16 v[40:43], v[168:171], a[48:51], v[40:43]
    v_mfma_f32_16x16x32_bf16 v[60:63], v[168:171], a[52:55], v[60:63]
    buffer_load_dwordx4 a[4:7], v8, s[28:31], s51 offen offset:0 sc1
    v_mfma_f32_16x16x32_bf16 v[44:47], v[172:175], a[48:51], v[44:47]
    v_mfma_f32_16x16x32_bf16 v[64:67], v[172:175], a[52:55], v[64:67]
    v_mfma_f32_16x16x32_bf16 v[48:51], v[176:179], a[48:51], v[48:51]
    v_mfma_f32_16x16x32_bf16 v[68:71], v[176:179], a[52:55], v[68:71]
    s_waitcnt vmcnt(10)
    v_mfma_f32_16x16x32_bf16 v[32:35], a[96:99], a[56:59], v[32:35]
    v_mfma_f32_16x16x32_bf16 v[52:55], a[96:99], a[60:63], v[52:55]
    v_mfma_f32_16x16x32_bf16 v[36:39], a[100:103], a[56:59], v[36:39]
    v_mfma_f32_16x16x32_bf16 v[56:59], a[100:103], a[60:63], v[56:59]
    buffer_load_dwordx4 a[8:11], v8, s[28:31], s50 offen offset:1024 sc1
    v_mfma_f32_16x16x32_bf16 v[40:43], a[104:107], a[56:59], v[40:43]
    v_mfma_f32_16x16x32_bf16 v[60:63], a[104:107], a[60:63], v[60:63]
    v_mfma_f32_16x16x32_bf16 v[44:47], a[108:111], a[56:59], v[44:47]
    v_mfma_f32_16x16x32_bf16 v[64:67], a[108:111], a[60:63], v[64:67]
    buffer_load_dwordx4 a[12:15], v8, s[28:31], s51 offen offset:1024 sc1
    v_mfma_f32_16x16x32_bf16 v[48:51], a[112:115], a[56:59], v[48:51]
    v_mfma_f32_16x16x32_bf16 v[68:71], a[112:115], a[60:63], v[68:71]
    s_waitcnt vmcnt(10)
    v_mfma_f32_16x16x32_bf16 v[32:35], a[116:119], a[64:67], v[32:35]
    v_mfma_f32_16x16x32_bf16 v[52:55], a[116:119], a[68:71], v[52:55]
    buffer_load_dwordx4 a[16:19], v8, s[28:31], s50 offen offset:2048 sc1
    v_mfma_f32_16x16x32_bf16 v[36:39], a[120:123], a[64:67], v[36:39]
    v_mfma_f32_16x16x32_bf16 v[56:59], a[120:123], a[68:71], v[56:59]
    v_mfma_f32_16x16x32_bf16 v[40:43], a[124:127], a[64:67], v[40:43]
    v_mfma_f32_16x16x32_bf16 v[60:63], a[124:127], a[68:71], v[60:63]
    buffer_load_dwordx4 a[20:23], v8, s[28:31], s51 offen offset:2048 sc1
    v_mfma_f32_16x16x32_bf16 v[44:47], a[128:131], a[64:67], v[44:47]
    v_mfma_f32_16x16x32_bf16 v[64:67], a[128:131], a[68:71], v[64:67]
    v_mfma_f32_16x16x32_bf16 v[48:51], a[132:135], a[64:67], v[48:51]
    v_mfma_f32_16x16x32_bf16 v[68:71], a[132:135], a[68:71], v[68:71]
    s_waitcnt vmcnt(10)
    v_mfma_f32_16x16x32_bf16 v[32:35], a[136:139], a[72:75], v[32:35]
    v_mfma_f32_16x16x32_bf16 v[52:55], a[136:139], a[76:79], v[52:55]
    v_mfma_f32_16x16x32_bf16 v[36:39], a[140:143], a[72:75], v[36:39]
    v_mfma_f32_16x16x32_bf16 v[56:59], a[140:143], a[76:79], v[56:59]
    v_mfma_f32_16x16x32_bf16 v[40:43], a[144:147], a[72:75], v[40:43]
    v_mfma_f32_16x16x32_bf16 v[60:63], a[144:147], a[76:79], v[60:63]
    v_mfma_f32_16x16x32_bf16 v[44:47], a[148:151], a[72:75], v[44:47]
    v_mfma_f32_16x16x32_bf16 v[64:67], a[148:151], a[76:79], v[64:67]
    v_mfma_f32_16x16x32_bf16 v[48:51], a[152:155], a[72:75], v[48:51]
    v_mfma_f32_16x16x32_bf16 v[68:71], a[152:155], a[76:79], v[68:71]
    s_waitcnt vmcnt(8)
    v_mfma_f32_16x16x32_bf16 v[32:35], a[156:159], a[80:83], v[32:35]
    v_mfma_f32_16x16x32_bf16 v[52:55], a[156:159], a[84:87], v[52:55]
    v_mfma_f32_16x16x32_bf16 v[36:39], a[160:163], a[80:83], v[36:39]
    v_mfma_f32_16x16x32_bf16 v[56:59], a[160:163], a[84:87], v[56:59]
    v_mfma_f32_16x16x32_bf16 v[40:43], a[164:167], a[80:83], v[40:43]
    v_mfma_f32_16x16x32_bf16 v[60:63], a[164:167], a[84:87], v[60:63]
    v_mfma_f32_16x16x32_bf16 v[44:47], a[168:171], a[80:83], v[44:47]
    v_mfma_f32_16x16x32_bf16 v[64:67], a[168:171], a[84:87], v[64:67]
    v_mfma_f32_16x16x32_bf16 v[48:51], a[172:175], a[80:83], v[48:51]
    v_mfma_f32_16x16x32_bf16 v[68:71], a[172:175], a[84:87], v[68:71]
    s_waitcnt vmcnt(6)
    v_mfma_f32_16x16x32_bf16 v[32:35], a[176:179], a[88:91], v[32:35]
    v_mfma_f32_16x16x32_bf16 v[52:55], a[176:179], a[92:95], v[52:55]
    v_mfma_f32_16x16x32_bf16 v[36:39], a[180:183], a[88:91], v[36:39]
    v_mfma_f32_16x16x32_bf16 v[56:59], a[180:183], a[92:95], v[56:59]
    v_mfma_f32_16x16x32_bf16 v[40:43], a[184:187], a[88:91], v[40:43]
    v_mfma_f32_16x16x32_bf16 v[60:63], a[184:187], a[92:95], v[60:63]
    v_mfma_f32_16x16x32_bf16 v[44:47], a[188:191], a[88:91], v[44:47]
    v_mfma_f32_16x16x32_bf16 v[64:67], a[188:191], a[92:95], v[64:67]
    v_mfma_f32_16x16x32_bf16 v[48:51], a[192:195], a[88:91], v[48:51]
    v_mfma_f32_16x16x32_bf16 v[68:71], a[192:195], a[92:95], v[68:71]
    s_waitcnt vmcnt(4)
    v_mfma_f32_16x16x32_bf16 v[32:35], a[196:199], a[0:3], v[32:35]
    v_mfma_f32_16x16x32_bf16 v[52:55], a[196:199], a[4:7], v[52:55]
    v_mfma_f32_16x16x32_bf16 v[36:39], a[200:203], a[0:3], v[36:39]
    v_mfma_f32_16x16x32_bf16 v[56:59], a[200:203], a[4:7], v[56:59]
    v_mfma_f32_16x16x32_bf16 v[40:43], a[204:207], a[0:3], v[40:43]
    v_mfma_f32_16x16x32_bf16 v[60:63], a[204:207], a[4:7], v[60:63]
    v_mfma_f32_16x16x32_bf16 v[44:47], a[208:211], a[0:3], v[44:47]
    v_mfma_f32_16x16x32_bf16 v[64:67], a[208:211], a[4:7], v[64:67]
    v_mfma_f32_16x16x32_bf16 v[48:51], a[212:215], a[0:3], v[48:51]
    v_mfma_f32_16x16x32_bf16 v[68:71], a[212:215], a[4:7], v[68:71]
    s_waitcnt vmcnt(2)
    v_mfma_f32_16x16x32_bf16 v[32:35], a[216:219], a[8:11], v[32:35]
    v_mfma_f32_16x16x32_bf16 v[52:55], a[216:219], a[12:15], v[52:55]
    v_mfma_f32_16x16x32_bf16 v[36:39], a[220:223], a[8:11], v[36:39]
    v_mfma_f32_16x16x32_bf16 v[56:59], a[220:223], a[12:15], v[56:59]
    v_mfma_f32_16x16x32_bf16 v[40:43], a[224:227], a[8:11], v[40:43]
    v_mfma_f32_16x16x32_bf16 v[60:63], a[224:227], a[12:15], v[60:63]
    v_mfma_f32_16x16x32_bf16 v[44:47], a[228:231], a[8:11], v[44:47]
    v_mfma_f32_16x16x32_bf16 v[64:67], a[228:231], a[12:15], v[64:67]
    v_mfma_f32_16x16x32_bf16 v[48:51], a[232:235], a[8:11], v[48:51]
    v_mfma_f32_16x16x32_bf16 v[68:71], a[232:235], a[12:15], v[68:71]
    s_waitcnt vmcnt(0)
    v_mfma_f32_16x16x32_bf16 v[32:35], a[236:239], a[16:19], v[32:35]
    v_mfma_f32_16x16x32_bf16 v[52:55], a[236:239], a[20:23], v[52:55]
    v_mfma_f32_16x16x32_bf16 v[36:39], a[240:243], a[16:19], v[36:39]
    v_mfma_f32_16x16x32_bf16 v[56:59], a[240:243], a[20:23], v[56:59]
    v_mfma_f32_16x16x32_bf16 v[40:43], a[244:247], a[16:19], v[40:43]
    v_mfma_f32_16x16x32_bf16 v[60:63], a[244:247], a[20:23], v[60:63]
    v_mfma_f32_16x16x32_bf16 v[44:47], a[248:251], a[16:19], v[44:47]
    v_mfma_f32_16x16x32_bf16 v[64:67], a[248:251], a[20:23], v[64:67]
    v_mfma_f32_16x16x32_bf16 v[48:51], a[252:255], a[16:19], v[48:51]
    v_mfma_f32_16x16x32_bf16 v[68:71], a[252:255], a[20:23], v[68:71]
    s_barrier
    s_nop 4
    ds_write_b128 v246, v[52:55] offset:0
    ds_write_b128 v246, v[56:59] offset:1024
    ds_write_b128 v246, v[60:63] offset:2048
    ds_write_b128 v246, v[64:67] offset:3072
    ds_write_b128 v246, v[68:71] offset:4096
    v_lshlrev_b32 v136, 16, v96
    v_and_b32 v137, 0xffff0000, v96
    v_lshlrev_b32 v138, 16, v97
    v_and_b32 v139, 0xffff0000, v97
    v_lshlrev_b32 v156, 16, v116
    v_and_b32 v157, 0xffff0000, v116
    v_lshlrev_b32 v158, 16, v117
    v_and_b32 v159, 0xffff0000, v117
    v_lshlrev_b32 v140, 16, v98
    v_and_b32 v141, 0xffff0000, v98
    v_lshlrev_b32 v142, 16, v99
    v_and_b32 v143, 0xffff0000, v99
    v_lshlrev_b32 v160, 16, v118
    v_and_b32 v161, 0xffff0000, v118
    v_lshlrev_b32 v162, 16, v119
    v_and_b32 v163, 0xffff0000, v119
    v_lshlrev_b32 v144, 16, v100
    v_and_b32 v145, 0xffff0000, v100
    v_lshlrev_b32 v146, 16, v101
    v_and_b32 v147, 0xffff0000, v101
    v_lshlrev_b32 v164, 16, v120
    v_and_b32 v165, 0xffff0000, v120
    v_lshlrev_b32 v166, 16, v121
    v_and_b32 v167, 0xffff0000, v121
    v_lshlrev_b32 v148, 16, v102
    v_and_b32 v149, 0xffff0000, v102
    v_lshlrev_b32 v150, 16, v103
    v_and_b32 v151, 0xffff0000, v103
    v_lshlrev_b32 v168, 16, v122
    v_and_b32 v169, 0xffff0000, v122
    v_lshlrev_b32 v170, 16, v123
    v_and_b32 v171, 0xffff0000, v123
    v_lshlrev_b32 v152, 16, v104
    v_and_b32 v153, 0xffff0000, v104
    v_lshlrev_b32 v154, 16, v105
    v_and_b32 v155, 0xffff0000, v105
    v_lshlrev_b32 v172, 16, v124
    v_and_b32 v173, 0xffff0000, v124
    v_lshlrev_b32 v174, 16, v125
    v_and_b32 v175, 0xffff0000, v125
    v_pk_add_f32 v[32:33], v[32:33], v[136:137]
    v_pk_add_f32 v[34:35], v[34:35], v[138:139]
    v_pk_add_f32 v[36:37], v[36:37], v[140:141]
    v_pk_add_f32 v[38:39], v[38:39], v[142:143]
    v_pk_add_f32 v[40:41], v[40:41], v[144:145]
    v_pk_add_f32 v[42:43], v[42:43], v[146:147]
    v_pk_add_f32 v[44:45], v[44:45], v[148:149]
    v_pk_add_f32 v[46:47], v[46:47], v[150:151]
    v_pk_add_f32 v[48:49], v[48:49], v[152:153]
    v_pk_add_f32 v[50:51], v[50:51], v[154:155]
    s_waitcnt lgkmcnt(0)
    s_barrier
    ds_read_b128 v[72:75], v247 offset:0
    ds_read_b128 v[76:79], v247 offset:1024
    ds_read_b128 v[80:83], v247 offset:2048
    ds_read_b128 v[84:87], v247 offset:3072
    ds_read_b128 v[88:91], v247 offset:4096
    s_waitcnt lgkmcnt(4)
    v_pk_add_f32 v[32:33], v[32:33], v[72:73]
    v_pk_add_f32 v[34:35], v[34:35], v[74:75]
    v_pk_fma_f32 v[32:33], v[32:33], v[204:205], v[156:157]
    v_pk_fma_f32 v[34:35], v[34:35], v[206:207], v[158:159]
    v_cvt_pk_bf16_f32 v180, v32, v33
    v_cvt_pk_bf16_f32 v181, v34, v35
    s_waitcnt lgkmcnt(3)
    v_pk_add_f32 v[36:37], v[36:37], v[76:77]
    v_pk_add_f32 v[38:39], v[38:39], v[78:79]
    v_pk_fma_f32 v[36:37], v[36:37], v[208:209], v[160:161]
    v_pk_fma_f32 v[38:39], v[38:39], v[210:211], v[162:163]
    v_cvt_pk_bf16_f32 v182, v36, v37
    v_cvt_pk_bf16_f32 v183, v38, v39
    s_waitcnt lgkmcnt(2)
    v_pk_add_f32 v[40:41], v[40:41], v[80:81]
    v_pk_add_f32 v[42:43], v[42:43], v[82:83]
    v_pk_fma_f32 v[40:41], v[40:41], v[212:213], v[164:165]
    v_pk_fma_f32 v[42:43], v[42:43], v[214:215], v[166:167]
    v_cvt_pk_bf16_f32 v184, v40, v41
    v_cvt_pk_bf16_f32 v185, v42, v43
    s_waitcnt lgkmcnt(1)
    v_pk_add_f32 v[44:45], v[44:45], v[84:85]
    v_pk_add_f32 v[46:47], v[46:47], v[86:87]
    v_pk_fma_f32 v[44:45], v[44:45], v[216:217], v[168:169]
    v_pk_fma_f32 v[46:47], v[46:47], v[218:219], v[170:171]
    v_cvt_pk_bf16_f32 v186, v44, v45
    v_cvt_pk_bf16_f32 v187, v46, v47
    s_waitcnt lgkmcnt(0)
    v_pk_add_f32 v[48:49], v[48:49], v[88:89]
    v_pk_add_f32 v[50:51], v[50:51], v[90:91]
    v_pk_fma_f32 v[48:49], v[48:49], v[220:221], v[172:173]
    v_pk_fma_f32 v[50:51], v[50:51], v[222:223], v[174:175]
    v_cvt_pk_bf16_f32 v188, v48, v49
    v_cvt_pk_bf16_f32 v189, v50, v51
    s_nop 1
    v_permlane16_swap_b32 v180, v182
    v_permlane16_swap_b32 v181, v183
    v_permlane16_swap_b32 v184, v186
    v_permlane16_swap_b32 v185, v187
    buffer_store_dwordx4 v[180:183], v231, s[32:35], s46 offen sc1
    buffer_store_dwordx4 v[184:187], v231, s[32:35], s46 offen offset:64 sc1
    buffer_store_dwordx2 v[188:189], v232, s[32:35], s49 offen sc1
    s_endpgm
chain_end:
    s_endpgm
.section .rodata,"a"
.p2align 6
.amdhsa_kernel prep_kernel
  .amdhsa_next_free_vgpr 256
  .amdhsa_next_free_sgpr 100
  .amdhsa_accum_offset 256
  .amdhsa_group_segment_fixed_size 0
  .amdhsa_kernarg_size 128
  .amdhsa_user_sgpr_count 2
  .amdhsa_user_sgpr_kernarg_segment_ptr 1
  .amdhsa_system_sgpr_workgroup_id_x 1
  .amdhsa_float_denorm_mode_32 3
.end_amdhsa_kernel
.p2align 6
.amdhsa_kernel chain_kernel
  .amdhsa_next_free_vgpr 512
  .amdhsa_next_free_sgpr 100
  .amdhsa_accum_offset 256
  .amdhsa_group_segment_fixed_size 0
  .amdhsa_kernarg_size 128
  .amdhsa_user_sgpr_count 2
  .amdhsa_user_sgpr_kernarg_segment_ptr 1
  .amdhsa_system_sgpr_workgroup_id_x 1
  .amdhsa_float_denorm_mode_32 3
.end_amdhsa_kernel
```

```asm
; @launch kernel=prep_kernel grid=(512,1,1) block=(512,1,1) lds=104512
; @launch kernel=chain_kernel grid=(256,1,1) block=(256,1,1) lds=163840
.amdgcn_target "amdgcn-amd-amdhsa--gfx950"
.text
.globl prep_kernel
.p2align 8
.type prep_kernel,@function
prep_kernel:
    s_cmp_ge_u32 s2, 512
    s_cbranch_scc1 prep_end
    s_load_dwordx4 s[4:7], s[0:1], 8
    s_load_dwordx2 s[8:9], s[0:1], 24
    s_load_dwordx2 s[10:11], s[0:1], 120
    s_load_dwordx8 s[12:19], s[0:1], 56
    s_load_dwordx2 s[60:61], s[0:1], 0
    s_load_dwordx2 s[62:63], s[0:1], 96
    s_load_dwordx2 s[52:53], s[0:1], 88
    s_load_dwordx2 s[54:55], s[0:1], 112
    s_load_dwordx4 s[56:59], s[0:1], 32
    s_memrealtime s[64:65]
    v_lshrrev_b32 v2, 6, v0
    v_and_b32 v1, 63, v0
    v_readfirstlane_b32 s20, v2
    s_waitcnt lgkmcnt(0)
    s_mov_b32 s28, s10
    s_mov_b32 s29, s11
    s_mov_b32 s30, 268435456
    s_mov_b32 s31, 0x00020000
    s_mov_b32 s48, s54
    s_mov_b32 s49, s55
    s_mov_b32 s50, 256
    s_mov_b32 s51, 0x00020000
    s_cmp_ge_u32 s2, 416
    s_cbranch_scc1 p_pack
    s_cmp_ge_u32 s2, 256
    s_cbranch_scc1 p_conv
    s_cmp_ge_u32 s2, 160
    s_cbranch_scc1 p_aux
    s_or_b32 s21, s2, s20
    s_cmp_lg_u32 s21, 0
    s_cbranch_scc1 prep_kernel_n01
    s_or_b32 s64, s64, 1
    v_mov_b32 v3, s64
    v_mov_b32 v4, 0
    s_mov_b64 exec, 1
    buffer_store_dword v3, v4, s[48:51], 0 offen sc1
    s_mov_b64 exec, -1
prep_kernel_n01:
    s_mov_b32 s45, s20
    s_mov_b32 s16, s4
    s_mov_b32 s17, s5
    s_mov_b32 s18, 2621440
    s_mov_b32 s19, 0x00020000
    s_mov_b32 s20, s6
    s_mov_b32 s21, s7
    s_mov_b32 s22, 2621440
    s_mov_b32 s23, 0x00020000
    s_mov_b32 s24, s8
    s_mov_b32 s25, s9
    s_mov_b32 s26, 5120
    s_mov_b32 s27, 0x00020000
    s_lshr_b32 s47, s45, 2
    s_lshl_b32 s46, s2, 1
    s_add_u32 s46, s46, s47
    v_and_b32 v0, 255, v0
    s_mul_i32 s32, s46, 52429
    s_lshr_b32 s32, s32, 19
    s_mul_i32 s33, s32, 10
    s_sub_u32 s33, s46, s33
    s_lshl_b32 s43, s47, 13
    v_and_b32 v1, 15, v0
    v_lshrrev_b32 v2, 4, v0
    s_lshl_b32 s34, s32, 6
    v_lshl_add_u32 v3, v2, 2, s34
    v_mul_u32_u24 v4, 1280, v3
    s_lshl_b32 s35, s33, 7
    v_lshl_add_u32 v5, v1, 3, s35
    v_add_u32 v4, v4, v5
    v_subrev_u32 v6, 3840, v4
    v_subrev_u32 v7, 2560, v4
    v_subrev_u32 v8, 1280, v4
    buffer_load_dwordx2 v[10:11], v6, s[16:19], 0 offen nt
    buffer_load_dwordx2 v[12:13], v7, s[16:19], 0 offen nt
    buffer_load_dwordx2 v[14:15], v8, s[16:19], 0 offen nt
    buffer_load_dwordx2 v[16:17], v4, s[16:19], 0 offen offset:0 nt
    buffer_load_dwordx2 v[18:19], v4, s[16:19], 0 offen offset:1280 nt
    buffer_load_dwordx2 v[20:21], v4, s[16:19], 0 offen offset:2560 nt
    buffer_load_dwordx2 v[22:23], v4, s[16:19], 0 offen offset:3840 nt
    v_lshlrev_b32 v100, 2, v5
    buffer_load_dwordx4 v[32:35], v100, s[24:27], 0 offen
    buffer_load_dwordx4 v[36:39], v100, s[24:27], 0 offen offset:16
    buffer_load_dwordx2 v[24:25], v4, s[20:23], 0 offen offset:0 nt
    buffer_load_dwordx2 v[26:27], v4, s[20:23], 0 offen offset:1280 nt
    buffer_load_dwordx2 v[28:29], v4, s[20:23], 0 offen offset:2560 nt
    buffer_load_dwordx2 v[30:31], v4, s[20:23], 0 offen offset:3840 nt
    v_lshlrev_b32 v100, 9, v1
    v_sub_u32 v101, 15, v2
    v_lshl_add_u32 v100, v101, 3, v100
    v_add_u32 v100, s43, v100
    v_lshrrev_b32 v101, 3, v0
    v_mul_u32_u24 v101, 4352, v101
    v_and_b32 v102, 7, v0
    v_lshl_add_u32 v103, v102, 4, v101
    v_lshlrev_b32 v104, 4, v0
    v_add_u32 v104, s43, v104
    s_mul_i32 s36, s33, 278528
    s_lshr_b32 s37, s32, 1
    s_mul_i32 s37, s37, 272
    s_add_u32 s36, s36, s37
    s_add_u32 s36, s36, 0
    s_and_b32 s37, s32, 1
    s_lshl_b32 s38, s37, 7
    s_sub_u32 s38, 128, s38
    s_add_u32 s38, s38, s36
    s_lshl_b32 s44, s33, 5
    s_add_u32 s44, s44, s32
    s_lshl_b32 s44, s44, 7
    s_add_u32 s44, s44, 29642752
    s_waitcnt vmcnt(4)
    v_mov_b32 v123, 0
    buffer_load_dword v122, v123, s[48:51], 0 offen sc1
    v_lshlrev_b32 v40, 16, v32
    v_and_b32 v44, 0xffff0000, v32
    v_lshlrev_b32 v48, 16, v33
    v_and_b32 v52, 0xffff0000, v33
    v_lshlrev_b32 v41, 16, v34
    v_and_b32 v45, 0xffff0000, v34
    v_lshlrev_b32 v49, 16, v35
    v_and_b32 v53, 0xffff0000, v35
    v_lshlrev_b32 v42, 16, v36
    v_and_b32 v46, 0xffff0000, v36
    v_lshlrev_b32 v50, 16, v37
    v_and_b32 v54, 0xffff0000, v37
    v_lshlrev_b32 v43, 16, v38
    v_and_b32 v47, 0xffff0000, v38
    v_lshlrev_b32 v51, 16, v39
    v_and_b32 v55, 0xffff0000, v39
    v_lshlrev_b32 v56, 16, v10
    v_and_b32 v57, 0xffff0000, v10
    v_lshlrev_b32 v58, 16, v11
    v_and_b32 v59, 0xffff0000, v11
    v_lshlrev_b32 v60, 16, v12
    v_and_b32 v61, 0xffff0000, v12
    v_lshlrev_b32 v62, 16, v13
    v_and_b32 v63, 0xffff0000, v13
    v_lshlrev_b32 v64, 16, v14
    v_and_b32 v65, 0xffff0000, v14
    v_lshlrev_b32 v66, 16, v15
    v_and_b32 v67, 0xffff0000, v15
    v_lshlrev_b32 v68, 16, v16
    v_and_b32 v69, 0xffff0000, v16
    v_lshlrev_b32 v70, 16, v17
    v_and_b32 v71, 0xffff0000, v17
    v_lshlrev_b32 v72, 16, v18
    v_and_b32 v73, 0xffff0000, v18
    v_lshlrev_b32 v74, 16, v19
    v_and_b32 v75, 0xffff0000, v19
    v_lshlrev_b32 v76, 16, v20
    v_and_b32 v77, 0xffff0000, v20
    v_lshlrev_b32 v78, 16, v21
    v_and_b32 v79, 0xffff0000, v21
    v_lshlrev_b32 v80, 16, v22
    v_and_b32 v81, 0xffff0000, v22
    v_lshlrev_b32 v82, 16, v23
    v_and_b32 v83, 0xffff0000, v23
    v_pk_mul_f32 v[84:85], v[56:57], v[52:53]
    v_pk_mul_f32 v[86:87], v[58:59], v[54:55]
    v_pk_mul_f32 v[88:89], v[60:61], v[52:53]
    v_pk_mul_f32 v[90:91], v[62:63], v[54:55]
    v_pk_mul_f32 v[92:93], v[64:65], v[52:53]
    v_pk_mul_f32 v[94:95], v[66:67], v[54:55]
    v_pk_mul_f32 v[96:97], v[68:69], v[52:53]
    v_pk_mul_f32 v[98:99], v[70:71], v[54:55]
    v_pk_fma_f32 v[84:85], v[60:61], v[48:49], v[84:85]
    v_pk_fma_f32 v[86:87], v[62:63], v[50:51], v[86:87]
    v_pk_fma_f32 v[88:89], v[64:65], v[48:49], v[88:89]
    v_pk_fma_f32 v[90:91], v[66:67], v[50:51], v[90:91]
    v_pk_fma_f32 v[92:93], v[68:69], v[48:49], v[92:93]
    v_pk_fma_f32 v[94:95], v[70:71], v[50:51], v[94:95]
    v_pk_fma_f32 v[96:97], v[72:73], v[48:49], v[96:97]
    v_pk_fma_f32 v[98:99], v[74:75], v[50:51], v[98:99]
    v_pk_fma_f32 v[84:85], v[64:65], v[44:45], v[84:85]
    v_pk_fma_f32 v[86:87], v[66:67], v[46:47], v[86:87]
    v_pk_fma_f32 v[88:89], v[68:69], v[44:45], v[88:89]
    v_pk_fma_f32 v[90:91], v[70:71], v[46:47], v[90:91]
    v_pk_fma_f32 v[92:93], v[72:73], v[44:45], v[92:93]
    v_pk_fma_f32 v[94:95], v[74:75], v[46:47], v[94:95]
    v_pk_fma_f32 v[96:97], v[76:77], v[44:45], v[96:97]
    v_pk_fma_f32 v[98:99], v[78:79], v[46:47], v[98:99]
    v_pk_fma_f32 v[84:85], v[68:69], v[40:41], v[84:85]
    v_pk_fma_f32 v[86:87], v[70:71], v[42:43], v[86:87]
    v_pk_fma_f32 v[88:89], v[72:73], v[40:41], v[88:89]
    v_pk_fma_f32 v[90:91], v[74:75], v[42:43], v[90:91]
    v_pk_fma_f32 v[92:93], v[76:77], v[40:41], v[92:93]
    v_pk_fma_f32 v[94:95], v[78:79], v[42:43], v[94:95]
    v_pk_fma_f32 v[96:97], v[80:81], v[40:41], v[96:97]
    v_pk_fma_f32 v[98:99], v[82:83], v[42:43], v[98:99]
    v_cvt_pk_bf16_f32 v56, v84, v85
    v_cvt_pk_bf16_f32 v57, v86, v87
    v_cvt_pk_bf16_f32 v58, v88, v89
    v_cvt_pk_bf16_f32 v59, v90, v91
    v_cvt_pk_bf16_f32 v60, v92, v93
    v_cvt_pk_bf16_f32 v61, v94, v95
    v_cvt_pk_bf16_f32 v62, v96, v97
    v_cvt_pk_bf16_f32 v63, v98, v99
    s_waitcnt vmcnt(1)
    v_lshlrev_b32 v84, 16, v56
    v_and_b32 v85, 0xffff0000, v56
    v_lshlrev_b32 v86, 16, v57
    v_and_b32 v87, 0xffff0000, v57
    v_lshlrev_b32 v88, 16, v58
    v_and_b32 v89, 0xffff0000, v58
    v_lshlrev_b32 v90, 16, v59
    v_and_b32 v91, 0xffff0000, v59
    v_lshlrev_b32 v92, 16, v60
    v_and_b32 v93, 0xffff0000, v60
    v_lshlrev_b32 v94, 16, v61
    v_and_b32 v95, 0xffff0000, v61
    v_lshlrev_b32 v96, 16, v62
    v_and_b32 v97, 0xffff0000, v62
    v_lshlrev_b32 v98, 16, v63
    v_and_b32 v99, 0xffff0000, v63
    v_lshlrev_b32 v64, 16, v24
    v_and_b32 v65, 0xffff0000, v24
    v_pk_mul_f32 v[84:85], v[84:85], v[64:65]
    v_lshlrev_b32 v66, 16, v25
    v_and_b32 v67, 0xffff0000, v25
    v_pk_mul_f32 v[86:87], v[86:87], v[66:67]
    v_lshlrev_b32 v68, 16, v26
    v_and_b32 v69, 0xffff0000, v26
    v_pk_mul_f32 v[88:89], v[88:89], v[68:69]
    v_lshlrev_b32 v70, 16, v27
    v_and_b32 v71, 0xffff0000, v27
    v_pk_mul_f32 v[90:91], v[90:91], v[70:71]
    v_lshlrev_b32 v64, 16, v28
    v_and_b32 v65, 0xffff0000, v28
    v_pk_mul_f32 v[92:93], v[92:93], v[64:65]
    v_lshlrev_b32 v66, 16, v29
    v_and_b32 v67, 0xffff0000, v29
    v_pk_mul_f32 v[94:95], v[94:95], v[66:67]
    v_lshlrev_b32 v68, 16, v30
    v_and_b32 v69, 0xffff0000, v30
    v_pk_mul_f32 v[96:97], v[96:97], v[68:69]
    v_lshlrev_b32 v70, 16, v31
    v_and_b32 v71, 0xffff0000, v31
    v_pk_mul_f32 v[98:99], v[98:99], v[70:71]
    v_cvt_pk_bf16_f32 v64, v96, v92
    v_cvt_pk_bf16_f32 v65, v88, v84
    v_cvt_pk_bf16_f32 v66, v97, v93
    v_cvt_pk_bf16_f32 v67, v89, v85
    v_cvt_pk_bf16_f32 v68, v98, v94
    v_cvt_pk_bf16_f32 v69, v90, v86
    v_cvt_pk_bf16_f32 v70, v99, v95
    v_cvt_pk_bf16_f32 v71, v91, v87
    ds_write_b64 v100, v[64:65] offset:0
    ds_write_b64 v100, v[66:67] offset:128
    ds_write_b64 v100, v[68:69] offset:256
    ds_write_b64 v100, v[70:71] offset:384
    s_waitcnt lgkmcnt(0)
    s_barrier
    ds_read_b128 v[10:13], v104 offset:0
    ds_read_b128 v[14:17], v104 offset:4096
    s_waitcnt lgkmcnt(1)
    buffer_store_dwordx4 v[10:13], v103, s[28:31], s38 offen sc1
    s_add_u32 s38, s38, 139264
    s_waitcnt lgkmcnt(0)
    buffer_store_dwordx4 v[14:17], v103, s[28:31], s38 offen sc1
    s_add_u32 s38, s38, 139264
    v_cmp_eq_u32 vcc, 0, v102
    s_and_saveexec_b64 s[66:67], vcc
    s_cmp_eq_u32 s37, 0
    s_cbranch_scc1 prep_kernel_L2
    s_cmp_eq_u32 s32, 31
    s_cbranch_scc1 prep_kernel_L3
    buffer_store_dwordx4 v[10:13], v101, s[28:31], s36 offen offset:528 sc1
    s_add_u32 s36, s36, 139264
    buffer_store_dwordx4 v[14:17], v101, s[28:31], s36 offen offset:528 sc1
    s_add_u32 s36, s36, 139264
    s_branch prep_kernel_L3
prep_kernel_L2:
    s_cmp_lg_u32 s32, 0
    s_cbranch_scc1 prep_kernel_L3
    v_mov_b32 v108, 0
    v_mov_b32 v109, 0
    v_mov_b32 v110, 0
    v_mov_b32 v111, 0
    buffer_store_dwordx4 v[108:111], v101, s[28:31], s36 offen offset:256 sc1
    s_add_u32 s36, s36, 139264
    buffer_store_dwordx4 v[108:111], v101, s[28:31], s36 offen offset:256 sc1
    s_add_u32 s36, s36, 139264
prep_kernel_L3:
    s_mov_b64 exec, -1
    s_waitcnt vmcnt(0)
    s_barrier
    s_and_b32 s45, s45, 3
    s_cmp_lg_u32 s45, 0
    s_cbranch_scc1 prep_end
    s_mov_b32 s47, 0
prep_kernel_nn4:
    v_readfirstlane_b32 s46, v122
    s_add_u32 s47, s47, 1
    s_cmp_lg_u32 s46, 0
    s_cbranch_scc1 prep_kernel_nd5
    s_cmp_ge_u32 s47, 200000
    s_cbranch_scc1 prep_kernel_nd5
    buffer_load_dword v122, v123, s[48:51], 0 offen sc1
    s_waitcnt vmcnt(0)
    s_branch prep_kernel_nn4
prep_kernel_nd5:
    v_mov_b32 v124, s46
    v_mov_b32 v125, 0
    s_mov_b64 exec, 1
    buffer_store_dword v124, v125, s[28:31], s44 offen sc1
    s_endpgm
prep_end:
    s_endpgm
p_aux:
    v_mov_b32 v251, 0
    buffer_load_dword v250, v251, s[48:51], 0 offen sc1
    s_waitcnt vmcnt(0)
    s_mov_b32 s47, 0
prep_kernel_nn6:
    v_readfirstlane_b32 s46, v250
    s_add_u32 s47, s47, 1
    s_cmp_lg_u32 s46, 0
    s_cbranch_scc1 prep_kernel_nd7
    s_cmp_ge_u32 s47, 200000
    s_cbranch_scc1 prep_kernel_nd7
    buffer_load_dword v250, v251, s[48:51], 0 offen sc1
    s_waitcnt vmcnt(0)
    s_branch prep_kernel_nn6
prep_kernel_nd7:
    s_sub_u32 s21, s2, 160
    s_cmp_ge_u32 s20, 6
    s_cbranch_scc1 prep_end
    s_cmp_ge_u32 s20, 3
    s_cbranch_scc1 p_misc
    s_cmp_eq_u32 s20, 0
    s_cbranch_scc1 p_st
    s_cmp_eq_u32 s20, 2
    s_cbranch_scc1 p_aux2
    s_add_u32 s21, s21, 96
    s_cmp_lt_u32 s21, 128
    s_cbranch_scc1 p_st
    s_sub_u32 s21, s21, 128
    s_branch p_mod
p_aux2:
    s_cmp_ge_u32 s21, 56
    s_cbranch_scc1 prep_end
    s_add_u32 s21, s21, 64
p_mod:
    s_lshr_b32 s32, s21, 2
    s_and_b32 s33, s21, 3
    v_lshrrev_b32 v4, 3, v1
    v_and_b32 v3, 7, v1
    s_mul_i32 s34, s33, 160
    v_add_u32 v4, s34, v4
    v_lshlrev_b32 v5, 1, v4
    v_mul_u32_u24 v6, 7680, v4
    s_lshl_b32 s36, s32, 7
    v_lshl_add_u32 v7, v3, 4, s36
    v_add_u32 v6, v6, v7
    s_mov_b32 s16, s52
    s_mov_b32 s17, s53
    s_mov_b32 s18, 1280
    s_mov_b32 s19, 0x00020000
    s_mov_b32 s24, s62
    s_mov_b32 s25, s63
    s_mov_b32 s26, 4915200
    s_mov_b32 s27, 0x00020000
    s_mul_i32 s35, s33, 320
    v_lshlrev_b32 v5, 3, v1
    buffer_load_dwordx2 v[30:31], v5, s[16:19], s35 offen
    s_mov_b32 s37, 0
    buffer_load_dwordx4 v[32:35], v6, s[24:27], s37 offen nt
    s_add_u32 s37, s37, 61440
    buffer_load_dwordx4 v[36:39], v6, s[24:27], s37 offen nt
    s_add_u32 s37, s37, 61440
    buffer_load_dwordx4 v[40:43], v6, s[24:27], s37 offen nt
    s_add_u32 s37, s37, 61440
    buffer_load_dwordx4 v[44:47], v6, s[24:27], s37 offen nt
    s_add_u32 s37, s37, 61440
    buffer_load_dwordx4 v[48:51], v6, s[24:27], s37 offen nt
    s_add_u32 s37, s37, 61440
    buffer_load_dwordx4 v[52:55], v6, s[24:27], s37 offen nt
    s_add_u32 s37, s37, 61440
    buffer_load_dwordx4 v[56:59], v6, s[24:27], s37 offen nt
    s_add_u32 s37, s37, 61440
    buffer_load_dwordx4 v[60:63], v6, s[24:27], s37 offen nt
    s_add_u32 s37, s37, 61440
    buffer_load_dwordx4 v[64:67], v6, s[24:27], s37 offen nt
    s_add_u32 s37, s37, 61440
    buffer_load_dwordx4 v[68:71], v6, s[24:27], s37 offen nt
    s_add_u32 s37, s37, 61440
    buffer_load_dwordx4 v[72:75], v6, s[24:27], s37 offen nt
    s_add_u32 s37, s37, 61440
    buffer_load_dwordx4 v[76:79], v6, s[24:27], s37 offen nt
    s_add_u32 s37, s37, 61440
    buffer_load_dwordx4 v[80:83], v6, s[24:27], s37 offen nt
    s_add_u32 s37, s37, 61440
    buffer_load_dwordx4 v[84:87], v6, s[24:27], s37 offen nt
    s_add_u32 s37, s37, 61440
    buffer_load_dwordx4 v[88:91], v6, s[24:27], s37 offen nt
    s_add_u32 s37, s37, 61440
    buffer_load_dwordx4 v[92:95], v6, s[24:27], s37 offen nt
    s_add_u32 s37, s37, 61440
    buffer_load_dwordx4 v[96:99], v6, s[24:27], s37 offen nt
    s_add_u32 s37, s37, 61440
    buffer_load_dwordx4 v[100:103], v6, s[24:27], s37 offen nt
    s_add_u32 s37, s37, 61440
    buffer_load_dwordx4 v[104:107], v6, s[24:27], s37 offen nt
    s_add_u32 s37, s37, 61440
    buffer_load_dwordx4 v[108:111], v6, s[24:27], s37 offen nt
    s_mul_i32 s35, s20, 13824
    v_lshlrev_b32 v5, 4, v1
    v_add_u32 v5, s35, v5
    v_lshrrev_b32 v29, 3, v1
    v_lshlrev_b32 v29, 2, v29
    v_add_u32 v29, s35, v29
    s_waitcnt vmcnt(20)
    v_lshlrev_b32 v8, 16, v30
    v_and_b32 v9, 0xffff0000, v30
    v_lshlrev_b32 v10, 16, v31
    v_and_b32 v11, 0xffff0000, v31
    v_mul_f32 v120, 0xbfb8aa3b, v8
    v_mul_f32 v121, 0xbfb8aa3b, v9
    v_mul_f32 v122, 0xbfb8aa3b, v10
    v_mul_f32 v123, 0xbfb8aa3b, v11
    v_exp_f32 v120, v120
    v_exp_f32 v121, v121
    v_exp_f32 v122, v122
    v_exp_f32 v123, v123
    v_add_f32 v120, 1.0, v120
    v_add_f32 v121, 1.0, v121
    v_add_f32 v122, 1.0, v122
    v_add_f32 v123, 1.0, v123
    v_rcp_f32 v120, v120
    v_rcp_f32 v121, v121
    v_rcp_f32 v122, v122
    v_rcp_f32 v123, v123
    s_nop 0
    v_mul_f32 v8, v8, v120
    v_mul_f32 v9, v9, v121
    v_mul_f32 v10, v10, v122
    v_mul_f32 v11, v11, v123
    v_cvt_pk_bf16_f32 v120, v8, v9
    v_lshlrev_b32 v8, 16, v120
    v_and_b32 v9, 0xffff0000, v120
    v_cvt_pk_bf16_f32 v120, v10, v11
    v_lshlrev_b32 v10, 16, v120
    v_and_b32 v11, 0xffff0000, v120
    ds_write_b128 v5, v[8:11]
    s_waitcnt lgkmcnt(0)
    ds_read_b32 v8, v29 offset:0
    ds_read_b32 v9, v29 offset:32
    ds_read_b32 v10, v29 offset:64
    ds_read_b32 v11, v29 offset:96
    ds_read_b32 v12, v29 offset:128
    ds_read_b32 v13, v29 offset:160
    ds_read_b32 v14, v29 offset:192
    ds_read_b32 v15, v29 offset:224
    ds_read_b32 v16, v29 offset:256
    ds_read_b32 v17, v29 offset:288
    ds_read_b32 v18, v29 offset:320
    ds_read_b32 v19, v29 offset:352
    ds_read_b32 v20, v29 offset:384
    ds_read_b32 v21, v29 offset:416
    ds_read_b32 v22, v29 offset:448
    ds_read_b32 v23, v29 offset:480
    ds_read_b32 v24, v29 offset:512
    ds_read_b32 v25, v29 offset:544
    ds_read_b32 v26, v29 offset:576
    ds_read_b32 v27, v29 offset:608
    s_waitcnt lgkmcnt(0)
    v_mov_b32 v112, 0
    v_mov_b32 v113, 0
    v_mov_b32 v114, 0
    v_mov_b32 v115, 0
    v_mov_b32 v116, 0
    v_mov_b32 v117, 0
    v_mov_b32 v118, 0
    v_mov_b32 v119, 0
    s_waitcnt vmcnt(19)
    v_lshlrev_b32 v120, 16, v32
    v_and_b32 v121, 0xffff0000, v32
    v_lshlrev_b32 v122, 16, v33
    v_and_b32 v123, 0xffff0000, v33
    v_lshlrev_b32 v124, 16, v34
    v_and_b32 v125, 0xffff0000, v34
    v_lshlrev_b32 v126, 16, v35
    v_and_b32 v127, 0xffff0000, v35
    v_pk_fma_f32 v[112:113], v[120:121], v[8:9], v[112:113] op_sel:[0,0,0] op_sel_hi:[1,0,1]
    v_pk_fma_f32 v[114:115], v[122:123], v[8:9], v[114:115] op_sel:[0,0,0] op_sel_hi:[1,0,1]
    v_pk_fma_f32 v[116:117], v[124:125], v[8:9], v[116:117] op_sel:[0,0,0] op_sel_hi:[1,0,1]
    v_pk_fma_f32 v[118:119], v[126:127], v[8:9], v[118:119] op_sel:[0,0,0] op_sel_hi:[1,0,1]
    s_waitcnt vmcnt(18)
    v_lshlrev_b32 v120, 16, v36
    v_and_b32 v121, 0xffff0000, v36
    v_lshlrev_b32 v122, 16, v37
    v_and_b32 v123, 0xffff0000, v37
    v_lshlrev_b32 v124, 16, v38
    v_and_b32 v125, 0xffff0000, v38
    v_lshlrev_b32 v126, 16, v39
    v_and_b32 v127, 0xffff0000, v39
    v_pk_fma_f32 v[112:113], v[120:121], v[8:9], v[112:113] op_sel:[0,1,0] op_sel_hi:[1,1,1]
    v_pk_fma_f32 v[114:115], v[122:123], v[8:9], v[114:115] op_sel:[0,1,0] op_sel_hi:[1,1,1]
    v_pk_fma_f32 v[116:117], v[124:125], v[8:9], v[116:117] op_sel:[0,1,0] op_sel_hi:[1,1,1]
    v_pk_fma_f32 v[118:119], v[126:127], v[8:9], v[118:119] op_sel:[0,1,0] op_sel_hi:[1,1,1]
    s_waitcnt vmcnt(17)
    v_lshlrev_b32 v120, 16, v40
    v_and_b32 v121, 0xffff0000, v40
    v_lshlrev_b32 v122, 16, v41
    v_and_b32 v123, 0xffff0000, v41
    v_lshlrev_b32 v124, 16, v42
    v_and_b32 v125, 0xffff0000, v42
    v_lshlrev_b32 v126, 16, v43
    v_and_b32 v127, 0xffff0000, v43
    v_pk_fma_f32 v[112:113], v[120:121], v[10:11], v[112:113] op_sel:[0,0,0] op_sel_hi:[1,0,1]
    v_pk_fma_f32 v[114:115], v[122:123], v[10:11], v[114:115] op_sel:[0,0,0] op_sel_hi:[1,0,1]
    v_pk_fma_f32 v[116:117], v[124:125], v[10:11], v[116:117] op_sel:[0,0,0] op_sel_hi:[1,0,1]
    v_pk_fma_f32 v[118:119], v[126:127], v[10:11], v[118:119] op_sel:[0,0,0] op_sel_hi:[1,0,1]
    s_waitcnt vmcnt(16)
    v_lshlrev_b32 v120, 16, v44
    v_and_b32 v121, 0xffff0000, v44
    v_lshlrev_b32 v122, 16, v45
    v_and_b32 v123, 0xffff0000, v45
    v_lshlrev_b32 v124, 16, v46
    v_and_b32 v125, 0xffff0000, v46
    v_lshlrev_b32 v126, 16, v47
    v_and_b32 v127, 0xffff0000, v47
    v_pk_fma_f32 v[112:113], v[120:121], v[10:11], v[112:113] op_sel:[0,1,0] op_sel_hi:[1,1,1]
    v_pk_fma_f32 v[114:115], v[122:123], v[10:11], v[114:115] op_sel:[0,1,0] op_sel_hi:[1,1,1]
    v_pk_fma_f32 v[116:117], v[124:125], v[10:11], v[116:117] op_sel:[0,1,0] op_sel_hi:[1,1,1]
    v_pk_fma_f32 v[118:119], v[126:127], v[10:11], v[118:119] op_sel:[0,1,0] op_sel_hi:[1,1,1]
    s_waitcnt vmcnt(15)
    v_lshlrev_b32 v120, 16, v48
    v_and_b32 v121, 0xffff0000, v48
    v_lshlrev_b32 v122, 16, v49
    v_and_b32 v123, 0xffff0000, v49
    v_lshlrev_b32 v124, 16, v50
    v_and_b32 v125, 0xffff0000, v50
    v_lshlrev_b32 v126, 16, v51
    v_and_b32 v127, 0xffff0000, v51
    v_pk_fma_f32 v[112:113], v[120:121], v[12:13], v[112:113] op_sel:[0,0,0] op_sel_hi:[1,0,1]
    v_pk_fma_f32 v[114:115], v[122:123], v[12:13], v[114:115] op_sel:[0,0,0] op_sel_hi:[1,0,1]
    v_pk_fma_f32 v[116:117], v[124:125], v[12:13], v[116:117] op_sel:[0,0,0] op_sel_hi:[1,0,1]
    v_pk_fma_f32 v[118:119], v[126:127], v[12:13], v[118:119] op_sel:[0,0,0] op_sel_hi:[1,0,1]
    s_waitcnt vmcnt(14)
    v_lshlrev_b32 v120, 16, v52
    v_and_b32 v121, 0xffff0000, v52
    v_lshlrev_b32 v122, 16, v53
    v_and_b32 v123, 0xffff0000, v53
    v_lshlrev_b32 v124, 16, v54
    v_and_b32 v125, 0xffff0000, v54
    v_lshlrev_b32 v126, 16, v55
    v_and_b32 v127, 0xffff0000, v55
    v_pk_fma_f32 v[112:113], v[120:121], v[12:13], v[112:113] op_sel:[0,1,0] op_sel_hi:[1,1,1]
    v_pk_fma_f32 v[114:115], v[122:123], v[12:13], v[114:115] op_sel:[0,1,0] op_sel_hi:[1,1,1]
    v_pk_fma_f32 v[116:117], v[124:125], v[12:13], v[116:117] op_sel:[0,1,0] op_sel_hi:[1,1,1]
    v_pk_fma_f32 v[118:119], v[126:127], v[12:13], v[118:119] op_sel:[0,1,0] op_sel_hi:[1,1,1]
    s_waitcnt vmcnt(13)
    v_lshlrev_b32 v120, 16, v56
    v_and_b32 v121, 0xffff0000, v56
    v_lshlrev_b32 v122, 16, v57
    v_and_b32 v123, 0xffff0000, v57
    v_lshlrev_b32 v124, 16, v58
    v_and_b32 v125, 0xffff0000, v58
    v_lshlrev_b32 v126, 16, v59
    v_and_b32 v127, 0xffff0000, v59
    v_pk_fma_f32 v[112:113], v[120:121], v[14:15], v[112:113] op_sel:[0,0,0] op_sel_hi:[1,0,1]
    v_pk_fma_f32 v[114:115], v[122:123], v[14:15], v[114:115] op_sel:[0,0,0] op_sel_hi:[1,0,1]
    v_pk_fma_f32 v[116:117], v[124:125], v[14:15], v[116:117] op_sel:[0,0,0] op_sel_hi:[1,0,1]
    v_pk_fma_f32 v[118:119], v[126:127], v[14:15], v[118:119] op_sel:[0,0,0] op_sel_hi:[1,0,1]
    s_waitcnt vmcnt(12)
    v_lshlrev_b32 v120, 16, v60
    v_and_b32 v121, 0xffff0000, v60
    v_lshlrev_b32 v122, 16, v61
    v_and_b32 v123, 0xffff0000, v61
    v_lshlrev_b32 v124, 16, v62
    v_and_b32 v125, 0xffff0000, v62
    v_lshlrev_b32 v126, 16, v63
    v_and_b32 v127, 0xffff0000, v63
    v_pk_fma_f32 v[112:113], v[120:121], v[14:15], v[112:113] op_sel:[0,1,0] op_sel_hi:[1,1,1]
    v_pk_fma_f32 v[114:115], v[122:123], v[14:15], v[114:115] op_sel:[0,1,0] op_sel_hi:[1,1,1]
    v_pk_fma_f32 v[116:117], v[124:125], v[14:15], v[116:117] op_sel:[0,1,0] op_sel_hi:[1,1,1]
    v_pk_fma_f32 v[118:119], v[126:127], v[14:15], v[118:119] op_sel:[0,1,0] op_sel_hi:[1,1,1]
    s_waitcnt vmcnt(11)
    v_lshlrev_b32 v120, 16, v64
    v_and_b32 v121, 0xffff0000, v64
    v_lshlrev_b32 v122, 16, v65
    v_and_b32 v123, 0xffff0000, v65
    v_lshlrev_b32 v124, 16, v66
    v_and_b32 v125, 0xffff0000, v66
    v_lshlrev_b32 v126, 16, v67
    v_and_b32 v127, 0xffff0000, v67
    v_pk_fma_f32 v[112:113], v[120:121], v[16:17], v[112:113] op_sel:[0,0,0] op_sel_hi:[1,0,1]
    v_pk_fma_f32 v[114:115], v[122:123], v[16:17], v[114:115] op_sel:[0,0,0] op_sel_hi:[1,0,1]
    v_pk_fma_f32 v[116:117], v[124:125], v[16:17], v[116:117] op_sel:[0,0,0] op_sel_hi:[1,0,1]
    v_pk_fma_f32 v[118:119], v[126:127], v[16:17], v[118:119] op_sel:[0,0,0] op_sel_hi:[1,0,1]
    s_waitcnt vmcnt(10)
    v_lshlrev_b32 v120, 16, v68
    v_and_b32 v121, 0xffff0000, v68
    v_lshlrev_b32 v122, 16, v69
    v_and_b32 v123, 0xffff0000, v69
    v_lshlrev_b32 v124, 16, v70
    v_and_b32 v125, 0xffff0000, v70
    v_lshlrev_b32 v126, 16, v71
    v_and_b32 v127, 0xffff0000, v71
    v_pk_fma_f32 v[112:113], v[120:121], v[16:17], v[112:113] op_sel:[0,1,0] op_sel_hi:[1,1,1]
    v_pk_fma_f32 v[114:115], v[122:123], v[16:17], v[114:115] op_sel:[0,1,0] op_sel_hi:[1,1,1]
    v_pk_fma_f32 v[116:117], v[124:125], v[16:17], v[116:117] op_sel:[0,1,0] op_sel_hi:[1,1,1]
    v_pk_fma_f32 v[118:119], v[126:127], v[16:17], v[118:119] op_sel:[0,1,0] op_sel_hi:[1,1,1]
    s_waitcnt vmcnt(9)
    v_lshlrev_b32 v120, 16, v72
    v_and_b32 v121, 0xffff0000, v72
    v_lshlrev_b32 v122, 16, v73
    v_and_b32 v123, 0xffff0000, v73
    v_lshlrev_b32 v124, 16, v74
    v_and_b32 v125, 0xffff0000, v74
    v_lshlrev_b32 v126, 16, v75
    v_and_b32 v127, 0xffff0000, v75
    v_pk_fma_f32 v[112:113], v[120:121], v[18:19], v[112:113] op_sel:[0,0,0] op_sel_hi:[1,0,1]
    v_pk_fma_f32 v[114:115], v[122:123], v[18:19], v[114:115] op_sel:[0,0,0] op_sel_hi:[1,0,1]
    v_pk_fma_f32 v[116:117], v[124:125], v[18:19], v[116:117] op_sel:[0,0,0] op_sel_hi:[1,0,1]
    v_pk_fma_f32 v[118:119], v[126:127], v[18:19], v[118:119] op_sel:[0,0,0] op_sel_hi:[1,0,1]
    s_waitcnt vmcnt(8)
    v_lshlrev_b32 v120, 16, v76
    v_and_b32 v121, 0xffff0000, v76
    v_lshlrev_b32 v122, 16, v77
    v_and_b32 v123, 0xffff0000, v77
    v_lshlrev_b32 v124, 16, v78
    v_and_b32 v125, 0xffff0000, v78
    v_lshlrev_b32 v126, 16, v79
    v_and_b32 v127, 0xffff0000, v79
    v_pk_fma_f32 v[112:113], v[120:121], v[18:19], v[112:113] op_sel:[0,1,0] op_sel_hi:[1,1,1]
    v_pk_fma_f32 v[114:115], v[122:123], v[18:19], v[114:115] op_sel:[0,1,0] op_sel_hi:[1,1,1]
    v_pk_fma_f32 v[116:117], v[124:125], v[18:19], v[116:117] op_sel:[0,1,0] op_sel_hi:[1,1,1]
    v_pk_fma_f32 v[118:119], v[126:127], v[18:19], v[118:119] op_sel:[0,1,0] op_sel_hi:[1,1,1]
    s_waitcnt vmcnt(7)
    v_lshlrev_b32 v120, 16, v80
    v_and_b32 v121, 0xffff0000, v80
    v_lshlrev_b32 v122, 16, v81
    v_and_b32 v123, 0xffff0000, v81
    v_lshlrev_b32 v124, 16, v82
    v_and_b32 v125, 0xffff0000, v82
    v_lshlrev_b32 v126, 16, v83
    v_and_b32 v127, 0xffff0000, v83
    v_pk_fma_f32 v[112:113], v[120:121], v[20:21], v[112:113] op_sel:[0,0,0] op_sel_hi:[1,0,1]
    v_pk_fma_f32 v[114:115], v[122:123], v[20:21], v[114:115] op_sel:[0,0,0] op_sel_hi:[1,0,1]
    v_pk_fma_f32 v[116:117], v[124:125], v[20:21], v[116:117] op_sel:[0,0,0] op_sel_hi:[1,0,1]
    v_pk_fma_f32 v[118:119], v[126:127], v[20:21], v[118:119] op_sel:[0,0,0] op_sel_hi:[1,0,1]
    s_waitcnt vmcnt(6)
    v_lshlrev_b32 v120, 16, v84
    v_and_b32 v121, 0xffff0000, v84
    v_lshlrev_b32 v122, 16, v85
    v_and_b32 v123, 0xffff0000, v85
    v_lshlrev_b32 v124, 16, v86
    v_and_b32 v125, 0xffff0000, v86
    v_lshlrev_b32 v126, 16, v87
    v_and_b32 v127, 0xffff0000, v87
    v_pk_fma_f32 v[112:113], v[120:121], v[20:21], v[112:113] op_sel:[0,1,0] op_sel_hi:[1,1,1]
    v_pk_fma_f32 v[114:115], v[122:123], v[20:21], v[114:115] op_sel:[0,1,0] op_sel_hi:[1,1,1]
    v_pk_fma_f32 v[116:117], v[124:125], v[20:21], v[116:117] op_sel:[0,1,0] op_sel_hi:[1,1,1]
    v_pk_fma_f32 v[118:119], v[126:127], v[20:21], v[118:119] op_sel:[0,1,0] op_sel_hi:[1,1,1]
    s_waitcnt vmcnt(5)
    v_lshlrev_b32 v120, 16, v88
    v_and_b32 v121, 0xffff0000, v88
    v_lshlrev_b32 v122, 16, v89
    v_and_b32 v123, 0xffff0000, v89
    v_lshlrev_b32 v124, 16, v90
    v_and_b32 v125, 0xffff0000, v90
    v_lshlrev_b32 v126, 16, v91
    v_and_b32 v127, 0xffff0000, v91
    v_pk_fma_f32 v[112:113], v[120:121], v[22:23], v[112:113] op_sel:[0,0,0] op_sel_hi:[1,0,1]
    v_pk_fma_f32 v[114:115], v[122:123], v[22:23], v[114:115] op_sel:[0,0,0] op_sel_hi:[1,0,1]
    v_pk_fma_f32 v[116:117], v[124:125], v[22:23], v[116:117] op_sel:[0,0,0] op_sel_hi:[1,0,1]
    v_pk_fma_f32 v[118:119], v[126:127], v[22:23], v[118:119] op_sel:[0,0,0] op_sel_hi:[1,0,1]
    s_waitcnt vmcnt(4)
    v_lshlrev_b32 v120, 16, v92
    v_and_b32 v121, 0xffff0000, v92
    v_lshlrev_b32 v122, 16, v93
    v_and_b32 v123, 0xffff0000, v93
    v_lshlrev_b32 v124, 16, v94
    v_and_b32 v125, 0xffff0000, v94
    v_lshlrev_b32 v126, 16, v95
    v_and_b32 v127, 0xffff0000, v95
    v_pk_fma_f32 v[112:113], v[120:121], v[22:23], v[112:113] op_sel:[0,1,0] op_sel_hi:[1,1,1]
    v_pk_fma_f32 v[114:115], v[122:123], v[22:23], v[114:115] op_sel:[0,1,0] op_sel_hi:[1,1,1]
    v_pk_fma_f32 v[116:117], v[124:125], v[22:23], v[116:117] op_sel:[0,1,0] op_sel_hi:[1,1,1]
    v_pk_fma_f32 v[118:119], v[126:127], v[22:23], v[118:119] op_sel:[0,1,0] op_sel_hi:[1,1,1]
    s_waitcnt vmcnt(3)
    v_lshlrev_b32 v120, 16, v96
    v_and_b32 v121, 0xffff0000, v96
    v_lshlrev_b32 v122, 16, v97
    v_and_b32 v123, 0xffff0000, v97
    v_lshlrev_b32 v124, 16, v98
    v_and_b32 v125, 0xffff0000, v98
    v_lshlrev_b32 v126, 16, v99
    v_and_b32 v127, 0xffff0000, v99
    v_pk_fma_f32 v[112:113], v[120:121], v[24:25], v[112:113] op_sel:[0,0,0] op_sel_hi:[1,0,1]
    v_pk_fma_f32 v[114:115], v[122:123], v[24:25], v[114:115] op_sel:[0,0,0] op_sel_hi:[1,0,1]
    v_pk_fma_f32 v[116:117], v[124:125], v[24:25], v[116:117] op_sel:[0,0,0] op_sel_hi:[1,0,1]
    v_pk_fma_f32 v[118:119], v[126:127], v[24:25], v[118:119] op_sel:[0,0,0] op_sel_hi:[1,0,1]
    s_waitcnt vmcnt(2)
    v_lshlrev_b32 v120, 16, v100
    v_and_b32 v121, 0xffff0000, v100
    v_lshlrev_b32 v122, 16, v101
    v_and_b32 v123, 0xffff0000, v101
    v_lshlrev_b32 v124, 16, v102
    v_and_b32 v125, 0xffff0000, v102
    v_lshlrev_b32 v126, 16, v103
    v_and_b32 v127, 0xffff0000, v103
    v_pk_fma_f32 v[112:113], v[120:121], v[24:25], v[112:113] op_sel:[0,1,0] op_sel_hi:[1,1,1]
    v_pk_fma_f32 v[114:115], v[122:123], v[24:25], v[114:115] op_sel:[0,1,0] op_sel_hi:[1,1,1]
    v_pk_fma_f32 v[116:117], v[124:125], v[24:25], v[116:117] op_sel:[0,1,0] op_sel_hi:[1,1,1]
    v_pk_fma_f32 v[118:119], v[126:127], v[24:25], v[118:119] op_sel:[0,1,0] op_sel_hi:[1,1,1]
    s_waitcnt vmcnt(1)
    v_lshlrev_b32 v120, 16, v104
    v_and_b32 v121, 0xffff0000, v104
    v_lshlrev_b32 v122, 16, v105
    v_and_b32 v123, 0xffff0000, v105
    v_lshlrev_b32 v124, 16, v106
    v_and_b32 v125, 0xffff0000, v106
    v_lshlrev_b32 v126, 16, v107
    v_and_b32 v127, 0xffff0000, v107
    v_pk_fma_f32 v[112:113], v[120:121], v[26:27], v[112:113] op_sel:[0,0,0] op_sel_hi:[1,0,1]
    v_pk_fma_f32 v[114:115], v[122:123], v[26:27], v[114:115] op_sel:[0,0,0] op_sel_hi:[1,0,1]
    v_pk_fma_f32 v[116:117], v[124:125], v[26:27], v[116:117] op_sel:[0,0,0] op_sel_hi:[1,0,1]
    v_pk_fma_f32 v[118:119], v[126:127], v[26:27], v[118:119] op_sel:[0,0,0] op_sel_hi:[1,0,1]
    s_waitcnt vmcnt(0)
    v_lshlrev_b32 v120, 16, v108
    v_and_b32 v121, 0xffff0000, v108
    v_lshlrev_b32 v122, 16, v109
    v_and_b32 v123, 0xffff0000, v109
    v_lshlrev_b32 v124, 16, v110
    v_and_b32 v125, 0xffff0000, v110
    v_lshlrev_b32 v126, 16, v111
    v_and_b32 v127, 0xffff0000, v111
    v_pk_fma_f32 v[112:113], v[120:121], v[26:27], v[112:113] op_sel:[0,1,0] op_sel_hi:[1,1,1]
    v_pk_fma_f32 v[114:115], v[122:123], v[26:27], v[114:115] op_sel:[0,1,0] op_sel_hi:[1,1,1]
    v_pk_fma_f32 v[116:117], v[124:125], v[26:27], v[116:117] op_sel:[0,1,0] op_sel_hi:[1,1,1]
    v_pk_fma_f32 v[118:119], v[126:127], v[26:27], v[118:119] op_sel:[0,1,0] op_sel_hi:[1,1,1]
    s_nop 1
    v_add_f32_dpp v112, v112, v112 row_ror:8 row_mask:0xf bank_mask:0xf
    v_add_f32_dpp v113, v113, v113 row_ror:8 row_mask:0xf bank_mask:0xf
    v_add_f32_dpp v114, v114, v114 row_ror:8 row_mask:0xf bank_mask:0xf
    v_add_f32_dpp v115, v115, v115 row_ror:8 row_mask:0xf bank_mask:0xf
    v_add_f32_dpp v116, v116, v116 row_ror:8 row_mask:0xf bank_mask:0xf
    v_add_f32_dpp v117, v117, v117 row_ror:8 row_mask:0xf bank_mask:0xf
    v_add_f32_dpp v118, v118, v118 row_ror:8 row_mask:0xf bank_mask:0xf
    v_add_f32_dpp v119, v119, v119 row_ror:8 row_mask:0xf bank_mask:0xf
    v_mov_b32 v120, v112
    v_mov_b32 v121, v113
    v_mov_b32 v122, v114
    v_mov_b32 v123, v115
    v_mov_b32 v124, v116
    v_mov_b32 v125, v117
    v_mov_b32 v126, v118
    v_mov_b32 v127, v119
    s_nop 1
    v_permlane32_swap_b32 v120, v112
    v_permlane32_swap_b32 v121, v113
    v_permlane32_swap_b32 v122, v114
    v_permlane32_swap_b32 v123, v115
    v_permlane32_swap_b32 v124, v116
    v_permlane32_swap_b32 v125, v117
    v_permlane32_swap_b32 v126, v118
    v_permlane32_swap_b32 v127, v119
    s_nop 1
    v_add_f32 v112, v112, v120
    v_add_f32 v113, v113, v121
    v_add_f32 v114, v114, v122
    v_add_f32 v115, v115, v123
    v_add_f32 v116, v116, v124
    v_add_f32 v117, v117, v125
    v_add_f32 v118, v118, v126
    v_add_f32 v119, v119, v127
    v_mov_b32 v120, v112
    v_mov_b32 v121, v113
    v_mov_b32 v122, v114
    v_mov_b32 v123, v115
    v_mov_b32 v124, v116
    v_mov_b32 v125, v117
    v_mov_b32 v126, v118
    v_mov_b32 v127, v119
    s_nop 1
    v_permlane16_swap_b32 v120, v112
    v_permlane16_swap_b32 v121, v113
    v_permlane16_swap_b32 v122, v114
    v_permlane16_swap_b32 v123, v115
    v_permlane16_swap_b32 v124, v116
    v_permlane16_swap_b32 v125, v117
    v_permlane16_swap_b32 v126, v118
    v_permlane16_swap_b32 v127, v119
    s_nop 1
    v_add_f32 v112, v112, v120
    v_add_f32 v113, v113, v121
    v_add_f32 v114, v114, v122
    v_add_f32 v115, v115, v123
    v_add_f32 v116, v116, v124
    v_add_f32 v117, v117, v125
    v_add_f32 v118, v118, v126
    v_add_f32 v119, v119, v127
    v_lshlrev_b32 v7, 5, v3
    s_mul_i32 s36, s33, 15360
    s_lshl_b32 s37, s32, 8
    s_add_u32 s37, s37, s36
    s_add_u32 s37, s37, 2793472
    s_lshl_b32 s44, s21, 7
    s_add_u32 s44, s44, 29700096
    s_mov_b64 exec, 0xff
    buffer_store_dwordx4 v[112:115], v7, s[28:31], s37 offen sc1
    buffer_store_dwordx4 v[116:119], v7, s[28:31], s37 offen offset:16 sc1
    s_mov_b64 exec, -1
    s_waitcnt vmcnt(0)
    s_mov_b32 s47, 0
prep_kernel_nn8:
    v_readfirstlane_b32 s46, v250
    s_add_u32 s47, s47, 1
    s_cmp_lg_u32 s46, 0
    s_cbranch_scc1 prep_kernel_nd9
    s_cmp_ge_u32 s47, 200000
    s_cbranch_scc1 prep_kernel_nd9
    buffer_load_dword v250, v251, s[48:51], 0 offen sc1
    s_waitcnt vmcnt(0)
    s_branch prep_kernel_nn8
prep_kernel_nd9:
    v_mov_b32 v132, s46
    v_mov_b32 v133, 0
    s_mov_b64 exec, 1
    buffer_store_dword v132, v133, s[28:31], s44 offen sc1
    s_endpgm
p_st:
    s_mov_b32 s16, s60
    s_mov_b32 s17, s61
    s_mov_b32 s18, 2621440
    s_mov_b32 s19, 0x00020000
    v_lshrrev_b32 v5, 3, v1
    v_and_b32 v6, 7, v1
    s_lshl_b32 s23, s21, 4
    v_add_u32 v7, s23, v5
    v_mul_u32_u24 v9, 1280, v7
    v_lshl_add_u32 v9, v6, 4, v9
    v_mov_b32 v20, 0x3f803f80
    s_mov_b32 s24, 0
    buffer_load_dwordx4 v[32:35], v9, s[16:19], s24 offen offset:0 nt
    buffer_load_dwordx4 v[36:39], v9, s[16:19], s24 offen offset:128 nt
    buffer_load_dwordx4 v[40:43], v9, s[16:19], s24 offen offset:256 nt
    buffer_load_dwordx4 v[44:47], v9, s[16:19], s24 offen offset:384 nt
    buffer_load_dwordx4 v[48:51], v9, s[16:19], s24 offen offset:512 nt
    buffer_load_dwordx4 v[52:55], v9, s[16:19], s24 offen offset:640 nt
    buffer_load_dwordx4 v[56:59], v9, s[16:19], s24 offen offset:768 nt
    buffer_load_dwordx4 v[60:63], v9, s[16:19], s24 offen offset:896 nt
    buffer_load_dwordx4 v[64:67], v9, s[16:19], s24 offen offset:1024 nt
    buffer_load_dwordx4 v[68:71], v9, s[16:19], s24 offen offset:1152 nt
    s_add_u32 s24, s24, 10240
    buffer_load_dwordx4 v[72:75], v9, s[16:19], s24 offen offset:0 nt
    buffer_load_dwordx4 v[76:79], v9, s[16:19], s24 offen offset:128 nt
    buffer_load_dwordx4 v[80:83], v9, s[16:19], s24 offen offset:256 nt
    buffer_load_dwordx4 v[84:87], v9, s[16:19], s24 offen offset:384 nt
    buffer_load_dwordx4 v[88:91], v9, s[16:19], s24 offen offset:512 nt
    buffer_load_dwordx4 v[92:95], v9, s[16:19], s24 offen offset:640 nt
    buffer_load_dwordx4 v[96:99], v9, s[16:19], s24 offen offset:768 nt
    buffer_load_dwordx4 v[100:103], v9, s[16:19], s24 offen offset:896 nt
    buffer_load_dwordx4 v[104:107], v9, s[16:19], s24 offen offset:1024 nt
    buffer_load_dwordx4 v[108:111], v9, s[16:19], s24 offen offset:1152 nt
    v_and_b32 v21, 1, v5
    v_lshl_add_u32 v21, v6, 1, v21
    v_lshlrev_b32 v21, 7, v21
    v_lshrrev_b32 v22, 1, v5
    v_xor_b32 v22, v22, v6
    v_lshl_add_u32 v21, v22, 4, v21
    v_xor_b32 v23, 64, v21
    s_mul_i32 s25, s21, 20480
    s_add_u32 s25, s25, 2854912
    v_mov_b32 v10, 0
    v_mov_b32 v11, 0
    v_mov_b32 v12, 0
    v_mov_b32 v13, 0
    s_waitcnt vmcnt(19)
    v_dot2_f32_bf16 v10, v32, v20, v10
    v_dot2_f32_bf16 v11, v32, v32, v11
    v_dot2_f32_bf16 v10, v33, v20, v10
    v_dot2_f32_bf16 v11, v33, v33, v11
    v_dot2_f32_bf16 v10, v34, v20, v10
    v_dot2_f32_bf16 v11, v34, v34, v11
    v_dot2_f32_bf16 v10, v35, v20, v10
    v_dot2_f32_bf16 v11, v35, v35, v11
    v_mov_b32 v120, v32
    v_mov_b32 v121, v33
    v_mov_b32 v122, v34
    v_mov_b32 v123, v35
    v_mov_b32_dpp v120, v34 row_ror:8 row_mask:0xf bank_mask:0xc
    v_mov_b32_dpp v121, v35 row_ror:8 row_mask:0xf bank_mask:0xc
    v_mov_b32_dpp v122, v32 row_ror:8 row_mask:0xf bank_mask:0x3
    v_mov_b32_dpp v123, v33 row_ror:8 row_mask:0xf bank_mask:0x3
    s_add_u32 s26, s25, 0
    buffer_store_dwordx4 v[120:123], v21, s[28:31], s26 offen sc1
    s_waitcnt vmcnt(19)
    v_dot2_f32_bf16 v10, v36, v20, v10
    v_dot2_f32_bf16 v11, v36, v36, v11
    v_dot2_f32_bf16 v10, v37, v20, v10
    v_dot2_f32_bf16 v11, v37, v37, v11
    v_dot2_f32_bf16 v10, v38, v20, v10
    v_dot2_f32_bf16 v11, v38, v38, v11
    v_dot2_f32_bf16 v10, v39, v20, v10
    v_dot2_f32_bf16 v11, v39, v39, v11
    v_mov_b32 v124, v36
    v_mov_b32 v125, v37
    v_mov_b32 v126, v38
    v_mov_b32 v127, v39
    v_mov_b32_dpp v124, v38 row_ror:8 row_mask:0xf bank_mask:0xc
    v_mov_b32_dpp v125, v39 row_ror:8 row_mask:0xf bank_mask:0xc
    v_mov_b32_dpp v126, v36 row_ror:8 row_mask:0xf bank_mask:0x3
    v_mov_b32_dpp v127, v37 row_ror:8 row_mask:0xf bank_mask:0x3
    s_add_u32 s26, s25, 2048
    buffer_store_dwordx4 v[124:127], v21, s[28:31], s26 offen sc1
    s_waitcnt vmcnt(19)
    v_dot2_f32_bf16 v10, v40, v20, v10
    v_dot2_f32_bf16 v11, v40, v40, v11
    v_dot2_f32_bf16 v10, v41, v20, v10
    v_dot2_f32_bf16 v11, v41, v41, v11
    v_dot2_f32_bf16 v10, v42, v20, v10
    v_dot2_f32_bf16 v11, v42, v42, v11
    v_dot2_f32_bf16 v10, v43, v20, v10
    v_dot2_f32_bf16 v11, v43, v43, v11
    v_mov_b32 v120, v40
    v_mov_b32 v121, v41
    v_mov_b32 v122, v42
    v_mov_b32 v123, v43
    v_mov_b32_dpp v120, v42 row_ror:8 row_mask:0xf bank_mask:0xc
    v_mov_b32_dpp v121, v43 row_ror:8 row_mask:0xf bank_mask:0xc
    v_mov_b32_dpp v122, v40 row_ror:8 row_mask:0xf bank_mask:0x3
    v_mov_b32_dpp v123, v41 row_ror:8 row_mask:0xf bank_mask:0x3
    s_add_u32 s26, s25, 4096
    buffer_store_dwordx4 v[120:123], v21, s[28:31], s26 offen sc1
    s_waitcnt vmcnt(19)
    v_dot2_f32_bf16 v10, v44, v20, v10
    v_dot2_f32_bf16 v11, v44, v44, v11
    v_dot2_f32_bf16 v10, v45, v20, v10
    v_dot2_f32_bf16 v11, v45, v45, v11
    v_dot2_f32_bf16 v10, v46, v20, v10
    v_dot2_f32_bf16 v11, v46, v46, v11
    v_dot2_f32_bf16 v10, v47, v20, v10
    v_dot2_f32_bf16 v11, v47, v47, v11
    v_mov_b32 v124, v44
    v_mov_b32 v125, v45
    v_mov_b32 v126, v46
    v_mov_b32 v127, v47
    v_mov_b32_dpp v124, v46 row_ror:8 row_mask:0xf bank_mask:0xc
    v_mov_b32_dpp v125, v47 row_ror:8 row_mask:0xf bank_mask:0xc
    v_mov_b32_dpp v126, v44 row_ror:8 row_mask:0xf bank_mask:0x3
    v_mov_b32_dpp v127, v45 row_ror:8 row_mask:0xf bank_mask:0x3
    s_add_u32 s26, s25, 6144
    buffer_store_dwordx4 v[124:127], v21, s[28:31], s26 offen sc1
    s_waitcnt vmcnt(19)
    v_dot2_f32_bf16 v10, v48, v20, v10
    v_dot2_f32_bf16 v11, v48, v48, v11
    v_dot2_f32_bf16 v10, v49, v20, v10
    v_dot2_f32_bf16 v11, v49, v49, v11
    v_dot2_f32_bf16 v10, v50, v20, v10
    v_dot2_f32_bf16 v11, v50, v50, v11
    v_dot2_f32_bf16 v10, v51, v20, v10
    v_dot2_f32_bf16 v11, v51, v51, v11
    v_mov_b32 v120, v48
    v_mov_b32 v121, v49
    v_mov_b32 v122, v50
    v_mov_b32 v123, v51
    v_mov_b32_dpp v120, v50 row_ror:8 row_mask:0xf bank_mask:0xc
    v_mov_b32_dpp v121, v51 row_ror:8 row_mask:0xf bank_mask:0xc
    v_mov_b32_dpp v122, v48 row_ror:8 row_mask:0xf bank_mask:0x3
    v_mov_b32_dpp v123, v49 row_ror:8 row_mask:0xf bank_mask:0x3
    s_add_u32 s26, s25, 8192
    buffer_store_dwordx4 v[120:123], v21, s[28:31], s26 offen sc1
    s_waitcnt vmcnt(19)
    v_dot2_f32_bf16 v10, v52, v20, v10
    v_dot2_f32_bf16 v11, v52, v52, v11
    v_dot2_f32_bf16 v10, v53, v20, v10
    v_dot2_f32_bf16 v11, v53, v53, v11
    v_dot2_f32_bf16 v10, v54, v20, v10
    v_dot2_f32_bf16 v11, v54, v54, v11
    v_dot2_f32_bf16 v10, v55, v20, v10
    v_dot2_f32_bf16 v11, v55, v55, v11
    v_mov_b32 v124, v52
    v_mov_b32 v125, v53
    v_mov_b32 v126, v54
    v_mov_b32 v127, v55
    v_mov_b32_dpp v124, v54 row_ror:8 row_mask:0xf bank_mask:0xc
    v_mov_b32_dpp v125, v55 row_ror:8 row_mask:0xf bank_mask:0xc
    v_mov_b32_dpp v126, v52 row_ror:8 row_mask:0xf bank_mask:0x3
    v_mov_b32_dpp v127, v53 row_ror:8 row_mask:0xf bank_mask:0x3
    s_add_u32 s26, s25, 10240
    buffer_store_dwordx4 v[124:127], v21, s[28:31], s26 offen sc1
    s_waitcnt vmcnt(19)
    v_dot2_f32_bf16 v10, v56, v20, v10
    v_dot2_f32_bf16 v11, v56, v56, v11
    v_dot2_f32_bf16 v10, v57, v20, v10
    v_dot2_f32_bf16 v11, v57, v57, v11
    v_dot2_f32_bf16 v10, v58, v20, v10
    v_dot2_f32_bf16 v11, v58, v58, v11
    v_dot2_f32_bf16 v10, v59, v20, v10
    v_dot2_f32_bf16 v11, v59, v59, v11
    v_mov_b32 v120, v56
    v_mov_b32 v121, v57
    v_mov_b32 v122, v58
    v_mov_b32 v123, v59
    v_mov_b32_dpp v120, v58 row_ror:8 row_mask:0xf bank_mask:0xc
    v_mov_b32_dpp v121, v59 row_ror:8 row_mask:0xf bank_mask:0xc
    v_mov_b32_dpp v122, v56 row_ror:8 row_mask:0xf bank_mask:0x3
    v_mov_b32_dpp v123, v57 row_ror:8 row_mask:0xf bank_mask:0x3
    s_add_u32 s26, s25, 12288
    buffer_store_dwordx4 v[120:123], v21, s[28:31], s26 offen sc1
    s_waitcnt vmcnt(19)
    v_dot2_f32_bf16 v10, v60, v20, v10
    v_dot2_f32_bf16 v11, v60, v60, v11
    v_dot2_f32_bf16 v10, v61, v20, v10
    v_dot2_f32_bf16 v11, v61, v61, v11
    v_dot2_f32_bf16 v10, v62, v20, v10
    v_dot2_f32_bf16 v11, v62, v62, v11
    v_dot2_f32_bf16 v10, v63, v20, v10
    v_dot2_f32_bf16 v11, v63, v63, v11
    v_mov_b32 v124, v60
    v_mov_b32 v125, v61
    v_mov_b32 v126, v62
    v_mov_b32 v127, v63
    v_mov_b32_dpp v124, v62 row_ror:8 row_mask:0xf bank_mask:0xc
    v_mov_b32_dpp v125, v63 row_ror:8 row_mask:0xf bank_mask:0xc
    v_mov_b32_dpp v126, v60 row_ror:8 row_mask:0xf bank_mask:0x3
    v_mov_b32_dpp v127, v61 row_ror:8 row_mask:0xf bank_mask:0x3
    s_add_u32 s26, s25, 14336
    buffer_store_dwordx4 v[124:127], v21, s[28:31], s26 offen sc1
    s_waitcnt vmcnt(19)
    v_dot2_f32_bf16 v10, v64, v20, v10
    v_dot2_f32_bf16 v11, v64, v64, v11
    v_dot2_f32_bf16 v10, v65, v20, v10
    v_dot2_f32_bf16 v11, v65, v65, v11
    v_dot2_f32_bf16 v10, v66, v20, v10
    v_dot2_f32_bf16 v11, v66, v66, v11
    v_dot2_f32_bf16 v10, v67, v20, v10
    v_dot2_f32_bf16 v11, v67, v67, v11
    v_mov_b32 v120, v64
    v_mov_b32 v121, v65
    v_mov_b32 v122, v66
    v_mov_b32 v123, v67
    v_mov_b32_dpp v120, v66 row_ror:8 row_mask:0xf bank_mask:0xc
    v_mov_b32_dpp v121, v67 row_ror:8 row_mask:0xf bank_mask:0xc
    v_mov_b32_dpp v122, v64 row_ror:8 row_mask:0xf bank_mask:0x3
    v_mov_b32_dpp v123, v65 row_ror:8 row_mask:0xf bank_mask:0x3
    s_add_u32 s26, s25, 16384
    buffer_store_dwordx4 v[120:123], v21, s[28:31], s26 offen sc1
    s_waitcnt vmcnt(19)
    v_dot2_f32_bf16 v10, v68, v20, v10
    v_dot2_f32_bf16 v11, v68, v68, v11
    v_dot2_f32_bf16 v10, v69, v20, v10
    v_dot2_f32_bf16 v11, v69, v69, v11
    v_dot2_f32_bf16 v10, v70, v20, v10
    v_dot2_f32_bf16 v11, v70, v70, v11
    v_dot2_f32_bf16 v10, v71, v20, v10
    v_dot2_f32_bf16 v11, v71, v71, v11
    v_mov_b32 v124, v68
    v_mov_b32 v125, v69
    v_mov_b32 v126, v70
    v_mov_b32 v127, v71
    v_mov_b32_dpp v124, v70 row_ror:8 row_mask:0xf bank_mask:0xc
    v_mov_b32_dpp v125, v71 row_ror:8 row_mask:0xf bank_mask:0xc
    v_mov_b32_dpp v126, v68 row_ror:8 row_mask:0xf bank_mask:0x3
    v_mov_b32_dpp v127, v69 row_ror:8 row_mask:0xf bank_mask:0x3
    s_add_u32 s26, s25, 18432
    buffer_store_dwordx4 v[124:127], v21, s[28:31], s26 offen sc1
    s_waitcnt vmcnt(19)
    v_dot2_f32_bf16 v12, v72, v20, v12
    v_dot2_f32_bf16 v13, v72, v72, v13
    v_dot2_f32_bf16 v12, v73, v20, v12
    v_dot2_f32_bf16 v13, v73, v73, v13
    v_dot2_f32_bf16 v12, v74, v20, v12
    v_dot2_f32_bf16 v13, v74, v74, v13
    v_dot2_f32_bf16 v12, v75, v20, v12
    v_dot2_f32_bf16 v13, v75, v75, v13
    v_mov_b32 v120, v72
    v_mov_b32 v121, v73
    v_mov_b32 v122, v74
    v_mov_b32 v123, v75
    v_mov_b32_dpp v120, v74 row_ror:8 row_mask:0xf bank_mask:0xc
    v_mov_b32_dpp v121, v75 row_ror:8 row_mask:0xf bank_mask:0xc
    v_mov_b32_dpp v122, v72 row_ror:8 row_mask:0xf bank_mask:0x3
    v_mov_b32_dpp v123, v73 row_ror:8 row_mask:0xf bank_mask:0x3
    s_add_u32 s26, s25, 0
    buffer_store_dwordx4 v[120:123], v23, s[28:31], s26 offen sc1
    s_waitcnt vmcnt(19)
    v_dot2_f32_bf16 v12, v76, v20, v12
    v_dot2_f32_bf16 v13, v76, v76, v13
    v_dot2_f32_bf16 v12, v77, v20, v12
    v_dot2_f32_bf16 v13, v77, v77, v13
    v_dot2_f32_bf16 v12, v78, v20, v12
    v_dot2_f32_bf16 v13, v78, v78, v13
    v_dot2_f32_bf16 v12, v79, v20, v12
    v_dot2_f32_bf16 v13, v79, v79, v13
    v_mov_b32 v124, v76
    v_mov_b32 v125, v77
    v_mov_b32 v126, v78
    v_mov_b32 v127, v79
    v_mov_b32_dpp v124, v78 row_ror:8 row_mask:0xf bank_mask:0xc
    v_mov_b32_dpp v125, v79 row_ror:8 row_mask:0xf bank_mask:0xc
    v_mov_b32_dpp v126, v76 row_ror:8 row_mask:0xf bank_mask:0x3
    v_mov_b32_dpp v127, v77 row_ror:8 row_mask:0xf bank_mask:0x3
    s_add_u32 s26, s25, 2048
    buffer_store_dwordx4 v[124:127], v23, s[28:31], s26 offen sc1
    s_waitcnt vmcnt(19)
    v_dot2_f32_bf16 v12, v80, v20, v12
    v_dot2_f32_bf16 v13, v80, v80, v13
    v_dot2_f32_bf16 v12, v81, v20, v12
    v_dot2_f32_bf16 v13, v81, v81, v13
    v_dot2_f32_bf16 v12, v82, v20, v12
    v_dot2_f32_bf16 v13, v82, v82, v13
    v_dot2_f32_bf16 v12, v83, v20, v12
    v_dot2_f32_bf16 v13, v83, v83, v13
    v_mov_b32 v120, v80
    v_mov_b32 v121, v81
    v_mov_b32 v122, v82
    v_mov_b32 v123, v83
    v_mov_b32_dpp v120, v82 row_ror:8 row_mask:0xf bank_mask:0xc
    v_mov_b32_dpp v121, v83 row_ror:8 row_mask:0xf bank_mask:0xc
    v_mov_b32_dpp v122, v80 row_ror:8 row_mask:0xf bank_mask:0x3
    v_mov_b32_dpp v123, v81 row_ror:8 row_mask:0xf bank_mask:0x3
    s_add_u32 s26, s25, 4096
    buffer_store_dwordx4 v[120:123], v23, s[28:31], s26 offen sc1
    s_waitcnt vmcnt(19)
    v_dot2_f32_bf16 v12, v84, v20, v12
    v_dot2_f32_bf16 v13, v84, v84, v13
    v_dot2_f32_bf16 v12, v85, v20, v12
    v_dot2_f32_bf16 v13, v85, v85, v13
    v_dot2_f32_bf16 v12, v86, v20, v12
    v_dot2_f32_bf16 v13, v86, v86, v13
    v_dot2_f32_bf16 v12, v87, v20, v12
    v_dot2_f32_bf16 v13, v87, v87, v13
    v_mov_b32 v124, v84
    v_mov_b32 v125, v85
    v_mov_b32 v126, v86
    v_mov_b32 v127, v87
    v_mov_b32_dpp v124, v86 row_ror:8 row_mask:0xf bank_mask:0xc
    v_mov_b32_dpp v125, v87 row_ror:8 row_mask:0xf bank_mask:0xc
    v_mov_b32_dpp v126, v84 row_ror:8 row_mask:0xf bank_mask:0x3
    v_mov_b32_dpp v127, v85 row_ror:8 row_mask:0xf bank_mask:0x3
    s_add_u32 s26, s25, 6144
    buffer_store_dwordx4 v[124:127], v23, s[28:31], s26 offen sc1
    s_waitcnt vmcnt(19)
    v_dot2_f32_bf16 v12, v88, v20, v12
    v_dot2_f32_bf16 v13, v88, v88, v13
    v_dot2_f32_bf16 v12, v89, v20, v12
    v_dot2_f32_bf16 v13, v89, v89, v13
    v_dot2_f32_bf16 v12, v90, v20, v12
    v_dot2_f32_bf16 v13, v90, v90, v13
    v_dot2_f32_bf16 v12, v91, v20, v12
    v_dot2_f32_bf16 v13, v91, v91, v13
    v_mov_b32 v120, v88
    v_mov_b32 v121, v89
    v_mov_b32 v122, v90
    v_mov_b32 v123, v91
    v_mov_b32_dpp v120, v90 row_ror:8 row_mask:0xf bank_mask:0xc
    v_mov_b32_dpp v121, v91 row_ror:8 row_mask:0xf bank_mask:0xc
    v_mov_b32_dpp v122, v88 row_ror:8 row_mask:0xf bank_mask:0x3
    v_mov_b32_dpp v123, v89 row_ror:8 row_mask:0xf bank_mask:0x3
    s_add_u32 s26, s25, 8192
    buffer_store_dwordx4 v[120:123], v23, s[28:31], s26 offen sc1
    s_waitcnt vmcnt(19)
    v_dot2_f32_bf16 v12, v92, v20, v12
    v_dot2_f32_bf16 v13, v92, v92, v13
    v_dot2_f32_bf16 v12, v93, v20, v12
    v_dot2_f32_bf16 v13, v93, v93, v13
    v_dot2_f32_bf16 v12, v94, v20, v12
    v_dot2_f32_bf16 v13, v94, v94, v13
    v_dot2_f32_bf16 v12, v95, v20, v12
    v_dot2_f32_bf16 v13, v95, v95, v13
    v_mov_b32 v124, v92
    v_mov_b32 v125, v93
    v_mov_b32 v126, v94
    v_mov_b32 v127, v95
    v_mov_b32_dpp v124, v94 row_ror:8 row_mask:0xf bank_mask:0xc
    v_mov_b32_dpp v125, v95 row_ror:8 row_mask:0xf bank_mask:0xc
    v_mov_b32_dpp v126, v92 row_ror:8 row_mask:0xf bank_mask:0x3
    v_mov_b32_dpp v127, v93 row_ror:8 row_mask:0xf bank_mask:0x3
    s_add_u32 s26, s25, 10240
    buffer_store_dwordx4 v[124:127], v23, s[28:31], s26 offen sc1
    s_waitcnt vmcnt(19)
    v_dot2_f32_bf16 v12, v96, v20, v12
    v_dot2_f32_bf16 v13, v96, v96, v13
    v_dot2_f32_bf16 v12, v97, v20, v12
    v_dot2_f32_bf16 v13, v97, v97, v13
    v_dot2_f32_bf16 v12, v98, v20, v12
    v_dot2_f32_bf16 v13, v98, v98, v13
    v_dot2_f32_bf16 v12, v99, v20, v12
    v_dot2_f32_bf16 v13, v99, v99, v13
    v_mov_b32 v120, v96
    v_mov_b32 v121, v97
    v_mov_b32 v122, v98
    v_mov_b32 v123, v99
    v_mov_b32_dpp v120, v98 row_ror:8 row_mask:0xf bank_mask:0xc
    v_mov_b32_dpp v121, v99 row_ror:8 row_mask:0xf bank_mask:0xc
    v_mov_b32_dpp v122, v96 row_ror:8 row_mask:0xf bank_mask:0x3
    v_mov_b32_dpp v123, v97 row_ror:8 row_mask:0xf bank_mask:0x3
    s_add_u32 s26, s25, 12288
    buffer_store_dwordx4 v[120:123], v23, s[28:31], s26 offen sc1
    s_waitcnt vmcnt(19)
    v_dot2_f32_bf16 v12, v100, v20, v12
    v_dot2_f32_bf16 v13, v100, v100, v13
    v_dot2_f32_bf16 v12, v101, v20, v12
    v_dot2_f32_bf16 v13, v101, v101, v13
    v_dot2_f32_bf16 v12, v102, v20, v12
    v_dot2_f32_bf16 v13, v102, v102, v13
    v_dot2_f32_bf16 v12, v103, v20, v12
    v_dot2_f32_bf16 v13, v103, v103, v13
    v_mov_b32 v124, v100
    v_mov_b32 v125, v101
    v_mov_b32 v126, v102
    v_mov_b32 v127, v103
    v_mov_b32_dpp v124, v102 row_ror:8 row_mask:0xf bank_mask:0xc
    v_mov_b32_dpp v125, v103 row_ror:8 row_mask:0xf bank_mask:0xc
    v_mov_b32_dpp v126, v100 row_ror:8 row_mask:0xf bank_mask:0x3
    v_mov_b32_dpp v127, v101 row_ror:8 row_mask:0xf bank_mask:0x3
    s_add_u32 s26, s25, 14336
    buffer_store_dwordx4 v[124:127], v23, s[28:31], s26 offen sc1
    s_waitcnt vmcnt(19)
    v_dot2_f32_bf16 v12, v104, v20, v12
    v_dot2_f32_bf16 v13, v104, v104, v13
    v_dot2_f32_bf16 v12, v105, v20, v12
    v_dot2_f32_bf16 v13, v105, v105, v13
    v_dot2_f32_bf16 v12, v106, v20, v12
    v_dot2_f32_bf16 v13, v106, v106, v13
    v_dot2_f32_bf16 v12, v107, v20, v12
    v_dot2_f32_bf16 v13, v107, v107, v13
    v_mov_b32 v120, v104
    v_mov_b32 v121, v105
    v_mov_b32 v122, v106
    v_mov_b32 v123, v107
    v_mov_b32_dpp v120, v106 row_ror:8 row_mask:0xf bank_mask:0xc
    v_mov_b32_dpp v121, v107 row_ror:8 row_mask:0xf bank_mask:0xc
    v_mov_b32_dpp v122, v104 row_ror:8 row_mask:0xf bank_mask:0x3
    v_mov_b32_dpp v123, v105 row_ror:8 row_mask:0xf bank_mask:0x3
    s_add_u32 s26, s25, 16384
    buffer_store_dwordx4 v[120:123], v23, s[28:31], s26 offen sc1
    s_waitcnt vmcnt(19)
    v_dot2_f32_bf16 v12, v108, v20, v12
    v_dot2_f32_bf16 v13, v108, v108, v13
    v_dot2_f32_bf16 v12, v109, v20, v12
    v_dot2_f32_bf16 v13, v109, v109, v13
    v_dot2_f32_bf16 v12, v110, v20, v12
    v_dot2_f32_bf16 v13, v110, v110, v13
    v_dot2_f32_bf16 v12, v111, v20, v12
    v_dot2_f32_bf16 v13, v111, v111, v13
    v_mov_b32 v124, v108
    v_mov_b32 v125, v109
    v_mov_b32 v126, v110
    v_mov_b32 v127, v111
    v_mov_b32_dpp v124, v110 row_ror:8 row_mask:0xf bank_mask:0xc
    v_mov_b32_dpp v125, v111 row_ror:8 row_mask:0xf bank_mask:0xc
    v_mov_b32_dpp v126, v108 row_ror:8 row_mask:0xf bank_mask:0x3
    v_mov_b32_dpp v127, v109 row_ror:8 row_mask:0xf bank_mask:0x3
    s_add_u32 s26, s25, 18432
    buffer_store_dwordx4 v[124:127], v23, s[28:31], s26 offen sc1
    s_nop 2
    v_add_f32_dpp v10, v10, v10 quad_perm:[1,0,3,2] row_mask:0xf bank_mask:0xf
    v_add_f32_dpp v11, v11, v11 quad_perm:[1,0,3,2] row_mask:0xf bank_mask:0xf
    v_add_f32_dpp v12, v12, v12 quad_perm:[1,0,3,2] row_mask:0xf bank_mask:0xf
    v_add_f32_dpp v13, v13, v13 quad_perm:[1,0,3,2] row_mask:0xf bank_mask:0xf
    v_add_f32_dpp v10, v10, v10 quad_perm:[2,3,0,1] row_mask:0xf bank_mask:0xf
    v_add_f32_dpp v11, v11, v11 quad_perm:[2,3,0,1] row_mask:0xf bank_mask:0xf
    v_add_f32_dpp v12, v12, v12 quad_perm:[2,3,0,1] row_mask:0xf bank_mask:0xf
    v_add_f32_dpp v13, v13, v13 quad_perm:[2,3,0,1] row_mask:0xf bank_mask:0xf
    v_add_f32_dpp v10, v10, v10 row_half_mirror row_mask:0xf bank_mask:0xf
    v_add_f32_dpp v11, v11, v11 row_half_mirror row_mask:0xf bank_mask:0xf
    v_add_f32_dpp v12, v12, v12 row_half_mirror row_mask:0xf bank_mask:0xf
    v_add_f32_dpp v13, v13, v13 row_half_mirror row_mask:0xf bank_mask:0xf
    v_mul_f32 v10, 0x3acccccd, v10
    v_mul_f32 v12, 0x3acccccd, v12
    v_mul_f32 v11, 0x3acccccd, v11
    v_mul_f32 v13, 0x3acccccd, v13
    v_fma_f32 v11, -v10, v10, v11
    v_fma_f32 v13, -v12, v12, v13
    v_max_f32 v11, 0, v11
    v_max_f32 v13, 0, v13
    v_cvt_pk_bf16_f32 v24, v10, v11
    v_cvt_pk_bf16_f32 v25, v12, v13
    v_lshlrev_b32 v10, 16, v24
    v_lshlrev_b32 v12, 16, v25
    v_and_b32 v11, 0xffff0000, v24
    v_and_b32 v13, 0xffff0000, v25
    v_add_f32 v11, 0x3727c5ac, v11
    v_add_f32 v13, 0x3727c5ac, v13
    v_cvt_pk_bf16_f32 v24, v11, v11
    v_cvt_pk_bf16_f32 v25, v13, v13
    v_lshlrev_b32 v11, 16, v24
    v_lshlrev_b32 v13, 16, v25
    v_sqrt_f32 v11, v11
    v_sqrt_f32 v13, v13
    s_nop 0
    s_nop 0
    v_cvt_pk_bf16_f32 v24, v11, v11
    v_cvt_pk_bf16_f32 v25, v13, v13
    v_lshlrev_b32 v11, 16, v24
    v_lshlrev_b32 v13, 16, v25
    v_rcp_f32 v11, v11
    v_rcp_f32 v13, v13
    s_nop 0
    s_nop 0
    v_mul_f32 v10, v10, v11
    v_mul_f32 v12, v12, v13
    v_sub_f32 v10, 0, v10
    v_sub_f32 v12, 0, v12
    v_lshlrev_b32 v7, 3, v7
    v_cmp_eq_u32 vcc, 0, v6
    s_lshl_b32 s44, s21, 7
    s_add_u32 s44, s44, 29683712
    s_mov_b32 s23, 5476352
    s_and_saveexec_b64 s[66:67], vcc
    buffer_store_dwordx2 v[10:11], v7, s[28:31], s23 offen offset:0 sc1
    buffer_store_dwordx2 v[12:13], v7, s[28:31], s23 offen offset:64 sc1
    s_mov_b64 exec, -1
    s_waitcnt vmcnt(0)
    s_mov_b32 s47, 0
prep_kernel_nn10:
    v_readfirstlane_b32 s46, v250
    s_add_u32 s47, s47, 1
    s_cmp_lg_u32 s46, 0
    s_cbranch_scc1 prep_kernel_nd11
    s_cmp_ge_u32 s47, 200000
    s_cbranch_scc1 prep_kernel_nd11
    buffer_load_dword v250, v251, s[48:51], 0 offen sc1
    s_waitcnt vmcnt(0)
    s_branch prep_kernel_nn10
prep_kernel_nd11:
    v_mov_b32 v30, s46
    v_mov_b32 v31, 0
    s_mov_b64 exec, 1
    buffer_store_dword v30, v31, s[28:31], s44 offen sc1
    s_endpgm
p_misc:
    s_sub_u32 s24, s20, 3
    s_mul_i32 s23, s24, 96
    s_add_u32 s23, s23, s21
    s_cmp_ge_u32 s23, 256
    s_cbranch_scc1 prep_end
    s_mul_i32 s22, s24, 12
    s_lshr_b32 s25, s21, 3
    s_add_u32 s22, s22, s25
    v_lshlrev_b32 v1, 4, v1
    v_mov_b32 v60, 0
    v_mov_b32 v61, 0
    v_mov_b32 v62, 0
    v_mov_b32 v63, 0
    s_lshl_b32 s24, s23, 10
    s_add_u32 s25, s24, 29380608
    s_add_u32 s26, s24, 10784768
    s_add_u32 s27, s24, 13365248
    s_cmp_ge_u32 s23, 20
    s_cselect_b32 s26, s27, s26
    s_cmp_ge_u32 s23, 256
    s_cbranch_scc1 prep_kernel_nz12
    buffer_store_dwordx4 v[60:63], v1, s[28:31], s25 offen sc1
prep_kernel_nz12:
    s_cmp_ge_u32 s23, 40
    s_cbranch_scc1 prep_kernel_nz13
    buffer_store_dwordx4 v[60:63], v1, s[28:31], s26 offen sc1
prep_kernel_nz13:
    s_getpc_b64 s[24:25]
p_pcref:
    s_sub_u32 s24, s24, p_pcref-prep_kernel
    s_subb_u32 s25, s25, 0
    s_lshl_b32 s23, s22, 11
    s_add_u32 s26, s23, 0
    s_min_u32 s26, s26, (chain_end-prep_kernel-1020)&0xfffffff0
    v_add_u32 v64, s26, v1
    v_mov_b32 v5, s25
    v_add_co_u32 v4, vcc, s24, v64
    v_addc_co_u32 v5, vcc, 0, v5, vcc
    global_load_dwordx4 v[72:75], v[4:5], off
    s_add_u32 s26, s23, 1024
    s_min_u32 s26, s26, (chain_end-prep_kernel-1020)&0xfffffff0
    v_add_u32 v64, s26, v1
    v_mov_b32 v5, s25
    v_add_co_u32 v4, vcc, s24, v64
    v_addc_co_u32 v5, vcc, 0, v5, vcc
    global_load_dwordx4 v[76:79], v[4:5], off
    s_waitcnt vmcnt(0)
    s_endpgm
p_conv:
    s_and_b32 s21, s2, 7
    s_mul_i32 s21, s21, 20
    s_sub_u32 s2, s2, 256
    s_lshr_b32 s2, s2, 3
    s_add_u32 s2, s2, s21
    s_and_b32 s19, s20, 3
    s_mov_b32 s24, s56
    s_mov_b32 s25, s57
    s_mov_b32 s26, 2621440
    s_mov_b32 s27, 0x00020000
    s_lshl_b32 s21, s2, 3
    s_add_u32 s22, s58, s21
    s_addc_u32 s23, s59, 0
    s_load_dwordx2 s[32:33], s[22:23], 0
    s_lshl_b32 s21, s2, 2
    s_add_u32 s21, s21, s19
    s_mul_i32 s34, s19, 13824
    v_lshlrev_b32 v3, 4, v1
    s_lshl_b32 s35, s21, 12
    s_mul_i32 s37, s21, 4352
    s_add_u32 s37, s37, 0
    v_lshrrev_b32 v4, 3, v0
    v_mul_u32_u24 v4, 20480, v4
    s_lshr_b32 s38, s2, 1
    s_and_b32 s38, s38, 7
    v_and_b32 v5, 7, v0
    v_xor_b32 v5, s38, v5
    v_lshl_add_u32 v4, v5, 4, v4
    s_lshl_b32 s38, s2, 7
    v_lshl_add_u32 v5, v1, 2, s34
    v_mov_b32 v6, 0
    v_and_b32 v7, 15, v1
    v_bfe_u32 v8, v1, 4, 1
    v_lshrrev_b32 v9, 5, v1
    v_and_b32 v14, 31, v1
    v_lshlrev_b32 v14, 3, v14
    v_lshl_add_u32 v14, v9, 4, v14
    v_add_u32 v14, s34, v14
    v_and_b32 v17, 1, v1
    v_mul_u32_u24 v17, 9464, v17
    v_sub_u32 v17, 9472, v17
    v_add_u32 v14, v17, v14
    s_cmp_ge_u32 s20, 4
    s_cbranch_scc1 p_convP
    s_add_u32 s36, s34, 256
    s_mov_b32 m0, s36
    ds_write_b32 v5, v6
    buffer_load_dwordx4 v3, s[24:27], s35 offen offset:0 nt lds
    buffer_load_dwordx4 v3, s[24:27], s35 offen offset:1024 nt lds
    buffer_load_dwordx4 v3, s[24:27], s35 offen offset:2048 nt lds
    buffer_load_dwordx4 v3, s[24:27], s35 offen offset:3072 nt lds
    v_mul_u32_u24 v10, 272, v7
    v_lshl_add_u32 v10, v9, 4, v10
    v_add_u32 v10, s34, v10
    v_add_u32 v10, 4356, v10
    v_lshlrev_b32 v11, 2, v8
    v_sub_u32 v10, v10, v11
    s_cmp_lg_u32 s20, 0
    s_cbranch_scc1 prep_kernel_w014
    v_mov_b32 v16, 0
    buffer_load_dword v17, v16, s[48:51], 0 offen sc1
    s_waitcnt vmcnt(0)
    s_mov_b32 s47, 0
prep_kernel_nn15:
    v_readfirstlane_b32 s46, v17
    s_add_u32 s47, s47, 1
    s_cmp_lg_u32 s46, 0
    s_cbranch_scc1 prep_kernel_nd16
    s_cmp_ge_u32 s47, 200000
    s_cbranch_scc1 prep_kernel_nd16
    buffer_load_dword v17, v16, s[48:51], 0 offen sc1
    s_waitcnt vmcnt(0)
    s_branch prep_kernel_nn15
prep_kernel_nd16:
    s_lshr_b32 s40, s2, 4
    s_lshl_b32 s40, s40, 12
    s_add_u32 s40, s40, 29642752
    v_lshlrev_b32 v16, 7, v1
    s_mov_b32 s47, 0
    s_mov_b32 exec_lo, -1
    s_mov_b32 exec_hi, 0
prep_kernel_pl17:
    buffer_load_dword v17, v16, s[28:31], s40 offen sc1
    s_add_u32 s47, s47, 1
    s_waitcnt vmcnt(0)
    v_cmp_ne_u32 vcc, s46, v17
    s_cmp_ge_u32 s47, 200000
    s_cbranch_scc1 prep_kernel_pd18
    s_cbranch_vccz prep_kernel_pd18
    s_sleep 14
    s_branch prep_kernel_pl17
prep_kernel_pd18:
    s_mov_b64 exec, -1
prep_kernel_w014:
    s_barrier
    s_add_u32 s36, s34, 4352
    s_mov_b32 m0, s36
    s_nop 0
    buffer_load_dwordx4 v3, s[28:31], s37 offen offset:0 sc1 lds
    buffer_load_dwordx4 v3, s[28:31], s37 offen offset:1024 sc1 lds
    buffer_load_dwordx4 v3, s[28:31], s37 offen offset:2048 sc1 lds
    buffer_load_dwordx4 v3, s[28:31], s37 offen offset:3072 sc1 lds
    s_add_u32 s36, s34, 8448
    s_mov_b32 m0, s36
    s_add_u32 s37, s37, 4096
    buffer_load_dwordx4 v3, s[28:31], s37 offen sc1 lds
    s_waitcnt vmcnt(0) lgkmcnt(0)
    s_barrier
    ds_read2_b32 v[64:65], v10 offset0:0 offset1:1
    ds_read2_b32 v[66:67], v10 offset0:2 offset1:3
    ds_read2_b32 v[68:69], v10 offset0:8 offset1:9
    ds_read2_b32 v[70:71], v10 offset0:10 offset1:11
    ds_read2_b32 v[72:73], v10 offset0:16 offset1:17
    ds_read2_b32 v[74:75], v10 offset0:18 offset1:19
    ds_read2_b32 v[76:77], v10 offset0:24 offset1:25
    ds_read2_b32 v[78:79], v10 offset0:26 offset1:27
    ds_read2_b32 v[80:81], v10 offset0:32 offset1:33
    ds_read2_b32 v[82:83], v10 offset0:34 offset1:35
    ds_read2_b32 v[84:85], v10 offset0:40 offset1:41
    ds_read2_b32 v[86:87], v10 offset0:42 offset1:43
    ds_read2_b32 v[88:89], v10 offset0:48 offset1:49
    ds_read2_b32 v[90:91], v10 offset0:50 offset1:51
    ds_read2_b32 v[92:93], v10 offset0:56 offset1:57
    ds_read2_b32 v[94:95], v10 offset0:58 offset1:59
    ds_read_b32 v16, v10 offset:16
    ds_read_b32 v17, v10 offset:48
    ds_read_b32 v18, v10 offset:80
    ds_read_b32 v19, v10 offset:112
    ds_read_b32 v20, v10 offset:144
    ds_read_b32 v21, v10 offset:176
    ds_read_b32 v22, v10 offset:208
    ds_read_b32 v23, v10 offset:240
    s_waitcnt lgkmcnt(8)
    ds_read_b128 v[208:211], v14 offset:1792
    ds_read_b128 v[212:215], v14 offset:1824
    ds_read_b128 v[216:219], v14 offset:1856
    ds_read_b128 v[220:223], v14 offset:1888
    ds_read_b128 v[224:227], v14 offset:1920
    ds_read_b128 v[228:231], v14 offset:1952
    ds_read_b128 v[232:235], v14 offset:1984
    ds_read_b128 v[236:239], v14 offset:2016
    s_waitcnt lgkmcnt(0)
    v_mfma_f32_32x32x16_bf16 v[144:159], v[208:211], v[64:67], 0
    v_alignbit_b32 v32, v65, v64, 16
    v_alignbit_b32 v33, v66, v65, 16
    v_alignbit_b32 v34, v67, v66, 16
    v_alignbit_b32 v35, v16, v67, 16
    v_mfma_f32_32x32x16_bf16 v[144:159], v[212:215], v[68:71], v[144:159]
    v_alignbit_b32 v36, v69, v68, 16
    v_alignbit_b32 v37, v70, v69, 16
    v_alignbit_b32 v38, v71, v70, 16
    v_alignbit_b32 v39, v17, v71, 16
    v_mfma_f32_32x32x16_bf16 v[144:159], v[216:219], v[72:75], v[144:159]
    v_alignbit_b32 v40, v73, v72, 16
    v_alignbit_b32 v41, v74, v73, 16
    v_alignbit_b32 v42, v75, v74, 16
    v_alignbit_b32 v43, v18, v75, 16
    v_mfma_f32_32x32x16_bf16 v[144:159], v[220:223], v[76:79], v[144:159]
    v_alignbit_b32 v44, v77, v76, 16
    v_alignbit_b32 v45, v78, v77, 16
    v_alignbit_b32 v46, v79, v78, 16
    v_alignbit_b32 v47, v19, v79, 16
    v_mfma_f32_32x32x16_bf16 v[144:159], v[224:227], v[80:83], v[144:159]
    v_alignbit_b32 v48, v81, v80, 16
    v_alignbit_b32 v49, v82, v81, 16
    v_alignbit_b32 v50, v83, v82, 16
    v_alignbit_b32 v51, v20, v83, 16
    v_mfma_f32_32x32x16_bf16 v[144:159], v[228:231], v[84:87], v[144:159]
    v_alignbit_b32 v52, v85, v84, 16
    v_alignbit_b32 v53, v86, v85, 16
    v_alignbit_b32 v54, v87, v86, 16
    v_alignbit_b32 v55, v21, v87, 16
    v_mfma_f32_32x32x16_bf16 v[144:159], v[232:235], v[88:91], v[144:159]
    v_alignbit_b32 v56, v89, v88, 16
    v_alignbit_b32 v57, v90, v89, 16
    v_alignbit_b32 v58, v91, v90, 16
    v_alignbit_b32 v59, v22, v91, 16
    v_mfma_f32_32x32x16_bf16 v[144:159], v[236:239], v[92:95], v[144:159]
    v_alignbit_b32 v60, v93, v92, 16
    v_alignbit_b32 v61, v94, v93, 16
    v_alignbit_b32 v62, v95, v94, 16
    v_alignbit_b32 v63, v23, v95, 16
    s_nop 1
    v_mfma_f32_32x32x16_bf16 v[128:143], v[208:211], v[32:35], 0
    ds_read_b128 v[176:179], v14 offset:1536
    ds_read_b128 v[180:183], v14 offset:1568
    s_nop 2
    v_mfma_f32_32x32x16_bf16 v[128:143], v[212:215], v[36:39], v[128:143]
    ds_read_b128 v[184:187], v14 offset:1600
    ds_read_b128 v[188:191], v14 offset:1632
    s_nop 2
    v_mfma_f32_32x32x16_bf16 v[128:143], v[216:219], v[40:43], v[128:143]
    ds_read_b128 v[192:195], v14 offset:1664
    v_mov_b32_dpp v144, v144 row_shr:1 row_mask:0xf bank_mask:0xf bound_ctrl:0
    v_mov_b32_dpp v145, v145 row_shr:1 row_mask:0xf bank_mask:0xf bound_ctrl:0
    v_mov_b32_dpp v146, v146 row_shr:1 row_mask:0xf bank_mask:0xf bound_ctrl:0
    v_mfma_f32_32x32x16_bf16 v[128:143], v[220:223], v[44:47], v[128:143]
    ds_read_b128 v[196:199], v14 offset:1696
    v_mov_b32_dpp v147, v147 row_shr:1 row_mask:0xf bank_mask:0xf bound_ctrl:0
    v_mov_b32_dpp v148, v148 row_shr:1 row_mask:0xf bank_mask:0xf bound_ctrl:0
    v_mov_b32_dpp v149, v149 row_shr:1 row_mask:0xf bank_mask:0xf bound_ctrl:0
    v_mfma_f32_32x32x16_bf16 v[128:143], v[224:227], v[48:51], v[128:143]
    ds_read_b128 v[200:203], v14 offset:1728
    v_mov_b32_dpp v150, v150 row_shr:1 row_mask:0xf bank_mask:0xf bound_ctrl:0
    v_mov_b32_dpp v151, v151 row_shr:1 row_mask:0xf bank_mask:0xf bound_ctrl:0
    v_mov_b32_dpp v152, v152 row_shr:1 row_mask:0xf bank_mask:0xf bound_ctrl:0
    v_mfma_f32_32x32x16_bf16 v[128:143], v[228:231], v[52:55], v[128:143]
    ds_read_b128 v[204:207], v14 offset:1760
    v_mov_b32_dpp v153, v153 row_shr:1 row_mask:0xf bank_mask:0xf bound_ctrl:0
    v_mov_b32_dpp v154, v154 row_shr:1 row_mask:0xf bank_mask:0xf bound_ctrl:0
    v_mov_b32_dpp v155, v155 row_shr:1 row_mask:0xf bank_mask:0xf bound_ctrl:0
    v_mfma_f32_32x32x16_bf16 v[128:143], v[232:235], v[56:59], v[128:143]
    v_mov_b32_dpp v156, v156 row_shr:1 row_mask:0xf bank_mask:0xf bound_ctrl:0
    v_mov_b32_dpp v157, v157 row_shr:1 row_mask:0xf bank_mask:0xf bound_ctrl:0
    v_mfma_f32_32x32x16_bf16 v[128:143], v[236:239], v[60:63], v[128:143]
    v_mov_b32_dpp v158, v158 row_shr:1 row_mask:0xf bank_mask:0xf bound_ctrl:0
    v_mov_b32_dpp v159, v159 row_shr:1 row_mask:0xf bank_mask:0xf bound_ctrl:0
    s_waitcnt lgkmcnt(0)
    s_nop 0
    v_mfma_f32_32x32x16_bf16 v[144:159], v[176:179], v[64:67], v[144:159]
    s_nop 4
    v_mfma_f32_32x32x16_bf16 v[144:159], v[180:183], v[68:71], v[144:159]
    s_nop 4
    v_mfma_f32_32x32x16_bf16 v[144:159], v[184:187], v[72:75], v[144:159]
    v_mov_b32_dpp v128, v128 row_shr:1 row_mask:0xf bank_mask:0xf bound_ctrl:0
    v_mov_b32_dpp v129, v129 row_shr:1 row_mask:0xf bank_mask:0xf bound_ctrl:0
    v_mov_b32_dpp v130, v130 row_shr:1 row_mask:0xf bank_mask:0xf bound_ctrl:0
    v_mfma_f32_32x32x16_bf16 v[144:159], v[188:191], v[76:79], v[144:159]
    v_mov_b32_dpp v131, v131 row_shr:1 row_mask:0xf bank_mask:0xf bound_ctrl:0
    v_mov_b32_dpp v132, v132 row_shr:1 row_mask:0xf bank_mask:0xf bound_ctrl:0
    v_mov_b32_dpp v133, v133 row_shr:1 row_mask:0xf bank_mask:0xf bound_ctrl:0
    v_mfma_f32_32x32x16_bf16 v[144:159], v[192:195], v[80:83], v[144:159]
    v_mov_b32_dpp v134, v134 row_shr:1 row_mask:0xf bank_mask:0xf bound_ctrl:0
    v_mov_b32_dpp v135, v135 row_shr:1 row_mask:0xf bank_mask:0xf bound_ctrl:0
    v_mov_b32_dpp v136, v136 row_shr:1 row_mask:0xf bank_mask:0xf bound_ctrl:0
    v_mfma_f32_32x32x16_bf16 v[144:159], v[196:199], v[84:87], v[144:159]
    v_mov_b32_dpp v137, v137 row_shr:1 row_mask:0xf bank_mask:0xf bound_ctrl:0
    v_mov_b32_dpp v138, v138 row_shr:1 row_mask:0xf bank_mask:0xf bound_ctrl:0
    v_mov_b32_dpp v139, v139 row_shr:1 row_mask:0xf bank_mask:0xf bound_ctrl:0
    v_mfma_f32_32x32x16_bf16 v[144:159], v[200:203], v[88:91], v[144:159]
    v_mov_b32_dpp v140, v140 row_shr:1 row_mask:0xf bank_mask:0xf bound_ctrl:0
    v_mov_b32_dpp v141, v141 row_shr:1 row_mask:0xf bank_mask:0xf bound_ctrl:0
    v_mfma_f32_32x32x16_bf16 v[144:159], v[204:207], v[92:95], v[144:159]
    v_mov_b32_dpp v142, v142 row_shr:1 row_mask:0xf bank_mask:0xf bound_ctrl:0
    v_mov_b32_dpp v143, v143 row_shr:1 row_mask:0xf bank_mask:0xf bound_ctrl:0
    s_nop 1
    v_mfma_f32_32x32x16_bf16 v[128:143], v[176:179], v[32:35], v[128:143]
    ds_read_b128 v[208:211], v14 offset:1280
    ds_read_b128 v[212:215], v14 offset:1312
    s_nop 2
    v_mfma_f32_32x32x16_bf16 v[128:143], v[180:183], v[36:39], v[128:143]
    ds_read_b128 v[216:219], v14 offset:1344
    ds_read_b128 v[220:223], v14 offset:1376
    s_nop 2
    v_mfma_f32_32x32x16_bf16 v[128:143], v[184:187], v[40:43], v[128:143]
    ds_read_b128 v[224:227], v14 offset:1408
    v_mov_b32_dpp v144, v144 row_shr:1 row_mask:0xf bank_mask:0xf bound_ctrl:0
    v_mov_b32_dpp v145, v145 row_shr:1 row_mask:0xf bank_mask:0xf bound_ctrl:0
    v_mov_b32_dpp v146, v146 row_shr:1 row_mask:0xf bank_mask:0xf bound_ctrl:0
    v_mfma_f32_32x32x16_bf16 v[128:143], v[188:191], v[44:47], v[128:143]
    ds_read_b128 v[228:231], v14 offset:1440
    v_mov_b32_dpp v147, v147 row_shr:1 row_mask:0xf bank_mask:0xf bound_ctrl:0
    v_mov_b32_dpp v148, v148 row_shr:1 row_mask:0xf bank_mask:0xf bound_ctrl:0
    v_mov_b32_dpp v149, v149 row_shr:1 row_mask:0xf bank_mask:0xf bound_ctrl:0
    v_mfma_f32_32x32x16_bf16 v[128:143], v[192:195], v[48:51], v[128:143]
    ds_read_b128 v[232:235], v14 offset:1472
    v_mov_b32_dpp v150, v150 row_shr:1 row_mask:0xf bank_mask:0xf bound_ctrl:0
    v_mov_b32_dpp v151, v151 row_shr:1 row_mask:0xf bank_mask:0xf bound_ctrl:0
    v_mov_b32_dpp v152, v152 row_shr:1 row_mask:0xf bank_mask:0xf bound_ctrl:0
    v_mfma_f32_32x32x16_bf16 v[128:143], v[196:199], v[52:55], v[128:143]
    ds_read_b128 v[236:239], v14 offset:1504
    v_mov_b32_dpp v153, v153 row_shr:1 row_mask:0xf bank_mask:0xf bound_ctrl:0
    v_mov_b32_dpp v154, v154 row_shr:1 row_mask:0xf bank_mask:0xf bound_ctrl:0
    v_mov_b32_dpp v155, v155 row_shr:1 row_mask:0xf bank_mask:0xf bound_ctrl:0
    v_mfma_f32_32x32x16_bf16 v[128:143], v[200:203], v[56:59], v[128:143]
    v_mov_b32_dpp v156, v156 row_shr:1 row_mask:0xf bank_mask:0xf bound_ctrl:0
    v_mov_b32_dpp v157, v157 row_shr:1 row_mask:0xf bank_mask:0xf bound_ctrl:0
    v_mfma_f32_32x32x16_bf16 v[128:143], v[204:207], v[60:63], v[128:143]
    v_mov_b32_dpp v158, v158 row_shr:1 row_mask:0xf bank_mask:0xf bound_ctrl:0
    v_mov_b32_dpp v159, v159 row_shr:1 row_mask:0xf bank_mask:0xf bound_ctrl:0
    s_waitcnt lgkmcnt(0)
    s_nop 0
    v_mfma_f32_32x32x16_bf16 v[144:159], v[208:211], v[64:67], v[144:159]
    s_nop 4
    v_mfma_f32_32x32x16_bf16 v[144:159], v[212:215], v[68:71], v[144:159]
    s_nop 4
    v_mfma_f32_32x32x16_bf16 v[144:159], v[216:219], v[72:75], v[144:159]
    v_mov_b32_dpp v128, v128 row_shr:1 row_mask:0xf bank_mask:0xf bound_ctrl:0
    v_mov_b32_dpp v129, v129 row_shr:1 row_mask:0xf bank_mask:0xf bound_ctrl:0
    v_mov_b32_dpp v130, v130 row_shr:1 row_mask:0xf bank_mask:0xf bound_ctrl:0
    v_mfma_f32_32x32x16_bf16 v[144:159], v[220:223], v[76:79], v[144:159]
    v_mov_b32_dpp v131, v131 row_shr:1 row_mask:0xf bank_mask:0xf bound_ctrl:0
    v_mov_b32_dpp v132, v132 row_shr:1 row_mask:0xf bank_mask:0xf bound_ctrl:0
    v_mov_b32_dpp v133, v133 row_shr:1 row_mask:0xf bank_mask:0xf bound_ctrl:0
    v_mfma_f32_32x32x16_bf16 v[144:159], v[224:227], v[80:83], v[144:159]
    v_mov_b32_dpp v134, v134 row_shr:1 row_mask:0xf bank_mask:0xf bound_ctrl:0
    v_mov_b32_dpp v135, v135 row_shr:1 row_mask:0xf bank_mask:0xf bound_ctrl:0
    v_mov_b32_dpp v136, v136 row_shr:1 row_mask:0xf bank_mask:0xf bound_ctrl:0
    v_mfma_f32_32x32x16_bf16 v[144:159], v[228:231], v[84:87], v[144:159]
    v_mov_b32_dpp v137, v137 row_shr:1 row_mask:0xf bank_mask:0xf bound_ctrl:0
    v_mov_b32_dpp v138, v138 row_shr:1 row_mask:0xf bank_mask:0xf bound_ctrl:0
    v_mov_b32_dpp v139, v139 row_shr:1 row_mask:0xf bank_mask:0xf bound_ctrl:0
    v_mfma_f32_32x32x16_bf16 v[144:159], v[232:235], v[88:91], v[144:159]
    v_mov_b32_dpp v140, v140 row_shr:1 row_mask:0xf bank_mask:0xf bound_ctrl:0
    v_mov_b32_dpp v141, v141 row_shr:1 row_mask:0xf bank_mask:0xf bound_ctrl:0
    v_mfma_f32_32x32x16_bf16 v[144:159], v[236:239], v[92:95], v[144:159]
    v_mov_b32_dpp v142, v142 row_shr:1 row_mask:0xf bank_mask:0xf bound_ctrl:0
    v_mov_b32_dpp v143, v143 row_shr:1 row_mask:0xf bank_mask:0xf bound_ctrl:0
    s_nop 1
    v_mfma_f32_32x32x16_bf16 v[128:143], v[208:211], v[32:35], v[128:143]
    ds_read_b128 v[176:179], v14 offset:1024
    ds_read_b128 v[180:183], v14 offset:1056
    s_nop 2
    v_mfma_f32_32x32x16_bf16 v[128:143], v[212:215], v[36:39], v[128:143]
    ds_read_b128 v[184:187], v14 offset:1088
    ds_read_b128 v[188:191], v14 offset:1120
    s_nop 2
    v_mfma_f32_32x32x16_bf16 v[128:143], v[216:219], v[40:43], v[128:143]
    ds_read_b128 v[192:195], v14 offset:1152
    v_mov_b32_dpp v144, v144 row_shr:1 row_mask:0xf bank_mask:0xf bound_ctrl:0
    v_mov_b32_dpp v145, v145 row_shr:1 row_mask:0xf bank_mask:0xf bound_ctrl:0
    v_mov_b32_dpp v146, v146 row_shr:1 row_mask:0xf bank_mask:0xf bound_ctrl:0
    v_mfma_f32_32x32x16_bf16 v[128:143], v[220:223], v[44:47], v[128:143]
    ds_read_b128 v[196:199], v14 offset:1184
    v_mov_b32_dpp v147, v147 row_shr:1 row_mask:0xf bank_mask:0xf bound_ctrl:0
    v_mov_b32_dpp v148, v148 row_shr:1 row_mask:0xf bank_mask:0xf bound_ctrl:0
    v_mov_b32_dpp v149, v149 row_shr:1 row_mask:0xf bank_mask:0xf bound_ctrl:0
    v_mfma_f32_32x32x16_bf16 v[128:143], v[224:227], v[48:51], v[128:143]
    ds_read_b128 v[200:203], v14 offset:1216
    v_mov_b32_dpp v150, v150 row_shr:1 row_mask:0xf bank_mask:0xf bound_ctrl:0
    v_mov_b32_dpp v151, v151 row_shr:1 row_mask:0xf bank_mask:0xf bound_ctrl:0
    v_mov_b32_dpp v152, v152 row_shr:1 row_mask:0xf bank_mask:0xf bound_ctrl:0
    v_mfma_f32_32x32x16_bf16 v[128:143], v[228:231], v[52:55], v[128:143]
    ds_read_b128 v[204:207], v14 offset:1248
    v_mov_b32_dpp v153, v153 row_shr:1 row_mask:0xf bank_mask:0xf bound_ctrl:0
    v_mov_b32_dpp v154, v154 row_shr:1 row_mask:0xf bank_mask:0xf bound_ctrl:0
    v_mov_b32_dpp v155, v155 row_shr:1 row_mask:0xf bank_mask:0xf bound_ctrl:0
    v_mfma_f32_32x32x16_bf16 v[128:143], v[232:235], v[56:59], v[128:143]
    v_mov_b32_dpp v156, v156 row_shr:1 row_mask:0xf bank_mask:0xf bound_ctrl:0
    v_mov_b32_dpp v157, v157 row_shr:1 row_mask:0xf bank_mask:0xf bound_ctrl:0
    v_mfma_f32_32x32x16_bf16 v[128:143], v[236:239], v[60:63], v[128:143]
    v_mov_b32_dpp v158, v158 row_shr:1 row_mask:0xf bank_mask:0xf bound_ctrl:0
    v_mov_b32_dpp v159, v159 row_shr:1 row_mask:0xf bank_mask:0xf bound_ctrl:0
    s_waitcnt lgkmcnt(0)
    s_nop 0
    v_mfma_f32_32x32x16_bf16 v[144:159], v[176:179], v[64:67], v[144:159]
    s_nop 4
    v_mfma_f32_32x32x16_bf16 v[144:159], v[180:183], v[68:71], v[144:159]
    s_nop 4
    v_mfma_f32_32x32x16_bf16 v[144:159], v[184:187], v[72:75], v[144:159]
    v_mov_b32_dpp v128, v128 row_shr:1 row_mask:0xf bank_mask:0xf bound_ctrl:0
    v_mov_b32_dpp v129, v129 row_shr:1 row_mask:0xf bank_mask:0xf bound_ctrl:0
    v_mov_b32_dpp v130, v130 row_shr:1 row_mask:0xf bank_mask:0xf bound_ctrl:0
    v_mfma_f32_32x32x16_bf16 v[144:159], v[188:191], v[76:79], v[144:159]
    v_mov_b32_dpp v131, v131 row_shr:1 row_mask:0xf bank_mask:0xf bound_ctrl:0
    v_mov_b32_dpp v132, v132 row_shr:1 row_mask:0xf bank_mask:0xf bound_ctrl:0
    v_mov_b32_dpp v133, v133 row_shr:1 row_mask:0xf bank_mask:0xf bound_ctrl:0
    v_mfma_f32_32x32x16_bf16 v[144:159], v[192:195], v[80:83], v[144:159]
    v_mov_b32_dpp v134, v134 row_shr:1 row_mask:0xf bank_mask:0xf bound_ctrl:0
    v_mov_b32_dpp v135, v135 row_shr:1 row_mask:0xf bank_mask:0xf bound_ctrl:0
    v_mov_b32_dpp v136, v136 row_shr:1 row_mask:0xf bank_mask:0xf bound_ctrl:0
    v_mfma_f32_32x32x16_bf16 v[144:159], v[196:199], v[84:87], v[144:159]
    v_mov_b32_dpp v137, v137 row_shr:1 row_mask:0xf bank_mask:0xf bound_ctrl:0
    v_mov_b32_dpp v138, v138 row_shr:1 row_mask:0xf bank_mask:0xf bound_ctrl:0
    v_mov_b32_dpp v139, v139 row_shr:1 row_mask:0xf bank_mask:0xf bound_ctrl:0
    v_mfma_f32_32x32x16_bf16 v[144:159], v[200:203], v[88:91], v[144:159]
    v_mov_b32_dpp v140, v140 row_shr:1 row_mask:0xf bank_mask:0xf bound_ctrl:0
    v_mov_b32_dpp v141, v141 row_shr:1 row_mask:0xf bank_mask:0xf bound_ctrl:0
    v_mfma_f32_32x32x16_bf16 v[144:159], v[204:207], v[92:95], v[144:159]
    v_mov_b32_dpp v142, v142 row_shr:1 row_mask:0xf bank_mask:0xf bound_ctrl:0
    v_mov_b32_dpp v143, v143 row_shr:1 row_mask:0xf bank_mask:0xf bound_ctrl:0
    s_nop 1
    v_mfma_f32_32x32x16_bf16 v[128:143], v[176:179], v[32:35], v[128:143]
    ds_read_b128 v[208:211], v14 offset:768
    ds_read_b128 v[212:215], v14 offset:800
    s_nop 2
    v_mfma_f32_32x32x16_bf16 v[128:143], v[180:183], v[36:39], v[128:143]
    ds_read_b128 v[216:219], v14 offset:832
    ds_read_b128 v[220:223], v14 offset:864
    s_nop 2
    v_mfma_f32_32x32x16_bf16 v[128:143], v[184:187], v[40:43], v[128:143]
    ds_read_b128 v[224:227], v14 offset:896
    v_mov_b32_dpp v144, v144 row_shr:1 row_mask:0xf bank_mask:0xf bound_ctrl:0
    v_mov_b32_dpp v145, v145 row_shr:1 row_mask:0xf bank_mask:0xf bound_ctrl:0
    v_mov_b32_dpp v146, v146 row_shr:1 row_mask:0xf bank_mask:0xf bound_ctrl:0
    v_mfma_f32_32x32x16_bf16 v[128:143], v[188:191], v[44:47], v[128:143]
    ds_read_b128 v[228:231], v14 offset:928
    v_mov_b32_dpp v147, v147 row_shr:1 row_mask:0xf bank_mask:0xf bound_ctrl:0
    v_mov_b32_dpp v148, v148 row_shr:1 row_mask:0xf bank_mask:0xf bound_ctrl:0
    v_mov_b32_dpp v149, v149 row_shr:1 row_mask:0xf bank_mask:0xf bound_ctrl:0
    v_mfma_f32_32x32x16_bf16 v[128:143], v[192:195], v[48:51], v[128:143]
    ds_read_b128 v[232:235], v14 offset:960
    v_mov_b32_dpp v150, v150 row_shr:1 row_mask:0xf bank_mask:0xf bound_ctrl:0
    v_mov_b32_dpp v151, v151 row_shr:1 row_mask:0xf bank_mask:0xf bound_ctrl:0
    v_mov_b32_dpp v152, v152 row_shr:1 row_mask:0xf bank_mask:0xf bound_ctrl:0
    v_mfma_f32_32x32x16_bf16 v[128:143], v[196:199], v[52:55], v[128:143]
    ds_read_b128 v[236:239], v14 offset:992
    v_mov_b32_dpp v153, v153 row_shr:1 row_mask:0xf bank_mask:0xf bound_ctrl:0
    v_mov_b32_dpp v154, v154 row_shr:1 row_mask:0xf bank_mask:0xf bound_ctrl:0
    v_mov_b32_dpp v155, v155 row_shr:1 row_mask:0xf bank_mask:0xf bound_ctrl:0
    v_mfma_f32_32x32x16_bf16 v[128:143], v[200:203], v[56:59], v[128:143]
    v_mov_b32_dpp v156, v156 row_shr:1 row_mask:0xf bank_mask:0xf bound_ctrl:0
    v_mov_b32_dpp v157, v157 row_shr:1 row_mask:0xf bank_mask:0xf bound_ctrl:0
    v_mfma_f32_32x32x16_bf16 v[128:143], v[204:207], v[60:63], v[128:143]
    v_mov_b32_dpp v158, v158 row_shr:1 row_mask:0xf bank_mask:0xf bound_ctrl:0
    v_mov_b32_dpp v159, v159 row_shr:1 row_mask:0xf bank_mask:0xf bound_ctrl:0
    s_waitcnt lgkmcnt(0)
    s_nop 0
    v_mfma_f32_32x32x16_bf16 v[144:159], v[208:211], v[64:67], v[144:159]
    s_nop 4
    v_mfma_f32_32x32x16_bf16 v[144:159], v[212:215], v[68:71], v[144:159]
    s_nop 4
    v_mfma_f32_32x32x16_bf16 v[144:159], v[216:219], v[72:75], v[144:159]
    v_mov_b32_dpp v128, v128 row_shr:1 row_mask:0xf bank_mask:0xf bound_ctrl:0
    v_mov_b32_dpp v129, v129 row_shr:1 row_mask:0xf bank_mask:0xf bound_ctrl:0
    v_mov_b32_dpp v130, v130 row_shr:1 row_mask:0xf bank_mask:0xf bound_ctrl:0
    v_mfma_f32_32x32x16_bf16 v[144:159], v[220:223], v[76:79], v[144:159]
    v_mov_b32_dpp v131, v131 row_shr:1 row_mask:0xf bank_mask:0xf bound_ctrl:0
    v_mov_b32_dpp v132, v132 row_shr:1 row_mask:0xf bank_mask:0xf bound_ctrl:0
    v_mov_b32_dpp v133, v133 row_shr:1 row_mask:0xf bank_mask:0xf bound_ctrl:0
    v_mfma_f32_32x32x16_bf16 v[144:159], v[224:227], v[80:83], v[144:159]
    v_mov_b32_dpp v134, v134 row_shr:1 row_mask:0xf bank_mask:0xf bound_ctrl:0
    v_mov_b32_dpp v135, v135 row_shr:1 row_mask:0xf bank_mask:0xf bound_ctrl:0
    v_mov_b32_dpp v136, v136 row_shr:1 row_mask:0xf bank_mask:0xf bound_ctrl:0
    v_mfma_f32_32x32x16_bf16 v[144:159], v[228:231], v[84:87], v[144:159]
    v_mov_b32_dpp v137, v137 row_shr:1 row_mask:0xf bank_mask:0xf bound_ctrl:0
    v_mov_b32_dpp v138, v138 row_shr:1 row_mask:0xf bank_mask:0xf bound_ctrl:0
    v_mov_b32_dpp v139, v139 row_shr:1 row_mask:0xf bank_mask:0xf bound_ctrl:0
    v_mfma_f32_32x32x16_bf16 v[144:159], v[232:235], v[88:91], v[144:159]
    v_mov_b32_dpp v140, v140 row_shr:1 row_mask:0xf bank_mask:0xf bound_ctrl:0
    v_mov_b32_dpp v141, v141 row_shr:1 row_mask:0xf bank_mask:0xf bound_ctrl:0
    v_mfma_f32_32x32x16_bf16 v[144:159], v[236:239], v[92:95], v[144:159]
    v_mov_b32_dpp v142, v142 row_shr:1 row_mask:0xf bank_mask:0xf bound_ctrl:0
    v_mov_b32_dpp v143, v143 row_shr:1 row_mask:0xf bank_mask:0xf bound_ctrl:0
    s_nop 1
    v_mfma_f32_32x32x16_bf16 v[128:143], v[208:211], v[32:35], v[128:143]
    ds_read_b128 v[176:179], v14 offset:512
    ds_read_b128 v[180:183], v14 offset:544
    s_nop 2
    v_mfma_f32_32x32x16_bf16 v[128:143], v[212:215], v[36:39], v[128:143]
    ds_read_b128 v[184:187], v14 offset:576
    ds_read_b128 v[188:191], v14 offset:608
    s_nop 2
    v_mfma_f32_32x32x16_bf16 v[128:143], v[216:219], v[40:43], v[128:143]
    ds_read_b128 v[192:195], v14 offset:640
    v_mov_b32_dpp v144, v144 row_shr:1 row_mask:0xf bank_mask:0xf bound_ctrl:0
    v_mov_b32_dpp v145, v145 row_shr:1 row_mask:0xf bank_mask:0xf bound_ctrl:0
    v_mov_b32_dpp v146, v146 row_shr:1 row_mask:0xf bank_mask:0xf bound_ctrl:0
    v_mfma_f32_32x32x16_bf16 v[128:143], v[220:223], v[44:47], v[128:143]
    ds_read_b128 v[196:199], v14 offset:672
    v_mov_b32_dpp v147, v147 row_shr:1 row_mask:0xf bank_mask:0xf bound_ctrl:0
    v_mov_b32_dpp v148, v148 row_shr:1 row_mask:0xf bank_mask:0xf bound_ctrl:0
    v_mov_b32_dpp v149, v149 row_shr:1 row_mask:0xf bank_mask:0xf bound_ctrl:0
    v_mfma_f32_32x32x16_bf16 v[128:143], v[224:227], v[48:51], v[128:143]
    ds_read_b128 v[200:203], v14 offset:704
    v_mov_b32_dpp v150, v150 row_shr:1 row_mask:0xf bank_mask:0xf bound_ctrl:0
    v_mov_b32_dpp v151, v151 row_shr:1 row_mask:0xf bank_mask:0xf bound_ctrl:0
    v_mov_b32_dpp v152, v152 row_shr:1 row_mask:0xf bank_mask:0xf bound_ctrl:0
    v_mfma_f32_32x32x16_bf16 v[128:143], v[228:231], v[52:55], v[128:143]
    ds_read_b128 v[204:207], v14 offset:736
    v_mov_b32_dpp v153, v153 row_shr:1 row_mask:0xf bank_mask:0xf bound_ctrl:0
    v_mov_b32_dpp v154, v154 row_shr:1 row_mask:0xf bank_mask:0xf bound_ctrl:0
    v_mov_b32_dpp v155, v155 row_shr:1 row_mask:0xf bank_mask:0xf bound_ctrl:0
    v_mfma_f32_32x32x16_bf16 v[128:143], v[232:235], v[56:59], v[128:143]
    v_mov_b32_dpp v156, v156 row_shr:1 row_mask:0xf bank_mask:0xf bound_ctrl:0
    v_mov_b32_dpp v157, v157 row_shr:1 row_mask:0xf bank_mask:0xf bound_ctrl:0
    v_mfma_f32_32x32x16_bf16 v[128:143], v[236:239], v[60:63], v[128:143]
    v_mov_b32_dpp v158, v158 row_shr:1 row_mask:0xf bank_mask:0xf bound_ctrl:0
    v_mov_b32_dpp v159, v159 row_shr:1 row_mask:0xf bank_mask:0xf bound_ctrl:0
    s_waitcnt lgkmcnt(0)
    s_nop 0
    v_mfma_f32_32x32x16_bf16 v[144:159], v[176:179], v[64:67], v[144:159]
    s_nop 4
    v_mfma_f32_32x32x16_bf16 v[144:159], v[180:183], v[68:71], v[144:159]
    s_nop 4
    v_mfma_f32_32x32x16_bf16 v[144:159], v[184:187], v[72:75], v[144:159]
    v_mov_b32_dpp v128, v128 row_shr:1 row_mask:0xf bank_mask:0xf bound_ctrl:0
    v_mov_b32_dpp v129, v129 row_shr:1 row_mask:0xf bank_mask:0xf bound_ctrl:0
    v_mov_b32_dpp v130, v130 row_shr:1 row_mask:0xf bank_mask:0xf bound_ctrl:0
    v_mfma_f32_32x32x16_bf16 v[144:159], v[188:191], v[76:79], v[144:159]
    v_mov_b32_dpp v131, v131 row_shr:1 row_mask:0xf bank_mask:0xf bound_ctrl:0
    v_mov_b32_dpp v132, v132 row_shr:1 row_mask:0xf bank_mask:0xf bound_ctrl:0
    v_mov_b32_dpp v133, v133 row_shr:1 row_mask:0xf bank_mask:0xf bound_ctrl:0
    v_mfma_f32_32x32x16_bf16 v[144:159], v[192:195], v[80:83], v[144:159]
    v_mov_b32_dpp v134, v134 row_shr:1 row_mask:0xf bank_mask:0xf bound_ctrl:0
    v_mov_b32_dpp v135, v135 row_shr:1 row_mask:0xf bank_mask:0xf bound_ctrl:0
    v_mov_b32_dpp v136, v136 row_shr:1 row_mask:0xf bank_mask:0xf bound_ctrl:0
    v_mfma_f32_32x32x16_bf16 v[144:159], v[196:199], v[84:87], v[144:159]
    v_mov_b32_dpp v137, v137 row_shr:1 row_mask:0xf bank_mask:0xf bound_ctrl:0
    v_mov_b32_dpp v138, v138 row_shr:1 row_mask:0xf bank_mask:0xf bound_ctrl:0
    v_mov_b32_dpp v139, v139 row_shr:1 row_mask:0xf bank_mask:0xf bound_ctrl:0
    v_mfma_f32_32x32x16_bf16 v[144:159], v[200:203], v[88:91], v[144:159]
    v_mov_b32_dpp v140, v140 row_shr:1 row_mask:0xf bank_mask:0xf bound_ctrl:0
    v_mov_b32_dpp v141, v141 row_shr:1 row_mask:0xf bank_mask:0xf bound_ctrl:0
    v_mfma_f32_32x32x16_bf16 v[144:159], v[204:207], v[92:95], v[144:159]
    v_mov_b32_dpp v142, v142 row_shr:1 row_mask:0xf bank_mask:0xf bound_ctrl:0
    v_mov_b32_dpp v143, v143 row_shr:1 row_mask:0xf bank_mask:0xf bound_ctrl:0
    s_nop 1
    v_mfma_f32_32x32x16_bf16 v[128:143], v[176:179], v[32:35], v[128:143]
    ds_read_b128 v[208:211], v14 offset:256
    ds_read_b128 v[212:215], v14 offset:288
    s_nop 2
    v_mfma_f32_32x32x16_bf16 v[128:143], v[180:183], v[36:39], v[128:143]
    ds_read_b128 v[216:219], v14 offset:320
    ds_read_b128 v[220:223], v14 offset:352
    s_nop 2
    v_mfma_f32_32x32x16_bf16 v[128:143], v[184:187], v[40:43], v[128:143]
    ds_read_b128 v[224:227], v14 offset:384
    v_mov_b32_dpp v144, v144 row_shr:1 row_mask:0xf bank_mask:0xf bound_ctrl:0
    v_mov_b32_dpp v145, v145 row_shr:1 row_mask:0xf bank_mask:0xf bound_ctrl:0
    v_mov_b32_dpp v146, v146 row_shr:1 row_mask:0xf bank_mask:0xf bound_ctrl:0
    v_mfma_f32_32x32x16_bf16 v[128:143], v[188:191], v[44:47], v[128:143]
    ds_read_b128 v[228:231], v14 offset:416
    v_mov_b32_dpp v147, v147 row_shr:1 row_mask:0xf bank_mask:0xf bound_ctrl:0
    v_mov_b32_dpp v148, v148 row_shr:1 row_mask:0xf bank_mask:0xf bound_ctrl:0
    v_mov_b32_dpp v149, v149 row_shr:1 row_mask:0xf bank_mask:0xf bound_ctrl:0
    v_mfma_f32_32x32x16_bf16 v[128:143], v[192:195], v[48:51], v[128:143]
    ds_read_b128 v[232:235], v14 offset:448
    v_mov_b32_dpp v150, v150 row_shr:1 row_mask:0xf bank_mask:0xf bound_ctrl:0
    v_mov_b32_dpp v151, v151 row_shr:1 row_mask:0xf bank_mask:0xf bound_ctrl:0
    v_mov_b32_dpp v152, v152 row_shr:1 row_mask:0xf bank_mask:0xf bound_ctrl:0
    v_mfma_f32_32x32x16_bf16 v[128:143], v[196:199], v[52:55], v[128:143]
    ds_read_b128 v[236:239], v14 offset:480
    v_mov_b32_dpp v153, v153 row_shr:1 row_mask:0xf bank_mask:0xf bound_ctrl:0
    v_mov_b32_dpp v154, v154 row_shr:1 row_mask:0xf bank_mask:0xf bound_ctrl:0
    v_mov_b32_dpp v155, v155 row_shr:1 row_mask:0xf bank_mask:0xf bound_ctrl:0
    v_mfma_f32_32x32x16_bf16 v[128:143], v[200:203], v[56:59], v[128:143]
    v_mov_b32_dpp v156, v156 row_shr:1 row_mask:0xf bank_mask:0xf bound_ctrl:0
    v_mov_b32_dpp v157, v157 row_shr:1 row_mask:0xf bank_mask:0xf bound_ctrl:0
    v_mfma_f32_32x32x16_bf16 v[128:143], v[204:207], v[60:63], v[128:143]
    v_mov_b32_dpp v158, v158 row_shr:1 row_mask:0xf bank_mask:0xf bound_ctrl:0
    v_mov_b32_dpp v159, v159 row_shr:1 row_mask:0xf bank_mask:0xf bound_ctrl:0
    s_waitcnt lgkmcnt(0)
    s_nop 0
    v_mfma_f32_32x32x16_bf16 v[144:159], v[208:211], v[64:67], v[144:159]
    s_nop 4
    v_mfma_f32_32x32x16_bf16 v[144:159], v[212:215], v[68:71], v[144:159]
    s_nop 4
    v_mfma_f32_32x32x16_bf16 v[144:159], v[216:219], v[72:75], v[144:159]
    v_mov_b32_dpp v128, v128 row_shr:1 row_mask:0xf bank_mask:0xf bound_ctrl:0
    v_mov_b32_dpp v129, v129 row_shr:1 row_mask:0xf bank_mask:0xf bound_ctrl:0
    v_mov_b32_dpp v130, v130 row_shr:1 row_mask:0xf bank_mask:0xf bound_ctrl:0
    v_mfma_f32_32x32x16_bf16 v[144:159], v[220:223], v[76:79], v[144:159]
    v_mov_b32_dpp v131, v131 row_shr:1 row_mask:0xf bank_mask:0xf bound_ctrl:0
    v_mov_b32_dpp v132, v132 row_shr:1 row_mask:0xf bank_mask:0xf bound_ctrl:0
    v_mov_b32_dpp v133, v133 row_shr:1 row_mask:0xf bank_mask:0xf bound_ctrl:0
    v_mfma_f32_32x32x16_bf16 v[144:159], v[224:227], v[80:83], v[144:159]
    v_mov_b32_dpp v134, v134 row_shr:1 row_mask:0xf bank_mask:0xf bound_ctrl:0
    v_mov_b32_dpp v135, v135 row_shr:1 row_mask:0xf bank_mask:0xf bound_ctrl:0
    v_mov_b32_dpp v136, v136 row_shr:1 row_mask:0xf bank_mask:0xf bound_ctrl:0
    v_mfma_f32_32x32x16_bf16 v[144:159], v[228:231], v[84:87], v[144:159]
    v_mov_b32_dpp v137, v137 row_shr:1 row_mask:0xf bank_mask:0xf bound_ctrl:0
    v_mov_b32_dpp v138, v138 row_shr:1 row_mask:0xf bank_mask:0xf bound_ctrl:0
    v_mov_b32_dpp v139, v139 row_shr:1 row_mask:0xf bank_mask:0xf bound_ctrl:0
    v_mfma_f32_32x32x16_bf16 v[144:159], v[232:235], v[88:91], v[144:159]
    v_mov_b32_dpp v140, v140 row_shr:1 row_mask:0xf bank_mask:0xf bound_ctrl:0
    v_mov_b32_dpp v141, v141 row_shr:1 row_mask:0xf bank_mask:0xf bound_ctrl:0
    v_mfma_f32_32x32x16_bf16 v[144:159], v[236:239], v[92:95], v[144:159]
    v_mov_b32_dpp v142, v142 row_shr:1 row_mask:0xf bank_mask:0xf bound_ctrl:0
    v_mov_b32_dpp v143, v143 row_shr:1 row_mask:0xf bank_mask:0xf bound_ctrl:0
    s_nop 1
    v_mfma_f32_32x32x16_bf16 v[128:143], v[208:211], v[32:35], v[128:143]
    ds_read_b128 v[176:179], v14 offset:0
    ds_read_b128 v[180:183], v14 offset:32
    s_nop 2
    v_mfma_f32_32x32x16_bf16 v[128:143], v[212:215], v[36:39], v[128:143]
    ds_read_b128 v[184:187], v14 offset:64
    ds_read_b128 v[188:191], v14 offset:96
    s_nop 2
    v_mfma_f32_32x32x16_bf16 v[128:143], v[216:219], v[40:43], v[128:143]
    ds_read_b128 v[192:195], v14 offset:128
    v_mov_b32_dpp v144, v144 row_shr:1 row_mask:0xf bank_mask:0xf bound_ctrl:0
    v_mov_b32_dpp v145, v145 row_shr:1 row_mask:0xf bank_mask:0xf bound_ctrl:0
    v_mov_b32_dpp v146, v146 row_shr:1 row_mask:0xf bank_mask:0xf bound_ctrl:0
    v_mfma_f32_32x32x16_bf16 v[128:143], v[220:223], v[44:47], v[128:143]
    ds_read_b128 v[196:199], v14 offset:160
    v_mov_b32_dpp v147, v147 row_shr:1 row_mask:0xf bank_mask:0xf bound_ctrl:0
    v_mov_b32_dpp v148, v148 row_shr:1 row_mask:0xf bank_mask:0xf bound_ctrl:0
    v_mov_b32_dpp v149, v149 row_shr:1 row_mask:0xf bank_mask:0xf bound_ctrl:0
    v_mfma_f32_32x32x16_bf16 v[128:143], v[224:227], v[48:51], v[128:143]
    ds_read_b128 v[200:203], v14 offset:192
    v_mov_b32_dpp v150, v150 row_shr:1 row_mask:0xf bank_mask:0xf bound_ctrl:0
    v_mov_b32_dpp v151, v151 row_shr:1 row_mask:0xf bank_mask:0xf bound_ctrl:0
    v_mov_b32_dpp v152, v152 row_shr:1 row_mask:0xf bank_mask:0xf bound_ctrl:0
    v_mfma_f32_32x32x16_bf16 v[128:143], v[228:231], v[52:55], v[128:143]
    ds_read_b128 v[204:207], v14 offset:224
    v_mov_b32_dpp v153, v153 row_shr:1 row_mask:0xf bank_mask:0xf bound_ctrl:0
    v_mov_b32_dpp v154, v154 row_shr:1 row_mask:0xf bank_mask:0xf bound_ctrl:0
    v_mov_b32_dpp v155, v155 row_shr:1 row_mask:0xf bank_mask:0xf bound_ctrl:0
    v_mfma_f32_32x32x16_bf16 v[128:143], v[232:235], v[56:59], v[128:143]
    v_mov_b32_dpp v156, v156 row_shr:1 row_mask:0xf bank_mask:0xf bound_ctrl:0
    v_mov_b32_dpp v157, v157 row_shr:1 row_mask:0xf bank_mask:0xf bound_ctrl:0
    v_mfma_f32_32x32x16_bf16 v[128:143], v[236:239], v[60:63], v[128:143]
    v_mov_b32_dpp v158, v158 row_shr:1 row_mask:0xf bank_mask:0xf bound_ctrl:0
    v_mov_b32_dpp v159, v159 row_shr:1 row_mask:0xf bank_mask:0xf bound_ctrl:0
    s_waitcnt lgkmcnt(0)
    s_nop 0
    v_mfma_f32_32x32x16_bf16 v[144:159], v[176:179], v[64:67], v[144:159]
    s_nop 4
    v_mfma_f32_32x32x16_bf16 v[144:159], v[180:183], v[68:71], v[144:159]
    s_nop 4
    v_mfma_f32_32x32x16_bf16 v[144:159], v[184:187], v[72:75], v[144:159]
    v_mov_b32_dpp v128, v128 row_shr:1 row_mask:0xf bank_mask:0xf bound_ctrl:0
    v_mov_b32_dpp v129, v129 row_shr:1 row_mask:0xf bank_mask:0xf bound_ctrl:0
    v_mov_b32_dpp v130, v130 row_shr:1 row_mask:0xf bank_mask:0xf bound_ctrl:0
    v_mfma_f32_32x32x16_bf16 v[144:159], v[188:191], v[76:79], v[144:159]
    v_mov_b32_dpp v131, v131 row_shr:1 row_mask:0xf bank_mask:0xf bound_ctrl:0
    v_mov_b32_dpp v132, v132 row_shr:1 row_mask:0xf bank_mask:0xf bound_ctrl:0
    v_mov_b32_dpp v133, v133 row_shr:1 row_mask:0xf bank_mask:0xf bound_ctrl:0
    v_mfma_f32_32x32x16_bf16 v[144:159], v[192:195], v[80:83], v[144:159]
    v_mov_b32_dpp v134, v134 row_shr:1 row_mask:0xf bank_mask:0xf bound_ctrl:0
    v_mov_b32_dpp v135, v135 row_shr:1 row_mask:0xf bank_mask:0xf bound_ctrl:0
    v_mov_b32_dpp v136, v136 row_shr:1 row_mask:0xf bank_mask:0xf bound_ctrl:0
    v_mfma_f32_32x32x16_bf16 v[144:159], v[196:199], v[84:87], v[144:159]
    v_mov_b32_dpp v137, v137 row_shr:1 row_mask:0xf bank_mask:0xf bound_ctrl:0
    v_mov_b32_dpp v138, v138 row_shr:1 row_mask:0xf bank_mask:0xf bound_ctrl:0
    v_mov_b32_dpp v139, v139 row_shr:1 row_mask:0xf bank_mask:0xf bound_ctrl:0
    v_mfma_f32_32x32x16_bf16 v[144:159], v[200:203], v[88:91], v[144:159]
    v_mov_b32_dpp v140, v140 row_shr:1 row_mask:0xf bank_mask:0xf bound_ctrl:0
    v_mov_b32_dpp v141, v141 row_shr:1 row_mask:0xf bank_mask:0xf bound_ctrl:0
    v_mfma_f32_32x32x16_bf16 v[144:159], v[204:207], v[92:95], v[144:159]
    v_mov_b32_dpp v142, v142 row_shr:1 row_mask:0xf bank_mask:0xf bound_ctrl:0
    v_mov_b32_dpp v143, v143 row_shr:1 row_mask:0xf bank_mask:0xf bound_ctrl:0
    s_nop 1
    v_mfma_f32_32x32x16_bf16 v[128:143], v[176:179], v[32:35], v[128:143]
    v_mfma_f32_32x32x16_bf16 v[128:143], v[180:183], v[36:39], v[128:143]
    v_mfma_f32_32x32x16_bf16 v[128:143], v[184:187], v[40:43], v[128:143]
    v_mfma_f32_32x32x16_bf16 v[128:143], v[188:191], v[44:47], v[128:143]
    v_mfma_f32_32x32x16_bf16 v[128:143], v[192:195], v[48:51], v[128:143]
    v_mfma_f32_32x32x16_bf16 v[128:143], v[196:199], v[52:55], v[128:143]
    v_mfma_f32_32x32x16_bf16 v[128:143], v[200:203], v[56:59], v[128:143]
    v_mfma_f32_32x32x16_bf16 v[128:143], v[204:207], v[60:63], v[128:143]
    s_nop 7
    s_barrier
    s_mul_i32 s36, s19, 4096
    s_add_u32 s36, s36, 88064
    v_lshlrev_b32 v16, 4, v1
    v_add_u32 v16, s36, v16
    ds_read_b128 v[160:163], v16 offset:0
    ds_read_b128 v[164:167], v16 offset:1024
    ds_read_b128 v[168:171], v16 offset:2048
    ds_read_b128 v[172:175], v16 offset:3072
    v_mul_u32_u24 v16, 264, v7
    v_lshl_add_u32 v16, v9, 5, v16
    v_lshl_add_u32 v16, v8, 2, v16
    v_add_u32 v16, s34, v16
    s_mov_b32 s42, 0xff00ff00
    s_mov_b32 s43, 0xff00ff00
    s_waitcnt lgkmcnt(0)
    v_add_f32_dpp v128, v160, v128 row_shr:8 row_mask:0xf bank_mask:0xf bound_ctrl:0
    v_add_f32_dpp v129, v161, v129 row_shr:8 row_mask:0xf bank_mask:0xf bound_ctrl:0
    v_add_f32_dpp v130, v162, v130 row_shr:8 row_mask:0xf bank_mask:0xf bound_ctrl:0
    v_add_f32_dpp v131, v163, v131 row_shr:8 row_mask:0xf bank_mask:0xf bound_ctrl:0
    v_add_f32_dpp v132, v164, v132 row_shr:8 row_mask:0xf bank_mask:0xf bound_ctrl:0
    v_add_f32_dpp v133, v165, v133 row_shr:8 row_mask:0xf bank_mask:0xf bound_ctrl:0
    v_add_f32_dpp v134, v166, v134 row_shr:8 row_mask:0xf bank_mask:0xf bound_ctrl:0
    v_add_f32_dpp v135, v167, v135 row_shr:8 row_mask:0xf bank_mask:0xf bound_ctrl:0
    v_add_f32_dpp v136, v168, v136 row_shr:8 row_mask:0xf bank_mask:0xf bound_ctrl:0
    v_add_f32_dpp v137, v169, v137 row_shr:8 row_mask:0xf bank_mask:0xf bound_ctrl:0
    v_add_f32_dpp v138, v170, v138 row_shr:8 row_mask:0xf bank_mask:0xf bound_ctrl:0
    v_add_f32_dpp v139, v171, v139 row_shr:8 row_mask:0xf bank_mask:0xf bound_ctrl:0
    v_add_f32_dpp v140, v172, v140 row_shr:8 row_mask:0xf bank_mask:0xf bound_ctrl:0
    v_add_f32_dpp v141, v173, v141 row_shr:8 row_mask:0xf bank_mask:0xf bound_ctrl:0
    v_add_f32_dpp v142, v174, v142 row_shr:8 row_mask:0xf bank_mask:0xf bound_ctrl:0
    v_add_f32_dpp v143, v175, v143 row_shr:8 row_mask:0xf bank_mask:0xf bound_ctrl:0
    s_mov_b64 exec, s[42:43]
    v_add_f32 v144, v160, v144
    v_add_f32 v145, v161, v145
    v_add_f32 v146, v162, v146
    v_add_f32 v147, v163, v147
    v_add_f32 v148, v164, v148
    v_add_f32 v149, v165, v149
    v_add_f32 v150, v166, v150
    v_add_f32 v151, v167, v151
    v_add_f32 v152, v168, v152
    v_add_f32 v153, v169, v153
    v_add_f32 v154, v170, v154
    v_add_f32 v155, v171, v155
    v_add_f32 v156, v172, v156
    v_add_f32 v157, v173, v157
    v_add_f32 v158, v174, v158
    v_add_f32 v159, v175, v159
    s_mov_b64 exec, -1
    v_cvt_pk_bf16_f32 v32, v128, v144
    v_cvt_pk_bf16_f32 v33, v129, v145
    v_cvt_pk_bf16_f32 v34, v130, v146
    v_cvt_pk_bf16_f32 v35, v131, v147
    v_cvt_pk_bf16_f32 v36, v132, v148
    v_cvt_pk_bf16_f32 v37, v133, v149
    v_cvt_pk_bf16_f32 v38, v134, v150
    v_cvt_pk_bf16_f32 v39, v135, v151
    v_cvt_pk_bf16_f32 v40, v136, v152
    v_cvt_pk_bf16_f32 v41, v137, v153
    v_cvt_pk_bf16_f32 v42, v138, v154
    v_cvt_pk_bf16_f32 v43, v139, v155
    v_cvt_pk_bf16_f32 v44, v140, v156
    v_cvt_pk_bf16_f32 v45, v141, v157
    v_cvt_pk_bf16_f32 v46, v142, v158
    v_cvt_pk_bf16_f32 v47, v143, v159
    ds_write_b32 v16, v32 offset:0
    ds_write_b32 v16, v33 offset:8
    ds_write_b32 v16, v34 offset:16
    ds_write_b32 v16, v35 offset:24
    ds_write_b32 v16, v36 offset:64
    ds_write_b32 v16, v37 offset:72
    ds_write_b32 v16, v38 offset:80
    ds_write_b32 v16, v39 offset:88
    ds_write_b32 v16, v40 offset:128
    ds_write_b32 v16, v41 offset:136
    ds_write_b32 v16, v42 offset:144
    ds_write_b32 v16, v43 offset:152
    ds_write_b32 v16, v44 offset:192
    ds_write_b32 v16, v45 offset:200
    ds_write_b32 v16, v46 offset:208
    ds_write_b32 v16, v47 offset:216
    s_branch p_convE
p_convP:
    s_add_u32 s36, s34, 9728
    s_mov_b32 m0, s36
    s_add_u32 s40, s35, 8
    v_mov_b32 v16, 0
    ds_write_b32 v5, v6 offset:9472
    buffer_load_dwordx4 v3, s[24:27], s40 offen offset:0 lds
    buffer_load_dwordx4 v3, s[24:27], s40 offen offset:1024 lds
    buffer_load_dwordx4 v3, s[24:27], s40 offen offset:2048 lds
    buffer_load_dwordx4 v3, s[24:27], s40 offen offset:3072 lds
    buffer_load_dwordx2 v[252:253], v16, s[24:27], s35 offen
    v_mov_b32 v251, 0
    buffer_load_dword v250, v251, s[48:51], 0 offen sc1
    v_lshlrev_b32 v11, 2, v8
    v_and_b32 v12, 7, v1
    v_mul_u32_u24 v13, 272, v12
    v_lshl_add_u32 v13, v9, 4, v13
    v_add_u32 v13, s34, v13
    v_add_u32 v13, 4356, v13
    v_sub_u32 v13, v13, v11
    v_bfe_u32 v11, v1, 3, 1
    v_lshlrev_b32 v11, 4, v11
    v_sub_u32 v11, 16, v11
    v_cmp_ne_u32 vcc, 0, v12
    v_mov_b32 v16, 0
    s_add_u32 s36, s34, 9720
    v_cndmask_b32 v15, v16, -1, vcc
    v_mov_b32 v17, s36
    s_waitcnt vmcnt(0) lgkmcnt(0)
    s_mov_b64 exec, 1
    ds_write_b64 v17, v[252:253]
    s_mov_b64 exec, -1
    s_barrier
    s_waitcnt lgkmcnt(0)
    s_barrier
    ds_read2_b32 v[96:97], v13 offset0:0 offset1:1
    ds_read2_b32 v[98:99], v13 offset0:2 offset1:3
    ds_read2_b32 v[100:101], v13 offset0:8 offset1:9
    ds_read2_b32 v[102:103], v13 offset0:10 offset1:11
    ds_read2_b32 v[104:105], v13 offset0:16 offset1:17
    ds_read2_b32 v[106:107], v13 offset0:18 offset1:19
    ds_read2_b32 v[108:109], v13 offset0:24 offset1:25
    ds_read2_b32 v[110:111], v13 offset0:26 offset1:27
    ds_read2_b32 v[112:113], v13 offset0:32 offset1:33
    ds_read2_b32 v[114:115], v13 offset0:34 offset1:35
    ds_read2_b32 v[116:117], v13 offset0:40 offset1:41
    ds_read2_b32 v[118:119], v13 offset0:42 offset1:43
    ds_read2_b32 v[120:121], v13 offset0:48 offset1:49
    ds_read2_b32 v[122:123], v13 offset0:50 offset1:51
    ds_read2_b32 v[124:125], v13 offset0:56 offset1:57
    ds_read2_b32 v[126:127], v13 offset0:58 offset1:59
    s_waitcnt lgkmcnt(6)
    ds_read_b32 v24, v13 offset:16
    ds_read_b32 v25, v13 offset:48
    ds_read_b32 v26, v13 offset:80
    ds_read_b32 v27, v13 offset:112
    ds_read_b32 v28, v13 offset:144
    ds_read_b32 v29, v13 offset:176
    ds_read_b32 v30, v13 offset:208
    ds_read_b32 v31, v13 offset:240
    s_waitcnt lgkmcnt(7)
    ds_read_b128 v[208:211], v14 offset:3840
    ds_read_b128 v[212:215], v14 offset:3872
    ds_read_b128 v[216:219], v14 offset:3904
    ds_read_b128 v[220:223], v14 offset:3936
    ds_read_b128 v[224:227], v14 offset:3968
    ds_read_b128 v[228:231], v14 offset:4000
    ds_read_b128 v[232:235], v14 offset:4032
    ds_read_b128 v[236:239], v14 offset:4064
    s_waitcnt lgkmcnt(8)
    v_alignbit_b32 v96, v97, v96, v11
    v_alignbit_b32 v97, v98, v97, v11
    v_alignbit_b32 v98, v99, v98, v11
    v_alignbit_b32 v99, v24, v99, v11
    v_alignbit_b32 v100, v101, v100, v11
    v_alignbit_b32 v101, v102, v101, v11
    v_alignbit_b32 v102, v103, v102, v11
    v_alignbit_b32 v103, v25, v103, v11
    v_alignbit_b32 v104, v105, v104, v11
    v_alignbit_b32 v105, v106, v105, v11
    v_alignbit_b32 v106, v107, v106, v11
    v_alignbit_b32 v107, v26, v107, v11
    v_alignbit_b32 v108, v109, v108, v11
    v_alignbit_b32 v109, v110, v109, v11
    v_alignbit_b32 v110, v111, v110, v11
    v_alignbit_b32 v111, v27, v111, v11
    v_alignbit_b32 v112, v113, v112, v11
    v_alignbit_b32 v113, v114, v113, v11
    v_alignbit_b32 v114, v115, v114, v11
    v_alignbit_b32 v115, v28, v115, v11
    v_alignbit_b32 v116, v117, v116, v11
    v_alignbit_b32 v117, v118, v117, v11
    v_alignbit_b32 v118, v119, v118, v11
    v_alignbit_b32 v119, v29, v119, v11
    v_alignbit_b32 v120, v121, v120, v11
    v_alignbit_b32 v121, v122, v121, v11
    v_alignbit_b32 v122, v123, v122, v11
    v_alignbit_b32 v123, v30, v123, v11
    v_alignbit_b32 v124, v125, v124, v11
    v_alignbit_b32 v125, v126, v125, v11
    v_alignbit_b32 v126, v127, v126, v11
    v_alignbit_b32 v127, v31, v127, v11
    s_setprio 3
    s_waitcnt lgkmcnt(0)
    s_nop 1
    v_mfma_f32_32x32x16_bf16 v[160:175], v[208:211], v[96:99], 0
    ds_read_b128 v[176:179], v14 offset:3584
    ds_read_b128 v[180:183], v14 offset:3616
    v_mfma_f32_32x32x16_bf16 v[160:175], v[212:215], v[100:103], v[160:175]
    ds_read_b128 v[184:187], v14 offset:3648
    ds_read_b128 v[188:191], v14 offset:3680
    v_mfma_f32_32x32x16_bf16 v[160:175], v[216:219], v[104:107], v[160:175]
    ds_read_b128 v[192:195], v14 offset:3712
    v_mfma_f32_32x32x16_bf16 v[160:175], v[220:223], v[108:111], v[160:175]
    ds_read_b128 v[196:199], v14 offset:3744
    v_mfma_f32_32x32x16_bf16 v[160:175], v[224:227], v[112:115], v[160:175]
    ds_read_b128 v[200:203], v14 offset:3776
    v_mfma_f32_32x32x16_bf16 v[160:175], v[228:231], v[116:119], v[160:175]
    ds_read_b128 v[204:207], v14 offset:3808
    v_mfma_f32_32x32x16_bf16 v[160:175], v[232:235], v[120:123], v[160:175]
    v_mfma_f32_32x32x16_bf16 v[160:175], v[236:239], v[124:127], v[160:175]
    s_waitcnt lgkmcnt(0)
    s_nop 11
    v_and_b32_dpp v160, v160, v15 row_shr:1 row_mask:0xf bank_mask:0xf bound_ctrl:0
    v_and_b32_dpp v161, v161, v15 row_shr:1 row_mask:0xf bank_mask:0xf bound_ctrl:0
    v_and_b32_dpp v162, v162, v15 row_shr:1 row_mask:0xf bank_mask:0xf bound_ctrl:0
    v_and_b32_dpp v163, v163, v15 row_shr:1 row_mask:0xf bank_mask:0xf bound_ctrl:0
    v_and_b32_dpp v164, v164, v15 row_shr:1 row_mask:0xf bank_mask:0xf bound_ctrl:0
    v_and_b32_dpp v165, v165, v15 row_shr:1 row_mask:0xf bank_mask:0xf bound_ctrl:0
    v_and_b32_dpp v166, v166, v15 row_shr:1 row_mask:0xf bank_mask:0xf bound_ctrl:0
    v_and_b32_dpp v167, v167, v15 row_shr:1 row_mask:0xf bank_mask:0xf bound_ctrl:0
    v_and_b32_dpp v168, v168, v15 row_shr:1 row_mask:0xf bank_mask:0xf bound_ctrl:0
    v_and_b32_dpp v169, v169, v15 row_shr:1 row_mask:0xf bank_mask:0xf bound_ctrl:0
    v_and_b32_dpp v170, v170, v15 row_shr:1 row_mask:0xf bank_mask:0xf bound_ctrl:0
    v_and_b32_dpp v171, v171, v15 row_shr:1 row_mask:0xf bank_mask:0xf bound_ctrl:0
    v_and_b32_dpp v172, v172, v15 row_shr:1 row_mask:0xf bank_mask:0xf bound_ctrl:0
    v_and_b32_dpp v173, v173, v15 row_shr:1 row_mask:0xf bank_mask:0xf bound_ctrl:0
    v_and_b32_dpp v174, v174, v15 row_shr:1 row_mask:0xf bank_mask:0xf bound_ctrl:0
    v_and_b32_dpp v175, v175, v15 row_shr:1 row_mask:0xf bank_mask:0xf bound_ctrl:0
    s_nop 1
    v_mfma_f32_32x32x16_bf16 v[160:175], v[176:179], v[96:99], v[160:175]
    ds_read_b128 v[208:211], v14 offset:3328
    ds_read_b128 v[212:215], v14 offset:3360
    v_mfma_f32_32x32x16_bf16 v[160:175], v[180:183], v[100:103], v[160:175]
    ds_read_b128 v[216:219], v14 offset:3392
    ds_read_b128 v[220:223], v14 offset:3424
    v_mfma_f32_32x32x16_bf16 v[160:175], v[184:187], v[104:107], v[160:175]
    ds_read_b128 v[224:227], v14 offset:3456
    v_mfma_f32_32x32x16_bf16 v[160:175], v[188:191], v[108:111], v[160:175]
    ds_read_b128 v[228:231], v14 offset:3488
    v_mfma_f32_32x32x16_bf16 v[160:175], v[192:195], v[112:115], v[160:175]
    ds_read_b128 v[232:235], v14 offset:3520
    v_mfma_f32_32x32x16_bf16 v[160:175], v[196:199], v[116:119], v[160:175]
    ds_read_b128 v[236:239], v14 offset:3552
    v_mfma_f32_32x32x16_bf16 v[160:175], v[200:203], v[120:123], v[160:175]
    v_mfma_f32_32x32x16_bf16 v[160:175], v[204:207], v[124:127], v[160:175]
    s_waitcnt lgkmcnt(0)
    s_nop 11
    v_and_b32_dpp v160, v160, v15 row_shr:1 row_mask:0xf bank_mask:0xf bound_ctrl:0
    v_and_b32_dpp v161, v161, v15 row_shr:1 row_mask:0xf bank_mask:0xf bound_ctrl:0
    v_and_b32_dpp v162, v162, v15 row_shr:1 row_mask:0xf bank_mask:0xf bound_ctrl:0
    v_and_b32_dpp v163, v163, v15 row_shr:1 row_mask:0xf bank_mask:0xf bound_ctrl:0
    v_and_b32_dpp v164, v164, v15 row_shr:1 row_mask:0xf bank_mask:0xf bound_ctrl:0
    v_and_b32_dpp v165, v165, v15 row_shr:1 row_mask:0xf bank_mask:0xf bound_ctrl:0
    v_and_b32_dpp v166, v166, v15 row_shr:1 row_mask:0xf bank_mask:0xf bound_ctrl:0
    v_and_b32_dpp v167, v167, v15 row_shr:1 row_mask:0xf bank_mask:0xf bound_ctrl:0
    v_and_b32_dpp v168, v168, v15 row_shr:1 row_mask:0xf bank_mask:0xf bound_ctrl:0
    v_and_b32_dpp v169, v169, v15 row_shr:1 row_mask:0xf bank_mask:0xf bound_ctrl:0
    v_and_b32_dpp v170, v170, v15 row_shr:1 row_mask:0xf bank_mask:0xf bound_ctrl:0
    v_and_b32_dpp v171, v171, v15 row_shr:1 row_mask:0xf bank_mask:0xf bound_ctrl:0
    v_and_b32_dpp v172, v172, v15 row_shr:1 row_mask:0xf bank_mask:0xf bound_ctrl:0
    v_and_b32_dpp v173, v173, v15 row_shr:1 row_mask:0xf bank_mask:0xf bound_ctrl:0
    v_and_b32_dpp v174, v174, v15 row_shr:1 row_mask:0xf bank_mask:0xf bound_ctrl:0
    v_and_b32_dpp v175, v175, v15 row_shr:1 row_mask:0xf bank_mask:0xf bound_ctrl:0
    s_nop 1
    v_mfma_f32_32x32x16_bf16 v[160:175], v[208:211], v[96:99], v[160:175]
    ds_read_b128 v[176:179], v14 offset:3072
    ds_read_b128 v[180:183], v14 offset:3104
    v_mfma_f32_32x32x16_bf16 v[160:175], v[212:215], v[100:103], v[160:175]
    ds_read_b128 v[184:187], v14 offset:3136
    ds_read_b128 v[188:191], v14 offset:3168
    v_mfma_f32_32x32x16_bf16 v[160:175], v[216:219], v[104:107], v[160:175]
    ds_read_b128 v[192:195], v14 offset:3200
    v_mfma_f32_32x32x16_bf16 v[160:175], v[220:223], v[108:111], v[160:175]
    ds_read_b128 v[196:199], v14 offset:3232
    v_mfma_f32_32x32x16_bf16 v[160:175], v[224:227], v[112:115], v[160:175]
    ds_read_b128 v[200:203], v14 offset:3264
    v_mfma_f32_32x32x16_bf16 v[160:175], v[228:231], v[116:119], v[160:175]
    ds_read_b128 v[204:207], v14 offset:3296
    v_mfma_f32_32x32x16_bf16 v[160:175], v[232:235], v[120:123], v[160:175]
    v_mfma_f32_32x32x16_bf16 v[160:175], v[236:239], v[124:127], v[160:175]
    s_waitcnt lgkmcnt(0)
    s_nop 11
    v_and_b32_dpp v160, v160, v15 row_shr:1 row_mask:0xf bank_mask:0xf bound_ctrl:0
    v_and_b32_dpp v161, v161, v15 row_shr:1 row_mask:0xf bank_mask:0xf bound_ctrl:0
    v_and_b32_dpp v162, v162, v15 row_shr:1 row_mask:0xf bank_mask:0xf bound_ctrl:0
    v_and_b32_dpp v163, v163, v15 row_shr:1 row_mask:0xf bank_mask:0xf bound_ctrl:0
    v_and_b32_dpp v164, v164, v15 row_shr:1 row_mask:0xf bank_mask:0xf bound_ctrl:0
    v_and_b32_dpp v165, v165, v15 row_shr:1 row_mask:0xf bank_mask:0xf bound_ctrl:0
    v_and_b32_dpp v166, v166, v15 row_shr:1 row_mask:0xf bank_mask:0xf bound_ctrl:0
    v_and_b32_dpp v167, v167, v15 row_shr:1 row_mask:0xf bank_mask:0xf bound_ctrl:0
    v_and_b32_dpp v168, v168, v15 row_shr:1 row_mask:0xf bank_mask:0xf bound_ctrl:0
    v_and_b32_dpp v169, v169, v15 row_shr:1 row_mask:0xf bank_mask:0xf bound_ctrl:0
    v_and_b32_dpp v170, v170, v15 row_shr:1 row_mask:0xf bank_mask:0xf bound_ctrl:0
    v_and_b32_dpp v171, v171, v15 row_shr:1 row_mask:0xf bank_mask:0xf bound_ctrl:0
    v_and_b32_dpp v172, v172, v15 row_shr:1 row_mask:0xf bank_mask:0xf bound_ctrl:0
    v_and_b32_dpp v173, v173, v15 row_shr:1 row_mask:0xf bank_mask:0xf bound_ctrl:0
    v_and_b32_dpp v174, v174, v15 row_shr:1 row_mask:0xf bank_mask:0xf bound_ctrl:0
    v_and_b32_dpp v175, v175, v15 row_shr:1 row_mask:0xf bank_mask:0xf bound_ctrl:0
    s_nop 1
    v_mfma_f32_32x32x16_bf16 v[160:175], v[176:179], v[96:99], v[160:175]
    ds_read_b128 v[208:211], v14 offset:2816
    ds_read_b128 v[212:215], v14 offset:2848
    v_mfma_f32_32x32x16_bf16 v[160:175], v[180:183], v[100:103], v[160:175]
    ds_read_b128 v[216:219], v14 offset:2880
    ds_read_b128 v[220:223], v14 offset:2912
    v_mfma_f32_32x32x16_bf16 v[160:175], v[184:187], v[104:107], v[160:175]
    ds_read_b128 v[224:227], v14 offset:2944
    v_mfma_f32_32x32x16_bf16 v[160:175], v[188:191], v[108:111], v[160:175]
    ds_read_b128 v[228:231], v14 offset:2976
    v_mfma_f32_32x32x16_bf16 v[160:175], v[192:195], v[112:115], v[160:175]
    ds_read_b128 v[232:235], v14 offset:3008
    v_mfma_f32_32x32x16_bf16 v[160:175], v[196:199], v[116:119], v[160:175]
    ds_read_b128 v[236:239], v14 offset:3040
    v_mfma_f32_32x32x16_bf16 v[160:175], v[200:203], v[120:123], v[160:175]
    v_mfma_f32_32x32x16_bf16 v[160:175], v[204:207], v[124:127], v[160:175]
    s_waitcnt lgkmcnt(0)
    s_nop 11
    v_and_b32_dpp v160, v160, v15 row_shr:1 row_mask:0xf bank_mask:0xf bound_ctrl:0
    v_and_b32_dpp v161, v161, v15 row_shr:1 row_mask:0xf bank_mask:0xf bound_ctrl:0
    v_and_b32_dpp v162, v162, v15 row_shr:1 row_mask:0xf bank_mask:0xf bound_ctrl:0
    v_and_b32_dpp v163, v163, v15 row_shr:1 row_mask:0xf bank_mask:0xf bound_ctrl:0
    v_and_b32_dpp v164, v164, v15 row_shr:1 row_mask:0xf bank_mask:0xf bound_ctrl:0
    v_and_b32_dpp v165, v165, v15 row_shr:1 row_mask:0xf bank_mask:0xf bound_ctrl:0
    v_and_b32_dpp v166, v166, v15 row_shr:1 row_mask:0xf bank_mask:0xf bound_ctrl:0
    v_and_b32_dpp v167, v167, v15 row_shr:1 row_mask:0xf bank_mask:0xf bound_ctrl:0
    v_and_b32_dpp v168, v168, v15 row_shr:1 row_mask:0xf bank_mask:0xf bound_ctrl:0
    v_and_b32_dpp v169, v169, v15 row_shr:1 row_mask:0xf bank_mask:0xf bound_ctrl:0
    v_and_b32_dpp v170, v170, v15 row_shr:1 row_mask:0xf bank_mask:0xf bound_ctrl:0
    v_and_b32_dpp v171, v171, v15 row_shr:1 row_mask:0xf bank_mask:0xf bound_ctrl:0
    v_and_b32_dpp v172, v172, v15 row_shr:1 row_mask:0xf bank_mask:0xf bound_ctrl:0
    v_and_b32_dpp v173, v173, v15 row_shr:1 row_mask:0xf bank_mask:0xf bound_ctrl:0
    v_and_b32_dpp v174, v174, v15 row_shr:1 row_mask:0xf bank_mask:0xf bound_ctrl:0
    v_and_b32_dpp v175, v175, v15 row_shr:1 row_mask:0xf bank_mask:0xf bound_ctrl:0
    s_nop 1
    v_mfma_f32_32x32x16_bf16 v[160:175], v[208:211], v[96:99], v[160:175]
    ds_read_b128 v[176:179], v14 offset:2560
    ds_read_b128 v[180:183], v14 offset:2592
    v_mfma_f32_32x32x16_bf16 v[160:175], v[212:215], v[100:103], v[160:175]
    ds_read_b128 v[184:187], v14 offset:2624
    ds_read_b128 v[188:191], v14 offset:2656
    v_mfma_f32_32x32x16_bf16 v[160:175], v[216:219], v[104:107], v[160:175]
    ds_read_b128 v[192:195], v14 offset:2688
    v_mfma_f32_32x32x16_bf16 v[160:175], v[220:223], v[108:111], v[160:175]
    ds_read_b128 v[196:199], v14 offset:2720
    v_mfma_f32_32x32x16_bf16 v[160:175], v[224:227], v[112:115], v[160:175]
    ds_read_b128 v[200:203], v14 offset:2752
    v_mfma_f32_32x32x16_bf16 v[160:175], v[228:231], v[116:119], v[160:175]
    ds_read_b128 v[204:207], v14 offset:2784
    v_mfma_f32_32x32x16_bf16 v[160:175], v[232:235], v[120:123], v[160:175]
    v_mfma_f32_32x32x16_bf16 v[160:175], v[236:239], v[124:127], v[160:175]
    s_waitcnt lgkmcnt(0)
    s_nop 11
    v_and_b32_dpp v160, v160, v15 row_shr:1 row_mask:0xf bank_mask:0xf bound_ctrl:0
    v_and_b32_dpp v161, v161, v15 row_shr:1 row_mask:0xf bank_mask:0xf bound_ctrl:0
    v_and_b32_dpp v162, v162, v15 row_shr:1 row_mask:0xf bank_mask:0xf bound_ctrl:0
    v_and_b32_dpp v163, v163, v15 row_shr:1 row_mask:0xf bank_mask:0xf bound_ctrl:0
    v_and_b32_dpp v164, v164, v15 row_shr:1 row_mask:0xf bank_mask:0xf bound_ctrl:0
    v_and_b32_dpp v165, v165, v15 row_shr:1 row_mask:0xf bank_mask:0xf bound_ctrl:0
    v_and_b32_dpp v166, v166, v15 row_shr:1 row_mask:0xf bank_mask:0xf bound_ctrl:0
    v_and_b32_dpp v167, v167, v15 row_shr:1 row_mask:0xf bank_mask:0xf bound_ctrl:0
    v_and_b32_dpp v168, v168, v15 row_shr:1 row_mask:0xf bank_mask:0xf bound_ctrl:0
    v_and_b32_dpp v169, v169, v15 row_shr:1 row_mask:0xf bank_mask:0xf bound_ctrl:0
    v_and_b32_dpp v170, v170, v15 row_shr:1 row_mask:0xf bank_mask:0xf bound_ctrl:0
    v_and_b32_dpp v171, v171, v15 row_shr:1 row_mask:0xf bank_mask:0xf bound_ctrl:0
    v_and_b32_dpp v172, v172, v15 row_shr:1 row_mask:0xf bank_mask:0xf bound_ctrl:0
    v_and_b32_dpp v173, v173, v15 row_shr:1 row_mask:0xf bank_mask:0xf bound_ctrl:0
    v_and_b32_dpp v174, v174, v15 row_shr:1 row_mask:0xf bank_mask:0xf bound_ctrl:0
    v_and_b32_dpp v175, v175, v15 row_shr:1 row_mask:0xf bank_mask:0xf bound_ctrl:0
    s_nop 1
    v_mfma_f32_32x32x16_bf16 v[160:175], v[176:179], v[96:99], v[160:175]
    ds_read_b128 v[208:211], v14 offset:2304
    ds_read_b128 v[212:215], v14 offset:2336
    v_mfma_f32_32x32x16_bf16 v[160:175], v[180:183], v[100:103], v[160:175]
    ds_read_b128 v[216:219], v14 offset:2368
    ds_read_b128 v[220:223], v14 offset:2400
    v_mfma_f32_32x32x16_bf16 v[160:175], v[184:187], v[104:107], v[160:175]
    ds_read_b128 v[224:227], v14 offset:2432
    v_mfma_f32_32x32x16_bf16 v[160:175], v[188:191], v[108:111], v[160:175]
    ds_read_b128 v[228:231], v14 offset:2464
    v_mfma_f32_32x32x16_bf16 v[160:175], v[192:195], v[112:115], v[160:175]
    ds_read_b128 v[232:235], v14 offset:2496
    v_mfma_f32_32x32x16_bf16 v[160:175], v[196:199], v[116:119], v[160:175]
    ds_read_b128 v[236:239], v14 offset:2528
    v_mfma_f32_32x32x16_bf16 v[160:175], v[200:203], v[120:123], v[160:175]
    v_mfma_f32_32x32x16_bf16 v[160:175], v[204:207], v[124:127], v[160:175]
    s_waitcnt lgkmcnt(0)
    s_nop 11
    v_and_b32_dpp v160, v160, v15 row_shr:1 row_mask:0xf bank_mask:0xf bound_ctrl:0
    v_and_b32_dpp v161, v161, v15 row_shr:1 row_mask:0xf bank_mask:0xf bound_ctrl:0
    v_and_b32_dpp v162, v162, v15 row_shr:1 row_mask:0xf bank_mask:0xf bound_ctrl:0
    v_and_b32_dpp v163, v163, v15 row_shr:1 row_mask:0xf bank_mask:0xf bound_ctrl:0
    v_and_b32_dpp v164, v164, v15 row_shr:1 row_mask:0xf bank_mask:0xf bound_ctrl:0
    v_and_b32_dpp v165, v165, v15 row_shr:1 row_mask:0xf bank_mask:0xf bound_ctrl:0
    v_and_b32_dpp v166, v166, v15 row_shr:1 row_mask:0xf bank_mask:0xf bound_ctrl:0
    v_and_b32_dpp v167, v167, v15 row_shr:1 row_mask:0xf bank_mask:0xf bound_ctrl:0
    v_and_b32_dpp v168, v168, v15 row_shr:1 row_mask:0xf bank_mask:0xf bound_ctrl:0
    v_and_b32_dpp v169, v169, v15 row_shr:1 row_mask:0xf bank_mask:0xf bound_ctrl:0
    v_and_b32_dpp v170, v170, v15 row_shr:1 row_mask:0xf bank_mask:0xf bound_ctrl:0
    v_and_b32_dpp v171, v171, v15 row_shr:1 row_mask:0xf bank_mask:0xf bound_ctrl:0
    v_and_b32_dpp v172, v172, v15 row_shr:1 row_mask:0xf bank_mask:0xf bound_ctrl:0
    v_and_b32_dpp v173, v173, v15 row_shr:1 row_mask:0xf bank_mask:0xf bound_ctrl:0
    v_and_b32_dpp v174, v174, v15 row_shr:1 row_mask:0xf bank_mask:0xf bound_ctrl:0
    v_and_b32_dpp v175, v175, v15 row_shr:1 row_mask:0xf bank_mask:0xf bound_ctrl:0
    s_nop 1
    v_mfma_f32_32x32x16_bf16 v[160:175], v[208:211], v[96:99], v[160:175]
    ds_read_b128 v[176:179], v14 offset:2048
    ds_read_b128 v[180:183], v14 offset:2080
    v_mfma_f32_32x32x16_bf16 v[160:175], v[212:215], v[100:103], v[160:175]
    ds_read_b128 v[184:187], v14 offset:2112
    ds_read_b128 v[188:191], v14 offset:2144
    v_mfma_f32_32x32x16_bf16 v[160:175], v[216:219], v[104:107], v[160:175]
    ds_read_b128 v[192:195], v14 offset:2176
    v_mfma_f32_32x32x16_bf16 v[160:175], v[220:223], v[108:111], v[160:175]
    ds_read_b128 v[196:199], v14 offset:2208
    v_mfma_f32_32x32x16_bf16 v[160:175], v[224:227], v[112:115], v[160:175]
    ds_read_b128 v[200:203], v14 offset:2240
    v_mfma_f32_32x32x16_bf16 v[160:175], v[228:231], v[116:119], v[160:175]
    ds_read_b128 v[204:207], v14 offset:2272
    v_mfma_f32_32x32x16_bf16 v[160:175], v[232:235], v[120:123], v[160:175]
    v_mfma_f32_32x32x16_bf16 v[160:175], v[236:239], v[124:127], v[160:175]
    s_waitcnt lgkmcnt(0)
    s_nop 11
    v_and_b32_dpp v160, v160, v15 row_shr:1 row_mask:0xf bank_mask:0xf bound_ctrl:0
    v_and_b32_dpp v161, v161, v15 row_shr:1 row_mask:0xf bank_mask:0xf bound_ctrl:0
    v_and_b32_dpp v162, v162, v15 row_shr:1 row_mask:0xf bank_mask:0xf bound_ctrl:0
    v_and_b32_dpp v163, v163, v15 row_shr:1 row_mask:0xf bank_mask:0xf bound_ctrl:0
    v_and_b32_dpp v164, v164, v15 row_shr:1 row_mask:0xf bank_mask:0xf bound_ctrl:0
    v_and_b32_dpp v165, v165, v15 row_shr:1 row_mask:0xf bank_mask:0xf bound_ctrl:0
    v_and_b32_dpp v166, v166, v15 row_shr:1 row_mask:0xf bank_mask:0xf bound_ctrl:0
    v_and_b32_dpp v167, v167, v15 row_shr:1 row_mask:0xf bank_mask:0xf bound_ctrl:0
    v_and_b32_dpp v168, v168, v15 row_shr:1 row_mask:0xf bank_mask:0xf bound_ctrl:0
    v_and_b32_dpp v169, v169, v15 row_shr:1 row_mask:0xf bank_mask:0xf bound_ctrl:0
    v_and_b32_dpp v170, v170, v15 row_shr:1 row_mask:0xf bank_mask:0xf bound_ctrl:0
    v_and_b32_dpp v171, v171, v15 row_shr:1 row_mask:0xf bank_mask:0xf bound_ctrl:0
    v_and_b32_dpp v172, v172, v15 row_shr:1 row_mask:0xf bank_mask:0xf bound_ctrl:0
    v_and_b32_dpp v173, v173, v15 row_shr:1 row_mask:0xf bank_mask:0xf bound_ctrl:0
    v_and_b32_dpp v174, v174, v15 row_shr:1 row_mask:0xf bank_mask:0xf bound_ctrl:0
    v_and_b32_dpp v175, v175, v15 row_shr:1 row_mask:0xf bank_mask:0xf bound_ctrl:0
    s_nop 1
    v_mfma_f32_32x32x16_bf16 v[160:175], v[176:179], v[96:99], v[160:175]
    v_mfma_f32_32x32x16_bf16 v[160:175], v[180:183], v[100:103], v[160:175]
    v_mfma_f32_32x32x16_bf16 v[160:175], v[184:187], v[104:107], v[160:175]
    v_mfma_f32_32x32x16_bf16 v[160:175], v[188:191], v[108:111], v[160:175]
    v_mfma_f32_32x32x16_bf16 v[160:175], v[192:195], v[112:115], v[160:175]
    v_mfma_f32_32x32x16_bf16 v[160:175], v[196:199], v[116:119], v[160:175]
    v_mfma_f32_32x32x16_bf16 v[160:175], v[200:203], v[120:123], v[160:175]
    v_mfma_f32_32x32x16_bf16 v[160:175], v[204:207], v[124:127], v[160:175]
    s_setprio 0
    s_mov_b32 s47, 0
prep_kernel_nn19:
    v_readfirstlane_b32 s46, v250
    s_add_u32 s47, s47, 1
    s_cmp_lg_u32 s46, 0
    s_cbranch_scc1 prep_kernel_nd20
    s_cmp_ge_u32 s47, 200000
    s_cbranch_scc1 prep_kernel_nd20
    buffer_load_dword v250, v251, s[48:51], 0 offen sc1
    s_waitcnt vmcnt(0)
    s_branch prep_kernel_nn19
prep_kernel_nd20:
    s_lshr_b32 s40, s2, 4
    s_lshl_b32 s40, s40, 9
    s_add_u32 s40, s40, 29700096
    s_mov_b32 s41, 29683712
    v_lshrrev_b32 v16, 2, v1
    v_mul_u32_u24 v16, 5120, v16
    v_and_b32 v17, 3, v1
    v_lshl_add_u32 v16, v17, 7, v16
    v_lshlrev_b32 v18, 7, v1
    v_mov_b32 v17, s46
    s_add_u32 s42, s41, 8192
    s_mov_b32 s47, 0
prep_kernel_mp21:
    buffer_load_dword v19, v18, s[28:31], s41 offen sc1
    buffer_load_dword v28, v18, s[28:31], s42 offen sc1
    s_mov_b64 exec, 0xfff
    buffer_load_dword v17, v16, s[28:31], s40 offen sc1
    s_mov_b64 exec, -1
    s_waitcnt vmcnt(0)
    v_cmp_ne_u32 vcc, s46, v17
    v_cmp_ne_u32 s[66:67], s46, v19
    v_cmp_ne_u32 s[68:69], s46, v28
    s_add_u32 s47, s47, 1
    s_nop 2
    s_or_b64 vcc, vcc, s[66:67]
    s_or_b64 vcc, vcc, s[68:69]
    s_cmp_ge_u32 s47, 200000
    s_cbranch_scc1 prep_kernel_md22
    s_cbranch_vccz prep_kernel_md22
    s_sleep 8
    s_branch prep_kernel_mp21
prep_kernel_md22:
    s_lshl_b32 s40, s2, 4
    s_add_u32 s40, s40, 2793472
    v_lshrrev_b32 v16, 2, v1
    v_mul_u32_u24 v16, 2560, v16
    v_and_b32 v17, 3, v1
    v_mul_u32_u24 v17, 15360, v17
    v_add_u32 v16, v16, v17
    s_mov_b64 exec, 0xfff
    buffer_load_dwordx4 v[20:23], v16, s[28:31], s40 offen sc1
    s_mov_b64 exec, -1
    v_lshlrev_b32 v18, 4, v1
    v_subrev_u32 v19, 655360, v4
    s_lshl_b32 s43, s20, 10
    s_sub_u32 s44, s43, 4096
    s_add_u32 m0, s43, 55296
    s_add_u32 s39, s38, 2854912
    buffer_load_dwordx4 v4, s[28:31], s39 offen sc1 lds
    s_add_u32 m0, s43, 71680
    s_add_u32 s39, s43, 5476352
    buffer_load_dwordx4 v18, s[28:31], s39 offen sc1 lds
    s_add_u32 m0, s44, 55296
    s_add_u32 s39, s38, 2854912
    buffer_load_dwordx4 v19, s[28:31], s39 offen sc1 lds
    s_add_u32 m0, s44, 71680
    s_add_u32 s39, s44, 5476352
    buffer_load_dwordx4 v18, s[28:31], s39 offen sc1 lds
    s_add_u32 m0, s43, 63488
    s_add_u32 s39, s38, 4165632
    buffer_load_dwordx4 v4, s[28:31], s39 offen sc1 lds
    s_add_u32 m0, s43, 79872
    s_add_u32 s39, s43, 5484544
    buffer_load_dwordx4 v18, s[28:31], s39 offen sc1 lds
    s_add_u32 m0, s44, 63488
    s_add_u32 s39, s38, 4165632
    buffer_load_dwordx4 v19, s[28:31], s39 offen sc1 lds
    s_add_u32 m0, s44, 79872
    s_add_u32 s39, s44, 5484544
    buffer_load_dwordx4 v18, s[28:31], s39 offen sc1 lds
    s_mul_i32 s36, s19, 4096
    s_add_u32 s36, s36, 88064
    v_lshlrev_b32 v16, 4, v1
    v_add_u32 v16, s36, v16
    s_nop 4
    ds_write_b128 v16, v[160:163] offset:0
    ds_write_b128 v16, v[164:167] offset:1024
    ds_write_b128 v16, v[168:171] offset:2048
    ds_write_b128 v16, v[172:175] offset:3072
    s_waitcnt vmcnt(8)
    s_nop 1
    v_add_f32_dpp v20, v20, v20 quad_perm:[1,0,3,2] row_mask:0xf bank_mask:0xf
    v_add_f32_dpp v21, v21, v21 quad_perm:[1,0,3,2] row_mask:0xf bank_mask:0xf
    v_add_f32_dpp v22, v22, v22 quad_perm:[1,0,3,2] row_mask:0xf bank_mask:0xf
    v_add_f32_dpp v23, v23, v23 quad_perm:[1,0,3,2] row_mask:0xf bank_mask:0xf
    s_nop 1
    v_add_f32_dpp v20, v20, v20 quad_perm:[2,3,0,1] row_mask:0xf bank_mask:0xf
    v_add_f32_dpp v21, v21, v21 quad_perm:[2,3,0,1] row_mask:0xf bank_mask:0xf
    v_add_f32_dpp v22, v22, v22 quad_perm:[2,3,0,1] row_mask:0xf bank_mask:0xf
    v_add_f32_dpp v23, v23, v23 quad_perm:[2,3,0,1] row_mask:0xf bank_mask:0xf
    s_nop 1
    v_cvt_pk_bf16_f32 v24, v20, v21
    v_lshlrev_b32 v20, 16, v24
    v_and_b32 v21, 0xffff0000, v24
    v_cvt_pk_bf16_f32 v24, v22, v23
    v_lshlrev_b32 v22, 16, v24
    v_and_b32 v23, 0xffff0000, v24
    v_add_f32 v24, 1.0, v20
    v_add_f32 v25, 1.0, v21
    v_add_f32 v26, 1.0, v22
    v_add_f32 v27, 1.0, v23
    v_cvt_pk_bf16_f32 v10, v24, v25
    v_lshlrev_b32 v24, 16, v10
    v_and_b32 v25, 0xffff0000, v10
    v_cvt_pk_bf16_f32 v10, v26, v27
    v_lshlrev_b32 v26, 16, v10
    v_and_b32 v27, 0xffff0000, v10
    s_nop 1
    v_readlane_b32 s68, v20, 0
    v_readlane_b32 s72, v24, 4
    v_readlane_b32 s76, v20, 8
    v_readlane_b32 s69, v21, 0
    v_readlane_b32 s73, v25, 4
    v_readlane_b32 s77, v21, 8
    v_readlane_b32 s70, v22, 0
    v_readlane_b32 s74, v26, 4
    v_readlane_b32 s78, v22, 8
    v_readlane_b32 s71, v23, 0
    v_readlane_b32 s75, v27, 4
    v_readlane_b32 s79, v23, 8
    s_nop 1
    v_mov_b32 v10, s76
    v_mov_b32 v11, s77
    v_mov_b32 v12, s78
    v_mov_b32 v13, s79
    v_mul_f32 v20, s72, v10
    v_mul_f32 v24, s68, v10
    v_mul_f32 v21, s73, v11
    v_mul_f32 v25, s69, v11
    v_mul_f32 v22, s74, v12
    v_mul_f32 v26, s70, v12
    v_mul_f32 v23, s75, v13
    v_mul_f32 v27, s71, v13
    v_mov_b32 v16, 104448
    s_mov_b64 exec, 1
    ds_write_b128 v16, v[20:23]
    ds_write_b128 v16, v[24:27] offset:16
    s_mov_b64 exec, -1
    s_waitcnt vmcnt(0) lgkmcnt(0)
    s_barrier
p_convE:
    v_lshrrev_b32 v2, 6, v0
    s_lshl_b32 s44, s32, 16
    s_and_b32 s45, s32, 0xffff0000
    s_lshl_b32 s46, s33, 16
    s_and_b32 s47, s33, 0xffff0000
    v_mul_u32_u24 v17, 264, v2
    v_lshl_add_u32 v17, v1, 2, v17
    v_mul_u32_u24 v19, 272, v2
    v_lshlrev_b32 v18, 2, v1
    v_sub_u32 v19, v19, v18
    v_add_u32 v19, 4604, v19
    v_lshlrev_b32 v18, 4, v0
    v_add_u32 v18, 55296, v18
    v_mov_b32 v16, 104448
    ds_read_b32 v224, v19 offset:0
    ds_read_b32 v225, v19 offset:13824
    ds_read_b32 v226, v19 offset:27648
    ds_read_b32 v227, v19 offset:41472
    ds_read_b32 v228, v19 offset:2176
    ds_read_b32 v229, v19 offset:16000
    ds_read_b32 v230, v19 offset:29824
    ds_read_b32 v231, v19 offset:43648
    ds_read_b128 v[176:179], v18 offset:0
    ds_read_b128 v[144:147], v18 offset:16384
    ds_read_b128 v[180:183], v18 offset:8192
    ds_read_b128 v[148:151], v18 offset:24576
    ds_read_b128 v[160:163], v16
    ds_read_b128 v[164:167], v16 offset:16
    v_mov_b32 v28, s44
    v_mov_b32 v29, s45
    v_mov_b32 v30, s46
    v_mov_b32 v31, s47
    s_waitcnt lgkmcnt(0)
    s_barrier
    ds_read_b32 v48, v17 offset:0
    ds_read_b32 v49, v17 offset:13824
    ds_read_b32 v50, v17 offset:27648
    ds_read_b32 v51, v17 offset:41472
    ds_read_b32 v52, v17 offset:2112
    ds_read_b32 v53, v17 offset:15936
    ds_read_b32 v54, v17 offset:29760
    ds_read_b32 v55, v17 offset:43584
    v_lshlrev_b32 v68, 16, v224
    v_and_b32 v64, 0xffff0000, v224
    v_lshlrev_b32 v69, 16, v225
    v_and_b32 v65, 0xffff0000, v225
    v_lshlrev_b32 v70, 16, v226
    v_and_b32 v66, 0xffff0000, v226
    v_lshlrev_b32 v71, 16, v227
    v_and_b32 v67, 0xffff0000, v227
    v_lshlrev_b32 v112, 16, v176
    v_and_b32 v113, 0xffff0000, v176
    v_lshlrev_b32 v114, 16, v177
    v_and_b32 v115, 0xffff0000, v177
    v_lshlrev_b32 v116, 16, v178
    v_and_b32 v117, 0xffff0000, v178
    v_lshlrev_b32 v118, 16, v179
    v_and_b32 v119, 0xffff0000, v179
    v_pk_fma_f32 v[120:121], v[112:113], v[144:145], v[144:145] op_sel:[0,1,0] op_sel_hi:[1,1,0]
    v_pk_fma_f32 v[122:123], v[114:115], v[144:145], v[144:145] op_sel:[0,1,0] op_sel_hi:[1,1,0]
    v_pk_fma_f32 v[124:125], v[116:117], v[146:147], v[146:147] op_sel:[0,1,0] op_sel_hi:[1,1,0]
    v_pk_fma_f32 v[126:127], v[118:119], v[146:147], v[146:147] op_sel:[0,1,0] op_sel_hi:[1,1,0]
    v_pk_fma_f32 v[120:121], v[120:121], v[160:161], v[164:165]
    v_pk_fma_f32 v[122:123], v[122:123], v[162:163], v[166:167]
    v_pk_fma_f32 v[124:125], v[124:125], v[160:161], v[164:165]
    v_pk_fma_f32 v[126:127], v[126:127], v[162:163], v[166:167]
    v_lshlrev_b32 v88, 16, v228
    v_and_b32 v84, 0xffff0000, v228
    v_lshlrev_b32 v89, 16, v229
    v_and_b32 v85, 0xffff0000, v229
    v_lshlrev_b32 v90, 16, v230
    v_and_b32 v86, 0xffff0000, v230
    v_lshlrev_b32 v91, 16, v231
    v_and_b32 v87, 0xffff0000, v231
    v_lshlrev_b32 v128, 16, v180
    v_and_b32 v129, 0xffff0000, v180
    v_lshlrev_b32 v130, 16, v181
    v_and_b32 v131, 0xffff0000, v181
    v_lshlrev_b32 v132, 16, v182
    v_and_b32 v133, 0xffff0000, v182
    v_lshlrev_b32 v134, 16, v183
    v_and_b32 v135, 0xffff0000, v183
    v_pk_fma_f32 v[136:137], v[128:129], v[148:149], v[148:149] op_sel:[0,1,0] op_sel_hi:[1,1,0]
    v_pk_fma_f32 v[138:139], v[130:131], v[148:149], v[148:149] op_sel:[0,1,0] op_sel_hi:[1,1,0]
    v_pk_fma_f32 v[140:141], v[132:133], v[150:151], v[150:151] op_sel:[0,1,0] op_sel_hi:[1,1,0]
    v_pk_fma_f32 v[142:143], v[134:135], v[150:151], v[150:151] op_sel:[0,1,0] op_sel_hi:[1,1,0]
    v_pk_fma_f32 v[136:137], v[136:137], v[160:161], v[164:165]
    v_pk_fma_f32 v[138:139], v[138:139], v[162:163], v[166:167]
    v_pk_fma_f32 v[140:141], v[140:141], v[160:161], v[164:165]
    v_pk_fma_f32 v[142:143], v[142:143], v[162:163], v[166:167]
    s_waitcnt lgkmcnt(0)
    v_lshlrev_b32 v74, 16, v48
    v_and_b32 v78, 0xffff0000, v48
    v_lshlrev_b32 v75, 16, v49
    v_and_b32 v79, 0xffff0000, v49
    v_lshlrev_b32 v76, 16, v50
    v_and_b32 v80, 0xffff0000, v50
    v_lshlrev_b32 v77, 16, v51
    v_and_b32 v81, 0xffff0000, v51
    v_pk_fma_f32 v[64:65], v[64:65], v[28:29], v[74:75]
    v_pk_fma_f32 v[66:67], v[66:67], v[30:31], v[76:77]
    v_pk_fma_f32 v[68:69], v[68:69], v[28:29], v[78:79]
    v_pk_fma_f32 v[70:71], v[70:71], v[30:31], v[80:81]
    v_pk_fma_f32 v[64:65], v[64:65], v[120:121], v[112:113]
    v_pk_fma_f32 v[66:67], v[66:67], v[122:123], v[114:115]
    v_pk_fma_f32 v[68:69], v[68:69], v[124:125], v[116:117]
    v_pk_fma_f32 v[70:71], v[70:71], v[126:127], v[118:119]
    v_cvt_pk_bf16_f32 v208, v64, v65
    v_cvt_pk_bf16_f32 v209, v66, v67
    v_cvt_pk_bf16_f32 v210, v68, v69
    v_cvt_pk_bf16_f32 v211, v70, v71
    s_add_u32 s39, s38, 5492736
    buffer_store_dwordx4 v[208:211], v4, s[28:31], s39 offen sc1
    v_lshlrev_b32 v94, 16, v52
    v_and_b32 v98, 0xffff0000, v52
    v_lshlrev_b32 v95, 16, v53
    v_and_b32 v99, 0xffff0000, v53
    v_lshlrev_b32 v96, 16, v54
    v_and_b32 v100, 0xffff0000, v54
    v_lshlrev_b32 v97, 16, v55
    v_and_b32 v101, 0xffff0000, v55
    v_pk_fma_f32 v[84:85], v[84:85], v[28:29], v[94:95]
    v_pk_fma_f32 v[86:87], v[86:87], v[30:31], v[96:97]
    v_pk_fma_f32 v[88:89], v[88:89], v[28:29], v[98:99]
    v_pk_fma_f32 v[90:91], v[90:91], v[30:31], v[100:101]
    v_pk_fma_f32 v[84:85], v[84:85], v[136:137], v[128:129]
    v_pk_fma_f32 v[86:87], v[86:87], v[138:139], v[130:131]
    v_pk_fma_f32 v[88:89], v[88:89], v[140:141], v[132:133]
    v_pk_fma_f32 v[90:91], v[90:91], v[142:143], v[134:135]
    v_cvt_pk_bf16_f32 v212, v84, v85
    v_cvt_pk_bf16_f32 v213, v86, v87
    v_cvt_pk_bf16_f32 v214, v88, v89
    v_cvt_pk_bf16_f32 v215, v90, v91
    s_add_u32 s39, s38, 6803456
    buffer_store_dwordx4 v[212:215], v4, s[28:31], s39 offen sc1
    s_waitcnt vmcnt(0)
    s_endpgm
p_pack:
    s_sub_u32 s21, s2, 416
    s_mul_i32 s34, s20, 13824
    s_cmp_ge_u32 s20, 4
    s_cbranch_scc1 prep_end
    s_cmp_eq_u32 s20, 0
    s_cbranch_scc1 k1_pack
    s_cmp_eq_u32 s20, 1
    s_cbranch_scc0 p_pk2
    s_cmp_lt_u32 s21, 58
    s_cbranch_scc0 p_pk1
    s_add_u32 s21, s21, 96
    s_branch k1_pack
p_pk1:
    s_sub_u32 s21, s21, 58
    s_cmp_ge_u32 s21, 30
    s_cbranch_scc1 prep_end
    s_branch p_fin
p_pk2:
    s_sub_u32 s22, s20, 2
    s_mul_i32 s22, s22, 96
    s_add_u32 s21, s21, s22
    s_cmp_ge_u32 s21, 120
    s_cbranch_scc1 prep_end
    s_add_u32 s21, s21, 120
    v_mov_b32 v251, 0
    buffer_load_dword v250, v251, s[48:51], 0 offen sc1
    s_branch p_mod
p_fin:
    s_add_u32 s21, s21, 30
    v_mov_b32 v16, 0
    buffer_load_dword v17, v16, s[48:51], 0 offen sc1
    s_waitcnt vmcnt(0)
    s_mov_b32 s47, 0
prep_kernel_nn23:
    v_readfirstlane_b32 s46, v17
    s_add_u32 s47, s47, 1
    s_cmp_lg_u32 s46, 0
    s_cbranch_scc1 prep_kernel_nd24
    s_cmp_ge_u32 s47, 200000
    s_cbranch_scc1 prep_kernel_nd24
    buffer_load_dword v17, v16, s[48:51], 0 offen sc1
    s_waitcnt vmcnt(0)
    s_branch prep_kernel_nn23
prep_kernel_nd24:
    s_lshl_b32 s40, s21, 9
    s_add_u32 s40, s40, 29700096
    v_lshlrev_b32 v16, 7, v1
    s_mov_b32 s47, 0
    s_mov_b64 exec, 15
prep_kernel_pl25:
    buffer_load_dword v17, v16, s[28:31], s40 offen sc1
    s_add_u32 s47, s47, 1
    s_waitcnt vmcnt(0)
    v_cmp_ne_u32 vcc, s46, v17
    s_cmp_ge_u32 s47, 200000
    s_cbranch_scc1 prep_kernel_pd26
    s_cbranch_vccz prep_kernel_pd26
    s_sleep 14
    s_branch prep_kernel_pl25
prep_kernel_pd26:
    s_mov_b64 exec, -1
    v_lshlrev_b32 v7, 2, v1
    s_lshl_b32 s22, s21, 8
    s_add_u32 s23, s22, 2793472
    buffer_load_dword v10, v7, s[28:31], s23 offen sc1
    s_add_u32 s23, s23, 15360
    buffer_load_dword v11, v7, s[28:31], s23 offen sc1
    s_add_u32 s23, s23, 15360
    buffer_load_dword v12, v7, s[28:31], s23 offen sc1
    s_add_u32 s23, s23, 15360
    buffer_load_dword v13, v7, s[28:31], s23 offen sc1
    s_waitcnt vmcnt(0)
    v_add_f32 v10, v10, v11
    v_add_f32 v12, v12, v13
    s_nop 0
    v_add_f32 v10, v10, v12
    s_nop 0
    v_cvt_pk_bf16_f32 v10, v10, v10
    s_nop 0
    v_lshlrev_b32 v10, 16, v10
    s_sub_u32 s24, s21, 10
    s_cmp_lt_u32 s24, 10
    s_cbranch_scc1 prep_kernel_f127
    s_sub_u32 s24, s21, 40
    s_cmp_lt_u32 s24, 10
    s_cbranch_scc0 prep_kernel_f228
prep_kernel_f127:
    v_add_f32 v10, 1.0, v10
    s_nop 0
    v_cvt_pk_bf16_f32 v10, v10, v10
    s_nop 0
    v_lshlrev_b32 v10, 16, v10
prep_kernel_f228:
    s_add_u32 s22, s22, 8114176
    buffer_store_dword v10, v7, s[28:31], s22 offen sc1
    s_endpgm
k1_pack:
    v_lshrrev_b32 v3, 3, v1
    v_and_b32 v4, 7, v1
    v_mul_u32_u24 v5, 144, v3
    v_lshl_add_u32 v5, v4, 4, v5
    v_add_u32 v5, s34, v5
    v_and_b32 v6, 15, v1
    v_lshrrev_b32 v7, 4, v1
    v_lshrrev_b32 v8, 2, v6
    v_lshl_add_u32 v8, v7, 3, v8
    v_mul_u32_u24 v8, 144, v8
    v_and_b32 v9, 3, v6
    v_lshl_add_u32 v8, v9, 3, v8
    v_add_u32 v8, s34, v8
    v_lshlrev_b32 v9, 4, v1
    s_cmp_lt_u32 s21, 20
    s_cbranch_scc1 prep_kernel_pk29
    s_cmp_lt_u32 s21, 40
    s_cbranch_scc1 prep_kernel_pk30
    s_cmp_lt_u32 s21, 94
    s_cbranch_scc1 prep_kernel_pk31
    s_branch prep_kernel_pk32
prep_kernel_pk29:
    s_mov_b32 s24, s12
    s_mov_b32 s25, s13
    s_mov_b32 s26, 819200
    s_mov_b32 s27, 0x00020000
    s_sub_u32 s32, s21, 0
    s_mul_i32 s33, s32, 52429
    s_lshr_b32 s33, s33, 19
    s_mul_i32 s35, s33, 10
    s_sub_u32 s35, s32, s35
    v_mul_u32_u24 v10, 1280, v3
    v_lshl_add_u32 v10, v4, 4, v10
    s_mul_i32 s36, s33, 409600
    s_lshl_b32 s37, s35, 7
    s_add_u32 s36, s36, s37
    buffer_load_dwordx4 v[32:35], v10, s[24:27], s36 offen nt
    s_add_u32 s36, s36, 10240
    buffer_load_dwordx4 v[36:39], v10, s[24:27], s36 offen nt
    s_add_u32 s36, s36, 10240
    buffer_load_dwordx4 v[40:43], v10, s[24:27], s36 offen nt
    s_add_u32 s36, s36, 10240
    buffer_load_dwordx4 v[44:47], v10, s[24:27], s36 offen nt
    s_add_u32 s36, s36, 10240
    buffer_load_dwordx4 v[48:51], v10, s[24:27], s36 offen nt
    s_add_u32 s36, s36, 10240
    buffer_load_dwordx4 v[52:55], v10, s[24:27], s36 offen nt
    s_add_u32 s36, s36, 10240
    buffer_load_dwordx4 v[56:59], v10, s[24:27], s36 offen nt
    s_add_u32 s36, s36, 10240
    buffer_load_dwordx4 v[60:63], v10, s[24:27], s36 offen nt
    s_add_u32 s36, s36, 10240
    buffer_load_dwordx4 v[64:67], v10, s[24:27], s36 offen nt
    s_add_u32 s36, s36, 10240
    buffer_load_dwordx4 v[68:71], v10, s[24:27], s36 offen nt
    s_add_u32 s36, s36, 10240
    buffer_load_dwordx4 v[72:75], v10, s[24:27], s36 offen nt
    s_add_u32 s36, s36, 10240
    buffer_load_dwordx4 v[76:79], v10, s[24:27], s36 offen nt
    s_add_u32 s36, s36, 10240
    buffer_load_dwordx4 v[80:83], v10, s[24:27], s36 offen nt
    s_add_u32 s36, s36, 10240
    buffer_load_dwordx4 v[84:87], v10, s[24:27], s36 offen nt
    s_add_u32 s36, s36, 10240
    buffer_load_dwordx4 v[88:91], v10, s[24:27], s36 offen nt
    s_add_u32 s36, s36, 10240
    buffer_load_dwordx4 v[92:95], v10, s[24:27], s36 offen nt
    s_add_u32 s36, s36, 10240
    buffer_load_dwordx4 v[96:99], v10, s[24:27], s36 offen nt
    s_add_u32 s36, s36, 10240
    buffer_load_dwordx4 v[100:103], v10, s[24:27], s36 offen nt
    s_add_u32 s36, s36, 10240
    buffer_load_dwordx4 v[104:107], v10, s[24:27], s36 offen nt
    s_add_u32 s36, s36, 10240
    buffer_load_dwordx4 v[108:111], v10, s[24:27], s36 offen nt
    s_add_u32 s36, s36, 10240
    buffer_load_dwordx4 v[112:115], v10, s[24:27], s36 offen nt
    s_add_u32 s36, s36, 10240
    buffer_load_dwordx4 v[116:119], v10, s[24:27], s36 offen nt
    s_add_u32 s36, s36, 10240
    buffer_load_dwordx4 v[120:123], v10, s[24:27], s36 offen nt
    s_add_u32 s36, s36, 10240
    buffer_load_dwordx4 v[124:127], v10, s[24:27], s36 offen nt
    s_add_u32 s36, s36, 10240
    buffer_load_dwordx4 v[128:131], v10, s[24:27], s36 offen nt
    s_add_u32 s36, s36, 10240
    buffer_load_dwordx4 v[132:135], v10, s[24:27], s36 offen nt
    s_add_u32 s36, s36, 10240
    buffer_load_dwordx4 v[136:139], v10, s[24:27], s36 offen nt
    s_add_u32 s36, s36, 10240
    buffer_load_dwordx4 v[140:143], v10, s[24:27], s36 offen nt
    s_add_u32 s36, s36, 10240
    buffer_load_dwordx4 v[144:147], v10, s[24:27], s36 offen nt
    s_add_u32 s36, s36, 10240
    buffer_load_dwordx4 v[148:151], v10, s[24:27], s36 offen nt
    s_add_u32 s36, s36, 10240
    buffer_load_dwordx4 v[152:155], v10, s[24:27], s36 offen nt
    s_add_u32 s36, s36, 10240
    buffer_load_dwordx4 v[156:159], v10, s[24:27], s36 offen nt
    s_add_u32 s36, s36, 10240
    buffer_load_dwordx4 v[160:163], v10, s[24:27], s36 offen nt
    s_add_u32 s36, s36, 10240
    buffer_load_dwordx4 v[164:167], v10, s[24:27], s36 offen nt
    s_add_u32 s36, s36, 10240
    buffer_load_dwordx4 v[168:171], v10, s[24:27], s36 offen nt
    s_add_u32 s36, s36, 10240
    buffer_load_dwordx4 v[172:175], v10, s[24:27], s36 offen nt
    s_add_u32 s36, s36, 10240
    buffer_load_dwordx4 v[176:179], v10, s[24:27], s36 offen nt
    s_add_u32 s36, s36, 10240
    buffer_load_dwordx4 v[180:183], v10, s[24:27], s36 offen nt
    s_add_u32 s36, s36, 10240
    buffer_load_dwordx4 v[184:187], v10, s[24:27], s36 offen nt
    s_add_u32 s36, s36, 10240
    buffer_load_dwordx4 v[188:191], v10, s[24:27], s36 offen nt
    s_lshl_b32 s36, s35, 2
    s_add_u32 s36, s36, 0
    s_mul_i32 s38, s36, 6554
    s_lshr_b32 s38, s38, 16
    s_mul_i32 s39, s38, 10
    s_sub_u32 s39, s36, s39
    s_cmp_ge_u32 s39, 5
    s_cselect_b32 s40, 1, 0
    s_sub_u32 s41, s39, 6
    s_cmp_eq_u32 s39, 5
    s_cselect_b32 s41, 4, s41
    s_cmp_eq_u32 s40, 1
    s_cselect_b32 s39, s41, s39
    s_mul_i32 s37, s38, 200
    s_mul_i32 s40, s40, 100
    s_add_u32 s37, s37, s40
    s_mul_i32 s40, s33, 50
    s_add_u32 s37, s37, s40
    s_add_u32 s37, s37, s39
    s_lshl_b32 s37, s37, 10
    s_add_u32 s44, s37, 23236608
    s_movk_i32 s48, 5120
    s_lshl_b32 s36, s35, 2
    s_add_u32 s36, s36, 1
    s_mul_i32 s38, s36, 6554
    s_lshr_b32 s38, s38, 16
    s_mul_i32 s39, s38, 10
    s_sub_u32 s39, s36, s39
    s_cmp_ge_u32 s39, 5
    s_cselect_b32 s40, 1, 0
    s_sub_u32 s41, s39, 6
    s_cmp_eq_u32 s39, 5
    s_cselect_b32 s41, 4, s41
    s_cmp_eq_u32 s40, 1
    s_cselect_b32 s39, s41, s39
    s_mul_i32 s37, s38, 200
    s_mul_i32 s40, s40, 100
    s_add_u32 s37, s37, s40
    s_mul_i32 s40, s33, 50
    s_add_u32 s37, s37, s40
    s_add_u32 s37, s37, s39
    s_lshl_b32 s37, s37, 10
    s_add_u32 s45, s37, 23236608
    s_movk_i32 s49, 5120
    s_lshl_b32 s36, s35, 2
    s_add_u32 s36, s36, 2
    s_mul_i32 s38, s36, 6554
    s_lshr_b32 s38, s38, 16
    s_mul_i32 s39, s38, 10
    s_sub_u32 s39, s36, s39
    s_cmp_ge_u32 s39, 5
    s_cselect_b32 s40, 1, 0
    s_sub_u32 s41, s39, 6
    s_cmp_eq_u32 s39, 5
    s_cselect_b32 s41, 4, s41
    s_cmp_eq_u32 s40, 1
    s_cselect_b32 s39, s41, s39
    s_mul_i32 s37, s38, 200
    s_mul_i32 s40, s40, 100
    s_add_u32 s37, s37, s40
    s_mul_i32 s40, s33, 50
    s_add_u32 s37, s37, s40
    s_add_u32 s37, s37, s39
    s_lshl_b32 s37, s37, 10
    s_add_u32 s46, s37, 23236608
    s_movk_i32 s50, 5120
    s_lshl_b32 s36, s35, 2
    s_add_u32 s36, s36, 3
    s_mul_i32 s38, s36, 6554
    s_lshr_b32 s38, s38, 16
    s_mul_i32 s39, s38, 10
    s_sub_u32 s39, s36, s39
    s_cmp_ge_u32 s39, 5
    s_cselect_b32 s40, 1, 0
    s_sub_u32 s41, s39, 6
    s_cmp_eq_u32 s39, 5
    s_cselect_b32 s41, 4, s41
    s_cmp_eq_u32 s40, 1
    s_cselect_b32 s39, s41, s39
    s_mul_i32 s37, s38, 200
    s_mul_i32 s40, s40, 100
    s_add_u32 s37, s37, s40
    s_mul_i32 s40, s33, 50
    s_add_u32 s37, s37, s40
    s_add_u32 s37, s37, s39
    s_lshl_b32 s37, s37, 10
    s_add_u32 s47, s37, 23236608
    s_movk_i32 s51, 5120
    v_mov_b32 v12, 0
    v_mov_b32 v13, 0
    v_mov_b32 v14, 0
    v_mov_b32 v15, 0
    v_mov_b32 v16, 0x3f803f80
    s_waitcnt vmcnt(36)
    ds_write_b128 v5, v[32:35] offset:0
    ds_write_b128 v5, v[36:39] offset:1152
    ds_write_b128 v5, v[40:43] offset:2304
    ds_write_b128 v5, v[44:47] offset:3456
    s_waitcnt lgkmcnt(0)
    ds_read_b64_tr_b16 v[200:201], v8 offset:0
    ds_read_b64_tr_b16 v[202:203], v8 offset:576
    ds_read_b64_tr_b16 v[204:205], v8 offset:32
    ds_read_b64_tr_b16 v[206:207], v8 offset:608
    ds_read_b64_tr_b16 v[208:209], v8 offset:64
    ds_read_b64_tr_b16 v[210:211], v8 offset:640
    ds_read_b64_tr_b16 v[212:213], v8 offset:96
    ds_read_b64_tr_b16 v[214:215], v8 offset:672
    s_waitcnt vmcnt(32)
    ds_write_b128 v5, v[48:51] offset:4608
    ds_write_b128 v5, v[52:55] offset:5760
    ds_write_b128 v5, v[56:59] offset:6912
    ds_write_b128 v5, v[60:63] offset:8064
    s_waitcnt lgkmcnt(4)
    buffer_store_dwordx4 v[200:203], v9, s[28:31], s44 offen sc1
    s_add_u32 s44, s44, s48
    v_dot2_f32_bf16 v12, v200, v16, v12
    v_dot2_f32_bf16 v12, v201, v16, v12
    v_dot2_f32_bf16 v12, v202, v16, v12
    v_dot2_f32_bf16 v12, v203, v16, v12
    buffer_store_dwordx4 v[204:207], v9, s[28:31], s45 offen sc1
    s_add_u32 s45, s45, s49
    v_dot2_f32_bf16 v13, v204, v16, v13
    v_dot2_f32_bf16 v13, v205, v16, v13
    v_dot2_f32_bf16 v13, v206, v16, v13
    v_dot2_f32_bf16 v13, v207, v16, v13
    buffer_store_dwordx4 v[208:211], v9, s[28:31], s46 offen sc1
    s_add_u32 s46, s46, s50
    v_dot2_f32_bf16 v14, v208, v16, v14
    v_dot2_f32_bf16 v14, v209, v16, v14
    v_dot2_f32_bf16 v14, v210, v16, v14
    v_dot2_f32_bf16 v14, v211, v16, v14
    buffer_store_dwordx4 v[212:215], v9, s[28:31], s47 offen sc1
    s_add_u32 s47, s47, s51
    v_dot2_f32_bf16 v15, v212, v16, v15
    v_dot2_f32_bf16 v15, v213, v16, v15
    v_dot2_f32_bf16 v15, v214, v16, v15
    v_dot2_f32_bf16 v15, v215, v16, v15
    s_waitcnt lgkmcnt(0)
    ds_read_b64_tr_b16 v[216:217], v8 offset:4608
    ds_read_b64_tr_b16 v[218:219], v8 offset:5184
    ds_read_b64_tr_b16 v[220:221], v8 offset:4640
    ds_read_b64_tr_b16 v[222:223], v8 offset:5216
    ds_read_b64_tr_b16 v[224:225], v8 offset:4672
    ds_read_b64_tr_b16 v[226:227], v8 offset:5248
    ds_read_b64_tr_b16 v[228:229], v8 offset:4704
    ds_read_b64_tr_b16 v[230:231], v8 offset:5280
    s_waitcnt vmcnt(32)
    ds_write_b128 v5, v[64:67] offset:0
    ds_write_b128 v5, v[68:71] offset:1152
    ds_write_b128 v5, v[72:75] offset:2304
    ds_write_b128 v5, v[76:79] offset:3456
    s_waitcnt lgkmcnt(4)
    buffer_store_dwordx4 v[216:219], v9, s[28:31], s44 offen sc1
    s_add_u32 s44, s44, s48
    v_dot2_f32_bf16 v12, v216, v16, v12
    v_dot2_f32_bf16 v12, v217, v16, v12
    v_dot2_f32_bf16 v12, v218, v16, v12
    v_dot2_f32_bf16 v12, v219, v16, v12
    buffer_store_dwordx4 v[220:223], v9, s[28:31], s45 offen sc1
    s_add_u32 s45, s45, s49
    v_dot2_f32_bf16 v13, v220, v16, v13
    v_dot2_f32_bf16 v13, v221, v16, v13
    v_dot2_f32_bf16 v13, v222, v16, v13
    v_dot2_f32_bf16 v13, v223, v16, v13
    buffer_store_dwordx4 v[224:227], v9, s[28:31], s46 offen sc1
    s_add_u32 s46, s46, s50
    v_dot2_f32_bf16 v14, v224, v16, v14
    v_dot2_f32_bf16 v14, v225, v16, v14
    v_dot2_f32_bf16 v14, v226, v16, v14
    v_dot2_f32_bf16 v14, v227, v16, v14
    buffer_store_dwordx4 v[228:231], v9, s[28:31], s47 offen sc1
    s_add_u32 s47, s47, s51
    v_dot2_f32_bf16 v15, v228, v16, v15
    v_dot2_f32_bf16 v15, v229, v16, v15
    v_dot2_f32_bf16 v15, v230, v16, v15
    v_dot2_f32_bf16 v15, v231, v16, v15
    s_waitcnt lgkmcnt(0)
    ds_read_b64_tr_b16 v[200:201], v8 offset:0
    ds_read_b64_tr_b16 v[202:203], v8 offset:576
    ds_read_b64_tr_b16 v[204:205], v8 offset:32
    ds_read_b64_tr_b16 v[206:207], v8 offset:608
    ds_read_b64_tr_b16 v[208:209], v8 offset:64
    ds_read_b64_tr_b16 v[210:211], v8 offset:640
    ds_read_b64_tr_b16 v[212:213], v8 offset:96
    ds_read_b64_tr_b16 v[214:215], v8 offset:672
    s_waitcnt vmcnt(32)
    ds_write_b128 v5, v[80:83] offset:4608
    ds_write_b128 v5, v[84:87] offset:5760
    ds_write_b128 v5, v[88:91] offset:6912
    ds_write_b128 v5, v[92:95] offset:8064
    s_waitcnt lgkmcnt(4)
    buffer_store_dwordx4 v[200:203], v9, s[28:31], s44 offen sc1
    s_add_u32 s44, s44, s48
    v_dot2_f32_bf16 v12, v200, v16, v12
    v_dot2_f32_bf16 v12, v201, v16, v12
    v_dot2_f32_bf16 v12, v202, v16, v12
    v_dot2_f32_bf16 v12, v203, v16, v12
    buffer_store_dwordx4 v[204:207], v9, s[28:31], s45 offen sc1
    s_add_u32 s45, s45, s49
    v_dot2_f32_bf16 v13, v204, v16, v13
    v_dot2_f32_bf16 v13, v205, v16, v13
    v_dot2_f32_bf16 v13, v206, v16, v13
    v_dot2_f32_bf16 v13, v207, v16, v13
    buffer_store_dwordx4 v[208:211], v9, s[28:31], s46 offen sc1
    s_add_u32 s46, s46, s50
    v_dot2_f32_bf16 v14, v208, v16, v14
    v_dot2_f32_bf16 v14, v209, v16, v14
    v_dot2_f32_bf16 v14, v210, v16, v14
    v_dot2_f32_bf16 v14, v211, v16, v14
    buffer_store_dwordx4 v[212:215], v9, s[28:31], s47 offen sc1
    s_add_u32 s47, s47, s51
    v_dot2_f32_bf16 v15, v212, v16, v15
    v_dot2_f32_bf16 v15, v213, v16, v15
    v_dot2_f32_bf16 v15, v214, v16, v15
    v_dot2_f32_bf16 v15, v215, v16, v15
    s_waitcnt lgkmcnt(0)
    ds_read_b64_tr_b16 v[216:217], v8 offset:4608
    ds_read_b64_tr_b16 v[218:219], v8 offset:5184
    ds_read_b64_tr_b16 v[220:221], v8 offset:4640
    ds_read_b64_tr_b16 v[222:223], v8 offset:5216
    ds_read_b64_tr_b16 v[224:225], v8 offset:4672
    ds_read_b64_tr_b16 v[226:227], v8 offset:5248
    ds_read_b64_tr_b16 v[228:229], v8 offset:4704
    ds_read_b64_tr_b16 v[230:231], v8 offset:5280
    s_waitcnt vmcnt(32)
    ds_write_b128 v5, v[96:99] offset:0
    ds_write_b128 v5, v[100:103] offset:1152
    ds_write_b128 v5, v[104:107] offset:2304
    ds_write_b128 v5, v[108:111] offset:3456
    s_waitcnt lgkmcnt(4)
    buffer_store_dwordx4 v[216:219], v9, s[28:31], s44 offen sc1
    s_add_u32 s44, s44, s48
    v_dot2_f32_bf16 v12, v216, v16, v12
    v_dot2_f32_bf16 v12, v217, v16, v12
    v_dot2_f32_bf16 v12, v218, v16, v12
    v_dot2_f32_bf16 v12, v219, v16, v12
    buffer_store_dwordx4 v[220:223], v9, s[28:31], s45 offen sc1
    s_add_u32 s45, s45, s49
    v_dot2_f32_bf16 v13, v220, v16, v13
    v_dot2_f32_bf16 v13, v221, v16, v13
    v_dot2_f32_bf16 v13, v222, v16, v13
    v_dot2_f32_bf16 v13, v223, v16, v13
    buffer_store_dwordx4 v[224:227], v9, s[28:31], s46 offen sc1
    s_add_u32 s46, s46, s50
    v_dot2_f32_bf16 v14, v224, v16, v14
    v_dot2_f32_bf16 v14, v225, v16, v14
    v_dot2_f32_bf16 v14, v226, v16, v14
    v_dot2_f32_bf16 v14, v227, v16, v14
    buffer_store_dwordx4 v[228:231], v9, s[28:31], s47 offen sc1
    s_add_u32 s47, s47, s51
    v_dot2_f32_bf16 v15, v228, v16, v15
    v_dot2_f32_bf16 v15, v229, v16, v15
    v_dot2_f32_bf16 v15, v230, v16, v15
    v_dot2_f32_bf16 v15, v231, v16, v15
    s_waitcnt lgkmcnt(0)
    ds_read_b64_tr_b16 v[200:201], v8 offset:0
    ds_read_b64_tr_b16 v[202:203], v8 offset:576
    ds_read_b64_tr_b16 v[204:205], v8 offset:32
    ds_read_b64_tr_b16 v[206:207], v8 offset:608
    ds_read_b64_tr_b16 v[208:209], v8 offset:64
    ds_read_b64_tr_b16 v[210:211], v8 offset:640
    ds_read_b64_tr_b16 v[212:213], v8 offset:96
    ds_read_b64_tr_b16 v[214:215], v8 offset:672
    s_waitcnt vmcnt(32)
    ds_write_b128 v5, v[112:115] offset:4608
    ds_write_b128 v5, v[116:119] offset:5760
    ds_write_b128 v5, v[120:123] offset:6912
    ds_write_b128 v5, v[124:127] offset:8064
    s_waitcnt lgkmcnt(4)
    buffer_store_dwordx4 v[200:203], v9, s[28:31], s44 offen sc1
    s_add_u32 s44, s44, s48
    v_dot2_f32_bf16 v12, v200, v16, v12
    v_dot2_f32_bf16 v12, v201, v16, v12
    v_dot2_f32_bf16 v12, v202, v16, v12
    v_dot2_f32_bf16 v12, v203, v16, v12
    buffer_store_dwordx4 v[204:207], v9, s[28:31], s45 offen sc1
    s_add_u32 s45, s45, s49
    v_dot2_f32_bf16 v13, v204, v16, v13
    v_dot2_f32_bf16 v13, v205, v16, v13
    v_dot2_f32_bf16 v13, v206, v16, v13
    v_dot2_f32_bf16 v13, v207, v16, v13
    buffer_store_dwordx4 v[208:211], v9, s[28:31], s46 offen sc1
    s_add_u32 s46, s46, s50
    v_dot2_f32_bf16 v14, v208, v16, v14
    v_dot2_f32_bf16 v14, v209, v16, v14
    v_dot2_f32_bf16 v14, v210, v16, v14
    v_dot2_f32_bf16 v14, v211, v16, v14
    buffer_store_dwordx4 v[212:215], v9, s[28:31], s47 offen sc1
    s_add_u32 s47, s47, s51
    v_dot2_f32_bf16 v15, v212, v16, v15
    v_dot2_f32_bf16 v15, v213, v16, v15
    v_dot2_f32_bf16 v15, v214, v16, v15
    v_dot2_f32_bf16 v15, v215, v16, v15
    s_waitcnt lgkmcnt(0)
    ds_read_b64_tr_b16 v[216:217], v8 offset:4608
    ds_read_b64_tr_b16 v[218:219], v8 offset:5184
    ds_read_b64_tr_b16 v[220:221], v8 offset:4640
    ds_read_b64_tr_b16 v[222:223], v8 offset:5216
    ds_read_b64_tr_b16 v[224:225], v8 offset:4672
    ds_read_b64_tr_b16 v[226:227], v8 offset:5248
    ds_read_b64_tr_b16 v[228:229], v8 offset:4704
    ds_read_b64_tr_b16 v[230:231], v8 offset:5280
    s_waitcnt vmcnt(32)
    ds_write_b128 v5, v[128:131] offset:0
    ds_write_b128 v5, v[132:135] offset:1152
    ds_write_b128 v5, v[136:139] offset:2304
    ds_write_b128 v5, v[140:143] offset:3456
    s_waitcnt lgkmcnt(4)
    buffer_store_dwordx4 v[216:219], v9, s[28:31], s44 offen sc1
    s_add_u32 s44, s44, s48
    v_dot2_f32_bf16 v12, v216, v16, v12
    v_dot2_f32_bf16 v12, v217, v16, v12
    v_dot2_f32_bf16 v12, v218, v16, v12
    v_dot2_f32_bf16 v12, v219, v16, v12
    buffer_store_dwordx4 v[220:223], v9, s[28:31], s45 offen sc1
    s_add_u32 s45, s45, s49
    v_dot2_f32_bf16 v13, v220, v16, v13
    v_dot2_f32_bf16 v13, v221, v16, v13
    v_dot2_f32_bf16 v13, v222, v16, v13
    v_dot2_f32_bf16 v13, v223, v16, v13
    buffer_store_dwordx4 v[224:227], v9, s[28:31], s46 offen sc1
    s_add_u32 s46, s46, s50
    v_dot2_f32_bf16 v14, v224, v16, v14
    v_dot2_f32_bf16 v14, v225, v16, v14
    v_dot2_f32_bf16 v14, v226, v16, v14
    v_dot2_f32_bf16 v14, v227, v16, v14
    buffer_store_dwordx4 v[228:231], v9, s[28:31], s47 offen sc1
    s_add_u32 s47, s47, s51
    v_dot2_f32_bf16 v15, v228, v16, v15
    v_dot2_f32_bf16 v15, v229, v16, v15
    v_dot2_f32_bf16 v15, v230, v16, v15
    v_dot2_f32_bf16 v15, v231, v16, v15
    s_waitcnt lgkmcnt(0)
    ds_read_b64_tr_b16 v[200:201], v8 offset:0
    ds_read_b64_tr_b16 v[202:203], v8 offset:576
    ds_read_b64_tr_b16 v[204:205], v8 offset:32
    ds_read_b64_tr_b16 v[206:207], v8 offset:608
    ds_read_b64_tr_b16 v[208:209], v8 offset:64
    ds_read_b64_tr_b16 v[210:211], v8 offset:640
    ds_read_b64_tr_b16 v[212:213], v8 offset:96
    ds_read_b64_tr_b16 v[214:215], v8 offset:672
    s_waitcnt vmcnt(32)
    ds_write_b128 v5, v[144:147] offset:4608
    ds_write_b128 v5, v[148:151] offset:5760
    ds_write_b128 v5, v[152:155] offset:6912
    ds_write_b128 v5, v[156:159] offset:8064
    s_waitcnt lgkmcnt(4)
    buffer_store_dwordx4 v[200:203], v9, s[28:31], s44 offen sc1
    s_add_u32 s44, s44, s48
    v_dot2_f32_bf16 v12, v200, v16, v12
    v_dot2_f32_bf16 v12, v201, v16, v12
    v_dot2_f32_bf16 v12, v202, v16, v12
    v_dot2_f32_bf16 v12, v203, v16, v12
    buffer_store_dwordx4 v[204:207], v9, s[28:31], s45 offen sc1
    s_add_u32 s45, s45, s49
    v_dot2_f32_bf16 v13, v204, v16, v13
    v_dot2_f32_bf16 v13, v205, v16, v13
    v_dot2_f32_bf16 v13, v206, v16, v13
    v_dot2_f32_bf16 v13, v207, v16, v13
    buffer_store_dwordx4 v[208:211], v9, s[28:31], s46 offen sc1
    s_add_u32 s46, s46, s50
    v_dot2_f32_bf16 v14, v208, v16, v14
    v_dot2_f32_bf16 v14, v209, v16, v14
    v_dot2_f32_bf16 v14, v210, v16, v14
    v_dot2_f32_bf16 v14, v211, v16, v14
    buffer_store_dwordx4 v[212:215], v9, s[28:31], s47 offen sc1
    s_add_u32 s47, s47, s51
    v_dot2_f32_bf16 v15, v212, v16, v15
    v_dot2_f32_bf16 v15, v213, v16, v15
    v_dot2_f32_bf16 v15, v214, v16, v15
    v_dot2_f32_bf16 v15, v215, v16, v15
    s_waitcnt lgkmcnt(0)
    ds_read_b64_tr_b16 v[216:217], v8 offset:4608
    ds_read_b64_tr_b16 v[218:219], v8 offset:5184
    ds_read_b64_tr_b16 v[220:221], v8 offset:4640
    ds_read_b64_tr_b16 v[222:223], v8 offset:5216
    ds_read_b64_tr_b16 v[224:225], v8 offset:4672
    ds_read_b64_tr_b16 v[226:227], v8 offset:5248
    ds_read_b64_tr_b16 v[228:229], v8 offset:4704
    ds_read_b64_tr_b16 v[230:231], v8 offset:5280
    s_waitcnt vmcnt(32)
    ds_write_b128 v5, v[160:163] offset:0
    ds_write_b128 v5, v[164:167] offset:1152
    ds_write_b128 v5, v[168:171] offset:2304
    ds_write_b128 v5, v[172:175] offset:3456
    s_waitcnt lgkmcnt(4)
    buffer_store_dwordx4 v[216:219], v9, s[28:31], s44 offen sc1
    s_add_u32 s44, s44, s48
    v_dot2_f32_bf16 v12, v216, v16, v12
    v_dot2_f32_bf16 v12, v217, v16, v12
    v_dot2_f32_bf16 v12, v218, v16, v12
    v_dot2_f32_bf16 v12, v219, v16, v12
    buffer_store_dwordx4 v[220:223], v9, s[28:31], s45 offen sc1
    s_add_u32 s45, s45, s49
    v_dot2_f32_bf16 v13, v220, v16, v13
    v_dot2_f32_bf16 v13, v221, v16, v13
    v_dot2_f32_bf16 v13, v222, v16, v13
    v_dot2_f32_bf16 v13, v223, v16, v13
    buffer_store_dwordx4 v[224:227], v9, s[28:31], s46 offen sc1
    s_add_u32 s46, s46, s50
    v_dot2_f32_bf16 v14, v224, v16, v14
    v_dot2_f32_bf16 v14, v225, v16, v14
    v_dot2_f32_bf16 v14, v226, v16, v14
    v_dot2_f32_bf16 v14, v227, v16, v14
    buffer_store_dwordx4 v[228:231], v9, s[28:31], s47 offen sc1
    s_add_u32 s47, s47, s51
    v_dot2_f32_bf16 v15, v228, v16, v15
    v_dot2_f32_bf16 v15, v229, v16, v15
    v_dot2_f32_bf16 v15, v230, v16, v15
    v_dot2_f32_bf16 v15, v231, v16, v15
    s_waitcnt lgkmcnt(0)
    ds_read_b64_tr_b16 v[200:201], v8 offset:0
    ds_read_b64_tr_b16 v[202:203], v8 offset:576
    ds_read_b64_tr_b16 v[204:205], v8 offset:32
    ds_read_b64_tr_b16 v[206:207], v8 offset:608
    ds_read_b64_tr_b16 v[208:209], v8 offset:64
    ds_read_b64_tr_b16 v[210:211], v8 offset:640
    ds_read_b64_tr_b16 v[212:213], v8 offset:96
    ds_read_b64_tr_b16 v[214:215], v8 offset:672
    s_waitcnt vmcnt(32)
    ds_write_b128 v5, v[176:179] offset:4608
    ds_write_b128 v5, v[180:183] offset:5760
    ds_write_b128 v5, v[184:187] offset:6912
    ds_write_b128 v5, v[188:191] offset:8064
    s_waitcnt lgkmcnt(4)
    buffer_store_dwordx4 v[200:203], v9, s[28:31], s44 offen sc1
    s_add_u32 s44, s44, s48
    v_dot2_f32_bf16 v12, v200, v16, v12
    v_dot2_f32_bf16 v12, v201, v16, v12
    v_dot2_f32_bf16 v12, v202, v16, v12
    v_dot2_f32_bf16 v12, v203, v16, v12
    buffer_store_dwordx4 v[204:207], v9, s[28:31], s45 offen sc1
    s_add_u32 s45, s45, s49
    v_dot2_f32_bf16 v13, v204, v16, v13
    v_dot2_f32_bf16 v13, v205, v16, v13
    v_dot2_f32_bf16 v13, v206, v16, v13
    v_dot2_f32_bf16 v13, v207, v16, v13
    buffer_store_dwordx4 v[208:211], v9, s[28:31], s46 offen sc1
    s_add_u32 s46, s46, s50
    v_dot2_f32_bf16 v14, v208, v16, v14
    v_dot2_f32_bf16 v14, v209, v16, v14
    v_dot2_f32_bf16 v14, v210, v16, v14
    v_dot2_f32_bf16 v14, v211, v16, v14
    buffer_store_dwordx4 v[212:215], v9, s[28:31], s47 offen sc1
    s_add_u32 s47, s47, s51
    v_dot2_f32_bf16 v15, v212, v16, v15
    v_dot2_f32_bf16 v15, v213, v16, v15
    v_dot2_f32_bf16 v15, v214, v16, v15
    v_dot2_f32_bf16 v15, v215, v16, v15
    s_waitcnt lgkmcnt(0)
    ds_read_b64_tr_b16 v[216:217], v8 offset:4608
    ds_read_b64_tr_b16 v[218:219], v8 offset:5184
    ds_read_b64_tr_b16 v[220:221], v8 offset:4640
    ds_read_b64_tr_b16 v[222:223], v8 offset:5216
    ds_read_b64_tr_b16 v[224:225], v8 offset:4672
    ds_read_b64_tr_b16 v[226:227], v8 offset:5248
    ds_read_b64_tr_b16 v[228:229], v8 offset:4704
    ds_read_b64_tr_b16 v[230:231], v8 offset:5280
    s_waitcnt lgkmcnt(0)
    buffer_store_dwordx4 v[216:219], v9, s[28:31], s44 offen sc1
    s_add_u32 s44, s44, s48
    v_dot2_f32_bf16 v12, v216, v16, v12
    v_dot2_f32_bf16 v12, v217, v16, v12
    v_dot2_f32_bf16 v12, v218, v16, v12
    v_dot2_f32_bf16 v12, v219, v16, v12
    buffer_store_dwordx4 v[220:223], v9, s[28:31], s45 offen sc1
    s_add_u32 s45, s45, s49
    v_dot2_f32_bf16 v13, v220, v16, v13
    v_dot2_f32_bf16 v13, v221, v16, v13
    v_dot2_f32_bf16 v13, v222, v16, v13
    v_dot2_f32_bf16 v13, v223, v16, v13
    buffer_store_dwordx4 v[224:227], v9, s[28:31], s46 offen sc1
    s_add_u32 s46, s46, s50
    v_dot2_f32_bf16 v14, v224, v16, v14
    v_dot2_f32_bf16 v14, v225, v16, v14
    v_dot2_f32_bf16 v14, v226, v16, v14
    v_dot2_f32_bf16 v14, v227, v16, v14
    buffer_store_dwordx4 v[228:231], v9, s[28:31], s47 offen sc1
    s_add_u32 s47, s47, s51
    v_dot2_f32_bf16 v15, v228, v16, v15
    v_dot2_f32_bf16 v15, v229, v16, v15
    v_dot2_f32_bf16 v15, v230, v16, v15
    v_dot2_f32_bf16 v15, v231, v16, v15
    s_nop 2
    v_mov_b32 v20, v12
    v_mov_b32 v21, v13
    v_mov_b32 v22, v14
    v_mov_b32 v23, v15
    s_nop 1
    v_permlane32_swap_b32 v20, v12
    v_permlane32_swap_b32 v21, v13
    v_permlane32_swap_b32 v22, v14
    v_permlane32_swap_b32 v23, v15
    s_nop 1
    v_add_f32 v12, v12, v20
    v_add_f32 v13, v13, v21
    v_add_f32 v14, v14, v22
    v_add_f32 v15, v15, v23
    v_mov_b32 v20, v12
    v_mov_b32 v21, v13
    v_mov_b32 v22, v14
    v_mov_b32 v23, v15
    s_nop 1
    v_permlane16_swap_b32 v20, v12
    v_permlane16_swap_b32 v21, v13
    v_permlane16_swap_b32 v22, v14
    v_permlane16_swap_b32 v23, v15
    s_nop 1
    v_add_f32 v12, v12, v20
    v_add_f32 v13, v13, v21
    v_add_f32 v14, v14, v22
    v_add_f32 v15, v15, v23
    s_mul_i32 s38, s33, 7168
    s_lshl_b32 s39, s35, 8
    s_add_u32 s38, s38, s39
    s_add_u32 s38, s38, 8146944
    v_lshlrev_b32 v17, 2, v1
    s_mov_b64 exec, 0xffff
    buffer_store_dword v12, v17, s[28:31], s38 offen offset:0 sc1
    buffer_store_dword v13, v17, s[28:31], s38 offen offset:64 sc1
    buffer_store_dword v14, v17, s[28:31], s38 offen offset:128 sc1
    buffer_store_dword v15, v17, s[28:31], s38 offen offset:192 sc1
    s_endpgm
prep_kernel_pk30:
    s_mov_b32 s24, s14
    s_mov_b32 s25, s15
    s_mov_b32 s26, 819200
    s_mov_b32 s27, 0x00020000
    s_sub_u32 s32, s21, 20
    s_mul_i32 s33, s32, 52429
    s_lshr_b32 s33, s33, 19
    s_mul_i32 s35, s33, 10
    s_sub_u32 s35, s32, s35
    v_mul_u32_u24 v10, 1280, v3
    v_lshl_add_u32 v10, v4, 4, v10
    s_mul_i32 s36, s33, 409600
    s_lshl_b32 s37, s35, 7
    s_add_u32 s36, s36, s37
    buffer_load_dwordx4 v[32:35], v10, s[24:27], s36 offen nt
    s_add_u32 s36, s36, 10240
    buffer_load_dwordx4 v[36:39], v10, s[24:27], s36 offen nt
    s_add_u32 s36, s36, 10240
    buffer_load_dwordx4 v[40:43], v10, s[24:27], s36 offen nt
    s_add_u32 s36, s36, 10240
    buffer_load_dwordx4 v[44:47], v10, s[24:27], s36 offen nt
    s_add_u32 s36, s36, 10240
    buffer_load_dwordx4 v[48:51], v10, s[24:27], s36 offen nt
    s_add_u32 s36, s36, 10240
    buffer_load_dwordx4 v[52:55], v10, s[24:27], s36 offen nt
    s_add_u32 s36, s36, 10240
    buffer_load_dwordx4 v[56:59], v10, s[24:27], s36 offen nt
    s_add_u32 s36, s36, 10240
    buffer_load_dwordx4 v[60:63], v10, s[24:27], s36 offen nt
    s_add_u32 s36, s36, 10240
    buffer_load_dwordx4 v[64:67], v10, s[24:27], s36 offen nt
    s_add_u32 s36, s36, 10240
    buffer_load_dwordx4 v[68:71], v10, s[24:27], s36 offen nt
    s_add_u32 s36, s36, 10240
    buffer_load_dwordx4 v[72:75], v10, s[24:27], s36 offen nt
    s_add_u32 s36, s36, 10240
    buffer_load_dwordx4 v[76:79], v10, s[24:27], s36 offen nt
    s_add_u32 s36, s36, 10240
    buffer_load_dwordx4 v[80:83], v10, s[24:27], s36 offen nt
    s_add_u32 s36, s36, 10240
    buffer_load_dwordx4 v[84:87], v10, s[24:27], s36 offen nt
    s_add_u32 s36, s36, 10240
    buffer_load_dwordx4 v[88:91], v10, s[24:27], s36 offen nt
    s_add_u32 s36, s36, 10240
    buffer_load_dwordx4 v[92:95], v10, s[24:27], s36 offen nt
    s_add_u32 s36, s36, 10240
    buffer_load_dwordx4 v[96:99], v10, s[24:27], s36 offen nt
    s_add_u32 s36, s36, 10240
    buffer_load_dwordx4 v[100:103], v10, s[24:27], s36 offen nt
    s_add_u32 s36, s36, 10240
    buffer_load_dwordx4 v[104:107], v10, s[24:27], s36 offen nt
    s_add_u32 s36, s36, 10240
    buffer_load_dwordx4 v[108:111], v10, s[24:27], s36 offen nt
    s_add_u32 s36, s36, 10240
    buffer_load_dwordx4 v[112:115], v10, s[24:27], s36 offen nt
    s_add_u32 s36, s36, 10240
    buffer_load_dwordx4 v[116:119], v10, s[24:27], s36 offen nt
    s_add_u32 s36, s36, 10240
    buffer_load_dwordx4 v[120:123], v10, s[24:27], s36 offen nt
    s_add_u32 s36, s36, 10240
    buffer_load_dwordx4 v[124:127], v10, s[24:27], s36 offen nt
    s_add_u32 s36, s36, 10240
    buffer_load_dwordx4 v[128:131], v10, s[24:27], s36 offen nt
    s_add_u32 s36, s36, 10240
    buffer_load_dwordx4 v[132:135], v10, s[24:27], s36 offen nt
    s_add_u32 s36, s36, 10240
    buffer_load_dwordx4 v[136:139], v10, s[24:27], s36 offen nt
    s_add_u32 s36, s36, 10240
    buffer_load_dwordx4 v[140:143], v10, s[24:27], s36 offen nt
    s_add_u32 s36, s36, 10240
    buffer_load_dwordx4 v[144:147], v10, s[24:27], s36 offen nt
    s_add_u32 s36, s36, 10240
    buffer_load_dwordx4 v[148:151], v10, s[24:27], s36 offen nt
    s_add_u32 s36, s36, 10240
    buffer_load_dwordx4 v[152:155], v10, s[24:27], s36 offen nt
    s_add_u32 s36, s36, 10240
    buffer_load_dwordx4 v[156:159], v10, s[24:27], s36 offen nt
    s_add_u32 s36, s36, 10240
    buffer_load_dwordx4 v[160:163], v10, s[24:27], s36 offen nt
    s_add_u32 s36, s36, 10240
    buffer_load_dwordx4 v[164:167], v10, s[24:27], s36 offen nt
    s_add_u32 s36, s36, 10240
    buffer_load_dwordx4 v[168:171], v10, s[24:27], s36 offen nt
    s_add_u32 s36, s36, 10240
    buffer_load_dwordx4 v[172:175], v10, s[24:27], s36 offen nt
    s_add_u32 s36, s36, 10240
    buffer_load_dwordx4 v[176:179], v10, s[24:27], s36 offen nt
    s_add_u32 s36, s36, 10240
    buffer_load_dwordx4 v[180:183], v10, s[24:27], s36 offen nt
    s_add_u32 s36, s36, 10240
    buffer_load_dwordx4 v[184:187], v10, s[24:27], s36 offen nt
    s_add_u32 s36, s36, 10240
    buffer_load_dwordx4 v[188:191], v10, s[24:27], s36 offen nt
    s_lshl_b32 s36, s35, 2
    s_add_u32 s36, s36, 0
    s_mul_i32 s38, s36, 6554
    s_lshr_b32 s38, s38, 16
    s_mul_i32 s39, s38, 10
    s_sub_u32 s39, s36, s39
    s_cmp_ge_u32 s39, 5
    s_cselect_b32 s40, 1, 0
    s_sub_u32 s41, s39, 6
    s_cmp_eq_u32 s39, 5
    s_cselect_b32 s41, 4, s41
    s_cmp_eq_u32 s40, 1
    s_cselect_b32 s39, s41, s39
    s_mul_i32 s37, s38, 200
    s_mul_i32 s40, s40, 100
    s_add_u32 s37, s37, s40
    s_mul_i32 s40, s33, 50
    s_add_u32 s37, s37, s40
    s_add_u32 s37, s37, s39
    s_lshl_b32 s37, s37, 10
    s_add_u32 s44, s37, 24055808
    s_movk_i32 s48, 5120
    s_lshl_b32 s36, s35, 2
    s_add_u32 s36, s36, 1
    s_mul_i32 s38, s36, 6554
    s_lshr_b32 s38, s38, 16
    s_mul_i32 s39, s38, 10
    s_sub_u32 s39, s36, s39
    s_cmp_ge_u32 s39, 5
    s_cselect_b32 s40, 1, 0
    s_sub_u32 s41, s39, 6
    s_cmp_eq_u32 s39, 5
    s_cselect_b32 s41, 4, s41
    s_cmp_eq_u32 s40, 1
    s_cselect_b32 s39, s41, s39
    s_mul_i32 s37, s38, 200
    s_mul_i32 s40, s40, 100
    s_add_u32 s37, s37, s40
    s_mul_i32 s40, s33, 50
    s_add_u32 s37, s37, s40
    s_add_u32 s37, s37, s39
    s_lshl_b32 s37, s37, 10
    s_add_u32 s45, s37, 24055808
    s_movk_i32 s49, 5120
    s_lshl_b32 s36, s35, 2
    s_add_u32 s36, s36, 2
    s_mul_i32 s38, s36, 6554
    s_lshr_b32 s38, s38, 16
    s_mul_i32 s39, s38, 10
    s_sub_u32 s39, s36, s39
    s_cmp_ge_u32 s39, 5
    s_cselect_b32 s40, 1, 0
    s_sub_u32 s41, s39, 6
    s_cmp_eq_u32 s39, 5
    s_cselect_b32 s41, 4, s41
    s_cmp_eq_u32 s40, 1
    s_cselect_b32 s39, s41, s39
    s_mul_i32 s37, s38, 200
    s_mul_i32 s40, s40, 100
    s_add_u32 s37, s37, s40
    s_mul_i32 s40, s33, 50
    s_add_u32 s37, s37, s40
    s_add_u32 s37, s37, s39
    s_lshl_b32 s37, s37, 10
    s_add_u32 s46, s37, 24055808
    s_movk_i32 s50, 5120
    s_lshl_b32 s36, s35, 2
    s_add_u32 s36, s36, 3
    s_mul_i32 s38, s36, 6554
    s_lshr_b32 s38, s38, 16
    s_mul_i32 s39, s38, 10
    s_sub_u32 s39, s36, s39
    s_cmp_ge_u32 s39, 5
    s_cselect_b32 s40, 1, 0
    s_sub_u32 s41, s39, 6
    s_cmp_eq_u32 s39, 5
    s_cselect_b32 s41, 4, s41
    s_cmp_eq_u32 s40, 1
    s_cselect_b32 s39, s41, s39
    s_mul_i32 s37, s38, 200
    s_mul_i32 s40, s40, 100
    s_add_u32 s37, s37, s40
    s_mul_i32 s40, s33, 50
    s_add_u32 s37, s37, s40
    s_add_u32 s37, s37, s39
    s_lshl_b32 s37, s37, 10
    s_add_u32 s47, s37, 24055808
    s_movk_i32 s51, 5120
    s_waitcnt vmcnt(36)
    ds_write_b128 v5, v[32:35] offset:0
    ds_write_b128 v5, v[36:39] offset:1152
    ds_write_b128 v5, v[40:43] offset:2304
    ds_write_b128 v5, v[44:47] offset:3456
    s_waitcnt lgkmcnt(0)
    ds_read_b64_tr_b16 v[200:201], v8 offset:0
    ds_read_b64_tr_b16 v[202:203], v8 offset:576
    ds_read_b64_tr_b16 v[204:205], v8 offset:32
    ds_read_b64_tr_b16 v[206:207], v8 offset:608
    ds_read_b64_tr_b16 v[208:209], v8 offset:64
    ds_read_b64_tr_b16 v[210:211], v8 offset:640
    ds_read_b64_tr_b16 v[212:213], v8 offset:96
    ds_read_b64_tr_b16 v[214:215], v8 offset:672
    s_waitcnt vmcnt(32)
    ds_write_b128 v5, v[48:51] offset:4608
    ds_write_b128 v5, v[52:55] offset:5760
    ds_write_b128 v5, v[56:59] offset:6912
    ds_write_b128 v5, v[60:63] offset:8064
    s_waitcnt lgkmcnt(4)
    buffer_store_dwordx4 v[200:203], v9, s[28:31], s44 offen sc1
    s_add_u32 s44, s44, s48
    buffer_store_dwordx4 v[204:207], v9, s[28:31], s45 offen sc1
    s_add_u32 s45, s45, s49
    buffer_store_dwordx4 v[208:211], v9, s[28:31], s46 offen sc1
    s_add_u32 s46, s46, s50
    buffer_store_dwordx4 v[212:215], v9, s[28:31], s47 offen sc1
    s_add_u32 s47, s47, s51
    s_waitcnt lgkmcnt(0)
    ds_read_b64_tr_b16 v[216:217], v8 offset:4608
    ds_read_b64_tr_b16 v[218:219], v8 offset:5184
    ds_read_b64_tr_b16 v[220:221], v8 offset:4640
    ds_read_b64_tr_b16 v[222:223], v8 offset:5216
    ds_read_b64_tr_b16 v[224:225], v8 offset:4672
    ds_read_b64_tr_b16 v[226:227], v8 offset:5248
    ds_read_b64_tr_b16 v[228:229], v8 offset:4704
    ds_read_b64_tr_b16 v[230:231], v8 offset:5280
    s_waitcnt vmcnt(32)
    ds_write_b128 v5, v[64:67] offset:0
    ds_write_b128 v5, v[68:71] offset:1152
    ds_write_b128 v5, v[72:75] offset:2304
    ds_write_b128 v5, v[76:79] offset:3456
    s_waitcnt lgkmcnt(4)
    buffer_store_dwordx4 v[216:219], v9, s[28:31], s44 offen sc1
    s_add_u32 s44, s44, s48
    buffer_store_dwordx4 v[220:223], v9, s[28:31], s45 offen sc1
    s_add_u32 s45, s45, s49
    buffer_store_dwordx4 v[224:227], v9, s[28:31], s46 offen sc1
    s_add_u32 s46, s46, s50
    buffer_store_dwordx4 v[228:231], v9, s[28:31], s47 offen sc1
    s_add_u32 s47, s47, s51
    s_waitcnt lgkmcnt(0)
    ds_read_b64_tr_b16 v[200:201], v8 offset:0
    ds_read_b64_tr_b16 v[202:203], v8 offset:576
    ds_read_b64_tr_b16 v[204:205], v8 offset:32
    ds_read_b64_tr_b16 v[206:207], v8 offset:608
    ds_read_b64_tr_b16 v[208:209], v8 offset:64
    ds_read_b64_tr_b16 v[210:211], v8 offset:640
    ds_read_b64_tr_b16 v[212:213], v8 offset:96
    ds_read_b64_tr_b16 v[214:215], v8 offset:672
    s_waitcnt vmcnt(32)
    ds_write_b128 v5, v[80:83] offset:4608
    ds_write_b128 v5, v[84:87] offset:5760
    ds_write_b128 v5, v[88:91] offset:6912
    ds_write_b128 v5, v[92:95] offset:8064
    s_waitcnt lgkmcnt(4)
    buffer_store_dwordx4 v[200:203], v9, s[28:31], s44 offen sc1
    s_add_u32 s44, s44, s48
    buffer_store_dwordx4 v[204:207], v9, s[28:31], s45 offen sc1
    s_add_u32 s45, s45, s49
    buffer_store_dwordx4 v[208:211], v9, s[28:31], s46 offen sc1
    s_add_u32 s46, s46, s50
    buffer_store_dwordx4 v[212:215], v9, s[28:31], s47 offen sc1
    s_add_u32 s47, s47, s51
    s_waitcnt lgkmcnt(0)
    ds_read_b64_tr_b16 v[216:217], v8 offset:4608
    ds_read_b64_tr_b16 v[218:219], v8 offset:5184
    ds_read_b64_tr_b16 v[220:221], v8 offset:4640
    ds_read_b64_tr_b16 v[222:223], v8 offset:5216
    ds_read_b64_tr_b16 v[224:225], v8 offset:4672
    ds_read_b64_tr_b16 v[226:227], v8 offset:5248
    ds_read_b64_tr_b16 v[228:229], v8 offset:4704
    ds_read_b64_tr_b16 v[230:231], v8 offset:5280
    s_waitcnt vmcnt(32)
    ds_write_b128 v5, v[96:99] offset:0
    ds_write_b128 v5, v[100:103] offset:1152
    ds_write_b128 v5, v[104:107] offset:2304
    ds_write_b128 v5, v[108:111] offset:3456
    s_waitcnt lgkmcnt(4)
    buffer_store_dwordx4 v[216:219], v9, s[28:31], s44 offen sc1
    s_add_u32 s44, s44, s48
    buffer_store_dwordx4 v[220:223], v9, s[28:31], s45 offen sc1
    s_add_u32 s45, s45, s49
    buffer_store_dwordx4 v[224:227], v9, s[28:31], s46 offen sc1
    s_add_u32 s46, s46, s50
    buffer_store_dwordx4 v[228:231], v9, s[28:31], s47 offen sc1
    s_add_u32 s47, s47, s51
    s_waitcnt lgkmcnt(0)
    ds_read_b64_tr_b16 v[200:201], v8 offset:0
    ds_read_b64_tr_b16 v[202:203], v8 offset:576
    ds_read_b64_tr_b16 v[204:205], v8 offset:32
    ds_read_b64_tr_b16 v[206:207], v8 offset:608
    ds_read_b64_tr_b16 v[208:209], v8 offset:64
    ds_read_b64_tr_b16 v[210:211], v8 offset:640
    ds_read_b64_tr_b16 v[212:213], v8 offset:96
    ds_read_b64_tr_b16 v[214:215], v8 offset:672
    s_waitcnt vmcnt(32)
    ds_write_b128 v5, v[112:115] offset:4608
    ds_write_b128 v5, v[116:119] offset:5760
    ds_write_b128 v5, v[120:123] offset:6912
    ds_write_b128 v5, v[124:127] offset:8064
    s_waitcnt lgkmcnt(4)
    buffer_store_dwordx4 v[200:203], v9, s[28:31], s44 offen sc1
    s_add_u32 s44, s44, s48
    buffer_store_dwordx4 v[204:207], v9, s[28:31], s45 offen sc1
    s_add_u32 s45, s45, s49
    buffer_store_dwordx4 v[208:211], v9, s[28:31], s46 offen sc1
    s_add_u32 s46, s46, s50
    buffer_store_dwordx4 v[212:215], v9, s[28:31], s47 offen sc1
    s_add_u32 s47, s47, s51
    s_waitcnt lgkmcnt(0)
    ds_read_b64_tr_b16 v[216:217], v8 offset:4608
    ds_read_b64_tr_b16 v[218:219], v8 offset:5184
    ds_read_b64_tr_b16 v[220:221], v8 offset:4640
    ds_read_b64_tr_b16 v[222:223], v8 offset:5216
    ds_read_b64_tr_b16 v[224:225], v8 offset:4672
    ds_read_b64_tr_b16 v[226:227], v8 offset:5248
    ds_read_b64_tr_b16 v[228:229], v8 offset:4704
    ds_read_b64_tr_b16 v[230:231], v8 offset:5280
    s_waitcnt vmcnt(32)
    ds_write_b128 v5, v[128:131] offset:0
    ds_write_b128 v5, v[132:135] offset:1152
    ds_write_b128 v5, v[136:139] offset:2304
    ds_write_b128 v5, v[140:143] offset:3456
    s_waitcnt lgkmcnt(4)
    buffer_store_dwordx4 v[216:219], v9, s[28:31], s44 offen sc1
    s_add_u32 s44, s44, s48
    buffer_store_dwordx4 v[220:223], v9, s[28:31], s45 offen sc1
    s_add_u32 s45, s45, s49
    buffer_store_dwordx4 v[224:227], v9, s[28:31], s46 offen sc1
    s_add_u32 s46, s46, s50
    buffer_store_dwordx4 v[228:231], v9, s[28:31], s47 offen sc1
    s_add_u32 s47, s47, s51
    s_waitcnt lgkmcnt(0)
    ds_read_b64_tr_b16 v[200:201], v8 offset:0
    ds_read_b64_tr_b16 v[202:203], v8 offset:576
    ds_read_b64_tr_b16 v[204:205], v8 offset:32
    ds_read_b64_tr_b16 v[206:207], v8 offset:608
    ds_read_b64_tr_b16 v[208:209], v8 offset:64
    ds_read_b64_tr_b16 v[210:211], v8 offset:640
    ds_read_b64_tr_b16 v[212:213], v8 offset:96
    ds_read_b64_tr_b16 v[214:215], v8 offset:672
    s_waitcnt vmcnt(32)
    ds_write_b128 v5, v[144:147] offset:4608
    ds_write_b128 v5, v[148:151] offset:5760
    ds_write_b128 v5, v[152:155] offset:6912
    ds_write_b128 v5, v[156:159] offset:8064
    s_waitcnt lgkmcnt(4)
    buffer_store_dwordx4 v[200:203], v9, s[28:31], s44 offen sc1
    s_add_u32 s44, s44, s48
    buffer_store_dwordx4 v[204:207], v9, s[28:31], s45 offen sc1
    s_add_u32 s45, s45, s49
    buffer_store_dwordx4 v[208:211], v9, s[28:31], s46 offen sc1
    s_add_u32 s46, s46, s50
    buffer_store_dwordx4 v[212:215], v9, s[28:31], s47 offen sc1
    s_add_u32 s47, s47, s51
    s_waitcnt lgkmcnt(0)
    ds_read_b64_tr_b16 v[216:217], v8 offset:4608
    ds_read_b64_tr_b16 v[218:219], v8 offset:5184
    ds_read_b64_tr_b16 v[220:221], v8 offset:4640
    ds_read_b64_tr_b16 v[222:223], v8 offset:5216
    ds_read_b64_tr_b16 v[224:225], v8 offset:4672
    ds_read_b64_tr_b16 v[226:227], v8 offset:5248
    ds_read_b64_tr_b16 v[228:229], v8 offset:4704
    ds_read_b64_tr_b16 v[230:231], v8 offset:5280
    s_waitcnt vmcnt(32)
    ds_write_b128 v5, v[160:163] offset:0
    ds_write_b128 v5, v[164:167] offset:1152
    ds_write_b128 v5, v[168:171] offset:2304
    ds_write_b128 v5, v[172:175] offset:3456
    s_waitcnt lgkmcnt(4)
    buffer_store_dwordx4 v[216:219], v9, s[28:31], s44 offen sc1
    s_add_u32 s44, s44, s48
    buffer_store_dwordx4 v[220:223], v9, s[28:31], s45 offen sc1
    s_add_u32 s45, s45, s49
    buffer_store_dwordx4 v[224:227], v9, s[28:31], s46 offen sc1
    s_add_u32 s46, s46, s50
    buffer_store_dwordx4 v[228:231], v9, s[28:31], s47 offen sc1
    s_add_u32 s47, s47, s51
    s_waitcnt lgkmcnt(0)
    ds_read_b64_tr_b16 v[200:201], v8 offset:0
    ds_read_b64_tr_b16 v[202:203], v8 offset:576
    ds_read_b64_tr_b16 v[204:205], v8 offset:32
    ds_read_b64_tr_b16 v[206:207], v8 offset:608
    ds_read_b64_tr_b16 v[208:209], v8 offset:64
    ds_read_b64_tr_b16 v[210:211], v8 offset:640
    ds_read_b64_tr_b16 v[212:213], v8 offset:96
    ds_read_b64_tr_b16 v[214:215], v8 offset:672
    s_waitcnt vmcnt(32)
    ds_write_b128 v5, v[176:179] offset:4608
    ds_write_b128 v5, v[180:183] offset:5760
    ds_write_b128 v5, v[184:187] offset:6912
    ds_write_b128 v5, v[188:191] offset:8064
    s_waitcnt lgkmcnt(4)
    buffer_store_dwordx4 v[200:203], v9, s[28:31], s44 offen sc1
    s_add_u32 s44, s44, s48
    buffer_store_dwordx4 v[204:207], v9, s[28:31], s45 offen sc1
    s_add_u32 s45, s45, s49
    buffer_store_dwordx4 v[208:211], v9, s[28:31], s46 offen sc1
    s_add_u32 s46, s46, s50
    buffer_store_dwordx4 v[212:215], v9, s[28:31], s47 offen sc1
    s_add_u32 s47, s47, s51
    s_waitcnt lgkmcnt(0)
    ds_read_b64_tr_b16 v[216:217], v8 offset:4608
    ds_read_b64_tr_b16 v[218:219], v8 offset:5184
    ds_read_b64_tr_b16 v[220:221], v8 offset:4640
    ds_read_b64_tr_b16 v[222:223], v8 offset:5216
    ds_read_b64_tr_b16 v[224:225], v8 offset:4672
    ds_read_b64_tr_b16 v[226:227], v8 offset:5248
    ds_read_b64_tr_b16 v[228:229], v8 offset:4704
    ds_read_b64_tr_b16 v[230:231], v8 offset:5280
    s_waitcnt lgkmcnt(0)
    buffer_store_dwordx4 v[216:219], v9, s[28:31], s44 offen sc1
    s_add_u32 s44, s44, s48
    buffer_store_dwordx4 v[220:223], v9, s[28:31], s45 offen sc1
    s_add_u32 s45, s45, s49
    buffer_store_dwordx4 v[224:227], v9, s[28:31], s46 offen sc1
    s_add_u32 s46, s46, s50
    buffer_store_dwordx4 v[228:231], v9, s[28:31], s47 offen sc1
    s_add_u32 s47, s47, s51
    s_endpgm
prep_kernel_pk31:
    s_mov_b32 s24, s16
    s_mov_b32 s25, s17
    s_mov_b32 s26, 2211840
    s_mov_b32 s27, 0x00020000
    s_sub_u32 s32, s21, 40
    s_mul_i32 s33, s32, 2428
    s_lshr_b32 s33, s33, 16
    s_mul_i32 s35, s33, 27
    s_sub_u32 s35, s32, s35
    v_mul_u32_u24 v10, 3456, v3
    v_lshl_add_u32 v10, v4, 4, v10
    s_mul_i32 s36, s33, 1105920
    s_lshl_b32 s37, s35, 7
    s_add_u32 s36, s36, s37
    buffer_load_dwordx4 v[32:35], v10, s[24:27], s36 offen nt
    s_add_u32 s36, s36, 27648
    buffer_load_dwordx4 v[36:39], v10, s[24:27], s36 offen nt
    s_add_u32 s36, s36, 27648
    buffer_load_dwordx4 v[40:43], v10, s[24:27], s36 offen nt
    s_add_u32 s36, s36, 27648
    buffer_load_dwordx4 v[44:47], v10, s[24:27], s36 offen nt
    s_add_u32 s36, s36, 27648
    buffer_load_dwordx4 v[48:51], v10, s[24:27], s36 offen nt
    s_add_u32 s36, s36, 27648
    buffer_load_dwordx4 v[52:55], v10, s[24:27], s36 offen nt
    s_add_u32 s36, s36, 27648
    buffer_load_dwordx4 v[56:59], v10, s[24:27], s36 offen nt
    s_add_u32 s36, s36, 27648
    buffer_load_dwordx4 v[60:63], v10, s[24:27], s36 offen nt
    s_add_u32 s36, s36, 27648
    buffer_load_dwordx4 v[64:67], v10, s[24:27], s36 offen nt
    s_add_u32 s36, s36, 27648
    buffer_load_dwordx4 v[68:71], v10, s[24:27], s36 offen nt
    s_add_u32 s36, s36, 27648
    buffer_load_dwordx4 v[72:75], v10, s[24:27], s36 offen nt
    s_add_u32 s36, s36, 27648
    buffer_load_dwordx4 v[76:79], v10, s[24:27], s36 offen nt
    s_add_u32 s36, s36, 27648
    buffer_load_dwordx4 v[80:83], v10, s[24:27], s36 offen nt
    s_add_u32 s36, s36, 27648
    buffer_load_dwordx4 v[84:87], v10, s[24:27], s36 offen nt
    s_add_u32 s36, s36, 27648
    buffer_load_dwordx4 v[88:91], v10, s[24:27], s36 offen nt
    s_add_u32 s36, s36, 27648
    buffer_load_dwordx4 v[92:95], v10, s[24:27], s36 offen nt
    s_add_u32 s36, s36, 27648
    buffer_load_dwordx4 v[96:99], v10, s[24:27], s36 offen nt
    s_add_u32 s36, s36, 27648
    buffer_load_dwordx4 v[100:103], v10, s[24:27], s36 offen nt
    s_add_u32 s36, s36, 27648
    buffer_load_dwordx4 v[104:107], v10, s[24:27], s36 offen nt
    s_add_u32 s36, s36, 27648
    buffer_load_dwordx4 v[108:111], v10, s[24:27], s36 offen nt
    s_add_u32 s36, s36, 27648
    buffer_load_dwordx4 v[112:115], v10, s[24:27], s36 offen nt
    s_add_u32 s36, s36, 27648
    buffer_load_dwordx4 v[116:119], v10, s[24:27], s36 offen nt
    s_add_u32 s36, s36, 27648
    buffer_load_dwordx4 v[120:123], v10, s[24:27], s36 offen nt
    s_add_u32 s36, s36, 27648
    buffer_load_dwordx4 v[124:127], v10, s[24:27], s36 offen nt
    s_add_u32 s36, s36, 27648
    buffer_load_dwordx4 v[128:131], v10, s[24:27], s36 offen nt
    s_add_u32 s36, s36, 27648
    buffer_load_dwordx4 v[132:135], v10, s[24:27], s36 offen nt
    s_add_u32 s36, s36, 27648
    buffer_load_dwordx4 v[136:139], v10, s[24:27], s36 offen nt
    s_add_u32 s36, s36, 27648
    buffer_load_dwordx4 v[140:143], v10, s[24:27], s36 offen nt
    s_add_u32 s36, s36, 27648
    buffer_load_dwordx4 v[144:147], v10, s[24:27], s36 offen nt
    s_add_u32 s36, s36, 27648
    buffer_load_dwordx4 v[148:151], v10, s[24:27], s36 offen nt
    s_add_u32 s36, s36, 27648
    buffer_load_dwordx4 v[152:155], v10, s[24:27], s36 offen nt
    s_add_u32 s36, s36, 27648
    buffer_load_dwordx4 v[156:159], v10, s[24:27], s36 offen nt
    s_add_u32 s36, s36, 27648
    buffer_load_dwordx4 v[160:163], v10, s[24:27], s36 offen nt
    s_add_u32 s36, s36, 27648
    buffer_load_dwordx4 v[164:167], v10, s[24:27], s36 offen nt
    s_add_u32 s36, s36, 27648
    buffer_load_dwordx4 v[168:171], v10, s[24:27], s36 offen nt
    s_add_u32 s36, s36, 27648
    buffer_load_dwordx4 v[172:175], v10, s[24:27], s36 offen nt
    s_add_u32 s36, s36, 27648
    buffer_load_dwordx4 v[176:179], v10, s[24:27], s36 offen nt
    s_add_u32 s36, s36, 27648
    buffer_load_dwordx4 v[180:183], v10, s[24:27], s36 offen nt
    s_add_u32 s36, s36, 27648
    buffer_load_dwordx4 v[184:187], v10, s[24:27], s36 offen nt
    s_add_u32 s36, s36, 27648
    buffer_load_dwordx4 v[188:191], v10, s[24:27], s36 offen nt
    s_lshl_b32 s36, s35, 2
    s_add_u32 s36, s36, 0
    s_mul_i32 s38, s36, 9363
    s_lshr_b32 s38, s38, 16
    s_mul_i32 s39, s38, 7
    s_sub_u32 s39, s36, s39
    s_sub_u32 s41, s39, 1
    s_cmp_eq_u32 s39, 0
    s_cselect_b32 s41, 6, s41
    s_and_b32 s40, s38, 1
    s_cmp_eq_u32 s40, 1
    s_cselect_b32 s39, s41, s39
    s_mov_b32 s41, 4
    s_mov_b32 s40, s39
    s_cmp_ge_u32 s39, 4
    s_cselect_b32 s41, 2, s41
    s_add_u32 s42, s39, 76
    s_cmp_ge_u32 s39, 4
    s_cselect_b32 s40, s42, s40
    s_cmp_eq_u32 s39, 6
    s_cselect_b32 s41, 1, s41
    s_cselect_b32 s40, 120, s40
    s_mul_i32 s42, s33, 10
    s_mul_i32 s42, s42, s41
    s_add_u32 s40, s40, s42
    s_mul_i32 s37, s38, 140
    s_add_u32 s37, s37, s40
    s_lshl_b32 s37, s37, 10
    s_add_u32 s44, s37, 24875008
    s_lshl_b32 s48, s41, 10
    s_lshl_b32 s36, s35, 2
    s_add_u32 s36, s36, 1
    s_mul_i32 s38, s36, 9363
    s_lshr_b32 s38, s38, 16
    s_mul_i32 s39, s38, 7
    s_sub_u32 s39, s36, s39
    s_sub_u32 s41, s39, 1
    s_cmp_eq_u32 s39, 0
    s_cselect_b32 s41, 6, s41
    s_and_b32 s40, s38, 1
    s_cmp_eq_u32 s40, 1
    s_cselect_b32 s39, s41, s39
    s_mov_b32 s41, 4
    s_mov_b32 s40, s39
    s_cmp_ge_u32 s39, 4
    s_cselect_b32 s41, 2, s41
    s_add_u32 s42, s39, 76
    s_cmp_ge_u32 s39, 4
    s_cselect_b32 s40, s42, s40
    s_cmp_eq_u32 s39, 6
    s_cselect_b32 s41, 1, s41
    s_cselect_b32 s40, 120, s40
    s_mul_i32 s42, s33, 10
    s_mul_i32 s42, s42, s41
    s_add_u32 s40, s40, s42
    s_mul_i32 s37, s38, 140
    s_add_u32 s37, s37, s40
    s_lshl_b32 s37, s37, 10
    s_add_u32 s45, s37, 24875008
    s_lshl_b32 s49, s41, 10
    s_lshl_b32 s36, s35, 2
    s_add_u32 s36, s36, 2
    s_mul_i32 s38, s36, 9363
    s_lshr_b32 s38, s38, 16
    s_mul_i32 s39, s38, 7
    s_sub_u32 s39, s36, s39
    s_sub_u32 s41, s39, 1
    s_cmp_eq_u32 s39, 0
    s_cselect_b32 s41, 6, s41
    s_and_b32 s40, s38, 1
    s_cmp_eq_u32 s40, 1
    s_cselect_b32 s39, s41, s39
    s_mov_b32 s41, 4
    s_mov_b32 s40, s39
    s_cmp_ge_u32 s39, 4
    s_cselect_b32 s41, 2, s41
    s_add_u32 s42, s39, 76
    s_cmp_ge_u32 s39, 4
    s_cselect_b32 s40, s42, s40
    s_cmp_eq_u32 s39, 6
    s_cselect_b32 s41, 1, s41
    s_cselect_b32 s40, 120, s40
    s_mul_i32 s42, s33, 10
    s_mul_i32 s42, s42, s41
    s_add_u32 s40, s40, s42
    s_mul_i32 s37, s38, 140
    s_add_u32 s37, s37, s40
    s_lshl_b32 s37, s37, 10
    s_add_u32 s46, s37, 24875008
    s_lshl_b32 s50, s41, 10
    s_lshl_b32 s36, s35, 2
    s_add_u32 s36, s36, 3
    s_mul_i32 s38, s36, 9363
    s_lshr_b32 s38, s38, 16
    s_mul_i32 s39, s38, 7
    s_sub_u32 s39, s36, s39
    s_sub_u32 s41, s39, 1
    s_cmp_eq_u32 s39, 0
    s_cselect_b32 s41, 6, s41
    s_and_b32 s40, s38, 1
    s_cmp_eq_u32 s40, 1
    s_cselect_b32 s39, s41, s39
    s_mov_b32 s41, 4
    s_mov_b32 s40, s39
    s_cmp_ge_u32 s39, 4
    s_cselect_b32 s41, 2, s41
    s_add_u32 s42, s39, 76
    s_cmp_ge_u32 s39, 4
    s_cselect_b32 s40, s42, s40
    s_cmp_eq_u32 s39, 6
    s_cselect_b32 s41, 1, s41
    s_cselect_b32 s40, 120, s40
    s_mul_i32 s42, s33, 10
    s_mul_i32 s42, s42, s41
    s_add_u32 s40, s40, s42
    s_mul_i32 s37, s38, 140
    s_add_u32 s37, s37, s40
    s_lshl_b32 s37, s37, 10
    s_add_u32 s47, s37, 24875008
    s_lshl_b32 s51, s41, 10
    v_mov_b32 v12, 0
    v_mov_b32 v13, 0
    v_mov_b32 v14, 0
    v_mov_b32 v15, 0
    v_mov_b32 v16, 0x3f803f80
    s_waitcnt vmcnt(36)
    ds_write_b128 v5, v[32:35] offset:0
    ds_write_b128 v5, v[36:39] offset:1152
    ds_write_b128 v5, v[40:43] offset:2304
    ds_write_b128 v5, v[44:47] offset:3456
    s_waitcnt lgkmcnt(0)
    ds_read_b64_tr_b16 v[200:201], v8 offset:0
    ds_read_b64_tr_b16 v[202:203], v8 offset:576
    ds_read_b64_tr_b16 v[204:205], v8 offset:32
    ds_read_b64_tr_b16 v[206:207], v8 offset:608
    ds_read_b64_tr_b16 v[208:209], v8 offset:64
    ds_read_b64_tr_b16 v[210:211], v8 offset:640
    ds_read_b64_tr_b16 v[212:213], v8 offset:96
    ds_read_b64_tr_b16 v[214:215], v8 offset:672
    s_waitcnt vmcnt(32)
    ds_write_b128 v5, v[48:51] offset:4608
    ds_write_b128 v5, v[52:55] offset:5760
    ds_write_b128 v5, v[56:59] offset:6912
    ds_write_b128 v5, v[60:63] offset:8064
    s_waitcnt lgkmcnt(4)
    buffer_store_dwordx4 v[200:203], v9, s[28:31], s44 offen sc1
    s_add_u32 s44, s44, s48
    v_dot2_f32_bf16 v12, v200, v16, v12
    v_dot2_f32_bf16 v12, v201, v16, v12
    v_dot2_f32_bf16 v12, v202, v16, v12
    v_dot2_f32_bf16 v12, v203, v16, v12
    buffer_store_dwordx4 v[204:207], v9, s[28:31], s45 offen sc1
    s_add_u32 s45, s45, s49
    v_dot2_f32_bf16 v13, v204, v16, v13
    v_dot2_f32_bf16 v13, v205, v16, v13
    v_dot2_f32_bf16 v13, v206, v16, v13
    v_dot2_f32_bf16 v13, v207, v16, v13
    buffer_store_dwordx4 v[208:211], v9, s[28:31], s46 offen sc1
    s_add_u32 s46, s46, s50
    v_dot2_f32_bf16 v14, v208, v16, v14
    v_dot2_f32_bf16 v14, v209, v16, v14
    v_dot2_f32_bf16 v14, v210, v16, v14
    v_dot2_f32_bf16 v14, v211, v16, v14
    buffer_store_dwordx4 v[212:215], v9, s[28:31], s47 offen sc1
    s_add_u32 s47, s47, s51
    v_dot2_f32_bf16 v15, v212, v16, v15
    v_dot2_f32_bf16 v15, v213, v16, v15
    v_dot2_f32_bf16 v15, v214, v16, v15
    v_dot2_f32_bf16 v15, v215, v16, v15
    s_waitcnt lgkmcnt(0)
    ds_read_b64_tr_b16 v[216:217], v8 offset:4608
    ds_read_b64_tr_b16 v[218:219], v8 offset:5184
    ds_read_b64_tr_b16 v[220:221], v8 offset:4640
    ds_read_b64_tr_b16 v[222:223], v8 offset:5216
    ds_read_b64_tr_b16 v[224:225], v8 offset:4672
    ds_read_b64_tr_b16 v[226:227], v8 offset:5248
    ds_read_b64_tr_b16 v[228:229], v8 offset:4704
    ds_read_b64_tr_b16 v[230:231], v8 offset:5280
    s_waitcnt vmcnt(32)
    ds_write_b128 v5, v[64:67] offset:0
    ds_write_b128 v5, v[68:71] offset:1152
    ds_write_b128 v5, v[72:75] offset:2304
    ds_write_b128 v5, v[76:79] offset:3456
    s_waitcnt lgkmcnt(4)
    buffer_store_dwordx4 v[216:219], v9, s[28:31], s44 offen sc1
    s_add_u32 s44, s44, s48
    v_dot2_f32_bf16 v12, v216, v16, v12
    v_dot2_f32_bf16 v12, v217, v16, v12
    v_dot2_f32_bf16 v12, v218, v16, v12
    v_dot2_f32_bf16 v12, v219, v16, v12
    buffer_store_dwordx4 v[220:223], v9, s[28:31], s45 offen sc1
    s_add_u32 s45, s45, s49
    v_dot2_f32_bf16 v13, v220, v16, v13
    v_dot2_f32_bf16 v13, v221, v16, v13
    v_dot2_f32_bf16 v13, v222, v16, v13
    v_dot2_f32_bf16 v13, v223, v16, v13
    buffer_store_dwordx4 v[224:227], v9, s[28:31], s46 offen sc1
    s_add_u32 s46, s46, s50
    v_dot2_f32_bf16 v14, v224, v16, v14
    v_dot2_f32_bf16 v14, v225, v16, v14
    v_dot2_f32_bf16 v14, v226, v16, v14
    v_dot2_f32_bf16 v14, v227, v16, v14
    buffer_store_dwordx4 v[228:231], v9, s[28:31], s47 offen sc1
    s_add_u32 s47, s47, s51
    v_dot2_f32_bf16 v15, v228, v16, v15
    v_dot2_f32_bf16 v15, v229, v16, v15
    v_dot2_f32_bf16 v15, v230, v16, v15
    v_dot2_f32_bf16 v15, v231, v16, v15
    s_waitcnt lgkmcnt(0)
    ds_read_b64_tr_b16 v[200:201], v8 offset:0
    ds_read_b64_tr_b16 v[202:203], v8 offset:576
    ds_read_b64_tr_b16 v[204:205], v8 offset:32
    ds_read_b64_tr_b16 v[206:207], v8 offset:608
    ds_read_b64_tr_b16 v[208:209], v8 offset:64
    ds_read_b64_tr_b16 v[210:211], v8 offset:640
    ds_read_b64_tr_b16 v[212:213], v8 offset:96
    ds_read_b64_tr_b16 v[214:215], v8 offset:672
    s_waitcnt vmcnt(32)
    ds_write_b128 v5, v[80:83] offset:4608
    ds_write_b128 v5, v[84:87] offset:5760
    ds_write_b128 v5, v[88:91] offset:6912
    ds_write_b128 v5, v[92:95] offset:8064
    s_waitcnt lgkmcnt(4)
    buffer_store_dwordx4 v[200:203], v9, s[28:31], s44 offen sc1
    s_add_u32 s44, s44, s48
    v_dot2_f32_bf16 v12, v200, v16, v12
    v_dot2_f32_bf16 v12, v201, v16, v12
    v_dot2_f32_bf16 v12, v202, v16, v12
    v_dot2_f32_bf16 v12, v203, v16, v12
    buffer_store_dwordx4 v[204:207], v9, s[28:31], s45 offen sc1
    s_add_u32 s45, s45, s49
    v_dot2_f32_bf16 v13, v204, v16, v13
    v_dot2_f32_bf16 v13, v205, v16, v13
    v_dot2_f32_bf16 v13, v206, v16, v13
    v_dot2_f32_bf16 v13, v207, v16, v13
    buffer_store_dwordx4 v[208:211], v9, s[28:31], s46 offen sc1
    s_add_u32 s46, s46, s50
    v_dot2_f32_bf16 v14, v208, v16, v14
    v_dot2_f32_bf16 v14, v209, v16, v14
    v_dot2_f32_bf16 v14, v210, v16, v14
    v_dot2_f32_bf16 v14, v211, v16, v14
    buffer_store_dwordx4 v[212:215], v9, s[28:31], s47 offen sc1
    s_add_u32 s47, s47, s51
    v_dot2_f32_bf16 v15, v212, v16, v15
    v_dot2_f32_bf16 v15, v213, v16, v15
    v_dot2_f32_bf16 v15, v214, v16, v15
    v_dot2_f32_bf16 v15, v215, v16, v15
    s_waitcnt lgkmcnt(0)
    ds_read_b64_tr_b16 v[216:217], v8 offset:4608
    ds_read_b64_tr_b16 v[218:219], v8 offset:5184
    ds_read_b64_tr_b16 v[220:221], v8 offset:4640
    ds_read_b64_tr_b16 v[222:223], v8 offset:5216
    ds_read_b64_tr_b16 v[224:225], v8 offset:4672
    ds_read_b64_tr_b16 v[226:227], v8 offset:5248
    ds_read_b64_tr_b16 v[228:229], v8 offset:4704
    ds_read_b64_tr_b16 v[230:231], v8 offset:5280
    s_waitcnt vmcnt(32)
    ds_write_b128 v5, v[96:99] offset:0
    ds_write_b128 v5, v[100:103] offset:1152
    ds_write_b128 v5, v[104:107] offset:2304
    ds_write_b128 v5, v[108:111] offset:3456
    s_waitcnt lgkmcnt(4)
    buffer_store_dwordx4 v[216:219], v9, s[28:31], s44 offen sc1
    s_add_u32 s44, s44, s48
    v_dot2_f32_bf16 v12, v216, v16, v12
    v_dot2_f32_bf16 v12, v217, v16, v12
    v_dot2_f32_bf16 v12, v218, v16, v12
    v_dot2_f32_bf16 v12, v219, v16, v12
    buffer_store_dwordx4 v[220:223], v9, s[28:31], s45 offen sc1
    s_add_u32 s45, s45, s49
    v_dot2_f32_bf16 v13, v220, v16, v13
    v_dot2_f32_bf16 v13, v221, v16, v13
    v_dot2_f32_bf16 v13, v222, v16, v13
    v_dot2_f32_bf16 v13, v223, v16, v13
    buffer_store_dwordx4 v[224:227], v9, s[28:31], s46 offen sc1
    s_add_u32 s46, s46, s50
    v_dot2_f32_bf16 v14, v224, v16, v14
    v_dot2_f32_bf16 v14, v225, v16, v14
    v_dot2_f32_bf16 v14, v226, v16, v14
    v_dot2_f32_bf16 v14, v227, v16, v14
    buffer_store_dwordx4 v[228:231], v9, s[28:31], s47 offen sc1
    s_add_u32 s47, s47, s51
    v_dot2_f32_bf16 v15, v228, v16, v15
    v_dot2_f32_bf16 v15, v229, v16, v15
    v_dot2_f32_bf16 v15, v230, v16, v15
    v_dot2_f32_bf16 v15, v231, v16, v15
    s_waitcnt lgkmcnt(0)
    ds_read_b64_tr_b16 v[200:201], v8 offset:0
    ds_read_b64_tr_b16 v[202:203], v8 offset:576
    ds_read_b64_tr_b16 v[204:205], v8 offset:32
    ds_read_b64_tr_b16 v[206:207], v8 offset:608
    ds_read_b64_tr_b16 v[208:209], v8 offset:64
    ds_read_b64_tr_b16 v[210:211], v8 offset:640
    ds_read_b64_tr_b16 v[212:213], v8 offset:96
    ds_read_b64_tr_b16 v[214:215], v8 offset:672
    s_waitcnt vmcnt(32)
    ds_write_b128 v5, v[112:115] offset:4608
    ds_write_b128 v5, v[116:119] offset:5760
    ds_write_b128 v5, v[120:123] offset:6912
    ds_write_b128 v5, v[124:127] offset:8064
    s_waitcnt lgkmcnt(4)
    buffer_store_dwordx4 v[200:203], v9, s[28:31], s44 offen sc1
    s_add_u32 s44, s44, s48
    v_dot2_f32_bf16 v12, v200, v16, v12
    v_dot2_f32_bf16 v12, v201, v16, v12
    v_dot2_f32_bf16 v12, v202, v16, v12
    v_dot2_f32_bf16 v12, v203, v16, v12
    buffer_store_dwordx4 v[204:207], v9, s[28:31], s45 offen sc1
    s_add_u32 s45, s45, s49
    v_dot2_f32_bf16 v13, v204, v16, v13
    v_dot2_f32_bf16 v13, v205, v16, v13
    v_dot2_f32_bf16 v13, v206, v16, v13
    v_dot2_f32_bf16 v13, v207, v16, v13
    buffer_store_dwordx4 v[208:211], v9, s[28:31], s46 offen sc1
    s_add_u32 s46, s46, s50
    v_dot2_f32_bf16 v14, v208, v16, v14
    v_dot2_f32_bf16 v14, v209, v16, v14
    v_dot2_f32_bf16 v14, v210, v16, v14
    v_dot2_f32_bf16 v14, v211, v16, v14
    buffer_store_dwordx4 v[212:215], v9, s[28:31], s47 offen sc1
    s_add_u32 s47, s47, s51
    v_dot2_f32_bf16 v15, v212, v16, v15
    v_dot2_f32_bf16 v15, v213, v16, v15
    v_dot2_f32_bf16 v15, v214, v16, v15
    v_dot2_f32_bf16 v15, v215, v16, v15
    s_waitcnt lgkmcnt(0)
    ds_read_b64_tr_b16 v[216:217], v8 offset:4608
    ds_read_b64_tr_b16 v[218:219], v8 offset:5184
    ds_read_b64_tr_b16 v[220:221], v8 offset:4640
    ds_read_b64_tr_b16 v[222:223], v8 offset:5216
    ds_read_b64_tr_b16 v[224:225], v8 offset:4672
    ds_read_b64_tr_b16 v[226:227], v8 offset:5248
    ds_read_b64_tr_b16 v[228:229], v8 offset:4704
    ds_read_b64_tr_b16 v[230:231], v8 offset:5280
    s_waitcnt vmcnt(32)
    ds_write_b128 v5, v[128:131] offset:0
    ds_write_b128 v5, v[132:135] offset:1152
    ds_write_b128 v5, v[136:139] offset:2304
    ds_write_b128 v5, v[140:143] offset:3456
    s_waitcnt lgkmcnt(4)
    buffer_store_dwordx4 v[216:219], v9, s[28:31], s44 offen sc1
    s_add_u32 s44, s44, s48
    v_dot2_f32_bf16 v12, v216, v16, v12
    v_dot2_f32_bf16 v12, v217, v16, v12
    v_dot2_f32_bf16 v12, v218, v16, v12
    v_dot2_f32_bf16 v12, v219, v16, v12
    buffer_store_dwordx4 v[220:223], v9, s[28:31], s45 offen sc1
    s_add_u32 s45, s45, s49
    v_dot2_f32_bf16 v13, v220, v16, v13
    v_dot2_f32_bf16 v13, v221, v16, v13
    v_dot2_f32_bf16 v13, v222, v16, v13
    v_dot2_f32_bf16 v13, v223, v16, v13
    buffer_store_dwordx4 v[224:227], v9, s[28:31], s46 offen sc1
    s_add_u32 s46, s46, s50
    v_dot2_f32_bf16 v14, v224, v16, v14
    v_dot2_f32_bf16 v14, v225, v16, v14
    v_dot2_f32_bf16 v14, v226, v16, v14
    v_dot2_f32_bf16 v14, v227, v16, v14
    buffer_store_dwordx4 v[228:231], v9, s[28:31], s47 offen sc1
    s_add_u32 s47, s47, s51
    v_dot2_f32_bf16 v15, v228, v16, v15
    v_dot2_f32_bf16 v15, v229, v16, v15
    v_dot2_f32_bf16 v15, v230, v16, v15
    v_dot2_f32_bf16 v15, v231, v16, v15
    s_waitcnt lgkmcnt(0)
    ds_read_b64_tr_b16 v[200:201], v8 offset:0
    ds_read_b64_tr_b16 v[202:203], v8 offset:576
    ds_read_b64_tr_b16 v[204:205], v8 offset:32
    ds_read_b64_tr_b16 v[206:207], v8 offset:608
    ds_read_b64_tr_b16 v[208:209], v8 offset:64
    ds_read_b64_tr_b16 v[210:211], v8 offset:640
    ds_read_b64_tr_b16 v[212:213], v8 offset:96
    ds_read_b64_tr_b16 v[214:215], v8 offset:672
    s_waitcnt vmcnt(32)
    ds_write_b128 v5, v[144:147] offset:4608
    ds_write_b128 v5, v[148:151] offset:5760
    ds_write_b128 v5, v[152:155] offset:6912
    ds_write_b128 v5, v[156:159] offset:8064
    s_waitcnt lgkmcnt(4)
    buffer_store_dwordx4 v[200:203], v9, s[28:31], s44 offen sc1
    s_add_u32 s44, s44, s48
    v_dot2_f32_bf16 v12, v200, v16, v12
    v_dot2_f32_bf16 v12, v201, v16, v12
    v_dot2_f32_bf16 v12, v202, v16, v12
    v_dot2_f32_bf16 v12, v203, v16, v12
    buffer_store_dwordx4 v[204:207], v9, s[28:31], s45 offen sc1
    s_add_u32 s45, s45, s49
    v_dot2_f32_bf16 v13, v204, v16, v13
    v_dot2_f32_bf16 v13, v205, v16, v13
    v_dot2_f32_bf16 v13, v206, v16, v13
    v_dot2_f32_bf16 v13, v207, v16, v13
    buffer_store_dwordx4 v[208:211], v9, s[28:31], s46 offen sc1
    s_add_u32 s46, s46, s50
    v_dot2_f32_bf16 v14, v208, v16, v14
    v_dot2_f32_bf16 v14, v209, v16, v14
    v_dot2_f32_bf16 v14, v210, v16, v14
    v_dot2_f32_bf16 v14, v211, v16, v14
    buffer_store_dwordx4 v[212:215], v9, s[28:31], s47 offen sc1
    s_add_u32 s47, s47, s51
    v_dot2_f32_bf16 v15, v212, v16, v15
    v_dot2_f32_bf16 v15, v213, v16, v15
    v_dot2_f32_bf16 v15, v214, v16, v15
    v_dot2_f32_bf16 v15, v215, v16, v15
    s_waitcnt lgkmcnt(0)
    ds_read_b64_tr_b16 v[216:217], v8 offset:4608
    ds_read_b64_tr_b16 v[218:219], v8 offset:5184
    ds_read_b64_tr_b16 v[220:221], v8 offset:4640
    ds_read_b64_tr_b16 v[222:223], v8 offset:5216
    ds_read_b64_tr_b16 v[224:225], v8 offset:4672
    ds_read_b64_tr_b16 v[226:227], v8 offset:5248
    ds_read_b64_tr_b16 v[228:229], v8 offset:4704
    ds_read_b64_tr_b16 v[230:231], v8 offset:5280
    s_waitcnt vmcnt(32)
    ds_write_b128 v5, v[160:163] offset:0
    ds_write_b128 v5, v[164:167] offset:1152
    ds_write_b128 v5, v[168:171] offset:2304
    ds_write_b128 v5, v[172:175] offset:3456
    s_waitcnt lgkmcnt(4)
    buffer_store_dwordx4 v[216:219], v9, s[28:31], s44 offen sc1
    s_add_u32 s44, s44, s48
    v_dot2_f32_bf16 v12, v216, v16, v12
    v_dot2_f32_bf16 v12, v217, v16, v12
    v_dot2_f32_bf16 v12, v218, v16, v12
    v_dot2_f32_bf16 v12, v219, v16, v12
    buffer_store_dwordx4 v[220:223], v9, s[28:31], s45 offen sc1
    s_add_u32 s45, s45, s49
    v_dot2_f32_bf16 v13, v220, v16, v13
    v_dot2_f32_bf16 v13, v221, v16, v13
    v_dot2_f32_bf16 v13, v222, v16, v13
    v_dot2_f32_bf16 v13, v223, v16, v13
    buffer_store_dwordx4 v[224:227], v9, s[28:31], s46 offen sc1
    s_add_u32 s46, s46, s50
    v_dot2_f32_bf16 v14, v224, v16, v14
    v_dot2_f32_bf16 v14, v225, v16, v14
    v_dot2_f32_bf16 v14, v226, v16, v14
    v_dot2_f32_bf16 v14, v227, v16, v14
    buffer_store_dwordx4 v[228:231], v9, s[28:31], s47 offen sc1
    s_add_u32 s47, s47, s51
    v_dot2_f32_bf16 v15, v228, v16, v15
    v_dot2_f32_bf16 v15, v229, v16, v15
    v_dot2_f32_bf16 v15, v230, v16, v15
    v_dot2_f32_bf16 v15, v231, v16, v15
    s_waitcnt lgkmcnt(0)
    ds_read_b64_tr_b16 v[200:201], v8 offset:0
    ds_read_b64_tr_b16 v[202:203], v8 offset:576
    ds_read_b64_tr_b16 v[204:205], v8 offset:32
    ds_read_b64_tr_b16 v[206:207], v8 offset:608
    ds_read_b64_tr_b16 v[208:209], v8 offset:64
    ds_read_b64_tr_b16 v[210:211], v8 offset:640
    ds_read_b64_tr_b16 v[212:213], v8 offset:96
    ds_read_b64_tr_b16 v[214:215], v8 offset:672
    s_waitcnt vmcnt(32)
    ds_write_b128 v5, v[176:179] offset:4608
    ds_write_b128 v5, v[180:183] offset:5760
    ds_write_b128 v5, v[184:187] offset:6912
    ds_write_b128 v5, v[188:191] offset:8064
    s_waitcnt lgkmcnt(4)
    buffer_store_dwordx4 v[200:203], v9, s[28:31], s44 offen sc1
    s_add_u32 s44, s44, s48
    v_dot2_f32_bf16 v12, v200, v16, v12
    v_dot2_f32_bf16 v12, v201, v16, v12
    v_dot2_f32_bf16 v12, v202, v16, v12
    v_dot2_f32_bf16 v12, v203, v16, v12
    buffer_store_dwordx4 v[204:207], v9, s[28:31], s45 offen sc1
    s_add_u32 s45, s45, s49
    v_dot2_f32_bf16 v13, v204, v16, v13
    v_dot2_f32_bf16 v13, v205, v16, v13
    v_dot2_f32_bf16 v13, v206, v16, v13
    v_dot2_f32_bf16 v13, v207, v16, v13
    buffer_store_dwordx4 v[208:211], v9, s[28:31], s46 offen sc1
    s_add_u32 s46, s46, s50
    v_dot2_f32_bf16 v14, v208, v16, v14
    v_dot2_f32_bf16 v14, v209, v16, v14
    v_dot2_f32_bf16 v14, v210, v16, v14
    v_dot2_f32_bf16 v14, v211, v16, v14
    buffer_store_dwordx4 v[212:215], v9, s[28:31], s47 offen sc1
    s_add_u32 s47, s47, s51
    v_dot2_f32_bf16 v15, v212, v16, v15
    v_dot2_f32_bf16 v15, v213, v16, v15
    v_dot2_f32_bf16 v15, v214, v16, v15
    v_dot2_f32_bf16 v15, v215, v16, v15
    s_waitcnt lgkmcnt(0)
    ds_read_b64_tr_b16 v[216:217], v8 offset:4608
    ds_read_b64_tr_b16 v[218:219], v8 offset:5184
    ds_read_b64_tr_b16 v[220:221], v8 offset:4640
    ds_read_b64_tr_b16 v[222:223], v8 offset:5216
    ds_read_b64_tr_b16 v[224:225], v8 offset:4672
    ds_read_b64_tr_b16 v[226:227], v8 offset:5248
    ds_read_b64_tr_b16 v[228:229], v8 offset:4704
    ds_read_b64_tr_b16 v[230:231], v8 offset:5280
    s_waitcnt lgkmcnt(0)
    buffer_store_dwordx4 v[216:219], v9, s[28:31], s44 offen sc1
    s_add_u32 s44, s44, s48
    v_dot2_f32_bf16 v12, v216, v16, v12
    v_dot2_f32_bf16 v12, v217, v16, v12
    v_dot2_f32_bf16 v12, v218, v16, v12
    v_dot2_f32_bf16 v12, v219, v16, v12
    buffer_store_dwordx4 v[220:223], v9, s[28:31], s45 offen sc1
    s_add_u32 s45, s45, s49
    v_dot2_f32_bf16 v13, v220, v16, v13
    v_dot2_f32_bf16 v13, v221, v16, v13
    v_dot2_f32_bf16 v13, v222, v16, v13
    v_dot2_f32_bf16 v13, v223, v16, v13
    buffer_store_dwordx4 v[224:227], v9, s[28:31], s46 offen sc1
    s_add_u32 s46, s46, s50
    v_dot2_f32_bf16 v14, v224, v16, v14
    v_dot2_f32_bf16 v14, v225, v16, v14
    v_dot2_f32_bf16 v14, v226, v16, v14
    v_dot2_f32_bf16 v14, v227, v16, v14
    buffer_store_dwordx4 v[228:231], v9, s[28:31], s47 offen sc1
    s_add_u32 s47, s47, s51
    v_dot2_f32_bf16 v15, v228, v16, v15
    v_dot2_f32_bf16 v15, v229, v16, v15
    v_dot2_f32_bf16 v15, v230, v16, v15
    v_dot2_f32_bf16 v15, v231, v16, v15
    s_nop 2
    v_mov_b32 v20, v12
    v_mov_b32 v21, v13
    v_mov_b32 v22, v14
    v_mov_b32 v23, v15
    s_nop 1
    v_permlane32_swap_b32 v20, v12
    v_permlane32_swap_b32 v21, v13
    v_permlane32_swap_b32 v22, v14
    v_permlane32_swap_b32 v23, v15
    s_nop 1
    v_add_f32 v12, v12, v20
    v_add_f32 v13, v13, v21
    v_add_f32 v14, v14, v22
    v_add_f32 v15, v15, v23
    v_mov_b32 v20, v12
    v_mov_b32 v21, v13
    v_mov_b32 v22, v14
    v_mov_b32 v23, v15
    s_nop 1
    v_permlane16_swap_b32 v20, v12
    v_permlane16_swap_b32 v21, v13
    v_permlane16_swap_b32 v22, v14
    v_permlane16_swap_b32 v23, v15
    s_nop 1
    v_add_f32 v12, v12, v20
    v_add_f32 v13, v13, v21
    v_add_f32 v14, v14, v22
    v_add_f32 v15, v15, v23
    s_mul_i32 s38, s33, 7168
    s_lshl_b32 s39, s35, 8
    s_add_u32 s38, s38, s39
    s_add_u32 s38, s38, 8130560
    v_lshlrev_b32 v17, 2, v1
    s_mov_b64 exec, 0xffff
    buffer_store_dword v12, v17, s[28:31], s38 offen offset:0 sc1
    buffer_store_dword v13, v17, s[28:31], s38 offen offset:64 sc1
    buffer_store_dword v14, v17, s[28:31], s38 offen offset:128 sc1
    buffer_store_dword v15, v17, s[28:31], s38 offen offset:192 sc1
    s_endpgm
prep_kernel_pk32:
    s_mov_b32 s24, s18
    s_mov_b32 s25, s19
    s_mov_b32 s26, 2211840
    s_mov_b32 s27, 0x00020000
    s_sub_u32 s32, s21, 94
    s_mul_i32 s33, s32, 52429
    s_lshr_b32 s33, s33, 19
    s_mul_i32 s35, s33, 10
    s_sub_u32 s35, s32, s35
    v_mul_u32_u24 v10, 1280, v3
    v_lshl_add_u32 v10, v4, 4, v10
    s_mul_i32 s36, s33, 368640
    s_lshl_b32 s37, s35, 7
    s_add_u32 s36, s36, s37
    buffer_load_dwordx4 v[32:35], v10, s[24:27], s36 offen nt
    s_add_u32 s36, s36, 10240
    buffer_load_dwordx4 v[36:39], v10, s[24:27], s36 offen nt
    s_add_u32 s36, s36, 10240
    buffer_load_dwordx4 v[40:43], v10, s[24:27], s36 offen nt
    s_add_u32 s36, s36, 10240
    buffer_load_dwordx4 v[44:47], v10, s[24:27], s36 offen nt
    s_add_u32 s36, s36, 10240
    buffer_load_dwordx4 v[48:51], v10, s[24:27], s36 offen nt
    s_add_u32 s36, s36, 10240
    buffer_load_dwordx4 v[52:55], v10, s[24:27], s36 offen nt
    s_add_u32 s36, s36, 10240
    buffer_load_dwordx4 v[56:59], v10, s[24:27], s36 offen nt
    s_add_u32 s36, s36, 10240
    buffer_load_dwordx4 v[60:63], v10, s[24:27], s36 offen nt
    s_add_u32 s36, s36, 10240
    buffer_load_dwordx4 v[64:67], v10, s[24:27], s36 offen nt
    s_add_u32 s36, s36, 10240
    buffer_load_dwordx4 v[68:71], v10, s[24:27], s36 offen nt
    s_add_u32 s36, s36, 10240
    buffer_load_dwordx4 v[72:75], v10, s[24:27], s36 offen nt
    s_add_u32 s36, s36, 10240
    buffer_load_dwordx4 v[76:79], v10, s[24:27], s36 offen nt
    s_add_u32 s36, s36, 10240
    buffer_load_dwordx4 v[80:83], v10, s[24:27], s36 offen nt
    s_add_u32 s36, s36, 10240
    buffer_load_dwordx4 v[84:87], v10, s[24:27], s36 offen nt
    s_add_u32 s36, s36, 10240
    buffer_load_dwordx4 v[88:91], v10, s[24:27], s36 offen nt
    s_add_u32 s36, s36, 10240
    buffer_load_dwordx4 v[92:95], v10, s[24:27], s36 offen nt
    s_add_u32 s36, s36, 10240
    buffer_load_dwordx4 v[96:99], v10, s[24:27], s36 offen nt
    s_add_u32 s36, s36, 10240
    buffer_load_dwordx4 v[100:103], v10, s[24:27], s36 offen nt
    s_add_u32 s36, s36, 10240
    buffer_load_dwordx4 v[104:107], v10, s[24:27], s36 offen nt
    s_add_u32 s36, s36, 10240
    buffer_load_dwordx4 v[108:111], v10, s[24:27], s36 offen nt
    s_add_u32 s36, s36, 10240
    buffer_load_dwordx4 v[112:115], v10, s[24:27], s36 offen nt
    s_add_u32 s36, s36, 10240
    buffer_load_dwordx4 v[116:119], v10, s[24:27], s36 offen nt
    s_add_u32 s36, s36, 10240
    buffer_load_dwordx4 v[120:123], v10, s[24:27], s36 offen nt
    s_add_u32 s36, s36, 10240
    buffer_load_dwordx4 v[124:127], v10, s[24:27], s36 offen nt
    s_add_u32 s36, s36, 10240
    buffer_load_dwordx4 v[128:131], v10, s[24:27], s36 offen nt
    s_add_u32 s36, s36, 10240
    buffer_load_dwordx4 v[132:135], v10, s[24:27], s36 offen nt
    s_add_u32 s36, s36, 10240
    buffer_load_dwordx4 v[136:139], v10, s[24:27], s36 offen nt
    s_add_u32 s36, s36, 10240
    buffer_load_dwordx4 v[140:143], v10, s[24:27], s36 offen nt
    s_add_u32 s36, s36, 10240
    buffer_load_dwordx4 v[144:147], v10, s[24:27], s36 offen nt
    s_add_u32 s36, s36, 10240
    buffer_load_dwordx4 v[148:151], v10, s[24:27], s36 offen nt
    s_add_u32 s36, s36, 10240
    buffer_load_dwordx4 v[152:155], v10, s[24:27], s36 offen nt
    s_add_u32 s36, s36, 10240
    buffer_load_dwordx4 v[156:159], v10, s[24:27], s36 offen nt
    s_add_u32 s36, s36, 10240
    buffer_load_dwordx4 v[160:163], v10, s[24:27], s36 offen nt
    s_add_u32 s36, s36, 10240
    buffer_load_dwordx4 v[164:167], v10, s[24:27], s36 offen nt
    s_add_u32 s36, s36, 10240
    buffer_load_dwordx4 v[168:171], v10, s[24:27], s36 offen nt
    s_add_u32 s36, s36, 10240
    buffer_load_dwordx4 v[172:175], v10, s[24:27], s36 offen nt
    s_lshl_b32 s36, s35, 2
    s_add_u32 s36, s36, 0
    s_mul_i32 s38, s36, 13108
    s_lshr_b32 s38, s38, 16
    s_mul_i32 s39, s38, 5
    s_sub_u32 s39, s36, s39
    s_sub_u32 s41, s39, 1
    s_cmp_eq_u32 s39, 0
    s_cselect_b32 s41, 4, s41
    s_and_b32 s40, s38, 1
    s_cmp_eq_u32 s40, 1
    s_cselect_b32 s39, s41, s39
    s_mul_i32 s40, s33, 21846
    s_lshr_b32 s40, s40, 16
    s_mul_i32 s41, s40, 3
    s_sub_u32 s41, s33, s41
    s_mul_i32 s37, s38, 270
    s_mul_i32 s41, s41, 90
    s_add_u32 s37, s37, s41
    s_mul_i32 s40, s40, 5
    s_add_u32 s37, s37, s40
    s_add_u32 s37, s37, s39
    s_lshl_b32 s37, s37, 10
    s_add_u32 s44, s37, 27168768
    s_movk_i32 s48, 10240
    s_lshl_b32 s36, s35, 2
    s_add_u32 s36, s36, 1
    s_mul_i32 s38, s36, 13108
    s_lshr_b32 s38, s38, 16
    s_mul_i32 s39, s38, 5
    s_sub_u32 s39, s36, s39
    s_sub_u32 s41, s39, 1
    s_cmp_eq_u32 s39, 0
    s_cselect_b32 s41, 4, s41
    s_and_b32 s40, s38, 1
    s_cmp_eq_u32 s40, 1
    s_cselect_b32 s39, s41, s39
    s_mul_i32 s40, s33, 21846
    s_lshr_b32 s40, s40, 16
    s_mul_i32 s41, s40, 3
    s_sub_u32 s41, s33, s41
    s_mul_i32 s37, s38, 270
    s_mul_i32 s41, s41, 90
    s_add_u32 s37, s37, s41
    s_mul_i32 s40, s40, 5
    s_add_u32 s37, s37, s40
    s_add_u32 s37, s37, s39
    s_lshl_b32 s37, s37, 10
    s_add_u32 s45, s37, 27168768
    s_movk_i32 s49, 10240
    s_lshl_b32 s36, s35, 2
    s_add_u32 s36, s36, 2
    s_mul_i32 s38, s36, 13108
    s_lshr_b32 s38, s38, 16
    s_mul_i32 s39, s38, 5
    s_sub_u32 s39, s36, s39
    s_sub_u32 s41, s39, 1
    s_cmp_eq_u32 s39, 0
    s_cselect_b32 s41, 4, s41
    s_and_b32 s40, s38, 1
    s_cmp_eq_u32 s40, 1
    s_cselect_b32 s39, s41, s39
    s_mul_i32 s40, s33, 21846
    s_lshr_b32 s40, s40, 16
    s_mul_i32 s41, s40, 3
    s_sub_u32 s41, s33, s41
    s_mul_i32 s37, s38, 270
    s_mul_i32 s41, s41, 90
    s_add_u32 s37, s37, s41
    s_mul_i32 s40, s40, 5
    s_add_u32 s37, s37, s40
    s_add_u32 s37, s37, s39
    s_lshl_b32 s37, s37, 10
    s_add_u32 s46, s37, 27168768
    s_movk_i32 s50, 10240
    s_lshl_b32 s36, s35, 2
    s_add_u32 s36, s36, 3
    s_mul_i32 s38, s36, 13108
    s_lshr_b32 s38, s38, 16
    s_mul_i32 s39, s38, 5
    s_sub_u32 s39, s36, s39
    s_sub_u32 s41, s39, 1
    s_cmp_eq_u32 s39, 0
    s_cselect_b32 s41, 4, s41
    s_and_b32 s40, s38, 1
    s_cmp_eq_u32 s40, 1
    s_cselect_b32 s39, s41, s39
    s_mul_i32 s40, s33, 21846
    s_lshr_b32 s40, s40, 16
    s_mul_i32 s41, s40, 3
    s_sub_u32 s41, s33, s41
    s_mul_i32 s37, s38, 270
    s_mul_i32 s41, s41, 90
    s_add_u32 s37, s37, s41
    s_mul_i32 s40, s40, 5
    s_add_u32 s37, s37, s40
    s_add_u32 s37, s37, s39
    s_lshl_b32 s37, s37, 10
    s_add_u32 s47, s37, 27168768
    s_movk_i32 s51, 10240
    s_waitcnt vmcnt(32)
    ds_write_b128 v5, v[32:35] offset:0
    ds_write_b128 v5, v[36:39] offset:1152
    ds_write_b128 v5, v[40:43] offset:2304
    ds_write_b128 v5, v[44:47] offset:3456
    s_waitcnt lgkmcnt(0)
    ds_read_b64_tr_b16 v[200:201], v8 offset:0
    ds_read_b64_tr_b16 v[202:203], v8 offset:576
    ds_read_b64_tr_b16 v[204:205], v8 offset:32
    ds_read_b64_tr_b16 v[206:207], v8 offset:608
    ds_read_b64_tr_b16 v[208:209], v8 offset:64
    ds_read_b64_tr_b16 v[210:211], v8 offset:640
    ds_read_b64_tr_b16 v[212:213], v8 offset:96
    ds_read_b64_tr_b16 v[214:215], v8 offset:672
    s_waitcnt vmcnt(28)
    ds_write_b128 v5, v[48:51] offset:4608
    ds_write_b128 v5, v[52:55] offset:5760
    ds_write_b128 v5, v[56:59] offset:6912
    ds_write_b128 v5, v[60:63] offset:8064
    s_waitcnt lgkmcnt(4)
    buffer_store_dwordx4 v[200:203], v9, s[28:31], s44 offen sc1
    s_add_u32 s44, s44, s48
    buffer_store_dwordx4 v[204:207], v9, s[28:31], s45 offen sc1
    s_add_u32 s45, s45, s49
    buffer_store_dwordx4 v[208:211], v9, s[28:31], s46 offen sc1
    s_add_u32 s46, s46, s50
    buffer_store_dwordx4 v[212:215], v9, s[28:31], s47 offen sc1
    s_add_u32 s47, s47, s51
    s_waitcnt lgkmcnt(0)
    ds_read_b64_tr_b16 v[216:217], v8 offset:4608
    ds_read_b64_tr_b16 v[218:219], v8 offset:5184
    ds_read_b64_tr_b16 v[220:221], v8 offset:4640
    ds_read_b64_tr_b16 v[222:223], v8 offset:5216
    ds_read_b64_tr_b16 v[224:225], v8 offset:4672
    ds_read_b64_tr_b16 v[226:227], v8 offset:5248
    ds_read_b64_tr_b16 v[228:229], v8 offset:4704
    ds_read_b64_tr_b16 v[230:231], v8 offset:5280
    s_waitcnt vmcnt(28)
    ds_write_b128 v5, v[64:67] offset:0
    ds_write_b128 v5, v[68:71] offset:1152
    ds_write_b128 v5, v[72:75] offset:2304
    ds_write_b128 v5, v[76:79] offset:3456
    s_waitcnt lgkmcnt(4)
    buffer_store_dwordx4 v[216:219], v9, s[28:31], s44 offen sc1
    s_add_u32 s44, s44, s48
    buffer_store_dwordx4 v[220:223], v9, s[28:31], s45 offen sc1
    s_add_u32 s45, s45, s49
    buffer_store_dwordx4 v[224:227], v9, s[28:31], s46 offen sc1
    s_add_u32 s46, s46, s50
    buffer_store_dwordx4 v[228:231], v9, s[28:31], s47 offen sc1
    s_add_u32 s47, s47, s51
    s_waitcnt lgkmcnt(0)
    ds_read_b64_tr_b16 v[200:201], v8 offset:0
    ds_read_b64_tr_b16 v[202:203], v8 offset:576
    ds_read_b64_tr_b16 v[204:205], v8 offset:32
    ds_read_b64_tr_b16 v[206:207], v8 offset:608
    ds_read_b64_tr_b16 v[208:209], v8 offset:64
    ds_read_b64_tr_b16 v[210:211], v8 offset:640
    ds_read_b64_tr_b16 v[212:213], v8 offset:96
    ds_read_b64_tr_b16 v[214:215], v8 offset:672
    s_waitcnt vmcnt(28)
    ds_write_b128 v5, v[80:83] offset:4608
    ds_write_b128 v5, v[84:87] offset:5760
    ds_write_b128 v5, v[88:91] offset:6912
    ds_write_b128 v5, v[92:95] offset:8064
    s_waitcnt lgkmcnt(4)
    buffer_store_dwordx4 v[200:203], v9, s[28:31], s44 offen sc1
    s_add_u32 s44, s44, s48
    buffer_store_dwordx4 v[204:207], v9, s[28:31], s45 offen sc1
    s_add_u32 s45, s45, s49
    buffer_store_dwordx4 v[208:211], v9, s[28:31], s46 offen sc1
    s_add_u32 s46, s46, s50
    buffer_store_dwordx4 v[212:215], v9, s[28:31], s47 offen sc1
    s_add_u32 s47, s47, s51
    s_waitcnt lgkmcnt(0)
    ds_read_b64_tr_b16 v[216:217], v8 offset:4608
    ds_read_b64_tr_b16 v[218:219], v8 offset:5184
    ds_read_b64_tr_b16 v[220:221], v8 offset:4640
    ds_read_b64_tr_b16 v[222:223], v8 offset:5216
    ds_read_b64_tr_b16 v[224:225], v8 offset:4672
    ds_read_b64_tr_b16 v[226:227], v8 offset:5248
    ds_read_b64_tr_b16 v[228:229], v8 offset:4704
    ds_read_b64_tr_b16 v[230:231], v8 offset:5280
    s_waitcnt vmcnt(28)
    ds_write_b128 v5, v[96:99] offset:0
    ds_write_b128 v5, v[100:103] offset:1152
    ds_write_b128 v5, v[104:107] offset:2304
    ds_write_b128 v5, v[108:111] offset:3456
    s_waitcnt lgkmcnt(4)
    buffer_store_dwordx4 v[216:219], v9, s[28:31], s44 offen sc1
    s_add_u32 s44, s44, s48
    buffer_store_dwordx4 v[220:223], v9, s[28:31], s45 offen sc1
    s_add_u32 s45, s45, s49
    buffer_store_dwordx4 v[224:227], v9, s[28:31], s46 offen sc1
    s_add_u32 s46, s46, s50
    buffer_store_dwordx4 v[228:231], v9, s[28:31], s47 offen sc1
    s_add_u32 s47, s47, s51
    s_waitcnt lgkmcnt(0)
    ds_read_b64_tr_b16 v[200:201], v8 offset:0
    ds_read_b64_tr_b16 v[202:203], v8 offset:576
    ds_read_b64_tr_b16 v[204:205], v8 offset:32
    ds_read_b64_tr_b16 v[206:207], v8 offset:608
    ds_read_b64_tr_b16 v[208:209], v8 offset:64
    ds_read_b64_tr_b16 v[210:211], v8 offset:640
    ds_read_b64_tr_b16 v[212:213], v8 offset:96
    ds_read_b64_tr_b16 v[214:215], v8 offset:672
    s_waitcnt vmcnt(28)
    ds_write_b128 v5, v[112:115] offset:4608
    ds_write_b128 v5, v[116:119] offset:5760
    ds_write_b128 v5, v[120:123] offset:6912
    ds_write_b128 v5, v[124:127] offset:8064
    s_waitcnt lgkmcnt(4)
    buffer_store_dwordx4 v[200:203], v9, s[28:31], s44 offen sc1
    s_add_u32 s44, s44, s48
    buffer_store_dwordx4 v[204:207], v9, s[28:31], s45 offen sc1
    s_add_u32 s45, s45, s49
    buffer_store_dwordx4 v[208:211], v9, s[28:31], s46 offen sc1
    s_add_u32 s46, s46, s50
    buffer_store_dwordx4 v[212:215], v9, s[28:31], s47 offen sc1
    s_add_u32 s47, s47, s51
    s_waitcnt lgkmcnt(0)
    ds_read_b64_tr_b16 v[216:217], v8 offset:4608
    ds_read_b64_tr_b16 v[218:219], v8 offset:5184
    ds_read_b64_tr_b16 v[220:221], v8 offset:4640
    ds_read_b64_tr_b16 v[222:223], v8 offset:5216
    ds_read_b64_tr_b16 v[224:225], v8 offset:4672
    ds_read_b64_tr_b16 v[226:227], v8 offset:5248
    ds_read_b64_tr_b16 v[228:229], v8 offset:4704
    ds_read_b64_tr_b16 v[230:231], v8 offset:5280
    s_waitcnt vmcnt(28)
    ds_write_b128 v5, v[128:131] offset:0
    ds_write_b128 v5, v[132:135] offset:1152
    ds_write_b128 v5, v[136:139] offset:2304
    ds_write_b128 v5, v[140:143] offset:3456
    s_waitcnt lgkmcnt(4)
    buffer_store_dwordx4 v[216:219], v9, s[28:31], s44 offen sc1
    s_add_u32 s44, s44, s48
    buffer_store_dwordx4 v[220:223], v9, s[28:31], s45 offen sc1
    s_add_u32 s45, s45, s49
    buffer_store_dwordx4 v[224:227], v9, s[28:31], s46 offen sc1
    s_add_u32 s46, s46, s50
    buffer_store_dwordx4 v[228:231], v9, s[28:31], s47 offen sc1
    s_add_u32 s47, s47, s51
    s_waitcnt lgkmcnt(0)
    ds_read_b64_tr_b16 v[200:201], v8 offset:0
    ds_read_b64_tr_b16 v[202:203], v8 offset:576
    ds_read_b64_tr_b16 v[204:205], v8 offset:32
    ds_read_b64_tr_b16 v[206:207], v8 offset:608
    ds_read_b64_tr_b16 v[208:209], v8 offset:64
    ds_read_b64_tr_b16 v[210:211], v8 offset:640
    ds_read_b64_tr_b16 v[212:213], v8 offset:96
    ds_read_b64_tr_b16 v[214:215], v8 offset:672
    s_waitcnt vmcnt(28)
    ds_write_b128 v5, v[144:147] offset:4608
    ds_write_b128 v5, v[148:151] offset:5760
    ds_write_b128 v5, v[152:155] offset:6912
    ds_write_b128 v5, v[156:159] offset:8064
    s_waitcnt lgkmcnt(4)
    buffer_store_dwordx4 v[200:203], v9, s[28:31], s44 offen sc1
    s_add_u32 s44, s44, s48
    buffer_store_dwordx4 v[204:207], v9, s[28:31], s45 offen sc1
    s_add_u32 s45, s45, s49
    buffer_store_dwordx4 v[208:211], v9, s[28:31], s46 offen sc1
    s_add_u32 s46, s46, s50
    buffer_store_dwordx4 v[212:215], v9, s[28:31], s47 offen sc1
    s_add_u32 s47, s47, s51
    s_waitcnt lgkmcnt(0)
    ds_read_b64_tr_b16 v[216:217], v8 offset:4608
    ds_read_b64_tr_b16 v[218:219], v8 offset:5184
    ds_read_b64_tr_b16 v[220:221], v8 offset:4640
    ds_read_b64_tr_b16 v[222:223], v8 offset:5216
    ds_read_b64_tr_b16 v[224:225], v8 offset:4672
    ds_read_b64_tr_b16 v[226:227], v8 offset:5248
    ds_read_b64_tr_b16 v[228:229], v8 offset:4704
    ds_read_b64_tr_b16 v[230:231], v8 offset:5280
    s_waitcnt vmcnt(28)
    ds_write_b128 v5, v[160:163] offset:0
    ds_write_b128 v5, v[164:167] offset:1152
    ds_write_b128 v5, v[168:171] offset:2304
    ds_write_b128 v5, v[172:175] offset:3456
    s_waitcnt lgkmcnt(4)
    buffer_store_dwordx4 v[216:219], v9, s[28:31], s44 offen sc1
    s_add_u32 s44, s44, s48
    buffer_store_dwordx4 v[220:223], v9, s[28:31], s45 offen sc1
    s_add_u32 s45, s45, s49
    buffer_store_dwordx4 v[224:227], v9, s[28:31], s46 offen sc1
    s_add_u32 s46, s46, s50
    buffer_store_dwordx4 v[228:231], v9, s[28:31], s47 offen sc1
    s_add_u32 s47, s47, s51
    s_waitcnt lgkmcnt(0)
    ds_read_b64_tr_b16 v[200:201], v8 offset:0
    ds_read_b64_tr_b16 v[202:203], v8 offset:576
    ds_read_b64_tr_b16 v[204:205], v8 offset:32
    ds_read_b64_tr_b16 v[206:207], v8 offset:608
    ds_read_b64_tr_b16 v[208:209], v8 offset:64
    ds_read_b64_tr_b16 v[210:211], v8 offset:640
    ds_read_b64_tr_b16 v[212:213], v8 offset:96
    ds_read_b64_tr_b16 v[214:215], v8 offset:672
    s_waitcnt lgkmcnt(0)
    buffer_store_dwordx4 v[200:203], v9, s[28:31], s44 offen sc1
    s_add_u32 s44, s44, s48
    buffer_store_dwordx4 v[204:207], v9, s[28:31], s45 offen sc1
    s_add_u32 s45, s45, s49
    buffer_store_dwordx4 v[208:211], v9, s[28:31], s46 offen sc1
    s_add_u32 s46, s46, s50
    buffer_store_dwordx4 v[212:215], v9, s[28:31], s47 offen sc1
    s_add_u32 s47, s47, s51
    s_endpgm
.globl chain_kernel
.p2align 8
.type chain_kernel,@function
chain_kernel:
    s_cmp_ge_u32 s2, 256
    s_cbranch_scc1 chain_end
    s_load_dwordx2 s[4:5], s[0:1], 0
    s_load_dwordx2 s[6:7], s[0:1], 104
    s_load_dwordx2 s[10:11], s[0:1], 120
    v_lshrrev_b32 v2, 6, v0
    v_and_b32 v1, 63, v0
    v_readfirstlane_b32 s20, v2
    s_and_b32 s25, s2, 7
    s_lshr_b32 s26, s2, 3
    s_lshl_b32 s23, s25, 3
    s_lshr_b32 s27, s26, 2
    s_add_u32 s23, s23, s27
    s_and_b32 s24, s26, 3
    s_and_b32 s21, s20, 1
    s_lshr_b32 s22, s20, 1
    v_lshrrev_b32 v3, 4, v1
    v_and_b32 v4, 15, v1
    v_lshlrev_b32 v8, 4, v1
    s_waitcnt lgkmcnt(0)
    s_mov_b32 s28, s10
    s_mov_b32 s29, s11
    s_mov_b32 s30, 268435456
    s_mov_b32 s31, 0x00020000
    s_mul_i32 s25, s20, 10240
    s_add_u32 s10, s25, 0
    s_mul_i32 s11, s23, 40960
    s_add_u32 s11, s11, s25
    s_add_u32 s11, s11, 5492736
    s_lshl_b32 s12, s20, 10
    s_add_u32 s13, s12, 8121856
    s_add_u32 s12, s12, 130560
    s_lshl_b32 s14, s21, 10
    s_add_u32 s14, s14, 139264
    s_mul_i32 s15, s21, 7168
    s_mul_i32 s25, s24, 640
    s_add_u32 s15, s15, s25
    s_add_u32 s15, s15, 8146944
    s_mov_b32 m0, s10
    s_add_u32 s10, s10, 4096
    buffer_load_dwordx4 v8, s[28:31], s11 offen offset:0 lds
    buffer_load_dwordx4 v8, s[28:31], s11 offen offset:1024 lds
    buffer_load_dwordx4 v8, s[28:31], s11 offen offset:2048 lds
    buffer_load_dwordx4 v8, s[28:31], s11 offen offset:3072 lds
    s_add_u32 s11, s11, 4096
    s_mov_b32 m0, s10
    s_add_u32 s10, s10, 4096
    buffer_load_dwordx4 v8, s[28:31], s11 offen offset:0 lds
    buffer_load_dwordx4 v8, s[28:31], s11 offen offset:1024 lds
    buffer_load_dwordx4 v8, s[28:31], s11 offen offset:2048 lds
    buffer_load_dwordx4 v8, s[28:31], s11 offen offset:3072 lds
    s_add_u32 s11, s11, 4096
    s_mov_b32 m0, s10
    s_add_u32 s10, s10, 4096
    buffer_load_dwordx4 v8, s[28:31], s11 offen offset:0 lds
    buffer_load_dwordx4 v8, s[28:31], s11 offen offset:1024 lds
    s_mov_b32 m0, s12
    s_nop 0
    buffer_load_dwordx4 v8, s[28:31], s13 offen lds
    s_mov_b32 m0, 134656
    s_mov_b32 s13, 8125952
    buffer_load_dwordx4 v8, s[28:31], s13 offen lds
    s_mov_b32 m0, s14
    s_nop 0
    buffer_load_dwordx4 v8, s[28:31], s15 offen lds
    s_mov_b32 s32, s6
    s_mov_b32 s33, s7
    s_mov_b32 s34, 2621440
    s_mov_b32 s35, 0x00020000
    s_mul_i32 s36, s24, 200
    s_mul_i32 s37, s21, 100
    s_add_u32 s36, s36, s37
    s_mul_i32 s37, s22, 50
    s_add_u32 s36, s36, s37
    s_lshl_b32 s36, s36, 10
    s_add_u32 s37, s36, 24055808
    s_add_u32 s36, s36, 23236608
    v_lshrrev_b32 v2, 1, v3
    s_lshl_b32 s26, s21, 2
    v_add_u32 v2, s26, v2
    v_and_b32 v7, 7, v4
    buffer_load_dwordx4 a[0:3], v8, s[28:31], s36 offen offset:0
    v_xor_b32 v2, v2, v7
    v_lshlrev_b32 v2, 4, v2
    v_lshl_add_u32 v226, v4, 8, v2
    v_and_b32 v2, 1, v3
    v_lshl_add_u32 v226, v2, 3, v226
    s_mul_i32 s26, s22, 20480
    s_add_u32 s27, s26, 0
    v_add_u32 v226, s27, v226
    v_lshlrev_b32 v227, 5, v4
    v_add_u32 v227, 122880, v227
    s_lshl_b32 s27, s21, 3
    v_add_u32 v2, s27, v3
    v_xor_b32 v2, v2, v7
    v_lshlrev_b32 v2, 4, v2
    v_and_b32 v7, 3, v4
    v_lshl_add_u32 v2, v7, 8, v2
    v_lshrrev_b32 v7, 2, v4
    buffer_load_dwordx4 a[4:7], v8, s[28:31], s36 offen offset:1024
    v_lshl_add_u32 v2, v7, 10, v2
    s_add_u32 s27, s26, 40960
    v_add_u32 v228, s27, v2
    v_xor_b32 v2, v4, v3
    v_lshlrev_b32 v2, 4, v2
    v_lshl_add_u32 v2, v3, 8, v2
    v_xor_b32 v7, 64, v2
    s_mul_i32 s26, s22, 30720
    s_add_u32 s26, s26, 40960
    s_mul_i32 s27, s22, 10240
    s_sub_u32 s27, 61440, s27
    v_add_u32 v229, s26, v2
    v_add_u32 v230, s26, v7
    v_add_u32 v231, s27, v2
    v_add_u32 v232, s27, v7
    v_lshlrev_b32 v2, 4, v3
    s_mul_i32 s26, s21, 384
    buffer_load_dwordx4 a[8:11], v8, s[28:31], s36 offen offset:2048
    s_add_u32 s26, s26, 139264
    v_add_u32 v233, s26, v2
    s_mul_i32 s26, s21, 64
    s_add_u32 s26, s26, 139520
    v_add_u32 v234, s26, v2
    s_lshl_b32 s26, s22, 7
    s_add_u32 s26, s26, 138240
    v_lshl_add_u32 v235, v4, 3, s26
    s_mul_i32 s39, s24, 5
    s_mul_i32 s40, s21, 3
    s_add_u32 s40, s40, s39
    s_add_u32 s41, s39, 2
    v_lshrrev_b32 v12, 1, v3
    v_and_b32 v13, 1, v3
    v_lshlrev_b32 v13, 3, v13
    s_add_u32 s26, s40, 0
    buffer_load_dwordx4 a[12:15], v8, s[28:31], s36 offen offset:3072
    v_add_u32 v14, 0, v12
    s_and_b32 s27, s26, 1
    s_lshl_b32 s27, s27, 2
    v_add_u32 v15, s27, v14
    v_xor_b32 v15, v15, v4
    v_lshlrev_b32 v15, 4, v15
    v_lshl_add_u32 v15, v14, 8, v15
    v_add_u32 v15, v15, v13
    s_mul_i32 s27, s22, 20
    s_add_u32 s27, s27, s26
    s_lshl_b32 s27, s27, 10
    s_add_u32 s27, s27, 40960
    v_add_u32 v236, s27, v15
    s_add_u32 s26, s40, 0
    v_add_u32 v14, 2, v12
    s_and_b32 s27, s26, 1
    s_lshl_b32 s27, s27, 2
    s_add_u32 s36, s36, 4096
    buffer_load_dwordx4 a[16:19], v8, s[28:31], s36 offen offset:0
    v_add_u32 v15, s27, v14
    v_xor_b32 v15, v15, v4
    v_lshlrev_b32 v15, 4, v15
    v_lshl_add_u32 v15, v14, 8, v15
    v_add_u32 v15, v15, v13
    s_mul_i32 s27, s22, 20
    s_add_u32 s27, s27, s26
    s_lshl_b32 s27, s27, 10
    s_add_u32 s27, s27, 40960
    v_add_u32 v237, s27, v15
    s_add_u32 s26, s40, 1
    v_add_u32 v14, 0, v12
    s_and_b32 s27, s26, 1
    s_lshl_b32 s27, s27, 2
    v_add_u32 v15, s27, v14
    v_xor_b32 v15, v15, v4
    v_lshlrev_b32 v15, 4, v15
    buffer_load_dwordx4 a[20:23], v8, s[28:31], s36 offen offset:1024
    v_lshl_add_u32 v15, v14, 8, v15
    v_add_u32 v15, v15, v13
    s_mul_i32 s27, s22, 20
    s_add_u32 s27, s27, s26
    s_lshl_b32 s27, s27, 10
    s_add_u32 s27, s27, 40960
    v_add_u32 v238, s27, v15
    s_add_u32 s26, s40, 1
    v_add_u32 v14, 2, v12
    s_and_b32 s27, s26, 1
    s_lshl_b32 s27, s27, 2
    v_add_u32 v15, s27, v14
    v_xor_b32 v15, v15, v4
    v_lshlrev_b32 v15, 4, v15
    v_lshl_add_u32 v15, v14, 8, v15
    v_add_u32 v15, v15, v13
    s_mul_i32 s27, s22, 20
    buffer_load_dwordx4 a[24:27], v8, s[28:31], s36 offen offset:2048
    s_add_u32 s27, s27, s26
    s_lshl_b32 s27, s27, 10
    s_add_u32 s27, s27, 40960
    v_add_u32 v239, s27, v15
    s_mov_b32 s26, s41
    s_lshl_b32 s27, s21, 1
    v_add_u32 v14, s27, v12
    s_and_b32 s27, s26, 1
    s_lshl_b32 s27, s27, 2
    v_add_u32 v15, s27, v14
    v_xor_b32 v15, v15, v4
    v_lshlrev_b32 v15, 4, v15
    v_lshl_add_u32 v15, v14, 8, v15
    v_add_u32 v15, v15, v13
    s_mul_i32 s27, s22, 20
    s_add_u32 s27, s27, s26
    s_lshl_b32 s27, s27, 10
    buffer_load_dwordx4 a[28:31], v8, s[28:31], s36 offen offset:3072
    s_add_u32 s27, s27, 40960
    v_add_u32 v240, s27, v15
    s_lshr_b32 s26, s24, 1
    s_add_u32 s26, s26, 1
    s_sub_u32 s27, 0, s26
    s_and_b32 s42, s24, 1
    s_cmp_eq_u32 s42, 1
    s_cselect_b32 s42, s27, s26
    s_lshl_b32 s43, s23, 5
    s_lshl_b32 s26, s22, 4
    s_add_u32 s43, s43, s26
    v_add_u32 v241, s43, v4
    v_add_u32 v241, s42, v241
    s_movk_i32 s27, 2048
    v_cmp_gt_u32 s[60:61], s27, v241
    v_lshrrev_b32 v242, 4, v241
    s_add_u32 s36, s36, 4096
    buffer_load_dwordx4 a[32:35], v8, s[28:31], s36 offen offset:0
    v_and_b32 v241, 15, v241
    s_mov_b32 s27, 20480
    v_mul_lo_u32 v242, v242, s27
    v_lshl_add_u32 v242, v241, 4, v242
    v_and_b32 v241, 1, v3
    v_lshlrev_b32 v241, 9, v241
    v_lshrrev_b32 v2, 1, v3
    v_lshl_add_u32 v241, v2, 8, v241
    v_add_u32 v241, v241, v242
    s_lshl_b32 s27, s21, 9
    v_lshl_add_u32 v242, v2, 8, v242
    v_add_u32 v242, s27, v242
    v_and_b32 v2, 1, v3
    v_lshl_add_u32 v242, v2, 3, v242
    s_lshl_b32 s44, s40, 10
    s_add_u32 s44, s44, 10784768
    s_lshl_b32 s45, s41, 10
    buffer_load_dwordx4 a[36:39], v8, s[28:31], s36 offen offset:1024
    s_add_u32 s45, s45, 10784768
    s_lshl_b32 s46, s23, 2
    s_add_u32 s46, s46, s24
    s_lshl_b32 s46, s46, 7
    s_add_u32 s46, s46, 29380608
    s_mul_i32 s26, s20, 5120
    s_add_u32 s26, s26, 143360
    v_add_u32 v246, s26, v8
    s_xor_b32 s27, s20, 2
    s_mul_i32 s27, s27, 5120
    s_add_u32 s27, s27, 143360
    v_add_u32 v247, s27, v8
    v_mov_b32 v224, 0x3f803f80
    v_mov_b32 v216, 0
    v_mov_b32 v217, 0
    v_mov_b32 v220, 0
    buffer_load_dwordx4 a[40:43], v8, s[28:31], s36 offen offset:2048
    v_mov_b32 v221, 0
    v_mov_b32 v218, 0
    v_mov_b32 v219, 0
    v_mov_b32 v222, 0
    v_mov_b32 v223, 0
    buffer_load_dwordx4 a[44:47], v8, s[28:31], s36 offen offset:3072
    s_add_u32 s36, s36, 4096
    buffer_load_dwordx4 a[48:51], v8, s[28:31], s36 offen offset:0
    s_waitcnt vmcnt(13)
    s_barrier
    v_xor_b32 v12, 32, v226
    ds_read_b64 v[32:33], v226 offset:0
    buffer_load_dwordx4 a[52:55], v8, s[28:31], s36 offen offset:1024
    ds_read_b64 v[34:35], v226 offset:128
    ds_read_b64 v[36:37], v12 offset:0
    ds_read_b64 v[38:39], v12 offset:128
    ds_read_b64 v[40:41], v226 offset:4096
    ds_read_b64 v[42:43], v226 offset:4224
    s_waitcnt lgkmcnt(4)
    v_dot2_f32_bf16 v220, v32, v224, v220
    buffer_load_dwordx4 a[56:59], v8, s[28:31], s36 offen offset:2048
    v_lshlrev_b32 v72, 16, v32
    v_dot2_f32_bf16 v221, v32, v32, v221
    v_and_b32 v73, 0xffff0000, v32
    v_dot2_f32_bf16 v220, v33, v224, v220
    ds_read_b64 v[44:45], v12 offset:4096
    v_lshlrev_b32 v74, 16, v33
    v_dot2_f32_bf16 v221, v33, v33, v221
    v_and_b32 v75, 0xffff0000, v33
    v_dot2_f32_bf16 v220, v34, v224, v220
    ds_read_b64 v[46:47], v12 offset:4224
    v_lshlrev_b32 v76, 16, v34
    v_dot2_f32_bf16 v221, v34, v34, v221
    v_and_b32 v77, 0xffff0000, v34
    buffer_load_dwordx4 a[60:63], v8, s[28:31], s36 offen offset:3072
    v_dot2_f32_bf16 v220, v35, v224, v220
    v_lshlrev_b32 v78, 16, v35
    v_dot2_f32_bf16 v221, v35, v35, v221
    v_and_b32 v79, 0xffff0000, v35
    s_waitcnt lgkmcnt(4)
    v_dot2_f32_bf16 v222, v36, v224, v222
    v_lshlrev_b32 v80, 16, v36
    v_dot2_f32_bf16 v223, v36, v36, v223
    v_and_b32 v81, 0xffff0000, v36
    v_dot2_f32_bf16 v222, v37, v224, v222
    ds_read_b64 v[48:49], v226 offset:8192
    v_lshlrev_b32 v82, 16, v37
    v_dot2_f32_bf16 v223, v37, v37, v223
    v_and_b32 v83, 0xffff0000, v37
    v_dot2_f32_bf16 v222, v38, v224, v222
    s_add_u32 s36, s36, 4096
    buffer_load_dwordx4 a[64:67], v8, s[28:31], s36 offen offset:0
    ds_read_b64 v[50:51], v226 offset:8320
    v_lshlrev_b32 v84, 16, v38
    v_dot2_f32_bf16 v223, v38, v38, v223
    v_and_b32 v85, 0xffff0000, v38
    v_dot2_f32_bf16 v222, v39, v224, v222
    v_lshlrev_b32 v86, 16, v39
    v_dot2_f32_bf16 v223, v39, v39, v223
    v_and_b32 v87, 0xffff0000, v39
    s_waitcnt lgkmcnt(4)
    v_dot2_f32_bf16 v220, v40, v224, v220
    v_lshlrev_b32 v88, 16, v40
    v_dot2_f32_bf16 v221, v40, v40, v221
    v_and_b32 v89, 0xffff0000, v40
    v_dot2_f32_bf16 v220, v41, v224, v220
    ds_read_b64 v[52:53], v12 offset:8192
    buffer_load_dwordx4 a[68:71], v8, s[28:31], s36 offen offset:1024
    v_lshlrev_b32 v90, 16, v41
    v_dot2_f32_bf16 v221, v41, v41, v221
    v_and_b32 v91, 0xffff0000, v41
    v_dot2_f32_bf16 v220, v42, v224, v220
    ds_read_b64 v[54:55], v12 offset:8320
    v_lshlrev_b32 v92, 16, v42
    v_dot2_f32_bf16 v221, v42, v42, v221
    v_and_b32 v93, 0xffff0000, v42
    v_dot2_f32_bf16 v220, v43, v224, v220
    v_lshlrev_b32 v94, 16, v43
    v_dot2_f32_bf16 v221, v43, v43, v221
    v_and_b32 v95, 0xffff0000, v43
    s_waitcnt lgkmcnt(4)
    v_dot2_f32_bf16 v222, v44, v224, v222
    v_lshlrev_b32 v96, 16, v44
    buffer_load_dwordx4 a[72:75], v8, s[28:31], s36 offen offset:2048
    v_dot2_f32_bf16 v223, v44, v44, v223
    v_and_b32 v97, 0xffff0000, v44
    v_dot2_f32_bf16 v222, v45, v224, v222
    ds_read_b64 v[56:57], v226 offset:12288
    v_lshlrev_b32 v98, 16, v45
    v_dot2_f32_bf16 v223, v45, v45, v223
    v_and_b32 v99, 0xffff0000, v45
    v_dot2_f32_bf16 v222, v46, v224, v222
    ds_read_b64 v[58:59], v226 offset:12416
    v_lshlrev_b32 v100, 16, v46
    v_dot2_f32_bf16 v223, v46, v46, v223
    v_and_b32 v101, 0xffff0000, v46
    v_dot2_f32_bf16 v222, v47, v224, v222
    buffer_load_dwordx4 a[76:79], v8, s[28:31], s36 offen offset:3072
    v_lshlrev_b32 v102, 16, v47
    v_dot2_f32_bf16 v223, v47, v47, v223
    v_and_b32 v103, 0xffff0000, v47
    s_waitcnt lgkmcnt(4)
    v_dot2_f32_bf16 v220, v48, v224, v220
    v_lshlrev_b32 v104, 16, v48
    v_dot2_f32_bf16 v221, v48, v48, v221
    v_and_b32 v105, 0xffff0000, v48
    v_dot2_f32_bf16 v220, v49, v224, v220
    ds_read_b64 v[60:61], v12 offset:12288
    v_lshlrev_b32 v106, 16, v49
    v_dot2_f32_bf16 v221, v49, v49, v221
    v_and_b32 v107, 0xffff0000, v49
    v_dot2_f32_bf16 v220, v50, v224, v220
    ds_read_b64 v[62:63], v12 offset:12416
    s_add_u32 s36, s36, 4096
    buffer_load_dwordx4 a[80:83], v8, s[28:31], s36 offen offset:0
    v_lshlrev_b32 v108, 16, v50
    v_dot2_f32_bf16 v221, v50, v50, v221
    v_and_b32 v109, 0xffff0000, v50
    v_dot2_f32_bf16 v220, v51, v224, v220
    v_lshlrev_b32 v110, 16, v51
    v_dot2_f32_bf16 v221, v51, v51, v221
    v_and_b32 v111, 0xffff0000, v51
    s_waitcnt lgkmcnt(4)
    v_dot2_f32_bf16 v222, v52, v224, v222
    v_lshlrev_b32 v112, 16, v52
    v_dot2_f32_bf16 v223, v52, v52, v223
    v_and_b32 v113, 0xffff0000, v52
    v_dot2_f32_bf16 v222, v53, v224, v222
    ds_read_b64 v[64:65], v226 offset:16384
    v_lshlrev_b32 v114, 16, v53
    buffer_load_dwordx4 a[84:87], v8, s[28:31], s36 offen offset:1024
    v_dot2_f32_bf16 v223, v53, v53, v223
    v_and_b32 v115, 0xffff0000, v53
    v_dot2_f32_bf16 v222, v54, v224, v222
    ds_read_b64 v[66:67], v226 offset:16512
    v_lshlrev_b32 v116, 16, v54
    v_dot2_f32_bf16 v223, v54, v54, v223
    v_and_b32 v117, 0xffff0000, v54
    v_dot2_f32_bf16 v222, v55, v224, v222
    v_lshlrev_b32 v118, 16, v55
    v_dot2_f32_bf16 v223, v55, v55, v223
    v_and_b32 v119, 0xffff0000, v55
    s_waitcnt lgkmcnt(4)
    v_dot2_f32_bf16 v220, v56, v224, v220
    v_lshlrev_b32 v120, 16, v56
    v_dot2_f32_bf16 v221, v56, v56, v221
    buffer_load_dwordx4 a[88:91], v8, s[28:31], s36 offen offset:2048
    v_and_b32 v121, 0xffff0000, v56
    v_dot2_f32_bf16 v220, v57, v224, v220
    ds_read_b64 v[68:69], v12 offset:16384
    v_lshlrev_b32 v122, 16, v57
    v_dot2_f32_bf16 v221, v57, v57, v221
    v_and_b32 v123, 0xffff0000, v57
    v_dot2_f32_bf16 v220, v58, v224, v220
    ds_read_b64 v[70:71], v12 offset:16512
    v_lshlrev_b32 v124, 16, v58
    v_dot2_f32_bf16 v221, v58, v58, v221
    v_and_b32 v125, 0xffff0000, v58
    v_dot2_f32_bf16 v220, v59, v224, v220
    v_lshlrev_b32 v126, 16, v59
    buffer_load_dwordx4 a[92:95], v8, s[28:31], s36 offen offset:3072
    v_dot2_f32_bf16 v221, v59, v59, v221
    v_and_b32 v127, 0xffff0000, v59
    s_waitcnt lgkmcnt(4)
    v_dot2_f32_bf16 v222, v60, v224, v222
    v_lshlrev_b32 v128, 16, v60
    v_dot2_f32_bf16 v223, v60, v60, v223
    v_and_b32 v129, 0xffff0000, v60
    v_dot2_f32_bf16 v222, v61, v224, v222
    v_lshlrev_b32 v130, 16, v61
    v_dot2_f32_bf16 v223, v61, v61, v223
    v_and_b32 v131, 0xffff0000, v61
    v_dot2_f32_bf16 v222, v62, v224, v222
    v_lshlrev_b32 v132, 16, v62
    v_dot2_f32_bf16 v223, v62, v62, v223
    v_and_b32 v133, 0xffff0000, v62
    v_dot2_f32_bf16 v222, v63, v224, v222
    v_lshlrev_b32 v134, 16, v63
    s_add_u32 s36, s36, 4096
    buffer_load_dwordx4 a[96:99], v8, s[28:31], s36 offen offset:0
    v_dot2_f32_bf16 v223, v63, v63, v223
    v_and_b32 v135, 0xffff0000, v63
    s_waitcnt lgkmcnt(2)
    v_dot2_f32_bf16 v220, v64, v224, v220
    v_lshlrev_b32 v136, 16, v64
    v_dot2_f32_bf16 v221, v64, v64, v221
    v_and_b32 v137, 0xffff0000, v64
    v_dot2_f32_bf16 v220, v65, v224, v220
    v_lshlrev_b32 v138, 16, v65
    v_dot2_f32_bf16 v221, v65, v65, v221
    v_and_b32 v139, 0xffff0000, v65
    v_dot2_f32_bf16 v220, v66, v224, v220
    v_lshlrev_b32 v140, 16, v66
    v_dot2_f32_bf16 v221, v66, v66, v221
    v_and_b32 v141, 0xffff0000, v66
    v_dot2_f32_bf16 v220, v67, v224, v220
    v_lshlrev_b32 v142, 16, v67
    buffer_load_dwordx4 a[100:103], v8, s[28:31], s36 offen offset:1024
    v_dot2_f32_bf16 v221, v67, v67, v221
    v_and_b32 v143, 0xffff0000, v67
    s_waitcnt lgkmcnt(0)
    v_dot2_f32_bf16 v222, v68, v224, v222
    v_lshlrev_b32 v144, 16, v68
    v_dot2_f32_bf16 v223, v68, v68, v223
    v_and_b32 v145, 0xffff0000, v68
    v_dot2_f32_bf16 v222, v69, v224, v222
    v_lshlrev_b32 v146, 16, v69
    v_dot2_f32_bf16 v223, v69, v69, v223
    v_and_b32 v147, 0xffff0000, v69
    v_dot2_f32_bf16 v222, v70, v224, v222
    v_lshlrev_b32 v148, 16, v70
    v_dot2_f32_bf16 v223, v70, v70, v223
    v_and_b32 v149, 0xffff0000, v70
    v_dot2_f32_bf16 v222, v71, v224, v222
    v_lshlrev_b32 v150, 16, v71
    buffer_load_dwordx4 a[104:107], v8, s[28:31], s36 offen offset:2048
    v_dot2_f32_bf16 v223, v71, v71, v223
    v_and_b32 v151, 0xffff0000, v71
    s_nop 2
    s_nop 1
    v_add_f32_dpp v220, v220, v220 quad_perm:[1,0,3,2] row_mask:0xf bank_mask:0xf
    v_add_f32_dpp v221, v221, v221 quad_perm:[1,0,3,2] row_mask:0xf bank_mask:0xf
    v_add_f32_dpp v222, v222, v222 quad_perm:[1,0,3,2] row_mask:0xf bank_mask:0xf
    v_add_f32_dpp v223, v223, v223 quad_perm:[1,0,3,2] row_mask:0xf bank_mask:0xf
    v_add_f32_dpp v220, v220, v220 quad_perm:[2,3,0,1] row_mask:0xf bank_mask:0xf
    v_add_f32_dpp v221, v221, v221 quad_perm:[2,3,0,1] row_mask:0xf bank_mask:0xf
    v_add_f32_dpp v222, v222, v222 quad_perm:[2,3,0,1] row_mask:0xf bank_mask:0xf
    v_add_f32_dpp v223, v223, v223 quad_perm:[2,3,0,1] row_mask:0xf bank_mask:0xf
    v_add_f32_dpp v220, v220, v220 row_half_mirror row_mask:0xf bank_mask:0xf
    v_add_f32_dpp v221, v221, v221 row_half_mirror row_mask:0xf bank_mask:0xf
    v_add_f32_dpp v222, v222, v222 row_half_mirror row_mask:0xf bank_mask:0xf
    v_add_f32_dpp v223, v223, v223 row_half_mirror row_mask:0xf bank_mask:0xf
    v_add_f32_dpp v220, v220, v220 row_mirror row_mask:0xf bank_mask:0xf
    buffer_load_dwordx4 a[108:111], v8, s[28:31], s36 offen offset:3072
    v_add_f32_dpp v221, v221, v221 row_mirror row_mask:0xf bank_mask:0xf
    v_add_f32_dpp v222, v222, v222 row_mirror row_mask:0xf bank_mask:0xf
    v_add_f32_dpp v223, v223, v223 row_mirror row_mask:0xf bank_mask:0xf
    v_mul_f32 v220, 0x3acccccd, v220
    v_mul_f32 v222, 0x3acccccd, v222
    v_mul_f32 v221, 0x3acccccd, v221
    v_mul_f32 v223, 0x3acccccd, v223
    v_fma_f32 v221, -v220, v220, v221
    v_fma_f32 v223, -v222, v222, v223
    v_max_f32 v221, 0, v221
    v_max_f32 v223, 0, v223
    v_cvt_pk_bf16_f32 v192, v220, v221
    v_cvt_pk_bf16_f32 v193, v222, v223
    v_lshlrev_b32 v220, 16, v192
    v_lshlrev_b32 v222, 16, v193
    v_and_b32 v221, 0xffff0000, v192
    v_and_b32 v223, 0xffff0000, v193
    s_add_u32 s36, s36, 4096
    buffer_load_dwordx4 a[112:115], v8, s[28:31], s36 offen offset:0
    v_add_f32 v221, 0x3727c5ac, v221
    v_add_f32 v223, 0x3727c5ac, v223
    v_cvt_pk_bf16_f32 v192, v221, v221
    v_cvt_pk_bf16_f32 v193, v223, v223
    v_lshlrev_b32 v221, 16, v192
    v_lshlrev_b32 v223, 16, v193
    v_sqrt_f32 v221, v221
    v_sqrt_f32 v223, v223
    s_nop 0
    s_nop 0
    v_cvt_pk_bf16_f32 v192, v221, v221
    v_cvt_pk_bf16_f32 v193, v223, v223
    v_lshlrev_b32 v221, 16, v192
    v_lshlrev_b32 v223, 16, v193
    v_rcp_f32 v221, v221
    buffer_load_dwordx4 a[116:119], v8, s[28:31], s36 offen offset:1024
    v_rcp_f32 v223, v223
    s_nop 0
    s_nop 0
    v_mul_f32 v220, v220, v221
    v_mul_f32 v222, v222, v223
    v_sub_f32 v220, 0, v220
    v_sub_f32 v222, 0, v222
    v_mov_b32 v216, 0
    v_mov_b32 v217, 0
    v_mov_b32 v218, 0
    v_mov_b32 v219, 0
    v_xor_b32 v12, 64, v228
    ds_read_b128 v[152:155], v227 offset:10240
    ds_read_b128 v[156:159], v227 offset:10256
    buffer_load_dwordx4 a[120:123], v8, s[28:31], s36 offen offset:2048
    ds_read_b128 v[160:163], v227 offset:7680
    ds_read_b128 v[164:167], v227 offset:7696
    s_waitcnt lgkmcnt(0)
    v_pk_fma_f32 v[72:73], v[72:73], v[220:221], v[220:221] op_sel:[0,1,0] op_sel_hi:[1,1,0]
    v_pk_fma_f32 v[74:75], v[74:75], v[220:221], v[220:221] op_sel:[0,1,0] op_sel_hi:[1,1,0]
    v_pk_fma_f32 v[76:77], v[76:77], v[220:221], v[220:221] op_sel:[0,1,0] op_sel_hi:[1,1,0]
    ds_read_b128 v[168:171], v227 offset:10752
    v_pk_fma_f32 v[78:79], v[78:79], v[220:221], v[220:221] op_sel:[0,1,0] op_sel_hi:[1,1,0]
    v_pk_fma_f32 v[72:73], v[72:73], v[152:153], v[160:161]
    v_pk_fma_f32 v[74:75], v[74:75], v[154:155], v[162:163]
    ds_read_b128 v[172:175], v227 offset:10768
    buffer_load_dwordx4 a[124:127], v8, s[28:31], s36 offen offset:3072
    v_pk_fma_f32 v[76:77], v[76:77], v[156:157], v[164:165]
    v_pk_fma_f32 v[78:79], v[78:79], v[158:159], v[166:167]
    v_cvt_pk_bf16_f32 v32, v72, v73
    ds_read_b128 v[176:179], v227 offset:8192
    v_cvt_pk_bf16_f32 v33, v74, v75
    v_cvt_pk_bf16_f32 v34, v76, v77
    v_cvt_pk_bf16_f32 v35, v78, v79
    ds_read_b128 v[180:183], v227 offset:8208
    v_dot2_f32_bf16 v216, v32, v224, v216
    v_dot2_f32_bf16 v217, v32, v32, v217
    v_dot2_f32_bf16 v216, v33, v224, v216
    v_dot2_f32_bf16 v217, v33, v33, v217
    v_dot2_f32_bf16 v216, v34, v224, v216
    s_add_u32 s36, s36, 4096
    buffer_load_dwordx4 a[128:131], v8, s[28:31], s36 offen offset:0
    v_dot2_f32_bf16 v217, v34, v34, v217
    v_dot2_f32_bf16 v216, v35, v224, v216
    v_dot2_f32_bf16 v217, v35, v35, v217
    ds_write_b128 v228, v[32:35] offset:0
    v_pk_fma_f32 v[80:81], v[80:81], v[222:223], v[222:223] op_sel:[0,1,0] op_sel_hi:[1,1,0]
    v_pk_fma_f32 v[82:83], v[82:83], v[222:223], v[222:223] op_sel:[0,1,0] op_sel_hi:[1,1,0]
    v_pk_fma_f32 v[84:85], v[84:85], v[222:223], v[222:223] op_sel:[0,1,0] op_sel_hi:[1,1,0]
    v_pk_fma_f32 v[86:87], v[86:87], v[222:223], v[222:223] op_sel:[0,1,0] op_sel_hi:[1,1,0]
    v_pk_fma_f32 v[80:81], v[80:81], v[152:153], v[160:161]
    v_pk_fma_f32 v[82:83], v[82:83], v[154:155], v[162:163]
    buffer_load_dwordx4 a[132:135], v8, s[28:31], s36 offen offset:1024
    v_pk_fma_f32 v[84:85], v[84:85], v[156:157], v[164:165]
    v_pk_fma_f32 v[86:87], v[86:87], v[158:159], v[166:167]
    v_cvt_pk_bf16_f32 v36, v80, v81
    v_cvt_pk_bf16_f32 v37, v82, v83
    v_cvt_pk_bf16_f32 v38, v84, v85
    v_cvt_pk_bf16_f32 v39, v86, v87
    v_dot2_f32_bf16 v218, v36, v224, v218
    v_dot2_f32_bf16 v219, v36, v36, v219
    v_dot2_f32_bf16 v218, v37, v224, v218
    v_dot2_f32_bf16 v219, v37, v37, v219
    v_dot2_f32_bf16 v218, v38, v224, v218
    v_dot2_f32_bf16 v219, v38, v38, v219
    v_dot2_f32_bf16 v218, v39, v224, v218
    v_dot2_f32_bf16 v219, v39, v39, v219
    ds_write_b128 v12, v[36:39] offset:0
    buffer_load_dwordx4 a[136:139], v8, s[28:31], s36 offen offset:2048
    s_waitcnt lgkmcnt(1)
    v_pk_fma_f32 v[88:89], v[88:89], v[220:221], v[220:221] op_sel:[0,1,0] op_sel_hi:[1,1,0]
    v_pk_fma_f32 v[90:91], v[90:91], v[220:221], v[220:221] op_sel:[0,1,0] op_sel_hi:[1,1,0]
    v_pk_fma_f32 v[92:93], v[92:93], v[220:221], v[220:221] op_sel:[0,1,0] op_sel_hi:[1,1,0]
    ds_read_b128 v[152:155], v227 offset:11264
    v_pk_fma_f32 v[94:95], v[94:95], v[220:221], v[220:221] op_sel:[0,1,0] op_sel_hi:[1,1,0]
    v_pk_fma_f32 v[88:89], v[88:89], v[168:169], v[176:177]
    v_pk_fma_f32 v[90:91], v[90:91], v[170:171], v[178:179]
    ds_read_b128 v[156:159], v227 offset:11280
    v_pk_fma_f32 v[92:93], v[92:93], v[172:173], v[180:181]
    v_pk_fma_f32 v[94:95], v[94:95], v[174:175], v[182:183]
    v_cvt_pk_bf16_f32 v40, v88, v89
    ds_read_b128 v[160:163], v227 offset:8704
    buffer_load_dwordx4 a[140:143], v8, s[28:31], s36 offen offset:3072
    v_cvt_pk_bf16_f32 v41, v90, v91
    v_cvt_pk_bf16_f32 v42, v92, v93
    v_cvt_pk_bf16_f32 v43, v94, v95
    ds_read_b128 v[164:167], v227 offset:8720
    v_dot2_f32_bf16 v216, v40, v224, v216
    v_dot2_f32_bf16 v217, v40, v40, v217
    v_dot2_f32_bf16 v216, v41, v224, v216
    v_dot2_f32_bf16 v217, v41, v41, v217
    v_dot2_f32_bf16 v216, v42, v224, v216
    v_dot2_f32_bf16 v217, v42, v42, v217
    v_dot2_f32_bf16 v216, v43, v224, v216
    v_dot2_f32_bf16 v217, v43, v43, v217
    ds_write_b128 v228, v[40:43] offset:4096
    s_add_u32 s36, s36, 4096
    buffer_load_dwordx4 a[144:147], v8, s[28:31], s36 offen offset:0
    v_pk_fma_f32 v[96:97], v[96:97], v[222:223], v[222:223] op_sel:[0,1,0] op_sel_hi:[1,1,0]
    v_pk_fma_f32 v[98:99], v[98:99], v[222:223], v[222:223] op_sel:[0,1,0] op_sel_hi:[1,1,0]
    v_pk_fma_f32 v[100:101], v[100:101], v[222:223], v[222:223] op_sel:[0,1,0] op_sel_hi:[1,1,0]
    v_pk_fma_f32 v[102:103], v[102:103], v[222:223], v[222:223] op_sel:[0,1,0] op_sel_hi:[1,1,0]
    v_pk_fma_f32 v[96:97], v[96:97], v[168:169], v[176:177]
    v_pk_fma_f32 v[98:99], v[98:99], v[170:171], v[178:179]
    v_pk_fma_f32 v[100:101], v[100:101], v[172:173], v[180:181]
    v_pk_fma_f32 v[102:103], v[102:103], v[174:175], v[182:183]
    v_cvt_pk_bf16_f32 v44, v96, v97
    v_cvt_pk_bf16_f32 v45, v98, v99
    v_cvt_pk_bf16_f32 v46, v100, v101
    v_cvt_pk_bf16_f32 v47, v102, v103
    v_dot2_f32_bf16 v218, v44, v224, v218
    v_dot2_f32_bf16 v219, v44, v44, v219
    v_dot2_f32_bf16 v218, v45, v224, v218
    v_dot2_f32_bf16 v219, v45, v45, v219
    v_dot2_f32_bf16 v218, v46, v224, v218
    buffer_load_dwordx4 a[148:151], v8, s[28:31], s36 offen offset:1024
    v_dot2_f32_bf16 v219, v46, v46, v219
    v_dot2_f32_bf16 v218, v47, v224, v218
    v_dot2_f32_bf16 v219, v47, v47, v219
    ds_write_b128 v12, v[44:47] offset:4096
    s_waitcnt lgkmcnt(1)
    v_pk_fma_f32 v[104:105], v[104:105], v[220:221], v[220:221] op_sel:[0,1,0] op_sel_hi:[1,1,0]
    v_pk_fma_f32 v[106:107], v[106:107], v[220:221], v[220:221] op_sel:[0,1,0] op_sel_hi:[1,1,0]
    v_pk_fma_f32 v[108:109], v[108:109], v[220:221], v[220:221] op_sel:[0,1,0] op_sel_hi:[1,1,0]
    ds_read_b128 v[168:171], v227 offset:11776
    buffer_load_dwordx4 a[152:155], v8, s[28:31], s36 offen offset:2048
    v_pk_fma_f32 v[110:111], v[110:111], v[220:221], v[220:221] op_sel:[0,1,0] op_sel_hi:[1,1,0]
    v_pk_fma_f32 v[104:105], v[104:105], v[152:153], v[160:161]
    v_pk_fma_f32 v[106:107], v[106:107], v[154:155], v[162:163]
    ds_read_b128 v[172:175], v227 offset:11792
    v_pk_fma_f32 v[108:109], v[108:109], v[156:157], v[164:165]
    v_pk_fma_f32 v[110:111], v[110:111], v[158:159], v[166:167]
    v_cvt_pk_bf16_f32 v48, v104, v105
    ds_read_b128 v[176:179], v227 offset:9216
    v_cvt_pk_bf16_f32 v49, v106, v107
    v_cvt_pk_bf16_f32 v50, v108, v109
    v_cvt_pk_bf16_f32 v51, v110, v111
    ds_read_b128 v[180:183], v227 offset:9232
    buffer_load_dwordx4 a[156:159], v8, s[28:31], s36 offen offset:3072
    v_dot2_f32_bf16 v216, v48, v224, v216
    v_dot2_f32_bf16 v217, v48, v48, v217
    v_dot2_f32_bf16 v216, v49, v224, v216
    v_dot2_f32_bf16 v217, v49, v49, v217
    v_dot2_f32_bf16 v216, v50, v224, v216
    v_dot2_f32_bf16 v217, v50, v50, v217
    v_dot2_f32_bf16 v216, v51, v224, v216
    v_dot2_f32_bf16 v217, v51, v51, v217
    ds_write_b128 v228, v[48:51] offset:8192
    v_pk_fma_f32 v[112:113], v[112:113], v[222:223], v[222:223] op_sel:[0,1,0] op_sel_hi:[1,1,0]
    s_add_u32 s36, s36, 4096
    buffer_load_dwordx4 a[160:163], v8, s[28:31], s36 offen offset:0
    v_pk_fma_f32 v[114:115], v[114:115], v[222:223], v[222:223] op_sel:[0,1,0] op_sel_hi:[1,1,0]
    v_pk_fma_f32 v[116:117], v[116:117], v[222:223], v[222:223] op_sel:[0,1,0] op_sel_hi:[1,1,0]
    v_pk_fma_f32 v[118:119], v[118:119], v[222:223], v[222:223] op_sel:[0,1,0] op_sel_hi:[1,1,0]
    v_pk_fma_f32 v[112:113], v[112:113], v[152:153], v[160:161]
    v_pk_fma_f32 v[114:115], v[114:115], v[154:155], v[162:163]
    v_pk_fma_f32 v[116:117], v[116:117], v[156:157], v[164:165]
    v_pk_fma_f32 v[118:119], v[118:119], v[158:159], v[166:167]
    v_cvt_pk_bf16_f32 v52, v112, v113
    v_cvt_pk_bf16_f32 v53, v114, v115
    v_cvt_pk_bf16_f32 v54, v116, v117
    v_cvt_pk_bf16_f32 v55, v118, v119
    v_dot2_f32_bf16 v218, v52, v224, v218
    v_dot2_f32_bf16 v219, v52, v52, v219
    v_dot2_f32_bf16 v218, v53, v224, v218
    v_dot2_f32_bf16 v219, v53, v53, v219
    v_dot2_f32_bf16 v218, v54, v224, v218
    v_dot2_f32_bf16 v219, v54, v54, v219
    buffer_load_dwordx4 a[164:167], v8, s[28:31], s36 offen offset:1024
    v_dot2_f32_bf16 v218, v55, v224, v218
    v_dot2_f32_bf16 v219, v55, v55, v219
    ds_write_b128 v12, v[52:55] offset:8192
    s_waitcnt lgkmcnt(1)
    v_pk_fma_f32 v[120:121], v[120:121], v[220:221], v[220:221] op_sel:[0,1,0] op_sel_hi:[1,1,0]
    v_pk_fma_f32 v[122:123], v[122:123], v[220:221], v[220:221] op_sel:[0,1,0] op_sel_hi:[1,1,0]
    v_pk_fma_f32 v[124:125], v[124:125], v[220:221], v[220:221] op_sel:[0,1,0] op_sel_hi:[1,1,0]
    ds_read_b128 v[152:155], v227 offset:12288
    buffer_load_dwordx4 a[168:171], v8, s[28:31], s36 offen offset:2048
    v_pk_fma_f32 v[126:127], v[126:127], v[220:221], v[220:221] op_sel:[0,1,0] op_sel_hi:[1,1,0]
    v_pk_fma_f32 v[120:121], v[120:121], v[168:169], v[176:177]
    v_pk_fma_f32 v[122:123], v[122:123], v[170:171], v[178:179]
    ds_read_b128 v[156:159], v227 offset:12304
    v_pk_fma_f32 v[124:125], v[124:125], v[172:173], v[180:181]
    v_pk_fma_f32 v[126:127], v[126:127], v[174:175], v[182:183]
    v_cvt_pk_bf16_f32 v56, v120, v121
    ds_read_b128 v[160:163], v227 offset:9728
    v_cvt_pk_bf16_f32 v57, v122, v123
    v_cvt_pk_bf16_f32 v58, v124, v125
    v_cvt_pk_bf16_f32 v59, v126, v127
    ds_read_b128 v[164:167], v227 offset:9744
    buffer_load_dwordx4 a[172:175], v8, s[28:31], s36 offen offset:3072
    v_dot2_f32_bf16 v216, v56, v224, v216
    v_dot2_f32_bf16 v217, v56, v56, v217
    v_dot2_f32_bf16 v216, v57, v224, v216
    v_dot2_f32_bf16 v217, v57, v57, v217
    v_dot2_f32_bf16 v216, v58, v224, v216
    v_dot2_f32_bf16 v217, v58, v58, v217
    v_dot2_f32_bf16 v216, v59, v224, v216
    v_dot2_f32_bf16 v217, v59, v59, v217
    ds_write_b128 v228, v[56:59] offset:12288
    v_pk_fma_f32 v[128:129], v[128:129], v[222:223], v[222:223] op_sel:[0,1,0] op_sel_hi:[1,1,0]
    s_add_u32 s36, s36, 4096
    buffer_load_dwordx4 a[176:179], v8, s[28:31], s36 offen offset:0
    v_pk_fma_f32 v[130:131], v[130:131], v[222:223], v[222:223] op_sel:[0,1,0] op_sel_hi:[1,1,0]
    v_pk_fma_f32 v[132:133], v[132:133], v[222:223], v[222:223] op_sel:[0,1,0] op_sel_hi:[1,1,0]
    v_pk_fma_f32 v[134:135], v[134:135], v[222:223], v[222:223] op_sel:[0,1,0] op_sel_hi:[1,1,0]
    v_pk_fma_f32 v[128:129], v[128:129], v[168:169], v[176:177]
    v_pk_fma_f32 v[130:131], v[130:131], v[170:171], v[178:179]
    v_pk_fma_f32 v[132:133], v[132:133], v[172:173], v[180:181]
    v_pk_fma_f32 v[134:135], v[134:135], v[174:175], v[182:183]
    v_cvt_pk_bf16_f32 v60, v128, v129
    v_cvt_pk_bf16_f32 v61, v130, v131
    v_cvt_pk_bf16_f32 v62, v132, v133
    v_cvt_pk_bf16_f32 v63, v134, v135
    v_dot2_f32_bf16 v218, v60, v224, v218
    v_dot2_f32_bf16 v219, v60, v60, v219
    v_dot2_f32_bf16 v218, v61, v224, v218
    v_dot2_f32_bf16 v219, v61, v61, v219
    v_dot2_f32_bf16 v218, v62, v224, v218
    v_dot2_f32_bf16 v219, v62, v62, v219
    buffer_load_dwordx4 a[180:183], v8, s[28:31], s36 offen offset:1024
    v_dot2_f32_bf16 v218, v63, v224, v218
    v_dot2_f32_bf16 v219, v63, v63, v219
    ds_write_b128 v12, v[60:63] offset:12288
    s_waitcnt lgkmcnt(1)
    v_pk_fma_f32 v[136:137], v[136:137], v[220:221], v[220:221] op_sel:[0,1,0] op_sel_hi:[1,1,0]
    v_pk_fma_f32 v[138:139], v[138:139], v[220:221], v[220:221] op_sel:[0,1,0] op_sel_hi:[1,1,0]
    v_pk_fma_f32 v[140:141], v[140:141], v[220:221], v[220:221] op_sel:[0,1,0] op_sel_hi:[1,1,0]
    v_pk_fma_f32 v[142:143], v[142:143], v[220:221], v[220:221] op_sel:[0,1,0] op_sel_hi:[1,1,0]
    v_pk_fma_f32 v[136:137], v[136:137], v[152:153], v[160:161]
    v_pk_fma_f32 v[138:139], v[138:139], v[154:155], v[162:163]
    buffer_load_dwordx4 a[184:187], v8, s[28:31], s36 offen offset:2048
    v_pk_fma_f32 v[140:141], v[140:141], v[156:157], v[164:165]
    v_pk_fma_f32 v[142:143], v[142:143], v[158:159], v[166:167]
    v_cvt_pk_bf16_f32 v64, v136, v137
    v_cvt_pk_bf16_f32 v65, v138, v139
    v_cvt_pk_bf16_f32 v66, v140, v141
    v_cvt_pk_bf16_f32 v67, v142, v143
    v_dot2_f32_bf16 v216, v64, v224, v216
    v_dot2_f32_bf16 v217, v64, v64, v217
    v_dot2_f32_bf16 v216, v65, v224, v216
    v_dot2_f32_bf16 v217, v65, v65, v217
    v_dot2_f32_bf16 v216, v66, v224, v216
    v_dot2_f32_bf16 v217, v66, v66, v217
    v_dot2_f32_bf16 v216, v67, v224, v216
    v_dot2_f32_bf16 v217, v67, v67, v217
    ds_write_b128 v228, v[64:67] offset:16384
    buffer_load_dwordx4 a[188:191], v8, s[28:31], s36 offen offset:3072
    v_pk_fma_f32 v[144:145], v[144:145], v[222:223], v[222:223] op_sel:[0,1,0] op_sel_hi:[1,1,0]
    v_pk_fma_f32 v[146:147], v[146:147], v[222:223], v[222:223] op_sel:[0,1,0] op_sel_hi:[1,1,0]
    v_pk_fma_f32 v[148:149], v[148:149], v[222:223], v[222:223] op_sel:[0,1,0] op_sel_hi:[1,1,0]
    v_pk_fma_f32 v[150:151], v[150:151], v[222:223], v[222:223] op_sel:[0,1,0] op_sel_hi:[1,1,0]
    v_pk_fma_f32 v[144:145], v[144:145], v[152:153], v[160:161]
    v_pk_fma_f32 v[146:147], v[146:147], v[154:155], v[162:163]
    v_pk_fma_f32 v[148:149], v[148:149], v[156:157], v[164:165]
    v_pk_fma_f32 v[150:151], v[150:151], v[158:159], v[166:167]
    v_cvt_pk_bf16_f32 v68, v144, v145
    v_cvt_pk_bf16_f32 v69, v146, v147
    v_cvt_pk_bf16_f32 v70, v148, v149
    v_cvt_pk_bf16_f32 v71, v150, v151
    v_dot2_f32_bf16 v218, v68, v224, v218
    v_dot2_f32_bf16 v219, v68, v68, v219
    v_dot2_f32_bf16 v218, v69, v224, v218
    v_dot2_f32_bf16 v219, v69, v69, v219
    v_dot2_f32_bf16 v218, v70, v224, v218
    s_add_u32 s36, s36, 4096
    buffer_load_dwordx4 a[192:195], v8, s[28:31], s36 offen offset:0
    v_dot2_f32_bf16 v219, v70, v70, v219
    v_dot2_f32_bf16 v218, v71, v224, v218
    v_dot2_f32_bf16 v219, v71, v71, v219
    ds_write_b128 v12, v[68:71] offset:16384
    buffer_load_dwordx4 a[196:199], v8, s[28:31], s36 offen offset:1024
    s_waitcnt lgkmcnt(0)
    s_barrier
    buffer_load_dwordx4 a[200:203], v8, s[28:31], s37 offen offset:0
    ds_read_b128 v[72:75], v229 offset:0
    ds_read_b128 v[76:79], v231 offset:0
    s_waitcnt vmcnt(46) lgkmcnt(0)
    v_mfma_f32_16x16x32_bf16 v[32:35], a[0:3], v[72:75], 0
    v_mfma_f32_16x16x32_bf16 v[52:55], a[0:3], v[76:79], 0
    ds_read_b128 v[80:83], v230 offset:1024
    buffer_load_dwordx4 a[204:207], v8, s[28:31], s37 offen offset:1024
    v_mfma_f32_16x16x32_bf16 v[36:39], a[4:7], v[72:75], 0
    v_mfma_f32_16x16x32_bf16 v[56:59], a[4:7], v[76:79], 0
    ds_read_b128 v[84:87], v232 offset:1024
    v_mfma_f32_16x16x32_bf16 v[40:43], a[8:11], v[72:75], 0
    v_mfma_f32_16x16x32_bf16 v[60:63], a[8:11], v[76:79], 0
    buffer_load_dwordx4 a[208:211], v8, s[28:31], s37 offen offset:2048
    ds_read_b128 v[112:115], v233 offset:0
    v_mfma_f32_16x16x32_bf16 v[44:47], a[12:15], v[72:75], 0
    v_mfma_f32_16x16x32_bf16 v[64:67], a[12:15], v[76:79], 0
    ds_read_b128 v[132:135], v233 offset:1024
    v_mfma_f32_16x16x32_bf16 v[48:51], a[16:19], v[72:75], 0
    buffer_load_dwordx4 a[212:215], v8, s[28:31], s37 offen offset:3072
    v_mfma_f32_16x16x32_bf16 v[68:71], a[16:19], v[76:79], 0
    s_waitcnt vmcnt(44) lgkmcnt(0)
    v_mfma_f32_16x16x32_bf16 v[32:35], a[20:23], v[80:83], v[32:35]
    v_add_f32_dpp v216, v216, v216 quad_perm:[1,0,3,2] row_mask:0xf bank_mask:0xf
    v_mfma_f32_16x16x32_bf16 v[52:55], a[20:23], v[84:87], v[52:55]
    ds_read_b128 v[72:75], v229 offset:2048
    v_mfma_f32_16x16x32_bf16 v[36:39], a[24:27], v[80:83], v[36:39]
    s_add_u32 s37, s37, 4096
    buffer_load_dwordx4 a[216:219], v8, s[28:31], s37 offen offset:0
    v_add_f32_dpp v217, v217, v217 quad_perm:[1,0,3,2] row_mask:0xf bank_mask:0xf
    v_mfma_f32_16x16x32_bf16 v[56:59], a[24:27], v[84:87], v[56:59]
    ds_read_b128 v[76:79], v231 offset:2048
    v_mfma_f32_16x16x32_bf16 v[40:43], a[28:31], v[80:83], v[40:43]
    v_add_f32_dpp v218, v218, v218 quad_perm:[1,0,3,2] row_mask:0xf bank_mask:0xf
    v_mfma_f32_16x16x32_bf16 v[60:63], a[28:31], v[84:87], v[60:63]
    ds_read_b128 v[116:119], v233 offset:64
    buffer_load_dwordx4 a[220:223], v8, s[28:31], s37 offen offset:1024
    v_mfma_f32_16x16x32_bf16 v[44:47], a[32:35], v[80:83], v[44:47]
    v_add_f32_dpp v219, v219, v219 quad_perm:[1,0,3,2] row_mask:0xf bank_mask:0xf
    v_mfma_f32_16x16x32_bf16 v[64:67], a[32:35], v[84:87], v[64:67]
    ds_read_b128 v[136:139], v233 offset:1088
    v_mfma_f32_16x16x32_bf16 v[48:51], a[36:39], v[80:83], v[48:51]
    v_add_f32_dpp v216, v216, v216 quad_perm:[2,3,0,1] row_mask:0xf bank_mask:0xf
    v_mfma_f32_16x16x32_bf16 v[68:71], a[36:39], v[84:87], v[68:71]
    buffer_load_dwordx4 a[224:227], v8, s[28:31], s37 offen offset:2048
    v_add_f32_dpp v217, v217, v217 quad_perm:[2,3,0,1] row_mask:0xf bank_mask:0xf
    s_waitcnt vmcnt(42) lgkmcnt(0)
    v_mfma_f32_16x16x32_bf16 v[32:35], a[40:43], v[72:75], v[32:35]
    v_add_f32_dpp v218, v218, v218 quad_perm:[2,3,0,1] row_mask:0xf bank_mask:0xf
    v_mfma_f32_16x16x32_bf16 v[52:55], a[40:43], v[76:79], v[52:55]
    ds_read_b128 v[80:83], v230 offset:3072
    v_mfma_f32_16x16x32_bf16 v[36:39], a[44:47], v[72:75], v[36:39]
    buffer_load_dwordx4 a[228:231], v8, s[28:31], s37 offen offset:3072
    v_add_f32_dpp v219, v219, v219 quad_perm:[2,3,0,1] row_mask:0xf bank_mask:0xf
    v_mfma_f32_16x16x32_bf16 v[56:59], a[44:47], v[76:79], v[56:59]
    ds_read_b128 v[84:87], v232 offset:3072
    v_mfma_f32_16x16x32_bf16 v[40:43], a[48:51], v[72:75], v[40:43]
    v_add_f32_dpp v216, v216, v216 row_half_mirror row_mask:0xf bank_mask:0xf
    v_mfma_f32_16x16x32_bf16 v[60:63], a[48:51], v[76:79], v[60:63]
    ds_read_b128 v[120:123], v233 offset:128
    s_add_u32 s37, s37, 4096
    buffer_load_dwordx4 a[232:235], v8, s[28:31], s37 offen offset:0
    v_mfma_f32_16x16x32_bf16 v[44:47], a[52:55], v[72:75], v[44:47]
    v_add_f32_dpp v217, v217, v217 row_half_mirror row_mask:0xf bank_mask:0xf
    v_mfma_f32_16x16x32_bf16 v[64:67], a[52:55], v[76:79], v[64:67]
    ds_read_b128 v[140:143], v233 offset:1152
    v_mfma_f32_16x16x32_bf16 v[48:51], a[56:59], v[72:75], v[48:51]
    v_add_f32_dpp v218, v218, v218 row_half_mirror row_mask:0xf bank_mask:0xf
    v_mfma_f32_16x16x32_bf16 v[68:71], a[56:59], v[76:79], v[68:71]
    buffer_load_dwordx4 a[236:239], v8, s[28:31], s37 offen offset:1024
    v_add_f32_dpp v219, v219, v219 row_half_mirror row_mask:0xf bank_mask:0xf
    s_waitcnt vmcnt(40) lgkmcnt(0)
    v_mfma_f32_16x16x32_bf16 v[32:35], a[60:63], v[80:83], v[32:35]
    v_add_f32_dpp v216, v216, v216 row_mirror row_mask:0xf bank_mask:0xf
    v_mfma_f32_16x16x32_bf16 v[52:55], a[60:63], v[84:87], v[52:55]
    ds_read_b128 v[72:75], v229 offset:4096
    v_mfma_f32_16x16x32_bf16 v[36:39], a[64:67], v[80:83], v[36:39]
    buffer_load_dwordx4 a[240:243], v8, s[28:31], s37 offen offset:2048
    v_add_f32_dpp v217, v217, v217 row_mirror row_mask:0xf bank_mask:0xf
    v_mfma_f32_16x16x32_bf16 v[56:59], a[64:67], v[84:87], v[56:59]
    ds_read_b128 v[76:79], v231 offset:4096
    v_mfma_f32_16x16x32_bf16 v[40:43], a[68:71], v[80:83], v[40:43]
    v_add_f32_dpp v218, v218, v218 row_mirror row_mask:0xf bank_mask:0xf
    v_mfma_f32_16x16x32_bf16 v[60:63], a[68:71], v[84:87], v[60:63]
    ds_read_b128 v[124:127], v233 offset:192
    buffer_load_dwordx4 a[244:247], v8, s[28:31], s37 offen offset:3072
    v_mfma_f32_16x16x32_bf16 v[44:47], a[72:75], v[80:83], v[44:47]
    v_add_f32_dpp v219, v219, v219 row_mirror row_mask:0xf bank_mask:0xf
    v_mfma_f32_16x16x32_bf16 v[64:67], a[72:75], v[84:87], v[64:67]
    ds_read_b128 v[144:147], v233 offset:1216
    v_mfma_f32_16x16x32_bf16 v[48:51], a[76:79], v[80:83], v[48:51]
    v_mul_f32 v216, 0x3acccccd, v216
    v_mfma_f32_16x16x32_bf16 v[68:71], a[76:79], v[84:87], v[68:71]
    s_add_u32 s37, s37, 4096
    buffer_load_dwordx4 a[248:251], v8, s[28:31], s37 offen offset:0
    v_mul_f32 v218, 0x3acccccd, v218
    s_waitcnt vmcnt(38) lgkmcnt(0)
    v_mfma_f32_16x16x32_bf16 v[32:35], a[80:83], v[72:75], v[32:35]
    v_mul_f32 v217, 0x3acccccd, v217
    v_mfma_f32_16x16x32_bf16 v[52:55], a[80:83], v[76:79], v[52:55]
    ds_read_b128 v[80:83], v230 offset:5120
    v_mfma_f32_16x16x32_bf16 v[36:39], a[84:87], v[72:75], v[36:39]
    buffer_load_dwordx4 a[252:255], v8, s[28:31], s37 offen offset:1024
    v_mul_f32 v219, 0x3acccccd, v219
    v_mfma_f32_16x16x32_bf16 v[56:59], a[84:87], v[76:79], v[56:59]
    ds_read_b128 v[84:87], v232 offset:5120
    v_mfma_f32_16x16x32_bf16 v[40:43], a[88:91], v[72:75], v[40:43]
    v_fma_f32 v217, -v216, v216, v217
    v_mfma_f32_16x16x32_bf16 v[60:63], a[88:91], v[76:79], v[60:63]
    ds_read_b128 v[128:131], v234
    buffer_load_dwordx4 a[0:3], v8, s[28:31], s37 offen offset:2048
    v_mfma_f32_16x16x32_bf16 v[44:47], a[92:95], v[72:75], v[44:47]
    v_fma_f32 v219, -v218, v218, v219
    v_mfma_f32_16x16x32_bf16 v[64:67], a[92:95], v[76:79], v[64:67]
    ds_read_b128 v[148:151], v234 offset:1024
    v_mfma_f32_16x16x32_bf16 v[48:51], a[96:99], v[72:75], v[48:51]
    v_max_f32 v217, 0, v217
    v_mfma_f32_16x16x32_bf16 v[68:71], a[96:99], v[76:79], v[68:71]
    buffer_load_dwordx4 a[4:7], v8, s[28:31], s37 offen offset:3072
    v_max_f32 v219, 0, v219
    s_waitcnt vmcnt(36) lgkmcnt(0)
    v_mfma_f32_16x16x32_bf16 v[32:35], a[100:103], v[80:83], v[32:35]
    v_cvt_pk_bf16_f32 v192, v216, v217
    v_mfma_f32_16x16x32_bf16 v[52:55], a[100:103], v[84:87], v[52:55]
    ds_read_b128 v[72:75], v229 offset:6144
    v_mfma_f32_16x16x32_bf16 v[36:39], a[104:107], v[80:83], v[36:39]
    s_add_u32 s37, s37, 4096
    buffer_load_dwordx4 a[8:11], v8, s[28:31], s37 offen offset:0
    v_cvt_pk_bf16_f32 v193, v218, v219
    v_mfma_f32_16x16x32_bf16 v[56:59], a[104:107], v[84:87], v[56:59]
    ds_read_b128 v[76:79], v231 offset:6144
    v_mfma_f32_16x16x32_bf16 v[40:43], a[108:111], v[80:83], v[40:43]
    v_lshlrev_b32 v216, 16, v192
    v_mfma_f32_16x16x32_bf16 v[60:63], a[108:111], v[84:87], v[60:63]
    ds_read_b64 v[16:17], v236
    buffer_load_dwordx4 a[12:15], v8, s[28:31], s37 offen offset:1024
    v_mfma_f32_16x16x32_bf16 v[44:47], a[112:115], v[80:83], v[44:47]
    v_lshlrev_b32 v218, 16, v193
    v_mfma_f32_16x16x32_bf16 v[64:67], a[112:115], v[84:87], v[64:67]
    ds_read_b64 v[18:19], v237
    v_mfma_f32_16x16x32_bf16 v[48:51], a[116:119], v[80:83], v[48:51]
    v_and_b32 v217, 0xffff0000, v192
    v_mfma_f32_16x16x32_bf16 v[68:71], a[116:119], v[84:87], v[68:71]
    buffer_load_dwordx4 a[16:19], v8, s[28:31], s37 offen offset:2048
    v_and_b32 v219, 0xffff0000, v193
    s_waitcnt vmcnt(34) lgkmcnt(0)
    v_mfma_f32_16x16x32_bf16 v[32:35], a[120:123], v[72:75], v[32:35]
    v_add_f32 v217, 0x3727c5ac, v217
    v_mfma_f32_16x16x32_bf16 v[52:55], a[120:123], v[76:79], v[52:55]
    ds_read_b128 v[80:83], v230 offset:7168
    v_mfma_f32_16x16x32_bf16 v[36:39], a[124:127], v[72:75], v[36:39]
    buffer_load_dwordx4 a[20:23], v8, s[28:31], s37 offen offset:3072
    v_add_f32 v219, 0x3727c5ac, v219
    v_mfma_f32_16x16x32_bf16 v[56:59], a[124:127], v[76:79], v[56:59]
    ds_read_b128 v[84:87], v232 offset:7168
    v_mfma_f32_16x16x32_bf16 v[40:43], a[128:131], v[72:75], v[40:43]
    v_cvt_pk_bf16_f32 v192, v217, v217
    v_mfma_f32_16x16x32_bf16 v[60:63], a[128:131], v[76:79], v[60:63]
    ds_read_b64 v[20:21], v238
    s_add_u32 s37, s37, 4096
    buffer_load_dwordx4 a[24:27], v8, s[28:31], s37 offen offset:0
    v_mfma_f32_16x16x32_bf16 v[44:47], a[132:135], v[72:75], v[44:47]
    v_cvt_pk_bf16_f32 v193, v219, v219
    v_mfma_f32_16x16x32_bf16 v[64:67], a[132:135], v[76:79], v[64:67]
    ds_read_b64 v[22:23], v239
    v_mfma_f32_16x16x32_bf16 v[48:51], a[136:139], v[72:75], v[48:51]
    v_lshlrev_b32 v217, 16, v192
    v_mfma_f32_16x16x32_bf16 v[68:71], a[136:139], v[76:79], v[68:71]
    buffer_load_dwordx4 a[28:31], v8, s[28:31], s37 offen offset:1024
    v_lshlrev_b32 v219, 16, v193
    s_waitcnt vmcnt(32) lgkmcnt(0)
    v_mfma_f32_16x16x32_bf16 v[32:35], a[140:143], v[80:83], v[32:35]
    v_sqrt_f32 v217, v217
    v_mfma_f32_16x16x32_bf16 v[52:55], a[140:143], v[84:87], v[52:55]
    ds_read_b128 v[72:75], v229 offset:8192
    v_mfma_f32_16x16x32_bf16 v[36:39], a[144:147], v[80:83], v[36:39]
    buffer_load_dwordx4 a[32:35], v8, s[28:31], s37 offen offset:2048
    v_sqrt_f32 v219, v219
    v_mfma_f32_16x16x32_bf16 v[56:59], a[144:147], v[84:87], v[56:59]
    ds_read_b128 v[76:79], v231 offset:8192
    v_mfma_f32_16x16x32_bf16 v[40:43], a[148:151], v[80:83], v[40:43]
    v_cvt_pk_bf16_f32 v192, v217, v217
    v_mfma_f32_16x16x32_bf16 v[60:63], a[148:151], v[84:87], v[60:63]
    buffer_load_dwordx4 a[36:39], v8, s[28:31], s37 offen offset:3072
    ds_read_b64 v[24:25], v240
    v_mfma_f32_16x16x32_bf16 v[44:47], a[152:155], v[80:83], v[44:47]
    v_cvt_pk_bf16_f32 v193, v219, v219
    v_mfma_f32_16x16x32_bf16 v[64:67], a[152:155], v[84:87], v[64:67]
    v_lshlrev_b32 v217, 16, v192
    v_mfma_f32_16x16x32_bf16 v[48:51], a[156:159], v[80:83], v[48:51]
    v_lshlrev_b32 v219, 16, v193
    s_add_u32 s37, s37, 4096
    buffer_load_dwordx4 a[40:43], v8, s[28:31], s37 offen offset:0
    v_mfma_f32_16x16x32_bf16 v[68:71], a[156:159], v[84:87], v[68:71]
    v_rcp_f32 v217, v217
    s_waitcnt vmcnt(30) lgkmcnt(0)
    v_mfma_f32_16x16x32_bf16 v[32:35], a[160:163], v[72:75], v[32:35]
    v_rcp_f32 v219, v219
    v_mfma_f32_16x16x32_bf16 v[52:55], a[160:163], v[76:79], v[52:55]
    ds_read_b128 v[80:83], v230 offset:9216
    buffer_load_dwordx4 a[44:47], v8, s[28:31], s37 offen offset:1024
    v_mfma_f32_16x16x32_bf16 v[36:39], a[164:167], v[72:75], v[36:39]
    v_mul_f32 v216, v216, v217
    v_mfma_f32_16x16x32_bf16 v[56:59], a[164:167], v[76:79], v[56:59]
    ds_read_b128 v[84:87], v232 offset:9216
    v_mfma_f32_16x16x32_bf16 v[40:43], a[168:171], v[72:75], v[40:43]
    v_mul_f32 v218, v218, v219
    v_mfma_f32_16x16x32_bf16 v[60:63], a[168:171], v[76:79], v[60:63]
    buffer_load_dwordx4 a[48:51], v8, s[28:31], s37 offen offset:2048
    v_sub_f32 v216, 0, v216
    v_mfma_f32_16x16x32_bf16 v[44:47], a[172:175], v[72:75], v[44:47]
    v_sub_f32 v218, 0, v218
    v_mfma_f32_16x16x32_bf16 v[64:67], a[172:175], v[76:79], v[64:67]
    s_lshl_b32 s26, s20, 6
    v_mfma_f32_16x16x32_bf16 v[48:51], a[176:179], v[72:75], v[48:51]
    v_lshl_add_u32 v2, v3, 3, s26
    v_mfma_f32_16x16x32_bf16 v[68:71], a[176:179], v[76:79], v[68:71]
    buffer_load_dwordx4 a[52:55], v8, s[28:31], s37 offen offset:3072
    v_add_u32 v2, 138240, v2
    s_waitcnt vmcnt(28) lgkmcnt(0)
    v_mfma_f32_16x16x32_bf16 v[32:35], a[180:183], v[80:83], v[32:35]
    ds_write_b64 v2, v[216:217]
    v_mfma_f32_16x16x32_bf16 v[52:55], a[180:183], v[84:87], v[52:55]
    s_add_u32 s37, s37, 4096
    buffer_load_dwordx4 a[56:59], v8, s[28:31], s37 offen offset:0
    ds_write_b64 v2, v[218:219] offset:32
    v_mfma_f32_16x16x32_bf16 v[36:39], a[184:187], v[80:83], v[36:39]
    v_mfma_f32_16x16x32_bf16 v[56:59], a[184:187], v[84:87], v[56:59]
    v_mfma_f32_16x16x32_bf16 v[40:43], a[188:191], v[80:83], v[40:43]
    buffer_load_dwordx4 a[60:63], v8, s[28:31], s37 offen offset:1024
    v_mfma_f32_16x16x32_bf16 v[60:63], a[188:191], v[84:87], v[60:63]
    v_mfma_f32_16x16x32_bf16 v[44:47], a[192:195], v[80:83], v[44:47]
    v_mfma_f32_16x16x32_bf16 v[64:67], a[192:195], v[84:87], v[64:67]
    v_mfma_f32_16x16x32_bf16 v[48:51], a[196:199], v[80:83], v[48:51]
    v_mfma_f32_16x16x32_bf16 v[68:71], a[196:199], v[84:87], v[68:71]
    buffer_load_dwordx4 a[64:67], v8, s[28:31], s37 offen offset:2048
    s_waitcnt lgkmcnt(0)
    s_nop 4
    ds_write_b128 v246, v[52:55] offset:0
    ds_write_b128 v246, v[56:59] offset:1024
    buffer_load_dwordx4 a[68:71], v8, s[28:31], s37 offen offset:3072
    ds_write_b128 v246, v[60:63] offset:2048
    ds_write_b128 v246, v[64:67] offset:3072
    s_add_u32 s37, s37, 4096
    buffer_load_dwordx4 a[72:75], v8, s[28:31], s37 offen offset:0
    ds_write_b128 v246, v[68:71] offset:4096
    v_pk_add_f32 v[112:113], v[112:113], v[132:133]
    v_pk_add_f32 v[114:115], v[114:115], v[134:135]
    v_pk_add_f32 v[116:117], v[116:117], v[136:137]
    v_pk_add_f32 v[118:119], v[118:119], v[138:139]
    v_pk_add_f32 v[120:121], v[120:121], v[140:141]
    v_pk_add_f32 v[122:123], v[122:123], v[142:143]
    v_pk_add_f32 v[124:125], v[124:125], v[144:145]
    v_pk_add_f32 v[126:127], v[126:127], v[146:147]
    v_pk_add_f32 v[128:129], v[128:129], v[148:149]
    buffer_load_dwordx4 a[76:79], v8, s[28:31], s37 offen offset:1024
    v_pk_add_f32 v[130:131], v[130:131], v[150:151]
    v_mov_b32 v30, 0xbdd2d3e8
    v_mov_b32 v31, 0xc0135761
    s_waitcnt lgkmcnt(0)
    s_barrier
    ds_read_b64 v[152:153], v235
    ds_read_b128 v[88:91], v247 offset:0
    ds_read_b128 v[92:95], v247 offset:1024
    ds_read_b128 v[96:99], v247 offset:2048
    buffer_load_dwordx4 a[80:83], v8, s[28:31], s37 offen offset:2048
    ds_read_b128 v[100:103], v247 offset:3072
    ds_read_b128 v[104:107], v247 offset:4096
    s_waitcnt lgkmcnt(5)
    v_pk_mul_f32 v[112:113], v[112:113], v[152:153] op_sel_hi:[1,0]
    v_pk_mul_f32 v[114:115], v[114:115], v[152:153] op_sel_hi:[1,0]
    v_pk_mul_f32 v[116:117], v[116:117], v[152:153] op_sel_hi:[1,0]
    v_pk_mul_f32 v[118:119], v[118:119], v[152:153] op_sel_hi:[1,0]
    v_pk_mul_f32 v[120:121], v[120:121], v[152:153] op_sel_hi:[1,0]
    v_pk_mul_f32 v[122:123], v[122:123], v[152:153] op_sel_hi:[1,0]
    v_pk_mul_f32 v[124:125], v[124:125], v[152:153] op_sel_hi:[1,0]
    v_pk_mul_f32 v[126:127], v[126:127], v[152:153] op_sel_hi:[1,0]
    v_pk_mul_f32 v[128:129], v[128:129], v[152:153] op_sel_hi:[1,0]
    v_pk_mul_f32 v[130:131], v[130:131], v[152:153] op_sel_hi:[1,0]
    buffer_load_dwordx4 a[84:87], v8, s[28:31], s37 offen offset:3072
    s_waitcnt lgkmcnt(4)
    v_pk_add_f32 v[32:33], v[32:33], v[88:89]
    v_pk_add_f32 v[34:35], v[34:35], v[90:91]
    s_waitcnt lgkmcnt(3)
    v_pk_add_f32 v[36:37], v[36:37], v[92:93]
    v_pk_add_f32 v[38:39], v[38:39], v[94:95]
    s_waitcnt lgkmcnt(2)
    v_pk_add_f32 v[40:41], v[40:41], v[96:97]
    v_pk_add_f32 v[42:43], v[42:43], v[98:99]
    s_waitcnt lgkmcnt(1)
    v_pk_add_f32 v[44:45], v[44:45], v[100:101]
    v_pk_add_f32 v[46:47], v[46:47], v[102:103]
    s_waitcnt lgkmcnt(0)
    v_pk_add_f32 v[48:49], v[48:49], v[104:105]
    v_pk_add_f32 v[50:51], v[50:51], v[106:107]
    v_pk_fma_f32 v[32:33], v[32:33], v[152:153], v[112:113] op_sel:[0,1,0] op_sel_hi:[1,1,1]
    v_pk_fma_f32 v[34:35], v[34:35], v[152:153], v[114:115] op_sel:[0,1,0] op_sel_hi:[1,1,1]
    s_add_u32 s37, s37, 4096
    buffer_load_dwordx4 a[88:91], v8, s[28:31], s37 offen offset:0
    v_pk_fma_f32 v[36:37], v[36:37], v[152:153], v[116:117] op_sel:[0,1,0] op_sel_hi:[1,1,1]
    v_pk_fma_f32 v[38:39], v[38:39], v[152:153], v[118:119] op_sel:[0,1,0] op_sel_hi:[1,1,1]
    v_pk_fma_f32 v[40:41], v[40:41], v[152:153], v[120:121] op_sel:[0,1,0] op_sel_hi:[1,1,1]
    v_pk_fma_f32 v[42:43], v[42:43], v[152:153], v[122:123] op_sel:[0,1,0] op_sel_hi:[1,1,1]
    v_pk_fma_f32 v[44:45], v[44:45], v[152:153], v[124:125] op_sel:[0,1,0] op_sel_hi:[1,1,1]
    v_pk_fma_f32 v[46:47], v[46:47], v[152:153], v[126:127] op_sel:[0,1,0] op_sel_hi:[1,1,1]
    v_pk_fma_f32 v[48:49], v[48:49], v[152:153], v[128:129] op_sel:[0,1,0] op_sel_hi:[1,1,1]
    v_pk_fma_f32 v[50:51], v[50:51], v[152:153], v[130:131] op_sel:[0,1,0] op_sel_hi:[1,1,1]
    v_pk_mul_f32 v[192:193], v[32:33], v[32:33]
    v_pk_mul_f32 v[194:195], v[34:35], v[34:35]
    v_pk_mul_f32 v[196:197], v[36:37], v[36:37]
    v_pk_mul_f32 v[198:199], v[38:39], v[38:39]
    v_pk_mul_f32 v[200:201], v[40:41], v[40:41]
    v_pk_mul_f32 v[202:203], v[42:43], v[42:43]
    v_pk_mul_f32 v[204:205], v[44:45], v[44:45]
    v_pk_mul_f32 v[206:207], v[46:47], v[46:47]
    v_pk_mul_f32 v[208:209], v[48:49], v[48:49]
    buffer_load_dwordx4 a[92:95], v8, s[28:31], s37 offen offset:1024
    v_pk_mul_f32 v[210:211], v[50:51], v[50:51]
    v_pk_fma_f32 v[192:193], v[192:193], v[30:31], v[30:31] op_sel:[0,0,1] op_sel_hi:[1,0,1]
    v_pk_fma_f32 v[194:195], v[194:195], v[30:31], v[30:31] op_sel:[0,0,1] op_sel_hi:[1,0,1]
    v_pk_fma_f32 v[196:197], v[196:197], v[30:31], v[30:31] op_sel:[0,0,1] op_sel_hi:[1,0,1]
    v_pk_fma_f32 v[198:199], v[198:199], v[30:31], v[30:31] op_sel:[0,0,1] op_sel_hi:[1,0,1]
    v_pk_fma_f32 v[200:201], v[200:201], v[30:31], v[30:31] op_sel:[0,0,1] op_sel_hi:[1,0,1]
    v_pk_fma_f32 v[202:203], v[202:203], v[30:31], v[30:31] op_sel:[0,0,1] op_sel_hi:[1,0,1]
    v_pk_fma_f32 v[204:205], v[204:205], v[30:31], v[30:31] op_sel:[0,0,1] op_sel_hi:[1,0,1]
    v_pk_fma_f32 v[206:207], v[206:207], v[30:31], v[30:31] op_sel:[0,0,1] op_sel_hi:[1,0,1]
    v_pk_fma_f32 v[208:209], v[208:209], v[30:31], v[30:31] op_sel:[0,0,1] op_sel_hi:[1,0,1]
    v_pk_fma_f32 v[210:211], v[210:211], v[30:31], v[30:31] op_sel:[0,0,1] op_sel_hi:[1,0,1]
    v_pk_mul_f32 v[192:193], v[192:193], v[32:33]
    v_pk_mul_f32 v[194:195], v[194:195], v[34:35]
    v_pk_mul_f32 v[196:197], v[196:197], v[36:37]
    v_pk_mul_f32 v[198:199], v[198:199], v[38:39]
    v_pk_mul_f32 v[200:201], v[200:201], v[40:41]
    v_pk_mul_f32 v[202:203], v[202:203], v[42:43]
    buffer_load_dwordx4 a[96:99], v8, s[28:31], s37 offen offset:2048
    v_pk_mul_f32 v[204:205], v[204:205], v[44:45]
    v_pk_mul_f32 v[206:207], v[206:207], v[46:47]
    v_pk_mul_f32 v[208:209], v[208:209], v[48:49]
    v_pk_mul_f32 v[210:211], v[210:211], v[50:51]
    v_exp_f32 v192, v192
    v_exp_f32 v193, v193
    v_exp_f32 v194, v194
    v_exp_f32 v195, v195
    v_exp_f32 v196, v196
    v_exp_f32 v197, v197
    v_exp_f32 v198, v198
    buffer_load_dwordx4 a[100:103], v8, s[28:31], s37 offen offset:3072
    v_exp_f32 v199, v199
    v_exp_f32 v200, v200
    v_exp_f32 v201, v201
    v_exp_f32 v202, v202
    v_exp_f32 v203, v203
    v_exp_f32 v204, v204
    v_exp_f32 v205, v205
    v_exp_f32 v206, v206
    v_exp_f32 v207, v207
    s_add_u32 s37, s37, 4096
    buffer_load_dwordx4 a[104:107], v8, s[28:31], s37 offen offset:0
    v_exp_f32 v208, v208
    v_exp_f32 v209, v209
    v_exp_f32 v210, v210
    v_exp_f32 v211, v211
    v_pk_add_f32 v[192:193], v[192:193], 1.0 op_sel_hi:[1,0]
    v_pk_add_f32 v[194:195], v[194:195], 1.0 op_sel_hi:[1,0]
    v_pk_add_f32 v[196:197], v[196:197], 1.0 op_sel_hi:[1,0]
    v_pk_add_f32 v[198:199], v[198:199], 1.0 op_sel_hi:[1,0]
    v_pk_add_f32 v[200:201], v[200:201], 1.0 op_sel_hi:[1,0]
    v_pk_add_f32 v[202:203], v[202:203], 1.0 op_sel_hi:[1,0]
    v_pk_add_f32 v[204:205], v[204:205], 1.0 op_sel_hi:[1,0]
    v_pk_add_f32 v[206:207], v[206:207], 1.0 op_sel_hi:[1,0]
    v_pk_add_f32 v[208:209], v[208:209], 1.0 op_sel_hi:[1,0]
    buffer_load_dwordx4 a[108:111], v8, s[28:31], s37 offen offset:1024
    v_pk_add_f32 v[210:211], v[210:211], 1.0 op_sel_hi:[1,0]
    v_rcp_f32 v192, v192
    v_rcp_f32 v193, v193
    v_rcp_f32 v194, v194
    v_rcp_f32 v195, v195
    v_rcp_f32 v196, v196
    v_rcp_f32 v197, v197
    v_rcp_f32 v198, v198
    v_rcp_f32 v199, v199
    buffer_load_dwordx4 a[112:115], v8, s[28:31], s37 offen offset:2048
    v_rcp_f32 v200, v200
    v_rcp_f32 v201, v201
    v_rcp_f32 v202, v202
    v_rcp_f32 v203, v203
    v_rcp_f32 v204, v204
    v_rcp_f32 v205, v205
    v_rcp_f32 v206, v206
    v_rcp_f32 v207, v207
    v_rcp_f32 v208, v208
    buffer_load_dwordx4 a[116:119], v8, s[28:31], s37 offen offset:3072
    v_rcp_f32 v209, v209
    v_rcp_f32 v210, v210
    v_rcp_f32 v211, v211
    v_pk_mul_f32 v[32:33], v[32:33], v[192:193]
    v_pk_mul_f32 v[34:35], v[34:35], v[194:195]
    v_pk_mul_f32 v[36:37], v[36:37], v[196:197]
    v_pk_mul_f32 v[38:39], v[38:39], v[198:199]
    v_pk_mul_f32 v[40:41], v[40:41], v[200:201]
    v_pk_mul_f32 v[42:43], v[42:43], v[202:203]
    v_pk_mul_f32 v[44:45], v[44:45], v[204:205]
    v_pk_mul_f32 v[46:47], v[46:47], v[206:207]
    v_pk_mul_f32 v[48:49], v[48:49], v[208:209]
    v_pk_mul_f32 v[50:51], v[50:51], v[210:211]
    v_cvt_pk_bf16_f32 v180, v32, v33
    v_cvt_pk_bf16_f32 v181, v34, v35
    v_cvt_pk_bf16_f32 v182, v36, v37
    v_cvt_pk_bf16_f32 v183, v38, v39
    v_cvt_pk_bf16_f32 v184, v40, v41
    v_cvt_pk_bf16_f32 v185, v42, v43
    v_cvt_pk_bf16_f32 v186, v44, v45
    v_cvt_pk_bf16_f32 v187, v46, v47
    v_cvt_pk_bf16_f32 v188, v48, v49
    v_cvt_pk_bf16_f32 v189, v50, v51
    s_nop 1
    v_permlane16_swap_b32 v180, v182
    v_permlane16_swap_b32 v181, v183
    v_permlane16_swap_b32 v184, v186
    v_permlane16_swap_b32 v185, v187
    s_mov_b64 exec, s[60:61]
    buffer_store_dwordx4 v[180:183], v241, s[28:31], s44 offen sc1
    buffer_store_dwordx4 v[184:187], v241, s[28:31], s44 offen offset:1024 sc1
    buffer_store_dwordx2 v[188:189], v242, s[28:31], s45 offen sc1
    s_mov_b64 exec, -1
    v_add_u32 v243, s43, v4
    v_lshrrev_b32 v244, 4, v243
    v_and_b32 v243, 15, v243
    s_mov_b32 s27, 20480
    v_mul_lo_u32 v244, v244, s27
    v_lshl_add_u32 v244, v243, 4, v244
    v_and_b32 v243, 1, v3
    v_lshlrev_b32 v243, 9, v243
    v_lshrrev_b32 v2, 1, v3
    v_lshl_add_u32 v243, v2, 8, v243
    v_add_u32 v243, v243, v244
    s_lshl_b32 s27, s21, 9
    v_lshl_add_u32 v244, v2, 8, v244
    v_add_u32 v244, s27, v244
    v_and_b32 v2, 1, v3
    v_lshl_add_u32 v244, v2, 3, v244
    s_add_u32 s38, s44, 2621440
    s_add_u32 s39, s45, 2621440
    s_add_u32 s49, s46, 32768
    v_add_u32 v7, 1, v1
    v_lshrrev_b32 v7, 1, v7
    v_add_u32 v7, s23, v7
    v_subrev_u32 v7, 1, v7
    v_max_i32 v7, 0, v7
    v_min_i32 v7, 63, v7
    v_lshrrev_b32 v2, 1, v1
    s_lshl_b32 s26, s22, 1
    v_add_u32 v2, s26, v2
    v_lshl_add_u32 v7, v7, 2, v2
    v_lshlrev_b32 v245, 7, v7
    s_lshl_b32 s26, s23, 1
    s_add_u32 s27, s26, s22
    s_mul_i32 s27, s27, 20
    s_mul_i32 s3, s22, 10
    s_add_u32 s27, s27, s3
    s_lshl_b32 s27, s27, 10
    s_add_u32 s50, s27, 10784768
    s_add_u32 s27, s26, 1
    s_sub_u32 s27, s27, s22
    s_mul_i32 s27, s27, 20
    s_add_u32 s27, s27, s3
    s_lshl_b32 s27, s27, 10
    s_add_u32 s51, s27, 10784768
    s_lshr_b32 s26, s2, 3
    s_and_b32 s3, s2, 7
    s_and_b32 s4, s3, 1
    s_lshr_b32 s3, s3, 1
    s_and_b32 s52, s26, 7
    s_lshl_b32 s27, s4, 3
    s_add_u32 s52, s52, s27
    s_lshr_b32 s27, s26, 3
    s_lshl_b32 s53, s3, 2
    s_add_u32 s53, s53, s27
    s_and_b32 s57, s26, 3
    s_lshl_b32 s27, s4, 2
    s_add_u32 s57, s57, s27
    s_lshr_b32 s27, s26, 2
    s_lshl_b32 s58, s3, 3
    s_add_u32 s58, s58, s27
    s_and_b32 s57, s26, 7
    s_lshr_b32 s27, s26, 3
    s_and_b32 s58, s2, 7
    s_lshl_b32 s58, s58, 2
    s_add_u32 s58, s58, s27
    s_mul_i32 s54, s52, 143360
    s_add_u32 s54, s54, 24875008
    s_mul_i32 s59, s57, 276480
    s_add_u32 s59, s59, 27168768
    s_waitcnt vmcnt(0)
    s_barrier
    s_cmp_lg_u32 s20, 0
    s_cbranch_scc1 chain_kernel_sig1
    v_mov_b32 v2, 1
    v_mov_b32 v7, 0
    s_mov_b64 exec, 1
    buffer_store_dword v2, v7, s[28:31], s46 offen sc1
    s_mov_b64 exec, -1
chain_kernel_sig1:
    s_add_u32 s37, s37, 4096
    buffer_load_dwordx4 a[120:123], v8, s[28:31], s37 offen offset:0
    buffer_load_dwordx4 a[124:127], v8, s[28:31], s37 offen offset:1024
    buffer_load_dwordx4 a[128:131], v8, s[28:31], s37 offen offset:2048
    buffer_load_dwordx4 a[132:135], v8, s[28:31], s37 offen offset:3072
    s_add_u32 s37, s37, 4096
    buffer_load_dwordx4 a[136:139], v8, s[28:31], s37 offen offset:0
    buffer_load_dwordx4 a[140:143], v8, s[28:31], s37 offen offset:1024
    s_mul_i32 s25, s20, 10
    s_lshl_b32 s25, s25, 10
    s_add_u32 s62, s25, 0
    s_add_u32 s63, s25, s54
    s_add_u32 s63, s63, 0
    s_mov_b32 m0, s62
    buffer_load_dwordx4 v8, s[28:31], s63 offen offset:0 lds
    buffer_load_dwordx4 v8, s[28:31], s63 offen offset:1024 lds
    buffer_load_dwordx4 v8, s[28:31], s63 offen offset:2048 lds
    buffer_load_dwordx4 v8, s[28:31], s63 offen offset:3072 lds
    s_add_u32 s62, s62, 4096
    s_add_u32 s63, s63, 4096
    s_mov_b32 m0, s62
    buffer_load_dwordx4 v8, s[28:31], s63 offen offset:0 lds
    buffer_load_dwordx4 v8, s[28:31], s63 offen offset:1024 lds
    buffer_load_dwordx4 v8, s[28:31], s63 offen offset:2048 lds
    buffer_load_dwordx4 v8, s[28:31], s63 offen offset:3072 lds
    s_add_u32 s62, s62, 4096
    s_add_u32 s63, s63, 4096
    s_mov_b32 m0, s62
    buffer_load_dwordx4 v8, s[28:31], s63 offen offset:0 lds
    buffer_load_dwordx4 v8, s[28:31], s63 offen offset:1024 lds
    s_lshl_b32 s26, s53, 3
    s_lshl_b32 s27, s20, 1
    s_add_u32 s56, s26, s27
    s_mul_i32 s6, s56, 20480
    s_add_u32 s6, s6, 13406208
    s_add_u32 s7, s6, 20480
    s_lshl_b32 s26, s53, 2
    s_add_u32 s26, s26, s20
    s_lshl_b32 s26, s26, 9
    s_add_u32 s8, s26, 29413376
    v_lshlrev_b32 v228, 3, v4
    v_lshl_add_u32 v228, v3, 8, v228
    s_lshl_b32 s9, s56, 10
    s_add_u32 s9, s9, 23105536
    s_and_b32 s42, s52, 1
    s_mul_i32 s12, s52, 7
    s_add_u32 s13, s12, 1
    s_lshr_b32 s13, s13, 1
    s_add_u32 s26, s13, 3
    s_sub_u32 s27, s13, 1
    s_cmp_eq_u32 s42, 1
    s_cselect_b32 s12, s27, s26
    s_lshl_b32 s13, s13, 10
    s_add_u32 s13, s13, 16027648
    s_lshl_b32 s12, s12, 10
    s_add_u32 s12, s12, 16027648
    s_lshl_b32 s14, s56, 4
    s_lshl_b32 s15, s53, 4
    s_add_u32 s15, s15, s52
    s_lshl_b32 s15, s15, 2
    s_add_u32 s15, s15, s20
    s_lshl_b32 s15, s15, 7
    s_add_u32 s15, s15, 29446144
    s_lshr_b32 s26, s43, 4
    s_lshl_b32 s26, s26, 3
    s_lshl_b32 s27, s24, 1
    s_add_u32 s26, s26, s27
    s_add_u32 s26, s26, s21
    s_lshl_b32 s26, s26, 7
    s_add_u32 s19, s26, 23105536
    v_add_u32 v226, s14, v4
    v_lshrrev_b32 v227, 4, v226
    v_and_b32 v226, 15, v226
    s_mov_b32 s27, 55296
    v_mul_lo_u32 v227, v227, s27
    v_lshl_add_u32 v227, v226, 4, v227
    v_and_b32 v226, 1, v3
    v_lshlrev_b32 v226, 9, v226
    v_lshrrev_b32 v2, 1, v3
    v_lshl_add_u32 v226, v2, 8, v226
    v_add_u32 v226, v226, v227
    s_lshl_b32 s27, s42, 9
    v_lshl_add_u32 v227, v2, 8, v227
    v_add_u32 v227, s27, v227
    v_and_b32 v2, 1, v3
    v_lshl_add_u32 v227, v2, 3, v227
    s_mov_b32 s48, 29380608
    s_mov_b32 s47, 0
    s_mov_b64 exec, 15
chain_kernel_poll2:
    buffer_load_dword v2, v245, s[28:31], s48 offen sc1
    s_add_u32 s47, s47, 1
    s_waitcnt vmcnt(0)
    v_cmp_ne_u32 vcc, 1, v2
    s_cmp_ge_u32 s47, 200000
    s_cbranch_scc1 chain_kernel_polld3
    s_cbranch_vccnz chain_kernel_poll2
chain_kernel_polld3:
    s_mov_b64 exec, -1
    buffer_load_dwordx4 v[72:75], v8, s[28:31], s50 offen offset:0 sc1
    buffer_load_dwordx4 v[76:79], v8, s[28:31], s51 offen offset:0 sc1
    buffer_load_dwordx4 v[80:83], v8, s[28:31], s50 offen offset:1024 sc1
    buffer_load_dwordx4 v[84:87], v8, s[28:31], s51 offen offset:1024 sc1
    buffer_load_dwordx4 v[88:91], v8, s[28:31], s50 offen offset:2048 sc1
    buffer_load_dwordx4 v[92:95], v8, s[28:31], s51 offen offset:2048 sc1
    buffer_load_dwordx4 v[96:99], v8, s[28:31], s50 offen offset:3072 sc1
    buffer_load_dwordx4 v[100:103], v8, s[28:31], s51 offen offset:3072 sc1
    s_add_u32 s50, s50, 4096
    s_add_u32 s51, s51, 4096
    buffer_load_dwordx4 v[104:107], v8, s[28:31], s50 offen offset:0 sc1
    buffer_load_dwordx4 v[108:111], v8, s[28:31], s51 offen offset:0 sc1
    s_waitcnt vmcnt(8)
    v_mfma_f32_16x16x32_bf16 v[32:35], a[200:203], v[72:75], 0
    v_mfma_f32_16x16x32_bf16 v[52:55], a[200:203], v[76:79], 0
    buffer_load_dwordx4 v[112:115], v8, s[28:31], s50 offen offset:1024 sc1
    v_mfma_f32_16x16x32_bf16 v[36:39], a[204:207], v[72:75], 0
    v_mfma_f32_16x16x32_bf16 v[56:59], a[204:207], v[76:79], 0
    v_mfma_f32_16x16x32_bf16 v[40:43], a[208:211], v[72:75], 0
    v_mfma_f32_16x16x32_bf16 v[60:63], a[208:211], v[76:79], 0
    buffer_load_dwordx4 v[116:119], v8, s[28:31], s51 offen offset:1024 sc1
    v_mfma_f32_16x16x32_bf16 v[44:47], a[212:215], v[72:75], 0
    v_mfma_f32_16x16x32_bf16 v[64:67], a[212:215], v[76:79], 0
    v_mfma_f32_16x16x32_bf16 v[48:51], a[216:219], v[72:75], 0
    v_mfma_f32_16x16x32_bf16 v[68:71], a[216:219], v[76:79], 0
    s_waitcnt vmcnt(8)
    v_mfma_f32_16x16x32_bf16 v[32:35], a[220:223], v[80:83], v[32:35]
    v_mfma_f32_16x16x32_bf16 v[52:55], a[220:223], v[84:87], v[52:55]
    buffer_load_dwordx4 v[120:123], v8, s[28:31], s50 offen offset:2048 sc1
    v_mfma_f32_16x16x32_bf16 v[36:39], a[224:227], v[80:83], v[36:39]
    v_mfma_f32_16x16x32_bf16 v[56:59], a[224:227], v[84:87], v[56:59]
    v_mfma_f32_16x16x32_bf16 v[40:43], a[228:231], v[80:83], v[40:43]
    v_mfma_f32_16x16x32_bf16 v[60:63], a[228:231], v[84:87], v[60:63]
    buffer_load_dwordx4 v[124:127], v8, s[28:31], s51 offen offset:2048 sc1
    v_mfma_f32_16x16x32_bf16 v[44:47], a[232:235], v[80:83], v[44:47]
    v_mfma_f32_16x16x32_bf16 v[64:67], a[232:235], v[84:87], v[64:67]
    v_mfma_f32_16x16x32_bf16 v[48:51], a[236:239], v[80:83], v[48:51]
    v_mfma_f32_16x16x32_bf16 v[68:71], a[236:239], v[84:87], v[68:71]
    s_waitcnt vmcnt(8)
    v_mfma_f32_16x16x32_bf16 v[32:35], a[240:243], v[88:91], v[32:35]
    v_mfma_f32_16x16x32_bf16 v[52:55], a[240:243], v[92:95], v[52:55]
    buffer_load_dwordx4 v[128:131], v8, s[28:31], s50 offen offset:3072 sc1
    v_mfma_f32_16x16x32_bf16 v[36:39], a[244:247], v[88:91], v[36:39]
    v_mfma_f32_16x16x32_bf16 v[56:59], a[244:247], v[92:95], v[56:59]
    v_mfma_f32_16x16x32_bf16 v[40:43], a[248:251], v[88:91], v[40:43]
    v_mfma_f32_16x16x32_bf16 v[60:63], a[248:251], v[92:95], v[60:63]
    buffer_load_dwordx4 v[132:135], v8, s[28:31], s51 offen offset:3072 sc1
    v_mfma_f32_16x16x32_bf16 v[44:47], a[252:255], v[88:91], v[44:47]
    v_mfma_f32_16x16x32_bf16 v[64:67], a[252:255], v[92:95], v[64:67]
    v_mfma_f32_16x16x32_bf16 v[48:51], a[0:3], v[88:91], v[48:51]
    v_mfma_f32_16x16x32_bf16 v[68:71], a[0:3], v[92:95], v[68:71]
    s_waitcnt vmcnt(8)
    v_mfma_f32_16x16x32_bf16 v[32:35], a[4:7], v[96:99], v[32:35]
    v_mfma_f32_16x16x32_bf16 v[52:55], a[4:7], v[100:103], v[52:55]
    s_add_u32 s50, s50, 4096
    s_add_u32 s51, s51, 4096
    buffer_load_dwordx4 v[136:139], v8, s[28:31], s50 offen offset:0 sc1
    v_mfma_f32_16x16x32_bf16 v[36:39], a[8:11], v[96:99], v[36:39]
    v_mfma_f32_16x16x32_bf16 v[56:59], a[8:11], v[100:103], v[56:59]
    v_mfma_f32_16x16x32_bf16 v[40:43], a[12:15], v[96:99], v[40:43]
    v_mfma_f32_16x16x32_bf16 v[60:63], a[12:15], v[100:103], v[60:63]
    buffer_load_dwordx4 v[140:143], v8, s[28:31], s51 offen offset:0 sc1
    v_mfma_f32_16x16x32_bf16 v[44:47], a[16:19], v[96:99], v[44:47]
    v_mfma_f32_16x16x32_bf16 v[64:67], a[16:19], v[100:103], v[64:67]
    v_mfma_f32_16x16x32_bf16 v[48:51], a[20:23], v[96:99], v[48:51]
    v_mfma_f32_16x16x32_bf16 v[68:71], a[20:23], v[100:103], v[68:71]
    s_waitcnt vmcnt(8)
    v_mfma_f32_16x16x32_bf16 v[32:35], a[24:27], v[104:107], v[32:35]
    v_mfma_f32_16x16x32_bf16 v[52:55], a[24:27], v[108:111], v[52:55]
    buffer_load_dwordx4 v[144:147], v8, s[28:31], s50 offen offset:1024 sc1
    v_mfma_f32_16x16x32_bf16 v[36:39], a[28:31], v[104:107], v[36:39]
    v_mfma_f32_16x16x32_bf16 v[56:59], a[28:31], v[108:111], v[56:59]
    v_mfma_f32_16x16x32_bf16 v[40:43], a[32:35], v[104:107], v[40:43]
    v_mfma_f32_16x16x32_bf16 v[60:63], a[32:35], v[108:111], v[60:63]
    buffer_load_dwordx4 v[148:151], v8, s[28:31], s51 offen offset:1024 sc1
    v_mfma_f32_16x16x32_bf16 v[44:47], a[36:39], v[104:107], v[44:47]
    v_mfma_f32_16x16x32_bf16 v[64:67], a[36:39], v[108:111], v[64:67]
    s_mul_i32 s25, s20, 20
    s_lshl_b32 s25, s25, 10
    s_add_u32 s62, s25, 40960
    s_add_u32 s63, s25, s54
    s_add_u32 s63, s63, 40960
    s_mov_b32 m0, s62
    buffer_load_dwordx4 v8, s[28:31], s63 offen offset:0 lds
    v_mfma_f32_16x16x32_bf16 v[48:51], a[40:43], v[104:107], v[48:51]
    v_mfma_f32_16x16x32_bf16 v[68:71], a[40:43], v[108:111], v[68:71]
    s_waitcnt vmcnt(9)
    v_mfma_f32_16x16x32_bf16 v[32:35], a[44:47], v[112:115], v[32:35]
    v_mfma_f32_16x16x32_bf16 v[52:55], a[44:47], v[116:119], v[52:55]
    buffer_load_dwordx4 v8, s[28:31], s63 offen offset:1024 lds
    v_mfma_f32_16x16x32_bf16 v[36:39], a[48:51], v[112:115], v[36:39]
    v_mfma_f32_16x16x32_bf16 v[56:59], a[48:51], v[116:119], v[56:59]
    buffer_load_dwordx4 v8, s[28:31], s63 offen offset:2048 lds
    v_mfma_f32_16x16x32_bf16 v[40:43], a[52:55], v[112:115], v[40:43]
    v_mfma_f32_16x16x32_bf16 v[60:63], a[52:55], v[116:119], v[60:63]
    v_mfma_f32_16x16x32_bf16 v[44:47], a[56:59], v[112:115], v[44:47]
    v_mfma_f32_16x16x32_bf16 v[64:67], a[56:59], v[116:119], v[64:67]
    buffer_load_dwordx4 v8, s[28:31], s63 offen offset:3072 lds
    v_mfma_f32_16x16x32_bf16 v[48:51], a[60:63], v[112:115], v[48:51]
    v_mfma_f32_16x16x32_bf16 v[68:71], a[60:63], v[116:119], v[68:71]
    s_waitcnt vmcnt(10)
    v_mfma_f32_16x16x32_bf16 v[32:35], a[64:67], v[120:123], v[32:35]
    v_mfma_f32_16x16x32_bf16 v[52:55], a[64:67], v[124:127], v[52:55]
    s_add_u32 s62, s62, 4096
    s_add_u32 s63, s63, 4096
    s_mov_b32 m0, s62
    buffer_load_dwordx4 v8, s[28:31], s63 offen offset:0 lds
    v_mfma_f32_16x16x32_bf16 v[36:39], a[68:71], v[120:123], v[36:39]
    v_mfma_f32_16x16x32_bf16 v[56:59], a[68:71], v[124:127], v[56:59]
    buffer_load_dwordx4 v8, s[28:31], s63 offen offset:1024 lds
    v_mfma_f32_16x16x32_bf16 v[40:43], a[72:75], v[120:123], v[40:43]
    v_mfma_f32_16x16x32_bf16 v[60:63], a[72:75], v[124:127], v[60:63]
    v_mfma_f32_16x16x32_bf16 v[44:47], a[76:79], v[120:123], v[44:47]
    v_mfma_f32_16x16x32_bf16 v[64:67], a[76:79], v[124:127], v[64:67]
    buffer_load_dwordx4 v8, s[28:31], s63 offen offset:2048 lds
    v_mfma_f32_16x16x32_bf16 v[48:51], a[80:83], v[120:123], v[48:51]
    v_mfma_f32_16x16x32_bf16 v[68:71], a[80:83], v[124:127], v[68:71]
    s_waitcnt vmcnt(11)
    v_mfma_f32_16x16x32_bf16 v[32:35], a[84:87], v[128:131], v[32:35]
    v_mfma_f32_16x16x32_bf16 v[52:55], a[84:87], v[132:135], v[52:55]
    buffer_load_dwordx4 v8, s[28:31], s63 offen offset:3072 lds
    v_mfma_f32_16x16x32_bf16 v[36:39], a[88:91], v[128:131], v[36:39]
    v_mfma_f32_16x16x32_bf16 v[56:59], a[88:91], v[132:135], v[56:59]
    s_add_u32 s62, s62, 4096
    s_add_u32 s63, s63, 4096
    s_mov_b32 m0, s62
    buffer_load_dwordx4 v8, s[28:31], s63 offen offset:0 lds
    v_mfma_f32_16x16x32_bf16 v[40:43], a[92:95], v[128:131], v[40:43]
    v_mfma_f32_16x16x32_bf16 v[60:63], a[92:95], v[132:135], v[60:63]
    v_mfma_f32_16x16x32_bf16 v[44:47], a[96:99], v[128:131], v[44:47]
    v_mfma_f32_16x16x32_bf16 v[64:67], a[96:99], v[132:135], v[64:67]
    buffer_load_dwordx4 v8, s[28:31], s63 offen offset:1024 lds
    v_mfma_f32_16x16x32_bf16 v[48:51], a[100:103], v[128:131], v[48:51]
    v_mfma_f32_16x16x32_bf16 v[68:71], a[100:103], v[132:135], v[68:71]
    s_waitcnt vmcnt(12)
    v_mfma_f32_16x16x32_bf16 v[32:35], a[104:107], v[136:139], v[32:35]
    v_mfma_f32_16x16x32_bf16 v[52:55], a[104:107], v[140:143], v[52:55]
    buffer_load_dwordx4 v8, s[28:31], s63 offen offset:2048 lds
    v_mfma_f32_16x16x32_bf16 v[36:39], a[108:111], v[136:139], v[36:39]
    v_mfma_f32_16x16x32_bf16 v[56:59], a[108:111], v[140:143], v[56:59]
    buffer_load_dwordx4 v8, s[28:31], s63 offen offset:3072 lds
    v_mfma_f32_16x16x32_bf16 v[40:43], a[112:115], v[136:139], v[40:43]
    v_mfma_f32_16x16x32_bf16 v[60:63], a[112:115], v[140:143], v[60:63]
    v_mfma_f32_16x16x32_bf16 v[44:47], a[116:119], v[136:139], v[44:47]
    v_mfma_f32_16x16x32_bf16 v[64:67], a[116:119], v[140:143], v[64:67]
    s_add_u32 s62, s62, 4096
    s_add_u32 s63, s63, 4096
    s_mov_b32 m0, s62
    buffer_load_dwordx4 v8, s[28:31], s63 offen offset:0 lds
    v_mfma_f32_16x16x32_bf16 v[48:51], a[120:123], v[136:139], v[48:51]
    v_mfma_f32_16x16x32_bf16 v[68:71], a[120:123], v[140:143], v[68:71]
    s_waitcnt vmcnt(13)
    v_mfma_f32_16x16x32_bf16 v[32:35], a[124:127], v[144:147], v[32:35]
    v_mfma_f32_16x16x32_bf16 v[52:55], a[124:127], v[148:151], v[52:55]
    buffer_load_dwordx4 v8, s[28:31], s63 offen offset:1024 lds
    v_mfma_f32_16x16x32_bf16 v[36:39], a[128:131], v[144:147], v[36:39]
    v_mfma_f32_16x16x32_bf16 v[56:59], a[128:131], v[148:151], v[56:59]
    buffer_load_dwordx4 v8, s[28:31], s63 offen offset:2048 lds
    v_mfma_f32_16x16x32_bf16 v[40:43], a[132:135], v[144:147], v[40:43]
    v_mfma_f32_16x16x32_bf16 v[60:63], a[132:135], v[148:151], v[60:63]
    v_mfma_f32_16x16x32_bf16 v[44:47], a[136:139], v[144:147], v[44:47]
    v_mfma_f32_16x16x32_bf16 v[64:67], a[136:139], v[148:151], v[64:67]
    buffer_load_dwordx4 v8, s[28:31], s63 offen offset:3072 lds
    v_mfma_f32_16x16x32_bf16 v[48:51], a[140:143], v[144:147], v[48:51]
    v_mfma_f32_16x16x32_bf16 v[68:71], a[140:143], v[148:151], v[68:71]
    s_nop 4
    ds_write_b128 v246, v[52:55] offset:0
    ds_write_b128 v246, v[56:59] offset:1024
    ds_write_b128 v246, v[60:63] offset:2048
    ds_write_b128 v246, v[64:67] offset:3072
    ds_write_b128 v246, v[68:71] offset:4096
    v_lshlrev_b32 v112, 16, v16
    v_and_b32 v113, 0xffff0000, v16
    v_lshlrev_b32 v114, 16, v17
    v_and_b32 v115, 0xffff0000, v17
    v_lshlrev_b32 v116, 16, v18
    v_and_b32 v117, 0xffff0000, v18
    v_lshlrev_b32 v118, 16, v19
    v_and_b32 v119, 0xffff0000, v19
    v_lshlrev_b32 v120, 16, v20
    v_and_b32 v121, 0xffff0000, v20
    v_lshlrev_b32 v122, 16, v21
    v_and_b32 v123, 0xffff0000, v21
    v_lshlrev_b32 v124, 16, v22
    v_and_b32 v125, 0xffff0000, v22
    v_lshlrev_b32 v126, 16, v23
    v_and_b32 v127, 0xffff0000, v23
    v_lshlrev_b32 v128, 16, v24
    v_and_b32 v129, 0xffff0000, v24
    v_lshlrev_b32 v130, 16, v25
    v_and_b32 v131, 0xffff0000, v25
    v_pk_add_f32 v[32:33], v[32:33], v[112:113]
    v_pk_add_f32 v[34:35], v[34:35], v[114:115]
    v_pk_add_f32 v[36:37], v[36:37], v[116:117]
    v_pk_add_f32 v[38:39], v[38:39], v[118:119]
    v_pk_add_f32 v[40:41], v[40:41], v[120:121]
    v_pk_add_f32 v[42:43], v[42:43], v[122:123]
    v_pk_add_f32 v[44:45], v[44:45], v[124:125]
    v_pk_add_f32 v[46:47], v[46:47], v[126:127]
    v_pk_add_f32 v[48:49], v[48:49], v[128:129]
    v_pk_add_f32 v[50:51], v[50:51], v[130:131]
    v_mov_b32 v28, 0
    v_mov_b32 v29, 0
    s_add_u32 s62, s62, 4096
    s_add_u32 s63, s63, 4096
    s_mov_b32 m0, s62
    buffer_load_dwordx4 v8, s[28:31], s63 offen offset:0 lds
    buffer_load_dwordx4 v8, s[28:31], s63 offen offset:1024 lds
    buffer_load_dwordx4 v8, s[28:31], s63 offen offset:2048 lds
    buffer_load_dwordx4 v8, s[28:31], s63 offen offset:3072 lds
    s_mul_i32 s25, s20, 5
    s_lshl_b32 s25, s25, 10
    s_add_u32 s62, s25, 122880
    s_add_u32 s63, s25, s54
    s_add_u32 s63, s63, 122880
    s_mov_b32 m0, s62
    buffer_load_dwordx4 v8, s[28:31], s63 offen offset:0 lds
    buffer_load_dwordx4 v8, s[28:31], s63 offen offset:1024 lds
    buffer_load_dwordx4 v8, s[28:31], s63 offen offset:2048 lds
    buffer_load_dwordx4 v8, s[28:31], s63 offen offset:3072 lds
    s_add_u32 s62, s62, 4096
    s_add_u32 s63, s63, 4096
    s_mov_b32 m0, s62
    buffer_load_dwordx4 v8, s[28:31], s63 offen offset:0 lds
    s_waitcnt lgkmcnt(0)
    s_barrier
    ds_read_b128 v[88:91], v247 offset:0
    ds_read_b128 v[92:95], v247 offset:1024
    ds_read_b128 v[96:99], v247 offset:2048
    ds_read_b128 v[100:103], v247 offset:3072
    ds_read_b128 v[104:107], v247 offset:4096
    s_waitcnt lgkmcnt(4)
    v_pk_add_f32 v[32:33], v[32:33], v[88:89]
    v_pk_add_f32 v[34:35], v[34:35], v[90:91]
    v_cvt_pk_bf16_f32 v180, v32, v33
    v_cvt_pk_bf16_f32 v181, v34, v35
    s_waitcnt lgkmcnt(3)
    v_pk_add_f32 v[36:37], v[36:37], v[92:93]
    v_pk_add_f32 v[38:39], v[38:39], v[94:95]
    v_cvt_pk_bf16_f32 v182, v36, v37
    v_cvt_pk_bf16_f32 v183, v38, v39
    s_waitcnt lgkmcnt(2)
    v_pk_add_f32 v[40:41], v[40:41], v[96:97]
    v_pk_add_f32 v[42:43], v[42:43], v[98:99]
    v_cvt_pk_bf16_f32 v184, v40, v41
    v_cvt_pk_bf16_f32 v185, v42, v43
    s_waitcnt lgkmcnt(1)
    v_pk_add_f32 v[44:45], v[44:45], v[100:101]
    v_pk_add_f32 v[46:47], v[46:47], v[102:103]
    v_cvt_pk_bf16_f32 v186, v44, v45
    v_cvt_pk_bf16_f32 v187, v46, v47
    s_waitcnt lgkmcnt(0)
    v_pk_add_f32 v[48:49], v[48:49], v[104:105]
    v_pk_add_f32 v[50:51], v[50:51], v[106:107]
    v_cvt_pk_bf16_f32 v188, v48, v49
    v_cvt_pk_bf16_f32 v189, v50, v51
    v_dot2_f32_bf16 v28, v180, v224, v28
    v_dot2_f32_bf16 v29, v180, v180, v29
    v_dot2_f32_bf16 v28, v181, v224, v28
    v_dot2_f32_bf16 v29, v181, v181, v29
    v_dot2_f32_bf16 v28, v182, v224, v28
    v_dot2_f32_bf16 v29, v182, v182, v29
    v_dot2_f32_bf16 v28, v183, v224, v28
    v_dot2_f32_bf16 v29, v183, v183, v29
    v_dot2_f32_bf16 v28, v184, v224, v28
    v_dot2_f32_bf16 v29, v184, v184, v29
    v_dot2_f32_bf16 v28, v185, v224, v28
    v_dot2_f32_bf16 v29, v185, v185, v29
    v_dot2_f32_bf16 v28, v186, v224, v28
    v_dot2_f32_bf16 v29, v186, v186, v29
    v_dot2_f32_bf16 v28, v187, v224, v28
    v_dot2_f32_bf16 v29, v187, v187, v29
    v_dot2_f32_bf16 v28, v188, v224, v28
    v_dot2_f32_bf16 v29, v188, v188, v29
    v_dot2_f32_bf16 v28, v189, v224, v28
    v_dot2_f32_bf16 v29, v189, v189, v29
    s_nop 1
    v_permlane16_swap_b32 v180, v182
    v_permlane16_swap_b32 v181, v183
    v_permlane16_swap_b32 v184, v186
    v_permlane16_swap_b32 v185, v187
    buffer_store_dwordx4 v[180:183], v243, s[28:31], s38 offen sc1
    buffer_store_dwordx4 v[184:187], v243, s[28:31], s38 offen offset:1024 sc1
    buffer_store_dwordx2 v[188:189], v244, s[28:31], s39 offen sc1
    v_mov_b32 v160, v28
    v_mov_b32 v161, v29
    s_nop 1
    v_permlane32_swap_b32 v160, v28
    v_permlane32_swap_b32 v161, v29
    s_nop 1
    v_add_f32 v28, v28, v160
    v_add_f32 v29, v29, v161
    v_mov_b32 v160, v28
    v_mov_b32 v161, v29
    s_nop 1
    v_permlane16_swap_b32 v160, v28
    v_permlane16_swap_b32 v161, v29
    s_nop 1
    v_add_f32 v28, v28, v160
    v_add_f32 v29, v29, v161
    v_lshlrev_b32 v2, 3, v4
    s_mov_b64 exec, 0xffff
    buffer_store_dwordx2 v[28:29], v2, s[28:31], s19 offen sc1
    s_mov_b64 exec, -1
    s_waitcnt vmcnt(0)
    s_barrier
    s_cmp_lg_u32 s20, 0
    s_cbranch_scc1 chain_kernel_sig4
    v_mov_b32 v2, 1
    v_mov_b32 v7, 0
    s_mov_b64 exec, 1
    buffer_store_dword v2, v7, s[28:31], s49 offen sc1
    s_mov_b64 exec, -1
chain_kernel_sig4:
    v_and_b32 v2, 31, v1
    v_lshlrev_b32 v2, 4, v2
    v_lshrrev_b32 v7, 5, v1
    v_mul_u32_u24 v7, 7168, v7
    v_add_u32 v2, v2, v7
    s_mul_i32 s26, s52, 448
    s_add_u32 s26, s26, 8130560
    s_mov_b32 m0, 162816
    s_nop 0
    buffer_load_dwordx4 v2, s[28:31], s26 offen lds
    s_and_b32 s36, s57, 1
    s_lshl_b32 s43, s58, 6
    s_lshl_b32 s26, s21, 5
    s_add_u32 s43, s43, s26
    s_lshl_b32 s26, s22, 4
    s_add_u32 s43, s43, s26
    s_mul_i32 s40, s57, 5
    s_add_u32 s41, s40, 1
    s_lshr_b32 s41, s41, 1
    s_add_u32 s26, s41, 2
    s_sub_u32 s27, s41, 1
    s_cmp_eq_u32 s36, 1
    s_cselect_b32 s40, s27, s26
    s_lshl_b32 s44, s41, 10
    s_lshl_b32 s45, s40, 10
    s_lshl_b32 s26, s36, 9
    s_add_u32 s45, s45, s26
    s_lshr_b32 s26, s58, 1
    s_lshl_b32 s26, s26, 4
    s_mul_i32 s27, s22, 7
    s_add_u32 s26, s26, s27
    s_lshl_b32 s26, s26, 2
    s_and_b32 s27, s58, 1
    s_lshl_b32 s27, s27, 1
    s_add_u32 s26, s26, s27
    s_add_u32 s26, s26, s21
    s_lshl_b32 s26, s26, 7
    s_add_u32 s48, s26, 29446144
    v_lshlrev_b32 v234, 9, v1
    s_lshl_b32 s26, s58, 2
    s_lshl_b32 s27, s21, 1
    s_add_u32 s26, s26, s27
    s_add_u32 s27, s26, s22
    s_mul_i32 s27, s27, 54
    s_mul_i32 s39, s22, 27
    s_add_u32 s27, s27, s39
    s_lshl_b32 s27, s27, 10
    s_add_u32 s50, s27, 16027648
    s_add_u32 s27, s26, 1
    s_sub_u32 s27, s27, s22
    s_mul_i32 s27, s27, 54
    s_add_u32 s27, s27, s39
    s_lshl_b32 s27, s27, 10
    s_add_u32 s51, s27, 16027648
    v_add_u32 v9, s43, v4
    v_lshrrev_b32 v11, 4, v9
    v_and_b32 v10, 15, v9
    v_mul_u32_u24 v11, 20480, v11
    v_lshl_add_u32 v11, v10, 4, v11
    v_lshrrev_b32 v2, 1, v3
    v_lshl_add_u32 v11, v2, 8, v11
    v_and_b32 v7, 1, v3
    v_lshl_add_u32 v230, v7, 3, v11
    v_mul_u32_u24 v9, 1280, v9
    v_lshlrev_b32 v7, 5, v7
    v_lshl_add_u32 v7, v2, 4, v7
    v_add_u32 v231, v9, v7
    v_lshl_add_u32 v232, v3, 3, v9
    v_lshlrev_b32 v233, 4, v3
    v_add_u32 v9, s43, v4
    v_lshrrev_b32 v10, 4, v9
    v_mul_u32_u24 v10, 20480, v10
    v_and_b32 v11, 1, v9
    v_lshl_add_u32 v10, v11, 3, v10
    v_lshl_add_u32 v10, v3, 7, v10
    v_bfe_u32 v11, v9, 1, 3
    s_mul_i32 s26, s57, 20
    s_lshl_b32 s27, s36, 2
    s_add_u32 s27, s27, s26
    s_mul_i32 s3, s36, 16
    s_sub_u32 s3, 16, s3
    s_add_u32 s3, s3, s26
    s_add_u32 s4, s27, 0
    v_add_u32 v2, s4, v3
    v_bfe_u32 v2, v2, 1, 3
    v_xor_b32 v2, v2, v11
    v_lshl_add_u32 v2, v2, 4, v10
    s_lshl_b32 s4, s4, 7
    v_add_u32 v235, s4, v2
    s_add_u32 s4, s27, 4
    v_add_u32 v2, s4, v3
    v_bfe_u32 v2, v2, 1, 3
    v_xor_b32 v2, v2, v11
    v_lshl_add_u32 v2, v2, 4, v10
    s_lshl_b32 s4, s4, 7
    v_add_u32 v236, s4, v2
    s_add_u32 s4, s27, 8
    v_add_u32 v2, s4, v3
    v_bfe_u32 v2, v2, 1, 3
    v_xor_b32 v2, v2, v11
    v_lshl_add_u32 v2, v2, 4, v10
    s_lshl_b32 s4, s4, 7
    v_add_u32 v237, s4, v2
    s_add_u32 s4, s27, 12
    v_add_u32 v2, s4, v3
    v_bfe_u32 v2, v2, 1, 3
    v_xor_b32 v2, v2, v11
    v_lshl_add_u32 v2, v2, 4, v10
    s_lshl_b32 s4, s4, 7
    v_add_u32 v238, s4, v2
    s_mov_b32 s4, s3
    v_add_u32 v2, s4, v3
    v_bfe_u32 v2, v2, 1, 3
    v_xor_b32 v2, v2, v11
    v_lshl_add_u32 v2, v2, 4, v10
    s_lshl_b32 s4, s4, 7
    v_add_u32 v239, s4, v2
    s_mul_i32 s37, s57, 320
    s_add_u32 s37, s37, 8126976
    s_mul_i32 s26, s36, 256
    s_sub_u32 s26, 256, s26
    s_add_u32 s38, s37, s26
    s_lshl_b32 s26, s36, 6
    s_add_u32 s37, s37, s26
    s_mul_i32 s26, s57, 160
    s_lshl_b32 s27, s36, 5
    s_add_u32 s46, s26, s27
    s_mul_i32 s27, s36, 128
    s_sub_u32 s27, 128, s27
    s_add_u32 s49, s26, s27
    s_waitcnt vmcnt(0)
    s_lshl_b32 s26, s42, 6
    v_lshlrev_b32 v2, 4, v3
    v_add_u32 v7, 162816, v2
    v_add_u32 v2, s26, v7
    s_mul_i32 s26, s42, 384
    s_sub_u32 s26, 384, s26
    v_add_u32 v7, s26, v7
    ds_read_b128 v[88:91], v2 offset:0
    ds_read_b128 v[116:119], v2 offset:512
    ds_read_b128 v[92:95], v2 offset:64
    ds_read_b128 v[120:123], v2 offset:576
    ds_read_b128 v[96:99], v2 offset:128
    ds_read_b128 v[124:127], v2 offset:640
    ds_read_b128 v[100:103], v2 offset:192
    ds_read_b128 v[128:131], v2 offset:704
    ds_read_b128 v[104:107], v2 offset:256
    ds_read_b128 v[132:135], v2 offset:768
    ds_read_b128 v[108:111], v2 offset:320
    ds_read_b128 v[136:139], v2 offset:832
    ds_read_b128 v[112:115], v7
    ds_read_b128 v[140:143], v7 offset:512
    s_waitcnt lgkmcnt(0)
    v_pk_add_f32 v[88:89], v[88:89], v[116:117]
    v_pk_add_f32 v[90:91], v[90:91], v[118:119]
    v_pk_add_f32 v[92:93], v[92:93], v[120:121]
    v_pk_add_f32 v[94:95], v[94:95], v[122:123]
    v_pk_add_f32 v[96:97], v[96:97], v[124:125]
    v_pk_add_f32 v[98:99], v[98:99], v[126:127]
    v_pk_add_f32 v[100:101], v[100:101], v[128:129]
    v_pk_add_f32 v[102:103], v[102:103], v[130:131]
    v_pk_add_f32 v[104:105], v[104:105], v[132:133]
    v_pk_add_f32 v[106:107], v[106:107], v[134:135]
    v_pk_add_f32 v[108:109], v[108:109], v[136:137]
    v_pk_add_f32 v[110:111], v[110:111], v[138:139]
    v_pk_add_f32 v[112:113], v[112:113], v[140:141]
    v_pk_add_f32 v[114:115], v[114:115], v[142:143]
    v_mov_b32 v12, v8
    v_add_u32 v13, 0x10000, v8
    v_add_u32 v14, 0x20000, v8
    ds_read_b128 a[160:163], v12 offset:0
    ds_read_b128 a[164:167], v12 offset:1024
    ds_read_b128 a[168:171], v12 offset:2048
    ds_read_b128 a[172:175], v12 offset:3072
    ds_read_b128 a[176:179], v13 offset:57344
    ds_read_b128 a[180:183], v12 offset:4096
    ds_read_b128 a[184:187], v12 offset:5120
    ds_read_b128 a[188:191], v12 offset:6144
    ds_read_b128 a[192:195], v12 offset:7168
    ds_read_b128 a[196:199], v13 offset:58368
    ds_read_b128 a[200:203], v12 offset:8192
    v_lshlrev_b32 v7, 7, v1
    s_mov_b32 s47, 0
    s_mov_b64 exec, 15
chain_kernel_poll5:
    buffer_load_dword v2, v7, s[28:31], s8 offen sc1
    s_add_u32 s47, s47, 1
    s_waitcnt vmcnt(0)
    v_cmp_ne_u32 vcc, 1, v2
    s_cmp_ge_u32 s47, 200000
    s_cbranch_scc1 chain_kernel_polld6
    s_cbranch_vccnz chain_kernel_poll5
chain_kernel_polld6:
    s_mov_b64 exec, -1
    buffer_load_dwordx4 a[0:3], v8, s[28:31], s6 offen offset:0 sc1
    buffer_load_dwordx4 a[4:7], v8, s[28:31], s7 offen offset:0 sc1
    buffer_load_dwordx4 a[8:11], v8, s[28:31], s6 offen offset:1024 sc1
    buffer_load_dwordx4 a[12:15], v8, s[28:31], s7 offen offset:1024 sc1
    buffer_load_dwordx4 a[16:19], v8, s[28:31], s6 offen offset:2048 sc1
    buffer_load_dwordx4 a[20:23], v8, s[28:31], s7 offen offset:2048 sc1
    buffer_load_dwordx4 a[24:27], v8, s[28:31], s6 offen offset:3072 sc1
    buffer_load_dwordx4 a[28:31], v8, s[28:31], s7 offen offset:3072 sc1
    s_add_u32 s6, s6, 4096
    s_add_u32 s7, s7, 4096
    buffer_load_dwordx4 a[32:35], v8, s[28:31], s6 offen offset:0 sc1
    buffer_load_dwordx4 a[36:39], v8, s[28:31], s7 offen offset:0 sc1
    s_waitcnt vmcnt(8) lgkmcnt(6)
    v_mfma_f32_16x16x32_bf16 v[32:35], a[160:163], a[0:3], 0
    v_mfma_f32_16x16x32_bf16 v[60:63], a[160:163], a[4:7], 0
    ds_read_b128 a[204:207], v12 offset:9216
    buffer_load_dwordx4 a[40:43], v8, s[28:31], s6 offen offset:1024 sc1
    v_mfma_f32_16x16x32_bf16 v[36:39], a[164:167], a[0:3], 0
    v_mfma_f32_16x16x32_bf16 v[64:67], a[164:167], a[4:7], 0
    ds_read_b128 a[160:163], v12 offset:10240
    v_mfma_f32_16x16x32_bf16 v[40:43], a[168:171], a[0:3], 0
    v_mfma_f32_16x16x32_bf16 v[68:71], a[168:171], a[4:7], 0
    ds_read_b128 a[164:167], v12 offset:11264
    buffer_load_dwordx4 a[44:47], v8, s[28:31], s7 offen offset:1024 sc1
    v_mfma_f32_16x16x32_bf16 v[44:47], a[172:175], a[0:3], 0
    v_mfma_f32_16x16x32_bf16 v[72:75], a[172:175], a[4:7], 0
    ds_read_b128 a[168:171], v13 offset:59392
    v_mfma_f32_16x16x32_bf16 v[56:59], a[176:179], a[0:3], 0
    v_mfma_f32_16x16x32_bf16 v[84:87], a[176:179], a[4:7], 0
    ds_read_b128 a[172:175], v12 offset:12288
    s_waitcnt vmcnt(8) lgkmcnt(6)
    v_mfma_f32_16x16x32_bf16 v[32:35], a[180:183], a[8:11], v[32:35]
    v_mfma_f32_16x16x32_bf16 v[60:63], a[180:183], a[12:15], v[60:63]
    ds_read_b128 a[176:179], v12 offset:13312
    buffer_load_dwordx4 a[48:51], v8, s[28:31], s6 offen offset:2048 sc1
    v_mfma_f32_16x16x32_bf16 v[36:39], a[184:187], a[8:11], v[36:39]
    v_mfma_f32_16x16x32_bf16 v[64:67], a[184:187], a[12:15], v[64:67]
    ds_read_b128 a[180:183], v12 offset:14336
    v_mfma_f32_16x16x32_bf16 v[40:43], a[188:191], a[8:11], v[40:43]
    v_mfma_f32_16x16x32_bf16 v[68:71], a[188:191], a[12:15], v[68:71]
    ds_read_b128 a[184:187], v12 offset:15360
    buffer_load_dwordx4 a[52:55], v8, s[28:31], s7 offen offset:2048 sc1
    v_mfma_f32_16x16x32_bf16 v[44:47], a[192:195], a[8:11], v[44:47]
    v_mfma_f32_16x16x32_bf16 v[72:75], a[192:195], a[12:15], v[72:75]
    ds_read_b128 a[188:191], v13 offset:60416
    v_mfma_f32_16x16x32_bf16 v[56:59], a[196:199], a[8:11], v[56:59]
    v_mfma_f32_16x16x32_bf16 v[84:87], a[196:199], a[12:15], v[84:87]
    ds_read_b128 a[192:195], v12 offset:16384
    s_waitcnt vmcnt(8) lgkmcnt(6)
    v_mfma_f32_16x16x32_bf16 v[32:35], a[200:203], a[16:19], v[32:35]
    v_mfma_f32_16x16x32_bf16 v[60:63], a[200:203], a[20:23], v[60:63]
    ds_read_b128 a[196:199], v12 offset:17408
    buffer_load_dwordx4 a[56:59], v8, s[28:31], s6 offen offset:3072 sc1
    v_mfma_f32_16x16x32_bf16 v[36:39], a[204:207], a[16:19], v[36:39]
    v_mfma_f32_16x16x32_bf16 v[64:67], a[204:207], a[20:23], v[64:67]
    ds_read_b128 a[200:203], v12 offset:18432
    v_mfma_f32_16x16x32_bf16 v[40:43], a[160:163], a[16:19], v[40:43]
    v_mfma_f32_16x16x32_bf16 v[68:71], a[160:163], a[20:23], v[68:71]
    ds_read_b128 a[204:207], v12 offset:19456
    buffer_load_dwordx4 a[60:63], v8, s[28:31], s7 offen offset:3072 sc1
    v_mfma_f32_16x16x32_bf16 v[44:47], a[164:167], a[16:19], v[44:47]
    v_mfma_f32_16x16x32_bf16 v[72:75], a[164:167], a[20:23], v[72:75]
    ds_read_b128 a[160:163], v13 offset:61440
    v_mfma_f32_16x16x32_bf16 v[56:59], a[168:171], a[16:19], v[56:59]
    v_mfma_f32_16x16x32_bf16 v[84:87], a[168:171], a[20:23], v[84:87]
    ds_read_b128 a[164:167], v12 offset:20480
    s_waitcnt vmcnt(8) lgkmcnt(6)
    v_mfma_f32_16x16x32_bf16 v[32:35], a[172:175], a[24:27], v[32:35]
    v_mfma_f32_16x16x32_bf16 v[60:63], a[172:175], a[28:31], v[60:63]
    ds_read_b128 a[168:171], v12 offset:21504
    s_add_u32 s6, s6, 4096
    s_add_u32 s7, s7, 4096
    buffer_load_dwordx4 a[64:67], v8, s[28:31], s6 offen offset:0 sc1
    v_mfma_f32_16x16x32_bf16 v[36:39], a[176:179], a[24:27], v[36:39]
    v_mfma_f32_16x16x32_bf16 v[64:67], a[176:179], a[28:31], v[64:67]
    ds_read_b128 a[172:175], v12 offset:22528
    v_mfma_f32_16x16x32_bf16 v[40:43], a[180:183], a[24:27], v[40:43]
    v_mfma_f32_16x16x32_bf16 v[68:71], a[180:183], a[28:31], v[68:71]
    ds_read_b128 a[176:179], v12 offset:23552
    buffer_load_dwordx4 a[68:71], v8, s[28:31], s7 offen offset:0 sc1
    v_mfma_f32_16x16x32_bf16 v[44:47], a[184:187], a[24:27], v[44:47]
    v_mfma_f32_16x16x32_bf16 v[72:75], a[184:187], a[28:31], v[72:75]
    ds_read_b128 a[180:183], v13 offset:62464
    v_mfma_f32_16x16x32_bf16 v[56:59], a[188:191], a[24:27], v[56:59]
    v_mfma_f32_16x16x32_bf16 v[84:87], a[188:191], a[28:31], v[84:87]
    ds_read_b128 a[184:187], v12 offset:24576
    s_waitcnt vmcnt(8) lgkmcnt(6)
    v_mfma_f32_16x16x32_bf16 v[32:35], a[192:195], a[32:35], v[32:35]
    v_mfma_f32_16x16x32_bf16 v[60:63], a[192:195], a[36:39], v[60:63]
    ds_read_b128 a[188:191], v12 offset:25600
    buffer_load_dwordx4 a[72:75], v8, s[28:31], s6 offen offset:1024 sc1
    v_mfma_f32_16x16x32_bf16 v[36:39], a[196:199], a[32:35], v[36:39]
    v_mfma_f32_16x16x32_bf16 v[64:67], a[196:199], a[36:39], v[64:67]
    ds_read_b128 a[192:195], v12 offset:26624
    v_mfma_f32_16x16x32_bf16 v[40:43], a[200:203], a[32:35], v[40:43]
    v_mfma_f32_16x16x32_bf16 v[68:71], a[200:203], a[36:39], v[68:71]
    ds_read_b128 a[196:199], v12 offset:27648
    buffer_load_dwordx4 a[76:79], v8, s[28:31], s7 offen offset:1024 sc1
    v_mfma_f32_16x16x32_bf16 v[44:47], a[204:207], a[32:35], v[44:47]
    v_mfma_f32_16x16x32_bf16 v[72:75], a[204:207], a[36:39], v[72:75]
    ds_read_b128 a[200:203], v13 offset:63488
    v_mfma_f32_16x16x32_bf16 v[56:59], a[160:163], a[32:35], v[56:59]
    v_mfma_f32_16x16x32_bf16 v[84:87], a[160:163], a[36:39], v[84:87]
    ds_read_b128 a[204:207], v12 offset:28672
    s_waitcnt vmcnt(8) lgkmcnt(6)
    v_mfma_f32_16x16x32_bf16 v[32:35], a[164:167], a[40:43], v[32:35]
    v_mfma_f32_16x16x32_bf16 v[60:63], a[164:167], a[44:47], v[60:63]
    ds_read_b128 a[160:163], v12 offset:29696
    buffer_load_dwordx4 a[80:83], v8, s[28:31], s6 offen offset:2048 sc1
    v_mfma_f32_16x16x32_bf16 v[36:39], a[168:171], a[40:43], v[36:39]
    v_mfma_f32_16x16x32_bf16 v[64:67], a[168:171], a[44:47], v[64:67]
    ds_read_b128 a[164:167], v12 offset:30720
    v_mfma_f32_16x16x32_bf16 v[40:43], a[172:175], a[40:43], v[40:43]
    v_mfma_f32_16x16x32_bf16 v[68:71], a[172:175], a[44:47], v[68:71]
    ds_read_b128 a[168:171], v12 offset:31744
    buffer_load_dwordx4 a[84:87], v8, s[28:31], s7 offen offset:2048 sc1
    v_mfma_f32_16x16x32_bf16 v[44:47], a[176:179], a[40:43], v[44:47]
    v_mfma_f32_16x16x32_bf16 v[72:75], a[176:179], a[44:47], v[72:75]
    ds_read_b128 a[172:175], v13 offset:64512
    v_mfma_f32_16x16x32_bf16 v[56:59], a[180:183], a[40:43], v[56:59]
    v_mfma_f32_16x16x32_bf16 v[84:87], a[180:183], a[44:47], v[84:87]
    ds_read_b128 a[176:179], v12 offset:32768
    s_waitcnt vmcnt(8) lgkmcnt(6)
    v_mfma_f32_16x16x32_bf16 v[32:35], a[184:187], a[48:51], v[32:35]
    v_mfma_f32_16x16x32_bf16 v[60:63], a[184:187], a[52:55], v[60:63]
    ds_read_b128 a[180:183], v12 offset:33792
    buffer_load_dwordx4 a[88:91], v8, s[28:31], s6 offen offset:3072 sc1
    v_mfma_f32_16x16x32_bf16 v[36:39], a[188:191], a[48:51], v[36:39]
    v_mfma_f32_16x16x32_bf16 v[64:67], a[188:191], a[52:55], v[64:67]
    ds_read_b128 a[184:187], v12 offset:34816
    v_mfma_f32_16x16x32_bf16 v[40:43], a[192:195], a[48:51], v[40:43]
    v_mfma_f32_16x16x32_bf16 v[68:71], a[192:195], a[52:55], v[68:71]
    ds_read_b128 a[188:191], v12 offset:35840
    buffer_load_dwordx4 a[92:95], v8, s[28:31], s7 offen offset:3072 sc1
    v_mfma_f32_16x16x32_bf16 v[44:47], a[196:199], a[48:51], v[44:47]
    v_mfma_f32_16x16x32_bf16 v[72:75], a[196:199], a[52:55], v[72:75]
    ds_read_b128 a[192:195], v14 offset:0
    v_mfma_f32_16x16x32_bf16 v[56:59], a[200:203], a[48:51], v[56:59]
    v_mfma_f32_16x16x32_bf16 v[84:87], a[200:203], a[52:55], v[84:87]
    ds_read_b128 a[196:199], v12 offset:36864
    s_waitcnt vmcnt(8) lgkmcnt(6)
    v_mfma_f32_16x16x32_bf16 v[32:35], a[204:207], a[56:59], v[32:35]
    v_mfma_f32_16x16x32_bf16 v[60:63], a[204:207], a[60:63], v[60:63]
    ds_read_b128 a[200:203], v12 offset:37888
    s_add_u32 s6, s6, 4096
    s_add_u32 s7, s7, 4096
    buffer_load_dwordx4 a[96:99], v8, s[28:31], s6 offen offset:0 sc1
    v_mfma_f32_16x16x32_bf16 v[36:39], a[160:163], a[56:59], v[36:39]
    v_mfma_f32_16x16x32_bf16 v[64:67], a[160:163], a[60:63], v[64:67]
    ds_read_b128 a[204:207], v12 offset:38912
    v_mfma_f32_16x16x32_bf16 v[40:43], a[164:167], a[56:59], v[40:43]
    v_mfma_f32_16x16x32_bf16 v[68:71], a[164:167], a[60:63], v[68:71]
    ds_read_b128 a[160:163], v12 offset:39936
    buffer_load_dwordx4 a[100:103], v8, s[28:31], s7 offen offset:0 sc1
    v_mfma_f32_16x16x32_bf16 v[44:47], a[168:171], a[56:59], v[44:47]
    v_mfma_f32_16x16x32_bf16 v[72:75], a[168:171], a[60:63], v[72:75]
    ds_read_b128 a[164:167], v14 offset:1024
    v_mfma_f32_16x16x32_bf16 v[56:59], a[172:175], a[56:59], v[56:59]
    v_mfma_f32_16x16x32_bf16 v[84:87], a[172:175], a[60:63], v[84:87]
    ds_read_b128 a[168:171], v12 offset:40960
    s_waitcnt vmcnt(8) lgkmcnt(6)
    v_mfma_f32_16x16x32_bf16 v[32:35], a[176:179], a[64:67], v[32:35]
    v_mfma_f32_16x16x32_bf16 v[60:63], a[176:179], a[68:71], v[60:63]
    ds_read_b128 a[172:175], v12 offset:41984
    buffer_load_dwordx4 a[104:107], v8, s[28:31], s6 offen offset:1024 sc1
    v_mfma_f32_16x16x32_bf16 v[36:39], a[180:183], a[64:67], v[36:39]
    v_mfma_f32_16x16x32_bf16 v[64:67], a[180:183], a[68:71], v[64:67]
    ds_read_b128 a[176:179], v12 offset:43008
    v_mfma_f32_16x16x32_bf16 v[40:43], a[184:187], a[64:67], v[40:43]
    v_mfma_f32_16x16x32_bf16 v[68:71], a[184:187], a[68:71], v[68:71]
    ds_read_b128 a[180:183], v12 offset:44032
    buffer_load_dwordx4 a[108:111], v8, s[28:31], s7 offen offset:1024 sc1
    v_mfma_f32_16x16x32_bf16 v[44:47], a[188:191], a[64:67], v[44:47]
    v_mfma_f32_16x16x32_bf16 v[72:75], a[188:191], a[68:71], v[72:75]
    ds_read_b128 a[184:187], v14 offset:2048
    v_mfma_f32_16x16x32_bf16 v[56:59], a[192:195], a[64:67], v[56:59]
    v_mfma_f32_16x16x32_bf16 v[84:87], a[192:195], a[68:71], v[84:87]
    ds_read_b128 a[188:191], v12 offset:45056
    buffer_load_dwordx4 a[112:115], v8, s[28:31], s6 offen offset:2048 sc1
    s_waitcnt vmcnt(9) lgkmcnt(6)
    v_mfma_f32_16x16x32_bf16 v[32:35], a[196:199], a[72:75], v[32:35]
    v_mfma_f32_16x16x32_bf16 v[60:63], a[196:199], a[76:79], v[60:63]
    ds_read_b128 a[192:195], v12 offset:46080
    buffer_load_dwordx4 a[116:119], v8, s[28:31], s7 offen offset:2048 sc1
    v_mfma_f32_16x16x32_bf16 v[36:39], a[200:203], a[72:75], v[36:39]
    v_mfma_f32_16x16x32_bf16 v[64:67], a[200:203], a[76:79], v[64:67]
    ds_read_b128 a[196:199], v12 offset:47104
    v_mfma_f32_16x16x32_bf16 v[40:43], a[204:207], a[72:75], v[40:43]
    v_mfma_f32_16x16x32_bf16 v[68:71], a[204:207], a[76:79], v[68:71]
    ds_read_b128 a[200:203], v12 offset:48128
    buffer_load_dwordx4 a[120:123], v8, s[28:31], s6 offen offset:3072 sc1
    v_mfma_f32_16x16x32_bf16 v[44:47], a[160:163], a[72:75], v[44:47]
    v_mfma_f32_16x16x32_bf16 v[72:75], a[160:163], a[76:79], v[72:75]
    ds_read_b128 a[204:207], v14 offset:3072
    v_mfma_f32_16x16x32_bf16 v[56:59], a[164:167], a[72:75], v[56:59]
    v_mfma_f32_16x16x32_bf16 v[84:87], a[164:167], a[76:79], v[84:87]
    ds_read_b128 a[160:163], v12 offset:49152
    buffer_load_dwordx4 a[124:127], v8, s[28:31], s7 offen offset:3072 sc1
    s_waitcnt vmcnt(10) lgkmcnt(6)
    v_mfma_f32_16x16x32_bf16 v[32:35], a[168:171], a[80:83], v[32:35]
    v_mfma_f32_16x16x32_bf16 v[60:63], a[168:171], a[84:87], v[60:63]
    ds_read_b128 a[164:167], v12 offset:50176
    s_add_u32 s6, s6, 4096
    s_add_u32 s7, s7, 4096
    buffer_load_dwordx4 a[128:131], v8, s[28:31], s6 offen offset:0 sc1
    v_mfma_f32_16x16x32_bf16 v[36:39], a[172:175], a[80:83], v[36:39]
    v_mfma_f32_16x16x32_bf16 v[64:67], a[172:175], a[84:87], v[64:67]
    ds_read_b128 a[168:171], v12 offset:51200
    v_mfma_f32_16x16x32_bf16 v[40:43], a[176:179], a[80:83], v[40:43]
    v_mfma_f32_16x16x32_bf16 v[68:71], a[176:179], a[84:87], v[68:71]
    ds_read_b128 a[172:175], v12 offset:52224
    buffer_load_dwordx4 a[132:135], v8, s[28:31], s7 offen offset:0 sc1
    v_mfma_f32_16x16x32_bf16 v[44:47], a[180:183], a[80:83], v[44:47]
    v_mfma_f32_16x16x32_bf16 v[72:75], a[180:183], a[84:87], v[72:75]
    ds_read_b128 a[176:179], v14 offset:4096
    v_mfma_f32_16x16x32_bf16 v[56:59], a[184:187], a[80:83], v[56:59]
    v_mfma_f32_16x16x32_bf16 v[84:87], a[184:187], a[84:87], v[84:87]
    ds_read_b128 a[180:183], v12 offset:53248
    buffer_load_dwordx4 a[136:139], v8, s[28:31], s6 offen offset:1024 sc1
    s_waitcnt vmcnt(11) lgkmcnt(6)
    v_mfma_f32_16x16x32_bf16 v[32:35], a[188:191], a[88:91], v[32:35]
    v_mfma_f32_16x16x32_bf16 v[60:63], a[188:191], a[92:95], v[60:63]
    ds_read_b128 a[184:187], v12 offset:54272
    buffer_load_dwordx4 a[140:143], v8, s[28:31], s7 offen offset:1024 sc1
    v_mfma_f32_16x16x32_bf16 v[36:39], a[192:195], a[88:91], v[36:39]
    v_mfma_f32_16x16x32_bf16 v[64:67], a[192:195], a[92:95], v[64:67]
    ds_read_b128 a[188:191], v12 offset:55296
    v_mfma_f32_16x16x32_bf16 v[40:43], a[196:199], a[88:91], v[40:43]
    v_mfma_f32_16x16x32_bf16 v[68:71], a[196:199], a[92:95], v[68:71]
    ds_read_b128 a[192:195], v12 offset:56320
    buffer_load_dwordx4 a[144:147], v8, s[28:31], s6 offen offset:2048 sc1
    v_mfma_f32_16x16x32_bf16 v[44:47], a[200:203], a[88:91], v[44:47]
    v_mfma_f32_16x16x32_bf16 v[72:75], a[200:203], a[92:95], v[72:75]
    ds_read_b128 a[196:199], v14 offset:5120
    v_mfma_f32_16x16x32_bf16 v[56:59], a[204:207], a[88:91], v[56:59]
    v_mfma_f32_16x16x32_bf16 v[84:87], a[204:207], a[92:95], v[84:87]
    ds_read_b128 a[200:203], v12 offset:57344
    buffer_load_dwordx4 a[148:151], v8, s[28:31], s7 offen offset:2048 sc1
    s_waitcnt vmcnt(12) lgkmcnt(6)
    v_mfma_f32_16x16x32_bf16 v[32:35], a[160:163], a[96:99], v[32:35]
    v_mfma_f32_16x16x32_bf16 v[60:63], a[160:163], a[100:103], v[60:63]
    ds_read_b128 a[204:207], v12 offset:58368
    buffer_load_dwordx4 a[152:155], v8, s[28:31], s6 offen offset:3072 sc1
    v_mfma_f32_16x16x32_bf16 v[36:39], a[164:167], a[96:99], v[36:39]
    v_mfma_f32_16x16x32_bf16 v[64:67], a[164:167], a[100:103], v[64:67]
    ds_read_b128 a[160:163], v12 offset:59392
    v_mfma_f32_16x16x32_bf16 v[40:43], a[168:171], a[96:99], v[40:43]
    v_mfma_f32_16x16x32_bf16 v[68:71], a[168:171], a[100:103], v[68:71]
    ds_read_b128 a[164:167], v12 offset:60416
    buffer_load_dwordx4 a[156:159], v8, s[28:31], s7 offen offset:3072 sc1
    v_mfma_f32_16x16x32_bf16 v[44:47], a[172:175], a[96:99], v[44:47]
    v_mfma_f32_16x16x32_bf16 v[72:75], a[172:175], a[100:103], v[72:75]
    ds_read_b128 a[168:171], v14 offset:6144
    v_mfma_f32_16x16x32_bf16 v[56:59], a[176:179], a[96:99], v[56:59]
    v_mfma_f32_16x16x32_bf16 v[84:87], a[176:179], a[100:103], v[84:87]
    ds_read_b128 a[172:175], v12 offset:61440
    buffer_load_dwordx2 v[16:17], v228, s[28:31], s9 offen offset:0 sc1
    s_waitcnt vmcnt(13) lgkmcnt(6)
    v_mfma_f32_16x16x32_bf16 v[32:35], a[180:183], a[104:107], v[32:35]
    v_mfma_f32_16x16x32_bf16 v[60:63], a[180:183], a[108:111], v[60:63]
    ds_read_b128 a[176:179], v12 offset:62464
    buffer_load_dwordx2 v[18:19], v228, s[28:31], s9 offen offset:128 sc1
    v_mfma_f32_16x16x32_bf16 v[36:39], a[184:187], a[104:107], v[36:39]
    v_mfma_f32_16x16x32_bf16 v[64:67], a[184:187], a[108:111], v[64:67]
    ds_read_b128 a[180:183], v12 offset:63488
    v_mfma_f32_16x16x32_bf16 v[40:43], a[188:191], a[104:107], v[40:43]
    v_mfma_f32_16x16x32_bf16 v[68:71], a[188:191], a[108:111], v[68:71]
    ds_read_b128 a[184:187], v12 offset:64512
    buffer_load_dwordx2 v[20:21], v228, s[28:31], s9 offen offset:1024 sc1
    v_mfma_f32_16x16x32_bf16 v[44:47], a[192:195], a[104:107], v[44:47]
    v_mfma_f32_16x16x32_bf16 v[72:75], a[192:195], a[108:111], v[72:75]
    ds_read_b128 a[188:191], v14 offset:7168
    v_mfma_f32_16x16x32_bf16 v[56:59], a[196:199], a[104:107], v[56:59]
    v_mfma_f32_16x16x32_bf16 v[84:87], a[196:199], a[108:111], v[84:87]
    ds_read_b128 a[192:195], v13 offset:0
    buffer_load_dwordx2 v[22:23], v228, s[28:31], s9 offen offset:1152 sc1
    s_waitcnt vmcnt(14) lgkmcnt(6)
    v_mfma_f32_16x16x32_bf16 v[32:35], a[200:203], a[112:115], v[32:35]
    v_mfma_f32_16x16x32_bf16 v[60:63], a[200:203], a[116:119], v[60:63]
    ds_read_b128 a[196:199], v13 offset:1024
    s_mov_b32 s26, 5492736
    buffer_load_dwordx2 v[116:117], v235, s[28:31], s26 offen
    v_mfma_f32_16x16x32_bf16 v[36:39], a[204:207], a[112:115], v[36:39]
    v_mfma_f32_16x16x32_bf16 v[64:67], a[204:207], a[116:119], v[64:67]
    ds_read_b128 a[200:203], v13 offset:2048
    v_mfma_f32_16x16x32_bf16 v[40:43], a[160:163], a[112:115], v[40:43]
    v_mfma_f32_16x16x32_bf16 v[68:71], a[160:163], a[116:119], v[68:71]
    ds_read_b128 a[204:207], v13 offset:3072
    s_mov_b32 s26, 5492736
    buffer_load_dwordx2 v[118:119], v236, s[28:31], s26 offen
    v_mfma_f32_16x16x32_bf16 v[44:47], a[164:167], a[112:115], v[44:47]
    v_mfma_f32_16x16x32_bf16 v[72:75], a[164:167], a[116:119], v[72:75]
    ds_read_b128 a[160:163], v14 offset:8192
    v_mfma_f32_16x16x32_bf16 v[56:59], a[168:171], a[112:115], v[56:59]
    v_mfma_f32_16x16x32_bf16 v[84:87], a[168:171], a[116:119], v[84:87]
    ds_read_b128 a[164:167], v13 offset:4096
    s_mov_b32 s26, 5492736
    buffer_load_dwordx2 v[120:121], v237, s[28:31], s26 offen
    s_waitcnt vmcnt(15) lgkmcnt(6)
    v_mfma_f32_16x16x32_bf16 v[32:35], a[172:175], a[120:123], v[32:35]
    v_mfma_f32_16x16x32_bf16 v[60:63], a[172:175], a[124:127], v[60:63]
    ds_read_b128 a[168:171], v13 offset:5120
    s_mov_b32 s26, 5492736
    buffer_load_dwordx2 v[122:123], v238, s[28:31], s26 offen
    v_mfma_f32_16x16x32_bf16 v[36:39], a[176:179], a[120:123], v[36:39]
    v_mfma_f32_16x16x32_bf16 v[64:67], a[176:179], a[124:127], v[64:67]
    ds_read_b128 a[172:175], v13 offset:6144
    v_mfma_f32_16x16x32_bf16 v[40:43], a[180:183], a[120:123], v[40:43]
    v_mfma_f32_16x16x32_bf16 v[68:71], a[180:183], a[124:127], v[68:71]
    ds_read_b128 a[176:179], v13 offset:7168
    s_mov_b32 s26, 5492736
    buffer_load_dwordx2 v[124:125], v239, s[28:31], s26 offen
    v_mfma_f32_16x16x32_bf16 v[44:47], a[184:187], a[120:123], v[44:47]
    v_mfma_f32_16x16x32_bf16 v[72:75], a[184:187], a[124:127], v[72:75]
    ds_read_b128 a[180:183], v14 offset:9216
    v_mfma_f32_16x16x32_bf16 v[56:59], a[188:191], a[120:123], v[56:59]
    v_mfma_f32_16x16x32_bf16 v[84:87], a[188:191], a[124:127], v[84:87]
    ds_read_b128 a[184:187], v13 offset:8192
    buffer_load_dwordx4 v[204:207], v233, s[28:31], s37 offen offset:0
    s_waitcnt vmcnt(16) lgkmcnt(6)
    v_mfma_f32_16x16x32_bf16 v[32:35], a[192:195], a[128:131], v[32:35]
    v_mfma_f32_16x16x32_bf16 v[60:63], a[192:195], a[132:135], v[60:63]
    ds_read_b128 a[188:191], v13 offset:9216
    buffer_load_dwordx4 v[208:211], v233, s[28:31], s37 offen offset:64
    v_mfma_f32_16x16x32_bf16 v[36:39], a[196:199], a[128:131], v[36:39]
    v_mfma_f32_16x16x32_bf16 v[64:67], a[196:199], a[132:135], v[64:67]
    ds_read_b128 a[192:195], v13 offset:10240
    v_mfma_f32_16x16x32_bf16 v[40:43], a[200:203], a[128:131], v[40:43]
    v_mfma_f32_16x16x32_bf16 v[68:71], a[200:203], a[132:135], v[68:71]
    ds_read_b128 a[196:199], v13 offset:11264
    buffer_load_dwordx4 v[212:215], v233, s[28:31], s37 offen offset:128
    v_mfma_f32_16x16x32_bf16 v[44:47], a[204:207], a[128:131], v[44:47]
    v_mfma_f32_16x16x32_bf16 v[72:75], a[204:207], a[132:135], v[72:75]
    ds_read_b128 a[200:203], v14 offset:10240
    v_mfma_f32_16x16x32_bf16 v[56:59], a[160:163], a[128:131], v[56:59]
    v_mfma_f32_16x16x32_bf16 v[84:87], a[160:163], a[132:135], v[84:87]
    ds_read_b128 a[204:207], v13 offset:12288
    buffer_load_dwordx4 v[216:219], v233, s[28:31], s37 offen offset:192
    s_waitcnt vmcnt(17) lgkmcnt(6)
    v_mfma_f32_16x16x32_bf16 v[32:35], a[164:167], a[136:139], v[32:35]
    v_mfma_f32_16x16x32_bf16 v[60:63], a[164:167], a[140:143], v[60:63]
    ds_read_b128 a[160:163], v13 offset:13312
    buffer_load_dwordx4 v[220:223], v233, s[28:31], s38 offen
    v_mfma_f32_16x16x32_bf16 v[36:39], a[168:171], a[136:139], v[36:39]
    v_mfma_f32_16x16x32_bf16 v[64:67], a[168:171], a[140:143], v[64:67]
    ds_read_b128 a[164:167], v13 offset:14336
    s_mul_i32 s25, s20, 3
    s_min_u32 s25, s25, 7
    s_lshl_b32 s25, s25, 10
    s_add_u32 s62, s25, 143360
    s_add_u32 s63, s25, s59
    s_add_u32 s63, s63, 0
    s_mov_b32 m0, s62
    buffer_load_dwordx4 v8, s[28:31], s63 offen offset:0 lds
    v_mfma_f32_16x16x32_bf16 v[40:43], a[172:175], a[136:139], v[40:43]
    v_mfma_f32_16x16x32_bf16 v[68:71], a[172:175], a[140:143], v[68:71]
    ds_read_b128 a[168:171], v13 offset:15360
    v_mfma_f32_16x16x32_bf16 v[44:47], a[176:179], a[136:139], v[44:47]
    v_mfma_f32_16x16x32_bf16 v[72:75], a[176:179], a[140:143], v[72:75]
    ds_read_b128 a[172:175], v14 offset:11264
    buffer_load_dwordx4 v8, s[28:31], s63 offen offset:1024 lds
    v_mfma_f32_16x16x32_bf16 v[56:59], a[180:183], a[136:139], v[56:59]
    v_mfma_f32_16x16x32_bf16 v[84:87], a[180:183], a[140:143], v[84:87]
    ds_read_b128 a[176:179], v13 offset:16384
    s_waitcnt vmcnt(18) lgkmcnt(6)
    v_mfma_f32_16x16x32_bf16 v[32:35], a[184:187], a[144:147], v[32:35]
    v_mfma_f32_16x16x32_bf16 v[60:63], a[184:187], a[148:151], v[60:63]
    ds_read_b128 a[180:183], v13 offset:17408
    v_mfma_f32_16x16x32_bf16 v[36:39], a[188:191], a[144:147], v[36:39]
    v_mfma_f32_16x16x32_bf16 v[64:67], a[188:191], a[148:151], v[64:67]
    ds_read_b128 a[184:187], v13 offset:18432
    buffer_load_dwordx4 v8, s[28:31], s63 offen offset:2048 lds
    v_mfma_f32_16x16x32_bf16 v[40:43], a[192:195], a[144:147], v[40:43]
    v_mfma_f32_16x16x32_bf16 v[68:71], a[192:195], a[148:151], v[68:71]
    ds_read_b128 a[188:191], v13 offset:19456
    v_mfma_f32_16x16x32_bf16 v[44:47], a[196:199], a[144:147], v[44:47]
    v_mfma_f32_16x16x32_bf16 v[72:75], a[196:199], a[148:151], v[72:75]
    ds_read_b128 a[192:195], v13 offset:20480
    v_mfma_f32_16x16x32_bf16 v[56:59], a[200:203], a[144:147], v[56:59]
    v_mfma_f32_16x16x32_bf16 v[84:87], a[200:203], a[148:151], v[84:87]
    ds_read_b128 a[196:199], v13 offset:21504
    s_waitcnt vmcnt(17) lgkmcnt(6)
    v_mfma_f32_16x16x32_bf16 v[32:35], a[204:207], a[152:155], v[32:35]
    v_mfma_f32_16x16x32_bf16 v[60:63], a[204:207], a[156:159], v[60:63]
    ds_read_b128 a[200:203], v13 offset:22528
    v_mfma_f32_16x16x32_bf16 v[36:39], a[160:163], a[152:155], v[36:39]
    v_mfma_f32_16x16x32_bf16 v[64:67], a[160:163], a[156:159], v[64:67]
    ds_read_b128 a[204:207], v13 offset:23552
    v_mfma_f32_16x16x32_bf16 v[40:43], a[164:167], a[152:155], v[40:43]
    v_mfma_f32_16x16x32_bf16 v[68:71], a[164:167], a[156:159], v[68:71]
    ds_read_b128 a[160:163], v13 offset:24576
    v_mfma_f32_16x16x32_bf16 v[44:47], a[168:171], a[152:155], v[44:47]
    v_mfma_f32_16x16x32_bf16 v[72:75], a[168:171], a[156:159], v[72:75]
    ds_read_b128 a[164:167], v13 offset:25600
    v_mfma_f32_16x16x32_bf16 v[56:59], a[172:175], a[152:155], v[56:59]
    v_mfma_f32_16x16x32_bf16 v[84:87], a[172:175], a[156:159], v[84:87]
    ds_read_b128 a[168:171], v13 offset:26624
    s_waitcnt lgkmcnt(7)
    v_mfma_f32_16x16x32_bf16 v[48:51], a[176:179], a[0:3], 0
    v_mfma_f32_16x16x32_bf16 v[76:79], a[176:179], a[4:7], 0
    ds_read_b128 a[172:175], v13 offset:27648
    v_mfma_f32_16x16x32_bf16 v[52:55], a[180:183], a[0:3], 0
    v_mfma_f32_16x16x32_bf16 v[80:83], a[180:183], a[4:7], 0
    ds_read_b128 a[176:179], v13 offset:28672
    v_mfma_f32_16x16x32_bf16 v[48:51], a[184:187], a[8:11], v[48:51]
    v_mfma_f32_16x16x32_bf16 v[76:79], a[184:187], a[12:15], v[76:79]
    ds_read_b128 a[180:183], v13 offset:29696
    v_mfma_f32_16x16x32_bf16 v[52:55], a[188:191], a[8:11], v[52:55]
    v_mfma_f32_16x16x32_bf16 v[80:83], a[188:191], a[12:15], v[80:83]
    ds_read_b128 a[184:187], v13 offset:30720
    s_barrier
    s_waitcnt lgkmcnt(7)
    v_mfma_f32_16x16x32_bf16 v[48:51], a[192:195], a[16:19], v[48:51]
    v_mfma_f32_16x16x32_bf16 v[76:79], a[192:195], a[20:23], v[76:79]
    ds_read_b128 a[188:191], v13 offset:31744
    s_mul_i32 s25, s20, 20
    s_lshl_b32 s25, s25, 10
    s_add_u32 s62, s25, 0
    s_add_u32 s63, s25, s59
    s_add_u32 s63, s63, 10240
    s_mov_b32 m0, s62
    buffer_load_dwordx4 v8, s[28:31], s63 offen offset:0 lds
    v_mfma_f32_16x16x32_bf16 v[52:55], a[196:199], a[16:19], v[52:55]
    v_mfma_f32_16x16x32_bf16 v[80:83], a[196:199], a[20:23], v[80:83]
    ds_read_b128 a[192:195], v13 offset:32768
    buffer_load_dwordx4 v8, s[28:31], s63 offen offset:1024 lds
    v_mfma_f32_16x16x32_bf16 v[48:51], a[200:203], a[24:27], v[48:51]
    v_mfma_f32_16x16x32_bf16 v[76:79], a[200:203], a[28:31], v[76:79]
    ds_read_b128 a[196:199], v13 offset:33792
    buffer_load_dwordx4 v8, s[28:31], s63 offen offset:2048 lds
    v_mfma_f32_16x16x32_bf16 v[52:55], a[204:207], a[24:27], v[52:55]
    v_mfma_f32_16x16x32_bf16 v[80:83], a[204:207], a[28:31], v[80:83]
    ds_read_b128 a[200:203], v13 offset:34816
    buffer_load_dwordx4 v8, s[28:31], s63 offen offset:3072 lds
    s_waitcnt lgkmcnt(7)
    v_mfma_f32_16x16x32_bf16 v[48:51], a[160:163], a[32:35], v[48:51]
    v_mfma_f32_16x16x32_bf16 v[76:79], a[160:163], a[36:39], v[76:79]
    ds_read_b128 a[204:207], v13 offset:35840
    s_add_u32 s62, s62, 4096
    s_add_u32 s63, s63, 4096
    s_mov_b32 m0, s62
    buffer_load_dwordx4 v8, s[28:31], s63 offen offset:0 lds
    v_mfma_f32_16x16x32_bf16 v[52:55], a[164:167], a[32:35], v[52:55]
    v_mfma_f32_16x16x32_bf16 v[80:83], a[164:167], a[36:39], v[80:83]
    ds_read_b128 a[160:163], v13 offset:36864
    buffer_load_dwordx4 v8, s[28:31], s63 offen offset:1024 lds
    v_mfma_f32_16x16x32_bf16 v[48:51], a[168:171], a[40:43], v[48:51]
    v_mfma_f32_16x16x32_bf16 v[76:79], a[168:171], a[44:47], v[76:79]
    ds_read_b128 a[164:167], v13 offset:37888
    buffer_load_dwordx4 v8, s[28:31], s63 offen offset:2048 lds
    v_mfma_f32_16x16x32_bf16 v[52:55], a[172:175], a[40:43], v[52:55]
    v_mfma_f32_16x16x32_bf16 v[80:83], a[172:175], a[44:47], v[80:83]
    ds_read_b128 a[168:171], v13 offset:38912
    buffer_load_dwordx4 v8, s[28:31], s63 offen offset:3072 lds
    s_waitcnt lgkmcnt(7)
    v_mfma_f32_16x16x32_bf16 v[48:51], a[176:179], a[48:51], v[48:51]
    v_mfma_f32_16x16x32_bf16 v[76:79], a[176:179], a[52:55], v[76:79]
    ds_read_b128 a[172:175], v13 offset:39936
    s_add_u32 s62, s62, 4096
    s_add_u32 s63, s63, 4096
    s_mov_b32 m0, s62
    buffer_load_dwordx4 v8, s[28:31], s63 offen offset:0 lds
    v_mfma_f32_16x16x32_bf16 v[52:55], a[180:183], a[48:51], v[52:55]
    v_mfma_f32_16x16x32_bf16 v[80:83], a[180:183], a[52:55], v[80:83]
    ds_read_b128 a[176:179], v13 offset:40960
    buffer_load_dwordx4 v8, s[28:31], s63 offen offset:1024 lds
    v_mfma_f32_16x16x32_bf16 v[48:51], a[184:187], a[56:59], v[48:51]
    v_mfma_f32_16x16x32_bf16 v[76:79], a[184:187], a[60:63], v[76:79]
    ds_read_b128 a[180:183], v13 offset:41984
    buffer_load_dwordx4 v8, s[28:31], s63 offen offset:2048 lds
    v_mfma_f32_16x16x32_bf16 v[52:55], a[188:191], a[56:59], v[52:55]
    v_mfma_f32_16x16x32_bf16 v[80:83], a[188:191], a[60:63], v[80:83]
    ds_read_b128 a[184:187], v13 offset:43008
    buffer_load_dwordx4 v8, s[28:31], s63 offen offset:3072 lds
    s_waitcnt lgkmcnt(7)
    v_mfma_f32_16x16x32_bf16 v[48:51], a[192:195], a[64:67], v[48:51]
    v_mfma_f32_16x16x32_bf16 v[76:79], a[192:195], a[68:71], v[76:79]
    ds_read_b128 a[188:191], v13 offset:44032
    s_add_u32 s62, s62, 4096
    s_add_u32 s63, s63, 4096
    s_mov_b32 m0, s62
    buffer_load_dwordx4 v8, s[28:31], s63 offen offset:0 lds
    v_mfma_f32_16x16x32_bf16 v[52:55], a[196:199], a[64:67], v[52:55]
    v_mfma_f32_16x16x32_bf16 v[80:83], a[196:199], a[68:71], v[80:83]
    ds_read_b128 a[192:195], v13 offset:45056
    buffer_load_dwordx4 v8, s[28:31], s63 offen offset:1024 lds
    v_mfma_f32_16x16x32_bf16 v[48:51], a[200:203], a[72:75], v[48:51]
    v_mfma_f32_16x16x32_bf16 v[76:79], a[200:203], a[76:79], v[76:79]
    ds_read_b128 a[196:199], v13 offset:46080
    buffer_load_dwordx4 v8, s[28:31], s63 offen offset:2048 lds
    v_mfma_f32_16x16x32_bf16 v[52:55], a[204:207], a[72:75], v[52:55]
    v_mfma_f32_16x16x32_bf16 v[80:83], a[204:207], a[76:79], v[80:83]
    ds_read_b128 a[200:203], v13 offset:47104
    buffer_load_dwordx4 v8, s[28:31], s63 offen offset:3072 lds
    s_waitcnt lgkmcnt(7)
    v_mfma_f32_16x16x32_bf16 v[48:51], a[160:163], a[80:83], v[48:51]
    v_mfma_f32_16x16x32_bf16 v[76:79], a[160:163], a[84:87], v[76:79]
    ds_read_b128 a[204:207], v13 offset:48128
    s_add_u32 s62, s62, 4096
    s_add_u32 s63, s63, 4096
    s_mov_b32 m0, s62
    buffer_load_dwordx4 v8, s[28:31], s63 offen offset:0 lds
    v_mfma_f32_16x16x32_bf16 v[52:55], a[164:167], a[80:83], v[52:55]
    v_mfma_f32_16x16x32_bf16 v[80:83], a[164:167], a[84:87], v[80:83]
    ds_read_b128 a[160:163], v13 offset:49152
    buffer_load_dwordx4 v8, s[28:31], s63 offen offset:1024 lds
    v_mfma_f32_16x16x32_bf16 v[48:51], a[168:171], a[88:91], v[48:51]
    v_mfma_f32_16x16x32_bf16 v[76:79], a[168:171], a[92:95], v[76:79]
    ds_read_b128 a[164:167], v13 offset:50176
    buffer_load_dwordx4 v8, s[28:31], s63 offen offset:2048 lds
    v_mfma_f32_16x16x32_bf16 v[52:55], a[172:175], a[88:91], v[52:55]
    v_mfma_f32_16x16x32_bf16 v[80:83], a[172:175], a[92:95], v[80:83]
    ds_read_b128 a[168:171], v13 offset:51200
    buffer_load_dwordx4 v8, s[28:31], s63 offen offset:3072 lds
    s_waitcnt lgkmcnt(7)
    v_mfma_f32_16x16x32_bf16 v[48:51], a[176:179], a[96:99], v[48:51]
    v_mfma_f32_16x16x32_bf16 v[76:79], a[176:179], a[100:103], v[76:79]
    ds_read_b128 a[172:175], v13 offset:52224
    s_mul_i32 s25, s20, 3
    s_min_u32 s25, s25, 7
    s_lshl_b32 s25, s25, 10
    s_add_u32 s62, s25, 153600
    s_add_u32 s63, s25, s59
    s_add_u32 s63, s63, 92160
    s_mov_b32 m0, s62
    buffer_load_dwordx4 v8, s[28:31], s63 offen offset:0 lds
    v_mfma_f32_16x16x32_bf16 v[52:55], a[180:183], a[96:99], v[52:55]
    v_mfma_f32_16x16x32_bf16 v[80:83], a[180:183], a[100:103], v[80:83]
    ds_read_b128 a[176:179], v13 offset:53248
    buffer_load_dwordx4 v8, s[28:31], s63 offen offset:1024 lds
    v_mfma_f32_16x16x32_bf16 v[48:51], a[184:187], a[104:107], v[48:51]
    v_mfma_f32_16x16x32_bf16 v[76:79], a[184:187], a[108:111], v[76:79]
    ds_read_b128 a[180:183], v13 offset:54272
    buffer_load_dwordx4 v8, s[28:31], s63 offen offset:2048 lds
    v_mfma_f32_16x16x32_bf16 v[52:55], a[188:191], a[104:107], v[52:55]
    v_mfma_f32_16x16x32_bf16 v[80:83], a[188:191], a[108:111], v[80:83]
    ds_read_b128 a[184:187], v13 offset:55296
    s_mul_i32 s25, s20, 5
    s_lshl_b32 s25, s25, 10
    s_add_u32 s62, s25, 122880
    s_add_u32 s63, s25, s59
    s_add_u32 s63, s63, 102400
    s_mov_b32 m0, s62
    buffer_load_dwordx4 v8, s[28:31], s63 offen offset:0 lds
    s_waitcnt lgkmcnt(7)
    v_mfma_f32_16x16x32_bf16 v[48:51], a[192:195], a[112:115], v[48:51]
    v_mfma_f32_16x16x32_bf16 v[76:79], a[192:195], a[116:119], v[76:79]
    ds_read_b128 a[188:191], v13 offset:56320
    buffer_load_dwordx4 v8, s[28:31], s63 offen offset:1024 lds
    v_mfma_f32_16x16x32_bf16 v[52:55], a[196:199], a[112:115], v[52:55]
    v_mfma_f32_16x16x32_bf16 v[80:83], a[196:199], a[116:119], v[80:83]
    buffer_load_dwordx4 v8, s[28:31], s63 offen offset:2048 lds
    v_mfma_f32_16x16x32_bf16 v[48:51], a[200:203], a[120:123], v[48:51]
    v_mfma_f32_16x16x32_bf16 v[76:79], a[200:203], a[124:127], v[76:79]
    buffer_load_dwordx4 v8, s[28:31], s63 offen offset:3072 lds
    v_mfma_f32_16x16x32_bf16 v[52:55], a[204:207], a[120:123], v[52:55]
    v_mfma_f32_16x16x32_bf16 v[80:83], a[204:207], a[124:127], v[80:83]
    s_add_u32 s62, s62, 4096
    s_add_u32 s63, s63, 4096
    s_mov_b32 m0, s62
    buffer_load_dwordx4 v8, s[28:31], s63 offen offset:0 lds
    s_waitcnt lgkmcnt(4)
    v_mfma_f32_16x16x32_bf16 v[48:51], a[160:163], a[128:131], v[48:51]
    v_mfma_f32_16x16x32_bf16 v[76:79], a[160:163], a[132:135], v[76:79]
    v_mfma_f32_16x16x32_bf16 v[52:55], a[164:167], a[128:131], v[52:55]
    v_mfma_f32_16x16x32_bf16 v[80:83], a[164:167], a[132:135], v[80:83]
    v_mfma_f32_16x16x32_bf16 v[48:51], a[168:171], a[136:139], v[48:51]
    v_mfma_f32_16x16x32_bf16 v[76:79], a[168:171], a[140:143], v[76:79]
    v_mfma_f32_16x16x32_bf16 v[52:55], a[172:175], a[136:139], v[52:55]
    v_mfma_f32_16x16x32_bf16 v[80:83], a[172:175], a[140:143], v[80:83]
    s_waitcnt lgkmcnt(0)
    v_mfma_f32_16x16x32_bf16 v[48:51], a[176:179], a[144:147], v[48:51]
    v_mfma_f32_16x16x32_bf16 v[76:79], a[176:179], a[148:151], v[76:79]
    v_mfma_f32_16x16x32_bf16 v[52:55], a[180:183], a[144:147], v[52:55]
    v_mfma_f32_16x16x32_bf16 v[80:83], a[180:183], a[148:151], v[80:83]
    v_mfma_f32_16x16x32_bf16 v[48:51], a[184:187], a[152:155], v[48:51]
    v_mfma_f32_16x16x32_bf16 v[76:79], a[184:187], a[156:159], v[76:79]
    v_mfma_f32_16x16x32_bf16 v[52:55], a[188:191], a[152:155], v[52:55]
    v_mfma_f32_16x16x32_bf16 v[80:83], a[188:191], a[156:159], v[80:83]
    s_barrier
    s_mul_i32 s26, s22, 5120
    s_add_u32 s55, s59, s26
    s_add_u32 s55, s55, 194560
    s_waitcnt vmcnt(41)
    v_add_f32 v16, v16, v18
    v_add_f32 v17, v17, v19
    v_add_f32 v20, v20, v22
    v_add_f32 v21, v21, v23
    s_nop 0
    v_mov_b32 v24, v16
    v_mov_b32 v25, v17
    v_mov_b32 v26, v20
    v_mov_b32 v27, v21
    s_nop 1
    v_permlane32_swap_b32 v24, v16
    v_permlane32_swap_b32 v25, v17
    v_permlane32_swap_b32 v26, v20
    v_permlane32_swap_b32 v27, v21
    s_mul_i32 s25, s20, 10
    s_lshl_b32 s25, s25, 10
    s_add_u32 s62, s25, 81920
    s_add_u32 s63, s25, s59
    s_add_u32 s63, s63, 122880
    s_mov_b32 m0, s62
    buffer_load_dwordx4 v8, s[28:31], s63 offen offset:0 lds
    s_nop 1
    v_add_f32 v16, v16, v24
    v_add_f32 v17, v17, v25
    v_add_f32 v20, v20, v26
    v_add_f32 v21, v21, v27
    v_mov_b32 v24, v16
    v_mov_b32 v25, v17
    v_mov_b32 v26, v20
    v_mov_b32 v27, v21
    s_nop 1
    v_permlane16_swap_b32 v24, v16
    v_permlane16_swap_b32 v25, v17
    v_permlane16_swap_b32 v26, v20
    v_permlane16_swap_b32 v27, v21
    s_nop 1
    v_add_f32 v16, v16, v24
    buffer_load_dwordx4 v8, s[28:31], s63 offen offset:1024 lds
    v_add_f32 v17, v17, v25
    v_add_f32 v20, v20, v26
    v_add_f32 v21, v21, v27
    v_mul_f32 v16, 0x3acccccd, v16
    v_mul_f32 v20, 0x3acccccd, v20
    v_mul_f32 v17, 0x3acccccd, v17
    v_mul_f32 v21, 0x3acccccd, v21
    v_fma_f32 v17, -v16, v16, v17
    v_fma_f32 v21, -v20, v20, v21
    v_max_f32 v17, 0, v17
    v_max_f32 v21, 0, v21
    v_cvt_pk_bf16_f32 v18, v16, v17
    v_cvt_pk_bf16_f32 v22, v20, v21
    v_lshlrev_b32 v16, 16, v18
    v_lshlrev_b32 v20, 16, v22
    v_and_b32 v17, 0xffff0000, v18
    v_and_b32 v21, 0xffff0000, v22
    v_add_f32 v17, 0x3727c5ac, v17
    v_add_f32 v21, 0x3727c5ac, v21
    buffer_load_dwordx4 v8, s[28:31], s63 offen offset:2048 lds
    v_cvt_pk_bf16_f32 v18, v17, v17
    v_cvt_pk_bf16_f32 v22, v21, v21
    v_lshlrev_b32 v17, 16, v18
    v_lshlrev_b32 v21, 16, v22
    v_sqrt_f32 v17, v17
    v_sqrt_f32 v21, v21
    s_nop 0
    s_nop 0
    v_cvt_pk_bf16_f32 v18, v17, v17
    v_cvt_pk_bf16_f32 v22, v21, v21
    v_lshlrev_b32 v17, 16, v18
    v_lshlrev_b32 v21, 16, v22
    v_rcp_f32 v17, v17
    v_rcp_f32 v21, v21
    s_nop 0
    s_nop 0
    v_mul_f32 v16, v16, v17
    buffer_load_dwordx4 v8, s[28:31], s63 offen offset:3072 lds
    v_mul_f32 v20, v20, v21
    v_sub_f32 v16, 0, v16
    v_sub_f32 v20, 0, v20
    v_mov_b32 v30, 0xbdd2d3e8
    v_mov_b32 v31, 0xc0135761
    v_pk_mul_f32 v[176:177], v[88:89], v[16:17] op_sel_hi:[1,0]
    v_pk_mul_f32 v[178:179], v[90:91], v[16:17] op_sel_hi:[1,0]
    v_pk_mul_f32 v[180:181], v[92:93], v[16:17] op_sel_hi:[1,0]
    v_pk_mul_f32 v[182:183], v[94:95], v[16:17] op_sel_hi:[1,0]
    v_pk_mul_f32 v[184:185], v[96:97], v[16:17] op_sel_hi:[1,0]
    v_pk_mul_f32 v[186:187], v[98:99], v[16:17] op_sel_hi:[1,0]
    v_pk_mul_f32 v[188:189], v[100:101], v[16:17] op_sel_hi:[1,0]
    v_pk_mul_f32 v[190:191], v[102:103], v[16:17] op_sel_hi:[1,0]
    v_pk_mul_f32 v[192:193], v[104:105], v[16:17] op_sel_hi:[1,0]
    v_pk_mul_f32 v[194:195], v[106:107], v[16:17] op_sel_hi:[1,0]
    v_pk_mul_f32 v[196:197], v[108:109], v[16:17] op_sel_hi:[1,0]
    v_pk_mul_f32 v[198:199], v[110:111], v[16:17] op_sel_hi:[1,0]
    v_pk_mul_f32 v[200:201], v[112:113], v[16:17] op_sel_hi:[1,0]
    v_pk_mul_f32 v[202:203], v[114:115], v[16:17] op_sel_hi:[1,0]
    s_add_u32 s62, s62, 4096
    s_add_u32 s63, s63, 4096
    s_mov_b32 m0, s62
    buffer_load_dwordx4 v8, s[28:31], s63 offen offset:0 lds
    v_pk_fma_f32 v[32:33], v[32:33], v[16:17], v[176:177] op_sel:[0,1,0] op_sel_hi:[1,1,1]
    v_pk_fma_f32 v[34:35], v[34:35], v[16:17], v[178:179] op_sel:[0,1,0] op_sel_hi:[1,1,1]
    v_pk_fma_f32 v[36:37], v[36:37], v[16:17], v[180:181] op_sel:[0,1,0] op_sel_hi:[1,1,1]
    v_pk_fma_f32 v[38:39], v[38:39], v[16:17], v[182:183] op_sel:[0,1,0] op_sel_hi:[1,1,1]
    v_pk_fma_f32 v[40:41], v[40:41], v[16:17], v[184:185] op_sel:[0,1,0] op_sel_hi:[1,1,1]
    v_pk_fma_f32 v[42:43], v[42:43], v[16:17], v[186:187] op_sel:[0,1,0] op_sel_hi:[1,1,1]
    v_pk_fma_f32 v[44:45], v[44:45], v[16:17], v[188:189] op_sel:[0,1,0] op_sel_hi:[1,1,1]
    v_pk_fma_f32 v[46:47], v[46:47], v[16:17], v[190:191] op_sel:[0,1,0] op_sel_hi:[1,1,1]
    v_pk_fma_f32 v[48:49], v[48:49], v[16:17], v[192:193] op_sel:[0,1,0] op_sel_hi:[1,1,1]
    v_pk_fma_f32 v[50:51], v[50:51], v[16:17], v[194:195] op_sel:[0,1,0] op_sel_hi:[1,1,1]
    v_pk_fma_f32 v[52:53], v[52:53], v[16:17], v[196:197] op_sel:[0,1,0] op_sel_hi:[1,1,1]
    v_pk_fma_f32 v[54:55], v[54:55], v[16:17], v[198:199] op_sel:[0,1,0] op_sel_hi:[1,1,1]
    v_pk_fma_f32 v[56:57], v[56:57], v[16:17], v[200:201] op_sel:[0,1,0] op_sel_hi:[1,1,1]
    v_pk_fma_f32 v[58:59], v[58:59], v[16:17], v[202:203] op_sel:[0,1,0] op_sel_hi:[1,1,1]
    v_pk_mul_f32 v[176:177], v[32:33], v[32:33]
    v_pk_mul_f32 v[178:179], v[34:35], v[34:35]
    v_pk_mul_f32 v[180:181], v[36:37], v[36:37]
    v_pk_mul_f32 v[182:183], v[38:39], v[38:39]
    v_pk_mul_f32 v[184:185], v[40:41], v[40:41]
    buffer_load_dwordx4 v8, s[28:31], s63 offen offset:1024 lds
    v_pk_mul_f32 v[186:187], v[42:43], v[42:43]
    v_pk_mul_f32 v[188:189], v[44:45], v[44:45]
    v_pk_mul_f32 v[190:191], v[46:47], v[46:47]
    v_pk_mul_f32 v[192:193], v[48:49], v[48:49]
    v_pk_mul_f32 v[194:195], v[50:51], v[50:51]
    v_pk_mul_f32 v[196:197], v[52:53], v[52:53]
    v_pk_mul_f32 v[198:199], v[54:55], v[54:55]
    v_pk_mul_f32 v[200:201], v[56:57], v[56:57]
    v_pk_mul_f32 v[202:203], v[58:59], v[58:59]
    v_pk_fma_f32 v[176:177], v[176:177], v[30:31], v[30:31] op_sel:[0,0,1] op_sel_hi:[1,0,1]
    v_pk_fma_f32 v[178:179], v[178:179], v[30:31], v[30:31] op_sel:[0,0,1] op_sel_hi:[1,0,1]
    v_pk_fma_f32 v[180:181], v[180:181], v[30:31], v[30:31] op_sel:[0,0,1] op_sel_hi:[1,0,1]
    v_pk_fma_f32 v[182:183], v[182:183], v[30:31], v[30:31] op_sel:[0,0,1] op_sel_hi:[1,0,1]
    v_pk_fma_f32 v[184:185], v[184:185], v[30:31], v[30:31] op_sel:[0,0,1] op_sel_hi:[1,0,1]
    v_pk_fma_f32 v[186:187], v[186:187], v[30:31], v[30:31] op_sel:[0,0,1] op_sel_hi:[1,0,1]
    v_pk_fma_f32 v[188:189], v[188:189], v[30:31], v[30:31] op_sel:[0,0,1] op_sel_hi:[1,0,1]
    v_pk_fma_f32 v[190:191], v[190:191], v[30:31], v[30:31] op_sel:[0,0,1] op_sel_hi:[1,0,1]
    v_pk_fma_f32 v[192:193], v[192:193], v[30:31], v[30:31] op_sel:[0,0,1] op_sel_hi:[1,0,1]
    v_pk_fma_f32 v[194:195], v[194:195], v[30:31], v[30:31] op_sel:[0,0,1] op_sel_hi:[1,0,1]
    buffer_load_dwordx4 v8, s[28:31], s63 offen offset:2048 lds
    v_pk_fma_f32 v[196:197], v[196:197], v[30:31], v[30:31] op_sel:[0,0,1] op_sel_hi:[1,0,1]
    v_pk_fma_f32 v[198:199], v[198:199], v[30:31], v[30:31] op_sel:[0,0,1] op_sel_hi:[1,0,1]
    v_pk_fma_f32 v[200:201], v[200:201], v[30:31], v[30:31] op_sel:[0,0,1] op_sel_hi:[1,0,1]
    v_pk_fma_f32 v[202:203], v[202:203], v[30:31], v[30:31] op_sel:[0,0,1] op_sel_hi:[1,0,1]
    v_pk_mul_f32 v[176:177], v[176:177], v[32:33]
    v_pk_mul_f32 v[178:179], v[178:179], v[34:35]
    v_pk_mul_f32 v[180:181], v[180:181], v[36:37]
    v_pk_mul_f32 v[182:183], v[182:183], v[38:39]
    v_pk_mul_f32 v[184:185], v[184:185], v[40:41]
    v_pk_mul_f32 v[186:187], v[186:187], v[42:43]
    v_pk_mul_f32 v[188:189], v[188:189], v[44:45]
    v_pk_mul_f32 v[190:191], v[190:191], v[46:47]
    v_pk_mul_f32 v[192:193], v[192:193], v[48:49]
    v_pk_mul_f32 v[194:195], v[194:195], v[50:51]
    v_pk_mul_f32 v[196:197], v[196:197], v[52:53]
    v_pk_mul_f32 v[198:199], v[198:199], v[54:55]
    v_pk_mul_f32 v[200:201], v[200:201], v[56:57]
    v_pk_mul_f32 v[202:203], v[202:203], v[58:59]
    v_exp_f32 v176, v176
    buffer_load_dwordx4 v8, s[28:31], s63 offen offset:3072 lds
    v_exp_f32 v177, v177
    v_exp_f32 v178, v178
    v_exp_f32 v179, v179
    v_exp_f32 v180, v180
    v_exp_f32 v181, v181
    v_exp_f32 v182, v182
    v_exp_f32 v183, v183
    v_exp_f32 v184, v184
    v_exp_f32 v185, v185
    v_exp_f32 v186, v186
    s_add_u32 s62, s62, 4096
    s_add_u32 s63, s63, 4096
    s_mov_b32 m0, s62
    buffer_load_dwordx4 v8, s[28:31], s63 offen offset:0 lds
    v_exp_f32 v187, v187
    v_exp_f32 v188, v188
    v_exp_f32 v189, v189
    v_exp_f32 v190, v190
    v_exp_f32 v191, v191
    v_exp_f32 v192, v192
    v_exp_f32 v193, v193
    v_exp_f32 v194, v194
    v_exp_f32 v195, v195
    v_exp_f32 v196, v196
    buffer_load_dwordx4 v8, s[28:31], s63 offen offset:1024 lds
    v_exp_f32 v197, v197
    v_exp_f32 v198, v198
    v_exp_f32 v199, v199
    v_exp_f32 v200, v200
    v_exp_f32 v201, v201
    v_exp_f32 v202, v202
    v_exp_f32 v203, v203
    v_pk_add_f32 v[176:177], v[176:177], 1.0 op_sel_hi:[1,0]
    v_pk_add_f32 v[178:179], v[178:179], 1.0 op_sel_hi:[1,0]
    v_pk_add_f32 v[180:181], v[180:181], 1.0 op_sel_hi:[1,0]
    v_pk_add_f32 v[182:183], v[182:183], 1.0 op_sel_hi:[1,0]
    v_pk_add_f32 v[184:185], v[184:185], 1.0 op_sel_hi:[1,0]
    buffer_load_dwordx4 a[96:99], v8, s[28:31], s55 offen offset:0
    v_pk_add_f32 v[186:187], v[186:187], 1.0 op_sel_hi:[1,0]
    v_pk_add_f32 v[188:189], v[188:189], 1.0 op_sel_hi:[1,0]
    v_pk_add_f32 v[190:191], v[190:191], 1.0 op_sel_hi:[1,0]
    v_pk_add_f32 v[192:193], v[192:193], 1.0 op_sel_hi:[1,0]
    v_pk_add_f32 v[194:195], v[194:195], 1.0 op_sel_hi:[1,0]
    v_pk_add_f32 v[196:197], v[196:197], 1.0 op_sel_hi:[1,0]
    v_pk_add_f32 v[198:199], v[198:199], 1.0 op_sel_hi:[1,0]
    v_pk_add_f32 v[200:201], v[200:201], 1.0 op_sel_hi:[1,0]
    v_pk_add_f32 v[202:203], v[202:203], 1.0 op_sel_hi:[1,0]
    v_rcp_f32 v176, v176
    v_rcp_f32 v177, v177
    v_rcp_f32 v178, v178
    v_rcp_f32 v179, v179
    v_rcp_f32 v180, v180
    buffer_load_dwordx4 a[100:103], v8, s[28:31], s55 offen offset:1024
    v_rcp_f32 v181, v181
    v_rcp_f32 v182, v182
    v_rcp_f32 v183, v183
    v_rcp_f32 v184, v184
    v_rcp_f32 v185, v185
    v_rcp_f32 v186, v186
    v_rcp_f32 v187, v187
    v_rcp_f32 v188, v188
    v_rcp_f32 v189, v189
    v_rcp_f32 v190, v190
    buffer_load_dwordx4 a[104:107], v8, s[28:31], s55 offen offset:2048
    v_rcp_f32 v191, v191
    v_rcp_f32 v192, v192
    v_rcp_f32 v193, v193
    v_rcp_f32 v194, v194
    v_rcp_f32 v195, v195
    v_rcp_f32 v196, v196
    v_rcp_f32 v197, v197
    v_rcp_f32 v198, v198
    v_rcp_f32 v199, v199
    v_rcp_f32 v200, v200
    buffer_load_dwordx4 a[108:111], v8, s[28:31], s55 offen offset:3072
    v_rcp_f32 v201, v201
    v_rcp_f32 v202, v202
    v_rcp_f32 v203, v203
    v_pk_mul_f32 v[32:33], v[32:33], v[176:177]
    v_pk_mul_f32 v[34:35], v[34:35], v[178:179]
    v_pk_mul_f32 v[36:37], v[36:37], v[180:181]
    v_pk_mul_f32 v[38:39], v[38:39], v[182:183]
    v_pk_mul_f32 v[40:41], v[40:41], v[184:185]
    v_pk_mul_f32 v[42:43], v[42:43], v[186:187]
    v_pk_mul_f32 v[44:45], v[44:45], v[188:189]
    v_pk_mul_f32 v[46:47], v[46:47], v[190:191]
    v_pk_mul_f32 v[48:49], v[48:49], v[192:193]
    v_pk_mul_f32 v[50:51], v[50:51], v[194:195]
    v_pk_mul_f32 v[52:53], v[52:53], v[196:197]
    v_pk_mul_f32 v[54:55], v[54:55], v[198:199]
    v_pk_mul_f32 v[56:57], v[56:57], v[200:201]
    s_add_u32 s55, s55, 4096
    buffer_load_dwordx4 a[112:115], v8, s[28:31], s55 offen offset:0
    s_add_u32 s55, s55, 6144
    v_pk_mul_f32 v[58:59], v[58:59], v[202:203]
    v_cvt_pk_bf16_f32 v144, v32, v33
    v_cvt_pk_bf16_f32 v145, v34, v35
    v_cvt_pk_bf16_f32 v146, v36, v37
    v_cvt_pk_bf16_f32 v147, v38, v39
    v_cvt_pk_bf16_f32 v148, v40, v41
    v_cvt_pk_bf16_f32 v149, v42, v43
    v_cvt_pk_bf16_f32 v150, v44, v45
    v_cvt_pk_bf16_f32 v151, v46, v47
    v_cvt_pk_bf16_f32 v152, v48, v49
    v_cvt_pk_bf16_f32 v153, v50, v51
    v_cvt_pk_bf16_f32 v154, v52, v53
    v_cvt_pk_bf16_f32 v155, v54, v55
    v_cvt_pk_bf16_f32 v156, v56, v57
    v_cvt_pk_bf16_f32 v157, v58, v59
    s_nop 1
    v_permlane16_swap_b32 v144, v146
    v_permlane16_swap_b32 v145, v147
    v_permlane16_swap_b32 v148, v150
    v_permlane16_swap_b32 v149, v151
    v_permlane16_swap_b32 v152, v154
    v_permlane16_swap_b32 v153, v155
    s_add_u32 s26, s13, 0
    s_add_u32 s27, s12, 0
    buffer_store_dwordx4 v[144:147], v226, s[28:31], s26 offen sc1
    buffer_store_dwordx2 v[156:157], v227, s[28:31], s27 offen sc1
    s_cmp_eq_u32 s52, 15
    s_cbranch_scc1 chain_kernel_j157
    buffer_store_dwordx4 v[148:151], v226, s[28:31], s26 offen offset:1024 sc1
    buffer_store_dwordx4 v[152:155], v226, s[28:31], s26 offen offset:2048 sc1
chain_kernel_j157:
    v_pk_mul_f32 v[176:177], v[88:89], v[20:21] op_sel_hi:[1,0]
    buffer_load_dwordx4 a[116:119], v8, s[28:31], s55 offen offset:0
    v_pk_mul_f32 v[178:179], v[90:91], v[20:21] op_sel_hi:[1,0]
    v_pk_mul_f32 v[180:181], v[92:93], v[20:21] op_sel_hi:[1,0]
    v_pk_mul_f32 v[182:183], v[94:95], v[20:21] op_sel_hi:[1,0]
    v_pk_mul_f32 v[184:185], v[96:97], v[20:21] op_sel_hi:[1,0]
    v_pk_mul_f32 v[186:187], v[98:99], v[20:21] op_sel_hi:[1,0]
    v_pk_mul_f32 v[188:189], v[100:101], v[20:21] op_sel_hi:[1,0]
    v_pk_mul_f32 v[190:191], v[102:103], v[20:21] op_sel_hi:[1,0]
    v_pk_mul_f32 v[192:193], v[104:105], v[20:21] op_sel_hi:[1,0]
    v_pk_mul_f32 v[194:195], v[106:107], v[20:21] op_sel_hi:[1,0]
    v_pk_mul_f32 v[196:197], v[108:109], v[20:21] op_sel_hi:[1,0]
    v_pk_mul_f32 v[198:199], v[110:111], v[20:21] op_sel_hi:[1,0]
    v_pk_mul_f32 v[200:201], v[112:113], v[20:21] op_sel_hi:[1,0]
    v_pk_mul_f32 v[202:203], v[114:115], v[20:21] op_sel_hi:[1,0]
    v_pk_fma_f32 v[60:61], v[60:61], v[20:21], v[176:177] op_sel:[0,1,0] op_sel_hi:[1,1,1]
    v_pk_fma_f32 v[62:63], v[62:63], v[20:21], v[178:179] op_sel:[0,1,0] op_sel_hi:[1,1,1]
    v_pk_fma_f32 v[64:65], v[64:65], v[20:21], v[180:181] op_sel:[0,1,0] op_sel_hi:[1,1,1]
    v_pk_fma_f32 v[66:67], v[66:67], v[20:21], v[182:183] op_sel:[0,1,0] op_sel_hi:[1,1,1]
    v_pk_fma_f32 v[68:69], v[68:69], v[20:21], v[184:185] op_sel:[0,1,0] op_sel_hi:[1,1,1]
    v_pk_fma_f32 v[70:71], v[70:71], v[20:21], v[186:187] op_sel:[0,1,0] op_sel_hi:[1,1,1]
    buffer_load_dwordx4 a[120:123], v8, s[28:31], s55 offen offset:1024
    v_pk_fma_f32 v[72:73], v[72:73], v[20:21], v[188:189] op_sel:[0,1,0] op_sel_hi:[1,1,1]
    v_pk_fma_f32 v[74:75], v[74:75], v[20:21], v[190:191] op_sel:[0,1,0] op_sel_hi:[1,1,1]
    v_pk_fma_f32 v[76:77], v[76:77], v[20:21], v[192:193] op_sel:[0,1,0] op_sel_hi:[1,1,1]
    v_pk_fma_f32 v[78:79], v[78:79], v[20:21], v[194:195] op_sel:[0,1,0] op_sel_hi:[1,1,1]
    v_pk_fma_f32 v[80:81], v[80:81], v[20:21], v[196:197] op_sel:[0,1,0] op_sel_hi:[1,1,1]
    v_pk_fma_f32 v[82:83], v[82:83], v[20:21], v[198:199] op_sel:[0,1,0] op_sel_hi:[1,1,1]
    v_pk_fma_f32 v[84:85], v[84:85], v[20:21], v[200:201] op_sel:[0,1,0] op_sel_hi:[1,1,1]
    v_pk_fma_f32 v[86:87], v[86:87], v[20:21], v[202:203] op_sel:[0,1,0] op_sel_hi:[1,1,1]
    v_pk_mul_f32 v[176:177], v[60:61], v[60:61]
    v_pk_mul_f32 v[178:179], v[62:63], v[62:63]
    v_pk_mul_f32 v[180:181], v[64:65], v[64:65]
    v_pk_mul_f32 v[182:183], v[66:67], v[66:67]
    v_pk_mul_f32 v[184:185], v[68:69], v[68:69]
    v_pk_mul_f32 v[186:187], v[70:71], v[70:71]
    v_pk_mul_f32 v[188:189], v[72:73], v[72:73]
    v_pk_mul_f32 v[190:191], v[74:75], v[74:75]
    v_pk_mul_f32 v[192:193], v[76:77], v[76:77]
    v_pk_mul_f32 v[194:195], v[78:79], v[78:79]
    v_pk_mul_f32 v[196:197], v[80:81], v[80:81]
    buffer_load_dwordx4 a[124:127], v8, s[28:31], s55 offen offset:2048
    v_pk_mul_f32 v[198:199], v[82:83], v[82:83]
    v_pk_mul_f32 v[200:201], v[84:85], v[84:85]
    v_pk_mul_f32 v[202:203], v[86:87], v[86:87]
    v_pk_fma_f32 v[176:177], v[176:177], v[30:31], v[30:31] op_sel:[0,0,1] op_sel_hi:[1,0,1]
    v_pk_fma_f32 v[178:179], v[178:179], v[30:31], v[30:31] op_sel:[0,0,1] op_sel_hi:[1,0,1]
    v_pk_fma_f32 v[180:181], v[180:181], v[30:31], v[30:31] op_sel:[0,0,1] op_sel_hi:[1,0,1]
    v_pk_fma_f32 v[182:183], v[182:183], v[30:31], v[30:31] op_sel:[0,0,1] op_sel_hi:[1,0,1]
    v_pk_fma_f32 v[184:185], v[184:185], v[30:31], v[30:31] op_sel:[0,0,1] op_sel_hi:[1,0,1]
    v_pk_fma_f32 v[186:187], v[186:187], v[30:31], v[30:31] op_sel:[0,0,1] op_sel_hi:[1,0,1]
    v_pk_fma_f32 v[188:189], v[188:189], v[30:31], v[30:31] op_sel:[0,0,1] op_sel_hi:[1,0,1]
    v_pk_fma_f32 v[190:191], v[190:191], v[30:31], v[30:31] op_sel:[0,0,1] op_sel_hi:[1,0,1]
    v_pk_fma_f32 v[192:193], v[192:193], v[30:31], v[30:31] op_sel:[0,0,1] op_sel_hi:[1,0,1]
    v_pk_fma_f32 v[194:195], v[194:195], v[30:31], v[30:31] op_sel:[0,0,1] op_sel_hi:[1,0,1]
    v_pk_fma_f32 v[196:197], v[196:197], v[30:31], v[30:31] op_sel:[0,0,1] op_sel_hi:[1,0,1]
    v_pk_fma_f32 v[198:199], v[198:199], v[30:31], v[30:31] op_sel:[0,0,1] op_sel_hi:[1,0,1]
    v_pk_fma_f32 v[200:201], v[200:201], v[30:31], v[30:31] op_sel:[0,0,1] op_sel_hi:[1,0,1]
    v_pk_fma_f32 v[202:203], v[202:203], v[30:31], v[30:31] op_sel:[0,0,1] op_sel_hi:[1,0,1]
    v_pk_mul_f32 v[176:177], v[176:177], v[60:61]
    v_pk_mul_f32 v[178:179], v[178:179], v[62:63]
    buffer_load_dwordx4 a[128:131], v8, s[28:31], s55 offen offset:3072
    v_pk_mul_f32 v[180:181], v[180:181], v[64:65]
    v_pk_mul_f32 v[182:183], v[182:183], v[66:67]
    v_pk_mul_f32 v[184:185], v[184:185], v[68:69]
    v_pk_mul_f32 v[186:187], v[186:187], v[70:71]
    v_pk_mul_f32 v[188:189], v[188:189], v[72:73]
    v_pk_mul_f32 v[190:191], v[190:191], v[74:75]
    v_pk_mul_f32 v[192:193], v[192:193], v[76:77]
    v_pk_mul_f32 v[194:195], v[194:195], v[78:79]
    v_pk_mul_f32 v[196:197], v[196:197], v[80:81]
    v_pk_mul_f32 v[198:199], v[198:199], v[82:83]
    v_pk_mul_f32 v[200:201], v[200:201], v[84:85]
    v_pk_mul_f32 v[202:203], v[202:203], v[86:87]
    v_exp_f32 v176, v176
    v_exp_f32 v177, v177
    v_exp_f32 v178, v178
    v_exp_f32 v179, v179
    s_add_u32 s55, s55, 4096
    buffer_load_dwordx4 a[132:135], v8, s[28:31], s55 offen offset:0
    s_add_u32 s55, s55, 6144
    v_exp_f32 v180, v180
    v_exp_f32 v181, v181
    v_exp_f32 v182, v182
    v_exp_f32 v183, v183
    v_exp_f32 v184, v184
    v_exp_f32 v185, v185
    v_exp_f32 v186, v186
    v_exp_f32 v187, v187
    v_exp_f32 v188, v188
    v_exp_f32 v189, v189
    buffer_load_dwordx4 a[136:139], v8, s[28:31], s55 offen offset:0
    v_exp_f32 v190, v190
    v_exp_f32 v191, v191
    v_exp_f32 v192, v192
    v_exp_f32 v193, v193
    v_exp_f32 v194, v194
    v_exp_f32 v195, v195
    v_exp_f32 v196, v196
    v_exp_f32 v197, v197
    v_exp_f32 v198, v198
    v_exp_f32 v199, v199
    buffer_load_dwordx4 a[140:143], v8, s[28:31], s55 offen offset:1024
    v_exp_f32 v200, v200
    v_exp_f32 v201, v201
    v_exp_f32 v202, v202
    v_exp_f32 v203, v203
    v_pk_add_f32 v[176:177], v[176:177], 1.0 op_sel_hi:[1,0]
    v_pk_add_f32 v[178:179], v[178:179], 1.0 op_sel_hi:[1,0]
    v_pk_add_f32 v[180:181], v[180:181], 1.0 op_sel_hi:[1,0]
    v_pk_add_f32 v[182:183], v[182:183], 1.0 op_sel_hi:[1,0]
    v_pk_add_f32 v[184:185], v[184:185], 1.0 op_sel_hi:[1,0]
    v_pk_add_f32 v[186:187], v[186:187], 1.0 op_sel_hi:[1,0]
    v_pk_add_f32 v[188:189], v[188:189], 1.0 op_sel_hi:[1,0]
    v_pk_add_f32 v[190:191], v[190:191], 1.0 op_sel_hi:[1,0]
    v_pk_add_f32 v[192:193], v[192:193], 1.0 op_sel_hi:[1,0]
    v_pk_add_f32 v[194:195], v[194:195], 1.0 op_sel_hi:[1,0]
    v_pk_add_f32 v[196:197], v[196:197], 1.0 op_sel_hi:[1,0]
    buffer_load_dwordx4 a[144:147], v8, s[28:31], s55 offen offset:2048
    v_pk_add_f32 v[198:199], v[198:199], 1.0 op_sel_hi:[1,0]
    v_pk_add_f32 v[200:201], v[200:201], 1.0 op_sel_hi:[1,0]
    v_pk_add_f32 v[202:203], v[202:203], 1.0 op_sel_hi:[1,0]
    v_rcp_f32 v176, v176
    v_rcp_f32 v177, v177
    v_rcp_f32 v178, v178
    v_rcp_f32 v179, v179
    v_rcp_f32 v180, v180
    v_rcp_f32 v181, v181
    v_rcp_f32 v182, v182
    v_rcp_f32 v183, v183
    buffer_load_dwordx4 a[148:151], v8, s[28:31], s55 offen offset:3072
    v_rcp_f32 v184, v184
    v_rcp_f32 v185, v185
    v_rcp_f32 v186, v186
    v_rcp_f32 v187, v187
    v_rcp_f32 v188, v188
    v_rcp_f32 v189, v189
    v_rcp_f32 v190, v190
    v_rcp_f32 v191, v191
    v_rcp_f32 v192, v192
    v_rcp_f32 v193, v193
    s_add_u32 s55, s55, 4096
    buffer_load_dwordx4 a[152:155], v8, s[28:31], s55 offen offset:0
    s_add_u32 s55, s55, 6144
    v_rcp_f32 v194, v194
    v_rcp_f32 v195, v195
    v_rcp_f32 v196, v196
    v_rcp_f32 v197, v197
    v_rcp_f32 v198, v198
    v_rcp_f32 v199, v199
    v_rcp_f32 v200, v200
    v_rcp_f32 v201, v201
    v_rcp_f32 v202, v202
    v_rcp_f32 v203, v203
    buffer_load_dwordx4 a[156:159], v8, s[28:31], s55 offen offset:0
    v_pk_mul_f32 v[60:61], v[60:61], v[176:177]
    v_pk_mul_f32 v[62:63], v[62:63], v[178:179]
    v_pk_mul_f32 v[64:65], v[64:65], v[180:181]
    v_pk_mul_f32 v[66:67], v[66:67], v[182:183]
    v_pk_mul_f32 v[68:69], v[68:69], v[184:185]
    v_pk_mul_f32 v[70:71], v[70:71], v[186:187]
    v_pk_mul_f32 v[72:73], v[72:73], v[188:189]
    v_pk_mul_f32 v[74:75], v[74:75], v[190:191]
    v_pk_mul_f32 v[76:77], v[76:77], v[192:193]
    v_pk_mul_f32 v[78:79], v[78:79], v[194:195]
    v_pk_mul_f32 v[80:81], v[80:81], v[196:197]
    v_pk_mul_f32 v[82:83], v[82:83], v[198:199]
    v_pk_mul_f32 v[84:85], v[84:85], v[200:201]
    v_pk_mul_f32 v[86:87], v[86:87], v[202:203]
    v_cvt_pk_bf16_f32 v160, v60, v61
    v_cvt_pk_bf16_f32 v161, v62, v63
    v_cvt_pk_bf16_f32 v162, v64, v65
    v_cvt_pk_bf16_f32 v163, v66, v67
    v_cvt_pk_bf16_f32 v164, v68, v69
    v_cvt_pk_bf16_f32 v165, v70, v71
    v_cvt_pk_bf16_f32 v166, v72, v73
    v_cvt_pk_bf16_f32 v167, v74, v75
    v_cvt_pk_bf16_f32 v168, v76, v77
    v_cvt_pk_bf16_f32 v169, v78, v79
    v_cvt_pk_bf16_f32 v170, v80, v81
    v_cvt_pk_bf16_f32 v171, v82, v83
    v_cvt_pk_bf16_f32 v172, v84, v85
    v_cvt_pk_bf16_f32 v173, v86, v87
    s_nop 1
    v_permlane16_swap_b32 v160, v162
    v_permlane16_swap_b32 v161, v163
    v_permlane16_swap_b32 v164, v166
    v_permlane16_swap_b32 v165, v167
    v_permlane16_swap_b32 v168, v170
    v_permlane16_swap_b32 v169, v171
    s_add_u32 s26, s13, 55296
    s_add_u32 s27, s12, 55296
    buffer_store_dwordx4 v[160:163], v226, s[28:31], s26 offen sc1
    buffer_store_dwordx2 v[172:173], v227, s[28:31], s27 offen sc1
    s_cmp_eq_u32 s52, 15
    s_cbranch_scc1 chain_kernel_j158
    buffer_store_dwordx4 v[164:167], v226, s[28:31], s26 offen offset:1024 sc1
    buffer_store_dwordx4 v[168:171], v226, s[28:31], s26 offen offset:2048 sc1
chain_kernel_j158:
    s_waitcnt vmcnt(0)
    v_mov_b32 v2, 1
    v_mov_b32 v7, 0
    s_mov_b64 exec, 1
    buffer_store_dword v2, v7, s[28:31], s15 offen sc1
    s_mov_b64 exec, -1
    buffer_load_dwordx4 a[160:163], v8, s[28:31], s55 offen offset:1024
    buffer_load_dwordx4 a[164:167], v8, s[28:31], s55 offen offset:2048
    buffer_load_dwordx4 a[168:171], v8, s[28:31], s55 offen offset:3072
    s_add_u32 s55, s55, 4096
    buffer_load_dwordx4 a[172:175], v8, s[28:31], s55 offen offset:0
    s_add_u32 s55, s55, 6144
    buffer_load_dwordx4 a[176:179], v8, s[28:31], s55 offen offset:0
    buffer_load_dwordx4 a[180:183], v8, s[28:31], s55 offen offset:1024
    buffer_load_dwordx4 a[184:187], v8, s[28:31], s55 offen offset:2048
    buffer_load_dwordx4 a[188:191], v8, s[28:31], s55 offen offset:3072
    s_add_u32 s55, s55, 4096
    buffer_load_dwordx4 a[192:195], v8, s[28:31], s55 offen offset:0
    s_add_u32 s55, s55, 6144
    buffer_load_dwordx4 a[196:199], v8, s[28:31], s55 offen offset:0
    buffer_load_dwordx4 a[200:203], v8, s[28:31], s55 offen offset:1024
    buffer_load_dwordx4 a[204:207], v8, s[28:31], s55 offen offset:2048
    buffer_load_dwordx4 a[208:211], v8, s[28:31], s55 offen offset:3072
    s_add_u32 s55, s55, 4096
    buffer_load_dwordx4 a[212:215], v8, s[28:31], s55 offen offset:0
    s_add_u32 s55, s55, 6144
    buffer_load_dwordx4 a[216:219], v8, s[28:31], s55 offen offset:0
    buffer_load_dwordx4 a[220:223], v8, s[28:31], s55 offen offset:1024
    buffer_load_dwordx4 a[224:227], v8, s[28:31], s55 offen offset:2048
    buffer_load_dwordx4 a[228:231], v8, s[28:31], s55 offen offset:3072
    s_add_u32 s55, s55, 4096
    buffer_load_dwordx4 a[232:235], v8, s[28:31], s55 offen offset:0
    s_add_u32 s55, s55, 6144
    buffer_load_dwordx4 a[236:239], v8, s[28:31], s55 offen offset:0
    buffer_load_dwordx4 a[240:243], v8, s[28:31], s55 offen offset:1024
    buffer_load_dwordx4 a[244:247], v8, s[28:31], s55 offen offset:2048
    buffer_load_dwordx4 a[248:251], v8, s[28:31], s55 offen offset:3072
    s_add_u32 s55, s55, 4096
    buffer_load_dwordx4 a[252:255], v8, s[28:31], s55 offen offset:0
    s_add_u32 s55, s55, 6144
    s_mul_i32 s26, s22, 5120
    v_add_u32 v12, s26, v8
    v_add_u32 v13, 0x10000, v12
    v_add_u32 v14, 0x20000, v12
    s_mov_b32 s47, 0
    s_mov_b64 exec, 511
chain_kernel_poll9:
    buffer_load_dword v2, v234, s[28:31], s48 offen sc1
    s_add_u32 s47, s47, 1
    s_waitcnt vmcnt(0)
    v_cmp_ne_u32 vcc, 1, v2
    s_cmp_ge_u32 s47, 200000
    s_cbranch_scc1 chain_kernel_polld10
    s_cbranch_vccnz chain_kernel_poll9
chain_kernel_polld10:
    s_mov_b64 exec, -1
    buffer_load_dwordx4 a[0:3], v8, s[28:31], s50 offen offset:0 sc1
    buffer_load_dwordx4 a[4:7], v8, s[28:31], s51 offen offset:0 sc1
    buffer_load_dwordx4 a[8:11], v8, s[28:31], s50 offen offset:1024 sc1
    buffer_load_dwordx4 a[12:15], v8, s[28:31], s51 offen offset:1024 sc1
    buffer_load_dwordx4 a[16:19], v8, s[28:31], s50 offen offset:2048 sc1
    buffer_load_dwordx4 a[20:23], v8, s[28:31], s51 offen offset:2048 sc1
    buffer_load_dwordx4 a[24:27], v8, s[28:31], s50 offen offset:3072 sc1
    buffer_load_dwordx4 a[28:31], v8, s[28:31], s51 offen offset:3072 sc1
    s_add_u32 s50, s50, 4096
    s_add_u32 s51, s51, 4096
    buffer_load_dwordx4 a[32:35], v8, s[28:31], s50 offen offset:0 sc1
    buffer_load_dwordx4 a[36:39], v8, s[28:31], s51 offen offset:0 sc1
    s_barrier
    ds_read_b128 v[136:139], v14 offset:12288
    ds_read_b128 v[140:143], v14 offset:13312
    ds_read_b128 v[144:147], v14 offset:14336
    ds_read_b128 v[148:151], v14 offset:15360
    ds_read_b128 v[152:155], v14 offset:16384
    ds_read_b128 v[156:159], v12 offset:0
    ds_read_b128 v[160:163], v12 offset:1024
    ds_read_b128 v[164:167], v12 offset:2048
    ds_read_b128 v[168:171], v12 offset:3072
    ds_read_b128 v[172:175], v12 offset:4096
    ds_read_b128 v[176:179], v12 offset:10240
    s_waitcnt vmcnt(8) lgkmcnt(6)
    v_mfma_f32_16x16x32_bf16 v[32:35], v[136:139], a[0:3], 0
    v_mfma_f32_16x16x32_bf16 v[52:55], v[136:139], a[4:7], 0
    ds_read_b128 v[180:183], v12 offset:11264
    buffer_load_dwordx4 a[40:43], v8, s[28:31], s50 offen offset:1024 sc1
    v_mfma_f32_16x16x32_bf16 v[36:39], v[140:143], a[0:3], 0
    v_mfma_f32_16x16x32_bf16 v[56:59], v[140:143], a[4:7], 0
    ds_read_b128 v[136:139], v12 offset:12288
    v_mfma_f32_16x16x32_bf16 v[40:43], v[144:147], a[0:3], 0
    v_mfma_f32_16x16x32_bf16 v[60:63], v[144:147], a[4:7], 0
    ds_read_b128 v[140:143], v12 offset:13312
    buffer_load_dwordx4 a[44:47], v8, s[28:31], s51 offen offset:1024 sc1
    v_mfma_f32_16x16x32_bf16 v[44:47], v[148:151], a[0:3], 0
    v_mfma_f32_16x16x32_bf16 v[64:67], v[148:151], a[4:7], 0
    ds_read_b128 v[144:147], v12 offset:14336
    v_mfma_f32_16x16x32_bf16 v[48:51], v[152:155], a[0:3], 0
    v_mfma_f32_16x16x32_bf16 v[68:71], v[152:155], a[4:7], 0
    ds_read_b128 v[148:151], v12 offset:20480
    buffer_load_dwordx4 a[48:51], v8, s[28:31], s50 offen offset:2048 sc1
    s_waitcnt vmcnt(9) lgkmcnt(6)
    v_mfma_f32_16x16x32_bf16 v[32:35], v[156:159], a[8:11], v[32:35]
    v_mfma_f32_16x16x32_bf16 v[52:55], v[156:159], a[12:15], v[52:55]
    ds_read_b128 v[152:155], v12 offset:21504
    v_mfma_f32_16x16x32_bf16 v[36:39], v[160:163], a[8:11], v[36:39]
    v_mfma_f32_16x16x32_bf16 v[56:59], v[160:163], a[12:15], v[56:59]
    ds_read_b128 v[156:159], v12 offset:22528
    buffer_load_dwordx4 a[52:55], v8, s[28:31], s51 offen offset:2048 sc1
    v_mfma_f32_16x16x32_bf16 v[40:43], v[164:167], a[8:11], v[40:43]
    v_mfma_f32_16x16x32_bf16 v[60:63], v[164:167], a[12:15], v[60:63]
    ds_read_b128 v[160:163], v12 offset:23552
    v_mfma_f32_16x16x32_bf16 v[44:47], v[168:171], a[8:11], v[44:47]
    v_mfma_f32_16x16x32_bf16 v[64:67], v[168:171], a[12:15], v[64:67]
    ds_read_b128 v[164:167], v12 offset:24576
    buffer_load_dwordx4 a[56:59], v8, s[28:31], s50 offen offset:3072 sc1
    v_mfma_f32_16x16x32_bf16 v[48:51], v[172:175], a[8:11], v[48:51]
    v_mfma_f32_16x16x32_bf16 v[68:71], v[172:175], a[12:15], v[68:71]
    s_waitcnt lgkmcnt(5)
    s_barrier
    ds_read_b128 v[168:171], v12 offset:30720
    s_mul_i32 s25, s20, 3
    s_min_u32 s25, s25, 7
    s_lshl_b32 s25, s25, 10
    s_add_u32 s62, s25, 143360
    s_add_u32 s63, s25, s59
    s_add_u32 s63, s63, 163840
    s_mov_b32 m0, s62
    buffer_load_dwordx4 v8, s[28:31], s63 offen offset:0 lds
    s_waitcnt vmcnt(10) lgkmcnt(6)
    v_mfma_f32_16x16x32_bf16 v[32:35], v[176:179], a[16:19], v[32:35]
    v_mfma_f32_16x16x32_bf16 v[52:55], v[176:179], a[20:23], v[52:55]
    ds_read_b128 v[172:175], v12 offset:31744
    buffer_load_dwordx4 v8, s[28:31], s63 offen offset:1024 lds
    v_mfma_f32_16x16x32_bf16 v[36:39], v[180:183], a[16:19], v[36:39]
    v_mfma_f32_16x16x32_bf16 v[56:59], v[180:183], a[20:23], v[56:59]
    ds_read_b128 v[176:179], v12 offset:32768
    buffer_load_dwordx4 v8, s[28:31], s63 offen offset:2048 lds
    v_mfma_f32_16x16x32_bf16 v[40:43], v[136:139], a[16:19], v[40:43]
    v_mfma_f32_16x16x32_bf16 v[60:63], v[136:139], a[20:23], v[60:63]
    ds_read_b128 v[180:183], v12 offset:33792
    s_mul_i32 s25, s20, 5
    s_lshl_b32 s25, s25, 10
    s_add_u32 s62, s25, 0
    s_add_u32 s63, s25, s59
    s_add_u32 s63, s63, 174080
    s_mov_b32 m0, s62
    buffer_load_dwordx4 v8, s[28:31], s63 offen offset:0 lds
    v_mfma_f32_16x16x32_bf16 v[44:47], v[140:143], a[16:19], v[44:47]
    v_mfma_f32_16x16x32_bf16 v[64:67], v[140:143], a[20:23], v[64:67]
    ds_read_b128 v[136:139], v12 offset:34816
    buffer_load_dwordx4 v8, s[28:31], s63 offen offset:1024 lds
    v_mfma_f32_16x16x32_bf16 v[48:51], v[144:147], a[16:19], v[48:51]
    v_mfma_f32_16x16x32_bf16 v[68:71], v[144:147], a[20:23], v[68:71]
    ds_read_b128 v[140:143], v12 offset:40960
    buffer_load_dwordx4 v8, s[28:31], s63 offen offset:2048 lds
    s_waitcnt vmcnt(13) lgkmcnt(6)
    v_mfma_f32_16x16x32_bf16 v[32:35], v[148:151], a[24:27], v[32:35]
    v_mfma_f32_16x16x32_bf16 v[52:55], v[148:151], a[28:31], v[52:55]
    ds_read_b128 v[144:147], v12 offset:41984
    buffer_load_dwordx4 v8, s[28:31], s63 offen offset:3072 lds
    v_mfma_f32_16x16x32_bf16 v[36:39], v[152:155], a[24:27], v[36:39]
    v_mfma_f32_16x16x32_bf16 v[56:59], v[152:155], a[28:31], v[56:59]
    ds_read_b128 v[148:151], v12 offset:43008
    s_add_u32 s62, s62, 4096
    s_add_u32 s63, s63, 4096
    s_mov_b32 m0, s62
    buffer_load_dwordx4 v8, s[28:31], s63 offen offset:0 lds
    v_mfma_f32_16x16x32_bf16 v[40:43], v[156:159], a[24:27], v[40:43]
    v_mfma_f32_16x16x32_bf16 v[60:63], v[156:159], a[28:31], v[60:63]
    ds_read_b128 v[152:155], v12 offset:44032
    v_mfma_f32_16x16x32_bf16 v[44:47], v[160:163], a[24:27], v[44:47]
    v_mfma_f32_16x16x32_bf16 v[64:67], v[160:163], a[28:31], v[64:67]
    ds_read_b128 v[156:159], v12 offset:45056
    buffer_load_dwordx4 a[60:63], v8, s[28:31], s51 offen offset:3072 sc1
    v_mfma_f32_16x16x32_bf16 v[48:51], v[164:167], a[24:27], v[48:51]
    v_mfma_f32_16x16x32_bf16 v[68:71], v[164:167], a[28:31], v[68:71]
    ds_read_b128 v[160:163], v12 offset:51200
    s_waitcnt vmcnt(14) lgkmcnt(6)
    v_mfma_f32_16x16x32_bf16 v[32:35], v[168:171], a[32:35], v[32:35]
    v_mfma_f32_16x16x32_bf16 v[52:55], v[168:171], a[36:39], v[52:55]
    ds_read_b128 v[164:167], v12 offset:52224
    s_add_u32 s50, s50, 4096
    s_add_u32 s51, s51, 4096
    buffer_load_dwordx4 a[64:67], v8, s[28:31], s50 offen offset:0 sc1
    v_mfma_f32_16x16x32_bf16 v[36:39], v[172:175], a[32:35], v[36:39]
    v_mfma_f32_16x16x32_bf16 v[56:59], v[172:175], a[36:39], v[56:59]
    ds_read_b128 v[168:171], v12 offset:53248
    v_mfma_f32_16x16x32_bf16 v[40:43], v[176:179], a[32:35], v[40:43]
    v_mfma_f32_16x16x32_bf16 v[60:63], v[176:179], a[36:39], v[60:63]
    ds_read_b128 v[172:175], v12 offset:54272
    buffer_load_dwordx4 a[68:71], v8, s[28:31], s51 offen offset:0 sc1
    v_mfma_f32_16x16x32_bf16 v[44:47], v[180:183], a[32:35], v[44:47]
    v_mfma_f32_16x16x32_bf16 v[64:67], v[180:183], a[36:39], v[64:67]
    ds_read_b128 v[176:179], v12 offset:55296
    v_mfma_f32_16x16x32_bf16 v[48:51], v[136:139], a[32:35], v[48:51]
    v_mfma_f32_16x16x32_bf16 v[68:71], v[136:139], a[36:39], v[68:71]
    ds_read_b128 v[180:183], v12 offset:61440
    buffer_load_dwordx4 a[72:75], v8, s[28:31], s50 offen offset:1024 sc1
    s_waitcnt vmcnt(15) lgkmcnt(6)
    v_mfma_f32_16x16x32_bf16 v[32:35], v[140:143], a[40:43], v[32:35]
    v_mfma_f32_16x16x32_bf16 v[52:55], v[140:143], a[44:47], v[52:55]
    ds_read_b128 v[136:139], v12 offset:62464
    v_mfma_f32_16x16x32_bf16 v[36:39], v[144:147], a[40:43], v[36:39]
    v_mfma_f32_16x16x32_bf16 v[56:59], v[144:147], a[44:47], v[56:59]
    ds_read_b128 v[140:143], v12 offset:63488
    buffer_load_dwordx4 a[76:79], v8, s[28:31], s51 offen offset:1024 sc1
    v_mfma_f32_16x16x32_bf16 v[40:43], v[148:151], a[40:43], v[40:43]
    v_mfma_f32_16x16x32_bf16 v[60:63], v[148:151], a[44:47], v[60:63]
    ds_read_b128 v[144:147], v12 offset:64512
    v_mfma_f32_16x16x32_bf16 v[44:47], v[152:155], a[40:43], v[44:47]
    v_mfma_f32_16x16x32_bf16 v[64:67], v[152:155], a[44:47], v[64:67]
    ds_read_b128 v[148:151], v13 offset:0
    buffer_load_dwordx4 a[80:83], v8, s[28:31], s50 offen offset:2048 sc1
    v_mfma_f32_16x16x32_bf16 v[48:51], v[156:159], a[40:43], v[48:51]
    v_mfma_f32_16x16x32_bf16 v[68:71], v[156:159], a[44:47], v[68:71]
    ds_read_b128 v[152:155], v13 offset:6144
    s_waitcnt vmcnt(15) lgkmcnt(6)
    v_mfma_f32_16x16x32_bf16 v[32:35], v[160:163], a[48:51], v[32:35]
    v_mfma_f32_16x16x32_bf16 v[52:55], v[160:163], a[52:55], v[52:55]
    ds_read_b128 v[156:159], v13 offset:7168
    buffer_load_dwordx4 a[84:87], v8, s[28:31], s51 offen offset:2048 sc1
    v_mfma_f32_16x16x32_bf16 v[36:39], v[164:167], a[48:51], v[36:39]
    v_mfma_f32_16x16x32_bf16 v[56:59], v[164:167], a[52:55], v[56:59]
    ds_read_b128 v[160:163], v13 offset:8192
    v_mfma_f32_16x16x32_bf16 v[40:43], v[168:171], a[48:51], v[40:43]
    v_mfma_f32_16x16x32_bf16 v[60:63], v[168:171], a[52:55], v[60:63]
    ds_read_b128 v[164:167], v13 offset:9216
    buffer_load_dwordx4 a[88:91], v8, s[28:31], s50 offen offset:3072 sc1
    v_mfma_f32_16x16x32_bf16 v[44:47], v[172:175], a[48:51], v[44:47]
    v_mfma_f32_16x16x32_bf16 v[64:67], v[172:175], a[52:55], v[64:67]
    ds_read_b128 v[168:171], v13 offset:10240
    v_mfma_f32_16x16x32_bf16 v[48:51], v[176:179], a[48:51], v[48:51]
    v_mfma_f32_16x16x32_bf16 v[68:71], v[176:179], a[52:55], v[68:71]
    ds_read_b128 v[172:175], v14 offset:22528
    buffer_load_dwordx4 a[92:95], v8, s[28:31], s51 offen offset:3072 sc1
    s_waitcnt vmcnt(8) lgkmcnt(6)
    v_mfma_f32_16x16x32_bf16 v[32:35], v[180:183], a[56:59], v[32:35]
    v_mfma_f32_16x16x32_bf16 v[52:55], v[180:183], a[60:63], v[52:55]
    ds_read_b128 v[176:179], v14 offset:23552
    v_mfma_f32_16x16x32_bf16 v[36:39], v[136:139], a[56:59], v[36:39]
    v_mfma_f32_16x16x32_bf16 v[56:59], v[136:139], a[60:63], v[56:59]
    ds_read_b128 v[180:183], v14 offset:24576
    s_add_u32 s50, s50, 4096
    s_add_u32 s51, s51, 4096
    buffer_load_dwordx4 a[0:3], v8, s[28:31], s50 offen offset:0 sc1
    v_mfma_f32_16x16x32_bf16 v[40:43], v[140:143], a[56:59], v[40:43]
    v_mfma_f32_16x16x32_bf16 v[60:63], v[140:143], a[60:63], v[60:63]
    ds_read_b128 v[136:139], v14 offset:25600
    v_mfma_f32_16x16x32_bf16 v[44:47], v[144:147], a[56:59], v[44:47]
    v_mfma_f32_16x16x32_bf16 v[64:67], v[144:147], a[60:63], v[64:67]
    ds_read_b128 v[140:143], v14 offset:26624
    buffer_load_dwordx4 a[4:7], v8, s[28:31], s51 offen offset:0 sc1
    v_mfma_f32_16x16x32_bf16 v[48:51], v[148:151], a[56:59], v[48:51]
    v_mfma_f32_16x16x32_bf16 v[68:71], v[148:151], a[60:63], v[68:71]
    ds_read_b128 v[144:147], v13 offset:57344
    s_waitcnt vmcnt(8) lgkmcnt(6)
    v_mfma_f32_16x16x32_bf16 v[32:35], v[152:155], a[64:67], v[32:35]
    v_mfma_f32_16x16x32_bf16 v[52:55], v[152:155], a[68:71], v[52:55]
    ds_read_b128 v[148:151], v13 offset:58368
    buffer_load_dwordx4 a[8:11], v8, s[28:31], s50 offen offset:1024 sc1
    v_mfma_f32_16x16x32_bf16 v[36:39], v[156:159], a[64:67], v[36:39]
    v_mfma_f32_16x16x32_bf16 v[56:59], v[156:159], a[68:71], v[56:59]
    ds_read_b128 v[152:155], v13 offset:59392
    buffer_load_dwordx4 a[12:15], v8, s[28:31], s51 offen offset:1024 sc1
    v_mfma_f32_16x16x32_bf16 v[40:43], v[160:163], a[64:67], v[40:43]
    v_mfma_f32_16x16x32_bf16 v[60:63], v[160:163], a[68:71], v[60:63]
    ds_read_b128 v[156:159], v13 offset:60416
    buffer_load_dwordx4 a[16:19], v8, s[28:31], s50 offen offset:2048 sc1
    v_mfma_f32_16x16x32_bf16 v[44:47], v[164:167], a[64:67], v[44:47]
    v_mfma_f32_16x16x32_bf16 v[64:67], v[164:167], a[68:71], v[64:67]
    ds_read_b128 v[160:163], v13 offset:61440
    v_mfma_f32_16x16x32_bf16 v[48:51], v[168:171], a[64:67], v[48:51]
    v_mfma_f32_16x16x32_bf16 v[68:71], v[168:171], a[68:71], v[68:71]
    ds_read_b128 v[164:167], v14 offset:2048
    buffer_load_dwordx4 a[20:23], v8, s[28:31], s51 offen offset:2048 sc1
    s_waitcnt vmcnt(10) lgkmcnt(6)
    v_mfma_f32_16x16x32_bf16 v[32:35], v[172:175], a[72:75], v[32:35]
    v_mfma_f32_16x16x32_bf16 v[52:55], v[172:175], a[76:79], v[52:55]
    ds_read_b128 v[168:171], v14 offset:3072
    s_add_u32 s26, s44, 13406208
    buffer_load_dwordx2 v[96:97], v230, s[28:31], s26 offen sc1
    v_mfma_f32_16x16x32_bf16 v[36:39], v[176:179], a[72:75], v[36:39]
    v_mfma_f32_16x16x32_bf16 v[56:59], v[176:179], a[76:79], v[56:59]
    ds_read_b128 v[172:175], v14 offset:4096
    s_add_u32 s26, s44, 13406720
    buffer_load_dwordx2 v[98:99], v230, s[28:31], s26 offen sc1
    v_mfma_f32_16x16x32_bf16 v[40:43], v[180:183], a[72:75], v[40:43]
    v_mfma_f32_16x16x32_bf16 v[60:63], v[180:183], a[76:79], v[60:63]
    ds_read_b128 v[176:179], v14 offset:5120
    v_mfma_f32_16x16x32_bf16 v[44:47], v[136:139], a[72:75], v[44:47]
    v_mfma_f32_16x16x32_bf16 v[64:67], v[136:139], a[76:79], v[64:67]
    ds_read_b128 v[180:183], v14 offset:6144
    s_add_u32 s26, s44, 13407232
    buffer_load_dwordx2 v[100:101], v230, s[28:31], s26 offen sc1
    v_mfma_f32_16x16x32_bf16 v[48:51], v[140:143], a[72:75], v[48:51]
    v_mfma_f32_16x16x32_bf16 v[68:71], v[140:143], a[76:79], v[68:71]
    ds_read_b128 v[136:139], v13 offset:16384
    s_waitcnt vmcnt(11) lgkmcnt(6)
    v_mfma_f32_16x16x32_bf16 v[32:35], v[144:147], a[80:83], v[32:35]
    v_mfma_f32_16x16x32_bf16 v[52:55], v[144:147], a[84:87], v[52:55]
    ds_read_b128 v[140:143], v13 offset:17408
    s_add_u32 s26, s44, 13407744
    buffer_load_dwordx2 v[102:103], v230, s[28:31], s26 offen sc1
    v_mfma_f32_16x16x32_bf16 v[36:39], v[148:151], a[80:83], v[36:39]
    v_mfma_f32_16x16x32_bf16 v[56:59], v[148:151], a[84:87], v[56:59]
    ds_read_b128 v[144:147], v13 offset:18432
    v_mfma_f32_16x16x32_bf16 v[40:43], v[152:155], a[80:83], v[40:43]
    v_mfma_f32_16x16x32_bf16 v[60:63], v[152:155], a[84:87], v[60:63]
    ds_read_b128 v[148:151], v13 offset:19456
    s_add_u32 s26, s45, 13406208
    buffer_load_dwordx2 v[104:105], v230, s[28:31], s26 offen sc1
    v_mfma_f32_16x16x32_bf16 v[44:47], v[156:159], a[80:83], v[44:47]
    v_mfma_f32_16x16x32_bf16 v[64:67], v[156:159], a[84:87], v[64:67]
    ds_read_b128 v[152:155], v13 offset:20480
    v_mfma_f32_16x16x32_bf16 v[48:51], v[160:163], a[80:83], v[48:51]
    v_mfma_f32_16x16x32_bf16 v[68:71], v[160:163], a[84:87], v[68:71]
    ds_read_b128 v[156:159], v13 offset:26624
    buffer_load_dwordx4 a[24:27], v8, s[28:31], s50 offen offset:3072 sc1
    s_waitcnt vmcnt(12) lgkmcnt(6)
    v_mfma_f32_16x16x32_bf16 v[32:35], v[164:167], a[88:91], v[32:35]
    v_mfma_f32_16x16x32_bf16 v[52:55], v[164:167], a[92:95], v[52:55]
    ds_read_b128 v[160:163], v13 offset:27648
    v_mfma_f32_16x16x32_bf16 v[36:39], v[168:171], a[88:91], v[36:39]
    v_mfma_f32_16x16x32_bf16 v[56:59], v[168:171], a[92:95], v[56:59]
    ds_read_b128 v[164:167], v13 offset:28672
    buffer_load_dwordx4 a[28:31], v8, s[28:31], s51 offen offset:3072 sc1
    v_mfma_f32_16x16x32_bf16 v[40:43], v[172:175], a[88:91], v[40:43]
    v_mfma_f32_16x16x32_bf16 v[60:63], v[172:175], a[92:95], v[60:63]
    ds_read_b128 v[168:171], v13 offset:29696
    v_mfma_f32_16x16x32_bf16 v[44:47], v[176:179], a[88:91], v[44:47]
    v_mfma_f32_16x16x32_bf16 v[64:67], v[176:179], a[92:95], v[64:67]
    ds_read_b128 v[172:175], v13 offset:30720
    s_add_u32 s50, s50, 4096
    s_add_u32 s51, s51, 4096
    buffer_load_dwordx4 a[32:35], v8, s[28:31], s50 offen offset:0 sc1
    v_mfma_f32_16x16x32_bf16 v[48:51], v[180:183], a[88:91], v[48:51]
    v_mfma_f32_16x16x32_bf16 v[68:71], v[180:183], a[92:95], v[68:71]
    ds_read_b128 v[176:179], v13 offset:36864
    s_waitcnt vmcnt(12) lgkmcnt(6)
    v_mfma_f32_16x16x32_bf16 v[32:35], v[136:139], a[0:3], v[32:35]
    v_mfma_f32_16x16x32_bf16 v[52:55], v[136:139], a[4:7], v[52:55]
    ds_read_b128 v[180:183], v13 offset:37888
    buffer_load_dwordx4 a[36:39], v8, s[28:31], s51 offen offset:0 sc1
    v_mfma_f32_16x16x32_bf16 v[36:39], v[140:143], a[0:3], v[36:39]
    v_mfma_f32_16x16x32_bf16 v[56:59], v[140:143], a[4:7], v[56:59]
    ds_read_b128 v[136:139], v13 offset:38912
    v_mfma_f32_16x16x32_bf16 v[40:43], v[144:147], a[0:3], v[40:43]
    v_mfma_f32_16x16x32_bf16 v[60:63], v[144:147], a[4:7], v[60:63]
    ds_read_b128 v[140:143], v13 offset:39936
    buffer_load_dwordx4 a[40:43], v8, s[28:31], s50 offen offset:1024 sc1
    v_mfma_f32_16x16x32_bf16 v[44:47], v[148:151], a[0:3], v[44:47]
    v_mfma_f32_16x16x32_bf16 v[64:67], v[148:151], a[4:7], v[64:67]
    ds_read_b128 v[144:147], v13 offset:40960
    v_mfma_f32_16x16x32_bf16 v[48:51], v[152:155], a[0:3], v[48:51]
    v_mfma_f32_16x16x32_bf16 v[68:71], v[152:155], a[4:7], v[68:71]
    ds_read_b128 v[148:151], v13 offset:47104
    buffer_load_dwordx4 a[44:47], v8, s[28:31], s51 offen offset:1024 sc1
    s_waitcnt vmcnt(13) lgkmcnt(6)
    v_mfma_f32_16x16x32_bf16 v[32:35], v[156:159], a[8:11], v[32:35]
    v_mfma_f32_16x16x32_bf16 v[52:55], v[156:159], a[12:15], v[52:55]
    ds_read_b128 v[152:155], v13 offset:48128
    v_mfma_f32_16x16x32_bf16 v[36:39], v[160:163], a[8:11], v[36:39]
    v_mfma_f32_16x16x32_bf16 v[56:59], v[160:163], a[12:15], v[56:59]
    ds_read_b128 v[156:159], v13 offset:49152
    buffer_load_dwordx4 a[48:51], v8, s[28:31], s50 offen offset:2048 sc1
    v_mfma_f32_16x16x32_bf16 v[40:43], v[164:167], a[8:11], v[40:43]
    v_mfma_f32_16x16x32_bf16 v[60:63], v[164:167], a[12:15], v[60:63]
    ds_read_b128 v[160:163], v13 offset:50176
    v_mfma_f32_16x16x32_bf16 v[44:47], v[168:171], a[8:11], v[44:47]
    v_mfma_f32_16x16x32_bf16 v[64:67], v[168:171], a[12:15], v[64:67]
    ds_read_b128 v[164:167], v13 offset:51200
    buffer_load_dwordx4 a[52:55], v8, s[28:31], s51 offen offset:2048 sc1
    v_mfma_f32_16x16x32_bf16 v[48:51], v[172:175], a[8:11], v[48:51]
    v_mfma_f32_16x16x32_bf16 v[68:71], v[172:175], a[12:15], v[68:71]
    s_barrier
    ds_read_b128 v[168:171], v14 offset:12288
    s_waitcnt vmcnt(13) lgkmcnt(6)
    v_mfma_f32_16x16x32_bf16 v[32:35], v[176:179], a[16:19], v[32:35]
    v_mfma_f32_16x16x32_bf16 v[52:55], v[176:179], a[20:23], v[52:55]
    ds_read_b128 v[172:175], v14 offset:13312
    buffer_load_dwordx4 a[56:59], v8, s[28:31], s50 offen offset:3072 sc1
    v_mfma_f32_16x16x32_bf16 v[36:39], v[180:183], a[16:19], v[36:39]
    v_mfma_f32_16x16x32_bf16 v[56:59], v[180:183], a[20:23], v[56:59]
    ds_read_b128 v[176:179], v14 offset:14336
    v_mfma_f32_16x16x32_bf16 v[40:43], v[136:139], a[16:19], v[40:43]
    v_mfma_f32_16x16x32_bf16 v[60:63], v[136:139], a[20:23], v[60:63]
    ds_read_b128 v[180:183], v14 offset:15360
    buffer_load_dwordx4 a[60:63], v8, s[28:31], s51 offen offset:3072 sc1
    v_mfma_f32_16x16x32_bf16 v[44:47], v[140:143], a[16:19], v[44:47]
    v_mfma_f32_16x16x32_bf16 v[64:67], v[140:143], a[20:23], v[64:67]
    ds_read_b128 v[136:139], v14 offset:16384
    v_mfma_f32_16x16x32_bf16 v[48:51], v[144:147], a[16:19], v[48:51]
    v_mfma_f32_16x16x32_bf16 v[68:71], v[144:147], a[20:23], v[68:71]
    ds_read_b128 v[140:143], v12 offset:0
    s_add_u32 s50, s50, 4096
    s_add_u32 s51, s51, 4096
    buffer_load_dwordx4 a[64:67], v8, s[28:31], s50 offen offset:0 sc1
    s_waitcnt vmcnt(9) lgkmcnt(6)
    v_mfma_f32_16x16x32_bf16 v[32:35], v[148:151], a[24:27], v[32:35]
    v_mfma_f32_16x16x32_bf16 v[52:55], v[148:151], a[28:31], v[52:55]
    ds_read_b128 v[144:147], v12 offset:1024
    v_mfma_f32_16x16x32_bf16 v[36:39], v[152:155], a[24:27], v[36:39]
    v_mfma_f32_16x16x32_bf16 v[56:59], v[152:155], a[28:31], v[56:59]
    ds_read_b128 v[148:151], v12 offset:2048
    buffer_load_dwordx4 a[68:71], v8, s[28:31], s51 offen offset:0 sc1
    v_mfma_f32_16x16x32_bf16 v[40:43], v[156:159], a[24:27], v[40:43]
    v_mfma_f32_16x16x32_bf16 v[60:63], v[156:159], a[28:31], v[60:63]
    ds_read_b128 v[152:155], v12 offset:3072
    v_mfma_f32_16x16x32_bf16 v[44:47], v[160:163], a[24:27], v[44:47]
    v_mfma_f32_16x16x32_bf16 v[64:67], v[160:163], a[28:31], v[64:67]
    ds_read_b128 v[156:159], v12 offset:4096
    buffer_load_dwordx4 a[72:75], v8, s[28:31], s50 offen offset:1024 sc1
    v_mfma_f32_16x16x32_bf16 v[48:51], v[164:167], a[24:27], v[48:51]
    v_mfma_f32_16x16x32_bf16 v[68:71], v[164:167], a[28:31], v[68:71]
    ds_read_b128 v[160:163], v12 offset:10240
    s_waitcnt vmcnt(9) lgkmcnt(6)
    v_mfma_f32_16x16x32_bf16 v[32:35], v[168:171], a[32:35], v[32:35]
    v_mfma_f32_16x16x32_bf16 v[52:55], v[168:171], a[36:39], v[52:55]
    ds_read_b128 v[164:167], v12 offset:11264
    buffer_load_dwordx4 a[76:79], v8, s[28:31], s51 offen offset:1024 sc1
    v_mfma_f32_16x16x32_bf16 v[36:39], v[172:175], a[32:35], v[36:39]
    v_mfma_f32_16x16x32_bf16 v[56:59], v[172:175], a[36:39], v[56:59]
    ds_read_b128 v[168:171], v12 offset:12288
    v_mfma_f32_16x16x32_bf16 v[40:43], v[176:179], a[32:35], v[40:43]
    v_mfma_f32_16x16x32_bf16 v[60:63], v[176:179], a[36:39], v[60:63]
    ds_read_b128 v[172:175], v12 offset:13312
    buffer_load_dwordx4 a[80:83], v8, s[28:31], s50 offen offset:2048 sc1
    v_mfma_f32_16x16x32_bf16 v[44:47], v[180:183], a[32:35], v[44:47]
    v_mfma_f32_16x16x32_bf16 v[64:67], v[180:183], a[36:39], v[64:67]
    ds_read_b128 v[176:179], v12 offset:14336
    v_mfma_f32_16x16x32_bf16 v[48:51], v[136:139], a[32:35], v[48:51]
    v_mfma_f32_16x16x32_bf16 v[68:71], v[136:139], a[36:39], v[68:71]
    buffer_load_dwordx4 a[84:87], v8, s[28:31], s51 offen offset:2048 sc1
    s_waitcnt vmcnt(10) lgkmcnt(5)
    v_mfma_f32_16x16x32_bf16 v[32:35], v[140:143], a[40:43], v[32:35]
    v_mfma_f32_16x16x32_bf16 v[52:55], v[140:143], a[44:47], v[52:55]
    v_mfma_f32_16x16x32_bf16 v[36:39], v[144:147], a[40:43], v[36:39]
    v_mfma_f32_16x16x32_bf16 v[56:59], v[144:147], a[44:47], v[56:59]
    buffer_load_dwordx4 a[88:91], v8, s[28:31], s50 offen offset:3072 sc1
    v_mfma_f32_16x16x32_bf16 v[40:43], v[148:151], a[40:43], v[40:43]
    v_mfma_f32_16x16x32_bf16 v[60:63], v[148:151], a[44:47], v[60:63]
    v_mfma_f32_16x16x32_bf16 v[44:47], v[152:155], a[40:43], v[44:47]
    v_mfma_f32_16x16x32_bf16 v[64:67], v[152:155], a[44:47], v[64:67]
    buffer_load_dwordx4 a[92:95], v8, s[28:31], s51 offen offset:3072 sc1
    v_mfma_f32_16x16x32_bf16 v[48:51], v[156:159], a[40:43], v[48:51]
    v_mfma_f32_16x16x32_bf16 v[68:71], v[156:159], a[44:47], v[68:71]
    s_waitcnt vmcnt(10) lgkmcnt(0)
    v_mfma_f32_16x16x32_bf16 v[32:35], v[160:163], a[48:51], v[32:35]
    v_mfma_f32_16x16x32_bf16 v[52:55], v[160:163], a[52:55], v[52:55]
    s_add_u32 s50, s50, 4096
    s_add_u32 s51, s51, 4096
    buffer_load_dwordx4 a[0:3], v8, s[28:31], s50 offen offset:0 sc1
    v_mfma_f32_16x16x32_bf16 v[36:39], v[164:167], a[48:51], v[36:39]
    v_mfma_f32_16x16x32_bf16 v[56:59], v[164:167], a[52:55], v[56:59]
    v_mfma_f32_16x16x32_bf16 v[40:43], v[168:171], a[48:51], v[40:43]
    v_mfma_f32_16x16x32_bf16 v[60:63], v[168:171], a[52:55], v[60:63]
    buffer_load_dwordx4 a[4:7], v8, s[28:31], s51 offen offset:0 sc1
    v_mfma_f32_16x16x32_bf16 v[44:47], v[172:175], a[48:51], v[44:47]
    v_mfma_f32_16x16x32_bf16 v[64:67], v[172:175], a[52:55], v[64:67]
    v_mfma_f32_16x16x32_bf16 v[48:51], v[176:179], a[48:51], v[48:51]
    v_mfma_f32_16x16x32_bf16 v[68:71], v[176:179], a[52:55], v[68:71]
    s_waitcnt vmcnt(10)
    v_mfma_f32_16x16x32_bf16 v[32:35], a[96:99], a[56:59], v[32:35]
    v_mfma_f32_16x16x32_bf16 v[52:55], a[96:99], a[60:63], v[52:55]
    v_mfma_f32_16x16x32_bf16 v[36:39], a[100:103], a[56:59], v[36:39]
    v_mfma_f32_16x16x32_bf16 v[56:59], a[100:103], a[60:63], v[56:59]
    buffer_load_dwordx4 a[8:11], v8, s[28:31], s50 offen offset:1024 sc1
    v_mfma_f32_16x16x32_bf16 v[40:43], a[104:107], a[56:59], v[40:43]
    v_mfma_f32_16x16x32_bf16 v[60:63], a[104:107], a[60:63], v[60:63]
    v_mfma_f32_16x16x32_bf16 v[44:47], a[108:111], a[56:59], v[44:47]
    v_mfma_f32_16x16x32_bf16 v[64:67], a[108:111], a[60:63], v[64:67]
    buffer_load_dwordx4 a[12:15], v8, s[28:31], s51 offen offset:1024 sc1
    v_mfma_f32_16x16x32_bf16 v[48:51], a[112:115], a[56:59], v[48:51]
    v_mfma_f32_16x16x32_bf16 v[68:71], a[112:115], a[60:63], v[68:71]
    s_waitcnt vmcnt(10)
    v_mfma_f32_16x16x32_bf16 v[32:35], a[116:119], a[64:67], v[32:35]
    v_mfma_f32_16x16x32_bf16 v[52:55], a[116:119], a[68:71], v[52:55]
    buffer_load_dwordx4 a[16:19], v8, s[28:31], s50 offen offset:2048 sc1
    v_mfma_f32_16x16x32_bf16 v[36:39], a[120:123], a[64:67], v[36:39]
    v_mfma_f32_16x16x32_bf16 v[56:59], a[120:123], a[68:71], v[56:59]
    v_mfma_f32_16x16x32_bf16 v[40:43], a[124:127], a[64:67], v[40:43]
    v_mfma_f32_16x16x32_bf16 v[60:63], a[124:127], a[68:71], v[60:63]
    buffer_load_dwordx4 a[20:23], v8, s[28:31], s51 offen offset:2048 sc1
    v_mfma_f32_16x16x32_bf16 v[44:47], a[128:131], a[64:67], v[44:47]
    v_mfma_f32_16x16x32_bf16 v[64:67], a[128:131], a[68:71], v[64:67]
    v_mfma_f32_16x16x32_bf16 v[48:51], a[132:135], a[64:67], v[48:51]
    v_mfma_f32_16x16x32_bf16 v[68:71], a[132:135], a[68:71], v[68:71]
    s_waitcnt vmcnt(10)
    v_mfma_f32_16x16x32_bf16 v[32:35], a[136:139], a[72:75], v[32:35]
    v_mfma_f32_16x16x32_bf16 v[52:55], a[136:139], a[76:79], v[52:55]
    v_mfma_f32_16x16x32_bf16 v[36:39], a[140:143], a[72:75], v[36:39]
    v_mfma_f32_16x16x32_bf16 v[56:59], a[140:143], a[76:79], v[56:59]
    v_mfma_f32_16x16x32_bf16 v[40:43], a[144:147], a[72:75], v[40:43]
    v_mfma_f32_16x16x32_bf16 v[60:63], a[144:147], a[76:79], v[60:63]
    v_mfma_f32_16x16x32_bf16 v[44:47], a[148:151], a[72:75], v[44:47]
    v_mfma_f32_16x16x32_bf16 v[64:67], a[148:151], a[76:79], v[64:67]
    v_mfma_f32_16x16x32_bf16 v[48:51], a[152:155], a[72:75], v[48:51]
    v_mfma_f32_16x16x32_bf16 v[68:71], a[152:155], a[76:79], v[68:71]
    s_waitcnt vmcnt(8)
    v_mfma_f32_16x16x32_bf16 v[32:35], a[156:159], a[80:83], v[32:35]
    v_mfma_f32_16x16x32_bf16 v[52:55], a[156:159], a[84:87], v[52:55]
    v_mfma_f32_16x16x32_bf16 v[36:39], a[160:163], a[80:83], v[36:39]
    v_mfma_f32_16x16x32_bf16 v[56:59], a[160:163], a[84:87], v[56:59]
    v_mfma_f32_16x16x32_bf16 v[40:43], a[164:167], a[80:83], v[40:43]
    v_mfma_f32_16x16x32_bf16 v[60:63], a[164:167], a[84:87], v[60:63]
    v_mfma_f32_16x16x32_bf16 v[44:47], a[168:171], a[80:83], v[44:47]
    v_mfma_f32_16x16x32_bf16 v[64:67], a[168:171], a[84:87], v[64:67]
    v_mfma_f32_16x16x32_bf16 v[48:51], a[172:175], a[80:83], v[48:51]
    v_mfma_f32_16x16x32_bf16 v[68:71], a[172:175], a[84:87], v[68:71]
    s_waitcnt vmcnt(6)
    v_mfma_f32_16x16x32_bf16 v[32:35], a[176:179], a[88:91], v[32:35]
    v_mfma_f32_16x16x32_bf16 v[52:55], a[176:179], a[92:95], v[52:55]
    v_mfma_f32_16x16x32_bf16 v[36:39], a[180:183], a[88:91], v[36:39]
    v_mfma_f32_16x16x32_bf16 v[56:59], a[180:183], a[92:95], v[56:59]
    v_mfma_f32_16x16x32_bf16 v[40:43], a[184:187], a[88:91], v[40:43]
    v_mfma_f32_16x16x32_bf16 v[60:63], a[184:187], a[92:95], v[60:63]
    v_mfma_f32_16x16x32_bf16 v[44:47], a[188:191], a[88:91], v[44:47]
    v_mfma_f32_16x16x32_bf16 v[64:67], a[188:191], a[92:95], v[64:67]
    v_mfma_f32_16x16x32_bf16 v[48:51], a[192:195], a[88:91], v[48:51]
    v_mfma_f32_16x16x32_bf16 v[68:71], a[192:195], a[92:95], v[68:71]
    s_waitcnt vmcnt(4)
    v_mfma_f32_16x16x32_bf16 v[32:35], a[196:199], a[0:3], v[32:35]
    v_mfma_f32_16x16x32_bf16 v[52:55], a[196:199], a[4:7], v[52:55]
    v_mfma_f32_16x16x32_bf16 v[36:39], a[200:203], a[0:3], v[36:39]
    v_mfma_f32_16x16x32_bf16 v[56:59], a[200:203], a[4:7], v[56:59]
    v_mfma_f32_16x16x32_bf16 v[40:43], a[204:207], a[0:3], v[40:43]
    v_mfma_f32_16x16x32_bf16 v[60:63], a[204:207], a[4:7], v[60:63]
    v_mfma_f32_16x16x32_bf16 v[44:47], a[208:211], a[0:3], v[44:47]
    v_mfma_f32_16x16x32_bf16 v[64:67], a[208:211], a[4:7], v[64:67]
    v_mfma_f32_16x16x32_bf16 v[48:51], a[212:215], a[0:3], v[48:51]
    v_mfma_f32_16x16x32_bf16 v[68:71], a[212:215], a[4:7], v[68:71]
    s_waitcnt vmcnt(2)
    v_mfma_f32_16x16x32_bf16 v[32:35], a[216:219], a[8:11], v[32:35]
    v_mfma_f32_16x16x32_bf16 v[52:55], a[216:219], a[12:15], v[52:55]
    v_mfma_f32_16x16x32_bf16 v[36:39], a[220:223], a[8:11], v[36:39]
    v_mfma_f32_16x16x32_bf16 v[56:59], a[220:223], a[12:15], v[56:59]
    v_mfma_f32_16x16x32_bf16 v[40:43], a[224:227], a[8:11], v[40:43]
    v_mfma_f32_16x16x32_bf16 v[60:63], a[224:227], a[12:15], v[60:63]
    v_mfma_f32_16x16x32_bf16 v[44:47], a[228:231], a[8:11], v[44:47]
    v_mfma_f32_16x16x32_bf16 v[64:67], a[228:231], a[12:15], v[64:67]
    v_mfma_f32_16x16x32_bf16 v[48:51], a[232:235], a[8:11], v[48:51]
    v_mfma_f32_16x16x32_bf16 v[68:71], a[232:235], a[12:15], v[68:71]
    s_waitcnt vmcnt(0)
    v_mfma_f32_16x16x32_bf16 v[32:35], a[236:239], a[16:19], v[32:35]
    v_mfma_f32_16x16x32_bf16 v[52:55], a[236:239], a[20:23], v[52:55]
    v_mfma_f32_16x16x32_bf16 v[36:39], a[240:243], a[16:19], v[36:39]
    v_mfma_f32_16x16x32_bf16 v[56:59], a[240:243], a[20:23], v[56:59]
    v_mfma_f32_16x16x32_bf16 v[40:43], a[244:247], a[16:19], v[40:43]
    v_mfma_f32_16x16x32_bf16 v[60:63], a[244:247], a[20:23], v[60:63]
    v_mfma_f32_16x16x32_bf16 v[44:47], a[248:251], a[16:19], v[44:47]
    v_mfma_f32_16x16x32_bf16 v[64:67], a[248:251], a[20:23], v[64:67]
    v_mfma_f32_16x16x32_bf16 v[48:51], a[252:255], a[16:19], v[48:51]
    v_mfma_f32_16x16x32_bf16 v[68:71], a[252:255], a[20:23], v[68:71]
    s_barrier
    s_nop 4
    ds_write_b128 v246, v[52:55] offset:0
    ds_write_b128 v246, v[56:59] offset:1024
    ds_write_b128 v246, v[60:63] offset:2048
    ds_write_b128 v246, v[64:67] offset:3072
    ds_write_b128 v246, v[68:71] offset:4096
    v_lshlrev_b32 v136, 16, v96
    v_and_b32 v137, 0xffff0000, v96
    v_lshlrev_b32 v138, 16, v97
    v_and_b32 v139, 0xffff0000, v97
    v_lshlrev_b32 v156, 16, v116
    v_and_b32 v157, 0xffff0000, v116
    v_lshlrev_b32 v158, 16, v117
    v_and_b32 v159, 0xffff0000, v117
    v_lshlrev_b32 v140, 16, v98
    v_and_b32 v141, 0xffff0000, v98
    v_lshlrev_b32 v142, 16, v99
    v_and_b32 v143, 0xffff0000, v99
    v_lshlrev_b32 v160, 16, v118
    v_and_b32 v161, 0xffff0000, v118
    v_lshlrev_b32 v162, 16, v119
    v_and_b32 v163, 0xffff0000, v119
    v_lshlrev_b32 v144, 16, v100
    v_and_b32 v145, 0xffff0000, v100
    v_lshlrev_b32 v146, 16, v101
    v_and_b32 v147, 0xffff0000, v101
    v_lshlrev_b32 v164, 16, v120
    v_and_b32 v165, 0xffff0000, v120
    v_lshlrev_b32 v166, 16, v121
    v_and_b32 v167, 0xffff0000, v121
    v_lshlrev_b32 v148, 16, v102
    v_and_b32 v149, 0xffff0000, v102
    v_lshlrev_b32 v150, 16, v103
    v_and_b32 v151, 0xffff0000, v103
    v_lshlrev_b32 v168, 16, v122
    v_and_b32 v169, 0xffff0000, v122
    v_lshlrev_b32 v170, 16, v123
    v_and_b32 v171, 0xffff0000, v123
    v_lshlrev_b32 v152, 16, v104
    v_and_b32 v153, 0xffff0000, v104
    v_lshlrev_b32 v154, 16, v105
    v_and_b32 v155, 0xffff0000, v105
    v_lshlrev_b32 v172, 16, v124
    v_and_b32 v173, 0xffff0000, v124
    v_lshlrev_b32 v174, 16, v125
    v_and_b32 v175, 0xffff0000, v125
    v_pk_add_f32 v[32:33], v[32:33], v[136:137]
    v_pk_add_f32 v[34:35], v[34:35], v[138:139]
    v_pk_add_f32 v[36:37], v[36:37], v[140:141]
    v_pk_add_f32 v[38:39], v[38:39], v[142:143]
    v_pk_add_f32 v[40:41], v[40:41], v[144:145]
    v_pk_add_f32 v[42:43], v[42:43], v[146:147]
    v_pk_add_f32 v[44:45], v[44:45], v[148:149]
    v_pk_add_f32 v[46:47], v[46:47], v[150:151]
    v_pk_add_f32 v[48:49], v[48:49], v[152:153]
    v_pk_add_f32 v[50:51], v[50:51], v[154:155]
    s_waitcnt lgkmcnt(0)
    s_barrier
    ds_read_b128 v[72:75], v247 offset:0
    ds_read_b128 v[76:79], v247 offset:1024
    ds_read_b128 v[80:83], v247 offset:2048
    ds_read_b128 v[84:87], v247 offset:3072
    ds_read_b128 v[88:91], v247 offset:4096
    s_waitcnt lgkmcnt(4)
    v_pk_add_f32 v[32:33], v[32:33], v[72:73]
    v_pk_add_f32 v[34:35], v[34:35], v[74:75]
    v_pk_fma_f32 v[32:33], v[32:33], v[204:205], v[156:157]
    v_pk_fma_f32 v[34:35], v[34:35], v[206:207], v[158:159]
    v_cvt_pk_bf16_f32 v180, v32, v33
    v_cvt_pk_bf16_f32 v181, v34, v35
    s_waitcnt lgkmcnt(3)
    v_pk_add_f32 v[36:37], v[36:37], v[76:77]
    v_pk_add_f32 v[38:39], v[38:39], v[78:79]
    v_pk_fma_f32 v[36:37], v[36:37], v[208:209], v[160:161]
    v_pk_fma_f32 v[38:39], v[38:39], v[210:211], v[162:163]
    v_cvt_pk_bf16_f32 v182, v36, v37
    v_cvt_pk_bf16_f32 v183, v38, v39
    s_waitcnt lgkmcnt(2)
    v_pk_add_f32 v[40:41], v[40:41], v[80:81]
    v_pk_add_f32 v[42:43], v[42:43], v[82:83]
    v_pk_fma_f32 v[40:41], v[40:41], v[212:213], v[164:165]
    v_pk_fma_f32 v[42:43], v[42:43], v[214:215], v[166:167]
    v_cvt_pk_bf16_f32 v184, v40, v41
    v_cvt_pk_bf16_f32 v185, v42, v43
    s_waitcnt lgkmcnt(1)
    v_pk_add_f32 v[44:45], v[44:45], v[84:85]
    v_pk_add_f32 v[46:47], v[46:47], v[86:87]
    v_pk_fma_f32 v[44:45], v[44:45], v[216:217], v[168:169]
    v_pk_fma_f32 v[46:47], v[46:47], v[218:219], v[170:171]
    v_cvt_pk_bf16_f32 v186, v44, v45
    v_cvt_pk_bf16_f32 v187, v46, v47
    s_waitcnt lgkmcnt(0)
    v_pk_add_f32 v[48:49], v[48:49], v[88:89]
    v_pk_add_f32 v[50:51], v[50:51], v[90:91]
    v_pk_fma_f32 v[48:49], v[48:49], v[220:221], v[172:173]
    v_pk_fma_f32 v[50:51], v[50:51], v[222:223], v[174:175]
    v_cvt_pk_bf16_f32 v188, v48, v49
    v_cvt_pk_bf16_f32 v189, v50, v51
    s_nop 1
    v_permlane16_swap_b32 v180, v182
    v_permlane16_swap_b32 v181, v183
    v_permlane16_swap_b32 v184, v186
    v_permlane16_swap_b32 v185, v187
    buffer_store_dwordx4 v[180:183], v231, s[32:35], s46 offen sc1
    buffer_store_dwordx4 v[184:187], v231, s[32:35], s46 offen offset:64 sc1
    buffer_store_dwordx2 v[188:189], v232, s[32:35], s49 offen sc1
    s_endpgm
chain_end:
    s_endpgm
.section .rodata,"a"
.p2align 6
.amdhsa_kernel prep_kernel
  .amdhsa_next_free_vgpr 256
  .amdhsa_next_free_sgpr 100
  .amdhsa_accum_offset 256
  .amdhsa_group_segment_fixed_size 0
  .amdhsa_kernarg_size 128
  .amdhsa_user_sgpr_count 2
  .amdhsa_user_sgpr_kernarg_segment_ptr 1
  .amdhsa_system_sgpr_workgroup_id_x 1
  .amdhsa_float_denorm_mode_32 3
.end_amdhsa_kernel
.p2align 6
.amdhsa_kernel chain_kernel
  .amdhsa_next_free_vgpr 512
  .amdhsa_next_free_sgpr 100
  .amdhsa_accum_offset 256
  .amdhsa_group_segment_fixed_size 0
  .amdhsa_kernarg_size 128
  .amdhsa_user_sgpr_count 2
  .amdhsa_user_sgpr_kernarg_segment_ptr 1
  .amdhsa_system_sgpr_workgroup_id_x 1
  .amdhsa_float_denorm_mode_32 3
.end_amdhsa_kernel
```

```asm
; @launch kernel=prep_kernel grid=(512,1,1) block=(512,1,1) lds=104512
; @launch kernel=chain_kernel grid=(256,1,1) block=(256,1,1) lds=163840
.amdgcn_target "amdgcn-amd-amdhsa--gfx950"
.text
.globl prep_kernel
.p2align 8
.type prep_kernel,@function
prep_kernel:
    s_cmp_ge_u32 s2, 512
    s_cbranch_scc1 prep_end
    s_load_dwordx4 s[4:7], s[0:1], 8
    s_load_dwordx2 s[8:9], s[0:1], 24
    s_load_dwordx2 s[10:11], s[0:1], 120
    s_load_dwordx8 s[12:19], s[0:1], 56
    s_load_dwordx2 s[60:61], s[0:1], 0
    s_load_dwordx2 s[62:63], s[0:1], 96
    s_load_dwordx2 s[52:53], s[0:1], 88
    s_load_dwordx2 s[54:55], s[0:1], 112
    s_load_dwordx4 s[56:59], s[0:1], 32
    s_memrealtime s[64:65]
    v_lshrrev_b32 v2, 6, v0
    v_and_b32 v1, 63, v0
    v_readfirstlane_b32 s20, v2
    s_waitcnt lgkmcnt(0)
    s_mov_b32 s28, s10
    s_mov_b32 s29, s11
    s_mov_b32 s30, 268435456
    s_mov_b32 s31, 0x00020000
    s_mov_b32 s48, s54
    s_mov_b32 s49, s55
    s_mov_b32 s50, 256
    s_mov_b32 s51, 0x00020000
    s_cmp_ge_u32 s2, 416
    s_cbranch_scc1 p_pack
    s_cmp_ge_u32 s2, 256
    s_cbranch_scc1 p_conv
    s_cmp_ge_u32 s2, 160
    s_cbranch_scc1 p_aux
    s_or_b32 s21, s2, s20
    s_cmp_lg_u32 s21, 0
    s_cbranch_scc1 prep_kernel_n01
    s_or_b32 s64, s64, 1
    v_mov_b32 v3, s64
    v_mov_b32 v4, 0
    s_mov_b64 exec, 1
    buffer_store_dword v3, v4, s[48:51], 0 offen sc1
    s_mov_b64 exec, -1
prep_kernel_n01:
    s_mov_b32 s45, s20
    s_mov_b32 s16, s4
    s_mov_b32 s17, s5
    s_mov_b32 s18, 2621440
    s_mov_b32 s19, 0x00020000
    s_mov_b32 s20, s6
    s_mov_b32 s21, s7
    s_mov_b32 s22, 2621440
    s_mov_b32 s23, 0x00020000
    s_mov_b32 s24, s8
    s_mov_b32 s25, s9
    s_mov_b32 s26, 5120
    s_mov_b32 s27, 0x00020000
    s_lshr_b32 s47, s45, 2
    s_lshl_b32 s46, s2, 1
    s_add_u32 s46, s46, s47
    v_and_b32 v0, 255, v0
    s_mul_i32 s32, s46, 52429
    s_lshr_b32 s32, s32, 19
    s_mul_i32 s33, s32, 10
    s_sub_u32 s33, s46, s33
    s_lshl_b32 s43, s47, 13
    v_and_b32 v1, 15, v0
    v_lshrrev_b32 v2, 4, v0
    s_lshl_b32 s34, s32, 6
    v_lshl_add_u32 v3, v2, 2, s34
    v_mul_u32_u24 v4, 1280, v3
    s_lshl_b32 s35, s33, 7
    v_lshl_add_u32 v5, v1, 3, s35
    v_add_u32 v4, v4, v5
    v_subrev_u32 v6, 3840, v4
    v_subrev_u32 v7, 2560, v4
    v_subrev_u32 v8, 1280, v4
    buffer_load_dwordx2 v[10:11], v6, s[16:19], 0 offen nt
    buffer_load_dwordx2 v[12:13], v7, s[16:19], 0 offen nt
    buffer_load_dwordx2 v[14:15], v8, s[16:19], 0 offen nt
    buffer_load_dwordx2 v[16:17], v4, s[16:19], 0 offen offset:0 nt
    buffer_load_dwordx2 v[18:19], v4, s[16:19], 0 offen offset:1280 nt
    buffer_load_dwordx2 v[20:21], v4, s[16:19], 0 offen offset:2560 nt
    buffer_load_dwordx2 v[22:23], v4, s[16:19], 0 offen offset:3840 nt
    v_lshlrev_b32 v100, 2, v5
    buffer_load_dwordx4 v[32:35], v100, s[24:27], 0 offen
    buffer_load_dwordx4 v[36:39], v100, s[24:27], 0 offen offset:16
    buffer_load_dwordx2 v[24:25], v4, s[20:23], 0 offen offset:0 nt
    buffer_load_dwordx2 v[26:27], v4, s[20:23], 0 offen offset:1280 nt
    buffer_load_dwordx2 v[28:29], v4, s[20:23], 0 offen offset:2560 nt
    buffer_load_dwordx2 v[30:31], v4, s[20:23], 0 offen offset:3840 nt
    v_lshlrev_b32 v100, 9, v1
    v_sub_u32 v101, 15, v2
    v_lshl_add_u32 v100, v101, 3, v100
    v_add_u32 v100, s43, v100
    v_lshrrev_b32 v101, 3, v0
    v_mul_u32_u24 v101, 4352, v101
    v_and_b32 v102, 7, v0
    v_lshl_add_u32 v103, v102, 4, v101
    v_lshlrev_b32 v104, 4, v0
    v_add_u32 v104, s43, v104
    s_mul_i32 s36, s33, 278528
    s_lshr_b32 s37, s32, 1
    s_mul_i32 s37, s37, 272
    s_add_u32 s36, s36, s37
    s_add_u32 s36, s36, 0
    s_and_b32 s37, s32, 1
    s_lshl_b32 s38, s37, 7
    s_sub_u32 s38, 128, s38
    s_add_u32 s38, s38, s36
    s_lshl_b32 s44, s33, 5
    s_add_u32 s44, s44, s32
    s_lshl_b32 s44, s44, 7
    s_add_u32 s44, s44, 29642752
    s_waitcnt vmcnt(4)
    v_mov_b32 v123, 0
    buffer_load_dword v122, v123, s[48:51], 0 offen sc1
    v_lshlrev_b32 v40, 16, v32
    v_and_b32 v44, 0xffff0000, v32
    v_lshlrev_b32 v48, 16, v33
    v_and_b32 v52, 0xffff0000, v33
    v_lshlrev_b32 v41, 16, v34
    v_and_b32 v45, 0xffff0000, v34
    v_lshlrev_b32 v49, 16, v35
    v_and_b32 v53, 0xffff0000, v35
    v_lshlrev_b32 v42, 16, v36
    v_and_b32 v46, 0xffff0000, v36
    v_lshlrev_b32 v50, 16, v37
    v_and_b32 v54, 0xffff0000, v37
    v_lshlrev_b32 v43, 16, v38
    v_and_b32 v47, 0xffff0000, v38
    v_lshlrev_b32 v51, 16, v39
    v_and_b32 v55, 0xffff0000, v39
    v_lshlrev_b32 v56, 16, v10
    v_and_b32 v57, 0xffff0000, v10
    v_lshlrev_b32 v58, 16, v11
    v_and_b32 v59, 0xffff0000, v11
    v_lshlrev_b32 v60, 16, v12
    v_and_b32 v61, 0xffff0000, v12
    v_lshlrev_b32 v62, 16, v13
    v_and_b32 v63, 0xffff0000, v13
    v_lshlrev_b32 v64, 16, v14
    v_and_b32 v65, 0xffff0000, v14
    v_lshlrev_b32 v66, 16, v15
    v_and_b32 v67, 0xffff0000, v15
    v_lshlrev_b32 v68, 16, v16
    v_and_b32 v69, 0xffff0000, v16
    v_lshlrev_b32 v70, 16, v17
    v_and_b32 v71, 0xffff0000, v17
    v_lshlrev_b32 v72, 16, v18
    v_and_b32 v73, 0xffff0000, v18
    v_lshlrev_b32 v74, 16, v19
    v_and_b32 v75, 0xffff0000, v19
    v_lshlrev_b32 v76, 16, v20
    v_and_b32 v77, 0xffff0000, v20
    v_lshlrev_b32 v78, 16, v21
    v_and_b32 v79, 0xffff0000, v21
    v_lshlrev_b32 v80, 16, v22
    v_and_b32 v81, 0xffff0000, v22
    v_lshlrev_b32 v82, 16, v23
    v_and_b32 v83, 0xffff0000, v23
    v_pk_mul_f32 v[84:85], v[56:57], v[52:53]
    v_pk_mul_f32 v[86:87], v[58:59], v[54:55]
    v_pk_mul_f32 v[88:89], v[60:61], v[52:53]
    v_pk_mul_f32 v[90:91], v[62:63], v[54:55]
    v_pk_mul_f32 v[92:93], v[64:65], v[52:53]
    v_pk_mul_f32 v[94:95], v[66:67], v[54:55]
    v_pk_mul_f32 v[96:97], v[68:69], v[52:53]
    v_pk_mul_f32 v[98:99], v[70:71], v[54:55]
    v_pk_fma_f32 v[84:85], v[60:61], v[48:49], v[84:85]
    v_pk_fma_f32 v[86:87], v[62:63], v[50:51], v[86:87]
    v_pk_fma_f32 v[88:89], v[64:65], v[48:49], v[88:89]
    v_pk_fma_f32 v[90:91], v[66:67], v[50:51], v[90:91]
    v_pk_fma_f32 v[92:93], v[68:69], v[48:49], v[92:93]
    v_pk_fma_f32 v[94:95], v[70:71], v[50:51], v[94:95]
    v_pk_fma_f32 v[96:97], v[72:73], v[48:49], v[96:97]
    v_pk_fma_f32 v[98:99], v[74:75], v[50:51], v[98:99]
    v_pk_fma_f32 v[84:85], v[64:65], v[44:45], v[84:85]
    v_pk_fma_f32 v[86:87], v[66:67], v[46:47], v[86:87]
    v_pk_fma_f32 v[88:89], v[68:69], v[44:45], v[88:89]
    v_pk_fma_f32 v[90:91], v[70:71], v[46:47], v[90:91]
    v_pk_fma_f32 v[92:93], v[72:73], v[44:45], v[92:93]
    v_pk_fma_f32 v[94:95], v[74:75], v[46:47], v[94:95]
    v_pk_fma_f32 v[96:97], v[76:77], v[44:45], v[96:97]
    v_pk_fma_f32 v[98:99], v[78:79], v[46:47], v[98:99]
    v_pk_fma_f32 v[84:85], v[68:69], v[40:41], v[84:85]
    v_pk_fma_f32 v[86:87], v[70:71], v[42:43], v[86:87]
    v_pk_fma_f32 v[88:89], v[72:73], v[40:41], v[88:89]
    v_pk_fma_f32 v[90:91], v[74:75], v[42:43], v[90:91]
    v_pk_fma_f32 v[92:93], v[76:77], v[40:41], v[92:93]
    v_pk_fma_f32 v[94:95], v[78:79], v[42:43], v[94:95]
    v_pk_fma_f32 v[96:97], v[80:81], v[40:41], v[96:97]
    v_pk_fma_f32 v[98:99], v[82:83], v[42:43], v[98:99]
    v_cvt_pk_bf16_f32 v56, v84, v85
    v_cvt_pk_bf16_f32 v57, v86, v87
    v_cvt_pk_bf16_f32 v58, v88, v89
    v_cvt_pk_bf16_f32 v59, v90, v91
    v_cvt_pk_bf16_f32 v60, v92, v93
    v_cvt_pk_bf16_f32 v61, v94, v95
    v_cvt_pk_bf16_f32 v62, v96, v97
    v_cvt_pk_bf16_f32 v63, v98, v99
    s_waitcnt vmcnt(1)
    v_lshlrev_b32 v84, 16, v56
    v_and_b32 v85, 0xffff0000, v56
    v_lshlrev_b32 v86, 16, v57
    v_and_b32 v87, 0xffff0000, v57
    v_lshlrev_b32 v88, 16, v58
    v_and_b32 v89, 0xffff0000, v58
    v_lshlrev_b32 v90, 16, v59
    v_and_b32 v91, 0xffff0000, v59
    v_lshlrev_b32 v92, 16, v60
    v_and_b32 v93, 0xffff0000, v60
    v_lshlrev_b32 v94, 16, v61
    v_and_b32 v95, 0xffff0000, v61
    v_lshlrev_b32 v96, 16, v62
    v_and_b32 v97, 0xffff0000, v62
    v_lshlrev_b32 v98, 16, v63
    v_and_b32 v99, 0xffff0000, v63
    v_lshlrev_b32 v64, 16, v24
    v_and_b32 v65, 0xffff0000, v24
    v_pk_mul_f32 v[84:85], v[84:85], v[64:65]
    v_lshlrev_b32 v66, 16, v25
    v_and_b32 v67, 0xffff0000, v25
    v_pk_mul_f32 v[86:87], v[86:87], v[66:67]
    v_lshlrev_b32 v68, 16, v26
    v_and_b32 v69, 0xffff0000, v26
    v_pk_mul_f32 v[88:89], v[88:89], v[68:69]
    v_lshlrev_b32 v70, 16, v27
    v_and_b32 v71, 0xffff0000, v27
    v_pk_mul_f32 v[90:91], v[90:91], v[70:71]
    v_lshlrev_b32 v64, 16, v28
    v_and_b32 v65, 0xffff0000, v28
    v_pk_mul_f32 v[92:93], v[92:93], v[64:65]
    v_lshlrev_b32 v66, 16, v29
    v_and_b32 v67, 0xffff0000, v29
    v_pk_mul_f32 v[94:95], v[94:95], v[66:67]
    v_lshlrev_b32 v68, 16, v30
    v_and_b32 v69, 0xffff0000, v30
    v_pk_mul_f32 v[96:97], v[96:97], v[68:69]
    v_lshlrev_b32 v70, 16, v31
    v_and_b32 v71, 0xffff0000, v31
    v_pk_mul_f32 v[98:99], v[98:99], v[70:71]
    v_cvt_pk_bf16_f32 v64, v96, v92
    v_cvt_pk_bf16_f32 v65, v88, v84
    v_cvt_pk_bf16_f32 v66, v97, v93
    v_cvt_pk_bf16_f32 v67, v89, v85
    v_cvt_pk_bf16_f32 v68, v98, v94
    v_cvt_pk_bf16_f32 v69, v90, v86
    v_cvt_pk_bf16_f32 v70, v99, v95
    v_cvt_pk_bf16_f32 v71, v91, v87
    ds_write_b64 v100, v[64:65] offset:0
    ds_write_b64 v100, v[66:67] offset:128
    ds_write_b64 v100, v[68:69] offset:256
    ds_write_b64 v100, v[70:71] offset:384
    s_waitcnt lgkmcnt(0)
    s_barrier
    ds_read_b128 v[10:13], v104 offset:0
    ds_read_b128 v[14:17], v104 offset:4096
    s_waitcnt lgkmcnt(1)
    buffer_store_dwordx4 v[10:13], v103, s[28:31], s38 offen sc1
    s_add_u32 s38, s38, 139264
    s_waitcnt lgkmcnt(0)
    buffer_store_dwordx4 v[14:17], v103, s[28:31], s38 offen sc1
    s_add_u32 s38, s38, 139264
    v_cmp_eq_u32 vcc, 0, v102
    s_and_saveexec_b64 s[66:67], vcc
    s_cmp_eq_u32 s37, 0
    s_cbranch_scc1 prep_kernel_L2
    s_cmp_eq_u32 s32, 31
    s_cbranch_scc1 prep_kernel_L3
    buffer_store_dwordx4 v[10:13], v101, s[28:31], s36 offen offset:528 sc1
    s_add_u32 s36, s36, 139264
    buffer_store_dwordx4 v[14:17], v101, s[28:31], s36 offen offset:528 sc1
    s_add_u32 s36, s36, 139264
    s_branch prep_kernel_L3
prep_kernel_L2:
    s_cmp_lg_u32 s32, 0
    s_cbranch_scc1 prep_kernel_L3
    v_mov_b32 v108, 0
    v_mov_b32 v109, 0
    v_mov_b32 v110, 0
    v_mov_b32 v111, 0
    buffer_store_dwordx4 v[108:111], v101, s[28:31], s36 offen offset:256 sc1
    s_add_u32 s36, s36, 139264
    buffer_store_dwordx4 v[108:111], v101, s[28:31], s36 offen offset:256 sc1
    s_add_u32 s36, s36, 139264
prep_kernel_L3:
    s_mov_b64 exec, -1
    s_waitcnt vmcnt(0)
    s_barrier
    s_and_b32 s45, s45, 3
    s_cmp_lg_u32 s45, 0
    s_cbranch_scc1 prep_end
    s_mov_b32 s47, 0
prep_kernel_nn4:
    v_readfirstlane_b32 s46, v122
    s_add_u32 s47, s47, 1
    s_cmp_lg_u32 s46, 0
    s_cbranch_scc1 prep_kernel_nd5
    s_cmp_ge_u32 s47, 200000
    s_cbranch_scc1 prep_kernel_nd5
    buffer_load_dword v122, v123, s[48:51], 0 offen sc1
    s_waitcnt vmcnt(0)
    s_branch prep_kernel_nn4
prep_kernel_nd5:
    v_mov_b32 v124, s46
    v_mov_b32 v125, 0
    s_mov_b64 exec, 1
    buffer_store_dword v124, v125, s[28:31], s44 offen sc1
    s_endpgm
prep_end:
    s_endpgm
p_aux:
    v_mov_b32 v251, 0
    buffer_load_dword v250, v251, s[48:51], 0 offen sc1
    s_waitcnt vmcnt(0)
    s_mov_b32 s47, 0
prep_kernel_nn6:
    v_readfirstlane_b32 s46, v250
    s_add_u32 s47, s47, 1
    s_cmp_lg_u32 s46, 0
    s_cbranch_scc1 prep_kernel_nd7
    s_cmp_ge_u32 s47, 200000
    s_cbranch_scc1 prep_kernel_nd7
    buffer_load_dword v250, v251, s[48:51], 0 offen sc1
    s_waitcnt vmcnt(0)
    s_branch prep_kernel_nn6
prep_kernel_nd7:
    s_sub_u32 s21, s2, 160
    s_cmp_ge_u32 s20, 6
    s_cbranch_scc1 prep_end
    s_cmp_ge_u32 s20, 3
    s_cbranch_scc1 p_misc
    s_cmp_eq_u32 s20, 0
    s_cbranch_scc1 p_st
    s_cmp_eq_u32 s20, 2
    s_cbranch_scc1 p_aux2
    s_add_u32 s21, s21, 96
    s_cmp_lt_u32 s21, 128
    s_cbranch_scc1 p_st
    s_sub_u32 s21, s21, 128
    s_branch p_mod
p_aux2:
    s_cmp_ge_u32 s21, 56
    s_cbranch_scc1 prep_end
    s_add_u32 s21, s21, 64
p_mod:
    s_lshr_b32 s32, s21, 2
    s_and_b32 s33, s21, 3
    v_lshrrev_b32 v4, 3, v1
    v_and_b32 v3, 7, v1
    s_mul_i32 s34, s33, 160
    v_add_u32 v4, s34, v4
    v_lshlrev_b32 v5, 1, v4
    v_mul_u32_u24 v6, 7680, v4
    s_lshl_b32 s36, s32, 7
    v_lshl_add_u32 v7, v3, 4, s36
    v_add_u32 v6, v6, v7
    s_mov_b32 s16, s52
    s_mov_b32 s17, s53
    s_mov_b32 s18, 1280
    s_mov_b32 s19, 0x00020000
    s_mov_b32 s24, s62
    s_mov_b32 s25, s63
    s_mov_b32 s26, 4915200
    s_mov_b32 s27, 0x00020000
    s_mul_i32 s35, s33, 320
    v_lshlrev_b32 v5, 3, v1
    buffer_load_dwordx2 v[30:31], v5, s[16:19], s35 offen
    s_mov_b32 s37, 0
    buffer_load_dwordx4 v[32:35], v6, s[24:27], s37 offen nt
    s_add_u32 s37, s37, 61440
    buffer_load_dwordx4 v[36:39], v6, s[24:27], s37 offen nt
    s_add_u32 s37, s37, 61440
    buffer_load_dwordx4 v[40:43], v6, s[24:27], s37 offen nt
    s_add_u32 s37, s37, 61440
    buffer_load_dwordx4 v[44:47], v6, s[24:27], s37 offen nt
    s_add_u32 s37, s37, 61440
    buffer_load_dwordx4 v[48:51], v6, s[24:27], s37 offen nt
    s_add_u32 s37, s37, 61440
    buffer_load_dwordx4 v[52:55], v6, s[24:27], s37 offen nt
    s_add_u32 s37, s37, 61440
    buffer_load_dwordx4 v[56:59], v6, s[24:27], s37 offen nt
    s_add_u32 s37, s37, 61440
    buffer_load_dwordx4 v[60:63], v6, s[24:27], s37 offen nt
    s_add_u32 s37, s37, 61440
    buffer_load_dwordx4 v[64:67], v6, s[24:27], s37 offen nt
    s_add_u32 s37, s37, 61440
    buffer_load_dwordx4 v[68:71], v6, s[24:27], s37 offen nt
    s_add_u32 s37, s37, 61440
    buffer_load_dwordx4 v[72:75], v6, s[24:27], s37 offen nt
    s_add_u32 s37, s37, 61440
    buffer_load_dwordx4 v[76:79], v6, s[24:27], s37 offen nt
    s_add_u32 s37, s37, 61440
    buffer_load_dwordx4 v[80:83], v6, s[24:27], s37 offen nt
    s_add_u32 s37, s37, 61440
    buffer_load_dwordx4 v[84:87], v6, s[24:27], s37 offen nt
    s_add_u32 s37, s37, 61440
    buffer_load_dwordx4 v[88:91], v6, s[24:27], s37 offen nt
    s_add_u32 s37, s37, 61440
    buffer_load_dwordx4 v[92:95], v6, s[24:27], s37 offen nt
    s_add_u32 s37, s37, 61440
    buffer_load_dwordx4 v[96:99], v6, s[24:27], s37 offen nt
    s_add_u32 s37, s37, 61440
    buffer_load_dwordx4 v[100:103], v6, s[24:27], s37 offen nt
    s_add_u32 s37, s37, 61440
    buffer_load_dwordx4 v[104:107], v6, s[24:27], s37 offen nt
    s_add_u32 s37, s37, 61440
    buffer_load_dwordx4 v[108:111], v6, s[24:27], s37 offen nt
    s_mul_i32 s35, s20, 13824
    v_lshlrev_b32 v5, 4, v1
    v_add_u32 v5, s35, v5
    v_lshrrev_b32 v29, 3, v1
    v_lshlrev_b32 v29, 2, v29
    v_add_u32 v29, s35, v29
    s_waitcnt vmcnt(20)
    v_lshlrev_b32 v8, 16, v30
    v_and_b32 v9, 0xffff0000, v30
    v_lshlrev_b32 v10, 16, v31
    v_and_b32 v11, 0xffff0000, v31
    v_mul_f32 v120, 0xbfb8aa3b, v8
    v_mul_f32 v121, 0xbfb8aa3b, v9
    v_mul_f32 v122, 0xbfb8aa3b, v10
    v_mul_f32 v123, 0xbfb8aa3b, v11
    v_exp_f32 v120, v120
    v_exp_f32 v121, v121
    v_exp_f32 v122, v122
    v_exp_f32 v123, v123
    v_add_f32 v120, 1.0, v120
    v_add_f32 v121, 1.0, v121
    v_add_f32 v122, 1.0, v122
    v_add_f32 v123, 1.0, v123
    v_rcp_f32 v120, v120
    v_rcp_f32 v121, v121
    v_rcp_f32 v122, v122
    v_rcp_f32 v123, v123
    s_nop 0
    v_mul_f32 v8, v8, v120
    v_mul_f32 v9, v9, v121
    v_mul_f32 v10, v10, v122
    v_mul_f32 v11, v11, v123
    v_cvt_pk_bf16_f32 v120, v8, v9
    v_lshlrev_b32 v8, 16, v120
    v_and_b32 v9, 0xffff0000, v120
    v_cvt_pk_bf16_f32 v120, v10, v11
    v_lshlrev_b32 v10, 16, v120
    v_and_b32 v11, 0xffff0000, v120
    ds_write_b128 v5, v[8:11]
    s_waitcnt lgkmcnt(0)
    ds_read_b32 v8, v29 offset:0
    ds_read_b32 v9, v29 offset:32
    ds_read_b32 v10, v29 offset:64
    ds_read_b32 v11, v29 offset:96
    ds_read_b32 v12, v29 offset:128
    ds_read_b32 v13, v29 offset:160
    ds_read_b32 v14, v29 offset:192
    ds_read_b32 v15, v29 offset:224
    ds_read_b32 v16, v29 offset:256
    ds_read_b32 v17, v29 offset:288
    ds_read_b32 v18, v29 offset:320
    ds_read_b32 v19, v29 offset:352
    ds_read_b32 v20, v29 offset:384
    ds_read_b32 v21, v29 offset:416
    ds_read_b32 v22, v29 offset:448
    ds_read_b32 v23, v29 offset:480
    ds_read_b32 v24, v29 offset:512
    ds_read_b32 v25, v29 offset:544
    ds_read_b32 v26, v29 offset:576
    ds_read_b32 v27, v29 offset:608
    s_waitcnt lgkmcnt(0)
    v_mov_b32 v112, 0
    v_mov_b32 v113, 0
    v_mov_b32 v114, 0
    v_mov_b32 v115, 0
    v_mov_b32 v116, 0
    v_mov_b32 v117, 0
    v_mov_b32 v118, 0
    v_mov_b32 v119, 0
    s_waitcnt vmcnt(19)
    v_lshlrev_b32 v120, 16, v32
    v_and_b32 v121, 0xffff0000, v32
    v_lshlrev_b32 v122, 16, v33
    v_and_b32 v123, 0xffff0000, v33
    v_lshlrev_b32 v124, 16, v34
    v_and_b32 v125, 0xffff0000, v34
    v_lshlrev_b32 v126, 16, v35
    v_and_b32 v127, 0xffff0000, v35
    v_pk_fma_f32 v[112:113], v[120:121], v[8:9], v[112:113] op_sel:[0,0,0] op_sel_hi:[1,0,1]
    v_pk_fma_f32 v[114:115], v[122:123], v[8:9], v[114:115] op_sel:[0,0,0] op_sel_hi:[1,0,1]
    v_pk_fma_f32 v[116:117], v[124:125], v[8:9], v[116:117] op_sel:[0,0,0] op_sel_hi:[1,0,1]
    v_pk_fma_f32 v[118:119], v[126:127], v[8:9], v[118:119] op_sel:[0,0,0] op_sel_hi:[1,0,1]
    s_waitcnt vmcnt(18)
    v_lshlrev_b32 v120, 16, v36
    v_and_b32 v121, 0xffff0000, v36
    v_lshlrev_b32 v122, 16, v37
    v_and_b32 v123, 0xffff0000, v37
    v_lshlrev_b32 v124, 16, v38
    v_and_b32 v125, 0xffff0000, v38
    v_lshlrev_b32 v126, 16, v39
    v_and_b32 v127, 0xffff0000, v39
    v_pk_fma_f32 v[112:113], v[120:121], v[8:9], v[112:113] op_sel:[0,1,0] op_sel_hi:[1,1,1]
    v_pk_fma_f32 v[114:115], v[122:123], v[8:9], v[114:115] op_sel:[0,1,0] op_sel_hi:[1,1,1]
    v_pk_fma_f32 v[116:117], v[124:125], v[8:9], v[116:117] op_sel:[0,1,0] op_sel_hi:[1,1,1]
    v_pk_fma_f32 v[118:119], v[126:127], v[8:9], v[118:119] op_sel:[0,1,0] op_sel_hi:[1,1,1]
    s_waitcnt vmcnt(17)
    v_lshlrev_b32 v120, 16, v40
    v_and_b32 v121, 0xffff0000, v40
    v_lshlrev_b32 v122, 16, v41
    v_and_b32 v123, 0xffff0000, v41
    v_lshlrev_b32 v124, 16, v42
    v_and_b32 v125, 0xffff0000, v42
    v_lshlrev_b32 v126, 16, v43
    v_and_b32 v127, 0xffff0000, v43
    v_pk_fma_f32 v[112:113], v[120:121], v[10:11], v[112:113] op_sel:[0,0,0] op_sel_hi:[1,0,1]
    v_pk_fma_f32 v[114:115], v[122:123], v[10:11], v[114:115] op_sel:[0,0,0] op_sel_hi:[1,0,1]
    v_pk_fma_f32 v[116:117], v[124:125], v[10:11], v[116:117] op_sel:[0,0,0] op_sel_hi:[1,0,1]
    v_pk_fma_f32 v[118:119], v[126:127], v[10:11], v[118:119] op_sel:[0,0,0] op_sel_hi:[1,0,1]
    s_waitcnt vmcnt(16)
    v_lshlrev_b32 v120, 16, v44
    v_and_b32 v121, 0xffff0000, v44
    v_lshlrev_b32 v122, 16, v45
    v_and_b32 v123, 0xffff0000, v45
    v_lshlrev_b32 v124, 16, v46
    v_and_b32 v125, 0xffff0000, v46
    v_lshlrev_b32 v126, 16, v47
    v_and_b32 v127, 0xffff0000, v47
    v_pk_fma_f32 v[112:113], v[120:121], v[10:11], v[112:113] op_sel:[0,1,0] op_sel_hi:[1,1,1]
    v_pk_fma_f32 v[114:115], v[122:123], v[10:11], v[114:115] op_sel:[0,1,0] op_sel_hi:[1,1,1]
    v_pk_fma_f32 v[116:117], v[124:125], v[10:11], v[116:117] op_sel:[0,1,0] op_sel_hi:[1,1,1]
    v_pk_fma_f32 v[118:119], v[126:127], v[10:11], v[118:119] op_sel:[0,1,0] op_sel_hi:[1,1,1]
    s_waitcnt vmcnt(15)
    v_lshlrev_b32 v120, 16, v48
    v_and_b32 v121, 0xffff0000, v48
    v_lshlrev_b32 v122, 16, v49
    v_and_b32 v123, 0xffff0000, v49
    v_lshlrev_b32 v124, 16, v50
    v_and_b32 v125, 0xffff0000, v50
    v_lshlrev_b32 v126, 16, v51
    v_and_b32 v127, 0xffff0000, v51
    v_pk_fma_f32 v[112:113], v[120:121], v[12:13], v[112:113] op_sel:[0,0,0] op_sel_hi:[1,0,1]
    v_pk_fma_f32 v[114:115], v[122:123], v[12:13], v[114:115] op_sel:[0,0,0] op_sel_hi:[1,0,1]
    v_pk_fma_f32 v[116:117], v[124:125], v[12:13], v[116:117] op_sel:[0,0,0] op_sel_hi:[1,0,1]
    v_pk_fma_f32 v[118:119], v[126:127], v[12:13], v[118:119] op_sel:[0,0,0] op_sel_hi:[1,0,1]
    s_waitcnt vmcnt(14)
    v_lshlrev_b32 v120, 16, v52
    v_and_b32 v121, 0xffff0000, v52
    v_lshlrev_b32 v122, 16, v53
    v_and_b32 v123, 0xffff0000, v53
    v_lshlrev_b32 v124, 16, v54
    v_and_b32 v125, 0xffff0000, v54
    v_lshlrev_b32 v126, 16, v55
    v_and_b32 v127, 0xffff0000, v55
    v_pk_fma_f32 v[112:113], v[120:121], v[12:13], v[112:113] op_sel:[0,1,0] op_sel_hi:[1,1,1]
    v_pk_fma_f32 v[114:115], v[122:123], v[12:13], v[114:115] op_sel:[0,1,0] op_sel_hi:[1,1,1]
    v_pk_fma_f32 v[116:117], v[124:125], v[12:13], v[116:117] op_sel:[0,1,0] op_sel_hi:[1,1,1]
    v_pk_fma_f32 v[118:119], v[126:127], v[12:13], v[118:119] op_sel:[0,1,0] op_sel_hi:[1,1,1]
    s_waitcnt vmcnt(13)
    v_lshlrev_b32 v120, 16, v56
    v_and_b32 v121, 0xffff0000, v56
    v_lshlrev_b32 v122, 16, v57
    v_and_b32 v123, 0xffff0000, v57
    v_lshlrev_b32 v124, 16, v58
    v_and_b32 v125, 0xffff0000, v58
    v_lshlrev_b32 v126, 16, v59
    v_and_b32 v127, 0xffff0000, v59
    v_pk_fma_f32 v[112:113], v[120:121], v[14:15], v[112:113] op_sel:[0,0,0] op_sel_hi:[1,0,1]
    v_pk_fma_f32 v[114:115], v[122:123], v[14:15], v[114:115] op_sel:[0,0,0] op_sel_hi:[1,0,1]
    v_pk_fma_f32 v[116:117], v[124:125], v[14:15], v[116:117] op_sel:[0,0,0] op_sel_hi:[1,0,1]
    v_pk_fma_f32 v[118:119], v[126:127], v[14:15], v[118:119] op_sel:[0,0,0] op_sel_hi:[1,0,1]
    s_waitcnt vmcnt(12)
    v_lshlrev_b32 v120, 16, v60
    v_and_b32 v121, 0xffff0000, v60
    v_lshlrev_b32 v122, 16, v61
    v_and_b32 v123, 0xffff0000, v61
    v_lshlrev_b32 v124, 16, v62
    v_and_b32 v125, 0xffff0000, v62
    v_lshlrev_b32 v126, 16, v63
    v_and_b32 v127, 0xffff0000, v63
    v_pk_fma_f32 v[112:113], v[120:121], v[14:15], v[112:113] op_sel:[0,1,0] op_sel_hi:[1,1,1]
    v_pk_fma_f32 v[114:115], v[122:123], v[14:15], v[114:115] op_sel:[0,1,0] op_sel_hi:[1,1,1]
    v_pk_fma_f32 v[116:117], v[124:125], v[14:15], v[116:117] op_sel:[0,1,0] op_sel_hi:[1,1,1]
    v_pk_fma_f32 v[118:119], v[126:127], v[14:15], v[118:119] op_sel:[0,1,0] op_sel_hi:[1,1,1]
    s_waitcnt vmcnt(11)
    v_lshlrev_b32 v120, 16, v64
    v_and_b32 v121, 0xffff0000, v64
    v_lshlrev_b32 v122, 16, v65
    v_and_b32 v123, 0xffff0000, v65
    v_lshlrev_b32 v124, 16, v66
    v_and_b32 v125, 0xffff0000, v66
    v_lshlrev_b32 v126, 16, v67
    v_and_b32 v127, 0xffff0000, v67
    v_pk_fma_f32 v[112:113], v[120:121], v[16:17], v[112:113] op_sel:[0,0,0] op_sel_hi:[1,0,1]
    v_pk_fma_f32 v[114:115], v[122:123], v[16:17], v[114:115] op_sel:[0,0,0] op_sel_hi:[1,0,1]
    v_pk_fma_f32 v[116:117], v[124:125], v[16:17], v[116:117] op_sel:[0,0,0] op_sel_hi:[1,0,1]
    v_pk_fma_f32 v[118:119], v[126:127], v[16:17], v[118:119] op_sel:[0,0,0] op_sel_hi:[1,0,1]
    s_waitcnt vmcnt(10)
    v_lshlrev_b32 v120, 16, v68
    v_and_b32 v121, 0xffff0000, v68
    v_lshlrev_b32 v122, 16, v69
    v_and_b32 v123, 0xffff0000, v69
    v_lshlrev_b32 v124, 16, v70
    v_and_b32 v125, 0xffff0000, v70
    v_lshlrev_b32 v126, 16, v71
    v_and_b32 v127, 0xffff0000, v71
    v_pk_fma_f32 v[112:113], v[120:121], v[16:17], v[112:113] op_sel:[0,1,0] op_sel_hi:[1,1,1]
    v_pk_fma_f32 v[114:115], v[122:123], v[16:17], v[114:115] op_sel:[0,1,0] op_sel_hi:[1,1,1]
    v_pk_fma_f32 v[116:117], v[124:125], v[16:17], v[116:117] op_sel:[0,1,0] op_sel_hi:[1,1,1]
    v_pk_fma_f32 v[118:119], v[126:127], v[16:17], v[118:119] op_sel:[0,1,0] op_sel_hi:[1,1,1]
    s_waitcnt vmcnt(9)
    v_lshlrev_b32 v120, 16, v72
    v_and_b32 v121, 0xffff0000, v72
    v_lshlrev_b32 v122, 16, v73
    v_and_b32 v123, 0xffff0000, v73
    v_lshlrev_b32 v124, 16, v74
    v_and_b32 v125, 0xffff0000, v74
    v_lshlrev_b32 v126, 16, v75
    v_and_b32 v127, 0xffff0000, v75
    v_pk_fma_f32 v[112:113], v[120:121], v[18:19], v[112:113] op_sel:[0,0,0] op_sel_hi:[1,0,1]
    v_pk_fma_f32 v[114:115], v[122:123], v[18:19], v[114:115] op_sel:[0,0,0] op_sel_hi:[1,0,1]
    v_pk_fma_f32 v[116:117], v[124:125], v[18:19], v[116:117] op_sel:[0,0,0] op_sel_hi:[1,0,1]
    v_pk_fma_f32 v[118:119], v[126:127], v[18:19], v[118:119] op_sel:[0,0,0] op_sel_hi:[1,0,1]
    s_waitcnt vmcnt(8)
    v_lshlrev_b32 v120, 16, v76
    v_and_b32 v121, 0xffff0000, v76
    v_lshlrev_b32 v122, 16, v77
    v_and_b32 v123, 0xffff0000, v77
    v_lshlrev_b32 v124, 16, v78
    v_and_b32 v125, 0xffff0000, v78
    v_lshlrev_b32 v126, 16, v79
    v_and_b32 v127, 0xffff0000, v79
    v_pk_fma_f32 v[112:113], v[120:121], v[18:19], v[112:113] op_sel:[0,1,0] op_sel_hi:[1,1,1]
    v_pk_fma_f32 v[114:115], v[122:123], v[18:19], v[114:115] op_sel:[0,1,0] op_sel_hi:[1,1,1]
    v_pk_fma_f32 v[116:117], v[124:125], v[18:19], v[116:117] op_sel:[0,1,0] op_sel_hi:[1,1,1]
    v_pk_fma_f32 v[118:119], v[126:127], v[18:19], v[118:119] op_sel:[0,1,0] op_sel_hi:[1,1,1]
    s_waitcnt vmcnt(7)
    v_lshlrev_b32 v120, 16, v80
    v_and_b32 v121, 0xffff0000, v80
    v_lshlrev_b32 v122, 16, v81
    v_and_b32 v123, 0xffff0000, v81
    v_lshlrev_b32 v124, 16, v82
    v_and_b32 v125, 0xffff0000, v82
    v_lshlrev_b32 v126, 16, v83
    v_and_b32 v127, 0xffff0000, v83
    v_pk_fma_f32 v[112:113], v[120:121], v[20:21], v[112:113] op_sel:[0,0,0] op_sel_hi:[1,0,1]
    v_pk_fma_f32 v[114:115], v[122:123], v[20:21], v[114:115] op_sel:[0,0,0] op_sel_hi:[1,0,1]
    v_pk_fma_f32 v[116:117], v[124:125], v[20:21], v[116:117] op_sel:[0,0,0] op_sel_hi:[1,0,1]
    v_pk_fma_f32 v[118:119], v[126:127], v[20:21], v[118:119] op_sel:[0,0,0] op_sel_hi:[1,0,1]
    s_waitcnt vmcnt(6)
    v_lshlrev_b32 v120, 16, v84
    v_and_b32 v121, 0xffff0000, v84
    v_lshlrev_b32 v122, 16, v85
    v_and_b32 v123, 0xffff0000, v85
    v_lshlrev_b32 v124, 16, v86
    v_and_b32 v125, 0xffff0000, v86
    v_lshlrev_b32 v126, 16, v87
    v_and_b32 v127, 0xffff0000, v87
    v_pk_fma_f32 v[112:113], v[120:121], v[20:21], v[112:113] op_sel:[0,1,0] op_sel_hi:[1,1,1]
    v_pk_fma_f32 v[114:115], v[122:123], v[20:21], v[114:115] op_sel:[0,1,0] op_sel_hi:[1,1,1]
    v_pk_fma_f32 v[116:117], v[124:125], v[20:21], v[116:117] op_sel:[0,1,0] op_sel_hi:[1,1,1]
    v_pk_fma_f32 v[118:119], v[126:127], v[20:21], v[118:119] op_sel:[0,1,0] op_sel_hi:[1,1,1]
    s_waitcnt vmcnt(5)
    v_lshlrev_b32 v120, 16, v88
    v_and_b32 v121, 0xffff0000, v88
    v_lshlrev_b32 v122, 16, v89
    v_and_b32 v123, 0xffff0000, v89
    v_lshlrev_b32 v124, 16, v90
    v_and_b32 v125, 0xffff0000, v90
    v_lshlrev_b32 v126, 16, v91
    v_and_b32 v127, 0xffff0000, v91
    v_pk_fma_f32 v[112:113], v[120:121], v[22:23], v[112:113] op_sel:[0,0,0] op_sel_hi:[1,0,1]
    v_pk_fma_f32 v[114:115], v[122:123], v[22:23], v[114:115] op_sel:[0,0,0] op_sel_hi:[1,0,1]
    v_pk_fma_f32 v[116:117], v[124:125], v[22:23], v[116:117] op_sel:[0,0,0] op_sel_hi:[1,0,1]
    v_pk_fma_f32 v[118:119], v[126:127], v[22:23], v[118:119] op_sel:[0,0,0] op_sel_hi:[1,0,1]
    s_waitcnt vmcnt(4)
    v_lshlrev_b32 v120, 16, v92
    v_and_b32 v121, 0xffff0000, v92
    v_lshlrev_b32 v122, 16, v93
    v_and_b32 v123, 0xffff0000, v93
    v_lshlrev_b32 v124, 16, v94
    v_and_b32 v125, 0xffff0000, v94
    v_lshlrev_b32 v126, 16, v95
    v_and_b32 v127, 0xffff0000, v95
    v_pk_fma_f32 v[112:113], v[120:121], v[22:23], v[112:113] op_sel:[0,1,0] op_sel_hi:[1,1,1]
    v_pk_fma_f32 v[114:115], v[122:123], v[22:23], v[114:115] op_sel:[0,1,0] op_sel_hi:[1,1,1]
    v_pk_fma_f32 v[116:117], v[124:125], v[22:23], v[116:117] op_sel:[0,1,0] op_sel_hi:[1,1,1]
    v_pk_fma_f32 v[118:119], v[126:127], v[22:23], v[118:119] op_sel:[0,1,0] op_sel_hi:[1,1,1]
    s_waitcnt vmcnt(3)
    v_lshlrev_b32 v120, 16, v96
    v_and_b32 v121, 0xffff0000, v96
    v_lshlrev_b32 v122, 16, v97
    v_and_b32 v123, 0xffff0000, v97
    v_lshlrev_b32 v124, 16, v98
    v_and_b32 v125, 0xffff0000, v98
    v_lshlrev_b32 v126, 16, v99
    v_and_b32 v127, 0xffff0000, v99
    v_pk_fma_f32 v[112:113], v[120:121], v[24:25], v[112:113] op_sel:[0,0,0] op_sel_hi:[1,0,1]
    v_pk_fma_f32 v[114:115], v[122:123], v[24:25], v[114:115] op_sel:[0,0,0] op_sel_hi:[1,0,1]
    v_pk_fma_f32 v[116:117], v[124:125], v[24:25], v[116:117] op_sel:[0,0,0] op_sel_hi:[1,0,1]
    v_pk_fma_f32 v[118:119], v[126:127], v[24:25], v[118:119] op_sel:[0,0,0] op_sel_hi:[1,0,1]
    s_waitcnt vmcnt(2)
    v_lshlrev_b32 v120, 16, v100
    v_and_b32 v121, 0xffff0000, v100
    v_lshlrev_b32 v122, 16, v101
    v_and_b32 v123, 0xffff0000, v101
    v_lshlrev_b32 v124, 16, v102
    v_and_b32 v125, 0xffff0000, v102
    v_lshlrev_b32 v126, 16, v103
    v_and_b32 v127, 0xffff0000, v103
    v_pk_fma_f32 v[112:113], v[120:121], v[24:25], v[112:113] op_sel:[0,1,0] op_sel_hi:[1,1,1]
    v_pk_fma_f32 v[114:115], v[122:123], v[24:25], v[114:115] op_sel:[0,1,0] op_sel_hi:[1,1,1]
    v_pk_fma_f32 v[116:117], v[124:125], v[24:25], v[116:117] op_sel:[0,1,0] op_sel_hi:[1,1,1]
    v_pk_fma_f32 v[118:119], v[126:127], v[24:25], v[118:119] op_sel:[0,1,0] op_sel_hi:[1,1,1]
    s_waitcnt vmcnt(1)
    v_lshlrev_b32 v120, 16, v104
    v_and_b32 v121, 0xffff0000, v104
    v_lshlrev_b32 v122, 16, v105
    v_and_b32 v123, 0xffff0000, v105
    v_lshlrev_b32 v124, 16, v106
    v_and_b32 v125, 0xffff0000, v106
    v_lshlrev_b32 v126, 16, v107
    v_and_b32 v127, 0xffff0000, v107
    v_pk_fma_f32 v[112:113], v[120:121], v[26:27], v[112:113] op_sel:[0,0,0] op_sel_hi:[1,0,1]
    v_pk_fma_f32 v[114:115], v[122:123], v[26:27], v[114:115] op_sel:[0,0,0] op_sel_hi:[1,0,1]
    v_pk_fma_f32 v[116:117], v[124:125], v[26:27], v[116:117] op_sel:[0,0,0] op_sel_hi:[1,0,1]
    v_pk_fma_f32 v[118:119], v[126:127], v[26:27], v[118:119] op_sel:[0,0,0] op_sel_hi:[1,0,1]
    s_waitcnt vmcnt(0)
    v_lshlrev_b32 v120, 16, v108
    v_and_b32 v121, 0xffff0000, v108
    v_lshlrev_b32 v122, 16, v109
    v_and_b32 v123, 0xffff0000, v109
    v_lshlrev_b32 v124, 16, v110
    v_and_b32 v125, 0xffff0000, v110
    v_lshlrev_b32 v126, 16, v111
    v_and_b32 v127, 0xffff0000, v111
    v_pk_fma_f32 v[112:113], v[120:121], v[26:27], v[112:113] op_sel:[0,1,0] op_sel_hi:[1,1,1]
    v_pk_fma_f32 v[114:115], v[122:123], v[26:27], v[114:115] op_sel:[0,1,0] op_sel_hi:[1,1,1]
    v_pk_fma_f32 v[116:117], v[124:125], v[26:27], v[116:117] op_sel:[0,1,0] op_sel_hi:[1,1,1]
    v_pk_fma_f32 v[118:119], v[126:127], v[26:27], v[118:119] op_sel:[0,1,0] op_sel_hi:[1,1,1]
    s_nop 1
    v_add_f32_dpp v112, v112, v112 row_ror:8 row_mask:0xf bank_mask:0xf
    v_add_f32_dpp v113, v113, v113 row_ror:8 row_mask:0xf bank_mask:0xf
    v_add_f32_dpp v114, v114, v114 row_ror:8 row_mask:0xf bank_mask:0xf
    v_add_f32_dpp v115, v115, v115 row_ror:8 row_mask:0xf bank_mask:0xf
    v_add_f32_dpp v116, v116, v116 row_ror:8 row_mask:0xf bank_mask:0xf
    v_add_f32_dpp v117, v117, v117 row_ror:8 row_mask:0xf bank_mask:0xf
    v_add_f32_dpp v118, v118, v118 row_ror:8 row_mask:0xf bank_mask:0xf
    v_add_f32_dpp v119, v119, v119 row_ror:8 row_mask:0xf bank_mask:0xf
    v_mov_b32 v120, v112
    v_mov_b32 v121, v113
    v_mov_b32 v122, v114
    v_mov_b32 v123, v115
    v_mov_b32 v124, v116
    v_mov_b32 v125, v117
    v_mov_b32 v126, v118
    v_mov_b32 v127, v119
    s_nop 1
    v_permlane32_swap_b32 v120, v112
    v_permlane32_swap_b32 v121, v113
    v_permlane32_swap_b32 v122, v114
    v_permlane32_swap_b32 v123, v115
    v_permlane32_swap_b32 v124, v116
    v_permlane32_swap_b32 v125, v117
    v_permlane32_swap_b32 v126, v118
    v_permlane32_swap_b32 v127, v119
    s_nop 1
    v_add_f32 v112, v112, v120
    v_add_f32 v113, v113, v121
    v_add_f32 v114, v114, v122
    v_add_f32 v115, v115, v123
    v_add_f32 v116, v116, v124
    v_add_f32 v117, v117, v125
    v_add_f32 v118, v118, v126
    v_add_f32 v119, v119, v127
    v_mov_b32 v120, v112
    v_mov_b32 v121, v113
    v_mov_b32 v122, v114
    v_mov_b32 v123, v115
    v_mov_b32 v124, v116
    v_mov_b32 v125, v117
    v_mov_b32 v126, v118
    v_mov_b32 v127, v119
    s_nop 1
    v_permlane16_swap_b32 v120, v112
    v_permlane16_swap_b32 v121, v113
    v_permlane16_swap_b32 v122, v114
    v_permlane16_swap_b32 v123, v115
    v_permlane16_swap_b32 v124, v116
    v_permlane16_swap_b32 v125, v117
    v_permlane16_swap_b32 v126, v118
    v_permlane16_swap_b32 v127, v119
    s_nop 1
    v_add_f32 v112, v112, v120
    v_add_f32 v113, v113, v121
    v_add_f32 v114, v114, v122
    v_add_f32 v115, v115, v123
    v_add_f32 v116, v116, v124
    v_add_f32 v117, v117, v125
    v_add_f32 v118, v118, v126
    v_add_f32 v119, v119, v127
    v_lshlrev_b32 v7, 5, v3
    s_mul_i32 s36, s33, 15360
    s_lshl_b32 s37, s32, 8
    s_add_u32 s37, s37, s36
    s_add_u32 s37, s37, 2793472
    s_lshl_b32 s44, s21, 7
    s_add_u32 s44, s44, 29700096
    s_mov_b64 exec, 0xff
    buffer_store_dwordx4 v[112:115], v7, s[28:31], s37 offen sc1
    buffer_store_dwordx4 v[116:119], v7, s[28:31], s37 offen offset:16 sc1
    s_mov_b64 exec, -1
    s_waitcnt vmcnt(0)
    s_mov_b32 s47, 0
prep_kernel_nn8:
    v_readfirstlane_b32 s46, v250
    s_add_u32 s47, s47, 1
    s_cmp_lg_u32 s46, 0
    s_cbranch_scc1 prep_kernel_nd9
    s_cmp_ge_u32 s47, 200000
    s_cbranch_scc1 prep_kernel_nd9
    buffer_load_dword v250, v251, s[48:51], 0 offen sc1
    s_waitcnt vmcnt(0)
    s_branch prep_kernel_nn8
prep_kernel_nd9:
    v_mov_b32 v132, s46
    v_mov_b32 v133, 0
    s_mov_b64 exec, 1
    buffer_store_dword v132, v133, s[28:31], s44 offen sc1
    s_endpgm
p_st:
    s_mov_b32 s16, s60
    s_mov_b32 s17, s61
    s_mov_b32 s18, 2621440
    s_mov_b32 s19, 0x00020000
    v_lshrrev_b32 v5, 3, v1
    v_and_b32 v6, 7, v1
    s_lshl_b32 s23, s21, 4
    v_add_u32 v7, s23, v5
    v_mul_u32_u24 v9, 1280, v7
    v_lshl_add_u32 v9, v6, 4, v9
    v_mov_b32 v20, 0x3f803f80
    s_mov_b32 s24, 0
    buffer_load_dwordx4 v[32:35], v9, s[16:19], s24 offen offset:0 nt
    buffer_load_dwordx4 v[36:39], v9, s[16:19], s24 offen offset:128 nt
    buffer_load_dwordx4 v[40:43], v9, s[16:19], s24 offen offset:256 nt
    buffer_load_dwordx4 v[44:47], v9, s[16:19], s24 offen offset:384 nt
    buffer_load_dwordx4 v[48:51], v9, s[16:19], s24 offen offset:512 nt
    buffer_load_dwordx4 v[52:55], v9, s[16:19], s24 offen offset:640 nt
    buffer_load_dwordx4 v[56:59], v9, s[16:19], s24 offen offset:768 nt
    buffer_load_dwordx4 v[60:63], v9, s[16:19], s24 offen offset:896 nt
    buffer_load_dwordx4 v[64:67], v9, s[16:19], s24 offen offset:1024 nt
    buffer_load_dwordx4 v[68:71], v9, s[16:19], s24 offen offset:1152 nt
    s_add_u32 s24, s24, 10240
    buffer_load_dwordx4 v[72:75], v9, s[16:19], s24 offen offset:0 nt
    buffer_load_dwordx4 v[76:79], v9, s[16:19], s24 offen offset:128 nt
    buffer_load_dwordx4 v[80:83], v9, s[16:19], s24 offen offset:256 nt
    buffer_load_dwordx4 v[84:87], v9, s[16:19], s24 offen offset:384 nt
    buffer_load_dwordx4 v[88:91], v9, s[16:19], s24 offen offset:512 nt
    buffer_load_dwordx4 v[92:95], v9, s[16:19], s24 offen offset:640 nt
    buffer_load_dwordx4 v[96:99], v9, s[16:19], s24 offen offset:768 nt
    buffer_load_dwordx4 v[100:103], v9, s[16:19], s24 offen offset:896 nt
    buffer_load_dwordx4 v[104:107], v9, s[16:19], s24 offen offset:1024 nt
    buffer_load_dwordx4 v[108:111], v9, s[16:19], s24 offen offset:1152 nt
    v_and_b32 v21, 1, v5
    v_lshl_add_u32 v21, v6, 1, v21
    v_lshlrev_b32 v21, 7, v21
    v_lshrrev_b32 v22, 1, v5
    v_xor_b32 v22, v22, v6
    v_lshl_add_u32 v21, v22, 4, v21
    v_xor_b32 v23, 64, v21
    s_mul_i32 s25, s21, 20480
    s_add_u32 s25, s25, 2854912
    v_mov_b32 v10, 0
    v_mov_b32 v11, 0
    v_mov_b32 v12, 0
    v_mov_b32 v13, 0
    s_waitcnt vmcnt(19)
    v_dot2_f32_bf16 v10, v32, v20, v10
    v_dot2_f32_bf16 v11, v32, v32, v11
    v_dot2_f32_bf16 v10, v33, v20, v10
    v_dot2_f32_bf16 v11, v33, v33, v11
    v_dot2_f32_bf16 v10, v34, v20, v10
    v_dot2_f32_bf16 v11, v34, v34, v11
    v_dot2_f32_bf16 v10, v35, v20, v10
    v_dot2_f32_bf16 v11, v35, v35, v11
    v_mov_b32 v120, v32
    v_mov_b32 v121, v33
    v_mov_b32 v122, v34
    v_mov_b32 v123, v35
    v_mov_b32_dpp v120, v34 row_ror:8 row_mask:0xf bank_mask:0xc
    v_mov_b32_dpp v121, v35 row_ror:8 row_mask:0xf bank_mask:0xc
    v_mov_b32_dpp v122, v32 row_ror:8 row_mask:0xf bank_mask:0x3
    v_mov_b32_dpp v123, v33 row_ror:8 row_mask:0xf bank_mask:0x3
    s_add_u32 s26, s25, 0
    buffer_store_dwordx4 v[120:123], v21, s[28:31], s26 offen sc1
    s_waitcnt vmcnt(19)
    v_dot2_f32_bf16 v10, v36, v20, v10
    v_dot2_f32_bf16 v11, v36, v36, v11
    v_dot2_f32_bf16 v10, v37, v20, v10
    v_dot2_f32_bf16 v11, v37, v37, v11
    v_dot2_f32_bf16 v10, v38, v20, v10
    v_dot2_f32_bf16 v11, v38, v38, v11
    v_dot2_f32_bf16 v10, v39, v20, v10
    v_dot2_f32_bf16 v11, v39, v39, v11
    v_mov_b32 v124, v36
    v_mov_b32 v125, v37
    v_mov_b32 v126, v38
    v_mov_b32 v127, v39
    v_mov_b32_dpp v124, v38 row_ror:8 row_mask:0xf bank_mask:0xc
    v_mov_b32_dpp v125, v39 row_ror:8 row_mask:0xf bank_mask:0xc
    v_mov_b32_dpp v126, v36 row_ror:8 row_mask:0xf bank_mask:0x3
    v_mov_b32_dpp v127, v37 row_ror:8 row_mask:0xf bank_mask:0x3
    s_add_u32 s26, s25, 2048
    buffer_store_dwordx4 v[124:127], v21, s[28:31], s26 offen sc1
    s_waitcnt vmcnt(19)
    v_dot2_f32_bf16 v10, v40, v20, v10
    v_dot2_f32_bf16 v11, v40, v40, v11
    v_dot2_f32_bf16 v10, v41, v20, v10
    v_dot2_f32_bf16 v11, v41, v41, v11
    v_dot2_f32_bf16 v10, v42, v20, v10
    v_dot2_f32_bf16 v11, v42, v42, v11
    v_dot2_f32_bf16 v10, v43, v20, v10
    v_dot2_f32_bf16 v11, v43, v43, v11
    v_mov_b32 v120, v40
    v_mov_b32 v121, v41
    v_mov_b32 v122, v42
    v_mov_b32 v123, v43
    v_mov_b32_dpp v120, v42 row_ror:8 row_mask:0xf bank_mask:0xc
    v_mov_b32_dpp v121, v43 row_ror:8 row_mask:0xf bank_mask:0xc
    v_mov_b32_dpp v122, v40 row_ror:8 row_mask:0xf bank_mask:0x3
    v_mov_b32_dpp v123, v41 row_ror:8 row_mask:0xf bank_mask:0x3
    s_add_u32 s26, s25, 4096
    buffer_store_dwordx4 v[120:123], v21, s[28:31], s26 offen sc1
    s_waitcnt vmcnt(19)
    v_dot2_f32_bf16 v10, v44, v20, v10
    v_dot2_f32_bf16 v11, v44, v44, v11
    v_dot2_f32_bf16 v10, v45, v20, v10
    v_dot2_f32_bf16 v11, v45, v45, v11
    v_dot2_f32_bf16 v10, v46, v20, v10
    v_dot2_f32_bf16 v11, v46, v46, v11
    v_dot2_f32_bf16 v10, v47, v20, v10
    v_dot2_f32_bf16 v11, v47, v47, v11
    v_mov_b32 v124, v44
    v_mov_b32 v125, v45
    v_mov_b32 v126, v46
    v_mov_b32 v127, v47
    v_mov_b32_dpp v124, v46 row_ror:8 row_mask:0xf bank_mask:0xc
    v_mov_b32_dpp v125, v47 row_ror:8 row_mask:0xf bank_mask:0xc
    v_mov_b32_dpp v126, v44 row_ror:8 row_mask:0xf bank_mask:0x3
    v_mov_b32_dpp v127, v45 row_ror:8 row_mask:0xf bank_mask:0x3
    s_add_u32 s26, s25, 6144
    buffer_store_dwordx4 v[124:127], v21, s[28:31], s26 offen sc1
    s_waitcnt vmcnt(19)
    v_dot2_f32_bf16 v10, v48, v20, v10
    v_dot2_f32_bf16 v11, v48, v48, v11
    v_dot2_f32_bf16 v10, v49, v20, v10
    v_dot2_f32_bf16 v11, v49, v49, v11
    v_dot2_f32_bf16 v10, v50, v20, v10
    v_dot2_f32_bf16 v11, v50, v50, v11
    v_dot2_f32_bf16 v10, v51, v20, v10
    v_dot2_f32_bf16 v11, v51, v51, v11
    v_mov_b32 v120, v48
    v_mov_b32 v121, v49
    v_mov_b32 v122, v50
    v_mov_b32 v123, v51
    v_mov_b32_dpp v120, v50 row_ror:8 row_mask:0xf bank_mask:0xc
    v_mov_b32_dpp v121, v51 row_ror:8 row_mask:0xf bank_mask:0xc
    v_mov_b32_dpp v122, v48 row_ror:8 row_mask:0xf bank_mask:0x3
    v_mov_b32_dpp v123, v49 row_ror:8 row_mask:0xf bank_mask:0x3
    s_add_u32 s26, s25, 8192
    buffer_store_dwordx4 v[120:123], v21, s[28:31], s26 offen sc1
    s_waitcnt vmcnt(19)
    v_dot2_f32_bf16 v10, v52, v20, v10
    v_dot2_f32_bf16 v11, v52, v52, v11
    v_dot2_f32_bf16 v10, v53, v20, v10
    v_dot2_f32_bf16 v11, v53, v53, v11
    v_dot2_f32_bf16 v10, v54, v20, v10
    v_dot2_f32_bf16 v11, v54, v54, v11
    v_dot2_f32_bf16 v10, v55, v20, v10
    v_dot2_f32_bf16 v11, v55, v55, v11
    v_mov_b32 v124, v52
    v_mov_b32 v125, v53
    v_mov_b32 v126, v54
    v_mov_b32 v127, v55
    v_mov_b32_dpp v124, v54 row_ror:8 row_mask:0xf bank_mask:0xc
    v_mov_b32_dpp v125, v55 row_ror:8 row_mask:0xf bank_mask:0xc
    v_mov_b32_dpp v126, v52 row_ror:8 row_mask:0xf bank_mask:0x3
    v_mov_b32_dpp v127, v53 row_ror:8 row_mask:0xf bank_mask:0x3
    s_add_u32 s26, s25, 10240
    buffer_store_dwordx4 v[124:127], v21, s[28:31], s26 offen sc1
    s_waitcnt vmcnt(19)
    v_dot2_f32_bf16 v10, v56, v20, v10
    v_dot2_f32_bf16 v11, v56, v56, v11
    v_dot2_f32_bf16 v10, v57, v20, v10
    v_dot2_f32_bf16 v11, v57, v57, v11
    v_dot2_f32_bf16 v10, v58, v20, v10
    v_dot2_f32_bf16 v11, v58, v58, v11
    v_dot2_f32_bf16 v10, v59, v20, v10
    v_dot2_f32_bf16 v11, v59, v59, v11
    v_mov_b32 v120, v56
    v_mov_b32 v121, v57
    v_mov_b32 v122, v58
    v_mov_b32 v123, v59
    v_mov_b32_dpp v120, v58 row_ror:8 row_mask:0xf bank_mask:0xc
    v_mov_b32_dpp v121, v59 row_ror:8 row_mask:0xf bank_mask:0xc
    v_mov_b32_dpp v122, v56 row_ror:8 row_mask:0xf bank_mask:0x3
    v_mov_b32_dpp v123, v57 row_ror:8 row_mask:0xf bank_mask:0x3
    s_add_u32 s26, s25, 12288
    buffer_store_dwordx4 v[120:123], v21, s[28:31], s26 offen sc1
    s_waitcnt vmcnt(19)
    v_dot2_f32_bf16 v10, v60, v20, v10
    v_dot2_f32_bf16 v11, v60, v60, v11
    v_dot2_f32_bf16 v10, v61, v20, v10
    v_dot2_f32_bf16 v11, v61, v61, v11
    v_dot2_f32_bf16 v10, v62, v20, v10
    v_dot2_f32_bf16 v11, v62, v62, v11
    v_dot2_f32_bf16 v10, v63, v20, v10
    v_dot2_f32_bf16 v11, v63, v63, v11
    v_mov_b32 v124, v60
    v_mov_b32 v125, v61
    v_mov_b32 v126, v62
    v_mov_b32 v127, v63
    v_mov_b32_dpp v124, v62 row_ror:8 row_mask:0xf bank_mask:0xc
    v_mov_b32_dpp v125, v63 row_ror:8 row_mask:0xf bank_mask:0xc
    v_mov_b32_dpp v126, v60 row_ror:8 row_mask:0xf bank_mask:0x3
    v_mov_b32_dpp v127, v61 row_ror:8 row_mask:0xf bank_mask:0x3
    s_add_u32 s26, s25, 14336
    buffer_store_dwordx4 v[124:127], v21, s[28:31], s26 offen sc1
    s_waitcnt vmcnt(19)
    v_dot2_f32_bf16 v10, v64, v20, v10
    v_dot2_f32_bf16 v11, v64, v64, v11
    v_dot2_f32_bf16 v10, v65, v20, v10
    v_dot2_f32_bf16 v11, v65, v65, v11
    v_dot2_f32_bf16 v10, v66, v20, v10
    v_dot2_f32_bf16 v11, v66, v66, v11
    v_dot2_f32_bf16 v10, v67, v20, v10
    v_dot2_f32_bf16 v11, v67, v67, v11
    v_mov_b32 v120, v64
    v_mov_b32 v121, v65
    v_mov_b32 v122, v66
    v_mov_b32 v123, v67
    v_mov_b32_dpp v120, v66 row_ror:8 row_mask:0xf bank_mask:0xc
    v_mov_b32_dpp v121, v67 row_ror:8 row_mask:0xf bank_mask:0xc
    v_mov_b32_dpp v122, v64 row_ror:8 row_mask:0xf bank_mask:0x3
    v_mov_b32_dpp v123, v65 row_ror:8 row_mask:0xf bank_mask:0x3
    s_add_u32 s26, s25, 16384
    buffer_store_dwordx4 v[120:123], v21, s[28:31], s26 offen sc1
    s_waitcnt vmcnt(19)
    v_dot2_f32_bf16 v10, v68, v20, v10
    v_dot2_f32_bf16 v11, v68, v68, v11
    v_dot2_f32_bf16 v10, v69, v20, v10
    v_dot2_f32_bf16 v11, v69, v69, v11
    v_dot2_f32_bf16 v10, v70, v20, v10
    v_dot2_f32_bf16 v11, v70, v70, v11
    v_dot2_f32_bf16 v10, v71, v20, v10
    v_dot2_f32_bf16 v11, v71, v71, v11
    v_mov_b32 v124, v68
    v_mov_b32 v125, v69
    v_mov_b32 v126, v70
    v_mov_b32 v127, v71
    v_mov_b32_dpp v124, v70 row_ror:8 row_mask:0xf bank_mask:0xc
    v_mov_b32_dpp v125, v71 row_ror:8 row_mask:0xf bank_mask:0xc
    v_mov_b32_dpp v126, v68 row_ror:8 row_mask:0xf bank_mask:0x3
    v_mov_b32_dpp v127, v69 row_ror:8 row_mask:0xf bank_mask:0x3
    s_add_u32 s26, s25, 18432
    buffer_store_dwordx4 v[124:127], v21, s[28:31], s26 offen sc1
    s_waitcnt vmcnt(19)
    v_dot2_f32_bf16 v12, v72, v20, v12
    v_dot2_f32_bf16 v13, v72, v72, v13
    v_dot2_f32_bf16 v12, v73, v20, v12
    v_dot2_f32_bf16 v13, v73, v73, v13
    v_dot2_f32_bf16 v12, v74, v20, v12
    v_dot2_f32_bf16 v13, v74, v74, v13
    v_dot2_f32_bf16 v12, v75, v20, v12
    v_dot2_f32_bf16 v13, v75, v75, v13
    v_mov_b32 v120, v72
    v_mov_b32 v121, v73
    v_mov_b32 v122, v74
    v_mov_b32 v123, v75
    v_mov_b32_dpp v120, v74 row_ror:8 row_mask:0xf bank_mask:0xc
    v_mov_b32_dpp v121, v75 row_ror:8 row_mask:0xf bank_mask:0xc
    v_mov_b32_dpp v122, v72 row_ror:8 row_mask:0xf bank_mask:0x3
    v_mov_b32_dpp v123, v73 row_ror:8 row_mask:0xf bank_mask:0x3
    s_add_u32 s26, s25, 0
    buffer_store_dwordx4 v[120:123], v23, s[28:31], s26 offen sc1
    s_waitcnt vmcnt(19)
    v_dot2_f32_bf16 v12, v76, v20, v12
    v_dot2_f32_bf16 v13, v76, v76, v13
    v_dot2_f32_bf16 v12, v77, v20, v12
    v_dot2_f32_bf16 v13, v77, v77, v13
    v_dot2_f32_bf16 v12, v78, v20, v12
    v_dot2_f32_bf16 v13, v78, v78, v13
    v_dot2_f32_bf16 v12, v79, v20, v12
    v_dot2_f32_bf16 v13, v79, v79, v13
    v_mov_b32 v124, v76
    v_mov_b32 v125, v77
    v_mov_b32 v126, v78
    v_mov_b32 v127, v79
    v_mov_b32_dpp v124, v78 row_ror:8 row_mask:0xf bank_mask:0xc
    v_mov_b32_dpp v125, v79 row_ror:8 row_mask:0xf bank_mask:0xc
    v_mov_b32_dpp v126, v76 row_ror:8 row_mask:0xf bank_mask:0x3
    v_mov_b32_dpp v127, v77 row_ror:8 row_mask:0xf bank_mask:0x3
    s_add_u32 s26, s25, 2048
    buffer_store_dwordx4 v[124:127], v23, s[28:31], s26 offen sc1
    s_waitcnt vmcnt(19)
    v_dot2_f32_bf16 v12, v80, v20, v12
    v_dot2_f32_bf16 v13, v80, v80, v13
    v_dot2_f32_bf16 v12, v81, v20, v12
    v_dot2_f32_bf16 v13, v81, v81, v13
    v_dot2_f32_bf16 v12, v82, v20, v12
    v_dot2_f32_bf16 v13, v82, v82, v13
    v_dot2_f32_bf16 v12, v83, v20, v12
    v_dot2_f32_bf16 v13, v83, v83, v13
    v_mov_b32 v120, v80
    v_mov_b32 v121, v81
    v_mov_b32 v122, v82
    v_mov_b32 v123, v83
    v_mov_b32_dpp v120, v82 row_ror:8 row_mask:0xf bank_mask:0xc
    v_mov_b32_dpp v121, v83 row_ror:8 row_mask:0xf bank_mask:0xc
    v_mov_b32_dpp v122, v80 row_ror:8 row_mask:0xf bank_mask:0x3
    v_mov_b32_dpp v123, v81 row_ror:8 row_mask:0xf bank_mask:0x3
    s_add_u32 s26, s25, 4096
    buffer_store_dwordx4 v[120:123], v23, s[28:31], s26 offen sc1
    s_waitcnt vmcnt(19)
    v_dot2_f32_bf16 v12, v84, v20, v12
    v_dot2_f32_bf16 v13, v84, v84, v13
    v_dot2_f32_bf16 v12, v85, v20, v12
    v_dot2_f32_bf16 v13, v85, v85, v13
    v_dot2_f32_bf16 v12, v86, v20, v12
    v_dot2_f32_bf16 v13, v86, v86, v13
    v_dot2_f32_bf16 v12, v87, v20, v12
    v_dot2_f32_bf16 v13, v87, v87, v13
    v_mov_b32 v124, v84
    v_mov_b32 v125, v85
    v_mov_b32 v126, v86
    v_mov_b32 v127, v87
    v_mov_b32_dpp v124, v86 row_ror:8 row_mask:0xf bank_mask:0xc
    v_mov_b32_dpp v125, v87 row_ror:8 row_mask:0xf bank_mask:0xc
    v_mov_b32_dpp v126, v84 row_ror:8 row_mask:0xf bank_mask:0x3
    v_mov_b32_dpp v127, v85 row_ror:8 row_mask:0xf bank_mask:0x3
    s_add_u32 s26, s25, 6144
    buffer_store_dwordx4 v[124:127], v23, s[28:31], s26 offen sc1
    s_waitcnt vmcnt(19)
    v_dot2_f32_bf16 v12, v88, v20, v12
    v_dot2_f32_bf16 v13, v88, v88, v13
    v_dot2_f32_bf16 v12, v89, v20, v12
    v_dot2_f32_bf16 v13, v89, v89, v13
    v_dot2_f32_bf16 v12, v90, v20, v12
    v_dot2_f32_bf16 v13, v90, v90, v13
    v_dot2_f32_bf16 v12, v91, v20, v12
    v_dot2_f32_bf16 v13, v91, v91, v13
    v_mov_b32 v120, v88
    v_mov_b32 v121, v89
    v_mov_b32 v122, v90
    v_mov_b32 v123, v91
    v_mov_b32_dpp v120, v90 row_ror:8 row_mask:0xf bank_mask:0xc
    v_mov_b32_dpp v121, v91 row_ror:8 row_mask:0xf bank_mask:0xc
    v_mov_b32_dpp v122, v88 row_ror:8 row_mask:0xf bank_mask:0x3
    v_mov_b32_dpp v123, v89 row_ror:8 row_mask:0xf bank_mask:0x3
    s_add_u32 s26, s25, 8192
    buffer_store_dwordx4 v[120:123], v23, s[28:31], s26 offen sc1
    s_waitcnt vmcnt(19)
    v_dot2_f32_bf16 v12, v92, v20, v12
    v_dot2_f32_bf16 v13, v92, v92, v13
    v_dot2_f32_bf16 v12, v93, v20, v12
    v_dot2_f32_bf16 v13, v93, v93, v13
    v_dot2_f32_bf16 v12, v94, v20, v12
    v_dot2_f32_bf16 v13, v94, v94, v13
    v_dot2_f32_bf16 v12, v95, v20, v12
    v_dot2_f32_bf16 v13, v95, v95, v13
    v_mov_b32 v124, v92
    v_mov_b32 v125, v93
    v_mov_b32 v126, v94
    v_mov_b32 v127, v95
    v_mov_b32_dpp v124, v94 row_ror:8 row_mask:0xf bank_mask:0xc
    v_mov_b32_dpp v125, v95 row_ror:8 row_mask:0xf bank_mask:0xc
    v_mov_b32_dpp v126, v92 row_ror:8 row_mask:0xf bank_mask:0x3
    v_mov_b32_dpp v127, v93 row_ror:8 row_mask:0xf bank_mask:0x3
    s_add_u32 s26, s25, 10240
    buffer_store_dwordx4 v[124:127], v23, s[28:31], s26 offen sc1
    s_waitcnt vmcnt(19)
    v_dot2_f32_bf16 v12, v96, v20, v12
    v_dot2_f32_bf16 v13, v96, v96, v13
    v_dot2_f32_bf16 v12, v97, v20, v12
    v_dot2_f32_bf16 v13, v97, v97, v13
    v_dot2_f32_bf16 v12, v98, v20, v12
    v_dot2_f32_bf16 v13, v98, v98, v13
    v_dot2_f32_bf16 v12, v99, v20, v12
    v_dot2_f32_bf16 v13, v99, v99, v13
    v_mov_b32 v120, v96
    v_mov_b32 v121, v97
    v_mov_b32 v122, v98
    v_mov_b32 v123, v99
    v_mov_b32_dpp v120, v98 row_ror:8 row_mask:0xf bank_mask:0xc
    v_mov_b32_dpp v121, v99 row_ror:8 row_mask:0xf bank_mask:0xc
    v_mov_b32_dpp v122, v96 row_ror:8 row_mask:0xf bank_mask:0x3
    v_mov_b32_dpp v123, v97 row_ror:8 row_mask:0xf bank_mask:0x3
    s_add_u32 s26, s25, 12288
    buffer_store_dwordx4 v[120:123], v23, s[28:31], s26 offen sc1
    s_waitcnt vmcnt(19)
    v_dot2_f32_bf16 v12, v100, v20, v12
    v_dot2_f32_bf16 v13, v100, v100, v13
    v_dot2_f32_bf16 v12, v101, v20, v12
    v_dot2_f32_bf16 v13, v101, v101, v13
    v_dot2_f32_bf16 v12, v102, v20, v12
    v_dot2_f32_bf16 v13, v102, v102, v13
    v_dot2_f32_bf16 v12, v103, v20, v12
    v_dot2_f32_bf16 v13, v103, v103, v13
    v_mov_b32 v124, v100
    v_mov_b32 v125, v101
    v_mov_b32 v126, v102
    v_mov_b32 v127, v103
    v_mov_b32_dpp v124, v102 row_ror:8 row_mask:0xf bank_mask:0xc
    v_mov_b32_dpp v125, v103 row_ror:8 row_mask:0xf bank_mask:0xc
    v_mov_b32_dpp v126, v100 row_ror:8 row_mask:0xf bank_mask:0x3
    v_mov_b32_dpp v127, v101 row_ror:8 row_mask:0xf bank_mask:0x3
    s_add_u32 s26, s25, 14336
    buffer_store_dwordx4 v[124:127], v23, s[28:31], s26 offen sc1
    s_waitcnt vmcnt(19)
    v_dot2_f32_bf16 v12, v104, v20, v12
    v_dot2_f32_bf16 v13, v104, v104, v13
    v_dot2_f32_bf16 v12, v105, v20, v12
    v_dot2_f32_bf16 v13, v105, v105, v13
    v_dot2_f32_bf16 v12, v106, v20, v12
    v_dot2_f32_bf16 v13, v106, v106, v13
    v_dot2_f32_bf16 v12, v107, v20, v12
    v_dot2_f32_bf16 v13, v107, v107, v13
    v_mov_b32 v120, v104
    v_mov_b32 v121, v105
    v_mov_b32 v122, v106
    v_mov_b32 v123, v107
    v_mov_b32_dpp v120, v106 row_ror:8 row_mask:0xf bank_mask:0xc
    v_mov_b32_dpp v121, v107 row_ror:8 row_mask:0xf bank_mask:0xc
    v_mov_b32_dpp v122, v104 row_ror:8 row_mask:0xf bank_mask:0x3
    v_mov_b32_dpp v123, v105 row_ror:8 row_mask:0xf bank_mask:0x3
    s_add_u32 s26, s25, 16384
    buffer_store_dwordx4 v[120:123], v23, s[28:31], s26 offen sc1
    s_waitcnt vmcnt(19)
    v_dot2_f32_bf16 v12, v108, v20, v12
    v_dot2_f32_bf16 v13, v108, v108, v13
    v_dot2_f32_bf16 v12, v109, v20, v12
    v_dot2_f32_bf16 v13, v109, v109, v13
    v_dot2_f32_bf16 v12, v110, v20, v12
    v_dot2_f32_bf16 v13, v110, v110, v13
    v_dot2_f32_bf16 v12, v111, v20, v12
    v_dot2_f32_bf16 v13, v111, v111, v13
    v_mov_b32 v124, v108
    v_mov_b32 v125, v109
    v_mov_b32 v126, v110
    v_mov_b32 v127, v111
    v_mov_b32_dpp v124, v110 row_ror:8 row_mask:0xf bank_mask:0xc
    v_mov_b32_dpp v125, v111 row_ror:8 row_mask:0xf bank_mask:0xc
    v_mov_b32_dpp v126, v108 row_ror:8 row_mask:0xf bank_mask:0x3
    v_mov_b32_dpp v127, v109 row_ror:8 row_mask:0xf bank_mask:0x3
    s_add_u32 s26, s25, 18432
    buffer_store_dwordx4 v[124:127], v23, s[28:31], s26 offen sc1
    s_nop 2
    v_add_f32_dpp v10, v10, v10 quad_perm:[1,0,3,2] row_mask:0xf bank_mask:0xf
    v_add_f32_dpp v11, v11, v11 quad_perm:[1,0,3,2] row_mask:0xf bank_mask:0xf
    v_add_f32_dpp v12, v12, v12 quad_perm:[1,0,3,2] row_mask:0xf bank_mask:0xf
    v_add_f32_dpp v13, v13, v13 quad_perm:[1,0,3,2] row_mask:0xf bank_mask:0xf
    v_add_f32_dpp v10, v10, v10 quad_perm:[2,3,0,1] row_mask:0xf bank_mask:0xf
    v_add_f32_dpp v11, v11, v11 quad_perm:[2,3,0,1] row_mask:0xf bank_mask:0xf
    v_add_f32_dpp v12, v12, v12 quad_perm:[2,3,0,1] row_mask:0xf bank_mask:0xf
    v_add_f32_dpp v13, v13, v13 quad_perm:[2,3,0,1] row_mask:0xf bank_mask:0xf
    v_add_f32_dpp v10, v10, v10 row_half_mirror row_mask:0xf bank_mask:0xf
    v_add_f32_dpp v11, v11, v11 row_half_mirror row_mask:0xf bank_mask:0xf
    v_add_f32_dpp v12, v12, v12 row_half_mirror row_mask:0xf bank_mask:0xf
    v_add_f32_dpp v13, v13, v13 row_half_mirror row_mask:0xf bank_mask:0xf
    v_mul_f32 v10, 0x3acccccd, v10
    v_mul_f32 v12, 0x3acccccd, v12
    v_mul_f32 v11, 0x3acccccd, v11
    v_mul_f32 v13, 0x3acccccd, v13
    v_fma_f32 v11, -v10, v10, v11
    v_fma_f32 v13, -v12, v12, v13
    v_max_f32 v11, 0, v11
    v_max_f32 v13, 0, v13
    v_cvt_pk_bf16_f32 v24, v10, v11
    v_cvt_pk_bf16_f32 v25, v12, v13
    v_lshlrev_b32 v10, 16, v24
    v_lshlrev_b32 v12, 16, v25
    v_and_b32 v11, 0xffff0000, v24
    v_and_b32 v13, 0xffff0000, v25
    v_add_f32 v11, 0x3727c5ac, v11
    v_add_f32 v13, 0x3727c5ac, v13
    v_cvt_pk_bf16_f32 v24, v11, v11
    v_cvt_pk_bf16_f32 v25, v13, v13
    v_lshlrev_b32 v11, 16, v24
    v_lshlrev_b32 v13, 16, v25
    v_sqrt_f32 v11, v11
    v_sqrt_f32 v13, v13
    s_nop 0
    s_nop 0
    v_cvt_pk_bf16_f32 v24, v11, v11
    v_cvt_pk_bf16_f32 v25, v13, v13
    v_lshlrev_b32 v11, 16, v24
    v_lshlrev_b32 v13, 16, v25
    v_rcp_f32 v11, v11
    v_rcp_f32 v13, v13
    s_nop 0
    s_nop 0
    v_mul_f32 v10, v10, v11
    v_mul_f32 v12, v12, v13
    v_sub_f32 v10, 0, v10
    v_sub_f32 v12, 0, v12
    v_lshlrev_b32 v7, 3, v7
    v_cmp_eq_u32 vcc, 0, v6
    s_lshl_b32 s44, s21, 7
    s_add_u32 s44, s44, 29683712
    s_mov_b32 s23, 5476352
    s_and_saveexec_b64 s[66:67], vcc
    buffer_store_dwordx2 v[10:11], v7, s[28:31], s23 offen offset:0 sc1
    buffer_store_dwordx2 v[12:13], v7, s[28:31], s23 offen offset:64 sc1
    s_mov_b64 exec, -1
    s_waitcnt vmcnt(0)
    s_mov_b32 s47, 0
prep_kernel_nn10:
    v_readfirstlane_b32 s46, v250
    s_add_u32 s47, s47, 1
    s_cmp_lg_u32 s46, 0
    s_cbranch_scc1 prep_kernel_nd11
    s_cmp_ge_u32 s47, 200000
    s_cbranch_scc1 prep_kernel_nd11
    buffer_load_dword v250, v251, s[48:51], 0 offen sc1
    s_waitcnt vmcnt(0)
    s_branch prep_kernel_nn10
prep_kernel_nd11:
    v_mov_b32 v30, s46
    v_mov_b32 v31, 0
    s_mov_b64 exec, 1
    buffer_store_dword v30, v31, s[28:31], s44 offen sc1
    s_endpgm
p_misc:
    s_sub_u32 s24, s20, 3
    s_mul_i32 s23, s24, 96
    s_add_u32 s23, s23, s21
    s_cmp_ge_u32 s23, 256
    s_cbranch_scc1 prep_end
    s_mul_i32 s22, s24, 12
    s_lshr_b32 s25, s21, 3
    s_add_u32 s22, s22, s25
    v_lshlrev_b32 v1, 4, v1
    v_mov_b32 v60, 0
    v_mov_b32 v61, 0
    v_mov_b32 v62, 0
    v_mov_b32 v63, 0
    s_lshl_b32 s24, s23, 10
    s_add_u32 s25, s24, 29380608
    s_add_u32 s26, s24, 10784768
    s_add_u32 s27, s24, 13365248
    s_cmp_ge_u32 s23, 20
    s_cselect_b32 s26, s27, s26
    s_cmp_ge_u32 s23, 256
    s_cbranch_scc1 prep_kernel_nz12
    buffer_store_dwordx4 v[60:63], v1, s[28:31], s25 offen sc1
prep_kernel_nz12:
    s_cmp_ge_u32 s23, 40
    s_cbranch_scc1 prep_kernel_nz13
    buffer_store_dwordx4 v[60:63], v1, s[28:31], s26 offen sc1
prep_kernel_nz13:
    s_getpc_b64 s[24:25]
p_pcref:
    s_sub_u32 s24, s24, p_pcref-prep_kernel
    s_subb_u32 s25, s25, 0
    s_lshl_b32 s23, s22, 11
    s_add_u32 s26, s23, 0
    s_min_u32 s26, s26, (chain_end-prep_kernel-1020)&0xfffffff0
    v_add_u32 v64, s26, v1
    v_mov_b32 v5, s25
    v_add_co_u32 v4, vcc, s24, v64
    v_addc_co_u32 v5, vcc, 0, v5, vcc
    global_load_dwordx4 v[72:75], v[4:5], off
    s_add_u32 s26, s23, 1024
    s_min_u32 s26, s26, (chain_end-prep_kernel-1020)&0xfffffff0
    v_add_u32 v64, s26, v1
    v_mov_b32 v5, s25
    v_add_co_u32 v4, vcc, s24, v64
    v_addc_co_u32 v5, vcc, 0, v5, vcc
    global_load_dwordx4 v[76:79], v[4:5], off
    s_waitcnt vmcnt(0)
    s_endpgm
p_conv:
    s_and_b32 s21, s2, 7
    s_mul_i32 s21, s21, 20
    s_sub_u32 s2, s2, 256
    s_lshr_b32 s2, s2, 3
    s_add_u32 s2, s2, s21
    s_and_b32 s19, s20, 3
    s_mov_b32 s24, s56
    s_mov_b32 s25, s57
    s_mov_b32 s26, 2621440
    s_mov_b32 s27, 0x00020000
    s_lshl_b32 s21, s2, 3
    s_add_u32 s22, s58, s21
    s_addc_u32 s23, s59, 0
    s_load_dwordx2 s[32:33], s[22:23], 0
    s_lshl_b32 s21, s2, 2
    s_add_u32 s21, s21, s19
    s_mul_i32 s34, s19, 13824
    v_lshlrev_b32 v3, 4, v1
    s_lshl_b32 s35, s21, 12
    s_mul_i32 s37, s21, 4352
    s_add_u32 s37, s37, 0
    v_lshrrev_b32 v4, 3, v0
    v_mul_u32_u24 v4, 20480, v4
    s_lshr_b32 s38, s2, 1
    s_and_b32 s38, s38, 7
    v_and_b32 v5, 7, v0
    v_xor_b32 v5, s38, v5
    v_lshl_add_u32 v4, v5, 4, v4
    s_lshl_b32 s38, s2, 7
    v_lshl_add_u32 v5, v1, 2, s34
    v_mov_b32 v6, 0
    v_and_b32 v7, 15, v1
    v_bfe_u32 v8, v1, 4, 1
    v_lshrrev_b32 v9, 5, v1
    v_and_b32 v14, 31, v1
    v_lshlrev_b32 v14, 3, v14
    v_lshl_add_u32 v14, v9, 4, v14
    v_add_u32 v14, s34, v14
    v_and_b32 v17, 1, v1
    v_mul_u32_u24 v17, 9464, v17
    v_sub_u32 v17, 9472, v17
    v_add_u32 v14, v17, v14
    s_cmp_ge_u32 s20, 4
    s_cbranch_scc1 p_convP
    s_add_u32 s36, s34, 256
    s_mov_b32 m0, s36
    ds_write_b32 v5, v6
    buffer_load_dwordx4 v3, s[24:27], s35 offen offset:0 nt lds
    buffer_load_dwordx4 v3, s[24:27], s35 offen offset:1024 nt lds
    buffer_load_dwordx4 v3, s[24:27], s35 offen offset:2048 nt lds
    buffer_load_dwordx4 v3, s[24:27], s35 offen offset:3072 nt lds
    v_mul_u32_u24 v10, 272, v7
    v_lshl_add_u32 v10, v9, 4, v10
    v_add_u32 v10, s34, v10
    v_add_u32 v10, 4356, v10
    v_lshlrev_b32 v11, 2, v8
    v_sub_u32 v10, v10, v11
    s_cmp_lg_u32 s20, 0
    s_cbranch_scc1 prep_kernel_w014
    v_mov_b32 v16, 0
    buffer_load_dword v17, v16, s[48:51], 0 offen sc1
    s_waitcnt vmcnt(0)
    s_mov_b32 s47, 0
prep_kernel_nn15:
    v_readfirstlane_b32 s46, v17
    s_add_u32 s47, s47, 1
    s_cmp_lg_u32 s46, 0
    s_cbranch_scc1 prep_kernel_nd16
    s_cmp_ge_u32 s47, 200000
    s_cbranch_scc1 prep_kernel_nd16
    buffer_load_dword v17, v16, s[48:51], 0 offen sc1
    s_waitcnt vmcnt(0)
    s_branch prep_kernel_nn15
prep_kernel_nd16:
    s_lshr_b32 s40, s2, 4
    s_lshl_b32 s40, s40, 12
    s_add_u32 s40, s40, 29642752
    v_lshlrev_b32 v16, 7, v1
    s_mov_b32 s47, 0
    s_mov_b32 exec_lo, -1
    s_mov_b32 exec_hi, 0
prep_kernel_pl17:
    buffer_load_dword v17, v16, s[28:31], s40 offen sc1
    s_add_u32 s47, s47, 1
    s_waitcnt vmcnt(0)
    v_cmp_ne_u32 vcc, s46, v17
    s_cmp_ge_u32 s47, 200000
    s_cbranch_scc1 prep_kernel_pd18
    s_cbranch_vccz prep_kernel_pd18
    s_sleep 14
    s_branch prep_kernel_pl17
prep_kernel_pd18:
    s_mov_b64 exec, -1
prep_kernel_w014:
    s_barrier
    s_add_u32 s36, s34, 4352
    s_mov_b32 m0, s36
    s_nop 0
    buffer_load_dwordx4 v3, s[28:31], s37 offen offset:0 sc1 lds
    buffer_load_dwordx4 v3, s[28:31], s37 offen offset:1024 sc1 lds
    buffer_load_dwordx4 v3, s[28:31], s37 offen offset:2048 sc1 lds
    buffer_load_dwordx4 v3, s[28:31], s37 offen offset:3072 sc1 lds
    s_add_u32 s36, s34, 8448
    s_mov_b32 m0, s36
    s_add_u32 s37, s37, 4096
    buffer_load_dwordx4 v3, s[28:31], s37 offen sc1 lds
    s_waitcnt vmcnt(0) lgkmcnt(0)
    s_barrier
    ds_read2_b32 v[64:65], v10 offset0:0 offset1:1
    ds_read2_b32 v[66:67], v10 offset0:2 offset1:3
    ds_read2_b32 v[68:69], v10 offset0:8 offset1:9
    ds_read2_b32 v[70:71], v10 offset0:10 offset1:11
    ds_read2_b32 v[72:73], v10 offset0:16 offset1:17
    ds_read2_b32 v[74:75], v10 offset0:18 offset1:19
    ds_read2_b32 v[76:77], v10 offset0:24 offset1:25
    ds_read2_b32 v[78:79], v10 offset0:26 offset1:27
    ds_read2_b32 v[80:81], v10 offset0:32 offset1:33
    ds_read2_b32 v[82:83], v10 offset0:34 offset1:35
    ds_read2_b32 v[84:85], v10 offset0:40 offset1:41
    ds_read2_b32 v[86:87], v10 offset0:42 offset1:43
    ds_read2_b32 v[88:89], v10 offset0:48 offset1:49
    ds_read2_b32 v[90:91], v10 offset0:50 offset1:51
    ds_read2_b32 v[92:93], v10 offset0:56 offset1:57
    ds_read2_b32 v[94:95], v10 offset0:58 offset1:59
    ds_read_b32 v16, v10 offset:16
    ds_read_b32 v17, v10 offset:48
    ds_read_b32 v18, v10 offset:80
    ds_read_b32 v19, v10 offset:112
    ds_read_b32 v20, v10 offset:144
    ds_read_b32 v21, v10 offset:176
    ds_read_b32 v22, v10 offset:208
    ds_read_b32 v23, v10 offset:240
    s_waitcnt lgkmcnt(8)
    ds_read_b128 v[208:211], v14 offset:1792
    ds_read_b128 v[212:215], v14 offset:1824
    ds_read_b128 v[216:219], v14 offset:1856
    ds_read_b128 v[220:223], v14 offset:1888
    ds_read_b128 v[224:227], v14 offset:1920
    ds_read_b128 v[228:231], v14 offset:1952
    ds_read_b128 v[232:235], v14 offset:1984
    ds_read_b128 v[236:239], v14 offset:2016
    s_waitcnt lgkmcnt(0)
    v_mfma_f32_32x32x16_bf16 v[144:159], v[208:211], v[64:67], 0
    v_alignbit_b32 v32, v65, v64, 16
    v_alignbit_b32 v33, v66, v65, 16
    v_alignbit_b32 v34, v67, v66, 16
    v_alignbit_b32 v35, v16, v67, 16
    v_mfma_f32_32x32x16_bf16 v[144:159], v[212:215], v[68:71], v[144:159]
    v_alignbit_b32 v36, v69, v68, 16
    v_alignbit_b32 v37, v70, v69, 16
    v_alignbit_b32 v38, v71, v70, 16
    v_alignbit_b32 v39, v17, v71, 16
    v_mfma_f32_32x32x16_bf16 v[144:159], v[216:219], v[72:75], v[144:159]
    v_alignbit_b32 v40, v73, v72, 16
    v_alignbit_b32 v41, v74, v73, 16
    v_alignbit_b32 v42, v75, v74, 16
    v_alignbit_b32 v43, v18, v75, 16
    v_mfma_f32_32x32x16_bf16 v[144:159], v[220:223], v[76:79], v[144:159]
    v_alignbit_b32 v44, v77, v76, 16
    v_alignbit_b32 v45, v78, v77, 16
    v_alignbit_b32 v46, v79, v78, 16
    v_alignbit_b32 v47, v19, v79, 16
    v_mfma_f32_32x32x16_bf16 v[144:159], v[224:227], v[80:83], v[144:159]
    v_alignbit_b32 v48, v81, v80, 16
    v_alignbit_b32 v49, v82, v81, 16
    v_alignbit_b32 v50, v83, v82, 16
    v_alignbit_b32 v51, v20, v83, 16
    v_mfma_f32_32x32x16_bf16 v[144:159], v[228:231], v[84:87], v[144:159]
    v_alignbit_b32 v52, v85, v84, 16
    v_alignbit_b32 v53, v86, v85, 16
    v_alignbit_b32 v54, v87, v86, 16
    v_alignbit_b32 v55, v21, v87, 16
    v_mfma_f32_32x32x16_bf16 v[144:159], v[232:235], v[88:91], v[144:159]
    v_alignbit_b32 v56, v89, v88, 16
    v_alignbit_b32 v57, v90, v89, 16
    v_alignbit_b32 v58, v91, v90, 16
    v_alignbit_b32 v59, v22, v91, 16
    v_mfma_f32_32x32x16_bf16 v[144:159], v[236:239], v[92:95], v[144:159]
    v_alignbit_b32 v60, v93, v92, 16
    v_alignbit_b32 v61, v94, v93, 16
    v_alignbit_b32 v62, v95, v94, 16
    v_alignbit_b32 v63, v23, v95, 16
    s_nop 1
    v_mfma_f32_32x32x16_bf16 v[128:143], v[208:211], v[32:35], 0
    ds_read_b128 v[176:179], v14 offset:1536
    ds_read_b128 v[180:183], v14 offset:1568
    s_nop 2
    v_mfma_f32_32x32x16_bf16 v[128:143], v[212:215], v[36:39], v[128:143]
    ds_read_b128 v[184:187], v14 offset:1600
    ds_read_b128 v[188:191], v14 offset:1632
    s_nop 2
    v_mfma_f32_32x32x16_bf16 v[128:143], v[216:219], v[40:43], v[128:143]
    ds_read_b128 v[192:195], v14 offset:1664
    v_mov_b32_dpp v144, v144 row_shr:1 row_mask:0xf bank_mask:0xf bound_ctrl:0
    v_mov_b32_dpp v145, v145 row_shr:1 row_mask:0xf bank_mask:0xf bound_ctrl:0
    v_mov_b32_dpp v146, v146 row_shr:1 row_mask:0xf bank_mask:0xf bound_ctrl:0
    v_mfma_f32_32x32x16_bf16 v[128:143], v[220:223], v[44:47], v[128:143]
    ds_read_b128 v[196:199], v14 offset:1696
    v_mov_b32_dpp v147, v147 row_shr:1 row_mask:0xf bank_mask:0xf bound_ctrl:0
    v_mov_b32_dpp v148, v148 row_shr:1 row_mask:0xf bank_mask:0xf bound_ctrl:0
    v_mov_b32_dpp v149, v149 row_shr:1 row_mask:0xf bank_mask:0xf bound_ctrl:0
    v_mfma_f32_32x32x16_bf16 v[128:143], v[224:227], v[48:51], v[128:143]
    ds_read_b128 v[200:203], v14 offset:1728
    v_mov_b32_dpp v150, v150 row_shr:1 row_mask:0xf bank_mask:0xf bound_ctrl:0
    v_mov_b32_dpp v151, v151 row_shr:1 row_mask:0xf bank_mask:0xf bound_ctrl:0
    v_mov_b32_dpp v152, v152 row_shr:1 row_mask:0xf bank_mask:0xf bound_ctrl:0
    v_mfma_f32_32x32x16_bf16 v[128:143], v[228:231], v[52:55], v[128:143]
    ds_read_b128 v[204:207], v14 offset:1760
    v_mov_b32_dpp v153, v153 row_shr:1 row_mask:0xf bank_mask:0xf bound_ctrl:0
    v_mov_b32_dpp v154, v154 row_shr:1 row_mask:0xf bank_mask:0xf bound_ctrl:0
    v_mov_b32_dpp v155, v155 row_shr:1 row_mask:0xf bank_mask:0xf bound_ctrl:0
    v_mfma_f32_32x32x16_bf16 v[128:143], v[232:235], v[56:59], v[128:143]
    v_mov_b32_dpp v156, v156 row_shr:1 row_mask:0xf bank_mask:0xf bound_ctrl:0
    v_mov_b32_dpp v157, v157 row_shr:1 row_mask:0xf bank_mask:0xf bound_ctrl:0
    v_mfma_f32_32x32x16_bf16 v[128:143], v[236:239], v[60:63], v[128:143]
    v_mov_b32_dpp v158, v158 row_shr:1 row_mask:0xf bank_mask:0xf bound_ctrl:0
    v_mov_b32_dpp v159, v159 row_shr:1 row_mask:0xf bank_mask:0xf bound_ctrl:0
    s_waitcnt lgkmcnt(0)
    s_nop 0
    v_mfma_f32_32x32x16_bf16 v[144:159], v[176:179], v[64:67], v[144:159]
    s_nop 4
    v_mfma_f32_32x32x16_bf16 v[144:159], v[180:183], v[68:71], v[144:159]
    s_nop 4
    v_mfma_f32_32x32x16_bf16 v[144:159], v[184:187], v[72:75], v[144:159]
    v_mov_b32_dpp v128, v128 row_shr:1 row_mask:0xf bank_mask:0xf bound_ctrl:0
    v_mov_b32_dpp v129, v129 row_shr:1 row_mask:0xf bank_mask:0xf bound_ctrl:0
    v_mov_b32_dpp v130, v130 row_shr:1 row_mask:0xf bank_mask:0xf bound_ctrl:0
    v_mfma_f32_32x32x16_bf16 v[144:159], v[188:191], v[76:79], v[144:159]
    v_mov_b32_dpp v131, v131 row_shr:1 row_mask:0xf bank_mask:0xf bound_ctrl:0
    v_mov_b32_dpp v132, v132 row_shr:1 row_mask:0xf bank_mask:0xf bound_ctrl:0
    v_mov_b32_dpp v133, v133 row_shr:1 row_mask:0xf bank_mask:0xf bound_ctrl:0
    v_mfma_f32_32x32x16_bf16 v[144:159], v[192:195], v[80:83], v[144:159]
    v_mov_b32_dpp v134, v134 row_shr:1 row_mask:0xf bank_mask:0xf bound_ctrl:0
    v_mov_b32_dpp v135, v135 row_shr:1 row_mask:0xf bank_mask:0xf bound_ctrl:0
    v_mov_b32_dpp v136, v136 row_shr:1 row_mask:0xf bank_mask:0xf bound_ctrl:0
    v_mfma_f32_32x32x16_bf16 v[144:159], v[196:199], v[84:87], v[144:159]
    v_mov_b32_dpp v137, v137 row_shr:1 row_mask:0xf bank_mask:0xf bound_ctrl:0
    v_mov_b32_dpp v138, v138 row_shr:1 row_mask:0xf bank_mask:0xf bound_ctrl:0
    v_mov_b32_dpp v139, v139 row_shr:1 row_mask:0xf bank_mask:0xf bound_ctrl:0
    v_mfma_f32_32x32x16_bf16 v[144:159], v[200:203], v[88:91], v[144:159]
    v_mov_b32_dpp v140, v140 row_shr:1 row_mask:0xf bank_mask:0xf bound_ctrl:0
    v_mov_b32_dpp v141, v141 row_shr:1 row_mask:0xf bank_mask:0xf bound_ctrl:0
    v_mfma_f32_32x32x16_bf16 v[144:159], v[204:207], v[92:95], v[144:159]
    v_mov_b32_dpp v142, v142 row_shr:1 row_mask:0xf bank_mask:0xf bound_ctrl:0
    v_mov_b32_dpp v143, v143 row_shr:1 row_mask:0xf bank_mask:0xf bound_ctrl:0
    s_nop 1
    v_mfma_f32_32x32x16_bf16 v[128:143], v[176:179], v[32:35], v[128:143]
    ds_read_b128 v[208:211], v14 offset:1280
    ds_read_b128 v[212:215], v14 offset:1312
    s_nop 2
    v_mfma_f32_32x32x16_bf16 v[128:143], v[180:183], v[36:39], v[128:143]
    ds_read_b128 v[216:219], v14 offset:1344
    ds_read_b128 v[220:223], v14 offset:1376
    s_nop 2
    v_mfma_f32_32x32x16_bf16 v[128:143], v[184:187], v[40:43], v[128:143]
    ds_read_b128 v[224:227], v14 offset:1408
    v_mov_b32_dpp v144, v144 row_shr:1 row_mask:0xf bank_mask:0xf bound_ctrl:0
    v_mov_b32_dpp v145, v145 row_shr:1 row_mask:0xf bank_mask:0xf bound_ctrl:0
    v_mov_b32_dpp v146, v146 row_shr:1 row_mask:0xf bank_mask:0xf bound_ctrl:0
    v_mfma_f32_32x32x16_bf16 v[128:143], v[188:191], v[44:47], v[128:143]
    ds_read_b128 v[228:231], v14 offset:1440
    v_mov_b32_dpp v147, v147 row_shr:1 row_mask:0xf bank_mask:0xf bound_ctrl:0
    v_mov_b32_dpp v148, v148 row_shr:1 row_mask:0xf bank_mask:0xf bound_ctrl:0
    v_mov_b32_dpp v149, v149 row_shr:1 row_mask:0xf bank_mask:0xf bound_ctrl:0
    v_mfma_f32_32x32x16_bf16 v[128:143], v[192:195], v[48:51], v[128:143]
    ds_read_b128 v[232:235], v14 offset:1472
    v_mov_b32_dpp v150, v150 row_shr:1 row_mask:0xf bank_mask:0xf bound_ctrl:0
    v_mov_b32_dpp v151, v151 row_shr:1 row_mask:0xf bank_mask:0xf bound_ctrl:0
    v_mov_b32_dpp v152, v152 row_shr:1 row_mask:0xf bank_mask:0xf bound_ctrl:0
    v_mfma_f32_32x32x16_bf16 v[128:143], v[196:199], v[52:55], v[128:143]
    ds_read_b128 v[236:239], v14 offset:1504
    v_mov_b32_dpp v153, v153 row_shr:1 row_mask:0xf bank_mask:0xf bound_ctrl:0
    v_mov_b32_dpp v154, v154 row_shr:1 row_mask:0xf bank_mask:0xf bound_ctrl:0
    v_mov_b32_dpp v155, v155 row_shr:1 row_mask:0xf bank_mask:0xf bound_ctrl:0
    v_mfma_f32_32x32x16_bf16 v[128:143], v[200:203], v[56:59], v[128:143]
    v_mov_b32_dpp v156, v156 row_shr:1 row_mask:0xf bank_mask:0xf bound_ctrl:0
    v_mov_b32_dpp v157, v157 row_shr:1 row_mask:0xf bank_mask:0xf bound_ctrl:0
    v_mfma_f32_32x32x16_bf16 v[128:143], v[204:207], v[60:63], v[128:143]
    v_mov_b32_dpp v158, v158 row_shr:1 row_mask:0xf bank_mask:0xf bound_ctrl:0
    v_mov_b32_dpp v159, v159 row_shr:1 row_mask:0xf bank_mask:0xf bound_ctrl:0
    s_waitcnt lgkmcnt(0)
    s_nop 0
    v_mfma_f32_32x32x16_bf16 v[144:159], v[208:211], v[64:67], v[144:159]
    s_nop 4
    v_mfma_f32_32x32x16_bf16 v[144:159], v[212:215], v[68:71], v[144:159]
    s_nop 4
    v_mfma_f32_32x32x16_bf16 v[144:159], v[216:219], v[72:75], v[144:159]
    v_mov_b32_dpp v128, v128 row_shr:1 row_mask:0xf bank_mask:0xf bound_ctrl:0
    v_mov_b32_dpp v129, v129 row_shr:1 row_mask:0xf bank_mask:0xf bound_ctrl:0
    v_mov_b32_dpp v130, v130 row_shr:1 row_mask:0xf bank_mask:0xf bound_ctrl:0
    v_mfma_f32_32x32x16_bf16 v[144:159], v[220:223], v[76:79], v[144:159]
    v_mov_b32_dpp v131, v131 row_shr:1 row_mask:0xf bank_mask:0xf bound_ctrl:0
    v_mov_b32_dpp v132, v132 row_shr:1 row_mask:0xf bank_mask:0xf bound_ctrl:0
    v_mov_b32_dpp v133, v133 row_shr:1 row_mask:0xf bank_mask:0xf bound_ctrl:0
    v_mfma_f32_32x32x16_bf16 v[144:159], v[224:227], v[80:83], v[144:159]
    v_mov_b32_dpp v134, v134 row_shr:1 row_mask:0xf bank_mask:0xf bound_ctrl:0
    v_mov_b32_dpp v135, v135 row_shr:1 row_mask:0xf bank_mask:0xf bound_ctrl:0
    v_mov_b32_dpp v136, v136 row_shr:1 row_mask:0xf bank_mask:0xf bound_ctrl:0
    v_mfma_f32_32x32x16_bf16 v[144:159], v[228:231], v[84:87], v[144:159]
    v_mov_b32_dpp v137, v137 row_shr:1 row_mask:0xf bank_mask:0xf bound_ctrl:0
    v_mov_b32_dpp v138, v138 row_shr:1 row_mask:0xf bank_mask:0xf bound_ctrl:0
    v_mov_b32_dpp v139, v139 row_shr:1 row_mask:0xf bank_mask:0xf bound_ctrl:0
    v_mfma_f32_32x32x16_bf16 v[144:159], v[232:235], v[88:91], v[144:159]
    v_mov_b32_dpp v140, v140 row_shr:1 row_mask:0xf bank_mask:0xf bound_ctrl:0
    v_mov_b32_dpp v141, v141 row_shr:1 row_mask:0xf bank_mask:0xf bound_ctrl:0
    v_mfma_f32_32x32x16_bf16 v[144:159], v[236:239], v[92:95], v[144:159]
    v_mov_b32_dpp v142, v142 row_shr:1 row_mask:0xf bank_mask:0xf bound_ctrl:0
    v_mov_b32_dpp v143, v143 row_shr:1 row_mask:0xf bank_mask:0xf bound_ctrl:0
    s_nop 1
    v_mfma_f32_32x32x16_bf16 v[128:143], v[208:211], v[32:35], v[128:143]
    ds_read_b128 v[176:179], v14 offset:1024
    ds_read_b128 v[180:183], v14 offset:1056
    s_nop 2
    v_mfma_f32_32x32x16_bf16 v[128:143], v[212:215], v[36:39], v[128:143]
    ds_read_b128 v[184:187], v14 offset:1088
    ds_read_b128 v[188:191], v14 offset:1120
    s_nop 2
    v_mfma_f32_32x32x16_bf16 v[128:143], v[216:219], v[40:43], v[128:143]
    ds_read_b128 v[192:195], v14 offset:1152
    v_mov_b32_dpp v144, v144 row_shr:1 row_mask:0xf bank_mask:0xf bound_ctrl:0
    v_mov_b32_dpp v145, v145 row_shr:1 row_mask:0xf bank_mask:0xf bound_ctrl:0
    v_mov_b32_dpp v146, v146 row_shr:1 row_mask:0xf bank_mask:0xf bound_ctrl:0
    v_mfma_f32_32x32x16_bf16 v[128:143], v[220:223], v[44:47], v[128:143]
    ds_read_b128 v[196:199], v14 offset:1184
    v_mov_b32_dpp v147, v147 row_shr:1 row_mask:0xf bank_mask:0xf bound_ctrl:0
    v_mov_b32_dpp v148, v148 row_shr:1 row_mask:0xf bank_mask:0xf bound_ctrl:0
    v_mov_b32_dpp v149, v149 row_shr:1 row_mask:0xf bank_mask:0xf bound_ctrl:0
    v_mfma_f32_32x32x16_bf16 v[128:143], v[224:227], v[48:51], v[128:143]
    ds_read_b128 v[200:203], v14 offset:1216
    v_mov_b32_dpp v150, v150 row_shr:1 row_mask:0xf bank_mask:0xf bound_ctrl:0
    v_mov_b32_dpp v151, v151 row_shr:1 row_mask:0xf bank_mask:0xf bound_ctrl:0
    v_mov_b32_dpp v152, v152 row_shr:1 row_mask:0xf bank_mask:0xf bound_ctrl:0
    v_mfma_f32_32x32x16_bf16 v[128:143], v[228:231], v[52:55], v[128:143]
    ds_read_b128 v[204:207], v14 offset:1248
    v_mov_b32_dpp v153, v153 row_shr:1 row_mask:0xf bank_mask:0xf bound_ctrl:0
    v_mov_b32_dpp v154, v154 row_shr:1 row_mask:0xf bank_mask:0xf bound_ctrl:0
    v_mov_b32_dpp v155, v155 row_shr:1 row_mask:0xf bank_mask:0xf bound_ctrl:0
    v_mfma_f32_32x32x16_bf16 v[128:143], v[232:235], v[56:59], v[128:143]
    v_mov_b32_dpp v156, v156 row_shr:1 row_mask:0xf bank_mask:0xf bound_ctrl:0
    v_mov_b32_dpp v157, v157 row_shr:1 row_mask:0xf bank_mask:0xf bound_ctrl:0
    v_mfma_f32_32x32x16_bf16 v[128:143], v[236:239], v[60:63], v[128:143]
    v_mov_b32_dpp v158, v158 row_shr:1 row_mask:0xf bank_mask:0xf bound_ctrl:0
    v_mov_b32_dpp v159, v159 row_shr:1 row_mask:0xf bank_mask:0xf bound_ctrl:0
    s_waitcnt lgkmcnt(0)
    s_nop 0
    v_mfma_f32_32x32x16_bf16 v[144:159], v[176:179], v[64:67], v[144:159]
    s_nop 4
    v_mfma_f32_32x32x16_bf16 v[144:159], v[180:183], v[68:71], v[144:159]
    s_nop 4
    v_mfma_f32_32x32x16_bf16 v[144:159], v[184:187], v[72:75], v[144:159]
    v_mov_b32_dpp v128, v128 row_shr:1 row_mask:0xf bank_mask:0xf bound_ctrl:0
    v_mov_b32_dpp v129, v129 row_shr:1 row_mask:0xf bank_mask:0xf bound_ctrl:0
    v_mov_b32_dpp v130, v130 row_shr:1 row_mask:0xf bank_mask:0xf bound_ctrl:0
    v_mfma_f32_32x32x16_bf16 v[144:159], v[188:191], v[76:79], v[144:159]
    v_mov_b32_dpp v131, v131 row_shr:1 row_mask:0xf bank_mask:0xf bound_ctrl:0
    v_mov_b32_dpp v132, v132 row_shr:1 row_mask:0xf bank_mask:0xf bound_ctrl:0
    v_mov_b32_dpp v133, v133 row_shr:1 row_mask:0xf bank_mask:0xf bound_ctrl:0
    v_mfma_f32_32x32x16_bf16 v[144:159], v[192:195], v[80:83], v[144:159]
    v_mov_b32_dpp v134, v134 row_shr:1 row_mask:0xf bank_mask:0xf bound_ctrl:0
    v_mov_b32_dpp v135, v135 row_shr:1 row_mask:0xf bank_mask:0xf bound_ctrl:0
    v_mov_b32_dpp v136, v136 row_shr:1 row_mask:0xf bank_mask:0xf bound_ctrl:0
    v_mfma_f32_32x32x16_bf16 v[144:159], v[196:199], v[84:87], v[144:159]
    v_mov_b32_dpp v137, v137 row_shr:1 row_mask:0xf bank_mask:0xf bound_ctrl:0
    v_mov_b32_dpp v138, v138 row_shr:1 row_mask:0xf bank_mask:0xf bound_ctrl:0
    v_mov_b32_dpp v139, v139 row_shr:1 row_mask:0xf bank_mask:0xf bound_ctrl:0
    v_mfma_f32_32x32x16_bf16 v[144:159], v[200:203], v[88:91], v[144:159]
    v_mov_b32_dpp v140, v140 row_shr:1 row_mask:0xf bank_mask:0xf bound_ctrl:0
    v_mov_b32_dpp v141, v141 row_shr:1 row_mask:0xf bank_mask:0xf bound_ctrl:0
    v_mfma_f32_32x32x16_bf16 v[144:159], v[204:207], v[92:95], v[144:159]
    v_mov_b32_dpp v142, v142 row_shr:1 row_mask:0xf bank_mask:0xf bound_ctrl:0
    v_mov_b32_dpp v143, v143 row_shr:1 row_mask:0xf bank_mask:0xf bound_ctrl:0
    s_nop 1
    v_mfma_f32_32x32x16_bf16 v[128:143], v[176:179], v[32:35], v[128:143]
    ds_read_b128 v[208:211], v14 offset:768
    ds_read_b128 v[212:215], v14 offset:800
    s_nop 2
    v_mfma_f32_32x32x16_bf16 v[128:143], v[180:183], v[36:39], v[128:143]
    ds_read_b128 v[216:219], v14 offset:832
    ds_read_b128 v[220:223], v14 offset:864
    s_nop 2
    v_mfma_f32_32x32x16_bf16 v[128:143], v[184:187], v[40:43], v[128:143]
    ds_read_b128 v[224:227], v14 offset:896
    v_mov_b32_dpp v144, v144 row_shr:1 row_mask:0xf bank_mask:0xf bound_ctrl:0
    v_mov_b32_dpp v145, v145 row_shr:1 row_mask:0xf bank_mask:0xf bound_ctrl:0
    v_mov_b32_dpp v146, v146 row_shr:1 row_mask:0xf bank_mask:0xf bound_ctrl:0
    v_mfma_f32_32x32x16_bf16 v[128:143], v[188:191], v[44:47], v[128:143]
    ds_read_b128 v[228:231], v14 offset:928
    v_mov_b32_dpp v147, v147 row_shr:1 row_mask:0xf bank_mask:0xf bound_ctrl:0
    v_mov_b32_dpp v148, v148 row_shr:1 row_mask:0xf bank_mask:0xf bound_ctrl:0
    v_mov_b32_dpp v149, v149 row_shr:1 row_mask:0xf bank_mask:0xf bound_ctrl:0
    v_mfma_f32_32x32x16_bf16 v[128:143], v[192:195], v[48:51], v[128:143]
    ds_read_b128 v[232:235], v14 offset:960
    v_mov_b32_dpp v150, v150 row_shr:1 row_mask:0xf bank_mask:0xf bound_ctrl:0
    v_mov_b32_dpp v151, v151 row_shr:1 row_mask:0xf bank_mask:0xf bound_ctrl:0
    v_mov_b32_dpp v152, v152 row_shr:1 row_mask:0xf bank_mask:0xf bound_ctrl:0
    v_mfma_f32_32x32x16_bf16 v[128:143], v[196:199], v[52:55], v[128:143]
    ds_read_b128 v[236:239], v14 offset:992
    v_mov_b32_dpp v153, v153 row_shr:1 row_mask:0xf bank_mask:0xf bound_ctrl:0
    v_mov_b32_dpp v154, v154 row_shr:1 row_mask:0xf bank_mask:0xf bound_ctrl:0
    v_mov_b32_dpp v155, v155 row_shr:1 row_mask:0xf bank_mask:0xf bound_ctrl:0
    v_mfma_f32_32x32x16_bf16 v[128:143], v[200:203], v[56:59], v[128:143]
    v_mov_b32_dpp v156, v156 row_shr:1 row_mask:0xf bank_mask:0xf bound_ctrl:0
    v_mov_b32_dpp v157, v157 row_shr:1 row_mask:0xf bank_mask:0xf bound_ctrl:0
    v_mfma_f32_32x32x16_bf16 v[128:143], v[204:207], v[60:63], v[128:143]
    v_mov_b32_dpp v158, v158 row_shr:1 row_mask:0xf bank_mask:0xf bound_ctrl:0
    v_mov_b32_dpp v159, v159 row_shr:1 row_mask:0xf bank_mask:0xf bound_ctrl:0
    s_waitcnt lgkmcnt(0)
    s_nop 0
    v_mfma_f32_32x32x16_bf16 v[144:159], v[208:211], v[64:67], v[144:159]
    s_nop 4
    v_mfma_f32_32x32x16_bf16 v[144:159], v[212:215], v[68:71], v[144:159]
    s_nop 4
    v_mfma_f32_32x32x16_bf16 v[144:159], v[216:219], v[72:75], v[144:159]
    v_mov_b32_dpp v128, v128 row_shr:1 row_mask:0xf bank_mask:0xf bound_ctrl:0
    v_mov_b32_dpp v129, v129 row_shr:1 row_mask:0xf bank_mask:0xf bound_ctrl:0
    v_mov_b32_dpp v130, v130 row_shr:1 row_mask:0xf bank_mask:0xf bound_ctrl:0
    v_mfma_f32_32x32x16_bf16 v[144:159], v[220:223], v[76:79], v[144:159]
    v_mov_b32_dpp v131, v131 row_shr:1 row_mask:0xf bank_mask:0xf bound_ctrl:0
    v_mov_b32_dpp v132, v132 row_shr:1 row_mask:0xf bank_mask:0xf bound_ctrl:0
    v_mov_b32_dpp v133, v133 row_shr:1 row_mask:0xf bank_mask:0xf bound_ctrl:0
    v_mfma_f32_32x32x16_bf16 v[144:159], v[224:227], v[80:83], v[144:159]
    v_mov_b32_dpp v134, v134 row_shr:1 row_mask:0xf bank_mask:0xf bound_ctrl:0
    v_mov_b32_dpp v135, v135 row_shr:1 row_mask:0xf bank_mask:0xf bound_ctrl:0
    v_mov_b32_dpp v136, v136 row_shr:1 row_mask:0xf bank_mask:0xf bound_ctrl:0
    v_mfma_f32_32x32x16_bf16 v[144:159], v[228:231], v[84:87], v[144:159]
    v_mov_b32_dpp v137, v137 row_shr:1 row_mask:0xf bank_mask:0xf bound_ctrl:0
    v_mov_b32_dpp v138, v138 row_shr:1 row_mask:0xf bank_mask:0xf bound_ctrl:0
    v_mov_b32_dpp v139, v139 row_shr:1 row_mask:0xf bank_mask:0xf bound_ctrl:0
    v_mfma_f32_32x32x16_bf16 v[144:159], v[232:235], v[88:91], v[144:159]
    v_mov_b32_dpp v140, v140 row_shr:1 row_mask:0xf bank_mask:0xf bound_ctrl:0
    v_mov_b32_dpp v141, v141 row_shr:1 row_mask:0xf bank_mask:0xf bound_ctrl:0
    v_mfma_f32_32x32x16_bf16 v[144:159], v[236:239], v[92:95], v[144:159]
    v_mov_b32_dpp v142, v142 row_shr:1 row_mask:0xf bank_mask:0xf bound_ctrl:0
    v_mov_b32_dpp v143, v143 row_shr:1 row_mask:0xf bank_mask:0xf bound_ctrl:0
    s_nop 1
    v_mfma_f32_32x32x16_bf16 v[128:143], v[208:211], v[32:35], v[128:143]
    ds_read_b128 v[176:179], v14 offset:512
    ds_read_b128 v[180:183], v14 offset:544
    s_nop 2
    v_mfma_f32_32x32x16_bf16 v[128:143], v[212:215], v[36:39], v[128:143]
    ds_read_b128 v[184:187], v14 offset:576
    ds_read_b128 v[188:191], v14 offset:608
    s_nop 2
    v_mfma_f32_32x32x16_bf16 v[128:143], v[216:219], v[40:43], v[128:143]
    ds_read_b128 v[192:195], v14 offset:640
    v_mov_b32_dpp v144, v144 row_shr:1 row_mask:0xf bank_mask:0xf bound_ctrl:0
    v_mov_b32_dpp v145, v145 row_shr:1 row_mask:0xf bank_mask:0xf bound_ctrl:0
    v_mov_b32_dpp v146, v146 row_shr:1 row_mask:0xf bank_mask:0xf bound_ctrl:0
    v_mfma_f32_32x32x16_bf16 v[128:143], v[220:223], v[44:47], v[128:143]
    ds_read_b128 v[196:199], v14 offset:672
    v_mov_b32_dpp v147, v147 row_shr:1 row_mask:0xf bank_mask:0xf bound_ctrl:0
    v_mov_b32_dpp v148, v148 row_shr:1 row_mask:0xf bank_mask:0xf bound_ctrl:0
    v_mov_b32_dpp v149, v149 row_shr:1 row_mask:0xf bank_mask:0xf bound_ctrl:0
    v_mfma_f32_32x32x16_bf16 v[128:143], v[224:227], v[48:51], v[128:143]
    ds_read_b128 v[200:203], v14 offset:704
    v_mov_b32_dpp v150, v150 row_shr:1 row_mask:0xf bank_mask:0xf bound_ctrl:0
    v_mov_b32_dpp v151, v151 row_shr:1 row_mask:0xf bank_mask:0xf bound_ctrl:0
    v_mov_b32_dpp v152, v152 row_shr:1 row_mask:0xf bank_mask:0xf bound_ctrl:0
    v_mfma_f32_32x32x16_bf16 v[128:143], v[228:231], v[52:55], v[128:143]
    ds_read_b128 v[204:207], v14 offset:736
    v_mov_b32_dpp v153, v153 row_shr:1 row_mask:0xf bank_mask:0xf bound_ctrl:0
    v_mov_b32_dpp v154, v154 row_shr:1 row_mask:0xf bank_mask:0xf bound_ctrl:0
    v_mov_b32_dpp v155, v155 row_shr:1 row_mask:0xf bank_mask:0xf bound_ctrl:0
    v_mfma_f32_32x32x16_bf16 v[128:143], v[232:235], v[56:59], v[128:143]
    v_mov_b32_dpp v156, v156 row_shr:1 row_mask:0xf bank_mask:0xf bound_ctrl:0
    v_mov_b32_dpp v157, v157 row_shr:1 row_mask:0xf bank_mask:0xf bound_ctrl:0
    v_mfma_f32_32x32x16_bf16 v[128:143], v[236:239], v[60:63], v[128:143]
    v_mov_b32_dpp v158, v158 row_shr:1 row_mask:0xf bank_mask:0xf bound_ctrl:0
    v_mov_b32_dpp v159, v159 row_shr:1 row_mask:0xf bank_mask:0xf bound_ctrl:0
    s_waitcnt lgkmcnt(0)
    s_nop 0
    v_mfma_f32_32x32x16_bf16 v[144:159], v[176:179], v[64:67], v[144:159]
    s_nop 4
    v_mfma_f32_32x32x16_bf16 v[144:159], v[180:183], v[68:71], v[144:159]
    s_nop 4
    v_mfma_f32_32x32x16_bf16 v[144:159], v[184:187], v[72:75], v[144:159]
    v_mov_b32_dpp v128, v128 row_shr:1 row_mask:0xf bank_mask:0xf bound_ctrl:0
    v_mov_b32_dpp v129, v129 row_shr:1 row_mask:0xf bank_mask:0xf bound_ctrl:0
    v_mov_b32_dpp v130, v130 row_shr:1 row_mask:0xf bank_mask:0xf bound_ctrl:0
    v_mfma_f32_32x32x16_bf16 v[144:159], v[188:191], v[76:79], v[144:159]
    v_mov_b32_dpp v131, v131 row_shr:1 row_mask:0xf bank_mask:0xf bound_ctrl:0
    v_mov_b32_dpp v132, v132 row_shr:1 row_mask:0xf bank_mask:0xf bound_ctrl:0
    v_mov_b32_dpp v133, v133 row_shr:1 row_mask:0xf bank_mask:0xf bound_ctrl:0
    v_mfma_f32_32x32x16_bf16 v[144:159], v[192:195], v[80:83], v[144:159]
    v_mov_b32_dpp v134, v134 row_shr:1 row_mask:0xf bank_mask:0xf bound_ctrl:0
    v_mov_b32_dpp v135, v135 row_shr:1 row_mask:0xf bank_mask:0xf bound_ctrl:0
    v_mov_b32_dpp v136, v136 row_shr:1 row_mask:0xf bank_mask:0xf bound_ctrl:0
    v_mfma_f32_32x32x16_bf16 v[144:159], v[196:199], v[84:87], v[144:159]
    v_mov_b32_dpp v137, v137 row_shr:1 row_mask:0xf bank_mask:0xf bound_ctrl:0
    v_mov_b32_dpp v138, v138 row_shr:1 row_mask:0xf bank_mask:0xf bound_ctrl:0
    v_mov_b32_dpp v139, v139 row_shr:1 row_mask:0xf bank_mask:0xf bound_ctrl:0
    v_mfma_f32_32x32x16_bf16 v[144:159], v[200:203], v[88:91], v[144:159]
    v_mov_b32_dpp v140, v140 row_shr:1 row_mask:0xf bank_mask:0xf bound_ctrl:0
    v_mov_b32_dpp v141, v141 row_shr:1 row_mask:0xf bank_mask:0xf bound_ctrl:0
    v_mfma_f32_32x32x16_bf16 v[144:159], v[204:207], v[92:95], v[144:159]
    v_mov_b32_dpp v142, v142 row_shr:1 row_mask:0xf bank_mask:0xf bound_ctrl:0
    v_mov_b32_dpp v143, v143 row_shr:1 row_mask:0xf bank_mask:0xf bound_ctrl:0
    s_nop 1
    v_mfma_f32_32x32x16_bf16 v[128:143], v[176:179], v[32:35], v[128:143]
    ds_read_b128 v[208:211], v14 offset:256
    ds_read_b128 v[212:215], v14 offset:288
    s_nop 2
    v_mfma_f32_32x32x16_bf16 v[128:143], v[180:183], v[36:39], v[128:143]
    ds_read_b128 v[216:219], v14 offset:320
    ds_read_b128 v[220:223], v14 offset:352
    s_nop 2
    v_mfma_f32_32x32x16_bf16 v[128:143], v[184:187], v[40:43], v[128:143]
    ds_read_b128 v[224:227], v14 offset:384
    v_mov_b32_dpp v144, v144 row_shr:1 row_mask:0xf bank_mask:0xf bound_ctrl:0
    v_mov_b32_dpp v145, v145 row_shr:1 row_mask:0xf bank_mask:0xf bound_ctrl:0
    v_mov_b32_dpp v146, v146 row_shr:1 row_mask:0xf bank_mask:0xf bound_ctrl:0
    v_mfma_f32_32x32x16_bf16 v[128:143], v[188:191], v[44:47], v[128:143]
    ds_read_b128 v[228:231], v14 offset:416
    v_mov_b32_dpp v147, v147 row_shr:1 row_mask:0xf bank_mask:0xf bound_ctrl:0
    v_mov_b32_dpp v148, v148 row_shr:1 row_mask:0xf bank_mask:0xf bound_ctrl:0
    v_mov_b32_dpp v149, v149 row_shr:1 row_mask:0xf bank_mask:0xf bound_ctrl:0
    v_mfma_f32_32x32x16_bf16 v[128:143], v[192:195], v[48:51], v[128:143]
    ds_read_b128 v[232:235], v14 offset:448
    v_mov_b32_dpp v150, v150 row_shr:1 row_mask:0xf bank_mask:0xf bound_ctrl:0
    v_mov_b32_dpp v151, v151 row_shr:1 row_mask:0xf bank_mask:0xf bound_ctrl:0
    v_mov_b32_dpp v152, v152 row_shr:1 row_mask:0xf bank_mask:0xf bound_ctrl:0
    v_mfma_f32_32x32x16_bf16 v[128:143], v[196:199], v[52:55], v[128:143]
    ds_read_b128 v[236:239], v14 offset:480
    v_mov_b32_dpp v153, v153 row_shr:1 row_mask:0xf bank_mask:0xf bound_ctrl:0
    v_mov_b32_dpp v154, v154 row_shr:1 row_mask:0xf bank_mask:0xf bound_ctrl:0
    v_mov_b32_dpp v155, v155 row_shr:1 row_mask:0xf bank_mask:0xf bound_ctrl:0
    v_mfma_f32_32x32x16_bf16 v[128:143], v[200:203], v[56:59], v[128:143]
    v_mov_b32_dpp v156, v156 row_shr:1 row_mask:0xf bank_mask:0xf bound_ctrl:0
    v_mov_b32_dpp v157, v157 row_shr:1 row_mask:0xf bank_mask:0xf bound_ctrl:0
    v_mfma_f32_32x32x16_bf16 v[128:143], v[204:207], v[60:63], v[128:143]
    v_mov_b32_dpp v158, v158 row_shr:1 row_mask:0xf bank_mask:0xf bound_ctrl:0
    v_mov_b32_dpp v159, v159 row_shr:1 row_mask:0xf bank_mask:0xf bound_ctrl:0
    s_waitcnt lgkmcnt(0)
    s_nop 0
    v_mfma_f32_32x32x16_bf16 v[144:159], v[208:211], v[64:67], v[144:159]
    s_nop 4
    v_mfma_f32_32x32x16_bf16 v[144:159], v[212:215], v[68:71], v[144:159]
    s_nop 4
    v_mfma_f32_32x32x16_bf16 v[144:159], v[216:219], v[72:75], v[144:159]
    v_mov_b32_dpp v128, v128 row_shr:1 row_mask:0xf bank_mask:0xf bound_ctrl:0
    v_mov_b32_dpp v129, v129 row_shr:1 row_mask:0xf bank_mask:0xf bound_ctrl:0
    v_mov_b32_dpp v130, v130 row_shr:1 row_mask:0xf bank_mask:0xf bound_ctrl:0
    v_mfma_f32_32x32x16_bf16 v[144:159], v[220:223], v[76:79], v[144:159]
    v_mov_b32_dpp v131, v131 row_shr:1 row_mask:0xf bank_mask:0xf bound_ctrl:0
    v_mov_b32_dpp v132, v132 row_shr:1 row_mask:0xf bank_mask:0xf bound_ctrl:0
    v_mov_b32_dpp v133, v133 row_shr:1 row_mask:0xf bank_mask:0xf bound_ctrl:0
    v_mfma_f32_32x32x16_bf16 v[144:159], v[224:227], v[80:83], v[144:159]
    v_mov_b32_dpp v134, v134 row_shr:1 row_mask:0xf bank_mask:0xf bound_ctrl:0
    v_mov_b32_dpp v135, v135 row_shr:1 row_mask:0xf bank_mask:0xf bound_ctrl:0
    v_mov_b32_dpp v136, v136 row_shr:1 row_mask:0xf bank_mask:0xf bound_ctrl:0
    v_mfma_f32_32x32x16_bf16 v[144:159], v[228:231], v[84:87], v[144:159]
    v_mov_b32_dpp v137, v137 row_shr:1 row_mask:0xf bank_mask:0xf bound_ctrl:0
    v_mov_b32_dpp v138, v138 row_shr:1 row_mask:0xf bank_mask:0xf bound_ctrl:0
    v_mov_b32_dpp v139, v139 row_shr:1 row_mask:0xf bank_mask:0xf bound_ctrl:0
    v_mfma_f32_32x32x16_bf16 v[144:159], v[232:235], v[88:91], v[144:159]
    v_mov_b32_dpp v140, v140 row_shr:1 row_mask:0xf bank_mask:0xf bound_ctrl:0
    v_mov_b32_dpp v141, v141 row_shr:1 row_mask:0xf bank_mask:0xf bound_ctrl:0
    v_mfma_f32_32x32x16_bf16 v[144:159], v[236:239], v[92:95], v[144:159]
    v_mov_b32_dpp v142, v142 row_shr:1 row_mask:0xf bank_mask:0xf bound_ctrl:0
    v_mov_b32_dpp v143, v143 row_shr:1 row_mask:0xf bank_mask:0xf bound_ctrl:0
    s_nop 1
    v_mfma_f32_32x32x16_bf16 v[128:143], v[208:211], v[32:35], v[128:143]
    ds_read_b128 v[176:179], v14 offset:0
    ds_read_b128 v[180:183], v14 offset:32
    s_nop 2
    v_mfma_f32_32x32x16_bf16 v[128:143], v[212:215], v[36:39], v[128:143]
    ds_read_b128 v[184:187], v14 offset:64
    ds_read_b128 v[188:191], v14 offset:96
    s_nop 2
    v_mfma_f32_32x32x16_bf16 v[128:143], v[216:219], v[40:43], v[128:143]
    ds_read_b128 v[192:195], v14 offset:128
    v_mov_b32_dpp v144, v144 row_shr:1 row_mask:0xf bank_mask:0xf bound_ctrl:0
    v_mov_b32_dpp v145, v145 row_shr:1 row_mask:0xf bank_mask:0xf bound_ctrl:0
    v_mov_b32_dpp v146, v146 row_shr:1 row_mask:0xf bank_mask:0xf bound_ctrl:0
    v_mfma_f32_32x32x16_bf16 v[128:143], v[220:223], v[44:47], v[128:143]
    ds_read_b128 v[196:199], v14 offset:160
    v_mov_b32_dpp v147, v147 row_shr:1 row_mask:0xf bank_mask:0xf bound_ctrl:0
    v_mov_b32_dpp v148, v148 row_shr:1 row_mask:0xf bank_mask:0xf bound_ctrl:0
    v_mov_b32_dpp v149, v149 row_shr:1 row_mask:0xf bank_mask:0xf bound_ctrl:0
    v_mfma_f32_32x32x16_bf16 v[128:143], v[224:227], v[48:51], v[128:143]
    ds_read_b128 v[200:203], v14 offset:192
    v_mov_b32_dpp v150, v150 row_shr:1 row_mask:0xf bank_mask:0xf bound_ctrl:0
    v_mov_b32_dpp v151, v151 row_shr:1 row_mask:0xf bank_mask:0xf bound_ctrl:0
    v_mov_b32_dpp v152, v152 row_shr:1 row_mask:0xf bank_mask:0xf bound_ctrl:0
    v_mfma_f32_32x32x16_bf16 v[128:143], v[228:231], v[52:55], v[128:143]
    ds_read_b128 v[204:207], v14 offset:224
    v_mov_b32_dpp v153, v153 row_shr:1 row_mask:0xf bank_mask:0xf bound_ctrl:0
    v_mov_b32_dpp v154, v154 row_shr:1 row_mask:0xf bank_mask:0xf bound_ctrl:0
    v_mov_b32_dpp v155, v155 row_shr:1 row_mask:0xf bank_mask:0xf bound_ctrl:0
    v_mfma_f32_32x32x16_bf16 v[128:143], v[232:235], v[56:59], v[128:143]
    v_mov_b32_dpp v156, v156 row_shr:1 row_mask:0xf bank_mask:0xf bound_ctrl:0
    v_mov_b32_dpp v157, v157 row_shr:1 row_mask:0xf bank_mask:0xf bound_ctrl:0
    v_mfma_f32_32x32x16_bf16 v[128:143], v[236:239], v[60:63], v[128:143]
    v_mov_b32_dpp v158, v158 row_shr:1 row_mask:0xf bank_mask:0xf bound_ctrl:0
    v_mov_b32_dpp v159, v159 row_shr:1 row_mask:0xf bank_mask:0xf bound_ctrl:0
    s_waitcnt lgkmcnt(0)
    s_nop 0
    v_mfma_f32_32x32x16_bf16 v[144:159], v[176:179], v[64:67], v[144:159]
    s_nop 4
    v_mfma_f32_32x32x16_bf16 v[144:159], v[180:183], v[68:71], v[144:159]
    s_nop 4
    v_mfma_f32_32x32x16_bf16 v[144:159], v[184:187], v[72:75], v[144:159]
    v_mov_b32_dpp v128, v128 row_shr:1 row_mask:0xf bank_mask:0xf bound_ctrl:0
    v_mov_b32_dpp v129, v129 row_shr:1 row_mask:0xf bank_mask:0xf bound_ctrl:0
    v_mov_b32_dpp v130, v130 row_shr:1 row_mask:0xf bank_mask:0xf bound_ctrl:0
    v_mfma_f32_32x32x16_bf16 v[144:159], v[188:191], v[76:79], v[144:159]
    v_mov_b32_dpp v131, v131 row_shr:1 row_mask:0xf bank_mask:0xf bound_ctrl:0
    v_mov_b32_dpp v132, v132 row_shr:1 row_mask:0xf bank_mask:0xf bound_ctrl:0
    v_mov_b32_dpp v133, v133 row_shr:1 row_mask:0xf bank_mask:0xf bound_ctrl:0
    v_mfma_f32_32x32x16_bf16 v[144:159], v[192:195], v[80:83], v[144:159]
    v_mov_b32_dpp v134, v134 row_shr:1 row_mask:0xf bank_mask:0xf bound_ctrl:0
    v_mov_b32_dpp v135, v135 row_shr:1 row_mask:0xf bank_mask:0xf bound_ctrl:0
    v_mov_b32_dpp v136, v136 row_shr:1 row_mask:0xf bank_mask:0xf bound_ctrl:0
    v_mfma_f32_32x32x16_bf16 v[144:159], v[196:199], v[84:87], v[144:159]
    v_mov_b32_dpp v137, v137 row_shr:1 row_mask:0xf bank_mask:0xf bound_ctrl:0
    v_mov_b32_dpp v138, v138 row_shr:1 row_mask:0xf bank_mask:0xf bound_ctrl:0
    v_mov_b32_dpp v139, v139 row_shr:1 row_mask:0xf bank_mask:0xf bound_ctrl:0
    v_mfma_f32_32x32x16_bf16 v[144:159], v[200:203], v[88:91], v[144:159]
    v_mov_b32_dpp v140, v140 row_shr:1 row_mask:0xf bank_mask:0xf bound_ctrl:0
    v_mov_b32_dpp v141, v141 row_shr:1 row_mask:0xf bank_mask:0xf bound_ctrl:0
    v_mfma_f32_32x32x16_bf16 v[144:159], v[204:207], v[92:95], v[144:159]
    v_mov_b32_dpp v142, v142 row_shr:1 row_mask:0xf bank_mask:0xf bound_ctrl:0
    v_mov_b32_dpp v143, v143 row_shr:1 row_mask:0xf bank_mask:0xf bound_ctrl:0
    s_nop 1
    v_mfma_f32_32x32x16_bf16 v[128:143], v[176:179], v[32:35], v[128:143]
    v_mfma_f32_32x32x16_bf16 v[128:143], v[180:183], v[36:39], v[128:143]
    v_mfma_f32_32x32x16_bf16 v[128:143], v[184:187], v[40:43], v[128:143]
    v_mfma_f32_32x32x16_bf16 v[128:143], v[188:191], v[44:47], v[128:143]
    v_mfma_f32_32x32x16_bf16 v[128:143], v[192:195], v[48:51], v[128:143]
    v_mfma_f32_32x32x16_bf16 v[128:143], v[196:199], v[52:55], v[128:143]
    v_mfma_f32_32x32x16_bf16 v[128:143], v[200:203], v[56:59], v[128:143]
    v_mfma_f32_32x32x16_bf16 v[128:143], v[204:207], v[60:63], v[128:143]
    s_nop 7
    s_barrier
    s_mul_i32 s36, s19, 4096
    s_add_u32 s36, s36, 88064
    v_lshlrev_b32 v16, 4, v1
    v_add_u32 v16, s36, v16
    ds_read_b128 v[160:163], v16 offset:0
    ds_read_b128 v[164:167], v16 offset:1024
    ds_read_b128 v[168:171], v16 offset:2048
    ds_read_b128 v[172:175], v16 offset:3072
    v_mul_u32_u24 v16, 264, v7
    v_lshl_add_u32 v16, v9, 5, v16
    v_lshl_add_u32 v16, v8, 2, v16
    v_add_u32 v16, s34, v16
    s_mov_b32 s42, 0xff00ff00
    s_mov_b32 s43, 0xff00ff00
    s_waitcnt lgkmcnt(0)
    v_add_f32_dpp v128, v160, v128 row_shr:8 row_mask:0xf bank_mask:0xf bound_ctrl:0
    v_add_f32_dpp v129, v161, v129 row_shr:8 row_mask:0xf bank_mask:0xf bound_ctrl:0
    v_add_f32_dpp v130, v162, v130 row_shr:8 row_mask:0xf bank_mask:0xf bound_ctrl:0
    v_add_f32_dpp v131, v163, v131 row_shr:8 row_mask:0xf bank_mask:0xf bound_ctrl:0
    v_add_f32_dpp v132, v164, v132 row_shr:8 row_mask:0xf bank_mask:0xf bound_ctrl:0
    v_add_f32_dpp v133, v165, v133 row_shr:8 row_mask:0xf bank_mask:0xf bound_ctrl:0
    v_add_f32_dpp v134, v166, v134 row_shr:8 row_mask:0xf bank_mask:0xf bound_ctrl:0
    v_add_f32_dpp v135, v167, v135 row_shr:8 row_mask:0xf bank_mask:0xf bound_ctrl:0
    v_add_f32_dpp v136, v168, v136 row_shr:8 row_mask:0xf bank_mask:0xf bound_ctrl:0
    v_add_f32_dpp v137, v169, v137 row_shr:8 row_mask:0xf bank_mask:0xf bound_ctrl:0
    v_add_f32_dpp v138, v170, v138 row_shr:8 row_mask:0xf bank_mask:0xf bound_ctrl:0
    v_add_f32_dpp v139, v171, v139 row_shr:8 row_mask:0xf bank_mask:0xf bound_ctrl:0
    v_add_f32_dpp v140, v172, v140 row_shr:8 row_mask:0xf bank_mask:0xf bound_ctrl:0
    v_add_f32_dpp v141, v173, v141 row_shr:8 row_mask:0xf bank_mask:0xf bound_ctrl:0
    v_add_f32_dpp v142, v174, v142 row_shr:8 row_mask:0xf bank_mask:0xf bound_ctrl:0
    v_add_f32_dpp v143, v175, v143 row_shr:8 row_mask:0xf bank_mask:0xf bound_ctrl:0
    s_mov_b64 exec, s[42:43]
    v_add_f32 v144, v160, v144
    v_add_f32 v145, v161, v145
    v_add_f32 v146, v162, v146
    v_add_f32 v147, v163, v147
    v_add_f32 v148, v164, v148
    v_add_f32 v149, v165, v149
    v_add_f32 v150, v166, v150
    v_add_f32 v151, v167, v151
    v_add_f32 v152, v168, v152
    v_add_f32 v153, v169, v153
    v_add_f32 v154, v170, v154
    v_add_f32 v155, v171, v155
    v_add_f32 v156, v172, v156
    v_add_f32 v157, v173, v157
    v_add_f32 v158, v174, v158
    v_add_f32 v159, v175, v159
    s_mov_b64 exec, -1
    v_cvt_pk_bf16_f32 v32, v128, v144
    v_cvt_pk_bf16_f32 v33, v129, v145
    v_cvt_pk_bf16_f32 v34, v130, v146
    v_cvt_pk_bf16_f32 v35, v131, v147
    v_cvt_pk_bf16_f32 v36, v132, v148
    v_cvt_pk_bf16_f32 v37, v133, v149
    v_cvt_pk_bf16_f32 v38, v134, v150
    v_cvt_pk_bf16_f32 v39, v135, v151
    v_cvt_pk_bf16_f32 v40, v136, v152
    v_cvt_pk_bf16_f32 v41, v137, v153
    v_cvt_pk_bf16_f32 v42, v138, v154
    v_cvt_pk_bf16_f32 v43, v139, v155
    v_cvt_pk_bf16_f32 v44, v140, v156
    v_cvt_pk_bf16_f32 v45, v141, v157
    v_cvt_pk_bf16_f32 v46, v142, v158
    v_cvt_pk_bf16_f32 v47, v143, v159
    ds_write_b32 v16, v32 offset:0
    ds_write_b32 v16, v33 offset:8
    ds_write_b32 v16, v34 offset:16
    ds_write_b32 v16, v35 offset:24
    ds_write_b32 v16, v36 offset:64
    ds_write_b32 v16, v37 offset:72
    ds_write_b32 v16, v38 offset:80
    ds_write_b32 v16, v39 offset:88
    ds_write_b32 v16, v40 offset:128
    ds_write_b32 v16, v41 offset:136
    ds_write_b32 v16, v42 offset:144
    ds_write_b32 v16, v43 offset:152
    ds_write_b32 v16, v44 offset:192
    ds_write_b32 v16, v45 offset:200
    ds_write_b32 v16, v46 offset:208
    ds_write_b32 v16, v47 offset:216
    s_branch p_convE
p_convP:
    s_add_u32 s36, s34, 9728
    s_mov_b32 m0, s36
    s_add_u32 s40, s35, 8
    v_mov_b32 v16, 0
    ds_write_b32 v5, v6 offset:9472
    buffer_load_dwordx4 v3, s[24:27], s40 offen offset:0 lds
    buffer_load_dwordx4 v3, s[24:27], s40 offen offset:1024 lds
    buffer_load_dwordx4 v3, s[24:27], s40 offen offset:2048 lds
    buffer_load_dwordx4 v3, s[24:27], s40 offen offset:3072 lds
    buffer_load_dwordx2 v[252:253], v16, s[24:27], s35 offen
    v_mov_b32 v251, 0
    buffer_load_dword v250, v251, s[48:51], 0 offen sc1
    v_lshlrev_b32 v11, 2, v8
    v_and_b32 v12, 7, v1
    v_mul_u32_u24 v13, 272, v12
    v_lshl_add_u32 v13, v9, 4, v13
    v_add_u32 v13, s34, v13
    v_add_u32 v13, 4356, v13
    v_sub_u32 v13, v13, v11
    v_bfe_u32 v11, v1, 3, 1
    v_lshlrev_b32 v11, 4, v11
    v_sub_u32 v11, 16, v11
    v_cmp_ne_u32 vcc, 0, v12
    v_mov_b32 v16, 0
    s_add_u32 s36, s34, 9720
    v_cndmask_b32 v15, v16, -1, vcc
    v_mov_b32 v17, s36
    s_waitcnt vmcnt(0) lgkmcnt(0)
    s_mov_b64 exec, 1
    ds_write_b64 v17, v[252:253]
    s_mov_b64 exec, -1
    s_barrier
    s_waitcnt lgkmcnt(0)
    s_barrier
    ds_read2_b32 v[96:97], v13 offset0:0 offset1:1
    ds_read2_b32 v[98:99], v13 offset0:2 offset1:3
    ds_read2_b32 v[100:101], v13 offset0:8 offset1:9
    ds_read2_b32 v[102:103], v13 offset0:10 offset1:11
    ds_read2_b32 v[104:105], v13 offset0:16 offset1:17
    ds_read2_b32 v[106:107], v13 offset0:18 offset1:19
    ds_read2_b32 v[108:109], v13 offset0:24 offset1:25
    ds_read2_b32 v[110:111], v13 offset0:26 offset1:27
    ds_read2_b32 v[112:113], v13 offset0:32 offset1:33
    ds_read2_b32 v[114:115], v13 offset0:34 offset1:35
    ds_read2_b32 v[116:117], v13 offset0:40 offset1:41
    ds_read2_b32 v[118:119], v13 offset0:42 offset1:43
    ds_read2_b32 v[120:121], v13 offset0:48 offset1:49
    ds_read2_b32 v[122:123], v13 offset0:50 offset1:51
    ds_read2_b32 v[124:125], v13 offset0:56 offset1:57
    ds_read2_b32 v[126:127], v13 offset0:58 offset1:59
    s_waitcnt lgkmcnt(6)
    ds_read_b32 v24, v13 offset:16
    ds_read_b32 v25, v13 offset:48
    ds_read_b32 v26, v13 offset:80
    ds_read_b32 v27, v13 offset:112
    ds_read_b32 v28, v13 offset:144
    ds_read_b32 v29, v13 offset:176
    ds_read_b32 v30, v13 offset:208
    ds_read_b32 v31, v13 offset:240
    s_waitcnt lgkmcnt(7)
    ds_read_b128 v[208:211], v14 offset:3840
    ds_read_b128 v[212:215], v14 offset:3872
    ds_read_b128 v[216:219], v14 offset:3904
    ds_read_b128 v[220:223], v14 offset:3936
    ds_read_b128 v[224:227], v14 offset:3968
    ds_read_b128 v[228:231], v14 offset:4000
    ds_read_b128 v[232:235], v14 offset:4032
    ds_read_b128 v[236:239], v14 offset:4064
    s_waitcnt lgkmcnt(8)
    v_alignbit_b32 v96, v97, v96, v11
    v_alignbit_b32 v97, v98, v97, v11
    v_alignbit_b32 v98, v99, v98, v11
    v_alignbit_b32 v99, v24, v99, v11
    v_alignbit_b32 v100, v101, v100, v11
    v_alignbit_b32 v101, v102, v101, v11
    v_alignbit_b32 v102, v103, v102, v11
    v_alignbit_b32 v103, v25, v103, v11
    v_alignbit_b32 v104, v105, v104, v11
    v_alignbit_b32 v105, v106, v105, v11
    v_alignbit_b32 v106, v107, v106, v11
    v_alignbit_b32 v107, v26, v107, v11
    v_alignbit_b32 v108, v109, v108, v11
    v_alignbit_b32 v109, v110, v109, v11
    v_alignbit_b32 v110, v111, v110, v11
    v_alignbit_b32 v111, v27, v111, v11
    v_alignbit_b32 v112, v113, v112, v11
    v_alignbit_b32 v113, v114, v113, v11
    v_alignbit_b32 v114, v115, v114, v11
    v_alignbit_b32 v115, v28, v115, v11
    v_alignbit_b32 v116, v117, v116, v11
    v_alignbit_b32 v117, v118, v117, v11
    v_alignbit_b32 v118, v119, v118, v11
    v_alignbit_b32 v119, v29, v119, v11
    v_alignbit_b32 v120, v121, v120, v11
    v_alignbit_b32 v121, v122, v121, v11
    v_alignbit_b32 v122, v123, v122, v11
    v_alignbit_b32 v123, v30, v123, v11
    v_alignbit_b32 v124, v125, v124, v11
    v_alignbit_b32 v125, v126, v125, v11
    v_alignbit_b32 v126, v127, v126, v11
    v_alignbit_b32 v127, v31, v127, v11
    s_setprio 3
    s_waitcnt lgkmcnt(0)
    s_nop 1
    v_mfma_f32_32x32x16_bf16 v[160:175], v[208:211], v[96:99], 0
    ds_read_b128 v[176:179], v14 offset:3584
    ds_read_b128 v[180:183], v14 offset:3616
    v_mfma_f32_32x32x16_bf16 v[160:175], v[212:215], v[100:103], v[160:175]
    ds_read_b128 v[184:187], v14 offset:3648
    ds_read_b128 v[188:191], v14 offset:3680
    v_mfma_f32_32x32x16_bf16 v[160:175], v[216:219], v[104:107], v[160:175]
    ds_read_b128 v[192:195], v14 offset:3712
    v_mfma_f32_32x32x16_bf16 v[160:175], v[220:223], v[108:111], v[160:175]
    ds_read_b128 v[196:199], v14 offset:3744
    v_mfma_f32_32x32x16_bf16 v[160:175], v[224:227], v[112:115], v[160:175]
    ds_read_b128 v[200:203], v14 offset:3776
    v_mfma_f32_32x32x16_bf16 v[160:175], v[228:231], v[116:119], v[160:175]
    ds_read_b128 v[204:207], v14 offset:3808
    v_mfma_f32_32x32x16_bf16 v[160:175], v[232:235], v[120:123], v[160:175]
    v_mfma_f32_32x32x16_bf16 v[160:175], v[236:239], v[124:127], v[160:175]
    s_waitcnt lgkmcnt(0)
    s_nop 11
    v_and_b32_dpp v160, v160, v15 row_shr:1 row_mask:0xf bank_mask:0xf bound_ctrl:0
    v_and_b32_dpp v161, v161, v15 row_shr:1 row_mask:0xf bank_mask:0xf bound_ctrl:0
    v_and_b32_dpp v162, v162, v15 row_shr:1 row_mask:0xf bank_mask:0xf bound_ctrl:0
    v_and_b32_dpp v163, v163, v15 row_shr:1 row_mask:0xf bank_mask:0xf bound_ctrl:0
    v_and_b32_dpp v164, v164, v15 row_shr:1 row_mask:0xf bank_mask:0xf bound_ctrl:0
    v_and_b32_dpp v165, v165, v15 row_shr:1 row_mask:0xf bank_mask:0xf bound_ctrl:0
    v_and_b32_dpp v166, v166, v15 row_shr:1 row_mask:0xf bank_mask:0xf bound_ctrl:0
    v_and_b32_dpp v167, v167, v15 row_shr:1 row_mask:0xf bank_mask:0xf bound_ctrl:0
    v_and_b32_dpp v168, v168, v15 row_shr:1 row_mask:0xf bank_mask:0xf bound_ctrl:0
    v_and_b32_dpp v169, v169, v15 row_shr:1 row_mask:0xf bank_mask:0xf bound_ctrl:0
    v_and_b32_dpp v170, v170, v15 row_shr:1 row_mask:0xf bank_mask:0xf bound_ctrl:0
    v_and_b32_dpp v171, v171, v15 row_shr:1 row_mask:0xf bank_mask:0xf bound_ctrl:0
    v_and_b32_dpp v172, v172, v15 row_shr:1 row_mask:0xf bank_mask:0xf bound_ctrl:0
    v_and_b32_dpp v173, v173, v15 row_shr:1 row_mask:0xf bank_mask:0xf bound_ctrl:0
    v_and_b32_dpp v174, v174, v15 row_shr:1 row_mask:0xf bank_mask:0xf bound_ctrl:0
    v_and_b32_dpp v175, v175, v15 row_shr:1 row_mask:0xf bank_mask:0xf bound_ctrl:0
    s_nop 1
    v_mfma_f32_32x32x16_bf16 v[160:175], v[176:179], v[96:99], v[160:175]
    ds_read_b128 v[208:211], v14 offset:3328
    ds_read_b128 v[212:215], v14 offset:3360
    v_mfma_f32_32x32x16_bf16 v[160:175], v[180:183], v[100:103], v[160:175]
    ds_read_b128 v[216:219], v14 offset:3392
    ds_read_b128 v[220:223], v14 offset:3424
    v_mfma_f32_32x32x16_bf16 v[160:175], v[184:187], v[104:107], v[160:175]
    ds_read_b128 v[224:227], v14 offset:3456
    v_mfma_f32_32x32x16_bf16 v[160:175], v[188:191], v[108:111], v[160:175]
    ds_read_b128 v[228:231], v14 offset:3488
    v_mfma_f32_32x32x16_bf16 v[160:175], v[192:195], v[112:115], v[160:175]
    ds_read_b128 v[232:235], v14 offset:3520
    v_mfma_f32_32x32x16_bf16 v[160:175], v[196:199], v[116:119], v[160:175]
    ds_read_b128 v[236:239], v14 offset:3552
    v_mfma_f32_32x32x16_bf16 v[160:175], v[200:203], v[120:123], v[160:175]
    v_mfma_f32_32x32x16_bf16 v[160:175], v[204:207], v[124:127], v[160:175]
    s_waitcnt lgkmcnt(0)
    s_nop 11
    v_and_b32_dpp v160, v160, v15 row_shr:1 row_mask:0xf bank_mask:0xf bound_ctrl:0
    v_and_b32_dpp v161, v161, v15 row_shr:1 row_mask:0xf bank_mask:0xf bound_ctrl:0
    v_and_b32_dpp v162, v162, v15 row_shr:1 row_mask:0xf bank_mask:0xf bound_ctrl:0
    v_and_b32_dpp v163, v163, v15 row_shr:1 row_mask:0xf bank_mask:0xf bound_ctrl:0
    v_and_b32_dpp v164, v164, v15 row_shr:1 row_mask:0xf bank_mask:0xf bound_ctrl:0
    v_and_b32_dpp v165, v165, v15 row_shr:1 row_mask:0xf bank_mask:0xf bound_ctrl:0
    v_and_b32_dpp v166, v166, v15 row_shr:1 row_mask:0xf bank_mask:0xf bound_ctrl:0
    v_and_b32_dpp v167, v167, v15 row_shr:1 row_mask:0xf bank_mask:0xf bound_ctrl:0
    v_and_b32_dpp v168, v168, v15 row_shr:1 row_mask:0xf bank_mask:0xf bound_ctrl:0
    v_and_b32_dpp v169, v169, v15 row_shr:1 row_mask:0xf bank_mask:0xf bound_ctrl:0
    v_and_b32_dpp v170, v170, v15 row_shr:1 row_mask:0xf bank_mask:0xf bound_ctrl:0
    v_and_b32_dpp v171, v171, v15 row_shr:1 row_mask:0xf bank_mask:0xf bound_ctrl:0
    v_and_b32_dpp v172, v172, v15 row_shr:1 row_mask:0xf bank_mask:0xf bound_ctrl:0
    v_and_b32_dpp v173, v173, v15 row_shr:1 row_mask:0xf bank_mask:0xf bound_ctrl:0
    v_and_b32_dpp v174, v174, v15 row_shr:1 row_mask:0xf bank_mask:0xf bound_ctrl:0
    v_and_b32_dpp v175, v175, v15 row_shr:1 row_mask:0xf bank_mask:0xf bound_ctrl:0
    s_nop 1
    v_mfma_f32_32x32x16_bf16 v[160:175], v[208:211], v[96:99], v[160:175]
    ds_read_b128 v[176:179], v14 offset:3072
    ds_read_b128 v[180:183], v14 offset:3104
    v_mfma_f32_32x32x16_bf16 v[160:175], v[212:215], v[100:103], v[160:175]
    ds_read_b128 v[184:187], v14 offset:3136
    ds_read_b128 v[188:191], v14 offset:3168
    v_mfma_f32_32x32x16_bf16 v[160:175], v[216:219], v[104:107], v[160:175]
    ds_read_b128 v[192:195], v14 offset:3200
    v_mfma_f32_32x32x16_bf16 v[160:175], v[220:223], v[108:111], v[160:175]
    ds_read_b128 v[196:199], v14 offset:3232
    v_mfma_f32_32x32x16_bf16 v[160:175], v[224:227], v[112:115], v[160:175]
    ds_read_b128 v[200:203], v14 offset:3264
    v_mfma_f32_32x32x16_bf16 v[160:175], v[228:231], v[116:119], v[160:175]
    ds_read_b128 v[204:207], v14 offset:3296
    v_mfma_f32_32x32x16_bf16 v[160:175], v[232:235], v[120:123], v[160:175]
    v_mfma_f32_32x32x16_bf16 v[160:175], v[236:239], v[124:127], v[160:175]
    s_waitcnt lgkmcnt(0)
    s_nop 11
    v_and_b32_dpp v160, v160, v15 row_shr:1 row_mask:0xf bank_mask:0xf bound_ctrl:0
    v_and_b32_dpp v161, v161, v15 row_shr:1 row_mask:0xf bank_mask:0xf bound_ctrl:0
    v_and_b32_dpp v162, v162, v15 row_shr:1 row_mask:0xf bank_mask:0xf bound_ctrl:0
    v_and_b32_dpp v163, v163, v15 row_shr:1 row_mask:0xf bank_mask:0xf bound_ctrl:0
    v_and_b32_dpp v164, v164, v15 row_shr:1 row_mask:0xf bank_mask:0xf bound_ctrl:0
    v_and_b32_dpp v165, v165, v15 row_shr:1 row_mask:0xf bank_mask:0xf bound_ctrl:0
    v_and_b32_dpp v166, v166, v15 row_shr:1 row_mask:0xf bank_mask:0xf bound_ctrl:0
    v_and_b32_dpp v167, v167, v15 row_shr:1 row_mask:0xf bank_mask:0xf bound_ctrl:0
    v_and_b32_dpp v168, v168, v15 row_shr:1 row_mask:0xf bank_mask:0xf bound_ctrl:0
    v_and_b32_dpp v169, v169, v15 row_shr:1 row_mask:0xf bank_mask:0xf bound_ctrl:0
    v_and_b32_dpp v170, v170, v15 row_shr:1 row_mask:0xf bank_mask:0xf bound_ctrl:0
    v_and_b32_dpp v171, v171, v15 row_shr:1 row_mask:0xf bank_mask:0xf bound_ctrl:0
    v_and_b32_dpp v172, v172, v15 row_shr:1 row_mask:0xf bank_mask:0xf bound_ctrl:0
    v_and_b32_dpp v173, v173, v15 row_shr:1 row_mask:0xf bank_mask:0xf bound_ctrl:0
    v_and_b32_dpp v174, v174, v15 row_shr:1 row_mask:0xf bank_mask:0xf bound_ctrl:0
    v_and_b32_dpp v175, v175, v15 row_shr:1 row_mask:0xf bank_mask:0xf bound_ctrl:0
    s_nop 1
    v_mfma_f32_32x32x16_bf16 v[160:175], v[176:179], v[96:99], v[160:175]
    ds_read_b128 v[208:211], v14 offset:2816
    ds_read_b128 v[212:215], v14 offset:2848
    v_mfma_f32_32x32x16_bf16 v[160:175], v[180:183], v[100:103], v[160:175]
    ds_read_b128 v[216:219], v14 offset:2880
    ds_read_b128 v[220:223], v14 offset:2912
    v_mfma_f32_32x32x16_bf16 v[160:175], v[184:187], v[104:107], v[160:175]
    ds_read_b128 v[224:227], v14 offset:2944
    v_mfma_f32_32x32x16_bf16 v[160:175], v[188:191], v[108:111], v[160:175]
    ds_read_b128 v[228:231], v14 offset:2976
    v_mfma_f32_32x32x16_bf16 v[160:175], v[192:195], v[112:115], v[160:175]
    ds_read_b128 v[232:235], v14 offset:3008
    v_mfma_f32_32x32x16_bf16 v[160:175], v[196:199], v[116:119], v[160:175]
    ds_read_b128 v[236:239], v14 offset:3040
    v_mfma_f32_32x32x16_bf16 v[160:175], v[200:203], v[120:123], v[160:175]
    v_mfma_f32_32x32x16_bf16 v[160:175], v[204:207], v[124:127], v[160:175]
    s_waitcnt lgkmcnt(0)
    s_nop 11
    v_and_b32_dpp v160, v160, v15 row_shr:1 row_mask:0xf bank_mask:0xf bound_ctrl:0
    v_and_b32_dpp v161, v161, v15 row_shr:1 row_mask:0xf bank_mask:0xf bound_ctrl:0
    v_and_b32_dpp v162, v162, v15 row_shr:1 row_mask:0xf bank_mask:0xf bound_ctrl:0
    v_and_b32_dpp v163, v163, v15 row_shr:1 row_mask:0xf bank_mask:0xf bound_ctrl:0
    v_and_b32_dpp v164, v164, v15 row_shr:1 row_mask:0xf bank_mask:0xf bound_ctrl:0
    v_and_b32_dpp v165, v165, v15 row_shr:1 row_mask:0xf bank_mask:0xf bound_ctrl:0
    v_and_b32_dpp v166, v166, v15 row_shr:1 row_mask:0xf bank_mask:0xf bound_ctrl:0
    v_and_b32_dpp v167, v167, v15 row_shr:1 row_mask:0xf bank_mask:0xf bound_ctrl:0
    v_and_b32_dpp v168, v168, v15 row_shr:1 row_mask:0xf bank_mask:0xf bound_ctrl:0
    v_and_b32_dpp v169, v169, v15 row_shr:1 row_mask:0xf bank_mask:0xf bound_ctrl:0
    v_and_b32_dpp v170, v170, v15 row_shr:1 row_mask:0xf bank_mask:0xf bound_ctrl:0
    v_and_b32_dpp v171, v171, v15 row_shr:1 row_mask:0xf bank_mask:0xf bound_ctrl:0
    v_and_b32_dpp v172, v172, v15 row_shr:1 row_mask:0xf bank_mask:0xf bound_ctrl:0
    v_and_b32_dpp v173, v173, v15 row_shr:1 row_mask:0xf bank_mask:0xf bound_ctrl:0
    v_and_b32_dpp v174, v174, v15 row_shr:1 row_mask:0xf bank_mask:0xf bound_ctrl:0
    v_and_b32_dpp v175, v175, v15 row_shr:1 row_mask:0xf bank_mask:0xf bound_ctrl:0
    s_nop 1
    v_mfma_f32_32x32x16_bf16 v[160:175], v[208:211], v[96:99], v[160:175]
    ds_read_b128 v[176:179], v14 offset:2560
    ds_read_b128 v[180:183], v14 offset:2592
    v_mfma_f32_32x32x16_bf16 v[160:175], v[212:215], v[100:103], v[160:175]
    ds_read_b128 v[184:187], v14 offset:2624
    ds_read_b128 v[188:191], v14 offset:2656
    v_mfma_f32_32x32x16_bf16 v[160:175], v[216:219], v[104:107], v[160:175]
    ds_read_b128 v[192:195], v14 offset:2688
    v_mfma_f32_32x32x16_bf16 v[160:175], v[220:223], v[108:111], v[160:175]
    ds_read_b128 v[196:199], v14 offset:2720
    v_mfma_f32_32x32x16_bf16 v[160:175], v[224:227], v[112:115], v[160:175]
    ds_read_b128 v[200:203], v14 offset:2752
    v_mfma_f32_32x32x16_bf16 v[160:175], v[228:231], v[116:119], v[160:175]
    ds_read_b128 v[204:207], v14 offset:2784
    v_mfma_f32_32x32x16_bf16 v[160:175], v[232:235], v[120:123], v[160:175]
    v_mfma_f32_32x32x16_bf16 v[160:175], v[236:239], v[124:127], v[160:175]
    s_waitcnt lgkmcnt(0)
    s_nop 11
    v_and_b32_dpp v160, v160, v15 row_shr:1 row_mask:0xf bank_mask:0xf bound_ctrl:0
    v_and_b32_dpp v161, v161, v15 row_shr:1 row_mask:0xf bank_mask:0xf bound_ctrl:0
    v_and_b32_dpp v162, v162, v15 row_shr:1 row_mask:0xf bank_mask:0xf bound_ctrl:0
    v_and_b32_dpp v163, v163, v15 row_shr:1 row_mask:0xf bank_mask:0xf bound_ctrl:0
    v_and_b32_dpp v164, v164, v15 row_shr:1 row_mask:0xf bank_mask:0xf bound_ctrl:0
    v_and_b32_dpp v165, v165, v15 row_shr:1 row_mask:0xf bank_mask:0xf bound_ctrl:0
    v_and_b32_dpp v166, v166, v15 row_shr:1 row_mask:0xf bank_mask:0xf bound_ctrl:0
    v_and_b32_dpp v167, v167, v15 row_shr:1 row_mask:0xf bank_mask:0xf bound_ctrl:0
    v_and_b32_dpp v168, v168, v15 row_shr:1 row_mask:0xf bank_mask:0xf bound_ctrl:0
    v_and_b32_dpp v169, v169, v15 row_shr:1 row_mask:0xf bank_mask:0xf bound_ctrl:0
    v_and_b32_dpp v170, v170, v15 row_shr:1 row_mask:0xf bank_mask:0xf bound_ctrl:0
    v_and_b32_dpp v171, v171, v15 row_shr:1 row_mask:0xf bank_mask:0xf bound_ctrl:0
    v_and_b32_dpp v172, v172, v15 row_shr:1 row_mask:0xf bank_mask:0xf bound_ctrl:0
    v_and_b32_dpp v173, v173, v15 row_shr:1 row_mask:0xf bank_mask:0xf bound_ctrl:0
    v_and_b32_dpp v174, v174, v15 row_shr:1 row_mask:0xf bank_mask:0xf bound_ctrl:0
    v_and_b32_dpp v175, v175, v15 row_shr:1 row_mask:0xf bank_mask:0xf bound_ctrl:0
    s_nop 1
    v_mfma_f32_32x32x16_bf16 v[160:175], v[176:179], v[96:99], v[160:175]
    ds_read_b128 v[208:211], v14 offset:2304
    ds_read_b128 v[212:215], v14 offset:2336
    v_mfma_f32_32x32x16_bf16 v[160:175], v[180:183], v[100:103], v[160:175]
    ds_read_b128 v[216:219], v14 offset:2368
    ds_read_b128 v[220:223], v14 offset:2400
    v_mfma_f32_32x32x16_bf16 v[160:175], v[184:187], v[104:107], v[160:175]
    ds_read_b128 v[224:227], v14 offset:2432
    v_mfma_f32_32x32x16_bf16 v[160:175], v[188:191], v[108:111], v[160:175]
    ds_read_b128 v[228:231], v14 offset:2464
    v_mfma_f32_32x32x16_bf16 v[160:175], v[192:195], v[112:115], v[160:175]
    ds_read_b128 v[232:235], v14 offset:2496
    v_mfma_f32_32x32x16_bf16 v[160:175], v[196:199], v[116:119], v[160:175]
    ds_read_b128 v[236:239], v14 offset:2528
    v_mfma_f32_32x32x16_bf16 v[160:175], v[200:203], v[120:123], v[160:175]
    v_mfma_f32_32x32x16_bf16 v[160:175], v[204:207], v[124:127], v[160:175]
    s_waitcnt lgkmcnt(0)
    s_nop 11
    v_and_b32_dpp v160, v160, v15 row_shr:1 row_mask:0xf bank_mask:0xf bound_ctrl:0
    v_and_b32_dpp v161, v161, v15 row_shr:1 row_mask:0xf bank_mask:0xf bound_ctrl:0
    v_and_b32_dpp v162, v162, v15 row_shr:1 row_mask:0xf bank_mask:0xf bound_ctrl:0
    v_and_b32_dpp v163, v163, v15 row_shr:1 row_mask:0xf bank_mask:0xf bound_ctrl:0
    v_and_b32_dpp v164, v164, v15 row_shr:1 row_mask:0xf bank_mask:0xf bound_ctrl:0
    v_and_b32_dpp v165, v165, v15 row_shr:1 row_mask:0xf bank_mask:0xf bound_ctrl:0
    v_and_b32_dpp v166, v166, v15 row_shr:1 row_mask:0xf bank_mask:0xf bound_ctrl:0
    v_and_b32_dpp v167, v167, v15 row_shr:1 row_mask:0xf bank_mask:0xf bound_ctrl:0
    v_and_b32_dpp v168, v168, v15 row_shr:1 row_mask:0xf bank_mask:0xf bound_ctrl:0
    v_and_b32_dpp v169, v169, v15 row_shr:1 row_mask:0xf bank_mask:0xf bound_ctrl:0
    v_and_b32_dpp v170, v170, v15 row_shr:1 row_mask:0xf bank_mask:0xf bound_ctrl:0
    v_and_b32_dpp v171, v171, v15 row_shr:1 row_mask:0xf bank_mask:0xf bound_ctrl:0
    v_and_b32_dpp v172, v172, v15 row_shr:1 row_mask:0xf bank_mask:0xf bound_ctrl:0
    v_and_b32_dpp v173, v173, v15 row_shr:1 row_mask:0xf bank_mask:0xf bound_ctrl:0
    v_and_b32_dpp v174, v174, v15 row_shr:1 row_mask:0xf bank_mask:0xf bound_ctrl:0
    v_and_b32_dpp v175, v175, v15 row_shr:1 row_mask:0xf bank_mask:0xf bound_ctrl:0
    s_nop 1
    v_mfma_f32_32x32x16_bf16 v[160:175], v[208:211], v[96:99], v[160:175]
    ds_read_b128 v[176:179], v14 offset:2048
    ds_read_b128 v[180:183], v14 offset:2080
    v_mfma_f32_32x32x16_bf16 v[160:175], v[212:215], v[100:103], v[160:175]
    ds_read_b128 v[184:187], v14 offset:2112
    ds_read_b128 v[188:191], v14 offset:2144
    v_mfma_f32_32x32x16_bf16 v[160:175], v[216:219], v[104:107], v[160:175]
    ds_read_b128 v[192:195], v14 offset:2176
    v_mfma_f32_32x32x16_bf16 v[160:175], v[220:223], v[108:111], v[160:175]
    ds_read_b128 v[196:199], v14 offset:2208
    v_mfma_f32_32x32x16_bf16 v[160:175], v[224:227], v[112:115], v[160:175]
    ds_read_b128 v[200:203], v14 offset:2240
    v_mfma_f32_32x32x16_bf16 v[160:175], v[228:231], v[116:119], v[160:175]
    ds_read_b128 v[204:207], v14 offset:2272
    v_mfma_f32_32x32x16_bf16 v[160:175], v[232:235], v[120:123], v[160:175]
    v_mfma_f32_32x32x16_bf16 v[160:175], v[236:239], v[124:127], v[160:175]
    s_waitcnt lgkmcnt(0)
    s_nop 11
    v_and_b32_dpp v160, v160, v15 row_shr:1 row_mask:0xf bank_mask:0xf bound_ctrl:0
    v_and_b32_dpp v161, v161, v15 row_shr:1 row_mask:0xf bank_mask:0xf bound_ctrl:0
    v_and_b32_dpp v162, v162, v15 row_shr:1 row_mask:0xf bank_mask:0xf bound_ctrl:0
    v_and_b32_dpp v163, v163, v15 row_shr:1 row_mask:0xf bank_mask:0xf bound_ctrl:0
    v_and_b32_dpp v164, v164, v15 row_shr:1 row_mask:0xf bank_mask:0xf bound_ctrl:0
    v_and_b32_dpp v165, v165, v15 row_shr:1 row_mask:0xf bank_mask:0xf bound_ctrl:0
    v_and_b32_dpp v166, v166, v15 row_shr:1 row_mask:0xf bank_mask:0xf bound_ctrl:0
    v_and_b32_dpp v167, v167, v15 row_shr:1 row_mask:0xf bank_mask:0xf bound_ctrl:0
    v_and_b32_dpp v168, v168, v15 row_shr:1 row_mask:0xf bank_mask:0xf bound_ctrl:0
    v_and_b32_dpp v169, v169, v15 row_shr:1 row_mask:0xf bank_mask:0xf bound_ctrl:0
    v_and_b32_dpp v170, v170, v15 row_shr:1 row_mask:0xf bank_mask:0xf bound_ctrl:0
    v_and_b32_dpp v171, v171, v15 row_shr:1 row_mask:0xf bank_mask:0xf bound_ctrl:0
    v_and_b32_dpp v172, v172, v15 row_shr:1 row_mask:0xf bank_mask:0xf bound_ctrl:0
    v_and_b32_dpp v173, v173, v15 row_shr:1 row_mask:0xf bank_mask:0xf bound_ctrl:0
    v_and_b32_dpp v174, v174, v15 row_shr:1 row_mask:0xf bank_mask:0xf bound_ctrl:0
    v_and_b32_dpp v175, v175, v15 row_shr:1 row_mask:0xf bank_mask:0xf bound_ctrl:0
    s_nop 1
    v_mfma_f32_32x32x16_bf16 v[160:175], v[176:179], v[96:99], v[160:175]
    v_mfma_f32_32x32x16_bf16 v[160:175], v[180:183], v[100:103], v[160:175]
    v_mfma_f32_32x32x16_bf16 v[160:175], v[184:187], v[104:107], v[160:175]
    v_mfma_f32_32x32x16_bf16 v[160:175], v[188:191], v[108:111], v[160:175]
    v_mfma_f32_32x32x16_bf16 v[160:175], v[192:195], v[112:115], v[160:175]
    v_mfma_f32_32x32x16_bf16 v[160:175], v[196:199], v[116:119], v[160:175]
    v_mfma_f32_32x32x16_bf16 v[160:175], v[200:203], v[120:123], v[160:175]
    v_mfma_f32_32x32x16_bf16 v[160:175], v[204:207], v[124:127], v[160:175]
    s_setprio 0
    s_mov_b32 s47, 0
prep_kernel_nn19:
    v_readfirstlane_b32 s46, v250
    s_add_u32 s47, s47, 1
    s_cmp_lg_u32 s46, 0
    s_cbranch_scc1 prep_kernel_nd20
    s_cmp_ge_u32 s47, 200000
    s_cbranch_scc1 prep_kernel_nd20
    buffer_load_dword v250, v251, s[48:51], 0 offen sc1
    s_waitcnt vmcnt(0)
    s_branch prep_kernel_nn19
prep_kernel_nd20:
    s_lshr_b32 s40, s2, 4
    s_lshl_b32 s40, s40, 9
    s_add_u32 s40, s40, 29700096
    s_mov_b32 s41, 29683712
    v_lshrrev_b32 v16, 2, v1
    v_mul_u32_u24 v16, 5120, v16
    v_and_b32 v17, 3, v1
    v_lshl_add_u32 v16, v17, 7, v16
    v_lshlrev_b32 v18, 7, v1
    v_mov_b32 v17, s46
    s_add_u32 s42, s41, 8192
    s_mov_b32 s47, 0
prep_kernel_mp21:
    buffer_load_dword v19, v18, s[28:31], s41 offen sc1
    buffer_load_dword v28, v18, s[28:31], s42 offen sc1
    s_mov_b64 exec, 0xfff
    buffer_load_dword v17, v16, s[28:31], s40 offen sc1
    s_mov_b64 exec, -1
    s_waitcnt vmcnt(0)
    v_cmp_ne_u32 vcc, s46, v17
    v_cmp_ne_u32 s[66:67], s46, v19
    v_cmp_ne_u32 s[68:69], s46, v28
    s_add_u32 s47, s47, 1
    s_nop 2
    s_or_b64 vcc, vcc, s[66:67]
    s_or_b64 vcc, vcc, s[68:69]
    s_cmp_ge_u32 s47, 200000
    s_cbranch_scc1 prep_kernel_md22
    s_cbranch_vccz prep_kernel_md22
    s_sleep 8
    s_branch prep_kernel_mp21
prep_kernel_md22:
    s_lshl_b32 s40, s2, 4
    s_add_u32 s40, s40, 2793472
    v_lshrrev_b32 v16, 2, v1
    v_mul_u32_u24 v16, 2560, v16
    v_and_b32 v17, 3, v1
    v_mul_u32_u24 v17, 15360, v17
    v_add_u32 v16, v16, v17
    s_mov_b64 exec, 0xfff
    buffer_load_dwordx4 v[20:23], v16, s[28:31], s40 offen sc1
    s_mov_b64 exec, -1
    v_lshlrev_b32 v18, 4, v1
    v_subrev_u32 v19, 655360, v4
    s_lshl_b32 s43, s20, 10
    s_sub_u32 s44, s43, 4096
    s_add_u32 m0, s43, 55296
    s_add_u32 s39, s38, 2854912
    buffer_load_dwordx4 v4, s[28:31], s39 offen sc1 lds
    s_add_u32 m0, s43, 71680
    s_add_u32 s39, s43, 5476352
    buffer_load_dwordx4 v18, s[28:31], s39 offen sc1 lds
    s_add_u32 m0, s44, 55296
    s_add_u32 s39, s38, 2854912
    buffer_load_dwordx4 v19, s[28:31], s39 offen sc1 lds
    s_add_u32 m0, s44, 71680
    s_add_u32 s39, s44, 5476352
    buffer_load_dwordx4 v18, s[28:31], s39 offen sc1 lds
    s_add_u32 m0, s43, 63488
    s_add_u32 s39, s38, 4165632
    buffer_load_dwordx4 v4, s[28:31], s39 offen sc1 lds
    s_add_u32 m0, s43, 79872
    s_add_u32 s39, s43, 5484544
    buffer_load_dwordx4 v18, s[28:31], s39 offen sc1 lds
    s_add_u32 m0, s44, 63488
    s_add_u32 s39, s38, 4165632
    buffer_load_dwordx4 v19, s[28:31], s39 offen sc1 lds
    s_add_u32 m0, s44, 79872
    s_add_u32 s39, s44, 5484544
    buffer_load_dwordx4 v18, s[28:31], s39 offen sc1 lds
    s_mul_i32 s36, s19, 4096
    s_add_u32 s36, s36, 88064
    v_lshlrev_b32 v16, 4, v1
    v_add_u32 v16, s36, v16
    s_nop 4
    ds_write_b128 v16, v[160:163] offset:0
    ds_write_b128 v16, v[164:167] offset:1024
    ds_write_b128 v16, v[168:171] offset:2048
    ds_write_b128 v16, v[172:175] offset:3072
    s_waitcnt vmcnt(8)
    s_nop 1
    v_add_f32_dpp v20, v20, v20 quad_perm:[1,0,3,2] row_mask:0xf bank_mask:0xf
    v_add_f32_dpp v21, v21, v21 quad_perm:[1,0,3,2] row_mask:0xf bank_mask:0xf
    v_add_f32_dpp v22, v22, v22 quad_perm:[1,0,3,2] row_mask:0xf bank_mask:0xf
    v_add_f32_dpp v23, v23, v23 quad_perm:[1,0,3,2] row_mask:0xf bank_mask:0xf
    s_nop 1
    v_add_f32_dpp v20, v20, v20 quad_perm:[2,3,0,1] row_mask:0xf bank_mask:0xf
    v_add_f32_dpp v21, v21, v21 quad_perm:[2,3,0,1] row_mask:0xf bank_mask:0xf
    v_add_f32_dpp v22, v22, v22 quad_perm:[2,3,0,1] row_mask:0xf bank_mask:0xf
    v_add_f32_dpp v23, v23, v23 quad_perm:[2,3,0,1] row_mask:0xf bank_mask:0xf
    s_nop 1
    v_cvt_pk_bf16_f32 v24, v20, v21
    v_lshlrev_b32 v20, 16, v24
    v_and_b32 v21, 0xffff0000, v24
    v_cvt_pk_bf16_f32 v24, v22, v23
    v_lshlrev_b32 v22, 16, v24
    v_and_b32 v23, 0xffff0000, v24
    v_add_f32 v24, 1.0, v20
    v_add_f32 v25, 1.0, v21
    v_add_f32 v26, 1.0, v22
    v_add_f32 v27, 1.0, v23
    v_cvt_pk_bf16_f32 v10, v24, v25
    v_lshlrev_b32 v24, 16, v10
    v_and_b32 v25, 0xffff0000, v10
    v_cvt_pk_bf16_f32 v10, v26, v27
    v_lshlrev_b32 v26, 16, v10
    v_and_b32 v27, 0xffff0000, v10
    s_nop 1
    v_readlane_b32 s68, v20, 0
    v_readlane_b32 s72, v24, 4
    v_readlane_b32 s76, v20, 8
    v_readlane_b32 s69, v21, 0
    v_readlane_b32 s73, v25, 4
    v_readlane_b32 s77, v21, 8
    v_readlane_b32 s70, v22, 0
    v_readlane_b32 s74, v26, 4
    v_readlane_b32 s78, v22, 8
    v_readlane_b32 s71, v23, 0
    v_readlane_b32 s75, v27, 4
    v_readlane_b32 s79, v23, 8
    s_nop 1
    v_mov_b32 v10, s76
    v_mov_b32 v11, s77
    v_mov_b32 v12, s78
    v_mov_b32 v13, s79
    v_mul_f32 v20, s72, v10
    v_mul_f32 v24, s68, v10
    v_mul_f32 v21, s73, v11
    v_mul_f32 v25, s69, v11
    v_mul_f32 v22, s74, v12
    v_mul_f32 v26, s70, v12
    v_mul_f32 v23, s75, v13
    v_mul_f32 v27, s71, v13
    v_mov_b32 v16, 104448
    s_mov_b64 exec, 1
    ds_write_b128 v16, v[20:23]
    ds_write_b128 v16, v[24:27] offset:16
    s_mov_b64 exec, -1
    s_waitcnt vmcnt(0) lgkmcnt(0)
    s_barrier
p_convE:
    v_lshrrev_b32 v2, 6, v0
    s_lshl_b32 s44, s32, 16
    s_and_b32 s45, s32, 0xffff0000
    s_lshl_b32 s46, s33, 16
    s_and_b32 s47, s33, 0xffff0000
    v_mul_u32_u24 v17, 264, v2
    v_lshl_add_u32 v17, v1, 2, v17
    v_mul_u32_u24 v19, 272, v2
    v_lshlrev_b32 v18, 2, v1
    v_sub_u32 v19, v19, v18
    v_add_u32 v19, 4604, v19
    v_lshlrev_b32 v18, 4, v0
    v_add_u32 v18, 55296, v18
    v_mov_b32 v16, 104448
    ds_read_b32 v224, v19 offset:0
    ds_read_b32 v225, v19 offset:13824
    ds_read_b32 v226, v19 offset:27648
    ds_read_b32 v227, v19 offset:41472
    ds_read_b32 v228, v19 offset:2176
    ds_read_b32 v229, v19 offset:16000
    ds_read_b32 v230, v19 offset:29824
    ds_read_b32 v231, v19 offset:43648
    ds_read_b128 v[176:179], v18 offset:0
    ds_read_b128 v[144:147], v18 offset:16384
    ds_read_b128 v[180:183], v18 offset:8192
    ds_read_b128 v[148:151], v18 offset:24576
    ds_read_b128 v[160:163], v16
    ds_read_b128 v[164:167], v16 offset:16
    v_mov_b32 v28, s44
    v_mov_b32 v29, s45
    v_mov_b32 v30, s46
    v_mov_b32 v31, s47
    s_waitcnt lgkmcnt(0)
    s_barrier
    ds_read_b32 v48, v17 offset:0
    ds_read_b32 v49, v17 offset:13824
    ds_read_b32 v50, v17 offset:27648
    ds_read_b32 v51, v17 offset:41472
    ds_read_b32 v52, v17 offset:2112
    ds_read_b32 v53, v17 offset:15936
    ds_read_b32 v54, v17 offset:29760
    ds_read_b32 v55, v17 offset:43584
    v_lshlrev_b32 v68, 16, v224
    v_and_b32 v64, 0xffff0000, v224
    v_lshlrev_b32 v69, 16, v225
    v_and_b32 v65, 0xffff0000, v225
    v_lshlrev_b32 v70, 16, v226
    v_and_b32 v66, 0xffff0000, v226
    v_lshlrev_b32 v71, 16, v227
    v_and_b32 v67, 0xffff0000, v227
    v_lshlrev_b32 v112, 16, v176
    v_and_b32 v113, 0xffff0000, v176
    v_lshlrev_b32 v114, 16, v177
    v_and_b32 v115, 0xffff0000, v177
    v_lshlrev_b32 v116, 16, v178
    v_and_b32 v117, 0xffff0000, v178
    v_lshlrev_b32 v118, 16, v179
    v_and_b32 v119, 0xffff0000, v179
    v_pk_fma_f32 v[120:121], v[112:113], v[144:145], v[144:145] op_sel:[0,1,0] op_sel_hi:[1,1,0]
    v_pk_fma_f32 v[122:123], v[114:115], v[144:145], v[144:145] op_sel:[0,1,0] op_sel_hi:[1,1,0]
    v_pk_fma_f32 v[124:125], v[116:117], v[146:147], v[146:147] op_sel:[0,1,0] op_sel_hi:[1,1,0]
    v_pk_fma_f32 v[126:127], v[118:119], v[146:147], v[146:147] op_sel:[0,1,0] op_sel_hi:[1,1,0]
    v_pk_fma_f32 v[120:121], v[120:121], v[160:161], v[164:165]
    v_pk_fma_f32 v[122:123], v[122:123], v[162:163], v[166:167]
    v_pk_fma_f32 v[124:125], v[124:125], v[160:161], v[164:165]
    v_pk_fma_f32 v[126:127], v[126:127], v[162:163], v[166:167]
    v_lshlrev_b32 v88, 16, v228
    v_and_b32 v84, 0xffff0000, v228
    v_lshlrev_b32 v89, 16, v229
    v_and_b32 v85, 0xffff0000, v229
    v_lshlrev_b32 v90, 16, v230
    v_and_b32 v86, 0xffff0000, v230
    v_lshlrev_b32 v91, 16, v231
    v_and_b32 v87, 0xffff0000, v231
    v_lshlrev_b32 v128, 16, v180
    v_and_b32 v129, 0xffff0000, v180
    v_lshlrev_b32 v130, 16, v181
    v_and_b32 v131, 0xffff0000, v181
    v_lshlrev_b32 v132, 16, v182
    v_and_b32 v133, 0xffff0000, v182
    v_lshlrev_b32 v134, 16, v183
    v_and_b32 v135, 0xffff0000, v183
    v_pk_fma_f32 v[136:137], v[128:129], v[148:149], v[148:149] op_sel:[0,1,0] op_sel_hi:[1,1,0]
    v_pk_fma_f32 v[138:139], v[130:131], v[148:149], v[148:149] op_sel:[0,1,0] op_sel_hi:[1,1,0]
    v_pk_fma_f32 v[140:141], v[132:133], v[150:151], v[150:151] op_sel:[0,1,0] op_sel_hi:[1,1,0]
    v_pk_fma_f32 v[142:143], v[134:135], v[150:151], v[150:151] op_sel:[0,1,0] op_sel_hi:[1,1,0]
    v_pk_fma_f32 v[136:137], v[136:137], v[160:161], v[164:165]
    v_pk_fma_f32 v[138:139], v[138:139], v[162:163], v[166:167]
    v_pk_fma_f32 v[140:141], v[140:141], v[160:161], v[164:165]
    v_pk_fma_f32 v[142:143], v[142:143], v[162:163], v[166:167]
    s_waitcnt lgkmcnt(0)
    v_lshlrev_b32 v74, 16, v48
    v_and_b32 v78, 0xffff0000, v48
    v_lshlrev_b32 v75, 16, v49
    v_and_b32 v79, 0xffff0000, v49
    v_lshlrev_b32 v76, 16, v50
    v_and_b32 v80, 0xffff0000, v50
    v_lshlrev_b32 v77, 16, v51
    v_and_b32 v81, 0xffff0000, v51
    v_pk_fma_f32 v[64:65], v[64:65], v[28:29], v[74:75]
    v_pk_fma_f32 v[66:67], v[66:67], v[30:31], v[76:77]
    v_pk_fma_f32 v[68:69], v[68:69], v[28:29], v[78:79]
    v_pk_fma_f32 v[70:71], v[70:71], v[30:31], v[80:81]
    v_pk_fma_f32 v[64:65], v[64:65], v[120:121], v[112:113]
    v_pk_fma_f32 v[66:67], v[66:67], v[122:123], v[114:115]
    v_pk_fma_f32 v[68:69], v[68:69], v[124:125], v[116:117]
    v_pk_fma_f32 v[70:71], v[70:71], v[126:127], v[118:119]
    v_cvt_pk_bf16_f32 v208, v64, v65
    v_cvt_pk_bf16_f32 v209, v66, v67
    v_cvt_pk_bf16_f32 v210, v68, v69
    v_cvt_pk_bf16_f32 v211, v70, v71
    s_add_u32 s39, s38, 5492736
    buffer_store_dwordx4 v[208:211], v4, s[28:31], s39 offen sc1
    v_lshlrev_b32 v94, 16, v52
    v_and_b32 v98, 0xffff0000, v52
    v_lshlrev_b32 v95, 16, v53
    v_and_b32 v99, 0xffff0000, v53
    v_lshlrev_b32 v96, 16, v54
    v_and_b32 v100, 0xffff0000, v54
    v_lshlrev_b32 v97, 16, v55
    v_and_b32 v101, 0xffff0000, v55
    v_pk_fma_f32 v[84:85], v[84:85], v[28:29], v[94:95]
    v_pk_fma_f32 v[86:87], v[86:87], v[30:31], v[96:97]
    v_pk_fma_f32 v[88:89], v[88:89], v[28:29], v[98:99]
    v_pk_fma_f32 v[90:91], v[90:91], v[30:31], v[100:101]
    v_pk_fma_f32 v[84:85], v[84:85], v[136:137], v[128:129]
    v_pk_fma_f32 v[86:87], v[86:87], v[138:139], v[130:131]
    v_pk_fma_f32 v[88:89], v[88:89], v[140:141], v[132:133]
    v_pk_fma_f32 v[90:91], v[90:91], v[142:143], v[134:135]
    v_cvt_pk_bf16_f32 v212, v84, v85
    v_cvt_pk_bf16_f32 v213, v86, v87
    v_cvt_pk_bf16_f32 v214, v88, v89
    v_cvt_pk_bf16_f32 v215, v90, v91
    s_add_u32 s39, s38, 6803456
    buffer_store_dwordx4 v[212:215], v4, s[28:31], s39 offen sc1
    s_waitcnt vmcnt(0)
    s_endpgm
p_pack:
    s_sub_u32 s21, s2, 416
    s_mul_i32 s34, s20, 13824
    s_cmp_ge_u32 s20, 4
    s_cbranch_scc1 prep_end
    s_cmp_eq_u32 s20, 0
    s_cbranch_scc1 k1_pack
    s_cmp_eq_u32 s20, 1
    s_cbranch_scc0 p_pk2
    s_cmp_lt_u32 s21, 58
    s_cbranch_scc0 p_pk1
    s_add_u32 s21, s21, 96
    s_branch k1_pack
p_pk1:
    s_sub_u32 s21, s21, 58
    s_cmp_ge_u32 s21, 30
    s_cbranch_scc1 prep_end
    s_branch p_fin
p_pk2:
    s_sub_u32 s22, s20, 2
    s_mul_i32 s22, s22, 96
    s_add_u32 s21, s21, s22
    s_cmp_ge_u32 s21, 120
    s_cbranch_scc1 prep_end
    s_add_u32 s21, s21, 120
    v_mov_b32 v251, 0
    buffer_load_dword v250, v251, s[48:51], 0 offen sc1
    s_branch p_mod
p_fin:
    s_add_u32 s21, s21, 30
    v_mov_b32 v16, 0
    buffer_load_dword v17, v16, s[48:51], 0 offen sc1
    s_waitcnt vmcnt(0)
    s_mov_b32 s47, 0
prep_kernel_nn23:
    v_readfirstlane_b32 s46, v17
    s_add_u32 s47, s47, 1
    s_cmp_lg_u32 s46, 0
    s_cbranch_scc1 prep_kernel_nd24
    s_cmp_ge_u32 s47, 200000
    s_cbranch_scc1 prep_kernel_nd24
    buffer_load_dword v17, v16, s[48:51], 0 offen sc1
    s_waitcnt vmcnt(0)
    s_branch prep_kernel_nn23
prep_kernel_nd24:
    s_lshl_b32 s40, s21, 9
    s_add_u32 s40, s40, 29700096
    v_lshlrev_b32 v16, 7, v1
    s_mov_b32 s47, 0
    s_mov_b64 exec, 15
prep_kernel_pl25:
    buffer_load_dword v17, v16, s[28:31], s40 offen sc1
    s_add_u32 s47, s47, 1
    s_waitcnt vmcnt(0)
    v_cmp_ne_u32 vcc, s46, v17
    s_cmp_ge_u32 s47, 200000
    s_cbranch_scc1 prep_kernel_pd26
    s_cbranch_vccz prep_kernel_pd26
    s_sleep 14
    s_branch prep_kernel_pl25
prep_kernel_pd26:
    s_mov_b64 exec, -1
    v_lshlrev_b32 v7, 2, v1
    s_lshl_b32 s22, s21, 8
    s_add_u32 s23, s22, 2793472
    buffer_load_dword v10, v7, s[28:31], s23 offen sc1
    s_add_u32 s23, s23, 15360
    buffer_load_dword v11, v7, s[28:31], s23 offen sc1
    s_add_u32 s23, s23, 15360
    buffer_load_dword v12, v7, s[28:31], s23 offen sc1
    s_add_u32 s23, s23, 15360
    buffer_load_dword v13, v7, s[28:31], s23 offen sc1
    s_waitcnt vmcnt(0)
    v_add_f32 v10, v10, v11
    v_add_f32 v12, v12, v13
    s_nop 0
    v_add_f32 v10, v10, v12
    s_nop 0
    v_cvt_pk_bf16_f32 v10, v10, v10
    s_nop 0
    v_lshlrev_b32 v10, 16, v10
    s_sub_u32 s24, s21, 10
    s_cmp_lt_u32 s24, 10
    s_cbranch_scc1 prep_kernel_f127
    s_sub_u32 s24, s21, 40
    s_cmp_lt_u32 s24, 10
    s_cbranch_scc0 prep_kernel_f228
prep_kernel_f127:
    v_add_f32 v10, 1.0, v10
    s_nop 0
    v_cvt_pk_bf16_f32 v10, v10, v10
    s_nop 0
    v_lshlrev_b32 v10, 16, v10
prep_kernel_f228:
    s_add_u32 s22, s22, 8114176
    buffer_store_dword v10, v7, s[28:31], s22 offen sc1
    s_endpgm
k1_pack:
    v_lshrrev_b32 v3, 3, v1
    v_and_b32 v4, 7, v1
    v_mul_u32_u24 v5, 144, v3
    v_lshl_add_u32 v5, v4, 4, v5
    v_add_u32 v5, s34, v5
    v_and_b32 v6, 15, v1
    v_lshrrev_b32 v7, 4, v1
    v_lshrrev_b32 v8, 2, v6
    v_lshl_add_u32 v8, v7, 3, v8
    v_mul_u32_u24 v8, 144, v8
    v_and_b32 v9, 3, v6
    v_lshl_add_u32 v8, v9, 3, v8
    v_add_u32 v8, s34, v8
    v_lshlrev_b32 v9, 4, v1
    s_cmp_lt_u32 s21, 20
    s_cbranch_scc1 prep_kernel_pk29
    s_cmp_lt_u32 s21, 40
    s_cbranch_scc1 prep_kernel_pk30
    s_cmp_lt_u32 s21, 94
    s_cbranch_scc1 prep_kernel_pk31
    s_branch prep_kernel_pk32
prep_kernel_pk29:
    s_mov_b32 s24, s12
    s_mov_b32 s25, s13
    s_mov_b32 s26, 819200
    s_mov_b32 s27, 0x00020000
    s_sub_u32 s32, s21, 0
    s_mul_i32 s33, s32, 52429
    s_lshr_b32 s33, s33, 19
    s_mul_i32 s35, s33, 10
    s_sub_u32 s35, s32, s35
    v_mul_u32_u24 v10, 1280, v3
    v_lshl_add_u32 v10, v4, 4, v10
    s_mul_i32 s36, s33, 409600
    s_lshl_b32 s37, s35, 7
    s_add_u32 s36, s36, s37
    buffer_load_dwordx4 v[32:35], v10, s[24:27], s36 offen nt
    s_add_u32 s36, s36, 10240
    buffer_load_dwordx4 v[36:39], v10, s[24:27], s36 offen nt
    s_add_u32 s36, s36, 10240
    buffer_load_dwordx4 v[40:43], v10, s[24:27], s36 offen nt
    s_add_u32 s36, s36, 10240
    buffer_load_dwordx4 v[44:47], v10, s[24:27], s36 offen nt
    s_add_u32 s36, s36, 10240
    buffer_load_dwordx4 v[48:51], v10, s[24:27], s36 offen nt
    s_add_u32 s36, s36, 10240
    buffer_load_dwordx4 v[52:55], v10, s[24:27], s36 offen nt
    s_add_u32 s36, s36, 10240
    buffer_load_dwordx4 v[56:59], v10, s[24:27], s36 offen nt
    s_add_u32 s36, s36, 10240
    buffer_load_dwordx4 v[60:63], v10, s[24:27], s36 offen nt
    s_add_u32 s36, s36, 10240
    buffer_load_dwordx4 v[64:67], v10, s[24:27], s36 offen nt
    s_add_u32 s36, s36, 10240
    buffer_load_dwordx4 v[68:71], v10, s[24:27], s36 offen nt
    s_add_u32 s36, s36, 10240
    buffer_load_dwordx4 v[72:75], v10, s[24:27], s36 offen nt
    s_add_u32 s36, s36, 10240
    buffer_load_dwordx4 v[76:79], v10, s[24:27], s36 offen nt
    s_add_u32 s36, s36, 10240
    buffer_load_dwordx4 v[80:83], v10, s[24:27], s36 offen nt
    s_add_u32 s36, s36, 10240
    buffer_load_dwordx4 v[84:87], v10, s[24:27], s36 offen nt
    s_add_u32 s36, s36, 10240
    buffer_load_dwordx4 v[88:91], v10, s[24:27], s36 offen nt
    s_add_u32 s36, s36, 10240
    buffer_load_dwordx4 v[92:95], v10, s[24:27], s36 offen nt
    s_add_u32 s36, s36, 10240
    buffer_load_dwordx4 v[96:99], v10, s[24:27], s36 offen nt
    s_add_u32 s36, s36, 10240
    buffer_load_dwordx4 v[100:103], v10, s[24:27], s36 offen nt
    s_add_u32 s36, s36, 10240
    buffer_load_dwordx4 v[104:107], v10, s[24:27], s36 offen nt
    s_add_u32 s36, s36, 10240
    buffer_load_dwordx4 v[108:111], v10, s[24:27], s36 offen nt
    s_add_u32 s36, s36, 10240
    buffer_load_dwordx4 v[112:115], v10, s[24:27], s36 offen nt
    s_add_u32 s36, s36, 10240
    buffer_load_dwordx4 v[116:119], v10, s[24:27], s36 offen nt
    s_add_u32 s36, s36, 10240
    buffer_load_dwordx4 v[120:123], v10, s[24:27], s36 offen nt
    s_add_u32 s36, s36, 10240
    buffer_load_dwordx4 v[124:127], v10, s[24:27], s36 offen nt
    s_add_u32 s36, s36, 10240
    buffer_load_dwordx4 v[128:131], v10, s[24:27], s36 offen nt
    s_add_u32 s36, s36, 10240
    buffer_load_dwordx4 v[132:135], v10, s[24:27], s36 offen nt
    s_add_u32 s36, s36, 10240
    buffer_load_dwordx4 v[136:139], v10, s[24:27], s36 offen nt
    s_add_u32 s36, s36, 10240
    buffer_load_dwordx4 v[140:143], v10, s[24:27], s36 offen nt
    s_add_u32 s36, s36, 10240
    buffer_load_dwordx4 v[144:147], v10, s[24:27], s36 offen nt
    s_add_u32 s36, s36, 10240
    buffer_load_dwordx4 v[148:151], v10, s[24:27], s36 offen nt
    s_add_u32 s36, s36, 10240
    buffer_load_dwordx4 v[152:155], v10, s[24:27], s36 offen nt
    s_add_u32 s36, s36, 10240
    buffer_load_dwordx4 v[156:159], v10, s[24:27], s36 offen nt
    s_add_u32 s36, s36, 10240
    buffer_load_dwordx4 v[160:163], v10, s[24:27], s36 offen nt
    s_add_u32 s36, s36, 10240
    buffer_load_dwordx4 v[164:167], v10, s[24:27], s36 offen nt
    s_add_u32 s36, s36, 10240
    buffer_load_dwordx4 v[168:171], v10, s[24:27], s36 offen nt
    s_add_u32 s36, s36, 10240
    buffer_load_dwordx4 v[172:175], v10, s[24:27], s36 offen nt
    s_add_u32 s36, s36, 10240
    buffer_load_dwordx4 v[176:179], v10, s[24:27], s36 offen nt
    s_add_u32 s36, s36, 10240
    buffer_load_dwordx4 v[180:183], v10, s[24:27], s36 offen nt
    s_add_u32 s36, s36, 10240
    buffer_load_dwordx4 v[184:187], v10, s[24:27], s36 offen nt
    s_add_u32 s36, s36, 10240
    buffer_load_dwordx4 v[188:191], v10, s[24:27], s36 offen nt
    s_lshl_b32 s36, s35, 2
    s_add_u32 s36, s36, 0
    s_mul_i32 s38, s36, 6554
    s_lshr_b32 s38, s38, 16
    s_mul_i32 s39, s38, 10
    s_sub_u32 s39, s36, s39
    s_cmp_ge_u32 s39, 5
    s_cselect_b32 s40, 1, 0
    s_sub_u32 s41, s39, 6
    s_cmp_eq_u32 s39, 5
    s_cselect_b32 s41, 4, s41
    s_cmp_eq_u32 s40, 1
    s_cselect_b32 s39, s41, s39
    s_mul_i32 s37, s38, 200
    s_mul_i32 s40, s40, 100
    s_add_u32 s37, s37, s40
    s_mul_i32 s40, s33, 50
    s_add_u32 s37, s37, s40
    s_add_u32 s37, s37, s39
    s_lshl_b32 s37, s37, 10
    s_add_u32 s44, s37, 23236608
    s_movk_i32 s48, 5120
    s_lshl_b32 s36, s35, 2
    s_add_u32 s36, s36, 1
    s_mul_i32 s38, s36, 6554
    s_lshr_b32 s38, s38, 16
    s_mul_i32 s39, s38, 10
    s_sub_u32 s39, s36, s39
    s_cmp_ge_u32 s39, 5
    s_cselect_b32 s40, 1, 0
    s_sub_u32 s41, s39, 6
    s_cmp_eq_u32 s39, 5
    s_cselect_b32 s41, 4, s41
    s_cmp_eq_u32 s40, 1
    s_cselect_b32 s39, s41, s39
    s_mul_i32 s37, s38, 200
    s_mul_i32 s40, s40, 100
    s_add_u32 s37, s37, s40
    s_mul_i32 s40, s33, 50
    s_add_u32 s37, s37, s40
    s_add_u32 s37, s37, s39
    s_lshl_b32 s37, s37, 10
    s_add_u32 s45, s37, 23236608
    s_movk_i32 s49, 5120
    s_lshl_b32 s36, s35, 2
    s_add_u32 s36, s36, 2
    s_mul_i32 s38, s36, 6554
    s_lshr_b32 s38, s38, 16
    s_mul_i32 s39, s38, 10
    s_sub_u32 s39, s36, s39
    s_cmp_ge_u32 s39, 5
    s_cselect_b32 s40, 1, 0
    s_sub_u32 s41, s39, 6
    s_cmp_eq_u32 s39, 5
    s_cselect_b32 s41, 4, s41
    s_cmp_eq_u32 s40, 1
    s_cselect_b32 s39, s41, s39
    s_mul_i32 s37, s38, 200
    s_mul_i32 s40, s40, 100
    s_add_u32 s37, s37, s40
    s_mul_i32 s40, s33, 50
    s_add_u32 s37, s37, s40
    s_add_u32 s37, s37, s39
    s_lshl_b32 s37, s37, 10
    s_add_u32 s46, s37, 23236608
    s_movk_i32 s50, 5120
    s_lshl_b32 s36, s35, 2
    s_add_u32 s36, s36, 3
    s_mul_i32 s38, s36, 6554
    s_lshr_b32 s38, s38, 16
    s_mul_i32 s39, s38, 10
    s_sub_u32 s39, s36, s39
    s_cmp_ge_u32 s39, 5
    s_cselect_b32 s40, 1, 0
    s_sub_u32 s41, s39, 6
    s_cmp_eq_u32 s39, 5
    s_cselect_b32 s41, 4, s41
    s_cmp_eq_u32 s40, 1
    s_cselect_b32 s39, s41, s39
    s_mul_i32 s37, s38, 200
    s_mul_i32 s40, s40, 100
    s_add_u32 s37, s37, s40
    s_mul_i32 s40, s33, 50
    s_add_u32 s37, s37, s40
    s_add_u32 s37, s37, s39
    s_lshl_b32 s37, s37, 10
    s_add_u32 s47, s37, 23236608
    s_movk_i32 s51, 5120
    v_mov_b32 v12, 0
    v_mov_b32 v13, 0
    v_mov_b32 v14, 0
    v_mov_b32 v15, 0
    v_mov_b32 v16, 0x3f803f80
    s_waitcnt vmcnt(36)
    ds_write_b128 v5, v[32:35] offset:0
    ds_write_b128 v5, v[36:39] offset:1152
    ds_write_b128 v5, v[40:43] offset:2304
    ds_write_b128 v5, v[44:47] offset:3456
    s_waitcnt lgkmcnt(0)
    ds_read_b64_tr_b16 v[200:201], v8 offset:0
    ds_read_b64_tr_b16 v[202:203], v8 offset:576
    ds_read_b64_tr_b16 v[204:205], v8 offset:32
    ds_read_b64_tr_b16 v[206:207], v8 offset:608
    ds_read_b64_tr_b16 v[208:209], v8 offset:64
    ds_read_b64_tr_b16 v[210:211], v8 offset:640
    ds_read_b64_tr_b16 v[212:213], v8 offset:96
    ds_read_b64_tr_b16 v[214:215], v8 offset:672
    s_waitcnt vmcnt(32)
    ds_write_b128 v5, v[48:51] offset:4608
    ds_write_b128 v5, v[52:55] offset:5760
    ds_write_b128 v5, v[56:59] offset:6912
    ds_write_b128 v5, v[60:63] offset:8064
    s_waitcnt lgkmcnt(4)
    buffer_store_dwordx4 v[200:203], v9, s[28:31], s44 offen sc1
    s_add_u32 s44, s44, s48
    v_dot2_f32_bf16 v12, v200, v16, v12
    v_dot2_f32_bf16 v12, v201, v16, v12
    v_dot2_f32_bf16 v12, v202, v16, v12
    v_dot2_f32_bf16 v12, v203, v16, v12
    buffer_store_dwordx4 v[204:207], v9, s[28:31], s45 offen sc1
    s_add_u32 s45, s45, s49
    v_dot2_f32_bf16 v13, v204, v16, v13
    v_dot2_f32_bf16 v13, v205, v16, v13
    v_dot2_f32_bf16 v13, v206, v16, v13
    v_dot2_f32_bf16 v13, v207, v16, v13
    buffer_store_dwordx4 v[208:211], v9, s[28:31], s46 offen sc1
    s_add_u32 s46, s46, s50
    v_dot2_f32_bf16 v14, v208, v16, v14
    v_dot2_f32_bf16 v14, v209, v16, v14
    v_dot2_f32_bf16 v14, v210, v16, v14
    v_dot2_f32_bf16 v14, v211, v16, v14
    buffer_store_dwordx4 v[212:215], v9, s[28:31], s47 offen sc1
    s_add_u32 s47, s47, s51
    v_dot2_f32_bf16 v15, v212, v16, v15
    v_dot2_f32_bf16 v15, v213, v16, v15
    v_dot2_f32_bf16 v15, v214, v16, v15
    v_dot2_f32_bf16 v15, v215, v16, v15
    s_waitcnt lgkmcnt(0)
    ds_read_b64_tr_b16 v[216:217], v8 offset:4608
    ds_read_b64_tr_b16 v[218:219], v8 offset:5184
    ds_read_b64_tr_b16 v[220:221], v8 offset:4640
    ds_read_b64_tr_b16 v[222:223], v8 offset:5216
    ds_read_b64_tr_b16 v[224:225], v8 offset:4672
    ds_read_b64_tr_b16 v[226:227], v8 offset:5248
    ds_read_b64_tr_b16 v[228:229], v8 offset:4704
    ds_read_b64_tr_b16 v[230:231], v8 offset:5280
    s_waitcnt vmcnt(32)
    ds_write_b128 v5, v[64:67] offset:0
    ds_write_b128 v5, v[68:71] offset:1152
    ds_write_b128 v5, v[72:75] offset:2304
    ds_write_b128 v5, v[76:79] offset:3456
    s_waitcnt lgkmcnt(4)
    buffer_store_dwordx4 v[216:219], v9, s[28:31], s44 offen sc1
    s_add_u32 s44, s44, s48
    v_dot2_f32_bf16 v12, v216, v16, v12
    v_dot2_f32_bf16 v12, v217, v16, v12
    v_dot2_f32_bf16 v12, v218, v16, v12
    v_dot2_f32_bf16 v12, v219, v16, v12
    buffer_store_dwordx4 v[220:223], v9, s[28:31], s45 offen sc1
    s_add_u32 s45, s45, s49
    v_dot2_f32_bf16 v13, v220, v16, v13
    v_dot2_f32_bf16 v13, v221, v16, v13
    v_dot2_f32_bf16 v13, v222, v16, v13
    v_dot2_f32_bf16 v13, v223, v16, v13
    buffer_store_dwordx4 v[224:227], v9, s[28:31], s46 offen sc1
    s_add_u32 s46, s46, s50
    v_dot2_f32_bf16 v14, v224, v16, v14
    v_dot2_f32_bf16 v14, v225, v16, v14
    v_dot2_f32_bf16 v14, v226, v16, v14
    v_dot2_f32_bf16 v14, v227, v16, v14
    buffer_store_dwordx4 v[228:231], v9, s[28:31], s47 offen sc1
    s_add_u32 s47, s47, s51
    v_dot2_f32_bf16 v15, v228, v16, v15
    v_dot2_f32_bf16 v15, v229, v16, v15
    v_dot2_f32_bf16 v15, v230, v16, v15
    v_dot2_f32_bf16 v15, v231, v16, v15
    s_waitcnt lgkmcnt(0)
    ds_read_b64_tr_b16 v[200:201], v8 offset:0
    ds_read_b64_tr_b16 v[202:203], v8 offset:576
    ds_read_b64_tr_b16 v[204:205], v8 offset:32
    ds_read_b64_tr_b16 v[206:207], v8 offset:608
    ds_read_b64_tr_b16 v[208:209], v8 offset:64
    ds_read_b64_tr_b16 v[210:211], v8 offset:640
    ds_read_b64_tr_b16 v[212:213], v8 offset:96
    ds_read_b64_tr_b16 v[214:215], v8 offset:672
    s_waitcnt vmcnt(32)
    ds_write_b128 v5, v[80:83] offset:4608
    ds_write_b128 v5, v[84:87] offset:5760
    ds_write_b128 v5, v[88:91] offset:6912
    ds_write_b128 v5, v[92:95] offset:8064
    s_waitcnt lgkmcnt(4)
    buffer_store_dwordx4 v[200:203], v9, s[28:31], s44 offen sc1
    s_add_u32 s44, s44, s48
    v_dot2_f32_bf16 v12, v200, v16, v12
    v_dot2_f32_bf16 v12, v201, v16, v12
    v_dot2_f32_bf16 v12, v202, v16, v12
    v_dot2_f32_bf16 v12, v203, v16, v12
    buffer_store_dwordx4 v[204:207], v9, s[28:31], s45 offen sc1
    s_add_u32 s45, s45, s49
    v_dot2_f32_bf16 v13, v204, v16, v13
    v_dot2_f32_bf16 v13, v205, v16, v13
    v_dot2_f32_bf16 v13, v206, v16, v13
    v_dot2_f32_bf16 v13, v207, v16, v13
    buffer_store_dwordx4 v[208:211], v9, s[28:31], s46 offen sc1
    s_add_u32 s46, s46, s50
    v_dot2_f32_bf16 v14, v208, v16, v14
    v_dot2_f32_bf16 v14, v209, v16, v14
    v_dot2_f32_bf16 v14, v210, v16, v14
    v_dot2_f32_bf16 v14, v211, v16, v14
    buffer_store_dwordx4 v[212:215], v9, s[28:31], s47 offen sc1
    s_add_u32 s47, s47, s51
    v_dot2_f32_bf16 v15, v212, v16, v15
    v_dot2_f32_bf16 v15, v213, v16, v15
    v_dot2_f32_bf16 v15, v214, v16, v15
    v_dot2_f32_bf16 v15, v215, v16, v15
    s_waitcnt lgkmcnt(0)
    ds_read_b64_tr_b16 v[216:217], v8 offset:4608
    ds_read_b64_tr_b16 v[218:219], v8 offset:5184
    ds_read_b64_tr_b16 v[220:221], v8 offset:4640
    ds_read_b64_tr_b16 v[222:223], v8 offset:5216
    ds_read_b64_tr_b16 v[224:225], v8 offset:4672
    ds_read_b64_tr_b16 v[226:227], v8 offset:5248
    ds_read_b64_tr_b16 v[228:229], v8 offset:4704
    ds_read_b64_tr_b16 v[230:231], v8 offset:5280
    s_waitcnt vmcnt(32)
    ds_write_b128 v5, v[96:99] offset:0
    ds_write_b128 v5, v[100:103] offset:1152
    ds_write_b128 v5, v[104:107] offset:2304
    ds_write_b128 v5, v[108:111] offset:3456
    s_waitcnt lgkmcnt(4)
    buffer_store_dwordx4 v[216:219], v9, s[28:31], s44 offen sc1
    s_add_u32 s44, s44, s48
    v_dot2_f32_bf16 v12, v216, v16, v12
    v_dot2_f32_bf16 v12, v217, v16, v12
    v_dot2_f32_bf16 v12, v218, v16, v12
    v_dot2_f32_bf16 v12, v219, v16, v12
    buffer_store_dwordx4 v[220:223], v9, s[28:31], s45 offen sc1
    s_add_u32 s45, s45, s49
    v_dot2_f32_bf16 v13, v220, v16, v13
    v_dot2_f32_bf16 v13, v221, v16, v13
    v_dot2_f32_bf16 v13, v222, v16, v13
    v_dot2_f32_bf16 v13, v223, v16, v13
    buffer_store_dwordx4 v[224:227], v9, s[28:31], s46 offen sc1
    s_add_u32 s46, s46, s50
    v_dot2_f32_bf16 v14, v224, v16, v14
    v_dot2_f32_bf16 v14, v225, v16, v14
    v_dot2_f32_bf16 v14, v226, v16, v14
    v_dot2_f32_bf16 v14, v227, v16, v14
    buffer_store_dwordx4 v[228:231], v9, s[28:31], s47 offen sc1
    s_add_u32 s47, s47, s51
    v_dot2_f32_bf16 v15, v228, v16, v15
    v_dot2_f32_bf16 v15, v229, v16, v15
    v_dot2_f32_bf16 v15, v230, v16, v15
    v_dot2_f32_bf16 v15, v231, v16, v15
    s_waitcnt lgkmcnt(0)
    ds_read_b64_tr_b16 v[200:201], v8 offset:0
    ds_read_b64_tr_b16 v[202:203], v8 offset:576
    ds_read_b64_tr_b16 v[204:205], v8 offset:32
    ds_read_b64_tr_b16 v[206:207], v8 offset:608
    ds_read_b64_tr_b16 v[208:209], v8 offset:64
    ds_read_b64_tr_b16 v[210:211], v8 offset:640
    ds_read_b64_tr_b16 v[212:213], v8 offset:96
    ds_read_b64_tr_b16 v[214:215], v8 offset:672
    s_waitcnt vmcnt(32)
    ds_write_b128 v5, v[112:115] offset:4608
    ds_write_b128 v5, v[116:119] offset:5760
    ds_write_b128 v5, v[120:123] offset:6912
    ds_write_b128 v5, v[124:127] offset:8064
    s_waitcnt lgkmcnt(4)
    buffer_store_dwordx4 v[200:203], v9, s[28:31], s44 offen sc1
    s_add_u32 s44, s44, s48
    v_dot2_f32_bf16 v12, v200, v16, v12
    v_dot2_f32_bf16 v12, v201, v16, v12
    v_dot2_f32_bf16 v12, v202, v16, v12
    v_dot2_f32_bf16 v12, v203, v16, v12
    buffer_store_dwordx4 v[204:207], v9, s[28:31], s45 offen sc1
    s_add_u32 s45, s45, s49
    v_dot2_f32_bf16 v13, v204, v16, v13
    v_dot2_f32_bf16 v13, v205, v16, v13
    v_dot2_f32_bf16 v13, v206, v16, v13
    v_dot2_f32_bf16 v13, v207, v16, v13
    buffer_store_dwordx4 v[208:211], v9, s[28:31], s46 offen sc1
    s_add_u32 s46, s46, s50
    v_dot2_f32_bf16 v14, v208, v16, v14
    v_dot2_f32_bf16 v14, v209, v16, v14
    v_dot2_f32_bf16 v14, v210, v16, v14
    v_dot2_f32_bf16 v14, v211, v16, v14
    buffer_store_dwordx4 v[212:215], v9, s[28:31], s47 offen sc1
    s_add_u32 s47, s47, s51
    v_dot2_f32_bf16 v15, v212, v16, v15
    v_dot2_f32_bf16 v15, v213, v16, v15
    v_dot2_f32_bf16 v15, v214, v16, v15
    v_dot2_f32_bf16 v15, v215, v16, v15
    s_waitcnt lgkmcnt(0)
    ds_read_b64_tr_b16 v[216:217], v8 offset:4608
    ds_read_b64_tr_b16 v[218:219], v8 offset:5184
    ds_read_b64_tr_b16 v[220:221], v8 offset:4640
    ds_read_b64_tr_b16 v[222:223], v8 offset:5216
    ds_read_b64_tr_b16 v[224:225], v8 offset:4672
    ds_read_b64_tr_b16 v[226:227], v8 offset:5248
    ds_read_b64_tr_b16 v[228:229], v8 offset:4704
    ds_read_b64_tr_b16 v[230:231], v8 offset:5280
    s_waitcnt vmcnt(32)
    ds_write_b128 v5, v[128:131] offset:0
    ds_write_b128 v5, v[132:135] offset:1152
    ds_write_b128 v5, v[136:139] offset:2304
    ds_write_b128 v5, v[140:143] offset:3456
    s_waitcnt lgkmcnt(4)
    buffer_store_dwordx4 v[216:219], v9, s[28:31], s44 offen sc1
    s_add_u32 s44, s44, s48
    v_dot2_f32_bf16 v12, v216, v16, v12
    v_dot2_f32_bf16 v12, v217, v16, v12
    v_dot2_f32_bf16 v12, v218, v16, v12
    v_dot2_f32_bf16 v12, v219, v16, v12
    buffer_store_dwordx4 v[220:223], v9, s[28:31], s45 offen sc1
    s_add_u32 s45, s45, s49
    v_dot2_f32_bf16 v13, v220, v16, v13
    v_dot2_f32_bf16 v13, v221, v16, v13
    v_dot2_f32_bf16 v13, v222, v16, v13
    v_dot2_f32_bf16 v13, v223, v16, v13
    buffer_store_dwordx4 v[224:227], v9, s[28:31], s46 offen sc1
    s_add_u32 s46, s46, s50
    v_dot2_f32_bf16 v14, v224, v16, v14
    v_dot2_f32_bf16 v14, v225, v16, v14
    v_dot2_f32_bf16 v14, v226, v16, v14
    v_dot2_f32_bf16 v14, v227, v16, v14
    buffer_store_dwordx4 v[228:231], v9, s[28:31], s47 offen sc1
    s_add_u32 s47, s47, s51
    v_dot2_f32_bf16 v15, v228, v16, v15
    v_dot2_f32_bf16 v15, v229, v16, v15
    v_dot2_f32_bf16 v15, v230, v16, v15
    v_dot2_f32_bf16 v15, v231, v16, v15
    s_waitcnt lgkmcnt(0)
    ds_read_b64_tr_b16 v[200:201], v8 offset:0
    ds_read_b64_tr_b16 v[202:203], v8 offset:576
    ds_read_b64_tr_b16 v[204:205], v8 offset:32
    ds_read_b64_tr_b16 v[206:207], v8 offset:608
    ds_read_b64_tr_b16 v[208:209], v8 offset:64
    ds_read_b64_tr_b16 v[210:211], v8 offset:640
    ds_read_b64_tr_b16 v[212:213], v8 offset:96
    ds_read_b64_tr_b16 v[214:215], v8 offset:672
    s_waitcnt vmcnt(32)
    ds_write_b128 v5, v[144:147] offset:4608
    ds_write_b128 v5, v[148:151] offset:5760
    ds_write_b128 v5, v[152:155] offset:6912
    ds_write_b128 v5, v[156:159] offset:8064
    s_waitcnt lgkmcnt(4)
    buffer_store_dwordx4 v[200:203], v9, s[28:31], s44 offen sc1
    s_add_u32 s44, s44, s48
    v_dot2_f32_bf16 v12, v200, v16, v12
    v_dot2_f32_bf16 v12, v201, v16, v12
    v_dot2_f32_bf16 v12, v202, v16, v12
    v_dot2_f32_bf16 v12, v203, v16, v12
    buffer_store_dwordx4 v[204:207], v9, s[28:31], s45 offen sc1
    s_add_u32 s45, s45, s49
    v_dot2_f32_bf16 v13, v204, v16, v13
    v_dot2_f32_bf16 v13, v205, v16, v13
    v_dot2_f32_bf16 v13, v206, v16, v13
    v_dot2_f32_bf16 v13, v207, v16, v13
    buffer_store_dwordx4 v[208:211], v9, s[28:31], s46 offen sc1
    s_add_u32 s46, s46, s50
    v_dot2_f32_bf16 v14, v208, v16, v14
    v_dot2_f32_bf16 v14, v209, v16, v14
    v_dot2_f32_bf16 v14, v210, v16, v14
    v_dot2_f32_bf16 v14, v211, v16, v14
    buffer_store_dwordx4 v[212:215], v9, s[28:31], s47 offen sc1
    s_add_u32 s47, s47, s51
    v_dot2_f32_bf16 v15, v212, v16, v15
    v_dot2_f32_bf16 v15, v213, v16, v15
    v_dot2_f32_bf16 v15, v214, v16, v15
    v_dot2_f32_bf16 v15, v215, v16, v15
    s_waitcnt lgkmcnt(0)
    ds_read_b64_tr_b16 v[216:217], v8 offset:4608
    ds_read_b64_tr_b16 v[218:219], v8 offset:5184
    ds_read_b64_tr_b16 v[220:221], v8 offset:4640
    ds_read_b64_tr_b16 v[222:223], v8 offset:5216
    ds_read_b64_tr_b16 v[224:225], v8 offset:4672
    ds_read_b64_tr_b16 v[226:227], v8 offset:5248
    ds_read_b64_tr_b16 v[228:229], v8 offset:4704
    ds_read_b64_tr_b16 v[230:231], v8 offset:5280
    s_waitcnt vmcnt(32)
    ds_write_b128 v5, v[160:163] offset:0
    ds_write_b128 v5, v[164:167] offset:1152
    ds_write_b128 v5, v[168:171] offset:2304
    ds_write_b128 v5, v[172:175] offset:3456
    s_waitcnt lgkmcnt(4)
    buffer_store_dwordx4 v[216:219], v9, s[28:31], s44 offen sc1
    s_add_u32 s44, s44, s48
    v_dot2_f32_bf16 v12, v216, v16, v12
    v_dot2_f32_bf16 v12, v217, v16, v12
    v_dot2_f32_bf16 v12, v218, v16, v12
    v_dot2_f32_bf16 v12, v219, v16, v12
    buffer_store_dwordx4 v[220:223], v9, s[28:31], s45 offen sc1
    s_add_u32 s45, s45, s49
    v_dot2_f32_bf16 v13, v220, v16, v13
    v_dot2_f32_bf16 v13, v221, v16, v13
    v_dot2_f32_bf16 v13, v222, v16, v13
    v_dot2_f32_bf16 v13, v223, v16, v13
    buffer_store_dwordx4 v[224:227], v9, s[28:31], s46 offen sc1
    s_add_u32 s46, s46, s50
    v_dot2_f32_bf16 v14, v224, v16, v14
    v_dot2_f32_bf16 v14, v225, v16, v14
    v_dot2_f32_bf16 v14, v226, v16, v14
    v_dot2_f32_bf16 v14, v227, v16, v14
    buffer_store_dwordx4 v[228:231], v9, s[28:31], s47 offen sc1
    s_add_u32 s47, s47, s51
    v_dot2_f32_bf16 v15, v228, v16, v15
    v_dot2_f32_bf16 v15, v229, v16, v15
    v_dot2_f32_bf16 v15, v230, v16, v15
    v_dot2_f32_bf16 v15, v231, v16, v15
    s_waitcnt lgkmcnt(0)
    ds_read_b64_tr_b16 v[200:201], v8 offset:0
    ds_read_b64_tr_b16 v[202:203], v8 offset:576
    ds_read_b64_tr_b16 v[204:205], v8 offset:32
    ds_read_b64_tr_b16 v[206:207], v8 offset:608
    ds_read_b64_tr_b16 v[208:209], v8 offset:64
    ds_read_b64_tr_b16 v[210:211], v8 offset:640
    ds_read_b64_tr_b16 v[212:213], v8 offset:96
    ds_read_b64_tr_b16 v[214:215], v8 offset:672
    s_waitcnt vmcnt(32)
    ds_write_b128 v5, v[176:179] offset:4608
    ds_write_b128 v5, v[180:183] offset:5760
    ds_write_b128 v5, v[184:187] offset:6912
    ds_write_b128 v5, v[188:191] offset:8064
    s_waitcnt lgkmcnt(4)
    buffer_store_dwordx4 v[200:203], v9, s[28:31], s44 offen sc1
    s_add_u32 s44, s44, s48
    v_dot2_f32_bf16 v12, v200, v16, v12
    v_dot2_f32_bf16 v12, v201, v16, v12
    v_dot2_f32_bf16 v12, v202, v16, v12
    v_dot2_f32_bf16 v12, v203, v16, v12
    buffer_store_dwordx4 v[204:207], v9, s[28:31], s45 offen sc1
    s_add_u32 s45, s45, s49
    v_dot2_f32_bf16 v13, v204, v16, v13
    v_dot2_f32_bf16 v13, v205, v16, v13
    v_dot2_f32_bf16 v13, v206, v16, v13
    v_dot2_f32_bf16 v13, v207, v16, v13
    buffer_store_dwordx4 v[208:211], v9, s[28:31], s46 offen sc1
    s_add_u32 s46, s46, s50
    v_dot2_f32_bf16 v14, v208, v16, v14
    v_dot2_f32_bf16 v14, v209, v16, v14
    v_dot2_f32_bf16 v14, v210, v16, v14
    v_dot2_f32_bf16 v14, v211, v16, v14
    buffer_store_dwordx4 v[212:215], v9, s[28:31], s47 offen sc1
    s_add_u32 s47, s47, s51
    v_dot2_f32_bf16 v15, v212, v16, v15
    v_dot2_f32_bf16 v15, v213, v16, v15
    v_dot2_f32_bf16 v15, v214, v16, v15
    v_dot2_f32_bf16 v15, v215, v16, v15
    s_waitcnt lgkmcnt(0)
    ds_read_b64_tr_b16 v[216:217], v8 offset:4608
    ds_read_b64_tr_b16 v[218:219], v8 offset:5184
    ds_read_b64_tr_b16 v[220:221], v8 offset:4640
    ds_read_b64_tr_b16 v[222:223], v8 offset:5216
    ds_read_b64_tr_b16 v[224:225], v8 offset:4672
    ds_read_b64_tr_b16 v[226:227], v8 offset:5248
    ds_read_b64_tr_b16 v[228:229], v8 offset:4704
    ds_read_b64_tr_b16 v[230:231], v8 offset:5280
    s_waitcnt lgkmcnt(0)
    buffer_store_dwordx4 v[216:219], v9, s[28:31], s44 offen sc1
    s_add_u32 s44, s44, s48
    v_dot2_f32_bf16 v12, v216, v16, v12
    v_dot2_f32_bf16 v12, v217, v16, v12
    v_dot2_f32_bf16 v12, v218, v16, v12
    v_dot2_f32_bf16 v12, v219, v16, v12
    buffer_store_dwordx4 v[220:223], v9, s[28:31], s45 offen sc1
    s_add_u32 s45, s45, s49
    v_dot2_f32_bf16 v13, v220, v16, v13
    v_dot2_f32_bf16 v13, v221, v16, v13
    v_dot2_f32_bf16 v13, v222, v16, v13
    v_dot2_f32_bf16 v13, v223, v16, v13
    buffer_store_dwordx4 v[224:227], v9, s[28:31], s46 offen sc1
    s_add_u32 s46, s46, s50
    v_dot2_f32_bf16 v14, v224, v16, v14
    v_dot2_f32_bf16 v14, v225, v16, v14
    v_dot2_f32_bf16 v14, v226, v16, v14
    v_dot2_f32_bf16 v14, v227, v16, v14
    buffer_store_dwordx4 v[228:231], v9, s[28:31], s47 offen sc1
    s_add_u32 s47, s47, s51
    v_dot2_f32_bf16 v15, v228, v16, v15
    v_dot2_f32_bf16 v15, v229, v16, v15
    v_dot2_f32_bf16 v15, v230, v16, v15
    v_dot2_f32_bf16 v15, v231, v16, v15
    s_nop 2
    v_mov_b32 v20, v12
    v_mov_b32 v21, v13
    v_mov_b32 v22, v14
    v_mov_b32 v23, v15
    s_nop 1
    v_permlane32_swap_b32 v20, v12
    v_permlane32_swap_b32 v21, v13
    v_permlane32_swap_b32 v22, v14
    v_permlane32_swap_b32 v23, v15
    s_nop 1
    v_add_f32 v12, v12, v20
    v_add_f32 v13, v13, v21
    v_add_f32 v14, v14, v22
    v_add_f32 v15, v15, v23
    v_mov_b32 v20, v12
    v_mov_b32 v21, v13
    v_mov_b32 v22, v14
    v_mov_b32 v23, v15
    s_nop 1
    v_permlane16_swap_b32 v20, v12
    v_permlane16_swap_b32 v21, v13
    v_permlane16_swap_b32 v22, v14
    v_permlane16_swap_b32 v23, v15
    s_nop 1
    v_add_f32 v12, v12, v20
    v_add_f32 v13, v13, v21
    v_add_f32 v14, v14, v22
    v_add_f32 v15, v15, v23
    s_mul_i32 s38, s33, 7168
    s_lshl_b32 s39, s35, 8
    s_add_u32 s38, s38, s39
    s_add_u32 s38, s38, 8146944
    v_lshlrev_b32 v17, 2, v1
    s_mov_b64 exec, 0xffff
    buffer_store_dword v12, v17, s[28:31], s38 offen offset:0 sc1
    buffer_store_dword v13, v17, s[28:31], s38 offen offset:64 sc1
    buffer_store_dword v14, v17, s[28:31], s38 offen offset:128 sc1
    buffer_store_dword v15, v17, s[28:31], s38 offen offset:192 sc1
    s_endpgm
prep_kernel_pk30:
    s_mov_b32 s24, s14
    s_mov_b32 s25, s15
    s_mov_b32 s26, 819200
    s_mov_b32 s27, 0x00020000
    s_sub_u32 s32, s21, 20
    s_mul_i32 s33, s32, 52429
    s_lshr_b32 s33, s33, 19
    s_mul_i32 s35, s33, 10
    s_sub_u32 s35, s32, s35
    v_mul_u32_u24 v10, 1280, v3
    v_lshl_add_u32 v10, v4, 4, v10
    s_mul_i32 s36, s33, 409600
    s_lshl_b32 s37, s35, 7
    s_add_u32 s36, s36, s37
    buffer_load_dwordx4 v[32:35], v10, s[24:27], s36 offen nt
    s_add_u32 s36, s36, 10240
    buffer_load_dwordx4 v[36:39], v10, s[24:27], s36 offen nt
    s_add_u32 s36, s36, 10240
    buffer_load_dwordx4 v[40:43], v10, s[24:27], s36 offen nt
    s_add_u32 s36, s36, 10240
    buffer_load_dwordx4 v[44:47], v10, s[24:27], s36 offen nt
    s_add_u32 s36, s36, 10240
    buffer_load_dwordx4 v[48:51], v10, s[24:27], s36 offen nt
    s_add_u32 s36, s36, 10240
    buffer_load_dwordx4 v[52:55], v10, s[24:27], s36 offen nt
    s_add_u32 s36, s36, 10240
    buffer_load_dwordx4 v[56:59], v10, s[24:27], s36 offen nt
    s_add_u32 s36, s36, 10240
    buffer_load_dwordx4 v[60:63], v10, s[24:27], s36 offen nt
    s_add_u32 s36, s36, 10240
    buffer_load_dwordx4 v[64:67], v10, s[24:27], s36 offen nt
    s_add_u32 s36, s36, 10240
    buffer_load_dwordx4 v[68:71], v10, s[24:27], s36 offen nt
    s_add_u32 s36, s36, 10240
    buffer_load_dwordx4 v[72:75], v10, s[24:27], s36 offen nt
    s_add_u32 s36, s36, 10240
    buffer_load_dwordx4 v[76:79], v10, s[24:27], s36 offen nt
    s_add_u32 s36, s36, 10240
    buffer_load_dwordx4 v[80:83], v10, s[24:27], s36 offen nt
    s_add_u32 s36, s36, 10240
    buffer_load_dwordx4 v[84:87], v10, s[24:27], s36 offen nt
    s_add_u32 s36, s36, 10240
    buffer_load_dwordx4 v[88:91], v10, s[24:27], s36 offen nt
    s_add_u32 s36, s36, 10240
    buffer_load_dwordx4 v[92:95], v10, s[24:27], s36 offen nt
    s_add_u32 s36, s36, 10240
    buffer_load_dwordx4 v[96:99], v10, s[24:27], s36 offen nt
    s_add_u32 s36, s36, 10240
    buffer_load_dwordx4 v[100:103], v10, s[24:27], s36 offen nt
    s_add_u32 s36, s36, 10240
    buffer_load_dwordx4 v[104:107], v10, s[24:27], s36 offen nt
    s_add_u32 s36, s36, 10240
    buffer_load_dwordx4 v[108:111], v10, s[24:27], s36 offen nt
    s_add_u32 s36, s36, 10240
    buffer_load_dwordx4 v[112:115], v10, s[24:27], s36 offen nt
    s_add_u32 s36, s36, 10240
    buffer_load_dwordx4 v[116:119], v10, s[24:27], s36 offen nt
    s_add_u32 s36, s36, 10240
    buffer_load_dwordx4 v[120:123], v10, s[24:27], s36 offen nt
    s_add_u32 s36, s36, 10240
    buffer_load_dwordx4 v[124:127], v10, s[24:27], s36 offen nt
    s_add_u32 s36, s36, 10240
    buffer_load_dwordx4 v[128:131], v10, s[24:27], s36 offen nt
    s_add_u32 s36, s36, 10240
    buffer_load_dwordx4 v[132:135], v10, s[24:27], s36 offen nt
    s_add_u32 s36, s36, 10240
    buffer_load_dwordx4 v[136:139], v10, s[24:27], s36 offen nt
    s_add_u32 s36, s36, 10240
    buffer_load_dwordx4 v[140:143], v10, s[24:27], s36 offen nt
    s_add_u32 s36, s36, 10240
    buffer_load_dwordx4 v[144:147], v10, s[24:27], s36 offen nt
    s_add_u32 s36, s36, 10240
    buffer_load_dwordx4 v[148:151], v10, s[24:27], s36 offen nt
    s_add_u32 s36, s36, 10240
    buffer_load_dwordx4 v[152:155], v10, s[24:27], s36 offen nt
    s_add_u32 s36, s36, 10240
    buffer_load_dwordx4 v[156:159], v10, s[24:27], s36 offen nt
    s_add_u32 s36, s36, 10240
    buffer_load_dwordx4 v[160:163], v10, s[24:27], s36 offen nt
    s_add_u32 s36, s36, 10240
    buffer_load_dwordx4 v[164:167], v10, s[24:27], s36 offen nt
    s_add_u32 s36, s36, 10240
    buffer_load_dwordx4 v[168:171], v10, s[24:27], s36 offen nt
    s_add_u32 s36, s36, 10240
    buffer_load_dwordx4 v[172:175], v10, s[24:27], s36 offen nt
    s_add_u32 s36, s36, 10240
    buffer_load_dwordx4 v[176:179], v10, s[24:27], s36 offen nt
    s_add_u32 s36, s36, 10240
    buffer_load_dwordx4 v[180:183], v10, s[24:27], s36 offen nt
    s_add_u32 s36, s36, 10240
    buffer_load_dwordx4 v[184:187], v10, s[24:27], s36 offen nt
    s_add_u32 s36, s36, 10240
    buffer_load_dwordx4 v[188:191], v10, s[24:27], s36 offen nt
    s_lshl_b32 s36, s35, 2
    s_add_u32 s36, s36, 0
    s_mul_i32 s38, s36, 6554
    s_lshr_b32 s38, s38, 16
    s_mul_i32 s39, s38, 10
    s_sub_u32 s39, s36, s39
    s_cmp_ge_u32 s39, 5
    s_cselect_b32 s40, 1, 0
    s_sub_u32 s41, s39, 6
    s_cmp_eq_u32 s39, 5
    s_cselect_b32 s41, 4, s41
    s_cmp_eq_u32 s40, 1
    s_cselect_b32 s39, s41, s39
    s_mul_i32 s37, s38, 200
    s_mul_i32 s40, s40, 100
    s_add_u32 s37, s37, s40
    s_mul_i32 s40, s33, 50
    s_add_u32 s37, s37, s40
    s_add_u32 s37, s37, s39
    s_lshl_b32 s37, s37, 10
    s_add_u32 s44, s37, 24055808
    s_movk_i32 s48, 5120
    s_lshl_b32 s36, s35, 2
    s_add_u32 s36, s36, 1
    s_mul_i32 s38, s36, 6554
    s_lshr_b32 s38, s38, 16
    s_mul_i32 s39, s38, 10
    s_sub_u32 s39, s36, s39
    s_cmp_ge_u32 s39, 5
    s_cselect_b32 s40, 1, 0
    s_sub_u32 s41, s39, 6
    s_cmp_eq_u32 s39, 5
    s_cselect_b32 s41, 4, s41
    s_cmp_eq_u32 s40, 1
    s_cselect_b32 s39, s41, s39
    s_mul_i32 s37, s38, 200
    s_mul_i32 s40, s40, 100
    s_add_u32 s37, s37, s40
    s_mul_i32 s40, s33, 50
    s_add_u32 s37, s37, s40
    s_add_u32 s37, s37, s39
    s_lshl_b32 s37, s37, 10
    s_add_u32 s45, s37, 24055808
    s_movk_i32 s49, 5120
    s_lshl_b32 s36, s35, 2
    s_add_u32 s36, s36, 2
    s_mul_i32 s38, s36, 6554
    s_lshr_b32 s38, s38, 16
    s_mul_i32 s39, s38, 10
    s_sub_u32 s39, s36, s39
    s_cmp_ge_u32 s39, 5
    s_cselect_b32 s40, 1, 0
    s_sub_u32 s41, s39, 6
    s_cmp_eq_u32 s39, 5
    s_cselect_b32 s41, 4, s41
    s_cmp_eq_u32 s40, 1
    s_cselect_b32 s39, s41, s39
    s_mul_i32 s37, s38, 200
    s_mul_i32 s40, s40, 100
    s_add_u32 s37, s37, s40
    s_mul_i32 s40, s33, 50
    s_add_u32 s37, s37, s40
    s_add_u32 s37, s37, s39
    s_lshl_b32 s37, s37, 10
    s_add_u32 s46, s37, 24055808
    s_movk_i32 s50, 5120
    s_lshl_b32 s36, s35, 2
    s_add_u32 s36, s36, 3
    s_mul_i32 s38, s36, 6554
    s_lshr_b32 s38, s38, 16
    s_mul_i32 s39, s38, 10
    s_sub_u32 s39, s36, s39
    s_cmp_ge_u32 s39, 5
    s_cselect_b32 s40, 1, 0
    s_sub_u32 s41, s39, 6
    s_cmp_eq_u32 s39, 5
    s_cselect_b32 s41, 4, s41
    s_cmp_eq_u32 s40, 1
    s_cselect_b32 s39, s41, s39
    s_mul_i32 s37, s38, 200
    s_mul_i32 s40, s40, 100
    s_add_u32 s37, s37, s40
    s_mul_i32 s40, s33, 50
    s_add_u32 s37, s37, s40
    s_add_u32 s37, s37, s39
    s_lshl_b32 s37, s37, 10
    s_add_u32 s47, s37, 24055808
    s_movk_i32 s51, 5120
    s_waitcnt vmcnt(36)
    ds_write_b128 v5, v[32:35] offset:0
    ds_write_b128 v5, v[36:39] offset:1152
    ds_write_b128 v5, v[40:43] offset:2304
    ds_write_b128 v5, v[44:47] offset:3456
    s_waitcnt lgkmcnt(0)
    ds_read_b64_tr_b16 v[200:201], v8 offset:0
    ds_read_b64_tr_b16 v[202:203], v8 offset:576
    ds_read_b64_tr_b16 v[204:205], v8 offset:32
    ds_read_b64_tr_b16 v[206:207], v8 offset:608
    ds_read_b64_tr_b16 v[208:209], v8 offset:64
    ds_read_b64_tr_b16 v[210:211], v8 offset:640
    ds_read_b64_tr_b16 v[212:213], v8 offset:96
    ds_read_b64_tr_b16 v[214:215], v8 offset:672
    s_waitcnt vmcnt(32)
    ds_write_b128 v5, v[48:51] offset:4608
    ds_write_b128 v5, v[52:55] offset:5760
    ds_write_b128 v5, v[56:59] offset:6912
    ds_write_b128 v5, v[60:63] offset:8064
    s_waitcnt lgkmcnt(4)
    buffer_store_dwordx4 v[200:203], v9, s[28:31], s44 offen sc1
    s_add_u32 s44, s44, s48
    buffer_store_dwordx4 v[204:207], v9, s[28:31], s45 offen sc1
    s_add_u32 s45, s45, s49
    buffer_store_dwordx4 v[208:211], v9, s[28:31], s46 offen sc1
    s_add_u32 s46, s46, s50
    buffer_store_dwordx4 v[212:215], v9, s[28:31], s47 offen sc1
    s_add_u32 s47, s47, s51
    s_waitcnt lgkmcnt(0)
    ds_read_b64_tr_b16 v[216:217], v8 offset:4608
    ds_read_b64_tr_b16 v[218:219], v8 offset:5184
    ds_read_b64_tr_b16 v[220:221], v8 offset:4640
    ds_read_b64_tr_b16 v[222:223], v8 offset:5216
    ds_read_b64_tr_b16 v[224:225], v8 offset:4672
    ds_read_b64_tr_b16 v[226:227], v8 offset:5248
    ds_read_b64_tr_b16 v[228:229], v8 offset:4704
    ds_read_b64_tr_b16 v[230:231], v8 offset:5280
    s_waitcnt vmcnt(32)
    ds_write_b128 v5, v[64:67] offset:0
    ds_write_b128 v5, v[68:71] offset:1152
    ds_write_b128 v5, v[72:75] offset:2304
    ds_write_b128 v5, v[76:79] offset:3456
    s_waitcnt lgkmcnt(4)
    buffer_store_dwordx4 v[216:219], v9, s[28:31], s44 offen sc1
    s_add_u32 s44, s44, s48
    buffer_store_dwordx4 v[220:223], v9, s[28:31], s45 offen sc1
    s_add_u32 s45, s45, s49
    buffer_store_dwordx4 v[224:227], v9, s[28:31], s46 offen sc1
    s_add_u32 s46, s46, s50
    buffer_store_dwordx4 v[228:231], v9, s[28:31], s47 offen sc1
    s_add_u32 s47, s47, s51
    s_waitcnt lgkmcnt(0)
    ds_read_b64_tr_b16 v[200:201], v8 offset:0
    ds_read_b64_tr_b16 v[202:203], v8 offset:576
    ds_read_b64_tr_b16 v[204:205], v8 offset:32
    ds_read_b64_tr_b16 v[206:207], v8 offset:608
    ds_read_b64_tr_b16 v[208:209], v8 offset:64
    ds_read_b64_tr_b16 v[210:211], v8 offset:640
    ds_read_b64_tr_b16 v[212:213], v8 offset:96
    ds_read_b64_tr_b16 v[214:215], v8 offset:672
    s_waitcnt vmcnt(32)
    ds_write_b128 v5, v[80:83] offset:4608
    ds_write_b128 v5, v[84:87] offset:5760
    ds_write_b128 v5, v[88:91] offset:6912
    ds_write_b128 v5, v[92:95] offset:8064
    s_waitcnt lgkmcnt(4)
    buffer_store_dwordx4 v[200:203], v9, s[28:31], s44 offen sc1
    s_add_u32 s44, s44, s48
    buffer_store_dwordx4 v[204:207], v9, s[28:31], s45 offen sc1
    s_add_u32 s45, s45, s49
    buffer_store_dwordx4 v[208:211], v9, s[28:31], s46 offen sc1
    s_add_u32 s46, s46, s50
    buffer_store_dwordx4 v[212:215], v9, s[28:31], s47 offen sc1
    s_add_u32 s47, s47, s51
    s_waitcnt lgkmcnt(0)
    ds_read_b64_tr_b16 v[216:217], v8 offset:4608
    ds_read_b64_tr_b16 v[218:219], v8 offset:5184
    ds_read_b64_tr_b16 v[220:221], v8 offset:4640
    ds_read_b64_tr_b16 v[222:223], v8 offset:5216
    ds_read_b64_tr_b16 v[224:225], v8 offset:4672
    ds_read_b64_tr_b16 v[226:227], v8 offset:5248
    ds_read_b64_tr_b16 v[228:229], v8 offset:4704
    ds_read_b64_tr_b16 v[230:231], v8 offset:5280
    s_waitcnt vmcnt(32)
    ds_write_b128 v5, v[96:99] offset:0
    ds_write_b128 v5, v[100:103] offset:1152
    ds_write_b128 v5, v[104:107] offset:2304
    ds_write_b128 v5, v[108:111] offset:3456
    s_waitcnt lgkmcnt(4)
    buffer_store_dwordx4 v[216:219], v9, s[28:31], s44 offen sc1
    s_add_u32 s44, s44, s48
    buffer_store_dwordx4 v[220:223], v9, s[28:31], s45 offen sc1
    s_add_u32 s45, s45, s49
    buffer_store_dwordx4 v[224:227], v9, s[28:31], s46 offen sc1
    s_add_u32 s46, s46, s50
    buffer_store_dwordx4 v[228:231], v9, s[28:31], s47 offen sc1
    s_add_u32 s47, s47, s51
    s_waitcnt lgkmcnt(0)
    ds_read_b64_tr_b16 v[200:201], v8 offset:0
    ds_read_b64_tr_b16 v[202:203], v8 offset:576
    ds_read_b64_tr_b16 v[204:205], v8 offset:32
    ds_read_b64_tr_b16 v[206:207], v8 offset:608
    ds_read_b64_tr_b16 v[208:209], v8 offset:64
    ds_read_b64_tr_b16 v[210:211], v8 offset:640
    ds_read_b64_tr_b16 v[212:213], v8 offset:96
    ds_read_b64_tr_b16 v[214:215], v8 offset:672
    s_waitcnt vmcnt(32)
    ds_write_b128 v5, v[112:115] offset:4608
    ds_write_b128 v5, v[116:119] offset:5760
    ds_write_b128 v5, v[120:123] offset:6912
    ds_write_b128 v5, v[124:127] offset:8064
    s_waitcnt lgkmcnt(4)
    buffer_store_dwordx4 v[200:203], v9, s[28:31], s44 offen sc1
    s_add_u32 s44, s44, s48
    buffer_store_dwordx4 v[204:207], v9, s[28:31], s45 offen sc1
    s_add_u32 s45, s45, s49
    buffer_store_dwordx4 v[208:211], v9, s[28:31], s46 offen sc1
    s_add_u32 s46, s46, s50
    buffer_store_dwordx4 v[212:215], v9, s[28:31], s47 offen sc1
    s_add_u32 s47, s47, s51
    s_waitcnt lgkmcnt(0)
    ds_read_b64_tr_b16 v[216:217], v8 offset:4608
    ds_read_b64_tr_b16 v[218:219], v8 offset:5184
    ds_read_b64_tr_b16 v[220:221], v8 offset:4640
    ds_read_b64_tr_b16 v[222:223], v8 offset:5216
    ds_read_b64_tr_b16 v[224:225], v8 offset:4672
    ds_read_b64_tr_b16 v[226:227], v8 offset:5248
    ds_read_b64_tr_b16 v[228:229], v8 offset:4704
    ds_read_b64_tr_b16 v[230:231], v8 offset:5280
    s_waitcnt vmcnt(32)
    ds_write_b128 v5, v[128:131] offset:0
    ds_write_b128 v5, v[132:135] offset:1152
    ds_write_b128 v5, v[136:139] offset:2304
    ds_write_b128 v5, v[140:143] offset:3456
    s_waitcnt lgkmcnt(4)
    buffer_store_dwordx4 v[216:219], v9, s[28:31], s44 offen sc1
    s_add_u32 s44, s44, s48
    buffer_store_dwordx4 v[220:223], v9, s[28:31], s45 offen sc1
    s_add_u32 s45, s45, s49
    buffer_store_dwordx4 v[224:227], v9, s[28:31], s46 offen sc1
    s_add_u32 s46, s46, s50
    buffer_store_dwordx4 v[228:231], v9, s[28:31], s47 offen sc1
    s_add_u32 s47, s47, s51
    s_waitcnt lgkmcnt(0)
    ds_read_b64_tr_b16 v[200:201], v8 offset:0
    ds_read_b64_tr_b16 v[202:203], v8 offset:576
    ds_read_b64_tr_b16 v[204:205], v8 offset:32
    ds_read_b64_tr_b16 v[206:207], v8 offset:608
    ds_read_b64_tr_b16 v[208:209], v8 offset:64
    ds_read_b64_tr_b16 v[210:211], v8 offset:640
    ds_read_b64_tr_b16 v[212:213], v8 offset:96
    ds_read_b64_tr_b16 v[214:215], v8 offset:672
    s_waitcnt vmcnt(32)
    ds_write_b128 v5, v[144:147] offset:4608
    ds_write_b128 v5, v[148:151] offset:5760
    ds_write_b128 v5, v[152:155] offset:6912
    ds_write_b128 v5, v[156:159] offset:8064
    s_waitcnt lgkmcnt(4)
    buffer_store_dwordx4 v[200:203], v9, s[28:31], s44 offen sc1
    s_add_u32 s44, s44, s48
    buffer_store_dwordx4 v[204:207], v9, s[28:31], s45 offen sc1
    s_add_u32 s45, s45, s49
    buffer_store_dwordx4 v[208:211], v9, s[28:31], s46 offen sc1
    s_add_u32 s46, s46, s50
    buffer_store_dwordx4 v[212:215], v9, s[28:31], s47 offen sc1
    s_add_u32 s47, s47, s51
    s_waitcnt lgkmcnt(0)
    ds_read_b64_tr_b16 v[216:217], v8 offset:4608
    ds_read_b64_tr_b16 v[218:219], v8 offset:5184
    ds_read_b64_tr_b16 v[220:221], v8 offset:4640
    ds_read_b64_tr_b16 v[222:223], v8 offset:5216
    ds_read_b64_tr_b16 v[224:225], v8 offset:4672
    ds_read_b64_tr_b16 v[226:227], v8 offset:5248
    ds_read_b64_tr_b16 v[228:229], v8 offset:4704
    ds_read_b64_tr_b16 v[230:231], v8 offset:5280
    s_waitcnt vmcnt(32)
    ds_write_b128 v5, v[160:163] offset:0
    ds_write_b128 v5, v[164:167] offset:1152
    ds_write_b128 v5, v[168:171] offset:2304
    ds_write_b128 v5, v[172:175] offset:3456
    s_waitcnt lgkmcnt(4)
    buffer_store_dwordx4 v[216:219], v9, s[28:31], s44 offen sc1
    s_add_u32 s44, s44, s48
    buffer_store_dwordx4 v[220:223], v9, s[28:31], s45 offen sc1
    s_add_u32 s45, s45, s49
    buffer_store_dwordx4 v[224:227], v9, s[28:31], s46 offen sc1
    s_add_u32 s46, s46, s50
    buffer_store_dwordx4 v[228:231], v9, s[28:31], s47 offen sc1
    s_add_u32 s47, s47, s51
    s_waitcnt lgkmcnt(0)
    ds_read_b64_tr_b16 v[200:201], v8 offset:0
    ds_read_b64_tr_b16 v[202:203], v8 offset:576
    ds_read_b64_tr_b16 v[204:205], v8 offset:32
    ds_read_b64_tr_b16 v[206:207], v8 offset:608
    ds_read_b64_tr_b16 v[208:209], v8 offset:64
    ds_read_b64_tr_b16 v[210:211], v8 offset:640
    ds_read_b64_tr_b16 v[212:213], v8 offset:96
    ds_read_b64_tr_b16 v[214:215], v8 offset:672
    s_waitcnt vmcnt(32)
    ds_write_b128 v5, v[176:179] offset:4608
    ds_write_b128 v5, v[180:183] offset:5760
    ds_write_b128 v5, v[184:187] offset:6912
    ds_write_b128 v5, v[188:191] offset:8064
    s_waitcnt lgkmcnt(4)
    buffer_store_dwordx4 v[200:203], v9, s[28:31], s44 offen sc1
    s_add_u32 s44, s44, s48
    buffer_store_dwordx4 v[204:207], v9, s[28:31], s45 offen sc1
    s_add_u32 s45, s45, s49
    buffer_store_dwordx4 v[208:211], v9, s[28:31], s46 offen sc1
    s_add_u32 s46, s46, s50
    buffer_store_dwordx4 v[212:215], v9, s[28:31], s47 offen sc1
    s_add_u32 s47, s47, s51
    s_waitcnt lgkmcnt(0)
    ds_read_b64_tr_b16 v[216:217], v8 offset:4608
    ds_read_b64_tr_b16 v[218:219], v8 offset:5184
    ds_read_b64_tr_b16 v[220:221], v8 offset:4640
    ds_read_b64_tr_b16 v[222:223], v8 offset:5216
    ds_read_b64_tr_b16 v[224:225], v8 offset:4672
    ds_read_b64_tr_b16 v[226:227], v8 offset:5248
    ds_read_b64_tr_b16 v[228:229], v8 offset:4704
    ds_read_b64_tr_b16 v[230:231], v8 offset:5280
    s_waitcnt lgkmcnt(0)
    buffer_store_dwordx4 v[216:219], v9, s[28:31], s44 offen sc1
    s_add_u32 s44, s44, s48
    buffer_store_dwordx4 v[220:223], v9, s[28:31], s45 offen sc1
    s_add_u32 s45, s45, s49
    buffer_store_dwordx4 v[224:227], v9, s[28:31], s46 offen sc1
    s_add_u32 s46, s46, s50
    buffer_store_dwordx4 v[228:231], v9, s[28:31], s47 offen sc1
    s_add_u32 s47, s47, s51
    s_endpgm
prep_kernel_pk31:
    s_mov_b32 s24, s16
    s_mov_b32 s25, s17
    s_mov_b32 s26, 2211840
    s_mov_b32 s27, 0x00020000
    s_sub_u32 s32, s21, 40
    s_mul_i32 s33, s32, 2428
    s_lshr_b32 s33, s33, 16
    s_mul_i32 s35, s33, 27
    s_sub_u32 s35, s32, s35
    v_mul_u32_u24 v10, 3456, v3
    v_lshl_add_u32 v10, v4, 4, v10
    s_mul_i32 s36, s33, 1105920
    s_lshl_b32 s37, s35, 7
    s_add_u32 s36, s36, s37
    buffer_load_dwordx4 v[32:35], v10, s[24:27], s36 offen nt
    s_add_u32 s36, s36, 27648
    buffer_load_dwordx4 v[36:39], v10, s[24:27], s36 offen nt
    s_add_u32 s36, s36, 27648
    buffer_load_dwordx4 v[40:43], v10, s[24:27], s36 offen nt
    s_add_u32 s36, s36, 27648
    buffer_load_dwordx4 v[44:47], v10, s[24:27], s36 offen nt
    s_add_u32 s36, s36, 27648
    buffer_load_dwordx4 v[48:51], v10, s[24:27], s36 offen nt
    s_add_u32 s36, s36, 27648
    buffer_load_dwordx4 v[52:55], v10, s[24:27], s36 offen nt
    s_add_u32 s36, s36, 27648
    buffer_load_dwordx4 v[56:59], v10, s[24:27], s36 offen nt
    s_add_u32 s36, s36, 27648
    buffer_load_dwordx4 v[60:63], v10, s[24:27], s36 offen nt
    s_add_u32 s36, s36, 27648
    buffer_load_dwordx4 v[64:67], v10, s[24:27], s36 offen nt
    s_add_u32 s36, s36, 27648
    buffer_load_dwordx4 v[68:71], v10, s[24:27], s36 offen nt
    s_add_u32 s36, s36, 27648
    buffer_load_dwordx4 v[72:75], v10, s[24:27], s36 offen nt
    s_add_u32 s36, s36, 27648
    buffer_load_dwordx4 v[76:79], v10, s[24:27], s36 offen nt
    s_add_u32 s36, s36, 27648
    buffer_load_dwordx4 v[80:83], v10, s[24:27], s36 offen nt
    s_add_u32 s36, s36, 27648
    buffer_load_dwordx4 v[84:87], v10, s[24:27], s36 offen nt
    s_add_u32 s36, s36, 27648
    buffer_load_dwordx4 v[88:91], v10, s[24:27], s36 offen nt
    s_add_u32 s36, s36, 27648
    buffer_load_dwordx4 v[92:95], v10, s[24:27], s36 offen nt
    s_add_u32 s36, s36, 27648
    buffer_load_dwordx4 v[96:99], v10, s[24:27], s36 offen nt
    s_add_u32 s36, s36, 27648
    buffer_load_dwordx4 v[100:103], v10, s[24:27], s36 offen nt
    s_add_u32 s36, s36, 27648
    buffer_load_dwordx4 v[104:107], v10, s[24:27], s36 offen nt
    s_add_u32 s36, s36, 27648
    buffer_load_dwordx4 v[108:111], v10, s[24:27], s36 offen nt
    s_add_u32 s36, s36, 27648
    buffer_load_dwordx4 v[112:115], v10, s[24:27], s36 offen nt
    s_add_u32 s36, s36, 27648
    buffer_load_dwordx4 v[116:119], v10, s[24:27], s36 offen nt
    s_add_u32 s36, s36, 27648
    buffer_load_dwordx4 v[120:123], v10, s[24:27], s36 offen nt
    s_add_u32 s36, s36, 27648
    buffer_load_dwordx4 v[124:127], v10, s[24:27], s36 offen nt
    s_add_u32 s36, s36, 27648
    buffer_load_dwordx4 v[128:131], v10, s[24:27], s36 offen nt
    s_add_u32 s36, s36, 27648
    buffer_load_dwordx4 v[132:135], v10, s[24:27], s36 offen nt
    s_add_u32 s36, s36, 27648
    buffer_load_dwordx4 v[136:139], v10, s[24:27], s36 offen nt
    s_add_u32 s36, s36, 27648
    buffer_load_dwordx4 v[140:143], v10, s[24:27], s36 offen nt
    s_add_u32 s36, s36, 27648
    buffer_load_dwordx4 v[144:147], v10, s[24:27], s36 offen nt
    s_add_u32 s36, s36, 27648
    buffer_load_dwordx4 v[148:151], v10, s[24:27], s36 offen nt
    s_add_u32 s36, s36, 27648
    buffer_load_dwordx4 v[152:155], v10, s[24:27], s36 offen nt
    s_add_u32 s36, s36, 27648
    buffer_load_dwordx4 v[156:159], v10, s[24:27], s36 offen nt
    s_add_u32 s36, s36, 27648
    buffer_load_dwordx4 v[160:163], v10, s[24:27], s36 offen nt
    s_add_u32 s36, s36, 27648
    buffer_load_dwordx4 v[164:167], v10, s[24:27], s36 offen nt
    s_add_u32 s36, s36, 27648
    buffer_load_dwordx4 v[168:171], v10, s[24:27], s36 offen nt
    s_add_u32 s36, s36, 27648
    buffer_load_dwordx4 v[172:175], v10, s[24:27], s36 offen nt
    s_add_u32 s36, s36, 27648
    buffer_load_dwordx4 v[176:179], v10, s[24:27], s36 offen nt
    s_add_u32 s36, s36, 27648
    buffer_load_dwordx4 v[180:183], v10, s[24:27], s36 offen nt
    s_add_u32 s36, s36, 27648
    buffer_load_dwordx4 v[184:187], v10, s[24:27], s36 offen nt
    s_add_u32 s36, s36, 27648
    buffer_load_dwordx4 v[188:191], v10, s[24:27], s36 offen nt
    s_lshl_b32 s36, s35, 2
    s_add_u32 s36, s36, 0
    s_mul_i32 s38, s36, 9363
    s_lshr_b32 s38, s38, 16
    s_mul_i32 s39, s38, 7
    s_sub_u32 s39, s36, s39
    s_sub_u32 s41, s39, 1
    s_cmp_eq_u32 s39, 0
    s_cselect_b32 s41, 6, s41
    s_and_b32 s40, s38, 1
    s_cmp_eq_u32 s40, 1
    s_cselect_b32 s39, s41, s39
    s_mov_b32 s41, 4
    s_mov_b32 s40, s39
    s_cmp_ge_u32 s39, 4
    s_cselect_b32 s41, 2, s41
    s_add_u32 s42, s39, 76
    s_cmp_ge_u32 s39, 4
    s_cselect_b32 s40, s42, s40
    s_cmp_eq_u32 s39, 6
    s_cselect_b32 s41, 1, s41
    s_cselect_b32 s40, 120, s40
    s_mul_i32 s42, s33, 10
    s_mul_i32 s42, s42, s41
    s_add_u32 s40, s40, s42
    s_mul_i32 s37, s38, 140
    s_add_u32 s37, s37, s40
    s_lshl_b32 s37, s37, 10
    s_add_u32 s44, s37, 24875008
    s_lshl_b32 s48, s41, 10
    s_lshl_b32 s36, s35, 2
    s_add_u32 s36, s36, 1
    s_mul_i32 s38, s36, 9363
    s_lshr_b32 s38, s38, 16
    s_mul_i32 s39, s38, 7
    s_sub_u32 s39, s36, s39
    s_sub_u32 s41, s39, 1
    s_cmp_eq_u32 s39, 0
    s_cselect_b32 s41, 6, s41
    s_and_b32 s40, s38, 1
    s_cmp_eq_u32 s40, 1
    s_cselect_b32 s39, s41, s39
    s_mov_b32 s41, 4
    s_mov_b32 s40, s39
    s_cmp_ge_u32 s39, 4
    s_cselect_b32 s41, 2, s41
    s_add_u32 s42, s39, 76
    s_cmp_ge_u32 s39, 4
    s_cselect_b32 s40, s42, s40
    s_cmp_eq_u32 s39, 6
    s_cselect_b32 s41, 1, s41
    s_cselect_b32 s40, 120, s40
    s_mul_i32 s42, s33, 10
    s_mul_i32 s42, s42, s41
    s_add_u32 s40, s40, s42
    s_mul_i32 s37, s38, 140
    s_add_u32 s37, s37, s40
    s_lshl_b32 s37, s37, 10
    s_add_u32 s45, s37, 24875008
    s_lshl_b32 s49, s41, 10
    s_lshl_b32 s36, s35, 2
    s_add_u32 s36, s36, 2
    s_mul_i32 s38, s36, 9363
    s_lshr_b32 s38, s38, 16
    s_mul_i32 s39, s38, 7
    s_sub_u32 s39, s36, s39
    s_sub_u32 s41, s39, 1
    s_cmp_eq_u32 s39, 0
    s_cselect_b32 s41, 6, s41
    s_and_b32 s40, s38, 1
    s_cmp_eq_u32 s40, 1
    s_cselect_b32 s39, s41, s39
    s_mov_b32 s41, 4
    s_mov_b32 s40, s39
    s_cmp_ge_u32 s39, 4
    s_cselect_b32 s41, 2, s41
    s_add_u32 s42, s39, 76
    s_cmp_ge_u32 s39, 4
    s_cselect_b32 s40, s42, s40
    s_cmp_eq_u32 s39, 6
    s_cselect_b32 s41, 1, s41
    s_cselect_b32 s40, 120, s40
    s_mul_i32 s42, s33, 10
    s_mul_i32 s42, s42, s41
    s_add_u32 s40, s40, s42
    s_mul_i32 s37, s38, 140
    s_add_u32 s37, s37, s40
    s_lshl_b32 s37, s37, 10
    s_add_u32 s46, s37, 24875008
    s_lshl_b32 s50, s41, 10
    s_lshl_b32 s36, s35, 2
    s_add_u32 s36, s36, 3
    s_mul_i32 s38, s36, 9363
    s_lshr_b32 s38, s38, 16
    s_mul_i32 s39, s38, 7
    s_sub_u32 s39, s36, s39
    s_sub_u32 s41, s39, 1
    s_cmp_eq_u32 s39, 0
    s_cselect_b32 s41, 6, s41
    s_and_b32 s40, s38, 1
    s_cmp_eq_u32 s40, 1
    s_cselect_b32 s39, s41, s39
    s_mov_b32 s41, 4
    s_mov_b32 s40, s39
    s_cmp_ge_u32 s39, 4
    s_cselect_b32 s41, 2, s41
    s_add_u32 s42, s39, 76
    s_cmp_ge_u32 s39, 4
    s_cselect_b32 s40, s42, s40
    s_cmp_eq_u32 s39, 6
    s_cselect_b32 s41, 1, s41
    s_cselect_b32 s40, 120, s40
    s_mul_i32 s42, s33, 10
    s_mul_i32 s42, s42, s41
    s_add_u32 s40, s40, s42
    s_mul_i32 s37, s38, 140
    s_add_u32 s37, s37, s40
    s_lshl_b32 s37, s37, 10
    s_add_u32 s47, s37, 24875008
    s_lshl_b32 s51, s41, 10
    v_mov_b32 v12, 0
    v_mov_b32 v13, 0
    v_mov_b32 v14, 0
    v_mov_b32 v15, 0
    v_mov_b32 v16, 0x3f803f80
    s_waitcnt vmcnt(36)
    ds_write_b128 v5, v[32:35] offset:0
    ds_write_b128 v5, v[36:39] offset:1152
    ds_write_b128 v5, v[40:43] offset:2304
    ds_write_b128 v5, v[44:47] offset:3456
    s_waitcnt lgkmcnt(0)
    ds_read_b64_tr_b16 v[200:201], v8 offset:0
    ds_read_b64_tr_b16 v[202:203], v8 offset:576
    ds_read_b64_tr_b16 v[204:205], v8 offset:32
    ds_read_b64_tr_b16 v[206:207], v8 offset:608
    ds_read_b64_tr_b16 v[208:209], v8 offset:64
    ds_read_b64_tr_b16 v[210:211], v8 offset:640
    ds_read_b64_tr_b16 v[212:213], v8 offset:96
    ds_read_b64_tr_b16 v[214:215], v8 offset:672
    s_waitcnt vmcnt(32)
    ds_write_b128 v5, v[48:51] offset:4608
    ds_write_b128 v5, v[52:55] offset:5760
    ds_write_b128 v5, v[56:59] offset:6912
    ds_write_b128 v5, v[60:63] offset:8064
    s_waitcnt lgkmcnt(4)
    buffer_store_dwordx4 v[200:203], v9, s[28:31], s44 offen sc1
    s_add_u32 s44, s44, s48
    v_dot2_f32_bf16 v12, v200, v16, v12
    v_dot2_f32_bf16 v12, v201, v16, v12
    v_dot2_f32_bf16 v12, v202, v16, v12
    v_dot2_f32_bf16 v12, v203, v16, v12
    buffer_store_dwordx4 v[204:207], v9, s[28:31], s45 offen sc1
    s_add_u32 s45, s45, s49
    v_dot2_f32_bf16 v13, v204, v16, v13
    v_dot2_f32_bf16 v13, v205, v16, v13
    v_dot2_f32_bf16 v13, v206, v16, v13
    v_dot2_f32_bf16 v13, v207, v16, v13
    buffer_store_dwordx4 v[208:211], v9, s[28:31], s46 offen sc1
    s_add_u32 s46, s46, s50
    v_dot2_f32_bf16 v14, v208, v16, v14
    v_dot2_f32_bf16 v14, v209, v16, v14
    v_dot2_f32_bf16 v14, v210, v16, v14
    v_dot2_f32_bf16 v14, v211, v16, v14
    buffer_store_dwordx4 v[212:215], v9, s[28:31], s47 offen sc1
    s_add_u32 s47, s47, s51
    v_dot2_f32_bf16 v15, v212, v16, v15
    v_dot2_f32_bf16 v15, v213, v16, v15
    v_dot2_f32_bf16 v15, v214, v16, v15
    v_dot2_f32_bf16 v15, v215, v16, v15
    s_waitcnt lgkmcnt(0)
    ds_read_b64_tr_b16 v[216:217], v8 offset:4608
    ds_read_b64_tr_b16 v[218:219], v8 offset:5184
    ds_read_b64_tr_b16 v[220:221], v8 offset:4640
    ds_read_b64_tr_b16 v[222:223], v8 offset:5216
    ds_read_b64_tr_b16 v[224:225], v8 offset:4672
    ds_read_b64_tr_b16 v[226:227], v8 offset:5248
    ds_read_b64_tr_b16 v[228:229], v8 offset:4704
    ds_read_b64_tr_b16 v[230:231], v8 offset:5280
    s_waitcnt vmcnt(32)
    ds_write_b128 v5, v[64:67] offset:0
    ds_write_b128 v5, v[68:71] offset:1152
    ds_write_b128 v5, v[72:75] offset:2304
    ds_write_b128 v5, v[76:79] offset:3456
    s_waitcnt lgkmcnt(4)
    buffer_store_dwordx4 v[216:219], v9, s[28:31], s44 offen sc1
    s_add_u32 s44, s44, s48
    v_dot2_f32_bf16 v12, v216, v16, v12
    v_dot2_f32_bf16 v12, v217, v16, v12
    v_dot2_f32_bf16 v12, v218, v16, v12
    v_dot2_f32_bf16 v12, v219, v16, v12
    buffer_store_dwordx4 v[220:223], v9, s[28:31], s45 offen sc1
    s_add_u32 s45, s45, s49
    v_dot2_f32_bf16 v13, v220, v16, v13
    v_dot2_f32_bf16 v13, v221, v16, v13
    v_dot2_f32_bf16 v13, v222, v16, v13
    v_dot2_f32_bf16 v13, v223, v16, v13
    buffer_store_dwordx4 v[224:227], v9, s[28:31], s46 offen sc1
    s_add_u32 s46, s46, s50
    v_dot2_f32_bf16 v14, v224, v16, v14
    v_dot2_f32_bf16 v14, v225, v16, v14
    v_dot2_f32_bf16 v14, v226, v16, v14
    v_dot2_f32_bf16 v14, v227, v16, v14
    buffer_store_dwordx4 v[228:231], v9, s[28:31], s47 offen sc1
    s_add_u32 s47, s47, s51
    v_dot2_f32_bf16 v15, v228, v16, v15
    v_dot2_f32_bf16 v15, v229, v16, v15
    v_dot2_f32_bf16 v15, v230, v16, v15
    v_dot2_f32_bf16 v15, v231, v16, v15
    s_waitcnt lgkmcnt(0)
    ds_read_b64_tr_b16 v[200:201], v8 offset:0
    ds_read_b64_tr_b16 v[202:203], v8 offset:576
    ds_read_b64_tr_b16 v[204:205], v8 offset:32
    ds_read_b64_tr_b16 v[206:207], v8 offset:608
    ds_read_b64_tr_b16 v[208:209], v8 offset:64
    ds_read_b64_tr_b16 v[210:211], v8 offset:640
    ds_read_b64_tr_b16 v[212:213], v8 offset:96
    ds_read_b64_tr_b16 v[214:215], v8 offset:672
    s_waitcnt vmcnt(32)
    ds_write_b128 v5, v[80:83] offset:4608
    ds_write_b128 v5, v[84:87] offset:5760
    ds_write_b128 v5, v[88:91] offset:6912
    ds_write_b128 v5, v[92:95] offset:8064
    s_waitcnt lgkmcnt(4)
    buffer_store_dwordx4 v[200:203], v9, s[28:31], s44 offen sc1
    s_add_u32 s44, s44, s48
    v_dot2_f32_bf16 v12, v200, v16, v12
    v_dot2_f32_bf16 v12, v201, v16, v12
    v_dot2_f32_bf16 v12, v202, v16, v12
    v_dot2_f32_bf16 v12, v203, v16, v12
    buffer_store_dwordx4 v[204:207], v9, s[28:31], s45 offen sc1
    s_add_u32 s45, s45, s49
    v_dot2_f32_bf16 v13, v204, v16, v13
    v_dot2_f32_bf16 v13, v205, v16, v13
    v_dot2_f32_bf16 v13, v206, v16, v13
    v_dot2_f32_bf16 v13, v207, v16, v13
    buffer_store_dwordx4 v[208:211], v9, s[28:31], s46 offen sc1
    s_add_u32 s46, s46, s50
    v_dot2_f32_bf16 v14, v208, v16, v14
    v_dot2_f32_bf16 v14, v209, v16, v14
    v_dot2_f32_bf16 v14, v210, v16, v14
    v_dot2_f32_bf16 v14, v211, v16, v14
    buffer_store_dwordx4 v[212:215], v9, s[28:31], s47 offen sc1
    s_add_u32 s47, s47, s51
    v_dot2_f32_bf16 v15, v212, v16, v15
    v_dot2_f32_bf16 v15, v213, v16, v15
    v_dot2_f32_bf16 v15, v214, v16, v15
    v_dot2_f32_bf16 v15, v215, v16, v15
    s_waitcnt lgkmcnt(0)
    ds_read_b64_tr_b16 v[216:217], v8 offset:4608
    ds_read_b64_tr_b16 v[218:219], v8 offset:5184
    ds_read_b64_tr_b16 v[220:221], v8 offset:4640
    ds_read_b64_tr_b16 v[222:223], v8 offset:5216
    ds_read_b64_tr_b16 v[224:225], v8 offset:4672
    ds_read_b64_tr_b16 v[226:227], v8 offset:5248
    ds_read_b64_tr_b16 v[228:229], v8 offset:4704
    ds_read_b64_tr_b16 v[230:231], v8 offset:5280
    s_waitcnt vmcnt(32)
    ds_write_b128 v5, v[96:99] offset:0
    ds_write_b128 v5, v[100:103] offset:1152
    ds_write_b128 v5, v[104:107] offset:2304
    ds_write_b128 v5, v[108:111] offset:3456
    s_waitcnt lgkmcnt(4)
    buffer_store_dwordx4 v[216:219], v9, s[28:31], s44 offen sc1
    s_add_u32 s44, s44, s48
    v_dot2_f32_bf16 v12, v216, v16, v12
    v_dot2_f32_bf16 v12, v217, v16, v12
    v_dot2_f32_bf16 v12, v218, v16, v12
    v_dot2_f32_bf16 v12, v219, v16, v12
    buffer_store_dwordx4 v[220:223], v9, s[28:31], s45 offen sc1
    s_add_u32 s45, s45, s49
    v_dot2_f32_bf16 v13, v220, v16, v13
    v_dot2_f32_bf16 v13, v221, v16, v13
    v_dot2_f32_bf16 v13, v222, v16, v13
    v_dot2_f32_bf16 v13, v223, v16, v13
    buffer_store_dwordx4 v[224:227], v9, s[28:31], s46 offen sc1
    s_add_u32 s46, s46, s50
    v_dot2_f32_bf16 v14, v224, v16, v14
    v_dot2_f32_bf16 v14, v225, v16, v14
    v_dot2_f32_bf16 v14, v226, v16, v14
    v_dot2_f32_bf16 v14, v227, v16, v14
    buffer_store_dwordx4 v[228:231], v9, s[28:31], s47 offen sc1
    s_add_u32 s47, s47, s51
    v_dot2_f32_bf16 v15, v228, v16, v15
    v_dot2_f32_bf16 v15, v229, v16, v15
    v_dot2_f32_bf16 v15, v230, v16, v15
    v_dot2_f32_bf16 v15, v231, v16, v15
    s_waitcnt lgkmcnt(0)
    ds_read_b64_tr_b16 v[200:201], v8 offset:0
    ds_read_b64_tr_b16 v[202:203], v8 offset:576
    ds_read_b64_tr_b16 v[204:205], v8 offset:32
    ds_read_b64_tr_b16 v[206:207], v8 offset:608
    ds_read_b64_tr_b16 v[208:209], v8 offset:64
    ds_read_b64_tr_b16 v[210:211], v8 offset:640
    ds_read_b64_tr_b16 v[212:213], v8 offset:96
    ds_read_b64_tr_b16 v[214:215], v8 offset:672
    s_waitcnt vmcnt(32)
    ds_write_b128 v5, v[112:115] offset:4608
    ds_write_b128 v5, v[116:119] offset:5760
    ds_write_b128 v5, v[120:123] offset:6912
    ds_write_b128 v5, v[124:127] offset:8064
    s_waitcnt lgkmcnt(4)
    buffer_store_dwordx4 v[200:203], v9, s[28:31], s44 offen sc1
    s_add_u32 s44, s44, s48
    v_dot2_f32_bf16 v12, v200, v16, v12
    v_dot2_f32_bf16 v12, v201, v16, v12
    v_dot2_f32_bf16 v12, v202, v16, v12
    v_dot2_f32_bf16 v12, v203, v16, v12
    buffer_store_dwordx4 v[204:207], v9, s[28:31], s45 offen sc1
    s_add_u32 s45, s45, s49
    v_dot2_f32_bf16 v13, v204, v16, v13
    v_dot2_f32_bf16 v13, v205, v16, v13
    v_dot2_f32_bf16 v13, v206, v16, v13
    v_dot2_f32_bf16 v13, v207, v16, v13
    buffer_store_dwordx4 v[208:211], v9, s[28:31], s46 offen sc1
    s_add_u32 s46, s46, s50
    v_dot2_f32_bf16 v14, v208, v16, v14
    v_dot2_f32_bf16 v14, v209, v16, v14
    v_dot2_f32_bf16 v14, v210, v16, v14
    v_dot2_f32_bf16 v14, v211, v16, v14
    buffer_store_dwordx4 v[212:215], v9, s[28:31], s47 offen sc1
    s_add_u32 s47, s47, s51
    v_dot2_f32_bf16 v15, v212, v16, v15
    v_dot2_f32_bf16 v15, v213, v16, v15
    v_dot2_f32_bf16 v15, v214, v16, v15
    v_dot2_f32_bf16 v15, v215, v16, v15
    s_waitcnt lgkmcnt(0)
    ds_read_b64_tr_b16 v[216:217], v8 offset:4608
    ds_read_b64_tr_b16 v[218:219], v8 offset:5184
    ds_read_b64_tr_b16 v[220:221], v8 offset:4640
    ds_read_b64_tr_b16 v[222:223], v8 offset:5216
    ds_read_b64_tr_b16 v[224:225], v8 offset:4672
    ds_read_b64_tr_b16 v[226:227], v8 offset:5248
    ds_read_b64_tr_b16 v[228:229], v8 offset:4704
    ds_read_b64_tr_b16 v[230:231], v8 offset:5280
    s_waitcnt vmcnt(32)
    ds_write_b128 v5, v[128:131] offset:0
    ds_write_b128 v5, v[132:135] offset:1152
    ds_write_b128 v5, v[136:139] offset:2304
    ds_write_b128 v5, v[140:143] offset:3456
    s_waitcnt lgkmcnt(4)
    buffer_store_dwordx4 v[216:219], v9, s[28:31], s44 offen sc1
    s_add_u32 s44, s44, s48
    v_dot2_f32_bf16 v12, v216, v16, v12
    v_dot2_f32_bf16 v12, v217, v16, v12
    v_dot2_f32_bf16 v12, v218, v16, v12
    v_dot2_f32_bf16 v12, v219, v16, v12
    buffer_store_dwordx4 v[220:223], v9, s[28:31], s45 offen sc1
    s_add_u32 s45, s45, s49
    v_dot2_f32_bf16 v13, v220, v16, v13
    v_dot2_f32_bf16 v13, v221, v16, v13
    v_dot2_f32_bf16 v13, v222, v16, v13
    v_dot2_f32_bf16 v13, v223, v16, v13
    buffer_store_dwordx4 v[224:227], v9, s[28:31], s46 offen sc1
    s_add_u32 s46, s46, s50
    v_dot2_f32_bf16 v14, v224, v16, v14
    v_dot2_f32_bf16 v14, v225, v16, v14
    v_dot2_f32_bf16 v14, v226, v16, v14
    v_dot2_f32_bf16 v14, v227, v16, v14
    buffer_store_dwordx4 v[228:231], v9, s[28:31], s47 offen sc1
    s_add_u32 s47, s47, s51
    v_dot2_f32_bf16 v15, v228, v16, v15
    v_dot2_f32_bf16 v15, v229, v16, v15
    v_dot2_f32_bf16 v15, v230, v16, v15
    v_dot2_f32_bf16 v15, v231, v16, v15
    s_waitcnt lgkmcnt(0)
    ds_read_b64_tr_b16 v[200:201], v8 offset:0
    ds_read_b64_tr_b16 v[202:203], v8 offset:576
    ds_read_b64_tr_b16 v[204:205], v8 offset:32
    ds_read_b64_tr_b16 v[206:207], v8 offset:608
    ds_read_b64_tr_b16 v[208:209], v8 offset:64
    ds_read_b64_tr_b16 v[210:211], v8 offset:640
    ds_read_b64_tr_b16 v[212:213], v8 offset:96
    ds_read_b64_tr_b16 v[214:215], v8 offset:672
    s_waitcnt vmcnt(32)
    ds_write_b128 v5, v[144:147] offset:4608
    ds_write_b128 v5, v[148:151] offset:5760
    ds_write_b128 v5, v[152:155] offset:6912
    ds_write_b128 v5, v[156:159] offset:8064
    s_waitcnt lgkmcnt(4)
    buffer_store_dwordx4 v[200:203], v9, s[28:31], s44 offen sc1
    s_add_u32 s44, s44, s48
    v_dot2_f32_bf16 v12, v200, v16, v12
    v_dot2_f32_bf16 v12, v201, v16, v12
    v_dot2_f32_bf16 v12, v202, v16, v12
    v_dot2_f32_bf16 v12, v203, v16, v12
    buffer_store_dwordx4 v[204:207], v9, s[28:31], s45 offen sc1
    s_add_u32 s45, s45, s49
    v_dot2_f32_bf16 v13, v204, v16, v13
    v_dot2_f32_bf16 v13, v205, v16, v13
    v_dot2_f32_bf16 v13, v206, v16, v13
    v_dot2_f32_bf16 v13, v207, v16, v13
    buffer_store_dwordx4 v[208:211], v9, s[28:31], s46 offen sc1
    s_add_u32 s46, s46, s50
    v_dot2_f32_bf16 v14, v208, v16, v14
    v_dot2_f32_bf16 v14, v209, v16, v14
    v_dot2_f32_bf16 v14, v210, v16, v14
    v_dot2_f32_bf16 v14, v211, v16, v14
    buffer_store_dwordx4 v[212:215], v9, s[28:31], s47 offen sc1
    s_add_u32 s47, s47, s51
    v_dot2_f32_bf16 v15, v212, v16, v15
    v_dot2_f32_bf16 v15, v213, v16, v15
    v_dot2_f32_bf16 v15, v214, v16, v15
    v_dot2_f32_bf16 v15, v215, v16, v15
    s_waitcnt lgkmcnt(0)
    ds_read_b64_tr_b16 v[216:217], v8 offset:4608
    ds_read_b64_tr_b16 v[218:219], v8 offset:5184
    ds_read_b64_tr_b16 v[220:221], v8 offset:4640
    ds_read_b64_tr_b16 v[222:223], v8 offset:5216
    ds_read_b64_tr_b16 v[224:225], v8 offset:4672
    ds_read_b64_tr_b16 v[226:227], v8 offset:5248
    ds_read_b64_tr_b16 v[228:229], v8 offset:4704
    ds_read_b64_tr_b16 v[230:231], v8 offset:5280
    s_waitcnt vmcnt(32)
    ds_write_b128 v5, v[160:163] offset:0
    ds_write_b128 v5, v[164:167] offset:1152
    ds_write_b128 v5, v[168:171] offset:2304
    ds_write_b128 v5, v[172:175] offset:3456
    s_waitcnt lgkmcnt(4)
    buffer_store_dwordx4 v[216:219], v9, s[28:31], s44 offen sc1
    s_add_u32 s44, s44, s48
    v_dot2_f32_bf16 v12, v216, v16, v12
    v_dot2_f32_bf16 v12, v217, v16, v12
    v_dot2_f32_bf16 v12, v218, v16, v12
    v_dot2_f32_bf16 v12, v219, v16, v12
    buffer_store_dwordx4 v[220:223], v9, s[28:31], s45 offen sc1
    s_add_u32 s45, s45, s49
    v_dot2_f32_bf16 v13, v220, v16, v13
    v_dot2_f32_bf16 v13, v221, v16, v13
    v_dot2_f32_bf16 v13, v222, v16, v13
    v_dot2_f32_bf16 v13, v223, v16, v13
    buffer_store_dwordx4 v[224:227], v9, s[28:31], s46 offen sc1
    s_add_u32 s46, s46, s50
    v_dot2_f32_bf16 v14, v224, v16, v14
    v_dot2_f32_bf16 v14, v225, v16, v14
    v_dot2_f32_bf16 v14, v226, v16, v14
    v_dot2_f32_bf16 v14, v227, v16, v14
    buffer_store_dwordx4 v[228:231], v9, s[28:31], s47 offen sc1
    s_add_u32 s47, s47, s51
    v_dot2_f32_bf16 v15, v228, v16, v15
    v_dot2_f32_bf16 v15, v229, v16, v15
    v_dot2_f32_bf16 v15, v230, v16, v15
    v_dot2_f32_bf16 v15, v231, v16, v15
    s_waitcnt lgkmcnt(0)
    ds_read_b64_tr_b16 v[200:201], v8 offset:0
    ds_read_b64_tr_b16 v[202:203], v8 offset:576
    ds_read_b64_tr_b16 v[204:205], v8 offset:32
    ds_read_b64_tr_b16 v[206:207], v8 offset:608
    ds_read_b64_tr_b16 v[208:209], v8 offset:64
    ds_read_b64_tr_b16 v[210:211], v8 offset:640
    ds_read_b64_tr_b16 v[212:213], v8 offset:96
    ds_read_b64_tr_b16 v[214:215], v8 offset:672
    s_waitcnt vmcnt(32)
    ds_write_b128 v5, v[176:179] offset:4608
    ds_write_b128 v5, v[180:183] offset:5760
    ds_write_b128 v5, v[184:187] offset:6912
    ds_write_b128 v5, v[188:191] offset:8064
    s_waitcnt lgkmcnt(4)
    buffer_store_dwordx4 v[200:203], v9, s[28:31], s44 offen sc1
    s_add_u32 s44, s44, s48
    v_dot2_f32_bf16 v12, v200, v16, v12
    v_dot2_f32_bf16 v12, v201, v16, v12
    v_dot2_f32_bf16 v12, v202, v16, v12
    v_dot2_f32_bf16 v12, v203, v16, v12
    buffer_store_dwordx4 v[204:207], v9, s[28:31], s45 offen sc1
    s_add_u32 s45, s45, s49
    v_dot2_f32_bf16 v13, v204, v16, v13
    v_dot2_f32_bf16 v13, v205, v16, v13
    v_dot2_f32_bf16 v13, v206, v16, v13
    v_dot2_f32_bf16 v13, v207, v16, v13
    buffer_store_dwordx4 v[208:211], v9, s[28:31], s46 offen sc1
    s_add_u32 s46, s46, s50
    v_dot2_f32_bf16 v14, v208, v16, v14
    v_dot2_f32_bf16 v14, v209, v16, v14
    v_dot2_f32_bf16 v14, v210, v16, v14
    v_dot2_f32_bf16 v14, v211, v16, v14
    buffer_store_dwordx4 v[212:215], v9, s[28:31], s47 offen sc1
    s_add_u32 s47, s47, s51
    v_dot2_f32_bf16 v15, v212, v16, v15
    v_dot2_f32_bf16 v15, v213, v16, v15
    v_dot2_f32_bf16 v15, v214, v16, v15
    v_dot2_f32_bf16 v15, v215, v16, v15
    s_waitcnt lgkmcnt(0)
    ds_read_b64_tr_b16 v[216:217], v8 offset:4608
    ds_read_b64_tr_b16 v[218:219], v8 offset:5184
    ds_read_b64_tr_b16 v[220:221], v8 offset:4640
    ds_read_b64_tr_b16 v[222:223], v8 offset:5216
    ds_read_b64_tr_b16 v[224:225], v8 offset:4672
    ds_read_b64_tr_b16 v[226:227], v8 offset:5248
    ds_read_b64_tr_b16 v[228:229], v8 offset:4704
    ds_read_b64_tr_b16 v[230:231], v8 offset:5280
    s_waitcnt lgkmcnt(0)
    buffer_store_dwordx4 v[216:219], v9, s[28:31], s44 offen sc1
    s_add_u32 s44, s44, s48
    v_dot2_f32_bf16 v12, v216, v16, v12
    v_dot2_f32_bf16 v12, v217, v16, v12
    v_dot2_f32_bf16 v12, v218, v16, v12
    v_dot2_f32_bf16 v12, v219, v16, v12
    buffer_store_dwordx4 v[220:223], v9, s[28:31], s45 offen sc1
    s_add_u32 s45, s45, s49
    v_dot2_f32_bf16 v13, v220, v16, v13
    v_dot2_f32_bf16 v13, v221, v16, v13
    v_dot2_f32_bf16 v13, v222, v16, v13
    v_dot2_f32_bf16 v13, v223, v16, v13
    buffer_store_dwordx4 v[224:227], v9, s[28:31], s46 offen sc1
    s_add_u32 s46, s46, s50
    v_dot2_f32_bf16 v14, v224, v16, v14
    v_dot2_f32_bf16 v14, v225, v16, v14
    v_dot2_f32_bf16 v14, v226, v16, v14
    v_dot2_f32_bf16 v14, v227, v16, v14
    buffer_store_dwordx4 v[228:231], v9, s[28:31], s47 offen sc1
    s_add_u32 s47, s47, s51
    v_dot2_f32_bf16 v15, v228, v16, v15
    v_dot2_f32_bf16 v15, v229, v16, v15
    v_dot2_f32_bf16 v15, v230, v16, v15
    v_dot2_f32_bf16 v15, v231, v16, v15
    s_nop 2
    v_mov_b32 v20, v12
    v_mov_b32 v21, v13
    v_mov_b32 v22, v14
    v_mov_b32 v23, v15
    s_nop 1
    v_permlane32_swap_b32 v20, v12
    v_permlane32_swap_b32 v21, v13
    v_permlane32_swap_b32 v22, v14
    v_permlane32_swap_b32 v23, v15
    s_nop 1
    v_add_f32 v12, v12, v20
    v_add_f32 v13, v13, v21
    v_add_f32 v14, v14, v22
    v_add_f32 v15, v15, v23
    v_mov_b32 v20, v12
    v_mov_b32 v21, v13
    v_mov_b32 v22, v14
    v_mov_b32 v23, v15
    s_nop 1
    v_permlane16_swap_b32 v20, v12
    v_permlane16_swap_b32 v21, v13
    v_permlane16_swap_b32 v22, v14
    v_permlane16_swap_b32 v23, v15
    s_nop 1
    v_add_f32 v12, v12, v20
    v_add_f32 v13, v13, v21
    v_add_f32 v14, v14, v22
    v_add_f32 v15, v15, v23
    s_mul_i32 s38, s33, 7168
    s_lshl_b32 s39, s35, 8
    s_add_u32 s38, s38, s39
    s_add_u32 s38, s38, 8130560
    v_lshlrev_b32 v17, 2, v1
    s_mov_b64 exec, 0xffff
    buffer_store_dword v12, v17, s[28:31], s38 offen offset:0 sc1
    buffer_store_dword v13, v17, s[28:31], s38 offen offset:64 sc1
    buffer_store_dword v14, v17, s[28:31], s38 offen offset:128 sc1
    buffer_store_dword v15, v17, s[28:31], s38 offen offset:192 sc1
    s_endpgm
prep_kernel_pk32:
    s_mov_b32 s24, s18
    s_mov_b32 s25, s19
    s_mov_b32 s26, 2211840
    s_mov_b32 s27, 0x00020000
    s_sub_u32 s32, s21, 94
    s_mul_i32 s33, s32, 52429
    s_lshr_b32 s33, s33, 19
    s_mul_i32 s35, s33, 10
    s_sub_u32 s35, s32, s35
    v_mul_u32_u24 v10, 1280, v3
    v_lshl_add_u32 v10, v4, 4, v10
    s_mul_i32 s36, s33, 368640
    s_lshl_b32 s37, s35, 7
    s_add_u32 s36, s36, s37
    buffer_load_dwordx4 v[32:35], v10, s[24:27], s36 offen nt
    s_add_u32 s36, s36, 10240
    buffer_load_dwordx4 v[36:39], v10, s[24:27], s36 offen nt
    s_add_u32 s36, s36, 10240
    buffer_load_dwordx4 v[40:43], v10, s[24:27], s36 offen nt
    s_add_u32 s36, s36, 10240
    buffer_load_dwordx4 v[44:47], v10, s[24:27], s36 offen nt
    s_add_u32 s36, s36, 10240
    buffer_load_dwordx4 v[48:51], v10, s[24:27], s36 offen nt
    s_add_u32 s36, s36, 10240
    buffer_load_dwordx4 v[52:55], v10, s[24:27], s36 offen nt
    s_add_u32 s36, s36, 10240
    buffer_load_dwordx4 v[56:59], v10, s[24:27], s36 offen nt
    s_add_u32 s36, s36, 10240
    buffer_load_dwordx4 v[60:63], v10, s[24:27], s36 offen nt
    s_add_u32 s36, s36, 10240
    buffer_load_dwordx4 v[64:67], v10, s[24:27], s36 offen nt
    s_add_u32 s36, s36, 10240
    buffer_load_dwordx4 v[68:71], v10, s[24:27], s36 offen nt
    s_add_u32 s36, s36, 10240
    buffer_load_dwordx4 v[72:75], v10, s[24:27], s36 offen nt
    s_add_u32 s36, s36, 10240
    buffer_load_dwordx4 v[76:79], v10, s[24:27], s36 offen nt
    s_add_u32 s36, s36, 10240
    buffer_load_dwordx4 v[80:83], v10, s[24:27], s36 offen nt
    s_add_u32 s36, s36, 10240
    buffer_load_dwordx4 v[84:87], v10, s[24:27], s36 offen nt
    s_add_u32 s36, s36, 10240
    buffer_load_dwordx4 v[88:91], v10, s[24:27], s36 offen nt
    s_add_u32 s36, s36, 10240
    buffer_load_dwordx4 v[92:95], v10, s[24:27], s36 offen nt
    s_add_u32 s36, s36, 10240
    buffer_load_dwordx4 v[96:99], v10, s[24:27], s36 offen nt
    s_add_u32 s36, s36, 10240
    buffer_load_dwordx4 v[100:103], v10, s[24:27], s36 offen nt
    s_add_u32 s36, s36, 10240
    buffer_load_dwordx4 v[104:107], v10, s[24:27], s36 offen nt
    s_add_u32 s36, s36, 10240
    buffer_load_dwordx4 v[108:111], v10, s[24:27], s36 offen nt
    s_add_u32 s36, s36, 10240
    buffer_load_dwordx4 v[112:115], v10, s[24:27], s36 offen nt
    s_add_u32 s36, s36, 10240
    buffer_load_dwordx4 v[116:119], v10, s[24:27], s36 offen nt
    s_add_u32 s36, s36, 10240
    buffer_load_dwordx4 v[120:123], v10, s[24:27], s36 offen nt
    s_add_u32 s36, s36, 10240
    buffer_load_dwordx4 v[124:127], v10, s[24:27], s36 offen nt
    s_add_u32 s36, s36, 10240
    buffer_load_dwordx4 v[128:131], v10, s[24:27], s36 offen nt
    s_add_u32 s36, s36, 10240
    buffer_load_dwordx4 v[132:135], v10, s[24:27], s36 offen nt
    s_add_u32 s36, s36, 10240
    buffer_load_dwordx4 v[136:139], v10, s[24:27], s36 offen nt
    s_add_u32 s36, s36, 10240
    buffer_load_dwordx4 v[140:143], v10, s[24:27], s36 offen nt
    s_add_u32 s36, s36, 10240
    buffer_load_dwordx4 v[144:147], v10, s[24:27], s36 offen nt
    s_add_u32 s36, s36, 10240
    buffer_load_dwordx4 v[148:151], v10, s[24:27], s36 offen nt
    s_add_u32 s36, s36, 10240
    buffer_load_dwordx4 v[152:155], v10, s[24:27], s36 offen nt
    s_add_u32 s36, s36, 10240
    buffer_load_dwordx4 v[156:159], v10, s[24:27], s36 offen nt
    s_add_u32 s36, s36, 10240
    buffer_load_dwordx4 v[160:163], v10, s[24:27], s36 offen nt
    s_add_u32 s36, s36, 10240
    buffer_load_dwordx4 v[164:167], v10, s[24:27], s36 offen nt
    s_add_u32 s36, s36, 10240
    buffer_load_dwordx4 v[168:171], v10, s[24:27], s36 offen nt
    s_add_u32 s36, s36, 10240
    buffer_load_dwordx4 v[172:175], v10, s[24:27], s36 offen nt
    s_lshl_b32 s36, s35, 2
    s_add_u32 s36, s36, 0
    s_mul_i32 s38, s36, 13108
    s_lshr_b32 s38, s38, 16
    s_mul_i32 s39, s38, 5
    s_sub_u32 s39, s36, s39
    s_sub_u32 s41, s39, 1
    s_cmp_eq_u32 s39, 0
    s_cselect_b32 s41, 4, s41
    s_and_b32 s40, s38, 1
    s_cmp_eq_u32 s40, 1
    s_cselect_b32 s39, s41, s39
    s_mul_i32 s40, s33, 21846
    s_lshr_b32 s40, s40, 16
    s_mul_i32 s41, s40, 3
    s_sub_u32 s41, s33, s41
    s_mul_i32 s37, s38, 270
    s_mul_i32 s41, s41, 90
    s_add_u32 s37, s37, s41
    s_mul_i32 s40, s40, 5
    s_add_u32 s37, s37, s40
    s_add_u32 s37, s37, s39
    s_lshl_b32 s37, s37, 10
    s_add_u32 s44, s37, 27168768
    s_movk_i32 s48, 10240
    s_lshl_b32 s36, s35, 2
    s_add_u32 s36, s36, 1
    s_mul_i32 s38, s36, 13108
    s_lshr_b32 s38, s38, 16
    s_mul_i32 s39, s38, 5
    s_sub_u32 s39, s36, s39
    s_sub_u32 s41, s39, 1
    s_cmp_eq_u32 s39, 0
    s_cselect_b32 s41, 4, s41
    s_and_b32 s40, s38, 1
    s_cmp_eq_u32 s40, 1
    s_cselect_b32 s39, s41, s39
    s_mul_i32 s40, s33, 21846
    s_lshr_b32 s40, s40, 16
    s_mul_i32 s41, s40, 3
    s_sub_u32 s41, s33, s41
    s_mul_i32 s37, s38, 270
    s_mul_i32 s41, s41, 90
    s_add_u32 s37, s37, s41
    s_mul_i32 s40, s40, 5
    s_add_u32 s37, s37, s40
    s_add_u32 s37, s37, s39
    s_lshl_b32 s37, s37, 10
    s_add_u32 s45, s37, 27168768
    s_movk_i32 s49, 10240
    s_lshl_b32 s36, s35, 2
    s_add_u32 s36, s36, 2
    s_mul_i32 s38, s36, 13108
    s_lshr_b32 s38, s38, 16
    s_mul_i32 s39, s38, 5
    s_sub_u32 s39, s36, s39
    s_sub_u32 s41, s39, 1
    s_cmp_eq_u32 s39, 0
    s_cselect_b32 s41, 4, s41
    s_and_b32 s40, s38, 1
    s_cmp_eq_u32 s40, 1
    s_cselect_b32 s39, s41, s39
    s_mul_i32 s40, s33, 21846
    s_lshr_b32 s40, s40, 16
    s_mul_i32 s41, s40, 3
    s_sub_u32 s41, s33, s41
    s_mul_i32 s37, s38, 270
    s_mul_i32 s41, s41, 90
    s_add_u32 s37, s37, s41
    s_mul_i32 s40, s40, 5
    s_add_u32 s37, s37, s40
    s_add_u32 s37, s37, s39
    s_lshl_b32 s37, s37, 10
    s_add_u32 s46, s37, 27168768
    s_movk_i32 s50, 10240
    s_lshl_b32 s36, s35, 2
    s_add_u32 s36, s36, 3
    s_mul_i32 s38, s36, 13108
    s_lshr_b32 s38, s38, 16
    s_mul_i32 s39, s38, 5
    s_sub_u32 s39, s36, s39
    s_sub_u32 s41, s39, 1
    s_cmp_eq_u32 s39, 0
    s_cselect_b32 s41, 4, s41
    s_and_b32 s40, s38, 1
    s_cmp_eq_u32 s40, 1
    s_cselect_b32 s39, s41, s39
    s_mul_i32 s40, s33, 21846
    s_lshr_b32 s40, s40, 16
    s_mul_i32 s41, s40, 3
    s_sub_u32 s41, s33, s41
    s_mul_i32 s37, s38, 270
    s_mul_i32 s41, s41, 90
    s_add_u32 s37, s37, s41
    s_mul_i32 s40, s40, 5
    s_add_u32 s37, s37, s40
    s_add_u32 s37, s37, s39
    s_lshl_b32 s37, s37, 10
    s_add_u32 s47, s37, 27168768
    s_movk_i32 s51, 10240
    s_waitcnt vmcnt(32)
    ds_write_b128 v5, v[32:35] offset:0
    ds_write_b128 v5, v[36:39] offset:1152
    ds_write_b128 v5, v[40:43] offset:2304
    ds_write_b128 v5, v[44:47] offset:3456
    s_waitcnt lgkmcnt(0)
    ds_read_b64_tr_b16 v[200:201], v8 offset:0
    ds_read_b64_tr_b16 v[202:203], v8 offset:576
    ds_read_b64_tr_b16 v[204:205], v8 offset:32
    ds_read_b64_tr_b16 v[206:207], v8 offset:608
    ds_read_b64_tr_b16 v[208:209], v8 offset:64
    ds_read_b64_tr_b16 v[210:211], v8 offset:640
    ds_read_b64_tr_b16 v[212:213], v8 offset:96
    ds_read_b64_tr_b16 v[214:215], v8 offset:672
    s_waitcnt vmcnt(28)
    ds_write_b128 v5, v[48:51] offset:4608
    ds_write_b128 v5, v[52:55] offset:5760
    ds_write_b128 v5, v[56:59] offset:6912
    ds_write_b128 v5, v[60:63] offset:8064
    s_waitcnt lgkmcnt(4)
    buffer_store_dwordx4 v[200:203], v9, s[28:31], s44 offen sc1
    s_add_u32 s44, s44, s48
    buffer_store_dwordx4 v[204:207], v9, s[28:31], s45 offen sc1
    s_add_u32 s45, s45, s49
    buffer_store_dwordx4 v[208:211], v9, s[28:31], s46 offen sc1
    s_add_u32 s46, s46, s50
    buffer_store_dwordx4 v[212:215], v9, s[28:31], s47 offen sc1
    s_add_u32 s47, s47, s51
    s_waitcnt lgkmcnt(0)
    ds_read_b64_tr_b16 v[216:217], v8 offset:4608
    ds_read_b64_tr_b16 v[218:219], v8 offset:5184
    ds_read_b64_tr_b16 v[220:221], v8 offset:4640
    ds_read_b64_tr_b16 v[222:223], v8 offset:5216
    ds_read_b64_tr_b16 v[224:225], v8 offset:4672
    ds_read_b64_tr_b16 v[226:227], v8 offset:5248
    ds_read_b64_tr_b16 v[228:229], v8 offset:4704
    ds_read_b64_tr_b16 v[230:231], v8 offset:5280
    s_waitcnt vmcnt(28)
    ds_write_b128 v5, v[64:67] offset:0
    ds_write_b128 v5, v[68:71] offset:1152
    ds_write_b128 v5, v[72:75] offset:2304
    ds_write_b128 v5, v[76:79] offset:3456
    s_waitcnt lgkmcnt(4)
    buffer_store_dwordx4 v[216:219], v9, s[28:31], s44 offen sc1
    s_add_u32 s44, s44, s48
    buffer_store_dwordx4 v[220:223], v9, s[28:31], s45 offen sc1
    s_add_u32 s45, s45, s49
    buffer_store_dwordx4 v[224:227], v9, s[28:31], s46 offen sc1
    s_add_u32 s46, s46, s50
    buffer_store_dwordx4 v[228:231], v9, s[28:31], s47 offen sc1
    s_add_u32 s47, s47, s51
    s_waitcnt lgkmcnt(0)
    ds_read_b64_tr_b16 v[200:201], v8 offset:0
    ds_read_b64_tr_b16 v[202:203], v8 offset:576
    ds_read_b64_tr_b16 v[204:205], v8 offset:32
    ds_read_b64_tr_b16 v[206:207], v8 offset:608
    ds_read_b64_tr_b16 v[208:209], v8 offset:64
    ds_read_b64_tr_b16 v[210:211], v8 offset:640
    ds_read_b64_tr_b16 v[212:213], v8 offset:96
    ds_read_b64_tr_b16 v[214:215], v8 offset:672
    s_waitcnt vmcnt(28)
    ds_write_b128 v5, v[80:83] offset:4608
    ds_write_b128 v5, v[84:87] offset:5760
    ds_write_b128 v5, v[88:91] offset:6912
    ds_write_b128 v5, v[92:95] offset:8064
    s_waitcnt lgkmcnt(4)
    buffer_store_dwordx4 v[200:203], v9, s[28:31], s44 offen sc1
    s_add_u32 s44, s44, s48
    buffer_store_dwordx4 v[204:207], v9, s[28:31], s45 offen sc1
    s_add_u32 s45, s45, s49
    buffer_store_dwordx4 v[208:211], v9, s[28:31], s46 offen sc1
    s_add_u32 s46, s46, s50
    buffer_store_dwordx4 v[212:215], v9, s[28:31], s47 offen sc1
    s_add_u32 s47, s47, s51
    s_waitcnt lgkmcnt(0)
    ds_read_b64_tr_b16 v[216:217], v8 offset:4608
    ds_read_b64_tr_b16 v[218:219], v8 offset:5184
    ds_read_b64_tr_b16 v[220:221], v8 offset:4640
    ds_read_b64_tr_b16 v[222:223], v8 offset:5216
    ds_read_b64_tr_b16 v[224:225], v8 offset:4672
    ds_read_b64_tr_b16 v[226:227], v8 offset:5248
    ds_read_b64_tr_b16 v[228:229], v8 offset:4704
    ds_read_b64_tr_b16 v[230:231], v8 offset:5280
    s_waitcnt vmcnt(28)
    ds_write_b128 v5, v[96:99] offset:0
    ds_write_b128 v5, v[100:103] offset:1152
    ds_write_b128 v5, v[104:107] offset:2304
    ds_write_b128 v5, v[108:111] offset:3456
    s_waitcnt lgkmcnt(4)
    buffer_store_dwordx4 v[216:219], v9, s[28:31], s44 offen sc1
    s_add_u32 s44, s44, s48
    buffer_store_dwordx4 v[220:223], v9, s[28:31], s45 offen sc1
    s_add_u32 s45, s45, s49
    buffer_store_dwordx4 v[224:227], v9, s[28:31], s46 offen sc1
    s_add_u32 s46, s46, s50
    buffer_store_dwordx4 v[228:231], v9, s[28:31], s47 offen sc1
    s_add_u32 s47, s47, s51
    s_waitcnt lgkmcnt(0)
    ds_read_b64_tr_b16 v[200:201], v8 offset:0
    ds_read_b64_tr_b16 v[202:203], v8 offset:576
    ds_read_b64_tr_b16 v[204:205], v8 offset:32
    ds_read_b64_tr_b16 v[206:207], v8 offset:608
    ds_read_b64_tr_b16 v[208:209], v8 offset:64
    ds_read_b64_tr_b16 v[210:211], v8 offset:640
    ds_read_b64_tr_b16 v[212:213], v8 offset:96
    ds_read_b64_tr_b16 v[214:215], v8 offset:672
    s_waitcnt vmcnt(28)
    ds_write_b128 v5, v[112:115] offset:4608
    ds_write_b128 v5, v[116:119] offset:5760
    ds_write_b128 v5, v[120:123] offset:6912
    ds_write_b128 v5, v[124:127] offset:8064
    s_waitcnt lgkmcnt(4)
    buffer_store_dwordx4 v[200:203], v9, s[28:31], s44 offen sc1
    s_add_u32 s44, s44, s48
    buffer_store_dwordx4 v[204:207], v9, s[28:31], s45 offen sc1
    s_add_u32 s45, s45, s49
    buffer_store_dwordx4 v[208:211], v9, s[28:31], s46 offen sc1
    s_add_u32 s46, s46, s50
    buffer_store_dwordx4 v[212:215], v9, s[28:31], s47 offen sc1
    s_add_u32 s47, s47, s51
    s_waitcnt lgkmcnt(0)
    ds_read_b64_tr_b16 v[216:217], v8 offset:4608
    ds_read_b64_tr_b16 v[218:219], v8 offset:5184
    ds_read_b64_tr_b16 v[220:221], v8 offset:4640
    ds_read_b64_tr_b16 v[222:223], v8 offset:5216
    ds_read_b64_tr_b16 v[224:225], v8 offset:4672
    ds_read_b64_tr_b16 v[226:227], v8 offset:5248
    ds_read_b64_tr_b16 v[228:229], v8 offset:4704
    ds_read_b64_tr_b16 v[230:231], v8 offset:5280
    s_waitcnt vmcnt(28)
    ds_write_b128 v5, v[128:131] offset:0
    ds_write_b128 v5, v[132:135] offset:1152
    ds_write_b128 v5, v[136:139] offset:2304
    ds_write_b128 v5, v[140:143] offset:3456
    s_waitcnt lgkmcnt(4)
    buffer_store_dwordx4 v[216:219], v9, s[28:31], s44 offen sc1
    s_add_u32 s44, s44, s48
    buffer_store_dwordx4 v[220:223], v9, s[28:31], s45 offen sc1
    s_add_u32 s45, s45, s49
    buffer_store_dwordx4 v[224:227], v9, s[28:31], s46 offen sc1
    s_add_u32 s46, s46, s50
    buffer_store_dwordx4 v[228:231], v9, s[28:31], s47 offen sc1
    s_add_u32 s47, s47, s51
    s_waitcnt lgkmcnt(0)
    ds_read_b64_tr_b16 v[200:201], v8 offset:0
    ds_read_b64_tr_b16 v[202:203], v8 offset:576
    ds_read_b64_tr_b16 v[204:205], v8 offset:32
    ds_read_b64_tr_b16 v[206:207], v8 offset:608
    ds_read_b64_tr_b16 v[208:209], v8 offset:64
    ds_read_b64_tr_b16 v[210:211], v8 offset:640
    ds_read_b64_tr_b16 v[212:213], v8 offset:96
    ds_read_b64_tr_b16 v[214:215], v8 offset:672
    s_waitcnt vmcnt(28)
    ds_write_b128 v5, v[144:147] offset:4608
    ds_write_b128 v5, v[148:151] offset:5760
    ds_write_b128 v5, v[152:155] offset:6912
    ds_write_b128 v5, v[156:159] offset:8064
    s_waitcnt lgkmcnt(4)
    buffer_store_dwordx4 v[200:203], v9, s[28:31], s44 offen sc1
    s_add_u32 s44, s44, s48
    buffer_store_dwordx4 v[204:207], v9, s[28:31], s45 offen sc1
    s_add_u32 s45, s45, s49
    buffer_store_dwordx4 v[208:211], v9, s[28:31], s46 offen sc1
    s_add_u32 s46, s46, s50
    buffer_store_dwordx4 v[212:215], v9, s[28:31], s47 offen sc1
    s_add_u32 s47, s47, s51
    s_waitcnt lgkmcnt(0)
    ds_read_b64_tr_b16 v[216:217], v8 offset:4608
    ds_read_b64_tr_b16 v[218:219], v8 offset:5184
    ds_read_b64_tr_b16 v[220:221], v8 offset:4640
    ds_read_b64_tr_b16 v[222:223], v8 offset:5216
    ds_read_b64_tr_b16 v[224:225], v8 offset:4672
    ds_read_b64_tr_b16 v[226:227], v8 offset:5248
    ds_read_b64_tr_b16 v[228:229], v8 offset:4704
    ds_read_b64_tr_b16 v[230:231], v8 offset:5280
    s_waitcnt vmcnt(28)
    ds_write_b128 v5, v[160:163] offset:0
    ds_write_b128 v5, v[164:167] offset:1152
    ds_write_b128 v5, v[168:171] offset:2304
    ds_write_b128 v5, v[172:175] offset:3456
    s_waitcnt lgkmcnt(4)
    buffer_store_dwordx4 v[216:219], v9, s[28:31], s44 offen sc1
    s_add_u32 s44, s44, s48
    buffer_store_dwordx4 v[220:223], v9, s[28:31], s45 offen sc1
    s_add_u32 s45, s45, s49
    buffer_store_dwordx4 v[224:227], v9, s[28:31], s46 offen sc1
    s_add_u32 s46, s46, s50
    buffer_store_dwordx4 v[228:231], v9, s[28:31], s47 offen sc1
    s_add_u32 s47, s47, s51
    s_waitcnt lgkmcnt(0)
    ds_read_b64_tr_b16 v[200:201], v8 offset:0
    ds_read_b64_tr_b16 v[202:203], v8 offset:576
    ds_read_b64_tr_b16 v[204:205], v8 offset:32
    ds_read_b64_tr_b16 v[206:207], v8 offset:608
    ds_read_b64_tr_b16 v[208:209], v8 offset:64
    ds_read_b64_tr_b16 v[210:211], v8 offset:640
    ds_read_b64_tr_b16 v[212:213], v8 offset:96
    ds_read_b64_tr_b16 v[214:215], v8 offset:672
    s_waitcnt lgkmcnt(0)
    buffer_store_dwordx4 v[200:203], v9, s[28:31], s44 offen sc1
    s_add_u32 s44, s44, s48
    buffer_store_dwordx4 v[204:207], v9, s[28:31], s45 offen sc1
    s_add_u32 s45, s45, s49
    buffer_store_dwordx4 v[208:211], v9, s[28:31], s46 offen sc1
    s_add_u32 s46, s46, s50
    buffer_store_dwordx4 v[212:215], v9, s[28:31], s47 offen sc1
    s_add_u32 s47, s47, s51
    s_endpgm
.globl chain_kernel
.p2align 8
.type chain_kernel,@function
chain_kernel:
    s_cmp_ge_u32 s2, 256
    s_cbranch_scc1 chain_end
    s_load_dwordx2 s[4:5], s[0:1], 0
    s_load_dwordx2 s[6:7], s[0:1], 104
    s_load_dwordx2 s[10:11], s[0:1], 120
    v_lshrrev_b32 v2, 6, v0
    v_and_b32 v1, 63, v0
    v_readfirstlane_b32 s20, v2
    s_and_b32 s25, s2, 7
    s_lshr_b32 s26, s2, 3
    s_lshl_b32 s23, s25, 3
    s_lshr_b32 s27, s26, 2
    s_add_u32 s23, s23, s27
    s_and_b32 s24, s26, 3
    s_and_b32 s21, s20, 1
    s_lshr_b32 s22, s20, 1
    v_lshrrev_b32 v3, 4, v1
    v_and_b32 v4, 15, v1
    v_lshlrev_b32 v8, 4, v1
    s_waitcnt lgkmcnt(0)
    s_mov_b32 s28, s10
    s_mov_b32 s29, s11
    s_mov_b32 s30, 268435456
    s_mov_b32 s31, 0x00020000
    s_mul_i32 s25, s20, 10240
    s_add_u32 s10, s25, 0
    s_mul_i32 s11, s23, 40960
    s_add_u32 s11, s11, s25
    s_add_u32 s11, s11, 5492736
    s_lshl_b32 s12, s20, 10
    s_add_u32 s13, s12, 8121856
    s_add_u32 s12, s12, 130560
    s_lshl_b32 s14, s21, 10
    s_add_u32 s14, s14, 139264
    s_mul_i32 s15, s21, 7168
    s_mul_i32 s25, s24, 640
    s_add_u32 s15, s15, s25
    s_add_u32 s15, s15, 8146944
    s_mov_b32 m0, s10
    s_add_u32 s10, s10, 4096
    buffer_load_dwordx4 v8, s[28:31], s11 offen offset:0 lds
    buffer_load_dwordx4 v8, s[28:31], s11 offen offset:1024 lds
    buffer_load_dwordx4 v8, s[28:31], s11 offen offset:2048 lds
    buffer_load_dwordx4 v8, s[28:31], s11 offen offset:3072 lds
    s_add_u32 s11, s11, 4096
    s_mov_b32 m0, s10
    s_add_u32 s10, s10, 4096
    buffer_load_dwordx4 v8, s[28:31], s11 offen offset:0 lds
    buffer_load_dwordx4 v8, s[28:31], s11 offen offset:1024 lds
    buffer_load_dwordx4 v8, s[28:31], s11 offen offset:2048 lds
    buffer_load_dwordx4 v8, s[28:31], s11 offen offset:3072 lds
    s_add_u32 s11, s11, 4096
    s_mov_b32 m0, s10
    s_add_u32 s10, s10, 4096
    buffer_load_dwordx4 v8, s[28:31], s11 offen offset:0 lds
    buffer_load_dwordx4 v8, s[28:31], s11 offen offset:1024 lds
    s_mov_b32 m0, s12
    s_nop 0
    buffer_load_dwordx4 v8, s[28:31], s13 offen lds
    s_mov_b32 m0, 134656
    s_mov_b32 s13, 8125952
    buffer_load_dwordx4 v8, s[28:31], s13 offen lds
    s_mov_b32 m0, s14
    s_nop 0
    buffer_load_dwordx4 v8, s[28:31], s15 offen lds
    s_mov_b32 s32, s6
    s_mov_b32 s33, s7
    s_mov_b32 s34, 2621440
    s_mov_b32 s35, 0x00020000
    s_mul_i32 s36, s24, 200
    s_mul_i32 s37, s21, 100
    s_add_u32 s36, s36, s37
    s_mul_i32 s37, s22, 50
    s_add_u32 s36, s36, s37
    s_lshl_b32 s36, s36, 10
    s_add_u32 s37, s36, 24055808
    s_add_u32 s36, s36, 23236608
    v_lshrrev_b32 v2, 1, v3
    s_lshl_b32 s26, s21, 2
    v_add_u32 v2, s26, v2
    v_and_b32 v7, 7, v4
    buffer_load_dwordx4 a[0:3], v8, s[28:31], s36 offen offset:0
    v_xor_b32 v2, v2, v7
    v_lshlrev_b32 v2, 4, v2
    v_lshl_add_u32 v226, v4, 8, v2
    v_and_b32 v2, 1, v3
    v_lshl_add_u32 v226, v2, 3, v226
    s_mul_i32 s26, s22, 20480
    s_add_u32 s27, s26, 0
    v_add_u32 v226, s27, v226
    v_lshlrev_b32 v227, 5, v4
    v_add_u32 v227, 122880, v227
    s_lshl_b32 s27, s21, 3
    v_add_u32 v2, s27, v3
    v_xor_b32 v2, v2, v7
    v_lshlrev_b32 v2, 4, v2
    v_and_b32 v7, 3, v4
    v_lshl_add_u32 v2, v7, 8, v2
    v_lshrrev_b32 v7, 2, v4
    buffer_load_dwordx4 a[4:7], v8, s[28:31], s36 offen offset:1024
    v_lshl_add_u32 v2, v7, 10, v2
    s_add_u32 s27, s26, 40960
    v_add_u32 v228, s27, v2
    v_xor_b32 v2, v4, v3
    v_lshlrev_b32 v2, 4, v2
    v_lshl_add_u32 v2, v3, 8, v2
    v_xor_b32 v7, 64, v2
    s_mul_i32 s26, s22, 30720
    s_add_u32 s26, s26, 40960
    s_mul_i32 s27, s22, 10240
    s_sub_u32 s27, 61440, s27
    v_add_u32 v229, s26, v2
    v_add_u32 v230, s26, v7
    v_add_u32 v231, s27, v2
    v_add_u32 v232, s27, v7
    v_lshlrev_b32 v2, 4, v3
    s_mul_i32 s26, s21, 384
    buffer_load_dwordx4 a[8:11], v8, s[28:31], s36 offen offset:2048
    s_add_u32 s26, s26, 139264
    v_add_u32 v233, s26, v2
    s_mul_i32 s26, s21, 64
    s_add_u32 s26, s26, 139520
    v_add_u32 v234, s26, v2
    s_lshl_b32 s26, s22, 7
    s_add_u32 s26, s26, 138240
    v_lshl_add_u32 v235, v4, 3, s26
    s_mul_i32 s39, s24, 5
    s_mul_i32 s40, s21, 3
    s_add_u32 s40, s40, s39
    s_add_u32 s41, s39, 2
    v_lshrrev_b32 v12, 1, v3
    v_and_b32 v13, 1, v3
    v_lshlrev_b32 v13, 3, v13
    s_add_u32 s26, s40, 0
    buffer_load_dwordx4 a[12:15], v8, s[28:31], s36 offen offset:3072
    v_add_u32 v14, 0, v12
    s_and_b32 s27, s26, 1
    s_lshl_b32 s27, s27, 2
    v_add_u32 v15, s27, v14
    v_xor_b32 v15, v15, v4
    v_lshlrev_b32 v15, 4, v15
    v_lshl_add_u32 v15, v14, 8, v15
    v_add_u32 v15, v15, v13
    s_mul_i32 s27, s22, 20
    s_add_u32 s27, s27, s26
    s_lshl_b32 s27, s27, 10
    s_add_u32 s27, s27, 40960
    v_add_u32 v236, s27, v15
    s_add_u32 s26, s40, 0
    v_add_u32 v14, 2, v12
    s_and_b32 s27, s26, 1
    s_lshl_b32 s27, s27, 2
    s_add_u32 s36, s36, 4096
    buffer_load_dwordx4 a[16:19], v8, s[28:31], s36 offen offset:0
    v_add_u32 v15, s27, v14
    v_xor_b32 v15, v15, v4
    v_lshlrev_b32 v15, 4, v15
    v_lshl_add_u32 v15, v14, 8, v15
    v_add_u32 v15, v15, v13
    s_mul_i32 s27, s22, 20
    s_add_u32 s27, s27, s26
    s_lshl_b32 s27, s27, 10
    s_add_u32 s27, s27, 40960
    v_add_u32 v237, s27, v15
    s_add_u32 s26, s40, 1
    v_add_u32 v14, 0, v12
    s_and_b32 s27, s26, 1
    s_lshl_b32 s27, s27, 2
    v_add_u32 v15, s27, v14
    v_xor_b32 v15, v15, v4
    v_lshlrev_b32 v15, 4, v15
    buffer_load_dwordx4 a[20:23], v8, s[28:31], s36 offen offset:1024
    v_lshl_add_u32 v15, v14, 8, v15
    v_add_u32 v15, v15, v13
    s_mul_i32 s27, s22, 20
    s_add_u32 s27, s27, s26
    s_lshl_b32 s27, s27, 10
    s_add_u32 s27, s27, 40960
    v_add_u32 v238, s27, v15
    s_add_u32 s26, s40, 1
    v_add_u32 v14, 2, v12
    s_and_b32 s27, s26, 1
    s_lshl_b32 s27, s27, 2
    v_add_u32 v15, s27, v14
    v_xor_b32 v15, v15, v4
    v_lshlrev_b32 v15, 4, v15
    v_lshl_add_u32 v15, v14, 8, v15
    v_add_u32 v15, v15, v13
    s_mul_i32 s27, s22, 20
    buffer_load_dwordx4 a[24:27], v8, s[28:31], s36 offen offset:2048
    s_add_u32 s27, s27, s26
    s_lshl_b32 s27, s27, 10
    s_add_u32 s27, s27, 40960
    v_add_u32 v239, s27, v15
    s_mov_b32 s26, s41
    s_lshl_b32 s27, s21, 1
    v_add_u32 v14, s27, v12
    s_and_b32 s27, s26, 1
    s_lshl_b32 s27, s27, 2
    v_add_u32 v15, s27, v14
    v_xor_b32 v15, v15, v4
    v_lshlrev_b32 v15, 4, v15
    v_lshl_add_u32 v15, v14, 8, v15
    v_add_u32 v15, v15, v13
    s_mul_i32 s27, s22, 20
    s_add_u32 s27, s27, s26
    s_lshl_b32 s27, s27, 10
    buffer_load_dwordx4 a[28:31], v8, s[28:31], s36 offen offset:3072
    s_add_u32 s27, s27, 40960
    v_add_u32 v240, s27, v15
    s_lshr_b32 s26, s24, 1
    s_add_u32 s26, s26, 1
    s_sub_u32 s27, 0, s26
    s_and_b32 s42, s24, 1
    s_cmp_eq_u32 s42, 1
    s_cselect_b32 s42, s27, s26
    s_lshl_b32 s43, s23, 5
    s_lshl_b32 s26, s22, 4
    s_add_u32 s43, s43, s26
    v_add_u32 v241, s43, v4
    v_add_u32 v241, s42, v241
    s_movk_i32 s27, 2048
    v_cmp_gt_u32 s[60:61], s27, v241
    v_lshrrev_b32 v242, 4, v241
    s_add_u32 s36, s36, 4096
    buffer_load_dwordx4 a[32:35], v8, s[28:31], s36 offen offset:0
    v_and_b32 v241, 15, v241
    s_mov_b32 s27, 20480
    v_mul_lo_u32 v242, v242, s27
    v_lshl_add_u32 v242, v241, 4, v242
    v_and_b32 v241, 1, v3
    v_lshlrev_b32 v241, 9, v241
    v_lshrrev_b32 v2, 1, v3
    v_lshl_add_u32 v241, v2, 8, v241
    v_add_u32 v241, v241, v242
    s_lshl_b32 s27, s21, 9
    v_lshl_add_u32 v242, v2, 8, v242
    v_add_u32 v242, s27, v242
    v_and_b32 v2, 1, v3
    v_lshl_add_u32 v242, v2, 3, v242
    s_lshl_b32 s44, s40, 10
    s_add_u32 s44, s44, 10784768
    s_lshl_b32 s45, s41, 10
    buffer_load_dwordx4 a[36:39], v8, s[28:31], s36 offen offset:1024
    s_add_u32 s45, s45, 10784768
    s_lshl_b32 s46, s23, 2
    s_add_u32 s46, s46, s24
    s_lshl_b32 s46, s46, 7
    s_add_u32 s46, s46, 29380608
    s_mul_i32 s26, s20, 5120
    s_add_u32 s26, s26, 143360
    v_add_u32 v246, s26, v8
    s_xor_b32 s27, s20, 2
    s_mul_i32 s27, s27, 5120
    s_add_u32 s27, s27, 143360
    v_add_u32 v247, s27, v8
    v_mov_b32 v224, 0x3f803f80
    v_mov_b32 v216, 0
    v_mov_b32 v217, 0
    v_mov_b32 v220, 0
    buffer_load_dwordx4 a[40:43], v8, s[28:31], s36 offen offset:2048
    v_mov_b32 v221, 0
    v_mov_b32 v218, 0
    v_mov_b32 v219, 0
    v_mov_b32 v222, 0
    v_mov_b32 v223, 0
    buffer_load_dwordx4 a[44:47], v8, s[28:31], s36 offen offset:3072
    s_add_u32 s36, s36, 4096
    buffer_load_dwordx4 a[48:51], v8, s[28:31], s36 offen offset:0
    s_waitcnt vmcnt(13)
    s_barrier
    v_xor_b32 v12, 32, v226
    ds_read_b64 v[32:33], v226 offset:0
    buffer_load_dwordx4 a[52:55], v8, s[28:31], s36 offen offset:1024
    ds_read_b64 v[34:35], v226 offset:128
    ds_read_b64 v[36:37], v12 offset:0
    ds_read_b64 v[38:39], v12 offset:128
    ds_read_b64 v[40:41], v226 offset:4096
    ds_read_b64 v[42:43], v226 offset:4224
    s_waitcnt lgkmcnt(4)
    v_dot2_f32_bf16 v220, v32, v224, v220
    buffer_load_dwordx4 a[56:59], v8, s[28:31], s36 offen offset:2048
    v_lshlrev_b32 v72, 16, v32
    v_dot2_f32_bf16 v221, v32, v32, v221
    v_and_b32 v73, 0xffff0000, v32
    v_dot2_f32_bf16 v220, v33, v224, v220
    ds_read_b64 v[44:45], v12 offset:4096
    v_lshlrev_b32 v74, 16, v33
    v_dot2_f32_bf16 v221, v33, v33, v221
    v_and_b32 v75, 0xffff0000, v33
    v_dot2_f32_bf16 v220, v34, v224, v220
    ds_read_b64 v[46:47], v12 offset:4224
    v_lshlrev_b32 v76, 16, v34
    v_dot2_f32_bf16 v221, v34, v34, v221
    v_and_b32 v77, 0xffff0000, v34
    buffer_load_dwordx4 a[60:63], v8, s[28:31], s36 offen offset:3072
    v_dot2_f32_bf16 v220, v35, v224, v220
    v_lshlrev_b32 v78, 16, v35
    v_dot2_f32_bf16 v221, v35, v35, v221
    v_and_b32 v79, 0xffff0000, v35
    s_waitcnt lgkmcnt(4)
    v_dot2_f32_bf16 v222, v36, v224, v222
    v_lshlrev_b32 v80, 16, v36
    v_dot2_f32_bf16 v223, v36, v36, v223
    v_and_b32 v81, 0xffff0000, v36
    v_dot2_f32_bf16 v222, v37, v224, v222
    ds_read_b64 v[48:49], v226 offset:8192
    v_lshlrev_b32 v82, 16, v37
    v_dot2_f32_bf16 v223, v37, v37, v223
    v_and_b32 v83, 0xffff0000, v37
    v_dot2_f32_bf16 v222, v38, v224, v222
    s_add_u32 s36, s36, 4096
    buffer_load_dwordx4 a[64:67], v8, s[28:31], s36 offen offset:0
    ds_read_b64 v[50:51], v226 offset:8320
    v_lshlrev_b32 v84, 16, v38
    v_dot2_f32_bf16 v223, v38, v38, v223
    v_and_b32 v85, 0xffff0000, v38
    v_dot2_f32_bf16 v222, v39, v224, v222
    v_lshlrev_b32 v86, 16, v39
    v_dot2_f32_bf16 v223, v39, v39, v223
    v_and_b32 v87, 0xffff0000, v39
    s_waitcnt lgkmcnt(4)
    v_dot2_f32_bf16 v220, v40, v224, v220
    v_lshlrev_b32 v88, 16, v40
    v_dot2_f32_bf16 v221, v40, v40, v221
    v_and_b32 v89, 0xffff0000, v40
    v_dot2_f32_bf16 v220, v41, v224, v220
    ds_read_b64 v[52:53], v12 offset:8192
    buffer_load_dwordx4 a[68:71], v8, s[28:31], s36 offen offset:1024
    v_lshlrev_b32 v90, 16, v41
    v_dot2_f32_bf16 v221, v41, v41, v221
    v_and_b32 v91, 0xffff0000, v41
    v_dot2_f32_bf16 v220, v42, v224, v220
    ds_read_b64 v[54:55], v12 offset:8320
    v_lshlrev_b32 v92, 16, v42
    v_dot2_f32_bf16 v221, v42, v42, v221
    v_and_b32 v93, 0xffff0000, v42
    v_dot2_f32_bf16 v220, v43, v224, v220
    v_lshlrev_b32 v94, 16, v43
    v_dot2_f32_bf16 v221, v43, v43, v221
    v_and_b32 v95, 0xffff0000, v43
    s_waitcnt lgkmcnt(4)
    v_dot2_f32_bf16 v222, v44, v224, v222
    v_lshlrev_b32 v96, 16, v44
    buffer_load_dwordx4 a[72:75], v8, s[28:31], s36 offen offset:2048
    v_dot2_f32_bf16 v223, v44, v44, v223
    v_and_b32 v97, 0xffff0000, v44
    v_dot2_f32_bf16 v222, v45, v224, v222
    ds_read_b64 v[56:57], v226 offset:12288
    v_lshlrev_b32 v98, 16, v45
    v_dot2_f32_bf16 v223, v45, v45, v223
    v_and_b32 v99, 0xffff0000, v45
    v_dot2_f32_bf16 v222, v46, v224, v222
    ds_read_b64 v[58:59], v226 offset:12416
    v_lshlrev_b32 v100, 16, v46
    v_dot2_f32_bf16 v223, v46, v46, v223
    v_and_b32 v101, 0xffff0000, v46
    v_dot2_f32_bf16 v222, v47, v224, v222
    buffer_load_dwordx4 a[76:79], v8, s[28:31], s36 offen offset:3072
    v_lshlrev_b32 v102, 16, v47
    v_dot2_f32_bf16 v223, v47, v47, v223
    v_and_b32 v103, 0xffff0000, v47
    s_waitcnt lgkmcnt(4)
    v_dot2_f32_bf16 v220, v48, v224, v220
    v_lshlrev_b32 v104, 16, v48
    v_dot2_f32_bf16 v221, v48, v48, v221
    v_and_b32 v105, 0xffff0000, v48
    v_dot2_f32_bf16 v220, v49, v224, v220
    ds_read_b64 v[60:61], v12 offset:12288
    v_lshlrev_b32 v106, 16, v49
    v_dot2_f32_bf16 v221, v49, v49, v221
    v_and_b32 v107, 0xffff0000, v49
    v_dot2_f32_bf16 v220, v50, v224, v220
    ds_read_b64 v[62:63], v12 offset:12416
    s_add_u32 s36, s36, 4096
    buffer_load_dwordx4 a[80:83], v8, s[28:31], s36 offen offset:0
    v_lshlrev_b32 v108, 16, v50
    v_dot2_f32_bf16 v221, v50, v50, v221
    v_and_b32 v109, 0xffff0000, v50
    v_dot2_f32_bf16 v220, v51, v224, v220
    v_lshlrev_b32 v110, 16, v51
    v_dot2_f32_bf16 v221, v51, v51, v221
    v_and_b32 v111, 0xffff0000, v51
    s_waitcnt lgkmcnt(4)
    v_dot2_f32_bf16 v222, v52, v224, v222
    v_lshlrev_b32 v112, 16, v52
    v_dot2_f32_bf16 v223, v52, v52, v223
    v_and_b32 v113, 0xffff0000, v52
    v_dot2_f32_bf16 v222, v53, v224, v222
    ds_read_b64 v[64:65], v226 offset:16384
    v_lshlrev_b32 v114, 16, v53
    buffer_load_dwordx4 a[84:87], v8, s[28:31], s36 offen offset:1024
    v_dot2_f32_bf16 v223, v53, v53, v223
    v_and_b32 v115, 0xffff0000, v53
    v_dot2_f32_bf16 v222, v54, v224, v222
    ds_read_b64 v[66:67], v226 offset:16512
    v_lshlrev_b32 v116, 16, v54
    v_dot2_f32_bf16 v223, v54, v54, v223
    v_and_b32 v117, 0xffff0000, v54
    v_dot2_f32_bf16 v222, v55, v224, v222
    v_lshlrev_b32 v118, 16, v55
    v_dot2_f32_bf16 v223, v55, v55, v223
    v_and_b32 v119, 0xffff0000, v55
    s_waitcnt lgkmcnt(4)
    v_dot2_f32_bf16 v220, v56, v224, v220
    v_lshlrev_b32 v120, 16, v56
    v_dot2_f32_bf16 v221, v56, v56, v221
    buffer_load_dwordx4 a[88:91], v8, s[28:31], s36 offen offset:2048
    v_and_b32 v121, 0xffff0000, v56
    v_dot2_f32_bf16 v220, v57, v224, v220
    ds_read_b64 v[68:69], v12 offset:16384
    v_lshlrev_b32 v122, 16, v57
    v_dot2_f32_bf16 v221, v57, v57, v221
    v_and_b32 v123, 0xffff0000, v57
    v_dot2_f32_bf16 v220, v58, v224, v220
    ds_read_b64 v[70:71], v12 offset:16512
    v_lshlrev_b32 v124, 16, v58
    v_dot2_f32_bf16 v221, v58, v58, v221
    v_and_b32 v125, 0xffff0000, v58
    v_dot2_f32_bf16 v220, v59, v224, v220
    v_lshlrev_b32 v126, 16, v59
    buffer_load_dwordx4 a[92:95], v8, s[28:31], s36 offen offset:3072
    v_dot2_f32_bf16 v221, v59, v59, v221
    v_and_b32 v127, 0xffff0000, v59
    s_waitcnt lgkmcnt(4)
    v_dot2_f32_bf16 v222, v60, v224, v222
    v_lshlrev_b32 v128, 16, v60
    v_dot2_f32_bf16 v223, v60, v60, v223
    v_and_b32 v129, 0xffff0000, v60
    v_dot2_f32_bf16 v222, v61, v224, v222
    v_lshlrev_b32 v130, 16, v61
    v_dot2_f32_bf16 v223, v61, v61, v223
    v_and_b32 v131, 0xffff0000, v61
    v_dot2_f32_bf16 v222, v62, v224, v222
    v_lshlrev_b32 v132, 16, v62
    v_dot2_f32_bf16 v223, v62, v62, v223
    v_and_b32 v133, 0xffff0000, v62
    v_dot2_f32_bf16 v222, v63, v224, v222
    v_lshlrev_b32 v134, 16, v63
    s_add_u32 s36, s36, 4096
    buffer_load_dwordx4 a[96:99], v8, s[28:31], s36 offen offset:0
    v_dot2_f32_bf16 v223, v63, v63, v223
    v_and_b32 v135, 0xffff0000, v63
    s_waitcnt lgkmcnt(2)
    v_dot2_f32_bf16 v220, v64, v224, v220
    v_lshlrev_b32 v136, 16, v64
    v_dot2_f32_bf16 v221, v64, v64, v221
    v_and_b32 v137, 0xffff0000, v64
    v_dot2_f32_bf16 v220, v65, v224, v220
    v_lshlrev_b32 v138, 16, v65
    v_dot2_f32_bf16 v221, v65, v65, v221
    v_and_b32 v139, 0xffff0000, v65
    v_dot2_f32_bf16 v220, v66, v224, v220
    v_lshlrev_b32 v140, 16, v66
    v_dot2_f32_bf16 v221, v66, v66, v221
    v_and_b32 v141, 0xffff0000, v66
    v_dot2_f32_bf16 v220, v67, v224, v220
    v_lshlrev_b32 v142, 16, v67
    buffer_load_dwordx4 a[100:103], v8, s[28:31], s36 offen offset:1024
    v_dot2_f32_bf16 v221, v67, v67, v221
    v_and_b32 v143, 0xffff0000, v67
    s_waitcnt lgkmcnt(0)
    v_dot2_f32_bf16 v222, v68, v224, v222
    v_lshlrev_b32 v144, 16, v68
    v_dot2_f32_bf16 v223, v68, v68, v223
    v_and_b32 v145, 0xffff0000, v68
    v_dot2_f32_bf16 v222, v69, v224, v222
    v_lshlrev_b32 v146, 16, v69
    v_dot2_f32_bf16 v223, v69, v69, v223
    v_and_b32 v147, 0xffff0000, v69
    v_dot2_f32_bf16 v222, v70, v224, v222
    v_lshlrev_b32 v148, 16, v70
    v_dot2_f32_bf16 v223, v70, v70, v223
    v_and_b32 v149, 0xffff0000, v70
    v_dot2_f32_bf16 v222, v71, v224, v222
    v_lshlrev_b32 v150, 16, v71
    buffer_load_dwordx4 a[104:107], v8, s[28:31], s36 offen offset:2048
    v_dot2_f32_bf16 v223, v71, v71, v223
    v_and_b32 v151, 0xffff0000, v71
    s_nop 2
    s_nop 1
    v_add_f32_dpp v220, v220, v220 quad_perm:[1,0,3,2] row_mask:0xf bank_mask:0xf
    v_add_f32_dpp v221, v221, v221 quad_perm:[1,0,3,2] row_mask:0xf bank_mask:0xf
    v_add_f32_dpp v222, v222, v222 quad_perm:[1,0,3,2] row_mask:0xf bank_mask:0xf
    v_add_f32_dpp v223, v223, v223 quad_perm:[1,0,3,2] row_mask:0xf bank_mask:0xf
    v_add_f32_dpp v220, v220, v220 quad_perm:[2,3,0,1] row_mask:0xf bank_mask:0xf
    v_add_f32_dpp v221, v221, v221 quad_perm:[2,3,0,1] row_mask:0xf bank_mask:0xf
    v_add_f32_dpp v222, v222, v222 quad_perm:[2,3,0,1] row_mask:0xf bank_mask:0xf
    v_add_f32_dpp v223, v223, v223 quad_perm:[2,3,0,1] row_mask:0xf bank_mask:0xf
    v_add_f32_dpp v220, v220, v220 row_half_mirror row_mask:0xf bank_mask:0xf
    v_add_f32_dpp v221, v221, v221 row_half_mirror row_mask:0xf bank_mask:0xf
    v_add_f32_dpp v222, v222, v222 row_half_mirror row_mask:0xf bank_mask:0xf
    v_add_f32_dpp v223, v223, v223 row_half_mirror row_mask:0xf bank_mask:0xf
    v_add_f32_dpp v220, v220, v220 row_mirror row_mask:0xf bank_mask:0xf
    buffer_load_dwordx4 a[108:111], v8, s[28:31], s36 offen offset:3072
    v_add_f32_dpp v221, v221, v221 row_mirror row_mask:0xf bank_mask:0xf
    v_add_f32_dpp v222, v222, v222 row_mirror row_mask:0xf bank_mask:0xf
    v_add_f32_dpp v223, v223, v223 row_mirror row_mask:0xf bank_mask:0xf
    v_mul_f32 v220, 0x3acccccd, v220
    v_mul_f32 v222, 0x3acccccd, v222
    v_mul_f32 v221, 0x3acccccd, v221
    v_mul_f32 v223, 0x3acccccd, v223
    v_fma_f32 v221, -v220, v220, v221
    v_fma_f32 v223, -v222, v222, v223
    v_max_f32 v221, 0, v221
    v_max_f32 v223, 0, v223
    v_cvt_pk_bf16_f32 v192, v220, v221
    v_cvt_pk_bf16_f32 v193, v222, v223
    v_lshlrev_b32 v220, 16, v192
    v_lshlrev_b32 v222, 16, v193
    v_and_b32 v221, 0xffff0000, v192
    v_and_b32 v223, 0xffff0000, v193
    s_add_u32 s36, s36, 4096
    buffer_load_dwordx4 a[112:115], v8, s[28:31], s36 offen offset:0
    v_add_f32 v221, 0x3727c5ac, v221
    v_add_f32 v223, 0x3727c5ac, v223
    v_cvt_pk_bf16_f32 v192, v221, v221
    v_cvt_pk_bf16_f32 v193, v223, v223
    v_lshlrev_b32 v221, 16, v192
    v_lshlrev_b32 v223, 16, v193
    v_sqrt_f32 v221, v221
    v_sqrt_f32 v223, v223
    s_nop 0
    s_nop 0
    v_cvt_pk_bf16_f32 v192, v221, v221
    v_cvt_pk_bf16_f32 v193, v223, v223
    v_lshlrev_b32 v221, 16, v192
    v_lshlrev_b32 v223, 16, v193
    v_rcp_f32 v221, v221
    buffer_load_dwordx4 a[116:119], v8, s[28:31], s36 offen offset:1024
    v_rcp_f32 v223, v223
    s_nop 0
    s_nop 0
    v_mul_f32 v220, v220, v221
    v_mul_f32 v222, v222, v223
    v_sub_f32 v220, 0, v220
    v_sub_f32 v222, 0, v222
    v_mov_b32 v216, 0
    v_mov_b32 v217, 0
    v_mov_b32 v218, 0
    v_mov_b32 v219, 0
    v_xor_b32 v12, 64, v228
    ds_read_b128 v[152:155], v227 offset:10240
    ds_read_b128 v[156:159], v227 offset:10256
    buffer_load_dwordx4 a[120:123], v8, s[28:31], s36 offen offset:2048
    ds_read_b128 v[160:163], v227 offset:7680
    ds_read_b128 v[164:167], v227 offset:7696
    s_waitcnt lgkmcnt(0)
    v_pk_fma_f32 v[72:73], v[72:73], v[220:221], v[220:221] op_sel:[0,1,0] op_sel_hi:[1,1,0]
    v_pk_fma_f32 v[74:75], v[74:75], v[220:221], v[220:221] op_sel:[0,1,0] op_sel_hi:[1,1,0]
    v_pk_fma_f32 v[76:77], v[76:77], v[220:221], v[220:221] op_sel:[0,1,0] op_sel_hi:[1,1,0]
    ds_read_b128 v[168:171], v227 offset:10752
    v_pk_fma_f32 v[78:79], v[78:79], v[220:221], v[220:221] op_sel:[0,1,0] op_sel_hi:[1,1,0]
    v_pk_fma_f32 v[72:73], v[72:73], v[152:153], v[160:161]
    v_pk_fma_f32 v[74:75], v[74:75], v[154:155], v[162:163]
    ds_read_b128 v[172:175], v227 offset:10768
    buffer_load_dwordx4 a[124:127], v8, s[28:31], s36 offen offset:3072
    v_pk_fma_f32 v[76:77], v[76:77], v[156:157], v[164:165]
    v_pk_fma_f32 v[78:79], v[78:79], v[158:159], v[166:167]
    v_cvt_pk_bf16_f32 v32, v72, v73
    ds_read_b128 v[176:179], v227 offset:8192
    v_cvt_pk_bf16_f32 v33, v74, v75
    v_cvt_pk_bf16_f32 v34, v76, v77
    v_cvt_pk_bf16_f32 v35, v78, v79
    ds_read_b128 v[180:183], v227 offset:8208
    v_dot2_f32_bf16 v216, v32, v224, v216
    v_dot2_f32_bf16 v217, v32, v32, v217
    v_dot2_f32_bf16 v216, v33, v224, v216
    v_dot2_f32_bf16 v217, v33, v33, v217
    v_dot2_f32_bf16 v216, v34, v224, v216
    s_add_u32 s36, s36, 4096
    buffer_load_dwordx4 a[128:131], v8, s[28:31], s36 offen offset:0
    v_dot2_f32_bf16 v217, v34, v34, v217
    v_dot2_f32_bf16 v216, v35, v224, v216
    v_dot2_f32_bf16 v217, v35, v35, v217
    ds_write_b128 v228, v[32:35] offset:0
    v_pk_fma_f32 v[80:81], v[80:81], v[222:223], v[222:223] op_sel:[0,1,0] op_sel_hi:[1,1,0]
    v_pk_fma_f32 v[82:83], v[82:83], v[222:223], v[222:223] op_sel:[0,1,0] op_sel_hi:[1,1,0]
    v_pk_fma_f32 v[84:85], v[84:85], v[222:223], v[222:223] op_sel:[0,1,0] op_sel_hi:[1,1,0]
    v_pk_fma_f32 v[86:87], v[86:87], v[222:223], v[222:223] op_sel:[0,1,0] op_sel_hi:[1,1,0]
    v_pk_fma_f32 v[80:81], v[80:81], v[152:153], v[160:161]
    v_pk_fma_f32 v[82:83], v[82:83], v[154:155], v[162:163]
    buffer_load_dwordx4 a[132:135], v8, s[28:31], s36 offen offset:1024
    v_pk_fma_f32 v[84:85], v[84:85], v[156:157], v[164:165]
    v_pk_fma_f32 v[86:87], v[86:87], v[158:159], v[166:167]
    v_cvt_pk_bf16_f32 v36, v80, v81
    v_cvt_pk_bf16_f32 v37, v82, v83
    v_cvt_pk_bf16_f32 v38, v84, v85
    v_cvt_pk_bf16_f32 v39, v86, v87
    v_dot2_f32_bf16 v218, v36, v224, v218
    v_dot2_f32_bf16 v219, v36, v36, v219
    v_dot2_f32_bf16 v218, v37, v224, v218
    v_dot2_f32_bf16 v219, v37, v37, v219
    v_dot2_f32_bf16 v218, v38, v224, v218
    v_dot2_f32_bf16 v219, v38, v38, v219
    v_dot2_f32_bf16 v218, v39, v224, v218
    v_dot2_f32_bf16 v219, v39, v39, v219
    ds_write_b128 v12, v[36:39] offset:0
    buffer_load_dwordx4 a[136:139], v8, s[28:31], s36 offen offset:2048
    s_waitcnt lgkmcnt(1)
    v_pk_fma_f32 v[88:89], v[88:89], v[220:221], v[220:221] op_sel:[0,1,0] op_sel_hi:[1,1,0]
    v_pk_fma_f32 v[90:91], v[90:91], v[220:221], v[220:221] op_sel:[0,1,0] op_sel_hi:[1,1,0]
    v_pk_fma_f32 v[92:93], v[92:93], v[220:221], v[220:221] op_sel:[0,1,0] op_sel_hi:[1,1,0]
    ds_read_b128 v[152:155], v227 offset:11264
    v_pk_fma_f32 v[94:95], v[94:95], v[220:221], v[220:221] op_sel:[0,1,0] op_sel_hi:[1,1,0]
    v_pk_fma_f32 v[88:89], v[88:89], v[168:169], v[176:177]
    v_pk_fma_f32 v[90:91], v[90:91], v[170:171], v[178:179]
    ds_read_b128 v[156:159], v227 offset:11280
    v_pk_fma_f32 v[92:93], v[92:93], v[172:173], v[180:181]
    v_pk_fma_f32 v[94:95], v[94:95], v[174:175], v[182:183]
    v_cvt_pk_bf16_f32 v40, v88, v89
    ds_read_b128 v[160:163], v227 offset:8704
    buffer_load_dwordx4 a[140:143], v8, s[28:31], s36 offen offset:3072
    v_cvt_pk_bf16_f32 v41, v90, v91
    v_cvt_pk_bf16_f32 v42, v92, v93
    v_cvt_pk_bf16_f32 v43, v94, v95
    ds_read_b128 v[164:167], v227 offset:8720
    v_dot2_f32_bf16 v216, v40, v224, v216
    v_dot2_f32_bf16 v217, v40, v40, v217
    v_dot2_f32_bf16 v216, v41, v224, v216
    v_dot2_f32_bf16 v217, v41, v41, v217
    v_dot2_f32_bf16 v216, v42, v224, v216
    v_dot2_f32_bf16 v217, v42, v42, v217
    v_dot2_f32_bf16 v216, v43, v224, v216
    v_dot2_f32_bf16 v217, v43, v43, v217
    ds_write_b128 v228, v[40:43] offset:4096
    s_add_u32 s36, s36, 4096
    buffer_load_dwordx4 a[144:147], v8, s[28:31], s36 offen offset:0
    v_pk_fma_f32 v[96:97], v[96:97], v[222:223], v[222:223] op_sel:[0,1,0] op_sel_hi:[1,1,0]
    v_pk_fma_f32 v[98:99], v[98:99], v[222:223], v[222:223] op_sel:[0,1,0] op_sel_hi:[1,1,0]
    v_pk_fma_f32 v[100:101], v[100:101], v[222:223], v[222:223] op_sel:[0,1,0] op_sel_hi:[1,1,0]
    v_pk_fma_f32 v[102:103], v[102:103], v[222:223], v[222:223] op_sel:[0,1,0] op_sel_hi:[1,1,0]
    v_pk_fma_f32 v[96:97], v[96:97], v[168:169], v[176:177]
    v_pk_fma_f32 v[98:99], v[98:99], v[170:171], v[178:179]
    v_pk_fma_f32 v[100:101], v[100:101], v[172:173], v[180:181]
    v_pk_fma_f32 v[102:103], v[102:103], v[174:175], v[182:183]
    v_cvt_pk_bf16_f32 v44, v96, v97
    v_cvt_pk_bf16_f32 v45, v98, v99
    v_cvt_pk_bf16_f32 v46, v100, v101
    v_cvt_pk_bf16_f32 v47, v102, v103
    v_dot2_f32_bf16 v218, v44, v224, v218
    v_dot2_f32_bf16 v219, v44, v44, v219
    v_dot2_f32_bf16 v218, v45, v224, v218
    v_dot2_f32_bf16 v219, v45, v45, v219
    v_dot2_f32_bf16 v218, v46, v224, v218
    buffer_load_dwordx4 a[148:151], v8, s[28:31], s36 offen offset:1024
    v_dot2_f32_bf16 v219, v46, v46, v219
    v_dot2_f32_bf16 v218, v47, v224, v218
    v_dot2_f32_bf16 v219, v47, v47, v219
    ds_write_b128 v12, v[44:47] offset:4096
    s_waitcnt lgkmcnt(1)
    v_pk_fma_f32 v[104:105], v[104:105], v[220:221], v[220:221] op_sel:[0,1,0] op_sel_hi:[1,1,0]
    v_pk_fma_f32 v[106:107], v[106:107], v[220:221], v[220:221] op_sel:[0,1,0] op_sel_hi:[1,1,0]
    v_pk_fma_f32 v[108:109], v[108:109], v[220:221], v[220:221] op_sel:[0,1,0] op_sel_hi:[1,1,0]
    ds_read_b128 v[168:171], v227 offset:11776
    buffer_load_dwordx4 a[152:155], v8, s[28:31], s36 offen offset:2048
    v_pk_fma_f32 v[110:111], v[110:111], v[220:221], v[220:221] op_sel:[0,1,0] op_sel_hi:[1,1,0]
    v_pk_fma_f32 v[104:105], v[104:105], v[152:153], v[160:161]
    v_pk_fma_f32 v[106:107], v[106:107], v[154:155], v[162:163]
    ds_read_b128 v[172:175], v227 offset:11792
    v_pk_fma_f32 v[108:109], v[108:109], v[156:157], v[164:165]
    v_pk_fma_f32 v[110:111], v[110:111], v[158:159], v[166:167]
    v_cvt_pk_bf16_f32 v48, v104, v105
    ds_read_b128 v[176:179], v227 offset:9216
    v_cvt_pk_bf16_f32 v49, v106, v107
    v_cvt_pk_bf16_f32 v50, v108, v109
    v_cvt_pk_bf16_f32 v51, v110, v111
    ds_read_b128 v[180:183], v227 offset:9232
    buffer_load_dwordx4 a[156:159], v8, s[28:31], s36 offen offset:3072
    v_dot2_f32_bf16 v216, v48, v224, v216
    v_dot2_f32_bf16 v217, v48, v48, v217
    v_dot2_f32_bf16 v216, v49, v224, v216
    v_dot2_f32_bf16 v217, v49, v49, v217
    v_dot2_f32_bf16 v216, v50, v224, v216
    v_dot2_f32_bf16 v217, v50, v50, v217
    v_dot2_f32_bf16 v216, v51, v224, v216
    v_dot2_f32_bf16 v217, v51, v51, v217
    ds_write_b128 v228, v[48:51] offset:8192
    v_pk_fma_f32 v[112:113], v[112:113], v[222:223], v[222:223] op_sel:[0,1,0] op_sel_hi:[1,1,0]
    s_add_u32 s36, s36, 4096
    buffer_load_dwordx4 a[160:163], v8, s[28:31], s36 offen offset:0
    v_pk_fma_f32 v[114:115], v[114:115], v[222:223], v[222:223] op_sel:[0,1,0] op_sel_hi:[1,1,0]
    v_pk_fma_f32 v[116:117], v[116:117], v[222:223], v[222:223] op_sel:[0,1,0] op_sel_hi:[1,1,0]
    v_pk_fma_f32 v[118:119], v[118:119], v[222:223], v[222:223] op_sel:[0,1,0] op_sel_hi:[1,1,0]
    v_pk_fma_f32 v[112:113], v[112:113], v[152:153], v[160:161]
    v_pk_fma_f32 v[114:115], v[114:115], v[154:155], v[162:163]
    v_pk_fma_f32 v[116:117], v[116:117], v[156:157], v[164:165]
    v_pk_fma_f32 v[118:119], v[118:119], v[158:159], v[166:167]
    v_cvt_pk_bf16_f32 v52, v112, v113
    v_cvt_pk_bf16_f32 v53, v114, v115
    v_cvt_pk_bf16_f32 v54, v116, v117
    v_cvt_pk_bf16_f32 v55, v118, v119
    v_dot2_f32_bf16 v218, v52, v224, v218
    v_dot2_f32_bf16 v219, v52, v52, v219
    v_dot2_f32_bf16 v218, v53, v224, v218
    v_dot2_f32_bf16 v219, v53, v53, v219
    v_dot2_f32_bf16 v218, v54, v224, v218
    v_dot2_f32_bf16 v219, v54, v54, v219
    buffer_load_dwordx4 a[164:167], v8, s[28:31], s36 offen offset:1024
    v_dot2_f32_bf16 v218, v55, v224, v218
    v_dot2_f32_bf16 v219, v55, v55, v219
    ds_write_b128 v12, v[52:55] offset:8192
    s_waitcnt lgkmcnt(1)
    v_pk_fma_f32 v[120:121], v[120:121], v[220:221], v[220:221] op_sel:[0,1,0] op_sel_hi:[1,1,0]
    v_pk_fma_f32 v[122:123], v[122:123], v[220:221], v[220:221] op_sel:[0,1,0] op_sel_hi:[1,1,0]
    v_pk_fma_f32 v[124:125], v[124:125], v[220:221], v[220:221] op_sel:[0,1,0] op_sel_hi:[1,1,0]
    ds_read_b128 v[152:155], v227 offset:12288
    buffer_load_dwordx4 a[168:171], v8, s[28:31], s36 offen offset:2048
    v_pk_fma_f32 v[126:127], v[126:127], v[220:221], v[220:221] op_sel:[0,1,0] op_sel_hi:[1,1,0]
    v_pk_fma_f32 v[120:121], v[120:121], v[168:169], v[176:177]
    v_pk_fma_f32 v[122:123], v[122:123], v[170:171], v[178:179]
    ds_read_b128 v[156:159], v227 offset:12304
    v_pk_fma_f32 v[124:125], v[124:125], v[172:173], v[180:181]
    v_pk_fma_f32 v[126:127], v[126:127], v[174:175], v[182:183]
    v_cvt_pk_bf16_f32 v56, v120, v121
    ds_read_b128 v[160:163], v227 offset:9728
    v_cvt_pk_bf16_f32 v57, v122, v123
    v_cvt_pk_bf16_f32 v58, v124, v125
    v_cvt_pk_bf16_f32 v59, v126, v127
    ds_read_b128 v[164:167], v227 offset:9744
    buffer_load_dwordx4 a[172:175], v8, s[28:31], s36 offen offset:3072
    v_dot2_f32_bf16 v216, v56, v224, v216
    v_dot2_f32_bf16 v217, v56, v56, v217
    v_dot2_f32_bf16 v216, v57, v224, v216
    v_dot2_f32_bf16 v217, v57, v57, v217
    v_dot2_f32_bf16 v216, v58, v224, v216
    v_dot2_f32_bf16 v217, v58, v58, v217
    v_dot2_f32_bf16 v216, v59, v224, v216
    v_dot2_f32_bf16 v217, v59, v59, v217
    ds_write_b128 v228, v[56:59] offset:12288
    v_pk_fma_f32 v[128:129], v[128:129], v[222:223], v[222:223] op_sel:[0,1,0] op_sel_hi:[1,1,0]
    s_add_u32 s36, s36, 4096
    buffer_load_dwordx4 a[176:179], v8, s[28:31], s36 offen offset:0
    v_pk_fma_f32 v[130:131], v[130:131], v[222:223], v[222:223] op_sel:[0,1,0] op_sel_hi:[1,1,0]
    v_pk_fma_f32 v[132:133], v[132:133], v[222:223], v[222:223] op_sel:[0,1,0] op_sel_hi:[1,1,0]
    v_pk_fma_f32 v[134:135], v[134:135], v[222:223], v[222:223] op_sel:[0,1,0] op_sel_hi:[1,1,0]
    v_pk_fma_f32 v[128:129], v[128:129], v[168:169], v[176:177]
    v_pk_fma_f32 v[130:131], v[130:131], v[170:171], v[178:179]
    v_pk_fma_f32 v[132:133], v[132:133], v[172:173], v[180:181]
    v_pk_fma_f32 v[134:135], v[134:135], v[174:175], v[182:183]
    v_cvt_pk_bf16_f32 v60, v128, v129
    v_cvt_pk_bf16_f32 v61, v130, v131
    v_cvt_pk_bf16_f32 v62, v132, v133
    v_cvt_pk_bf16_f32 v63, v134, v135
    v_dot2_f32_bf16 v218, v60, v224, v218
    v_dot2_f32_bf16 v219, v60, v60, v219
    v_dot2_f32_bf16 v218, v61, v224, v218
    v_dot2_f32_bf16 v219, v61, v61, v219
    v_dot2_f32_bf16 v218, v62, v224, v218
    v_dot2_f32_bf16 v219, v62, v62, v219
    buffer_load_dwordx4 a[180:183], v8, s[28:31], s36 offen offset:1024
    v_dot2_f32_bf16 v218, v63, v224, v218
    v_dot2_f32_bf16 v219, v63, v63, v219
    ds_write_b128 v12, v[60:63] offset:12288
    s_waitcnt lgkmcnt(1)
    v_pk_fma_f32 v[136:137], v[136:137], v[220:221], v[220:221] op_sel:[0,1,0] op_sel_hi:[1,1,0]
    v_pk_fma_f32 v[138:139], v[138:139], v[220:221], v[220:221] op_sel:[0,1,0] op_sel_hi:[1,1,0]
    v_pk_fma_f32 v[140:141], v[140:141], v[220:221], v[220:221] op_sel:[0,1,0] op_sel_hi:[1,1,0]
    v_pk_fma_f32 v[142:143], v[142:143], v[220:221], v[220:221] op_sel:[0,1,0] op_sel_hi:[1,1,0]
    v_pk_fma_f32 v[136:137], v[136:137], v[152:153], v[160:161]
    v_pk_fma_f32 v[138:139], v[138:139], v[154:155], v[162:163]
    buffer_load_dwordx4 a[184:187], v8, s[28:31], s36 offen offset:2048
    v_pk_fma_f32 v[140:141], v[140:141], v[156:157], v[164:165]
    v_pk_fma_f32 v[142:143], v[142:143], v[158:159], v[166:167]
    v_cvt_pk_bf16_f32 v64, v136, v137
    v_cvt_pk_bf16_f32 v65, v138, v139
    v_cvt_pk_bf16_f32 v66, v140, v141
    v_cvt_pk_bf16_f32 v67, v142, v143
    v_dot2_f32_bf16 v216, v64, v224, v216
    v_dot2_f32_bf16 v217, v64, v64, v217
    v_dot2_f32_bf16 v216, v65, v224, v216
    v_dot2_f32_bf16 v217, v65, v65, v217
    v_dot2_f32_bf16 v216, v66, v224, v216
    v_dot2_f32_bf16 v217, v66, v66, v217
    v_dot2_f32_bf16 v216, v67, v224, v216
    v_dot2_f32_bf16 v217, v67, v67, v217
    ds_write_b128 v228, v[64:67] offset:16384
    buffer_load_dwordx4 a[188:191], v8, s[28:31], s36 offen offset:3072
    v_pk_fma_f32 v[144:145], v[144:145], v[222:223], v[222:223] op_sel:[0,1,0] op_sel_hi:[1,1,0]
    v_pk_fma_f32 v[146:147], v[146:147], v[222:223], v[222:223] op_sel:[0,1,0] op_sel_hi:[1,1,0]
    v_pk_fma_f32 v[148:149], v[148:149], v[222:223], v[222:223] op_sel:[0,1,0] op_sel_hi:[1,1,0]
    v_pk_fma_f32 v[150:151], v[150:151], v[222:223], v[222:223] op_sel:[0,1,0] op_sel_hi:[1,1,0]
    v_pk_fma_f32 v[144:145], v[144:145], v[152:153], v[160:161]
    v_pk_fma_f32 v[146:147], v[146:147], v[154:155], v[162:163]
    v_pk_fma_f32 v[148:149], v[148:149], v[156:157], v[164:165]
    v_pk_fma_f32 v[150:151], v[150:151], v[158:159], v[166:167]
    v_cvt_pk_bf16_f32 v68, v144, v145
    v_cvt_pk_bf16_f32 v69, v146, v147
    v_cvt_pk_bf16_f32 v70, v148, v149
    v_cvt_pk_bf16_f32 v71, v150, v151
    v_dot2_f32_bf16 v218, v68, v224, v218
    v_dot2_f32_bf16 v219, v68, v68, v219
    v_dot2_f32_bf16 v218, v69, v224, v218
    v_dot2_f32_bf16 v219, v69, v69, v219
    v_dot2_f32_bf16 v218, v70, v224, v218
    s_add_u32 s36, s36, 4096
    buffer_load_dwordx4 a[192:195], v8, s[28:31], s36 offen offset:0
    v_dot2_f32_bf16 v219, v70, v70, v219
    v_dot2_f32_bf16 v218, v71, v224, v218
    v_dot2_f32_bf16 v219, v71, v71, v219
    ds_write_b128 v12, v[68:71] offset:16384
    buffer_load_dwordx4 a[196:199], v8, s[28:31], s36 offen offset:1024
    s_waitcnt lgkmcnt(0)
    s_barrier
    buffer_load_dwordx4 a[200:203], v8, s[28:31], s37 offen offset:0
    ds_read_b128 v[72:75], v229 offset:0
    ds_read_b128 v[76:79], v231 offset:0
    s_waitcnt vmcnt(46) lgkmcnt(0)
    v_mfma_f32_16x16x32_bf16 v[32:35], a[0:3], v[72:75], 0
    v_mfma_f32_16x16x32_bf16 v[52:55], a[0:3], v[76:79], 0
    ds_read_b128 v[80:83], v230 offset:1024
    buffer_load_dwordx4 a[204:207], v8, s[28:31], s37 offen offset:1024
    v_mfma_f32_16x16x32_bf16 v[36:39], a[4:7], v[72:75], 0
    v_mfma_f32_16x16x32_bf16 v[56:59], a[4:7], v[76:79], 0
    ds_read_b128 v[84:87], v232 offset:1024
    v_mfma_f32_16x16x32_bf16 v[40:43], a[8:11], v[72:75], 0
    v_mfma_f32_16x16x32_bf16 v[60:63], a[8:11], v[76:79], 0
    buffer_load_dwordx4 a[208:211], v8, s[28:31], s37 offen offset:2048
    ds_read_b128 v[112:115], v233 offset:0
    v_mfma_f32_16x16x32_bf16 v[44:47], a[12:15], v[72:75], 0
    v_mfma_f32_16x16x32_bf16 v[64:67], a[12:15], v[76:79], 0
    ds_read_b128 v[132:135], v233 offset:1024
    v_mfma_f32_16x16x32_bf16 v[48:51], a[16:19], v[72:75], 0
    buffer_load_dwordx4 a[212:215], v8, s[28:31], s37 offen offset:3072
    v_mfma_f32_16x16x32_bf16 v[68:71], a[16:19], v[76:79], 0
    s_waitcnt vmcnt(44) lgkmcnt(0)
    v_mfma_f32_16x16x32_bf16 v[32:35], a[20:23], v[80:83], v[32:35]
    v_add_f32_dpp v216, v216, v216 quad_perm:[1,0,3,2] row_mask:0xf bank_mask:0xf
    v_mfma_f32_16x16x32_bf16 v[52:55], a[20:23], v[84:87], v[52:55]
    ds_read_b128 v[72:75], v229 offset:2048
    v_mfma_f32_16x16x32_bf16 v[36:39], a[24:27], v[80:83], v[36:39]
    s_add_u32 s37, s37, 4096
    buffer_load_dwordx4 a[216:219], v8, s[28:31], s37 offen offset:0
    v_add_f32_dpp v217, v217, v217 quad_perm:[1,0,3,2] row_mask:0xf bank_mask:0xf
    v_mfma_f32_16x16x32_bf16 v[56:59], a[24:27], v[84:87], v[56:59]
    ds_read_b128 v[76:79], v231 offset:2048
    v_mfma_f32_16x16x32_bf16 v[40:43], a[28:31], v[80:83], v[40:43]
    v_add_f32_dpp v218, v218, v218 quad_perm:[1,0,3,2] row_mask:0xf bank_mask:0xf
    v_mfma_f32_16x16x32_bf16 v[60:63], a[28:31], v[84:87], v[60:63]
    ds_read_b128 v[116:119], v233 offset:64
    buffer_load_dwordx4 a[220:223], v8, s[28:31], s37 offen offset:1024
    v_mfma_f32_16x16x32_bf16 v[44:47], a[32:35], v[80:83], v[44:47]
    v_add_f32_dpp v219, v219, v219 quad_perm:[1,0,3,2] row_mask:0xf bank_mask:0xf
    v_mfma_f32_16x16x32_bf16 v[64:67], a[32:35], v[84:87], v[64:67]
    ds_read_b128 v[136:139], v233 offset:1088
    v_mfma_f32_16x16x32_bf16 v[48:51], a[36:39], v[80:83], v[48:51]
    v_add_f32_dpp v216, v216, v216 quad_perm:[2,3,0,1] row_mask:0xf bank_mask:0xf
    v_mfma_f32_16x16x32_bf16 v[68:71], a[36:39], v[84:87], v[68:71]
    buffer_load_dwordx4 a[224:227], v8, s[28:31], s37 offen offset:2048
    v_add_f32_dpp v217, v217, v217 quad_perm:[2,3,0,1] row_mask:0xf bank_mask:0xf
    s_waitcnt vmcnt(42) lgkmcnt(0)
    v_mfma_f32_16x16x32_bf16 v[32:35], a[40:43], v[72:75], v[32:35]
    v_add_f32_dpp v218, v218, v218 quad_perm:[2,3,0,1] row_mask:0xf bank_mask:0xf
    v_mfma_f32_16x16x32_bf16 v[52:55], a[40:43], v[76:79], v[52:55]
    ds_read_b128 v[80:83], v230 offset:3072
    v_mfma_f32_16x16x32_bf16 v[36:39], a[44:47], v[72:75], v[36:39]
    buffer_load_dwordx4 a[228:231], v8, s[28:31], s37 offen offset:3072
    v_add_f32_dpp v219, v219, v219 quad_perm:[2,3,0,1] row_mask:0xf bank_mask:0xf
    v_mfma_f32_16x16x32_bf16 v[56:59], a[44:47], v[76:79], v[56:59]
    ds_read_b128 v[84:87], v232 offset:3072
    v_mfma_f32_16x16x32_bf16 v[40:43], a[48:51], v[72:75], v[40:43]
    v_add_f32_dpp v216, v216, v216 row_half_mirror row_mask:0xf bank_mask:0xf
    v_mfma_f32_16x16x32_bf16 v[60:63], a[48:51], v[76:79], v[60:63]
    ds_read_b128 v[120:123], v233 offset:128
    s_add_u32 s37, s37, 4096
    buffer_load_dwordx4 a[232:235], v8, s[28:31], s37 offen offset:0
    v_mfma_f32_16x16x32_bf16 v[44:47], a[52:55], v[72:75], v[44:47]
    v_add_f32_dpp v217, v217, v217 row_half_mirror row_mask:0xf bank_mask:0xf
    v_mfma_f32_16x16x32_bf16 v[64:67], a[52:55], v[76:79], v[64:67]
    ds_read_b128 v[140:143], v233 offset:1152
    v_mfma_f32_16x16x32_bf16 v[48:51], a[56:59], v[72:75], v[48:51]
    v_add_f32_dpp v218, v218, v218 row_half_mirror row_mask:0xf bank_mask:0xf
    v_mfma_f32_16x16x32_bf16 v[68:71], a[56:59], v[76:79], v[68:71]
    buffer_load_dwordx4 a[236:239], v8, s[28:31], s37 offen offset:1024
    v_add_f32_dpp v219, v219, v219 row_half_mirror row_mask:0xf bank_mask:0xf
    s_waitcnt vmcnt(40) lgkmcnt(0)
    v_mfma_f32_16x16x32_bf16 v[32:35], a[60:63], v[80:83], v[32:35]
    v_add_f32_dpp v216, v216, v216 row_mirror row_mask:0xf bank_mask:0xf
    v_mfma_f32_16x16x32_bf16 v[52:55], a[60:63], v[84:87], v[52:55]
    ds_read_b128 v[72:75], v229 offset:4096
    v_mfma_f32_16x16x32_bf16 v[36:39], a[64:67], v[80:83], v[36:39]
    buffer_load_dwordx4 a[240:243], v8, s[28:31], s37 offen offset:2048
    v_add_f32_dpp v217, v217, v217 row_mirror row_mask:0xf bank_mask:0xf
    v_mfma_f32_16x16x32_bf16 v[56:59], a[64:67], v[84:87], v[56:59]
    ds_read_b128 v[76:79], v231 offset:4096
    v_mfma_f32_16x16x32_bf16 v[40:43], a[68:71], v[80:83], v[40:43]
    v_add_f32_dpp v218, v218, v218 row_mirror row_mask:0xf bank_mask:0xf
    v_mfma_f32_16x16x32_bf16 v[60:63], a[68:71], v[84:87], v[60:63]
    ds_read_b128 v[124:127], v233 offset:192
    buffer_load_dwordx4 a[244:247], v8, s[28:31], s37 offen offset:3072
    v_mfma_f32_16x16x32_bf16 v[44:47], a[72:75], v[80:83], v[44:47]
    v_add_f32_dpp v219, v219, v219 row_mirror row_mask:0xf bank_mask:0xf
    v_mfma_f32_16x16x32_bf16 v[64:67], a[72:75], v[84:87], v[64:67]
    ds_read_b128 v[144:147], v233 offset:1216
    v_mfma_f32_16x16x32_bf16 v[48:51], a[76:79], v[80:83], v[48:51]
    v_mul_f32 v216, 0x3acccccd, v216
    v_mfma_f32_16x16x32_bf16 v[68:71], a[76:79], v[84:87], v[68:71]
    s_add_u32 s37, s37, 4096
    buffer_load_dwordx4 a[248:251], v8, s[28:31], s37 offen offset:0
    v_mul_f32 v218, 0x3acccccd, v218
    s_waitcnt vmcnt(38) lgkmcnt(0)
    v_mfma_f32_16x16x32_bf16 v[32:35], a[80:83], v[72:75], v[32:35]
    v_mul_f32 v217, 0x3acccccd, v217
    v_mfma_f32_16x16x32_bf16 v[52:55], a[80:83], v[76:79], v[52:55]
    ds_read_b128 v[80:83], v230 offset:5120
    v_mfma_f32_16x16x32_bf16 v[36:39], a[84:87], v[72:75], v[36:39]
    buffer_load_dwordx4 a[252:255], v8, s[28:31], s37 offen offset:1024
    v_mul_f32 v219, 0x3acccccd, v219
    v_mfma_f32_16x16x32_bf16 v[56:59], a[84:87], v[76:79], v[56:59]
    ds_read_b128 v[84:87], v232 offset:5120
    v_mfma_f32_16x16x32_bf16 v[40:43], a[88:91], v[72:75], v[40:43]
    v_fma_f32 v217, -v216, v216, v217
    v_mfma_f32_16x16x32_bf16 v[60:63], a[88:91], v[76:79], v[60:63]
    ds_read_b128 v[128:131], v234
    buffer_load_dwordx4 a[0:3], v8, s[28:31], s37 offen offset:2048
    v_mfma_f32_16x16x32_bf16 v[44:47], a[92:95], v[72:75], v[44:47]
    v_fma_f32 v219, -v218, v218, v219
    v_mfma_f32_16x16x32_bf16 v[64:67], a[92:95], v[76:79], v[64:67]
    ds_read_b128 v[148:151], v234 offset:1024
    v_mfma_f32_16x16x32_bf16 v[48:51], a[96:99], v[72:75], v[48:51]
    v_max_f32 v217, 0, v217
    v_mfma_f32_16x16x32_bf16 v[68:71], a[96:99], v[76:79], v[68:71]
    buffer_load_dwordx4 a[4:7], v8, s[28:31], s37 offen offset:3072
    v_max_f32 v219, 0, v219
    s_waitcnt vmcnt(36) lgkmcnt(0)
    v_mfma_f32_16x16x32_bf16 v[32:35], a[100:103], v[80:83], v[32:35]
    v_cvt_pk_bf16_f32 v192, v216, v217
    v_mfma_f32_16x16x32_bf16 v[52:55], a[100:103], v[84:87], v[52:55]
    ds_read_b128 v[72:75], v229 offset:6144
    v_mfma_f32_16x16x32_bf16 v[36:39], a[104:107], v[80:83], v[36:39]
    s_add_u32 s37, s37, 4096
    buffer_load_dwordx4 a[8:11], v8, s[28:31], s37 offen offset:0
    v_cvt_pk_bf16_f32 v193, v218, v219
    v_mfma_f32_16x16x32_bf16 v[56:59], a[104:107], v[84:87], v[56:59]
    ds_read_b128 v[76:79], v231 offset:6144
    v_mfma_f32_16x16x32_bf16 v[40:43], a[108:111], v[80:83], v[40:43]
    v_lshlrev_b32 v216, 16, v192
    v_mfma_f32_16x16x32_bf16 v[60:63], a[108:111], v[84:87], v[60:63]
    ds_read_b64 v[16:17], v236
    buffer_load_dwordx4 a[12:15], v8, s[28:31], s37 offen offset:1024
    v_mfma_f32_16x16x32_bf16 v[44:47], a[112:115], v[80:83], v[44:47]
    v_lshlrev_b32 v218, 16, v193
    v_mfma_f32_16x16x32_bf16 v[64:67], a[112:115], v[84:87], v[64:67]
    ds_read_b64 v[18:19], v237
    v_mfma_f32_16x16x32_bf16 v[48:51], a[116:119], v[80:83], v[48:51]
    v_and_b32 v217, 0xffff0000, v192
    v_mfma_f32_16x16x32_bf16 v[68:71], a[116:119], v[84:87], v[68:71]
    buffer_load_dwordx4 a[16:19], v8, s[28:31], s37 offen offset:2048
    v_and_b32 v219, 0xffff0000, v193
    s_waitcnt vmcnt(34) lgkmcnt(0)
    v_mfma_f32_16x16x32_bf16 v[32:35], a[120:123], v[72:75], v[32:35]
    v_add_f32 v217, 0x3727c5ac, v217
    v_mfma_f32_16x16x32_bf16 v[52:55], a[120:123], v[76:79], v[52:55]
    ds_read_b128 v[80:83], v230 offset:7168
    v_mfma_f32_16x16x32_bf16 v[36:39], a[124:127], v[72:75], v[36:39]
    buffer_load_dwordx4 a[20:23], v8, s[28:31], s37 offen offset:3072
    v_add_f32 v219, 0x3727c5ac, v219
    v_mfma_f32_16x16x32_bf16 v[56:59], a[124:127], v[76:79], v[56:59]
    ds_read_b128 v[84:87], v232 offset:7168
    v_mfma_f32_16x16x32_bf16 v[40:43], a[128:131], v[72:75], v[40:43]
    v_cvt_pk_bf16_f32 v192, v217, v217
    v_mfma_f32_16x16x32_bf16 v[60:63], a[128:131], v[76:79], v[60:63]
    ds_read_b64 v[20:21], v238
    s_add_u32 s37, s37, 4096
    buffer_load_dwordx4 a[24:27], v8, s[28:31], s37 offen offset:0
    v_mfma_f32_16x16x32_bf16 v[44:47], a[132:135], v[72:75], v[44:47]
    v_cvt_pk_bf16_f32 v193, v219, v219
    v_mfma_f32_16x16x32_bf16 v[64:67], a[132:135], v[76:79], v[64:67]
    ds_read_b64 v[22:23], v239
    v_mfma_f32_16x16x32_bf16 v[48:51], a[136:139], v[72:75], v[48:51]
    v_lshlrev_b32 v217, 16, v192
    v_mfma_f32_16x16x32_bf16 v[68:71], a[136:139], v[76:79], v[68:71]
    buffer_load_dwordx4 a[28:31], v8, s[28:31], s37 offen offset:1024
    v_lshlrev_b32 v219, 16, v193
    s_waitcnt vmcnt(32) lgkmcnt(0)
    v_mfma_f32_16x16x32_bf16 v[32:35], a[140:143], v[80:83], v[32:35]
    v_sqrt_f32 v217, v217
    v_mfma_f32_16x16x32_bf16 v[52:55], a[140:143], v[84:87], v[52:55]
    ds_read_b128 v[72:75], v229 offset:8192
    v_mfma_f32_16x16x32_bf16 v[36:39], a[144:147], v[80:83], v[36:39]
    buffer_load_dwordx4 a[32:35], v8, s[28:31], s37 offen offset:2048
    v_sqrt_f32 v219, v219
    v_mfma_f32_16x16x32_bf16 v[56:59], a[144:147], v[84:87], v[56:59]
    ds_read_b128 v[76:79], v231 offset:8192
    v_mfma_f32_16x16x32_bf16 v[40:43], a[148:151], v[80:83], v[40:43]
    v_cvt_pk_bf16_f32 v192, v217, v217
    v_mfma_f32_16x16x32_bf16 v[60:63], a[148:151], v[84:87], v[60:63]
    buffer_load_dwordx4 a[36:39], v8, s[28:31], s37 offen offset:3072
    ds_read_b64 v[24:25], v240
    v_mfma_f32_16x16x32_bf16 v[44:47], a[152:155], v[80:83], v[44:47]
    v_cvt_pk_bf16_f32 v193, v219, v219
    v_mfma_f32_16x16x32_bf16 v[64:67], a[152:155], v[84:87], v[64:67]
    v_lshlrev_b32 v217, 16, v192
    v_mfma_f32_16x16x32_bf16 v[48:51], a[156:159], v[80:83], v[48:51]
    v_lshlrev_b32 v219, 16, v193
    s_add_u32 s37, s37, 4096
    buffer_load_dwordx4 a[40:43], v8, s[28:31], s37 offen offset:0
    v_mfma_f32_16x16x32_bf16 v[68:71], a[156:159], v[84:87], v[68:71]
    v_rcp_f32 v217, v217
    s_waitcnt vmcnt(30) lgkmcnt(0)
    v_mfma_f32_16x16x32_bf16 v[32:35], a[160:163], v[72:75], v[32:35]
    v_rcp_f32 v219, v219
    v_mfma_f32_16x16x32_bf16 v[52:55], a[160:163], v[76:79], v[52:55]
    ds_read_b128 v[80:83], v230 offset:9216
    buffer_load_dwordx4 a[44:47], v8, s[28:31], s37 offen offset:1024
    v_mfma_f32_16x16x32_bf16 v[36:39], a[164:167], v[72:75], v[36:39]
    v_mul_f32 v216, v216, v217
    v_mfma_f32_16x16x32_bf16 v[56:59], a[164:167], v[76:79], v[56:59]
    ds_read_b128 v[84:87], v232 offset:9216
    v_mfma_f32_16x16x32_bf16 v[40:43], a[168:171], v[72:75], v[40:43]
    v_mul_f32 v218, v218, v219
    v_mfma_f32_16x16x32_bf16 v[60:63], a[168:171], v[76:79], v[60:63]
    buffer_load_dwordx4 a[48:51], v8, s[28:31], s37 offen offset:2048
    v_sub_f32 v216, 0, v216
    v_mfma_f32_16x16x32_bf16 v[44:47], a[172:175], v[72:75], v[44:47]
    v_sub_f32 v218, 0, v218
    v_mfma_f32_16x16x32_bf16 v[64:67], a[172:175], v[76:79], v[64:67]
    s_lshl_b32 s26, s20, 6
    v_mfma_f32_16x16x32_bf16 v[48:51], a[176:179], v[72:75], v[48:51]
    v_lshl_add_u32 v2, v3, 3, s26
    v_mfma_f32_16x16x32_bf16 v[68:71], a[176:179], v[76:79], v[68:71]
    buffer_load_dwordx4 a[52:55], v8, s[28:31], s37 offen offset:3072
    v_add_u32 v2, 138240, v2
    s_waitcnt vmcnt(28) lgkmcnt(0)
    v_mfma_f32_16x16x32_bf16 v[32:35], a[180:183], v[80:83], v[32:35]
    ds_write_b64 v2, v[216:217]
    v_mfma_f32_16x16x32_bf16 v[52:55], a[180:183], v[84:87], v[52:55]
    s_add_u32 s37, s37, 4096
    buffer_load_dwordx4 a[56:59], v8, s[28:31], s37 offen offset:0
    ds_write_b64 v2, v[218:219] offset:32
    v_mfma_f32_16x16x32_bf16 v[36:39], a[184:187], v[80:83], v[36:39]
    v_mfma_f32_16x16x32_bf16 v[56:59], a[184:187], v[84:87], v[56:59]
    v_mfma_f32_16x16x32_bf16 v[40:43], a[188:191], v[80:83], v[40:43]
    buffer_load_dwordx4 a[60:63], v8, s[28:31], s37 offen offset:1024
    v_mfma_f32_16x16x32_bf16 v[60:63], a[188:191], v[84:87], v[60:63]
    v_mfma_f32_16x16x32_bf16 v[44:47], a[192:195], v[80:83], v[44:47]
    v_mfma_f32_16x16x32_bf16 v[64:67], a[192:195], v[84:87], v[64:67]
    v_mfma_f32_16x16x32_bf16 v[48:51], a[196:199], v[80:83], v[48:51]
    v_mfma_f32_16x16x32_bf16 v[68:71], a[196:199], v[84:87], v[68:71]
    buffer_load_dwordx4 a[64:67], v8, s[28:31], s37 offen offset:2048
    s_waitcnt lgkmcnt(0)
    s_nop 4
    ds_write_b128 v246, v[52:55] offset:0
    ds_write_b128 v246, v[56:59] offset:1024
    buffer_load_dwordx4 a[68:71], v8, s[28:31], s37 offen offset:3072
    ds_write_b128 v246, v[60:63] offset:2048
    ds_write_b128 v246, v[64:67] offset:3072
    s_add_u32 s37, s37, 4096
    buffer_load_dwordx4 a[72:75], v8, s[28:31], s37 offen offset:0
    ds_write_b128 v246, v[68:71] offset:4096
    v_pk_add_f32 v[112:113], v[112:113], v[132:133]
    v_pk_add_f32 v[114:115], v[114:115], v[134:135]
    v_pk_add_f32 v[116:117], v[116:117], v[136:137]
    v_pk_add_f32 v[118:119], v[118:119], v[138:139]
    v_pk_add_f32 v[120:121], v[120:121], v[140:141]
    v_pk_add_f32 v[122:123], v[122:123], v[142:143]
    v_pk_add_f32 v[124:125], v[124:125], v[144:145]
    v_pk_add_f32 v[126:127], v[126:127], v[146:147]
    v_pk_add_f32 v[128:129], v[128:129], v[148:149]
    buffer_load_dwordx4 a[76:79], v8, s[28:31], s37 offen offset:1024
    v_pk_add_f32 v[130:131], v[130:131], v[150:151]
    v_mov_b32 v30, 0xbdd2d3e8
    v_mov_b32 v31, 0xc0135761
    s_waitcnt lgkmcnt(0)
    s_barrier
    ds_read_b64 v[152:153], v235
    ds_read_b128 v[88:91], v247 offset:0
    ds_read_b128 v[92:95], v247 offset:1024
    ds_read_b128 v[96:99], v247 offset:2048
    buffer_load_dwordx4 a[80:83], v8, s[28:31], s37 offen offset:2048
    ds_read_b128 v[100:103], v247 offset:3072
    ds_read_b128 v[104:107], v247 offset:4096
    s_waitcnt lgkmcnt(5)
    v_pk_mul_f32 v[112:113], v[112:113], v[152:153] op_sel_hi:[1,0]
    v_pk_mul_f32 v[114:115], v[114:115], v[152:153] op_sel_hi:[1,0]
    v_pk_mul_f32 v[116:117], v[116:117], v[152:153] op_sel_hi:[1,0]
    v_pk_mul_f32 v[118:119], v[118:119], v[152:153] op_sel_hi:[1,0]
    v_pk_mul_f32 v[120:121], v[120:121], v[152:153] op_sel_hi:[1,0]
    v_pk_mul_f32 v[122:123], v[122:123], v[152:153] op_sel_hi:[1,0]
    v_pk_mul_f32 v[124:125], v[124:125], v[152:153] op_sel_hi:[1,0]
    v_pk_mul_f32 v[126:127], v[126:127], v[152:153] op_sel_hi:[1,0]
    v_pk_mul_f32 v[128:129], v[128:129], v[152:153] op_sel_hi:[1,0]
    v_pk_mul_f32 v[130:131], v[130:131], v[152:153] op_sel_hi:[1,0]
    buffer_load_dwordx4 a[84:87], v8, s[28:31], s37 offen offset:3072
    s_waitcnt lgkmcnt(4)
    v_pk_add_f32 v[32:33], v[32:33], v[88:89]
    v_pk_add_f32 v[34:35], v[34:35], v[90:91]
    s_waitcnt lgkmcnt(3)
    v_pk_add_f32 v[36:37], v[36:37], v[92:93]
    v_pk_add_f32 v[38:39], v[38:39], v[94:95]
    s_waitcnt lgkmcnt(2)
    v_pk_add_f32 v[40:41], v[40:41], v[96:97]
    v_pk_add_f32 v[42:43], v[42:43], v[98:99]
    s_waitcnt lgkmcnt(1)
    v_pk_add_f32 v[44:45], v[44:45], v[100:101]
    v_pk_add_f32 v[46:47], v[46:47], v[102:103]
    s_waitcnt lgkmcnt(0)
    v_pk_add_f32 v[48:49], v[48:49], v[104:105]
    v_pk_add_f32 v[50:51], v[50:51], v[106:107]
    v_pk_fma_f32 v[32:33], v[32:33], v[152:153], v[112:113] op_sel:[0,1,0] op_sel_hi:[1,1,1]
    v_pk_fma_f32 v[34:35], v[34:35], v[152:153], v[114:115] op_sel:[0,1,0] op_sel_hi:[1,1,1]
    s_add_u32 s37, s37, 4096
    buffer_load_dwordx4 a[88:91], v8, s[28:31], s37 offen offset:0
    v_pk_fma_f32 v[36:37], v[36:37], v[152:153], v[116:117] op_sel:[0,1,0] op_sel_hi:[1,1,1]
    v_pk_fma_f32 v[38:39], v[38:39], v[152:153], v[118:119] op_sel:[0,1,0] op_sel_hi:[1,1,1]
    v_pk_fma_f32 v[40:41], v[40:41], v[152:153], v[120:121] op_sel:[0,1,0] op_sel_hi:[1,1,1]
    v_pk_fma_f32 v[42:43], v[42:43], v[152:153], v[122:123] op_sel:[0,1,0] op_sel_hi:[1,1,1]
    v_pk_fma_f32 v[44:45], v[44:45], v[152:153], v[124:125] op_sel:[0,1,0] op_sel_hi:[1,1,1]
    v_pk_fma_f32 v[46:47], v[46:47], v[152:153], v[126:127] op_sel:[0,1,0] op_sel_hi:[1,1,1]
    v_pk_fma_f32 v[48:49], v[48:49], v[152:153], v[128:129] op_sel:[0,1,0] op_sel_hi:[1,1,1]
    v_pk_fma_f32 v[50:51], v[50:51], v[152:153], v[130:131] op_sel:[0,1,0] op_sel_hi:[1,1,1]
    v_pk_mul_f32 v[192:193], v[32:33], v[32:33]
    v_pk_mul_f32 v[194:195], v[34:35], v[34:35]
    v_pk_mul_f32 v[196:197], v[36:37], v[36:37]
    v_pk_mul_f32 v[198:199], v[38:39], v[38:39]
    v_pk_mul_f32 v[200:201], v[40:41], v[40:41]
    v_pk_mul_f32 v[202:203], v[42:43], v[42:43]
    v_pk_mul_f32 v[204:205], v[44:45], v[44:45]
    v_pk_mul_f32 v[206:207], v[46:47], v[46:47]
    v_pk_mul_f32 v[208:209], v[48:49], v[48:49]
    buffer_load_dwordx4 a[92:95], v8, s[28:31], s37 offen offset:1024
    v_pk_mul_f32 v[210:211], v[50:51], v[50:51]
    v_pk_fma_f32 v[192:193], v[192:193], v[30:31], v[30:31] op_sel:[0,0,1] op_sel_hi:[1,0,1]
    v_pk_fma_f32 v[194:195], v[194:195], v[30:31], v[30:31] op_sel:[0,0,1] op_sel_hi:[1,0,1]
    v_pk_fma_f32 v[196:197], v[196:197], v[30:31], v[30:31] op_sel:[0,0,1] op_sel_hi:[1,0,1]
    v_pk_fma_f32 v[198:199], v[198:199], v[30:31], v[30:31] op_sel:[0,0,1] op_sel_hi:[1,0,1]
    v_pk_fma_f32 v[200:201], v[200:201], v[30:31], v[30:31] op_sel:[0,0,1] op_sel_hi:[1,0,1]
    v_pk_fma_f32 v[202:203], v[202:203], v[30:31], v[30:31] op_sel:[0,0,1] op_sel_hi:[1,0,1]
    v_pk_fma_f32 v[204:205], v[204:205], v[30:31], v[30:31] op_sel:[0,0,1] op_sel_hi:[1,0,1]
    v_pk_fma_f32 v[206:207], v[206:207], v[30:31], v[30:31] op_sel:[0,0,1] op_sel_hi:[1,0,1]
    v_pk_fma_f32 v[208:209], v[208:209], v[30:31], v[30:31] op_sel:[0,0,1] op_sel_hi:[1,0,1]
    v_pk_fma_f32 v[210:211], v[210:211], v[30:31], v[30:31] op_sel:[0,0,1] op_sel_hi:[1,0,1]
    v_pk_mul_f32 v[192:193], v[192:193], v[32:33]
    v_pk_mul_f32 v[194:195], v[194:195], v[34:35]
    v_pk_mul_f32 v[196:197], v[196:197], v[36:37]
    v_pk_mul_f32 v[198:199], v[198:199], v[38:39]
    v_pk_mul_f32 v[200:201], v[200:201], v[40:41]
    v_pk_mul_f32 v[202:203], v[202:203], v[42:43]
    buffer_load_dwordx4 a[96:99], v8, s[28:31], s37 offen offset:2048
    v_pk_mul_f32 v[204:205], v[204:205], v[44:45]
    v_pk_mul_f32 v[206:207], v[206:207], v[46:47]
    v_pk_mul_f32 v[208:209], v[208:209], v[48:49]
    v_pk_mul_f32 v[210:211], v[210:211], v[50:51]
    v_exp_f32 v192, v192
    v_exp_f32 v193, v193
    v_exp_f32 v194, v194
    v_exp_f32 v195, v195
    v_exp_f32 v196, v196
    v_exp_f32 v197, v197
    v_exp_f32 v198, v198
    buffer_load_dwordx4 a[100:103], v8, s[28:31], s37 offen offset:3072
    v_exp_f32 v199, v199
    v_exp_f32 v200, v200
    v_exp_f32 v201, v201
    v_exp_f32 v202, v202
    v_exp_f32 v203, v203
    v_exp_f32 v204, v204
    v_exp_f32 v205, v205
    v_exp_f32 v206, v206
    v_exp_f32 v207, v207
    s_add_u32 s37, s37, 4096
    buffer_load_dwordx4 a[104:107], v8, s[28:31], s37 offen offset:0
    v_exp_f32 v208, v208
    v_exp_f32 v209, v209
    v_exp_f32 v210, v210
    v_exp_f32 v211, v211
    v_pk_add_f32 v[192:193], v[192:193], 1.0 op_sel_hi:[1,0]
    v_pk_add_f32 v[194:195], v[194:195], 1.0 op_sel_hi:[1,0]
    v_pk_add_f32 v[196:197], v[196:197], 1.0 op_sel_hi:[1,0]
    v_pk_add_f32 v[198:199], v[198:199], 1.0 op_sel_hi:[1,0]
    v_pk_add_f32 v[200:201], v[200:201], 1.0 op_sel_hi:[1,0]
    v_pk_add_f32 v[202:203], v[202:203], 1.0 op_sel_hi:[1,0]
    v_pk_add_f32 v[204:205], v[204:205], 1.0 op_sel_hi:[1,0]
    v_pk_add_f32 v[206:207], v[206:207], 1.0 op_sel_hi:[1,0]
    v_pk_add_f32 v[208:209], v[208:209], 1.0 op_sel_hi:[1,0]
    buffer_load_dwordx4 a[108:111], v8, s[28:31], s37 offen offset:1024
    v_pk_add_f32 v[210:211], v[210:211], 1.0 op_sel_hi:[1,0]
    v_rcp_f32 v192, v192
    v_rcp_f32 v193, v193
    v_rcp_f32 v194, v194
    v_rcp_f32 v195, v195
    v_rcp_f32 v196, v196
    v_rcp_f32 v197, v197
    v_rcp_f32 v198, v198
    v_rcp_f32 v199, v199
    buffer_load_dwordx4 a[112:115], v8, s[28:31], s37 offen offset:2048
    v_rcp_f32 v200, v200
    v_rcp_f32 v201, v201
    v_rcp_f32 v202, v202
    v_rcp_f32 v203, v203
    v_rcp_f32 v204, v204
    v_rcp_f32 v205, v205
    v_rcp_f32 v206, v206
    v_rcp_f32 v207, v207
    v_rcp_f32 v208, v208
    buffer_load_dwordx4 a[116:119], v8, s[28:31], s37 offen offset:3072
    v_rcp_f32 v209, v209
    v_rcp_f32 v210, v210
    v_rcp_f32 v211, v211
    v_pk_mul_f32 v[32:33], v[32:33], v[192:193]
    v_pk_mul_f32 v[34:35], v[34:35], v[194:195]
    v_pk_mul_f32 v[36:37], v[36:37], v[196:197]
    v_pk_mul_f32 v[38:39], v[38:39], v[198:199]
    v_pk_mul_f32 v[40:41], v[40:41], v[200:201]
    v_pk_mul_f32 v[42:43], v[42:43], v[202:203]
    v_pk_mul_f32 v[44:45], v[44:45], v[204:205]
    v_pk_mul_f32 v[46:47], v[46:47], v[206:207]
    v_pk_mul_f32 v[48:49], v[48:49], v[208:209]
    v_pk_mul_f32 v[50:51], v[50:51], v[210:211]
    v_cvt_pk_bf16_f32 v180, v32, v33
    v_cvt_pk_bf16_f32 v181, v34, v35
    v_cvt_pk_bf16_f32 v182, v36, v37
    v_cvt_pk_bf16_f32 v183, v38, v39
    v_cvt_pk_bf16_f32 v184, v40, v41
    v_cvt_pk_bf16_f32 v185, v42, v43
    v_cvt_pk_bf16_f32 v186, v44, v45
    v_cvt_pk_bf16_f32 v187, v46, v47
    v_cvt_pk_bf16_f32 v188, v48, v49
    v_cvt_pk_bf16_f32 v189, v50, v51
    s_nop 1
    v_permlane16_swap_b32 v180, v182
    v_permlane16_swap_b32 v181, v183
    v_permlane16_swap_b32 v184, v186
    v_permlane16_swap_b32 v185, v187
    s_mov_b64 exec, s[60:61]
    buffer_store_dwordx4 v[180:183], v241, s[28:31], s44 offen sc1
    buffer_store_dwordx4 v[184:187], v241, s[28:31], s44 offen offset:1024 sc1
    buffer_store_dwordx2 v[188:189], v242, s[28:31], s45 offen sc1
    s_mov_b64 exec, -1
    v_add_u32 v243, s43, v4
    v_lshrrev_b32 v244, 4, v243
    v_and_b32 v243, 15, v243
    s_mov_b32 s27, 20480
    v_mul_lo_u32 v244, v244, s27
    v_lshl_add_u32 v244, v243, 4, v244
    v_and_b32 v243, 1, v3
    v_lshlrev_b32 v243, 9, v243
    v_lshrrev_b32 v2, 1, v3
    v_lshl_add_u32 v243, v2, 8, v243
    v_add_u32 v243, v243, v244
    s_lshl_b32 s27, s21, 9
    v_lshl_add_u32 v244, v2, 8, v244
    v_add_u32 v244, s27, v244
    v_and_b32 v2, 1, v3
    v_lshl_add_u32 v244, v2, 3, v244
    s_add_u32 s38, s44, 2621440
    s_add_u32 s39, s45, 2621440
    s_add_u32 s49, s46, 32768
    v_add_u32 v7, 1, v1
    v_lshrrev_b32 v7, 1, v7
    v_add_u32 v7, s23, v7
    v_subrev_u32 v7, 1, v7
    v_max_i32 v7, 0, v7
    v_min_i32 v7, 63, v7
    v_lshrrev_b32 v2, 1, v1
    s_lshl_b32 s26, s22, 1
    v_add_u32 v2, s26, v2
    v_lshl_add_u32 v7, v7, 2, v2
    v_lshlrev_b32 v245, 7, v7
    s_lshl_b32 s26, s23, 1
    s_add_u32 s27, s26, s22
    s_mul_i32 s27, s27, 20
    s_mul_i32 s3, s22, 10
    s_add_u32 s27, s27, s3
    s_lshl_b32 s27, s27, 10
    s_add_u32 s50, s27, 10784768
    s_add_u32 s27, s26, 1
    s_sub_u32 s27, s27, s22
    s_mul_i32 s27, s27, 20
    s_add_u32 s27, s27, s3
    s_lshl_b32 s27, s27, 10
    s_add_u32 s51, s27, 10784768
    s_lshr_b32 s26, s2, 3
    s_and_b32 s3, s2, 7
    s_and_b32 s4, s3, 1
    s_lshr_b32 s3, s3, 1
    s_and_b32 s52, s26, 7
    s_lshl_b32 s27, s4, 3
    s_add_u32 s52, s52, s27
    s_lshr_b32 s27, s26, 3
    s_lshl_b32 s53, s3, 2
    s_add_u32 s53, s53, s27
    s_and_b32 s57, s26, 3
    s_lshl_b32 s27, s4, 2
    s_add_u32 s57, s57, s27
    s_lshr_b32 s27, s26, 2
    s_lshl_b32 s58, s3, 3
    s_add_u32 s58, s58, s27
    s_and_b32 s57, s26, 7
    s_lshr_b32 s27, s26, 3
    s_and_b32 s58, s2, 7
    s_lshl_b32 s58, s58, 2
    s_add_u32 s58, s58, s27
    s_mul_i32 s54, s52, 143360
    s_add_u32 s54, s54, 24875008
    s_mul_i32 s59, s57, 276480
    s_add_u32 s59, s59, 27168768
    s_waitcnt vmcnt(0)
    s_barrier
    s_cmp_lg_u32 s20, 0
    s_cbranch_scc1 chain_kernel_sig1
    v_mov_b32 v2, 1
    v_mov_b32 v7, 0
    s_mov_b64 exec, 1
    buffer_store_dword v2, v7, s[28:31], s46 offen sc1
    s_mov_b64 exec, -1
chain_kernel_sig1:
    s_add_u32 s37, s37, 4096
    buffer_load_dwordx4 a[120:123], v8, s[28:31], s37 offen offset:0
    buffer_load_dwordx4 a[124:127], v8, s[28:31], s37 offen offset:1024
    buffer_load_dwordx4 a[128:131], v8, s[28:31], s37 offen offset:2048
    buffer_load_dwordx4 a[132:135], v8, s[28:31], s37 offen offset:3072
    s_add_u32 s37, s37, 4096
    buffer_load_dwordx4 a[136:139], v8, s[28:31], s37 offen offset:0
    buffer_load_dwordx4 a[140:143], v8, s[28:31], s37 offen offset:1024
    s_mul_i32 s25, s20, 10
    s_lshl_b32 s25, s25, 10
    s_add_u32 s62, s25, 0
    s_add_u32 s63, s25, s54
    s_mov_b32 m0, s62
    s_add_u32 s63, s63, 0
    buffer_load_dwordx4 v8, s[28:31], s63 offen offset:0 lds
    buffer_load_dwordx4 v8, s[28:31], s63 offen offset:1024 lds
    buffer_load_dwordx4 v8, s[28:31], s63 offen offset:2048 lds
    buffer_load_dwordx4 v8, s[28:31], s63 offen offset:3072 lds
    s_add_u32 s62, s62, 4096
    s_mov_b32 m0, s62
    s_add_u32 s63, s63, 4096
    buffer_load_dwordx4 v8, s[28:31], s63 offen offset:0 lds
    buffer_load_dwordx4 v8, s[28:31], s63 offen offset:1024 lds
    buffer_load_dwordx4 v8, s[28:31], s63 offen offset:2048 lds
    buffer_load_dwordx4 v8, s[28:31], s63 offen offset:3072 lds
    s_add_u32 s62, s62, 4096
    s_mov_b32 m0, s62
    s_add_u32 s63, s63, 4096
    buffer_load_dwordx4 v8, s[28:31], s63 offen offset:0 lds
    buffer_load_dwordx4 v8, s[28:31], s63 offen offset:1024 lds
    s_lshl_b32 s26, s53, 3
    s_lshl_b32 s27, s20, 1
    s_add_u32 s56, s26, s27
    s_mul_i32 s6, s56, 20480
    s_add_u32 s6, s6, 13406208
    s_add_u32 s7, s6, 20480
    s_lshl_b32 s26, s53, 2
    s_add_u32 s26, s26, s20
    s_lshl_b32 s26, s26, 9
    s_add_u32 s8, s26, 29413376
    v_lshlrev_b32 v228, 3, v4
    v_lshl_add_u32 v228, v3, 8, v228
    s_lshl_b32 s9, s56, 10
    s_add_u32 s9, s9, 23105536
    s_and_b32 s42, s52, 1
    s_mul_i32 s12, s52, 7
    s_add_u32 s13, s12, 1
    s_lshr_b32 s13, s13, 1
    s_add_u32 s26, s13, 3
    s_sub_u32 s27, s13, 1
    s_cmp_eq_u32 s42, 1
    s_cselect_b32 s12, s27, s26
    s_lshl_b32 s13, s13, 10
    s_add_u32 s13, s13, 16027648
    s_lshl_b32 s12, s12, 10
    s_add_u32 s12, s12, 16027648
    s_lshl_b32 s14, s56, 4
    s_lshl_b32 s15, s53, 4
    s_add_u32 s15, s15, s52
    s_lshl_b32 s15, s15, 2
    s_add_u32 s15, s15, s20
    s_lshl_b32 s15, s15, 7
    s_add_u32 s15, s15, 29446144
    s_lshr_b32 s26, s43, 4
    s_lshl_b32 s26, s26, 3
    s_lshl_b32 s27, s24, 1
    s_add_u32 s26, s26, s27
    s_add_u32 s26, s26, s21
    s_lshl_b32 s26, s26, 7
    s_add_u32 s19, s26, 23105536
    v_add_u32 v226, s14, v4
    v_lshrrev_b32 v227, 4, v226
    v_and_b32 v226, 15, v226
    s_mov_b32 s27, 55296
    v_mul_lo_u32 v227, v227, s27
    v_lshl_add_u32 v227, v226, 4, v227
    v_and_b32 v226, 1, v3
    v_lshlrev_b32 v226, 9, v226
    v_lshrrev_b32 v2, 1, v3
    v_lshl_add_u32 v226, v2, 8, v226
    v_add_u32 v226, v226, v227
    s_lshl_b32 s27, s42, 9
    v_lshl_add_u32 v227, v2, 8, v227
    v_add_u32 v227, s27, v227
    v_and_b32 v2, 1, v3
    v_lshl_add_u32 v227, v2, 3, v227
    s_mov_b32 s48, 29380608
    s_mov_b32 s47, 0
    s_mov_b64 exec, 15
chain_kernel_poll2:
    buffer_load_dword v2, v245, s[28:31], s48 offen sc1
    s_add_u32 s47, s47, 1
    s_waitcnt vmcnt(0)
    v_cmp_ne_u32 vcc, 1, v2
    s_cmp_ge_u32 s47, 200000
    s_cbranch_scc1 chain_kernel_polld3
    s_cbranch_vccnz chain_kernel_poll2
chain_kernel_polld3:
    s_mov_b64 exec, -1
    buffer_load_dwordx4 v[72:75], v8, s[28:31], s50 offen offset:0 sc1
    buffer_load_dwordx4 v[76:79], v8, s[28:31], s51 offen offset:0 sc1
    buffer_load_dwordx4 v[80:83], v8, s[28:31], s50 offen offset:1024 sc1
    buffer_load_dwordx4 v[84:87], v8, s[28:31], s51 offen offset:1024 sc1
    buffer_load_dwordx4 v[88:91], v8, s[28:31], s50 offen offset:2048 sc1
    buffer_load_dwordx4 v[92:95], v8, s[28:31], s51 offen offset:2048 sc1
    buffer_load_dwordx4 v[96:99], v8, s[28:31], s50 offen offset:3072 sc1
    buffer_load_dwordx4 v[100:103], v8, s[28:31], s51 offen offset:3072 sc1
    s_add_u32 s50, s50, 4096
    s_add_u32 s51, s51, 4096
    buffer_load_dwordx4 v[104:107], v8, s[28:31], s50 offen offset:0 sc1
    buffer_load_dwordx4 v[108:111], v8, s[28:31], s51 offen offset:0 sc1
    s_waitcnt vmcnt(8)
    v_mfma_f32_16x16x32_bf16 v[32:35], a[200:203], v[72:75], 0
    v_mfma_f32_16x16x32_bf16 v[52:55], a[200:203], v[76:79], 0
    buffer_load_dwordx4 v[112:115], v8, s[28:31], s50 offen offset:1024 sc1
    v_mfma_f32_16x16x32_bf16 v[36:39], a[204:207], v[72:75], 0
    v_mfma_f32_16x16x32_bf16 v[56:59], a[204:207], v[76:79], 0
    v_mfma_f32_16x16x32_bf16 v[40:43], a[208:211], v[72:75], 0
    v_mfma_f32_16x16x32_bf16 v[60:63], a[208:211], v[76:79], 0
    buffer_load_dwordx4 v[116:119], v8, s[28:31], s51 offen offset:1024 sc1
    v_mfma_f32_16x16x32_bf16 v[44:47], a[212:215], v[72:75], 0
    v_mfma_f32_16x16x32_bf16 v[64:67], a[212:215], v[76:79], 0
    v_mfma_f32_16x16x32_bf16 v[48:51], a[216:219], v[72:75], 0
    v_mfma_f32_16x16x32_bf16 v[68:71], a[216:219], v[76:79], 0
    s_waitcnt vmcnt(8)
    v_mfma_f32_16x16x32_bf16 v[32:35], a[220:223], v[80:83], v[32:35]
    v_mfma_f32_16x16x32_bf16 v[52:55], a[220:223], v[84:87], v[52:55]
    buffer_load_dwordx4 v[120:123], v8, s[28:31], s50 offen offset:2048 sc1
    v_mfma_f32_16x16x32_bf16 v[36:39], a[224:227], v[80:83], v[36:39]
    v_mfma_f32_16x16x32_bf16 v[56:59], a[224:227], v[84:87], v[56:59]
    v_mfma_f32_16x16x32_bf16 v[40:43], a[228:231], v[80:83], v[40:43]
    v_mfma_f32_16x16x32_bf16 v[60:63], a[228:231], v[84:87], v[60:63]
    buffer_load_dwordx4 v[124:127], v8, s[28:31], s51 offen offset:2048 sc1
    v_mfma_f32_16x16x32_bf16 v[44:47], a[232:235], v[80:83], v[44:47]
    v_mfma_f32_16x16x32_bf16 v[64:67], a[232:235], v[84:87], v[64:67]
    v_mfma_f32_16x16x32_bf16 v[48:51], a[236:239], v[80:83], v[48:51]
    v_mfma_f32_16x16x32_bf16 v[68:71], a[236:239], v[84:87], v[68:71]
    s_waitcnt vmcnt(8)
    v_mfma_f32_16x16x32_bf16 v[32:35], a[240:243], v[88:91], v[32:35]
    v_mfma_f32_16x16x32_bf16 v[52:55], a[240:243], v[92:95], v[52:55]
    buffer_load_dwordx4 v[128:131], v8, s[28:31], s50 offen offset:3072 sc1
    v_mfma_f32_16x16x32_bf16 v[36:39], a[244:247], v[88:91], v[36:39]
    v_mfma_f32_16x16x32_bf16 v[56:59], a[244:247], v[92:95], v[56:59]
    v_mfma_f32_16x16x32_bf16 v[40:43], a[248:251], v[88:91], v[40:43]
    v_mfma_f32_16x16x32_bf16 v[60:63], a[248:251], v[92:95], v[60:63]
    buffer_load_dwordx4 v[132:135], v8, s[28:31], s51 offen offset:3072 sc1
    v_mfma_f32_16x16x32_bf16 v[44:47], a[252:255], v[88:91], v[44:47]
    v_mfma_f32_16x16x32_bf16 v[64:67], a[252:255], v[92:95], v[64:67]
    v_mfma_f32_16x16x32_bf16 v[48:51], a[0:3], v[88:91], v[48:51]
    v_mfma_f32_16x16x32_bf16 v[68:71], a[0:3], v[92:95], v[68:71]
    s_waitcnt vmcnt(8)
    v_mfma_f32_16x16x32_bf16 v[32:35], a[4:7], v[96:99], v[32:35]
    v_mfma_f32_16x16x32_bf16 v[52:55], a[4:7], v[100:103], v[52:55]
    s_add_u32 s50, s50, 4096
    s_add_u32 s51, s51, 4096
    buffer_load_dwordx4 v[136:139], v8, s[28:31], s50 offen offset:0 sc1
    v_mfma_f32_16x16x32_bf16 v[36:39], a[8:11], v[96:99], v[36:39]
    v_mfma_f32_16x16x32_bf16 v[56:59], a[8:11], v[100:103], v[56:59]
    v_mfma_f32_16x16x32_bf16 v[40:43], a[12:15], v[96:99], v[40:43]
    v_mfma_f32_16x16x32_bf16 v[60:63], a[12:15], v[100:103], v[60:63]
    buffer_load_dwordx4 v[140:143], v8, s[28:31], s51 offen offset:0 sc1
    v_mfma_f32_16x16x32_bf16 v[44:47], a[16:19], v[96:99], v[44:47]
    v_mfma_f32_16x16x32_bf16 v[64:67], a[16:19], v[100:103], v[64:67]
    v_mfma_f32_16x16x32_bf16 v[48:51], a[20:23], v[96:99], v[48:51]
    v_mfma_f32_16x16x32_bf16 v[68:71], a[20:23], v[100:103], v[68:71]
    s_waitcnt vmcnt(8)
    v_mfma_f32_16x16x32_bf16 v[32:35], a[24:27], v[104:107], v[32:35]
    v_mfma_f32_16x16x32_bf16 v[52:55], a[24:27], v[108:111], v[52:55]
    buffer_load_dwordx4 v[144:147], v8, s[28:31], s50 offen offset:1024 sc1
    v_mfma_f32_16x16x32_bf16 v[36:39], a[28:31], v[104:107], v[36:39]
    v_mfma_f32_16x16x32_bf16 v[56:59], a[28:31], v[108:111], v[56:59]
    v_mfma_f32_16x16x32_bf16 v[40:43], a[32:35], v[104:107], v[40:43]
    v_mfma_f32_16x16x32_bf16 v[60:63], a[32:35], v[108:111], v[60:63]
    buffer_load_dwordx4 v[148:151], v8, s[28:31], s51 offen offset:1024 sc1
    v_mfma_f32_16x16x32_bf16 v[44:47], a[36:39], v[104:107], v[44:47]
    v_mfma_f32_16x16x32_bf16 v[64:67], a[36:39], v[108:111], v[64:67]
    s_mul_i32 s25, s20, 20
    s_lshl_b32 s25, s25, 10
    s_add_u32 s62, s25, 40960
    s_add_u32 s63, s25, s54
    s_mov_b32 m0, s62
    s_add_u32 s63, s63, 40960
    buffer_load_dwordx4 v8, s[28:31], s63 offen offset:0 lds
    v_mfma_f32_16x16x32_bf16 v[48:51], a[40:43], v[104:107], v[48:51]
    v_mfma_f32_16x16x32_bf16 v[68:71], a[40:43], v[108:111], v[68:71]
    s_waitcnt vmcnt(9)
    v_mfma_f32_16x16x32_bf16 v[32:35], a[44:47], v[112:115], v[32:35]
    v_mfma_f32_16x16x32_bf16 v[52:55], a[44:47], v[116:119], v[52:55]
    buffer_load_dwordx4 v8, s[28:31], s63 offen offset:1024 lds
    v_mfma_f32_16x16x32_bf16 v[36:39], a[48:51], v[112:115], v[36:39]
    v_mfma_f32_16x16x32_bf16 v[56:59], a[48:51], v[116:119], v[56:59]
    buffer_load_dwordx4 v8, s[28:31], s63 offen offset:2048 lds
    v_mfma_f32_16x16x32_bf16 v[40:43], a[52:55], v[112:115], v[40:43]
    v_mfma_f32_16x16x32_bf16 v[60:63], a[52:55], v[116:119], v[60:63]
    v_mfma_f32_16x16x32_bf16 v[44:47], a[56:59], v[112:115], v[44:47]
    v_mfma_f32_16x16x32_bf16 v[64:67], a[56:59], v[116:119], v[64:67]
    buffer_load_dwordx4 v8, s[28:31], s63 offen offset:3072 lds
    v_mfma_f32_16x16x32_bf16 v[48:51], a[60:63], v[112:115], v[48:51]
    v_mfma_f32_16x16x32_bf16 v[68:71], a[60:63], v[116:119], v[68:71]
    s_waitcnt vmcnt(10)
    v_mfma_f32_16x16x32_bf16 v[32:35], a[64:67], v[120:123], v[32:35]
    v_mfma_f32_16x16x32_bf16 v[52:55], a[64:67], v[124:127], v[52:55]
    s_add_u32 s62, s62, 4096
    s_mov_b32 m0, s62
    s_add_u32 s63, s63, 4096
    buffer_load_dwordx4 v8, s[28:31], s63 offen offset:0 lds
    v_mfma_f32_16x16x32_bf16 v[36:39], a[68:71], v[120:123], v[36:39]
    v_mfma_f32_16x16x32_bf16 v[56:59], a[68:71], v[124:127], v[56:59]
    buffer_load_dwordx4 v8, s[28:31], s63 offen offset:1024 lds
    v_mfma_f32_16x16x32_bf16 v[40:43], a[72:75], v[120:123], v[40:43]
    v_mfma_f32_16x16x32_bf16 v[60:63], a[72:75], v[124:127], v[60:63]
    v_mfma_f32_16x16x32_bf16 v[44:47], a[76:79], v[120:123], v[44:47]
    v_mfma_f32_16x16x32_bf16 v[64:67], a[76:79], v[124:127], v[64:67]
    buffer_load_dwordx4 v8, s[28:31], s63 offen offset:2048 lds
    v_mfma_f32_16x16x32_bf16 v[48:51], a[80:83], v[120:123], v[48:51]
    v_mfma_f32_16x16x32_bf16 v[68:71], a[80:83], v[124:127], v[68:71]
    s_waitcnt vmcnt(11)
    v_mfma_f32_16x16x32_bf16 v[32:35], a[84:87], v[128:131], v[32:35]
    v_mfma_f32_16x16x32_bf16 v[52:55], a[84:87], v[132:135], v[52:55]
    buffer_load_dwordx4 v8, s[28:31], s63 offen offset:3072 lds
    v_mfma_f32_16x16x32_bf16 v[36:39], a[88:91], v[128:131], v[36:39]
    v_mfma_f32_16x16x32_bf16 v[56:59], a[88:91], v[132:135], v[56:59]
    s_add_u32 s62, s62, 4096
    s_mov_b32 m0, s62
    s_add_u32 s63, s63, 4096
    buffer_load_dwordx4 v8, s[28:31], s63 offen offset:0 lds
    v_mfma_f32_16x16x32_bf16 v[40:43], a[92:95], v[128:131], v[40:43]
    v_mfma_f32_16x16x32_bf16 v[60:63], a[92:95], v[132:135], v[60:63]
    v_mfma_f32_16x16x32_bf16 v[44:47], a[96:99], v[128:131], v[44:47]
    v_mfma_f32_16x16x32_bf16 v[64:67], a[96:99], v[132:135], v[64:67]
    buffer_load_dwordx4 v8, s[28:31], s63 offen offset:1024 lds
    v_mfma_f32_16x16x32_bf16 v[48:51], a[100:103], v[128:131], v[48:51]
    v_mfma_f32_16x16x32_bf16 v[68:71], a[100:103], v[132:135], v[68:71]
    s_waitcnt vmcnt(12)
    v_mfma_f32_16x16x32_bf16 v[32:35], a[104:107], v[136:139], v[32:35]
    v_mfma_f32_16x16x32_bf16 v[52:55], a[104:107], v[140:143], v[52:55]
    buffer_load_dwordx4 v8, s[28:31], s63 offen offset:2048 lds
    v_mfma_f32_16x16x32_bf16 v[36:39], a[108:111], v[136:139], v[36:39]
    v_mfma_f32_16x16x32_bf16 v[56:59], a[108:111], v[140:143], v[56:59]
    buffer_load_dwordx4 v8, s[28:31], s63 offen offset:3072 lds
    v_mfma_f32_16x16x32_bf16 v[40:43], a[112:115], v[136:139], v[40:43]
    v_mfma_f32_16x16x32_bf16 v[60:63], a[112:115], v[140:143], v[60:63]
    v_mfma_f32_16x16x32_bf16 v[44:47], a[116:119], v[136:139], v[44:47]
    v_mfma_f32_16x16x32_bf16 v[64:67], a[116:119], v[140:143], v[64:67]
    s_add_u32 s62, s62, 4096
    s_mov_b32 m0, s62
    s_add_u32 s63, s63, 4096
    buffer_load_dwordx4 v8, s[28:31], s63 offen offset:0 lds
    v_mfma_f32_16x16x32_bf16 v[48:51], a[120:123], v[136:139], v[48:51]
    v_mfma_f32_16x16x32_bf16 v[68:71], a[120:123], v[140:143], v[68:71]
    s_waitcnt vmcnt(13)
    v_mfma_f32_16x16x32_bf16 v[32:35], a[124:127], v[144:147], v[32:35]
    v_mfma_f32_16x16x32_bf16 v[52:55], a[124:127], v[148:151], v[52:55]
    buffer_load_dwordx4 v8, s[28:31], s63 offen offset:1024 lds
    v_mfma_f32_16x16x32_bf16 v[36:39], a[128:131], v[144:147], v[36:39]
    v_mfma_f32_16x16x32_bf16 v[56:59], a[128:131], v[148:151], v[56:59]
    buffer_load_dwordx4 v8, s[28:31], s63 offen offset:2048 lds
    v_mfma_f32_16x16x32_bf16 v[40:43], a[132:135], v[144:147], v[40:43]
    v_mfma_f32_16x16x32_bf16 v[60:63], a[132:135], v[148:151], v[60:63]
    v_mfma_f32_16x16x32_bf16 v[44:47], a[136:139], v[144:147], v[44:47]
    v_mfma_f32_16x16x32_bf16 v[64:67], a[136:139], v[148:151], v[64:67]
    buffer_load_dwordx4 v8, s[28:31], s63 offen offset:3072 lds
    v_mfma_f32_16x16x32_bf16 v[48:51], a[140:143], v[144:147], v[48:51]
    v_mfma_f32_16x16x32_bf16 v[68:71], a[140:143], v[148:151], v[68:71]
    s_nop 4
    ds_write_b128 v246, v[52:55] offset:0
    ds_write_b128 v246, v[56:59] offset:1024
    ds_write_b128 v246, v[60:63] offset:2048
    ds_write_b128 v246, v[64:67] offset:3072
    ds_write_b128 v246, v[68:71] offset:4096
    v_lshlrev_b32 v112, 16, v16
    v_and_b32 v113, 0xffff0000, v16
    v_lshlrev_b32 v114, 16, v17
    v_and_b32 v115, 0xffff0000, v17
    v_lshlrev_b32 v116, 16, v18
    v_and_b32 v117, 0xffff0000, v18
    v_lshlrev_b32 v118, 16, v19
    v_and_b32 v119, 0xffff0000, v19
    v_lshlrev_b32 v120, 16, v20
    v_and_b32 v121, 0xffff0000, v20
    v_lshlrev_b32 v122, 16, v21
    v_and_b32 v123, 0xffff0000, v21
    v_lshlrev_b32 v124, 16, v22
    v_and_b32 v125, 0xffff0000, v22
    v_lshlrev_b32 v126, 16, v23
    v_and_b32 v127, 0xffff0000, v23
    v_lshlrev_b32 v128, 16, v24
    v_and_b32 v129, 0xffff0000, v24
    v_lshlrev_b32 v130, 16, v25
    v_and_b32 v131, 0xffff0000, v25
    v_pk_add_f32 v[32:33], v[32:33], v[112:113]
    v_pk_add_f32 v[34:35], v[34:35], v[114:115]
    v_pk_add_f32 v[36:37], v[36:37], v[116:117]
    v_pk_add_f32 v[38:39], v[38:39], v[118:119]
    v_pk_add_f32 v[40:41], v[40:41], v[120:121]
    v_pk_add_f32 v[42:43], v[42:43], v[122:123]
    v_pk_add_f32 v[44:45], v[44:45], v[124:125]
    v_pk_add_f32 v[46:47], v[46:47], v[126:127]
    v_pk_add_f32 v[48:49], v[48:49], v[128:129]
    v_pk_add_f32 v[50:51], v[50:51], v[130:131]
    v_mov_b32 v28, 0
    v_mov_b32 v29, 0
    s_add_u32 s62, s62, 4096
    s_mov_b32 m0, s62
    s_add_u32 s63, s63, 4096
    buffer_load_dwordx4 v8, s[28:31], s63 offen offset:0 lds
    buffer_load_dwordx4 v8, s[28:31], s63 offen offset:1024 lds
    buffer_load_dwordx4 v8, s[28:31], s63 offen offset:2048 lds
    buffer_load_dwordx4 v8, s[28:31], s63 offen offset:3072 lds
    s_mul_i32 s25, s20, 5
    s_lshl_b32 s25, s25, 10
    s_add_u32 s62, s25, 122880
    s_add_u32 s63, s25, s54
    s_mov_b32 m0, s62
    s_add_u32 s63, s63, 122880
    buffer_load_dwordx4 v8, s[28:31], s63 offen offset:0 lds
    buffer_load_dwordx4 v8, s[28:31], s63 offen offset:1024 lds
    buffer_load_dwordx4 v8, s[28:31], s63 offen offset:2048 lds
    buffer_load_dwordx4 v8, s[28:31], s63 offen offset:3072 lds
    s_add_u32 s62, s62, 4096
    s_mov_b32 m0, s62
    s_add_u32 s63, s63, 4096
    buffer_load_dwordx4 v8, s[28:31], s63 offen offset:0 lds
    s_waitcnt lgkmcnt(0)
    s_barrier
    ds_read_b128 v[88:91], v247 offset:0
    ds_read_b128 v[92:95], v247 offset:1024
    ds_read_b128 v[96:99], v247 offset:2048
    ds_read_b128 v[100:103], v247 offset:3072
    ds_read_b128 v[104:107], v247 offset:4096
    s_waitcnt lgkmcnt(4)
    v_pk_add_f32 v[32:33], v[32:33], v[88:89]
    v_pk_add_f32 v[34:35], v[34:35], v[90:91]
    v_cvt_pk_bf16_f32 v180, v32, v33
    v_cvt_pk_bf16_f32 v181, v34, v35
    s_waitcnt lgkmcnt(3)
    v_pk_add_f32 v[36:37], v[36:37], v[92:93]
    v_pk_add_f32 v[38:39], v[38:39], v[94:95]
    v_cvt_pk_bf16_f32 v182, v36, v37
    v_cvt_pk_bf16_f32 v183, v38, v39
    s_waitcnt lgkmcnt(2)
    v_pk_add_f32 v[40:41], v[40:41], v[96:97]
    v_pk_add_f32 v[42:43], v[42:43], v[98:99]
    v_cvt_pk_bf16_f32 v184, v40, v41
    v_cvt_pk_bf16_f32 v185, v42, v43
    s_waitcnt lgkmcnt(1)
    v_pk_add_f32 v[44:45], v[44:45], v[100:101]
    v_pk_add_f32 v[46:47], v[46:47], v[102:103]
    v_cvt_pk_bf16_f32 v186, v44, v45
    v_cvt_pk_bf16_f32 v187, v46, v47
    s_waitcnt lgkmcnt(0)
    v_pk_add_f32 v[48:49], v[48:49], v[104:105]
    v_pk_add_f32 v[50:51], v[50:51], v[106:107]
    v_cvt_pk_bf16_f32 v188, v48, v49
    v_cvt_pk_bf16_f32 v189, v50, v51
    v_dot2_f32_bf16 v28, v180, v224, v28
    v_dot2_f32_bf16 v29, v180, v180, v29
    v_dot2_f32_bf16 v28, v181, v224, v28
    v_dot2_f32_bf16 v29, v181, v181, v29
    v_dot2_f32_bf16 v28, v182, v224, v28
    v_dot2_f32_bf16 v29, v182, v182, v29
    v_dot2_f32_bf16 v28, v183, v224, v28
    v_dot2_f32_bf16 v29, v183, v183, v29
    v_dot2_f32_bf16 v28, v184, v224, v28
    v_dot2_f32_bf16 v29, v184, v184, v29
    v_dot2_f32_bf16 v28, v185, v224, v28
    v_dot2_f32_bf16 v29, v185, v185, v29
    v_dot2_f32_bf16 v28, v186, v224, v28
    v_dot2_f32_bf16 v29, v186, v186, v29
    v_dot2_f32_bf16 v28, v187, v224, v28
    v_dot2_f32_bf16 v29, v187, v187, v29
    v_dot2_f32_bf16 v28, v188, v224, v28
    v_dot2_f32_bf16 v29, v188, v188, v29
    v_dot2_f32_bf16 v28, v189, v224, v28
    v_dot2_f32_bf16 v29, v189, v189, v29
    s_nop 1
    v_permlane16_swap_b32 v180, v182
    v_permlane16_swap_b32 v181, v183
    v_permlane16_swap_b32 v184, v186
    v_permlane16_swap_b32 v185, v187
    buffer_store_dwordx4 v[180:183], v243, s[28:31], s38 offen sc1
    buffer_store_dwordx4 v[184:187], v243, s[28:31], s38 offen offset:1024 sc1
    buffer_store_dwordx2 v[188:189], v244, s[28:31], s39 offen sc1
    v_mov_b32 v160, v28
    v_mov_b32 v161, v29
    s_nop 1
    v_permlane32_swap_b32 v160, v28
    v_permlane32_swap_b32 v161, v29
    s_nop 1
    v_add_f32 v28, v28, v160
    v_add_f32 v29, v29, v161
    v_mov_b32 v160, v28
    v_mov_b32 v161, v29
    s_nop 1
    v_permlane16_swap_b32 v160, v28
    v_permlane16_swap_b32 v161, v29
    s_nop 1
    v_add_f32 v28, v28, v160
    v_add_f32 v29, v29, v161
    v_lshlrev_b32 v2, 3, v4
    s_mov_b64 exec, 0xffff
    buffer_store_dwordx2 v[28:29], v2, s[28:31], s19 offen sc1
    s_mov_b64 exec, -1
    s_waitcnt vmcnt(0)
    s_barrier
    s_cmp_lg_u32 s20, 0
    s_cbranch_scc1 chain_kernel_sig4
    v_mov_b32 v2, 1
    v_mov_b32 v7, 0
    s_mov_b64 exec, 1
    buffer_store_dword v2, v7, s[28:31], s49 offen sc1
    s_mov_b64 exec, -1
chain_kernel_sig4:
    v_and_b32 v2, 31, v1
    v_lshlrev_b32 v2, 4, v2
    v_lshrrev_b32 v7, 5, v1
    v_mul_u32_u24 v7, 7168, v7
    v_add_u32 v2, v2, v7
    s_mul_i32 s26, s52, 448
    s_add_u32 s26, s26, 8130560
    s_mov_b32 m0, 162816
    s_nop 0
    buffer_load_dwordx4 v2, s[28:31], s26 offen lds
    s_and_b32 s36, s57, 1
    s_lshl_b32 s43, s58, 6
    s_lshl_b32 s26, s21, 5
    s_add_u32 s43, s43, s26
    s_lshl_b32 s26, s22, 4
    s_add_u32 s43, s43, s26
    s_mul_i32 s40, s57, 5
    s_add_u32 s41, s40, 1
    s_lshr_b32 s41, s41, 1
    s_add_u32 s26, s41, 2
    s_sub_u32 s27, s41, 1
    s_cmp_eq_u32 s36, 1
    s_cselect_b32 s40, s27, s26
    s_lshl_b32 s44, s41, 10
    s_lshl_b32 s45, s40, 10
    s_lshl_b32 s26, s36, 9
    s_add_u32 s45, s45, s26
    s_lshr_b32 s26, s58, 1
    s_lshl_b32 s26, s26, 4
    s_mul_i32 s27, s22, 7
    s_add_u32 s26, s26, s27
    s_lshl_b32 s26, s26, 2
    s_and_b32 s27, s58, 1
    s_lshl_b32 s27, s27, 1
    s_add_u32 s26, s26, s27
    s_add_u32 s26, s26, s21
    s_lshl_b32 s26, s26, 7
    s_add_u32 s48, s26, 29446144
    v_lshlrev_b32 v234, 9, v1
    s_lshl_b32 s26, s58, 2
    s_lshl_b32 s27, s21, 1
    s_add_u32 s26, s26, s27
    s_add_u32 s27, s26, s22
    s_mul_i32 s27, s27, 54
    s_mul_i32 s39, s22, 27
    s_add_u32 s27, s27, s39
    s_lshl_b32 s27, s27, 10
    s_add_u32 s50, s27, 16027648
    s_add_u32 s27, s26, 1
    s_sub_u32 s27, s27, s22
    s_mul_i32 s27, s27, 54
    s_add_u32 s27, s27, s39
    s_lshl_b32 s27, s27, 10
    s_add_u32 s51, s27, 16027648
    v_add_u32 v9, s43, v4
    v_lshrrev_b32 v11, 4, v9
    v_and_b32 v10, 15, v9
    v_mul_u32_u24 v11, 20480, v11
    v_lshl_add_u32 v11, v10, 4, v11
    v_lshrrev_b32 v2, 1, v3
    v_lshl_add_u32 v11, v2, 8, v11
    v_and_b32 v7, 1, v3
    v_lshl_add_u32 v230, v7, 3, v11
    v_mul_u32_u24 v9, 1280, v9
    v_lshlrev_b32 v7, 5, v7
    v_lshl_add_u32 v7, v2, 4, v7
    v_add_u32 v231, v9, v7
    v_lshl_add_u32 v232, v3, 3, v9
    v_lshlrev_b32 v233, 4, v3
    v_add_u32 v9, s43, v4
    v_lshrrev_b32 v10, 4, v9
    v_mul_u32_u24 v10, 20480, v10
    v_and_b32 v11, 1, v9
    v_lshl_add_u32 v10, v11, 3, v10
    v_lshl_add_u32 v10, v3, 7, v10
    v_bfe_u32 v11, v9, 1, 3
    s_mul_i32 s26, s57, 20
    s_lshl_b32 s27, s36, 2
    s_add_u32 s27, s27, s26
    s_mul_i32 s3, s36, 16
    s_sub_u32 s3, 16, s3
    s_add_u32 s3, s3, s26
    s_add_u32 s4, s27, 0
    v_add_u32 v2, s4, v3
    v_bfe_u32 v2, v2, 1, 3
    v_xor_b32 v2, v2, v11
    v_lshl_add_u32 v2, v2, 4, v10
    s_lshl_b32 s4, s4, 7
    v_add_u32 v235, s4, v2
    s_add_u32 s4, s27, 4
    v_add_u32 v2, s4, v3
    v_bfe_u32 v2, v2, 1, 3
    v_xor_b32 v2, v2, v11
    v_lshl_add_u32 v2, v2, 4, v10
    s_lshl_b32 s4, s4, 7
    v_add_u32 v236, s4, v2
    s_add_u32 s4, s27, 8
    v_add_u32 v2, s4, v3
    v_bfe_u32 v2, v2, 1, 3
    v_xor_b32 v2, v2, v11
    v_lshl_add_u32 v2, v2, 4, v10
    s_lshl_b32 s4, s4, 7
    v_add_u32 v237, s4, v2
    s_add_u32 s4, s27, 12
    v_add_u32 v2, s4, v3
    v_bfe_u32 v2, v2, 1, 3
    v_xor_b32 v2, v2, v11
    v_lshl_add_u32 v2, v2, 4, v10
    s_lshl_b32 s4, s4, 7
    v_add_u32 v238, s4, v2
    s_mov_b32 s4, s3
    v_add_u32 v2, s4, v3
    v_bfe_u32 v2, v2, 1, 3
    v_xor_b32 v2, v2, v11
    v_lshl_add_u32 v2, v2, 4, v10
    s_lshl_b32 s4, s4, 7
    v_add_u32 v239, s4, v2
    s_mul_i32 s37, s57, 320
    s_add_u32 s37, s37, 8126976
    s_mul_i32 s26, s36, 256
    s_sub_u32 s26, 256, s26
    s_add_u32 s38, s37, s26
    s_lshl_b32 s26, s36, 6
    s_add_u32 s37, s37, s26
    s_mul_i32 s26, s57, 160
    s_lshl_b32 s27, s36, 5
    s_add_u32 s46, s26, s27
    s_mul_i32 s27, s36, 128
    s_sub_u32 s27, 128, s27
    s_add_u32 s49, s26, s27
    s_waitcnt vmcnt(0)
    s_lshl_b32 s26, s42, 6
    v_lshlrev_b32 v2, 4, v3
    v_add_u32 v7, 162816, v2
    v_add_u32 v2, s26, v7
    s_mul_i32 s26, s42, 384
    s_sub_u32 s26, 384, s26
    v_add_u32 v7, s26, v7
    ds_read_b128 v[88:91], v2 offset:0
    ds_read_b128 v[116:119], v2 offset:512
    ds_read_b128 v[92:95], v2 offset:64
    ds_read_b128 v[120:123], v2 offset:576
    ds_read_b128 v[96:99], v2 offset:128
    ds_read_b128 v[124:127], v2 offset:640
    ds_read_b128 v[100:103], v2 offset:192
    ds_read_b128 v[128:131], v2 offset:704
    ds_read_b128 v[104:107], v2 offset:256
    ds_read_b128 v[132:135], v2 offset:768
    ds_read_b128 v[108:111], v2 offset:320
    ds_read_b128 v[136:139], v2 offset:832
    ds_read_b128 v[112:115], v7
    ds_read_b128 v[140:143], v7 offset:512
    s_waitcnt lgkmcnt(0)
    v_pk_add_f32 v[88:89], v[88:89], v[116:117]
    v_pk_add_f32 v[90:91], v[90:91], v[118:119]
    v_pk_add_f32 v[92:93], v[92:93], v[120:121]
    v_pk_add_f32 v[94:95], v[94:95], v[122:123]
    v_pk_add_f32 v[96:97], v[96:97], v[124:125]
    v_pk_add_f32 v[98:99], v[98:99], v[126:127]
    v_pk_add_f32 v[100:101], v[100:101], v[128:129]
    v_pk_add_f32 v[102:103], v[102:103], v[130:131]
    v_pk_add_f32 v[104:105], v[104:105], v[132:133]
    v_pk_add_f32 v[106:107], v[106:107], v[134:135]
    v_pk_add_f32 v[108:109], v[108:109], v[136:137]
    v_pk_add_f32 v[110:111], v[110:111], v[138:139]
    v_pk_add_f32 v[112:113], v[112:113], v[140:141]
    v_pk_add_f32 v[114:115], v[114:115], v[142:143]
    v_mov_b32 v12, v8
    v_add_u32 v13, 0x10000, v8
    v_add_u32 v14, 0x20000, v8
    ds_read_b128 a[160:163], v12 offset:0
    ds_read_b128 a[164:167], v12 offset:1024
    ds_read_b128 a[168:171], v12 offset:2048
    ds_read_b128 a[172:175], v12 offset:3072
    ds_read_b128 a[176:179], v13 offset:57344
    ds_read_b128 a[180:183], v12 offset:4096
    ds_read_b128 a[184:187], v12 offset:5120
    ds_read_b128 a[188:191], v12 offset:6144
    ds_read_b128 a[192:195], v12 offset:7168
    ds_read_b128 a[196:199], v13 offset:58368
    ds_read_b128 a[200:203], v12 offset:8192
    v_lshlrev_b32 v7, 7, v1
    s_mov_b32 s47, 0
    s_mov_b64 exec, 15
chain_kernel_poll5:
    buffer_load_dword v2, v7, s[28:31], s8 offen sc1
    s_add_u32 s47, s47, 1
    s_waitcnt vmcnt(0)
    v_cmp_ne_u32 vcc, 1, v2
    s_cmp_ge_u32 s47, 200000
    s_cbranch_scc1 chain_kernel_polld6
    s_cbranch_vccnz chain_kernel_poll5
chain_kernel_polld6:
    s_mov_b64 exec, -1
    buffer_load_dwordx4 a[0:3], v8, s[28:31], s6 offen offset:0 sc1
    buffer_load_dwordx4 a[4:7], v8, s[28:31], s7 offen offset:0 sc1
    buffer_load_dwordx4 a[8:11], v8, s[28:31], s6 offen offset:1024 sc1
    buffer_load_dwordx4 a[12:15], v8, s[28:31], s7 offen offset:1024 sc1
    buffer_load_dwordx4 a[16:19], v8, s[28:31], s6 offen offset:2048 sc1
    buffer_load_dwordx4 a[20:23], v8, s[28:31], s7 offen offset:2048 sc1
    buffer_load_dwordx4 a[24:27], v8, s[28:31], s6 offen offset:3072 sc1
    buffer_load_dwordx4 a[28:31], v8, s[28:31], s7 offen offset:3072 sc1
    s_add_u32 s6, s6, 4096
    s_add_u32 s7, s7, 4096
    buffer_load_dwordx4 a[32:35], v8, s[28:31], s6 offen offset:0 sc1
    buffer_load_dwordx4 a[36:39], v8, s[28:31], s7 offen offset:0 sc1
    s_waitcnt vmcnt(8) lgkmcnt(6)
    v_mfma_f32_16x16x32_bf16 v[32:35], a[160:163], a[0:3], 0
    v_mfma_f32_16x16x32_bf16 v[60:63], a[160:163], a[4:7], 0
    ds_read_b128 a[204:207], v12 offset:9216
    buffer_load_dwordx4 a[40:43], v8, s[28:31], s6 offen offset:1024 sc1
    v_mfma_f32_16x16x32_bf16 v[36:39], a[164:167], a[0:3], 0
    v_mfma_f32_16x16x32_bf16 v[64:67], a[164:167], a[4:7], 0
    ds_read_b128 a[160:163], v12 offset:10240
    v_mfma_f32_16x16x32_bf16 v[40:43], a[168:171], a[0:3], 0
    v_mfma_f32_16x16x32_bf16 v[68:71], a[168:171], a[4:7], 0
    ds_read_b128 a[164:167], v12 offset:11264
    buffer_load_dwordx4 a[44:47], v8, s[28:31], s7 offen offset:1024 sc1
    v_mfma_f32_16x16x32_bf16 v[44:47], a[172:175], a[0:3], 0
    v_mfma_f32_16x16x32_bf16 v[72:75], a[172:175], a[4:7], 0
    ds_read_b128 a[168:171], v13 offset:59392
    v_mfma_f32_16x16x32_bf16 v[56:59], a[176:179], a[0:3], 0
    v_mfma_f32_16x16x32_bf16 v[84:87], a[176:179], a[4:7], 0
    ds_read_b128 a[172:175], v12 offset:12288
    s_waitcnt vmcnt(8) lgkmcnt(6)
    v_mfma_f32_16x16x32_bf16 v[32:35], a[180:183], a[8:11], v[32:35]
    v_mfma_f32_16x16x32_bf16 v[60:63], a[180:183], a[12:15], v[60:63]
    ds_read_b128 a[176:179], v12 offset:13312
    buffer_load_dwordx4 a[48:51], v8, s[28:31], s6 offen offset:2048 sc1
    v_mfma_f32_16x16x32_bf16 v[36:39], a[184:187], a[8:11], v[36:39]
    v_mfma_f32_16x16x32_bf16 v[64:67], a[184:187], a[12:15], v[64:67]
    ds_read_b128 a[180:183], v12 offset:14336
    v_mfma_f32_16x16x32_bf16 v[40:43], a[188:191], a[8:11], v[40:43]
    v_mfma_f32_16x16x32_bf16 v[68:71], a[188:191], a[12:15], v[68:71]
    ds_read_b128 a[184:187], v12 offset:15360
    buffer_load_dwordx4 a[52:55], v8, s[28:31], s7 offen offset:2048 sc1
    v_mfma_f32_16x16x32_bf16 v[44:47], a[192:195], a[8:11], v[44:47]
    v_mfma_f32_16x16x32_bf16 v[72:75], a[192:195], a[12:15], v[72:75]
    ds_read_b128 a[188:191], v13 offset:60416
    v_mfma_f32_16x16x32_bf16 v[56:59], a[196:199], a[8:11], v[56:59]
    v_mfma_f32_16x16x32_bf16 v[84:87], a[196:199], a[12:15], v[84:87]
    ds_read_b128 a[192:195], v12 offset:16384
    s_waitcnt vmcnt(8) lgkmcnt(6)
    v_mfma_f32_16x16x32_bf16 v[32:35], a[200:203], a[16:19], v[32:35]
    v_mfma_f32_16x16x32_bf16 v[60:63], a[200:203], a[20:23], v[60:63]
    ds_read_b128 a[196:199], v12 offset:17408
    buffer_load_dwordx4 a[56:59], v8, s[28:31], s6 offen offset:3072 sc1
    v_mfma_f32_16x16x32_bf16 v[36:39], a[204:207], a[16:19], v[36:39]
    v_mfma_f32_16x16x32_bf16 v[64:67], a[204:207], a[20:23], v[64:67]
    ds_read_b128 a[200:203], v12 offset:18432
    v_mfma_f32_16x16x32_bf16 v[40:43], a[160:163], a[16:19], v[40:43]
    v_mfma_f32_16x16x32_bf16 v[68:71], a[160:163], a[20:23], v[68:71]
    ds_read_b128 a[204:207], v12 offset:19456
    buffer_load_dwordx4 a[60:63], v8, s[28:31], s7 offen offset:3072 sc1
    v_mfma_f32_16x16x32_bf16 v[44:47], a[164:167], a[16:19], v[44:47]
    v_mfma_f32_16x16x32_bf16 v[72:75], a[164:167], a[20:23], v[72:75]
    ds_read_b128 a[160:163], v13 offset:61440
    v_mfma_f32_16x16x32_bf16 v[56:59], a[168:171], a[16:19], v[56:59]
    v_mfma_f32_16x16x32_bf16 v[84:87], a[168:171], a[20:23], v[84:87]
    ds_read_b128 a[164:167], v12 offset:20480
    s_waitcnt vmcnt(8) lgkmcnt(6)
    v_mfma_f32_16x16x32_bf16 v[32:35], a[172:175], a[24:27], v[32:35]
    v_mfma_f32_16x16x32_bf16 v[60:63], a[172:175], a[28:31], v[60:63]
    ds_read_b128 a[168:171], v12 offset:21504
    s_add_u32 s6, s6, 4096
    s_add_u32 s7, s7, 4096
    buffer_load_dwordx4 a[64:67], v8, s[28:31], s6 offen offset:0 sc1
    v_mfma_f32_16x16x32_bf16 v[36:39], a[176:179], a[24:27], v[36:39]
    v_mfma_f32_16x16x32_bf16 v[64:67], a[176:179], a[28:31], v[64:67]
    ds_read_b128 a[172:175], v12 offset:22528
    v_mfma_f32_16x16x32_bf16 v[40:43], a[180:183], a[24:27], v[40:43]
    v_mfma_f32_16x16x32_bf16 v[68:71], a[180:183], a[28:31], v[68:71]
    ds_read_b128 a[176:179], v12 offset:23552
    buffer_load_dwordx4 a[68:71], v8, s[28:31], s7 offen offset:0 sc1
    v_mfma_f32_16x16x32_bf16 v[44:47], a[184:187], a[24:27], v[44:47]
    v_mfma_f32_16x16x32_bf16 v[72:75], a[184:187], a[28:31], v[72:75]
    ds_read_b128 a[180:183], v13 offset:62464
    v_mfma_f32_16x16x32_bf16 v[56:59], a[188:191], a[24:27], v[56:59]
    v_mfma_f32_16x16x32_bf16 v[84:87], a[188:191], a[28:31], v[84:87]
    ds_read_b128 a[184:187], v12 offset:24576
    s_waitcnt vmcnt(8) lgkmcnt(6)
    v_mfma_f32_16x16x32_bf16 v[32:35], a[192:195], a[32:35], v[32:35]
    v_mfma_f32_16x16x32_bf16 v[60:63], a[192:195], a[36:39], v[60:63]
    ds_read_b128 a[188:191], v12 offset:25600
    buffer_load_dwordx4 a[72:75], v8, s[28:31], s6 offen offset:1024 sc1
    v_mfma_f32_16x16x32_bf16 v[36:39], a[196:199], a[32:35], v[36:39]
    v_mfma_f32_16x16x32_bf16 v[64:67], a[196:199], a[36:39], v[64:67]
    ds_read_b128 a[192:195], v12 offset:26624
    v_mfma_f32_16x16x32_bf16 v[40:43], a[200:203], a[32:35], v[40:43]
    v_mfma_f32_16x16x32_bf16 v[68:71], a[200:203], a[36:39], v[68:71]
    ds_read_b128 a[196:199], v12 offset:27648
    buffer_load_dwordx4 a[76:79], v8, s[28:31], s7 offen offset:1024 sc1
    v_mfma_f32_16x16x32_bf16 v[44:47], a[204:207], a[32:35], v[44:47]
    v_mfma_f32_16x16x32_bf16 v[72:75], a[204:207], a[36:39], v[72:75]
    ds_read_b128 a[200:203], v13 offset:63488
    v_mfma_f32_16x16x32_bf16 v[56:59], a[160:163], a[32:35], v[56:59]
    v_mfma_f32_16x16x32_bf16 v[84:87], a[160:163], a[36:39], v[84:87]
    ds_read_b128 a[204:207], v12 offset:28672
    s_waitcnt vmcnt(8) lgkmcnt(6)
    v_mfma_f32_16x16x32_bf16 v[32:35], a[164:167], a[40:43], v[32:35]
    v_mfma_f32_16x16x32_bf16 v[60:63], a[164:167], a[44:47], v[60:63]
    ds_read_b128 a[160:163], v12 offset:29696
    buffer_load_dwordx4 a[80:83], v8, s[28:31], s6 offen offset:2048 sc1
    v_mfma_f32_16x16x32_bf16 v[36:39], a[168:171], a[40:43], v[36:39]
    v_mfma_f32_16x16x32_bf16 v[64:67], a[168:171], a[44:47], v[64:67]
    ds_read_b128 a[164:167], v12 offset:30720
    v_mfma_f32_16x16x32_bf16 v[40:43], a[172:175], a[40:43], v[40:43]
    v_mfma_f32_16x16x32_bf16 v[68:71], a[172:175], a[44:47], v[68:71]
    ds_read_b128 a[168:171], v12 offset:31744
    buffer_load_dwordx4 a[84:87], v8, s[28:31], s7 offen offset:2048 sc1
    v_mfma_f32_16x16x32_bf16 v[44:47], a[176:179], a[40:43], v[44:47]
    v_mfma_f32_16x16x32_bf16 v[72:75], a[176:179], a[44:47], v[72:75]
    ds_read_b128 a[172:175], v13 offset:64512
    v_mfma_f32_16x16x32_bf16 v[56:59], a[180:183], a[40:43], v[56:59]
    v_mfma_f32_16x16x32_bf16 v[84:87], a[180:183], a[44:47], v[84:87]
    ds_read_b128 a[176:179], v12 offset:32768
    s_waitcnt vmcnt(8) lgkmcnt(6)
    v_mfma_f32_16x16x32_bf16 v[32:35], a[184:187], a[48:51], v[32:35]
    v_mfma_f32_16x16x32_bf16 v[60:63], a[184:187], a[52:55], v[60:63]
    ds_read_b128 a[180:183], v12 offset:33792
    buffer_load_dwordx4 a[88:91], v8, s[28:31], s6 offen offset:3072 sc1
    v_mfma_f32_16x16x32_bf16 v[36:39], a[188:191], a[48:51], v[36:39]
    v_mfma_f32_16x16x32_bf16 v[64:67], a[188:191], a[52:55], v[64:67]
    ds_read_b128 a[184:187], v12 offset:34816
    v_mfma_f32_16x16x32_bf16 v[40:43], a[192:195], a[48:51], v[40:43]
    v_mfma_f32_16x16x32_bf16 v[68:71], a[192:195], a[52:55], v[68:71]
    ds_read_b128 a[188:191], v12 offset:35840
    buffer_load_dwordx4 a[92:95], v8, s[28:31], s7 offen offset:3072 sc1
    v_mfma_f32_16x16x32_bf16 v[44:47], a[196:199], a[48:51], v[44:47]
    v_mfma_f32_16x16x32_bf16 v[72:75], a[196:199], a[52:55], v[72:75]
    ds_read_b128 a[192:195], v14 offset:0
    v_mfma_f32_16x16x32_bf16 v[56:59], a[200:203], a[48:51], v[56:59]
    v_mfma_f32_16x16x32_bf16 v[84:87], a[200:203], a[52:55], v[84:87]
    ds_read_b128 a[196:199], v12 offset:36864
    s_waitcnt vmcnt(8) lgkmcnt(6)
    v_mfma_f32_16x16x32_bf16 v[32:35], a[204:207], a[56:59], v[32:35]
    v_mfma_f32_16x16x32_bf16 v[60:63], a[204:207], a[60:63], v[60:63]
    ds_read_b128 a[200:203], v12 offset:37888
    s_add_u32 s6, s6, 4096
    s_add_u32 s7, s7, 4096
    buffer_load_dwordx4 a[96:99], v8, s[28:31], s6 offen offset:0 sc1
    v_mfma_f32_16x16x32_bf16 v[36:39], a[160:163], a[56:59], v[36:39]
    v_mfma_f32_16x16x32_bf16 v[64:67], a[160:163], a[60:63], v[64:67]
    ds_read_b128 a[204:207], v12 offset:38912
    v_mfma_f32_16x16x32_bf16 v[40:43], a[164:167], a[56:59], v[40:43]
    v_mfma_f32_16x16x32_bf16 v[68:71], a[164:167], a[60:63], v[68:71]
    ds_read_b128 a[160:163], v12 offset:39936
    buffer_load_dwordx4 a[100:103], v8, s[28:31], s7 offen offset:0 sc1
    v_mfma_f32_16x16x32_bf16 v[44:47], a[168:171], a[56:59], v[44:47]
    v_mfma_f32_16x16x32_bf16 v[72:75], a[168:171], a[60:63], v[72:75]
    ds_read_b128 a[164:167], v14 offset:1024
    v_mfma_f32_16x16x32_bf16 v[56:59], a[172:175], a[56:59], v[56:59]
    v_mfma_f32_16x16x32_bf16 v[84:87], a[172:175], a[60:63], v[84:87]
    ds_read_b128 a[168:171], v12 offset:40960
    s_waitcnt vmcnt(8) lgkmcnt(6)
    v_mfma_f32_16x16x32_bf16 v[32:35], a[176:179], a[64:67], v[32:35]
    v_mfma_f32_16x16x32_bf16 v[60:63], a[176:179], a[68:71], v[60:63]
    ds_read_b128 a[172:175], v12 offset:41984
    buffer_load_dwordx4 a[104:107], v8, s[28:31], s6 offen offset:1024 sc1
    v_mfma_f32_16x16x32_bf16 v[36:39], a[180:183], a[64:67], v[36:39]
    v_mfma_f32_16x16x32_bf16 v[64:67], a[180:183], a[68:71], v[64:67]
    ds_read_b128 a[176:179], v12 offset:43008
    v_mfma_f32_16x16x32_bf16 v[40:43], a[184:187], a[64:67], v[40:43]
    v_mfma_f32_16x16x32_bf16 v[68:71], a[184:187], a[68:71], v[68:71]
    ds_read_b128 a[180:183], v12 offset:44032
    buffer_load_dwordx4 a[108:111], v8, s[28:31], s7 offen offset:1024 sc1
    v_mfma_f32_16x16x32_bf16 v[44:47], a[188:191], a[64:67], v[44:47]
    v_mfma_f32_16x16x32_bf16 v[72:75], a[188:191], a[68:71], v[72:75]
    ds_read_b128 a[184:187], v14 offset:2048
    v_mfma_f32_16x16x32_bf16 v[56:59], a[192:195], a[64:67], v[56:59]
    v_mfma_f32_16x16x32_bf16 v[84:87], a[192:195], a[68:71], v[84:87]
    ds_read_b128 a[188:191], v12 offset:45056
    buffer_load_dwordx4 a[112:115], v8, s[28:31], s6 offen offset:2048 sc1
    s_waitcnt vmcnt(9) lgkmcnt(6)
    v_mfma_f32_16x16x32_bf16 v[32:35], a[196:199], a[72:75], v[32:35]
    v_mfma_f32_16x16x32_bf16 v[60:63], a[196:199], a[76:79], v[60:63]
    ds_read_b128 a[192:195], v12 offset:46080
    buffer_load_dwordx4 a[116:119], v8, s[28:31], s7 offen offset:2048 sc1
    v_mfma_f32_16x16x32_bf16 v[36:39], a[200:203], a[72:75], v[36:39]
    v_mfma_f32_16x16x32_bf16 v[64:67], a[200:203], a[76:79], v[64:67]
    ds_read_b128 a[196:199], v12 offset:47104
    v_mfma_f32_16x16x32_bf16 v[40:43], a[204:207], a[72:75], v[40:43]
    v_mfma_f32_16x16x32_bf16 v[68:71], a[204:207], a[76:79], v[68:71]
    ds_read_b128 a[200:203], v12 offset:48128
    buffer_load_dwordx4 a[120:123], v8, s[28:31], s6 offen offset:3072 sc1
    v_mfma_f32_16x16x32_bf16 v[44:47], a[160:163], a[72:75], v[44:47]
    v_mfma_f32_16x16x32_bf16 v[72:75], a[160:163], a[76:79], v[72:75]
    ds_read_b128 a[204:207], v14 offset:3072
    v_mfma_f32_16x16x32_bf16 v[56:59], a[164:167], a[72:75], v[56:59]
    v_mfma_f32_16x16x32_bf16 v[84:87], a[164:167], a[76:79], v[84:87]
    ds_read_b128 a[160:163], v12 offset:49152
    buffer_load_dwordx4 a[124:127], v8, s[28:31], s7 offen offset:3072 sc1
    s_waitcnt vmcnt(10) lgkmcnt(6)
    v_mfma_f32_16x16x32_bf16 v[32:35], a[168:171], a[80:83], v[32:35]
    v_mfma_f32_16x16x32_bf16 v[60:63], a[168:171], a[84:87], v[60:63]
    ds_read_b128 a[164:167], v12 offset:50176
    s_add_u32 s6, s6, 4096
    s_add_u32 s7, s7, 4096
    buffer_load_dwordx4 a[128:131], v8, s[28:31], s6 offen offset:0 sc1
    v_mfma_f32_16x16x32_bf16 v[36:39], a[172:175], a[80:83], v[36:39]
    v_mfma_f32_16x16x32_bf16 v[64:67], a[172:175], a[84:87], v[64:67]
    ds_read_b128 a[168:171], v12 offset:51200
    v_mfma_f32_16x16x32_bf16 v[40:43], a[176:179], a[80:83], v[40:43]
    v_mfma_f32_16x16x32_bf16 v[68:71], a[176:179], a[84:87], v[68:71]
    ds_read_b128 a[172:175], v12 offset:52224
    buffer_load_dwordx4 a[132:135], v8, s[28:31], s7 offen offset:0 sc1
    v_mfma_f32_16x16x32_bf16 v[44:47], a[180:183], a[80:83], v[44:47]
    v_mfma_f32_16x16x32_bf16 v[72:75], a[180:183], a[84:87], v[72:75]
    ds_read_b128 a[176:179], v14 offset:4096
    v_mfma_f32_16x16x32_bf16 v[56:59], a[184:187], a[80:83], v[56:59]
    v_mfma_f32_16x16x32_bf16 v[84:87], a[184:187], a[84:87], v[84:87]
    ds_read_b128 a[180:183], v12 offset:53248
    buffer_load_dwordx4 a[136:139], v8, s[28:31], s6 offen offset:1024 sc1
    s_waitcnt vmcnt(11) lgkmcnt(6)
    v_mfma_f32_16x16x32_bf16 v[32:35], a[188:191], a[88:91], v[32:35]
    v_mfma_f32_16x16x32_bf16 v[60:63], a[188:191], a[92:95], v[60:63]
    ds_read_b128 a[184:187], v12 offset:54272
    buffer_load_dwordx4 a[140:143], v8, s[28:31], s7 offen offset:1024 sc1
    v_mfma_f32_16x16x32_bf16 v[36:39], a[192:195], a[88:91], v[36:39]
    v_mfma_f32_16x16x32_bf16 v[64:67], a[192:195], a[92:95], v[64:67]
    ds_read_b128 a[188:191], v12 offset:55296
    v_mfma_f32_16x16x32_bf16 v[40:43], a[196:199], a[88:91], v[40:43]
    v_mfma_f32_16x16x32_bf16 v[68:71], a[196:199], a[92:95], v[68:71]
    ds_read_b128 a[192:195], v12 offset:56320
    buffer_load_dwordx4 a[144:147], v8, s[28:31], s6 offen offset:2048 sc1
    v_mfma_f32_16x16x32_bf16 v[44:47], a[200:203], a[88:91], v[44:47]
    v_mfma_f32_16x16x32_bf16 v[72:75], a[200:203], a[92:95], v[72:75]
    ds_read_b128 a[196:199], v14 offset:5120
    v_mfma_f32_16x16x32_bf16 v[56:59], a[204:207], a[88:91], v[56:59]
    v_mfma_f32_16x16x32_bf16 v[84:87], a[204:207], a[92:95], v[84:87]
    ds_read_b128 a[200:203], v12 offset:57344
    buffer_load_dwordx4 a[148:151], v8, s[28:31], s7 offen offset:2048 sc1
    s_waitcnt vmcnt(12) lgkmcnt(6)
    v_mfma_f32_16x16x32_bf16 v[32:35], a[160:163], a[96:99], v[32:35]
    v_mfma_f32_16x16x32_bf16 v[60:63], a[160:163], a[100:103], v[60:63]
    ds_read_b128 a[204:207], v12 offset:58368
    buffer_load_dwordx4 a[152:155], v8, s[28:31], s6 offen offset:3072 sc1
    v_mfma_f32_16x16x32_bf16 v[36:39], a[164:167], a[96:99], v[36:39]
    v_mfma_f32_16x16x32_bf16 v[64:67], a[164:167], a[100:103], v[64:67]
    ds_read_b128 a[160:163], v12 offset:59392
    v_mfma_f32_16x16x32_bf16 v[40:43], a[168:171], a[96:99], v[40:43]
    v_mfma_f32_16x16x32_bf16 v[68:71], a[168:171], a[100:103], v[68:71]
    ds_read_b128 a[164:167], v12 offset:60416
    buffer_load_dwordx4 a[156:159], v8, s[28:31], s7 offen offset:3072 sc1
    v_mfma_f32_16x16x32_bf16 v[44:47], a[172:175], a[96:99], v[44:47]
    v_mfma_f32_16x16x32_bf16 v[72:75], a[172:175], a[100:103], v[72:75]
    ds_read_b128 a[168:171], v14 offset:6144
    v_mfma_f32_16x16x32_bf16 v[56:59], a[176:179], a[96:99], v[56:59]
    v_mfma_f32_16x16x32_bf16 v[84:87], a[176:179], a[100:103], v[84:87]
    ds_read_b128 a[172:175], v12 offset:61440
    buffer_load_dwordx2 v[16:17], v228, s[28:31], s9 offen offset:0 sc1
    s_waitcnt vmcnt(13) lgkmcnt(6)
    v_mfma_f32_16x16x32_bf16 v[32:35], a[180:183], a[104:107], v[32:35]
    v_mfma_f32_16x16x32_bf16 v[60:63], a[180:183], a[108:111], v[60:63]
    ds_read_b128 a[176:179], v12 offset:62464
    buffer_load_dwordx2 v[18:19], v228, s[28:31], s9 offen offset:128 sc1
    v_mfma_f32_16x16x32_bf16 v[36:39], a[184:187], a[104:107], v[36:39]
    v_mfma_f32_16x16x32_bf16 v[64:67], a[184:187], a[108:111], v[64:67]
    ds_read_b128 a[180:183], v12 offset:63488
    v_mfma_f32_16x16x32_bf16 v[40:43], a[188:191], a[104:107], v[40:43]
    v_mfma_f32_16x16x32_bf16 v[68:71], a[188:191], a[108:111], v[68:71]
    ds_read_b128 a[184:187], v12 offset:64512
    buffer_load_dwordx2 v[20:21], v228, s[28:31], s9 offen offset:1024 sc1
    v_mfma_f32_16x16x32_bf16 v[44:47], a[192:195], a[104:107], v[44:47]
    v_mfma_f32_16x16x32_bf16 v[72:75], a[192:195], a[108:111], v[72:75]
    ds_read_b128 a[188:191], v14 offset:7168
    v_mfma_f32_16x16x32_bf16 v[56:59], a[196:199], a[104:107], v[56:59]
    v_mfma_f32_16x16x32_bf16 v[84:87], a[196:199], a[108:111], v[84:87]
    ds_read_b128 a[192:195], v13 offset:0
    buffer_load_dwordx2 v[22:23], v228, s[28:31], s9 offen offset:1152 sc1
    s_waitcnt vmcnt(14) lgkmcnt(6)
    v_mfma_f32_16x16x32_bf16 v[32:35], a[200:203], a[112:115], v[32:35]
    v_mfma_f32_16x16x32_bf16 v[60:63], a[200:203], a[116:119], v[60:63]
    ds_read_b128 a[196:199], v13 offset:1024
    s_mov_b32 s26, 5492736
    buffer_load_dwordx2 v[116:117], v235, s[28:31], s26 offen
    v_mfma_f32_16x16x32_bf16 v[36:39], a[204:207], a[112:115], v[36:39]
    v_mfma_f32_16x16x32_bf16 v[64:67], a[204:207], a[116:119], v[64:67]
    ds_read_b128 a[200:203], v13 offset:2048
    v_mfma_f32_16x16x32_bf16 v[40:43], a[160:163], a[112:115], v[40:43]
    v_mfma_f32_16x16x32_bf16 v[68:71], a[160:163], a[116:119], v[68:71]
    ds_read_b128 a[204:207], v13 offset:3072
    s_mov_b32 s26, 5492736
    buffer_load_dwordx2 v[118:119], v236, s[28:31], s26 offen
    v_mfma_f32_16x16x32_bf16 v[44:47], a[164:167], a[112:115], v[44:47]
    v_mfma_f32_16x16x32_bf16 v[72:75], a[164:167], a[116:119], v[72:75]
    ds_read_b128 a[160:163], v14 offset:8192
    v_mfma_f32_16x16x32_bf16 v[56:59], a[168:171], a[112:115], v[56:59]
    v_mfma_f32_16x16x32_bf16 v[84:87], a[168:171], a[116:119], v[84:87]
    ds_read_b128 a[164:167], v13 offset:4096
    s_mov_b32 s26, 5492736
    buffer_load_dwordx2 v[120:121], v237, s[28:31], s26 offen
    s_waitcnt vmcnt(15) lgkmcnt(6)
    v_mfma_f32_16x16x32_bf16 v[32:35], a[172:175], a[120:123], v[32:35]
    v_mfma_f32_16x16x32_bf16 v[60:63], a[172:175], a[124:127], v[60:63]
    ds_read_b128 a[168:171], v13 offset:5120
    s_mov_b32 s26, 5492736
    buffer_load_dwordx2 v[122:123], v238, s[28:31], s26 offen
    v_mfma_f32_16x16x32_bf16 v[36:39], a[176:179], a[120:123], v[36:39]
    v_mfma_f32_16x16x32_bf16 v[64:67], a[176:179], a[124:127], v[64:67]
    ds_read_b128 a[172:175], v13 offset:6144
    v_mfma_f32_16x16x32_bf16 v[40:43], a[180:183], a[120:123], v[40:43]
    v_mfma_f32_16x16x32_bf16 v[68:71], a[180:183], a[124:127], v[68:71]
    ds_read_b128 a[176:179], v13 offset:7168
    s_mov_b32 s26, 5492736
    buffer_load_dwordx2 v[124:125], v239, s[28:31], s26 offen
    v_mfma_f32_16x16x32_bf16 v[44:47], a[184:187], a[120:123], v[44:47]
    v_mfma_f32_16x16x32_bf16 v[72:75], a[184:187], a[124:127], v[72:75]
    ds_read_b128 a[180:183], v14 offset:9216
    v_mfma_f32_16x16x32_bf16 v[56:59], a[188:191], a[120:123], v[56:59]
    v_mfma_f32_16x16x32_bf16 v[84:87], a[188:191], a[124:127], v[84:87]
    ds_read_b128 a[184:187], v13 offset:8192
    buffer_load_dwordx4 v[204:207], v233, s[28:31], s37 offen offset:0
    s_waitcnt vmcnt(16) lgkmcnt(6)
    v_mfma_f32_16x16x32_bf16 v[32:35], a[192:195], a[128:131], v[32:35]
    v_mfma_f32_16x16x32_bf16 v[60:63], a[192:195], a[132:135], v[60:63]
    ds_read_b128 a[188:191], v13 offset:9216
    buffer_load_dwordx4 v[208:211], v233, s[28:31], s37 offen offset:64
    v_mfma_f32_16x16x32_bf16 v[36:39], a[196:199], a[128:131], v[36:39]
    v_mfma_f32_16x16x32_bf16 v[64:67], a[196:199], a[132:135], v[64:67]
    ds_read_b128 a[192:195], v13 offset:10240
    v_mfma_f32_16x16x32_bf16 v[40:43], a[200:203], a[128:131], v[40:43]
    v_mfma_f32_16x16x32_bf16 v[68:71], a[200:203], a[132:135], v[68:71]
    ds_read_b128 a[196:199], v13 offset:11264
    buffer_load_dwordx4 v[212:215], v233, s[28:31], s37 offen offset:128
    v_mfma_f32_16x16x32_bf16 v[44:47], a[204:207], a[128:131], v[44:47]
    v_mfma_f32_16x16x32_bf16 v[72:75], a[204:207], a[132:135], v[72:75]
    ds_read_b128 a[200:203], v14 offset:10240
    v_mfma_f32_16x16x32_bf16 v[56:59], a[160:163], a[128:131], v[56:59]
    v_mfma_f32_16x16x32_bf16 v[84:87], a[160:163], a[132:135], v[84:87]
    ds_read_b128 a[204:207], v13 offset:12288
    buffer_load_dwordx4 v[216:219], v233, s[28:31], s37 offen offset:192
    s_waitcnt vmcnt(17) lgkmcnt(6)
    v_mfma_f32_16x16x32_bf16 v[32:35], a[164:167], a[136:139], v[32:35]
    v_mfma_f32_16x16x32_bf16 v[60:63], a[164:167], a[140:143], v[60:63]
    ds_read_b128 a[160:163], v13 offset:13312
    buffer_load_dwordx4 v[220:223], v233, s[28:31], s38 offen
    v_mfma_f32_16x16x32_bf16 v[36:39], a[168:171], a[136:139], v[36:39]
    v_mfma_f32_16x16x32_bf16 v[64:67], a[168:171], a[140:143], v[64:67]
    ds_read_b128 a[164:167], v13 offset:14336
    s_mul_i32 s25, s20, 3
    s_min_u32 s25, s25, 7
    s_lshl_b32 s25, s25, 10
    s_add_u32 s62, s25, 143360
    s_add_u32 s63, s25, s59
    s_mov_b32 m0, s62
    s_add_u32 s63, s63, 0
    buffer_load_dwordx4 v8, s[28:31], s63 offen offset:0 lds
    v_mfma_f32_16x16x32_bf16 v[40:43], a[172:175], a[136:139], v[40:43]
    v_mfma_f32_16x16x32_bf16 v[68:71], a[172:175], a[140:143], v[68:71]
    ds_read_b128 a[168:171], v13 offset:15360
    v_mfma_f32_16x16x32_bf16 v[44:47], a[176:179], a[136:139], v[44:47]
    v_mfma_f32_16x16x32_bf16 v[72:75], a[176:179], a[140:143], v[72:75]
    ds_read_b128 a[172:175], v14 offset:11264
    buffer_load_dwordx4 v8, s[28:31], s63 offen offset:1024 lds
    v_mfma_f32_16x16x32_bf16 v[56:59], a[180:183], a[136:139], v[56:59]
    v_mfma_f32_16x16x32_bf16 v[84:87], a[180:183], a[140:143], v[84:87]
    ds_read_b128 a[176:179], v13 offset:16384
    s_waitcnt vmcnt(18) lgkmcnt(6)
    v_mfma_f32_16x16x32_bf16 v[32:35], a[184:187], a[144:147], v[32:35]
    v_mfma_f32_16x16x32_bf16 v[60:63], a[184:187], a[148:151], v[60:63]
    ds_read_b128 a[180:183], v13 offset:17408
    v_mfma_f32_16x16x32_bf16 v[36:39], a[188:191], a[144:147], v[36:39]
    v_mfma_f32_16x16x32_bf16 v[64:67], a[188:191], a[148:151], v[64:67]
    ds_read_b128 a[184:187], v13 offset:18432
    buffer_load_dwordx4 v8, s[28:31], s63 offen offset:2048 lds
    v_mfma_f32_16x16x32_bf16 v[40:43], a[192:195], a[144:147], v[40:43]
    v_mfma_f32_16x16x32_bf16 v[68:71], a[192:195], a[148:151], v[68:71]
    ds_read_b128 a[188:191], v13 offset:19456
    v_mfma_f32_16x16x32_bf16 v[44:47], a[196:199], a[144:147], v[44:47]
    v_mfma_f32_16x16x32_bf16 v[72:75], a[196:199], a[148:151], v[72:75]
    ds_read_b128 a[192:195], v13 offset:20480
    v_mfma_f32_16x16x32_bf16 v[56:59], a[200:203], a[144:147], v[56:59]
    v_mfma_f32_16x16x32_bf16 v[84:87], a[200:203], a[148:151], v[84:87]
    ds_read_b128 a[196:199], v13 offset:21504
    s_waitcnt vmcnt(17) lgkmcnt(6)
    v_mfma_f32_16x16x32_bf16 v[32:35], a[204:207], a[152:155], v[32:35]
    v_mfma_f32_16x16x32_bf16 v[60:63], a[204:207], a[156:159], v[60:63]
    ds_read_b128 a[200:203], v13 offset:22528
    v_mfma_f32_16x16x32_bf16 v[36:39], a[160:163], a[152:155], v[36:39]
    v_mfma_f32_16x16x32_bf16 v[64:67], a[160:163], a[156:159], v[64:67]
    ds_read_b128 a[204:207], v13 offset:23552
    v_mfma_f32_16x16x32_bf16 v[40:43], a[164:167], a[152:155], v[40:43]
    v_mfma_f32_16x16x32_bf16 v[68:71], a[164:167], a[156:159], v[68:71]
    ds_read_b128 a[160:163], v13 offset:24576
    v_mfma_f32_16x16x32_bf16 v[44:47], a[168:171], a[152:155], v[44:47]
    v_mfma_f32_16x16x32_bf16 v[72:75], a[168:171], a[156:159], v[72:75]
    ds_read_b128 a[164:167], v13 offset:25600
    v_mfma_f32_16x16x32_bf16 v[56:59], a[172:175], a[152:155], v[56:59]
    v_mfma_f32_16x16x32_bf16 v[84:87], a[172:175], a[156:159], v[84:87]
    ds_read_b128 a[168:171], v13 offset:26624
    s_waitcnt lgkmcnt(7)
    v_mfma_f32_16x16x32_bf16 v[48:51], a[176:179], a[0:3], 0
    v_mfma_f32_16x16x32_bf16 v[76:79], a[176:179], a[4:7], 0
    ds_read_b128 a[172:175], v13 offset:27648
    v_mfma_f32_16x16x32_bf16 v[52:55], a[180:183], a[0:3], 0
    v_mfma_f32_16x16x32_bf16 v[80:83], a[180:183], a[4:7], 0
    ds_read_b128 a[176:179], v13 offset:28672
    v_mfma_f32_16x16x32_bf16 v[48:51], a[184:187], a[8:11], v[48:51]
    v_mfma_f32_16x16x32_bf16 v[76:79], a[184:187], a[12:15], v[76:79]
    ds_read_b128 a[180:183], v13 offset:29696
    v_mfma_f32_16x16x32_bf16 v[52:55], a[188:191], a[8:11], v[52:55]
    v_mfma_f32_16x16x32_bf16 v[80:83], a[188:191], a[12:15], v[80:83]
    ds_read_b128 a[184:187], v13 offset:30720
    s_barrier
    s_waitcnt lgkmcnt(7)
    v_mfma_f32_16x16x32_bf16 v[48:51], a[192:195], a[16:19], v[48:51]
    v_mfma_f32_16x16x32_bf16 v[76:79], a[192:195], a[20:23], v[76:79]
    ds_read_b128 a[188:191], v13 offset:31744
    s_mul_i32 s25, s20, 20
    s_lshl_b32 s25, s25, 10
    s_add_u32 s62, s25, 0
    s_add_u32 s63, s25, s59
    s_mov_b32 m0, s62
    s_add_u32 s63, s63, 10240
    buffer_load_dwordx4 v8, s[28:31], s63 offen offset:0 lds
    v_mfma_f32_16x16x32_bf16 v[52:55], a[196:199], a[16:19], v[52:55]
    v_mfma_f32_16x16x32_bf16 v[80:83], a[196:199], a[20:23], v[80:83]
    ds_read_b128 a[192:195], v13 offset:32768
    buffer_load_dwordx4 v8, s[28:31], s63 offen offset:1024 lds
    v_mfma_f32_16x16x32_bf16 v[48:51], a[200:203], a[24:27], v[48:51]
    v_mfma_f32_16x16x32_bf16 v[76:79], a[200:203], a[28:31], v[76:79]
    ds_read_b128 a[196:199], v13 offset:33792
    buffer_load_dwordx4 v8, s[28:31], s63 offen offset:2048 lds
    v_mfma_f32_16x16x32_bf16 v[52:55], a[204:207], a[24:27], v[52:55]
    v_mfma_f32_16x16x32_bf16 v[80:83], a[204:207], a[28:31], v[80:83]
    ds_read_b128 a[200:203], v13 offset:34816
    buffer_load_dwordx4 v8, s[28:31], s63 offen offset:3072 lds
    s_waitcnt lgkmcnt(7)
    v_mfma_f32_16x16x32_bf16 v[48:51], a[160:163], a[32:35], v[48:51]
    v_mfma_f32_16x16x32_bf16 v[76:79], a[160:163], a[36:39], v[76:79]
    ds_read_b128 a[204:207], v13 offset:35840
    s_add_u32 s62, s62, 4096
    s_mov_b32 m0, s62
    s_add_u32 s63, s63, 4096
    buffer_load_dwordx4 v8, s[28:31], s63 offen offset:0 lds
    v_mfma_f32_16x16x32_bf16 v[52:55], a[164:167], a[32:35], v[52:55]
    v_mfma_f32_16x16x32_bf16 v[80:83], a[164:167], a[36:39], v[80:83]
    ds_read_b128 a[160:163], v13 offset:36864
    buffer_load_dwordx4 v8, s[28:31], s63 offen offset:1024 lds
    v_mfma_f32_16x16x32_bf16 v[48:51], a[168:171], a[40:43], v[48:51]
    v_mfma_f32_16x16x32_bf16 v[76:79], a[168:171], a[44:47], v[76:79]
    ds_read_b128 a[164:167], v13 offset:37888
    buffer_load_dwordx4 v8, s[28:31], s63 offen offset:2048 lds
    v_mfma_f32_16x16x32_bf16 v[52:55], a[172:175], a[40:43], v[52:55]
    v_mfma_f32_16x16x32_bf16 v[80:83], a[172:175], a[44:47], v[80:83]
    ds_read_b128 a[168:171], v13 offset:38912
    buffer_load_dwordx4 v8, s[28:31], s63 offen offset:3072 lds
    s_waitcnt lgkmcnt(7)
    v_mfma_f32_16x16x32_bf16 v[48:51], a[176:179], a[48:51], v[48:51]
    v_mfma_f32_16x16x32_bf16 v[76:79], a[176:179], a[52:55], v[76:79]
    ds_read_b128 a[172:175], v13 offset:39936
    s_add_u32 s62, s62, 4096
    s_mov_b32 m0, s62
    s_add_u32 s63, s63, 4096
    buffer_load_dwordx4 v8, s[28:31], s63 offen offset:0 lds
    v_mfma_f32_16x16x32_bf16 v[52:55], a[180:183], a[48:51], v[52:55]
    v_mfma_f32_16x16x32_bf16 v[80:83], a[180:183], a[52:55], v[80:83]
    ds_read_b128 a[176:179], v13 offset:40960
    buffer_load_dwordx4 v8, s[28:31], s63 offen offset:1024 lds
    v_mfma_f32_16x16x32_bf16 v[48:51], a[184:187], a[56:59], v[48:51]
    v_mfma_f32_16x16x32_bf16 v[76:79], a[184:187], a[60:63], v[76:79]
    ds_read_b128 a[180:183], v13 offset:41984
    buffer_load_dwordx4 v8, s[28:31], s63 offen offset:2048 lds
    v_mfma_f32_16x16x32_bf16 v[52:55], a[188:191], a[56:59], v[52:55]
    v_mfma_f32_16x16x32_bf16 v[80:83], a[188:191], a[60:63], v[80:83]
    ds_read_b128 a[184:187], v13 offset:43008
    buffer_load_dwordx4 v8, s[28:31], s63 offen offset:3072 lds
    s_waitcnt lgkmcnt(7)
    v_mfma_f32_16x16x32_bf16 v[48:51], a[192:195], a[64:67], v[48:51]
    v_mfma_f32_16x16x32_bf16 v[76:79], a[192:195], a[68:71], v[76:79]
    ds_read_b128 a[188:191], v13 offset:44032
    s_add_u32 s62, s62, 4096
    s_mov_b32 m0, s62
    s_add_u32 s63, s63, 4096
    buffer_load_dwordx4 v8, s[28:31], s63 offen offset:0 lds
    v_mfma_f32_16x16x32_bf16 v[52:55], a[196:199], a[64:67], v[52:55]
    v_mfma_f32_16x16x32_bf16 v[80:83], a[196:199], a[68:71], v[80:83]
    ds_read_b128 a[192:195], v13 offset:45056
    buffer_load_dwordx4 v8, s[28:31], s63 offen offset:1024 lds
    v_mfma_f32_16x16x32_bf16 v[48:51], a[200:203], a[72:75], v[48:51]
    v_mfma_f32_16x16x32_bf16 v[76:79], a[200:203], a[76:79], v[76:79]
    ds_read_b128 a[196:199], v13 offset:46080
    buffer_load_dwordx4 v8, s[28:31], s63 offen offset:2048 lds
    v_mfma_f32_16x16x32_bf16 v[52:55], a[204:207], a[72:75], v[52:55]
    v_mfma_f32_16x16x32_bf16 v[80:83], a[204:207], a[76:79], v[80:83]
    ds_read_b128 a[200:203], v13 offset:47104
    buffer_load_dwordx4 v8, s[28:31], s63 offen offset:3072 lds
    s_waitcnt lgkmcnt(7)
    v_mfma_f32_16x16x32_bf16 v[48:51], a[160:163], a[80:83], v[48:51]
    v_mfma_f32_16x16x32_bf16 v[76:79], a[160:163], a[84:87], v[76:79]
    ds_read_b128 a[204:207], v13 offset:48128
    s_add_u32 s62, s62, 4096
    s_mov_b32 m0, s62
    s_add_u32 s63, s63, 4096
    buffer_load_dwordx4 v8, s[28:31], s63 offen offset:0 lds
    v_mfma_f32_16x16x32_bf16 v[52:55], a[164:167], a[80:83], v[52:55]
    v_mfma_f32_16x16x32_bf16 v[80:83], a[164:167], a[84:87], v[80:83]
    ds_read_b128 a[160:163], v13 offset:49152
    buffer_load_dwordx4 v8, s[28:31], s63 offen offset:1024 lds
    v_mfma_f32_16x16x32_bf16 v[48:51], a[168:171], a[88:91], v[48:51]
    v_mfma_f32_16x16x32_bf16 v[76:79], a[168:171], a[92:95], v[76:79]
    ds_read_b128 a[164:167], v13 offset:50176
    buffer_load_dwordx4 v8, s[28:31], s63 offen offset:2048 lds
    v_mfma_f32_16x16x32_bf16 v[52:55], a[172:175], a[88:91], v[52:55]
    v_mfma_f32_16x16x32_bf16 v[80:83], a[172:175], a[92:95], v[80:83]
    ds_read_b128 a[168:171], v13 offset:51200
    buffer_load_dwordx4 v8, s[28:31], s63 offen offset:3072 lds
    s_waitcnt lgkmcnt(7)
    v_mfma_f32_16x16x32_bf16 v[48:51], a[176:179], a[96:99], v[48:51]
    v_mfma_f32_16x16x32_bf16 v[76:79], a[176:179], a[100:103], v[76:79]
    ds_read_b128 a[172:175], v13 offset:52224
    s_mul_i32 s25, s20, 3
    s_min_u32 s25, s25, 7
    s_lshl_b32 s25, s25, 10
    s_add_u32 s62, s25, 153600
    s_add_u32 s63, s25, s59
    s_mov_b32 m0, s62
    s_add_u32 s63, s63, 92160
    buffer_load_dwordx4 v8, s[28:31], s63 offen offset:0 lds
    v_mfma_f32_16x16x32_bf16 v[52:55], a[180:183], a[96:99], v[52:55]
    v_mfma_f32_16x16x32_bf16 v[80:83], a[180:183], a[100:103], v[80:83]
    ds_read_b128 a[176:179], v13 offset:53248
    buffer_load_dwordx4 v8, s[28:31], s63 offen offset:1024 lds
    v_mfma_f32_16x16x32_bf16 v[48:51], a[184:187], a[104:107], v[48:51]
    v_mfma_f32_16x16x32_bf16 v[76:79], a[184:187], a[108:111], v[76:79]
    ds_read_b128 a[180:183], v13 offset:54272
    buffer_load_dwordx4 v8, s[28:31], s63 offen offset:2048 lds
    v_mfma_f32_16x16x32_bf16 v[52:55], a[188:191], a[104:107], v[52:55]
    v_mfma_f32_16x16x32_bf16 v[80:83], a[188:191], a[108:111], v[80:83]
    ds_read_b128 a[184:187], v13 offset:55296
    s_mul_i32 s25, s20, 5
    s_lshl_b32 s25, s25, 10
    s_add_u32 s62, s25, 122880
    s_add_u32 s63, s25, s59
    s_mov_b32 m0, s62
    s_add_u32 s63, s63, 102400
    buffer_load_dwordx4 v8, s[28:31], s63 offen offset:0 lds
    s_waitcnt lgkmcnt(7)
    v_mfma_f32_16x16x32_bf16 v[48:51], a[192:195], a[112:115], v[48:51]
    v_mfma_f32_16x16x32_bf16 v[76:79], a[192:195], a[116:119], v[76:79]
    ds_read_b128 a[188:191], v13 offset:56320
    buffer_load_dwordx4 v8, s[28:31], s63 offen offset:1024 lds
    v_mfma_f32_16x16x32_bf16 v[52:55], a[196:199], a[112:115], v[52:55]
    v_mfma_f32_16x16x32_bf16 v[80:83], a[196:199], a[116:119], v[80:83]
    buffer_load_dwordx4 v8, s[28:31], s63 offen offset:2048 lds
    v_mfma_f32_16x16x32_bf16 v[48:51], a[200:203], a[120:123], v[48:51]
    v_mfma_f32_16x16x32_bf16 v[76:79], a[200:203], a[124:127], v[76:79]
    buffer_load_dwordx4 v8, s[28:31], s63 offen offset:3072 lds
    v_mfma_f32_16x16x32_bf16 v[52:55], a[204:207], a[120:123], v[52:55]
    v_mfma_f32_16x16x32_bf16 v[80:83], a[204:207], a[124:127], v[80:83]
    s_add_u32 s62, s62, 4096
    s_mov_b32 m0, s62
    s_add_u32 s63, s63, 4096
    buffer_load_dwordx4 v8, s[28:31], s63 offen offset:0 lds
    s_waitcnt lgkmcnt(4)
    v_mfma_f32_16x16x32_bf16 v[48:51], a[160:163], a[128:131], v[48:51]
    v_mfma_f32_16x16x32_bf16 v[76:79], a[160:163], a[132:135], v[76:79]
    v_mfma_f32_16x16x32_bf16 v[52:55], a[164:167], a[128:131], v[52:55]
    v_mfma_f32_16x16x32_bf16 v[80:83], a[164:167], a[132:135], v[80:83]
    v_mfma_f32_16x16x32_bf16 v[48:51], a[168:171], a[136:139], v[48:51]
    v_mfma_f32_16x16x32_bf16 v[76:79], a[168:171], a[140:143], v[76:79]
    v_mfma_f32_16x16x32_bf16 v[52:55], a[172:175], a[136:139], v[52:55]
    v_mfma_f32_16x16x32_bf16 v[80:83], a[172:175], a[140:143], v[80:83]
    s_waitcnt lgkmcnt(0)
    v_mfma_f32_16x16x32_bf16 v[48:51], a[176:179], a[144:147], v[48:51]
    v_mfma_f32_16x16x32_bf16 v[76:79], a[176:179], a[148:151], v[76:79]
    v_mfma_f32_16x16x32_bf16 v[52:55], a[180:183], a[144:147], v[52:55]
    v_mfma_f32_16x16x32_bf16 v[80:83], a[180:183], a[148:151], v[80:83]
    v_mfma_f32_16x16x32_bf16 v[48:51], a[184:187], a[152:155], v[48:51]
    v_mfma_f32_16x16x32_bf16 v[76:79], a[184:187], a[156:159], v[76:79]
    v_mfma_f32_16x16x32_bf16 v[52:55], a[188:191], a[152:155], v[52:55]
    v_mfma_f32_16x16x32_bf16 v[80:83], a[188:191], a[156:159], v[80:83]
    s_barrier
    s_mul_i32 s26, s22, 5120
    s_add_u32 s55, s59, s26
    s_add_u32 s55, s55, 194560
    s_waitcnt vmcnt(41)
    v_add_f32 v16, v16, v18
    v_add_f32 v17, v17, v19
    v_add_f32 v20, v20, v22
    v_add_f32 v21, v21, v23
    s_nop 0
    v_mov_b32 v24, v16
    v_mov_b32 v25, v17
    v_mov_b32 v26, v20
    v_mov_b32 v27, v21
    s_nop 1
    v_permlane32_swap_b32 v24, v16
    v_permlane32_swap_b32 v25, v17
    v_permlane32_swap_b32 v26, v20
    v_permlane32_swap_b32 v27, v21
    s_mul_i32 s25, s20, 10
    s_lshl_b32 s25, s25, 10
    s_add_u32 s62, s25, 81920
    s_add_u32 s63, s25, s59
    s_mov_b32 m0, s62
    s_add_u32 s63, s63, 122880
    buffer_load_dwordx4 v8, s[28:31], s63 offen offset:0 lds
    s_nop 1
    v_add_f32 v16, v16, v24
    v_add_f32 v17, v17, v25
    v_add_f32 v20, v20, v26
    v_add_f32 v21, v21, v27
    v_mov_b32 v24, v16
    v_mov_b32 v25, v17
    v_mov_b32 v26, v20
    v_mov_b32 v27, v21
    s_nop 1
    v_permlane16_swap_b32 v24, v16
    v_permlane16_swap_b32 v25, v17
    v_permlane16_swap_b32 v26, v20
    v_permlane16_swap_b32 v27, v21
    s_nop 1
    v_add_f32 v16, v16, v24
    buffer_load_dwordx4 v8, s[28:31], s63 offen offset:1024 lds
    v_add_f32 v17, v17, v25
    v_add_f32 v20, v20, v26
    v_add_f32 v21, v21, v27
    v_mul_f32 v16, 0x3acccccd, v16
    v_mul_f32 v20, 0x3acccccd, v20
    v_mul_f32 v17, 0x3acccccd, v17
    v_mul_f32 v21, 0x3acccccd, v21
    v_fma_f32 v17, -v16, v16, v17
    v_fma_f32 v21, -v20, v20, v21
    v_max_f32 v17, 0, v17
    v_max_f32 v21, 0, v21
    v_cvt_pk_bf16_f32 v18, v16, v17
    v_cvt_pk_bf16_f32 v22, v20, v21
    v_lshlrev_b32 v16, 16, v18
    v_lshlrev_b32 v20, 16, v22
    v_and_b32 v17, 0xffff0000, v18
    v_and_b32 v21, 0xffff0000, v22
    v_add_f32 v17, 0x3727c5ac, v17
    v_add_f32 v21, 0x3727c5ac, v21
    buffer_load_dwordx4 v8, s[28:31], s63 offen offset:2048 lds
    v_cvt_pk_bf16_f32 v18, v17, v17
    v_cvt_pk_bf16_f32 v22, v21, v21
    v_lshlrev_b32 v17, 16, v18
    v_lshlrev_b32 v21, 16, v22
    v_sqrt_f32 v17, v17
    v_sqrt_f32 v21, v21
    s_nop 0
    s_nop 0
    v_cvt_pk_bf16_f32 v18, v17, v17
    v_cvt_pk_bf16_f32 v22, v21, v21
    v_lshlrev_b32 v17, 16, v18
    v_lshlrev_b32 v21, 16, v22
    v_rcp_f32 v17, v17
    v_rcp_f32 v21, v21
    s_nop 0
    s_nop 0
    v_mul_f32 v16, v16, v17
    buffer_load_dwordx4 v8, s[28:31], s63 offen offset:3072 lds
    v_mul_f32 v20, v20, v21
    v_sub_f32 v16, 0, v16
    v_sub_f32 v20, 0, v20
    v_mov_b32 v30, 0xbdd2d3e8
    v_mov_b32 v31, 0xc0135761
    v_pk_mul_f32 v[176:177], v[88:89], v[16:17] op_sel_hi:[1,0]
    v_pk_mul_f32 v[178:179], v[90:91], v[16:17] op_sel_hi:[1,0]
    v_pk_mul_f32 v[180:181], v[92:93], v[16:17] op_sel_hi:[1,0]
    v_pk_mul_f32 v[182:183], v[94:95], v[16:17] op_sel_hi:[1,0]
    v_pk_mul_f32 v[184:185], v[96:97], v[16:17] op_sel_hi:[1,0]
    v_pk_mul_f32 v[186:187], v[98:99], v[16:17] op_sel_hi:[1,0]
    v_pk_mul_f32 v[188:189], v[100:101], v[16:17] op_sel_hi:[1,0]
    v_pk_mul_f32 v[190:191], v[102:103], v[16:17] op_sel_hi:[1,0]
    v_pk_mul_f32 v[192:193], v[104:105], v[16:17] op_sel_hi:[1,0]
    v_pk_mul_f32 v[194:195], v[106:107], v[16:17] op_sel_hi:[1,0]
    v_pk_mul_f32 v[196:197], v[108:109], v[16:17] op_sel_hi:[1,0]
    v_pk_mul_f32 v[198:199], v[110:111], v[16:17] op_sel_hi:[1,0]
    v_pk_mul_f32 v[200:201], v[112:113], v[16:17] op_sel_hi:[1,0]
    v_pk_mul_f32 v[202:203], v[114:115], v[16:17] op_sel_hi:[1,0]
    s_add_u32 s62, s62, 4096
    s_mov_b32 m0, s62
    s_add_u32 s63, s63, 4096
    buffer_load_dwordx4 v8, s[28:31], s63 offen offset:0 lds
    v_pk_fma_f32 v[32:33], v[32:33], v[16:17], v[176:177] op_sel:[0,1,0] op_sel_hi:[1,1,1]
    v_pk_fma_f32 v[34:35], v[34:35], v[16:17], v[178:179] op_sel:[0,1,0] op_sel_hi:[1,1,1]
    v_pk_fma_f32 v[36:37], v[36:37], v[16:17], v[180:181] op_sel:[0,1,0] op_sel_hi:[1,1,1]
    v_pk_fma_f32 v[38:39], v[38:39], v[16:17], v[182:183] op_sel:[0,1,0] op_sel_hi:[1,1,1]
    v_pk_fma_f32 v[40:41], v[40:41], v[16:17], v[184:185] op_sel:[0,1,0] op_sel_hi:[1,1,1]
    v_pk_fma_f32 v[42:43], v[42:43], v[16:17], v[186:187] op_sel:[0,1,0] op_sel_hi:[1,1,1]
    v_pk_fma_f32 v[44:45], v[44:45], v[16:17], v[188:189] op_sel:[0,1,0] op_sel_hi:[1,1,1]
    v_pk_fma_f32 v[46:47], v[46:47], v[16:17], v[190:191] op_sel:[0,1,0] op_sel_hi:[1,1,1]
    v_pk_fma_f32 v[48:49], v[48:49], v[16:17], v[192:193] op_sel:[0,1,0] op_sel_hi:[1,1,1]
    v_pk_fma_f32 v[50:51], v[50:51], v[16:17], v[194:195] op_sel:[0,1,0] op_sel_hi:[1,1,1]
    v_pk_fma_f32 v[52:53], v[52:53], v[16:17], v[196:197] op_sel:[0,1,0] op_sel_hi:[1,1,1]
    v_pk_fma_f32 v[54:55], v[54:55], v[16:17], v[198:199] op_sel:[0,1,0] op_sel_hi:[1,1,1]
    v_pk_fma_f32 v[56:57], v[56:57], v[16:17], v[200:201] op_sel:[0,1,0] op_sel_hi:[1,1,1]
    v_pk_fma_f32 v[58:59], v[58:59], v[16:17], v[202:203] op_sel:[0,1,0] op_sel_hi:[1,1,1]
    v_pk_mul_f32 v[176:177], v[32:33], v[32:33]
    v_pk_mul_f32 v[178:179], v[34:35], v[34:35]
    v_pk_mul_f32 v[180:181], v[36:37], v[36:37]
    v_pk_mul_f32 v[182:183], v[38:39], v[38:39]
    v_pk_mul_f32 v[184:185], v[40:41], v[40:41]
    buffer_load_dwordx4 v8, s[28:31], s63 offen offset:1024 lds
    v_pk_mul_f32 v[186:187], v[42:43], v[42:43]
    v_pk_mul_f32 v[188:189], v[44:45], v[44:45]
    v_pk_mul_f32 v[190:191], v[46:47], v[46:47]
    v_pk_mul_f32 v[192:193], v[48:49], v[48:49]
    v_pk_mul_f32 v[194:195], v[50:51], v[50:51]
    v_pk_mul_f32 v[196:197], v[52:53], v[52:53]
    v_pk_mul_f32 v[198:199], v[54:55], v[54:55]
    v_pk_mul_f32 v[200:201], v[56:57], v[56:57]
    v_pk_mul_f32 v[202:203], v[58:59], v[58:59]
    v_pk_fma_f32 v[176:177], v[176:177], v[30:31], v[30:31] op_sel:[0,0,1] op_sel_hi:[1,0,1]
    v_pk_fma_f32 v[178:179], v[178:179], v[30:31], v[30:31] op_sel:[0,0,1] op_sel_hi:[1,0,1]
    v_pk_fma_f32 v[180:181], v[180:181], v[30:31], v[30:31] op_sel:[0,0,1] op_sel_hi:[1,0,1]
    v_pk_fma_f32 v[182:183], v[182:183], v[30:31], v[30:31] op_sel:[0,0,1] op_sel_hi:[1,0,1]
    v_pk_fma_f32 v[184:185], v[184:185], v[30:31], v[30:31] op_sel:[0,0,1] op_sel_hi:[1,0,1]
    v_pk_fma_f32 v[186:187], v[186:187], v[30:31], v[30:31] op_sel:[0,0,1] op_sel_hi:[1,0,1]
    v_pk_fma_f32 v[188:189], v[188:189], v[30:31], v[30:31] op_sel:[0,0,1] op_sel_hi:[1,0,1]
    v_pk_fma_f32 v[190:191], v[190:191], v[30:31], v[30:31] op_sel:[0,0,1] op_sel_hi:[1,0,1]
    v_pk_fma_f32 v[192:193], v[192:193], v[30:31], v[30:31] op_sel:[0,0,1] op_sel_hi:[1,0,1]
    v_pk_fma_f32 v[194:195], v[194:195], v[30:31], v[30:31] op_sel:[0,0,1] op_sel_hi:[1,0,1]
    buffer_load_dwordx4 v8, s[28:31], s63 offen offset:2048 lds
    v_pk_fma_f32 v[196:197], v[196:197], v[30:31], v[30:31] op_sel:[0,0,1] op_sel_hi:[1,0,1]
    v_pk_fma_f32 v[198:199], v[198:199], v[30:31], v[30:31] op_sel:[0,0,1] op_sel_hi:[1,0,1]
    v_pk_fma_f32 v[200:201], v[200:201], v[30:31], v[30:31] op_sel:[0,0,1] op_sel_hi:[1,0,1]
    v_pk_fma_f32 v[202:203], v[202:203], v[30:31], v[30:31] op_sel:[0,0,1] op_sel_hi:[1,0,1]
    v_pk_mul_f32 v[176:177], v[176:177], v[32:33]
    v_pk_mul_f32 v[178:179], v[178:179], v[34:35]
    v_pk_mul_f32 v[180:181], v[180:181], v[36:37]
    v_pk_mul_f32 v[182:183], v[182:183], v[38:39]
    v_pk_mul_f32 v[184:185], v[184:185], v[40:41]
    v_pk_mul_f32 v[186:187], v[186:187], v[42:43]
    v_pk_mul_f32 v[188:189], v[188:189], v[44:45]
    v_pk_mul_f32 v[190:191], v[190:191], v[46:47]
    v_pk_mul_f32 v[192:193], v[192:193], v[48:49]
    v_pk_mul_f32 v[194:195], v[194:195], v[50:51]
    v_pk_mul_f32 v[196:197], v[196:197], v[52:53]
    v_pk_mul_f32 v[198:199], v[198:199], v[54:55]
    v_pk_mul_f32 v[200:201], v[200:201], v[56:57]
    v_pk_mul_f32 v[202:203], v[202:203], v[58:59]
    v_exp_f32 v176, v176
    buffer_load_dwordx4 v8, s[28:31], s63 offen offset:3072 lds
    v_exp_f32 v177, v177
    v_exp_f32 v178, v178
    v_exp_f32 v179, v179
    v_exp_f32 v180, v180
    v_exp_f32 v181, v181
    v_exp_f32 v182, v182
    v_exp_f32 v183, v183
    v_exp_f32 v184, v184
    v_exp_f32 v185, v185
    v_exp_f32 v186, v186
    s_add_u32 s62, s62, 4096
    s_mov_b32 m0, s62
    s_add_u32 s63, s63, 4096
    buffer_load_dwordx4 v8, s[28:31], s63 offen offset:0 lds
    v_exp_f32 v187, v187
    v_exp_f32 v188, v188
    v_exp_f32 v189, v189
    v_exp_f32 v190, v190
    v_exp_f32 v191, v191
    v_exp_f32 v192, v192
    v_exp_f32 v193, v193
    v_exp_f32 v194, v194
    v_exp_f32 v195, v195
    v_exp_f32 v196, v196
    buffer_load_dwordx4 v8, s[28:31], s63 offen offset:1024 lds
    v_exp_f32 v197, v197
    v_exp_f32 v198, v198
    v_exp_f32 v199, v199
    v_exp_f32 v200, v200
    v_exp_f32 v201, v201
    v_exp_f32 v202, v202
    v_exp_f32 v203, v203
    v_pk_add_f32 v[176:177], v[176:177], 1.0 op_sel_hi:[1,0]
    v_pk_add_f32 v[178:179], v[178:179], 1.0 op_sel_hi:[1,0]
    v_pk_add_f32 v[180:181], v[180:181], 1.0 op_sel_hi:[1,0]
    v_pk_add_f32 v[182:183], v[182:183], 1.0 op_sel_hi:[1,0]
    v_pk_add_f32 v[184:185], v[184:185], 1.0 op_sel_hi:[1,0]
    buffer_load_dwordx4 a[96:99], v8, s[28:31], s55 offen offset:0
    v_pk_add_f32 v[186:187], v[186:187], 1.0 op_sel_hi:[1,0]
    v_pk_add_f32 v[188:189], v[188:189], 1.0 op_sel_hi:[1,0]
    v_pk_add_f32 v[190:191], v[190:191], 1.0 op_sel_hi:[1,0]
    v_pk_add_f32 v[192:193], v[192:193], 1.0 op_sel_hi:[1,0]
    v_pk_add_f32 v[194:195], v[194:195], 1.0 op_sel_hi:[1,0]
    v_pk_add_f32 v[196:197], v[196:197], 1.0 op_sel_hi:[1,0]
    v_pk_add_f32 v[198:199], v[198:199], 1.0 op_sel_hi:[1,0]
    v_pk_add_f32 v[200:201], v[200:201], 1.0 op_sel_hi:[1,0]
    v_pk_add_f32 v[202:203], v[202:203], 1.0 op_sel_hi:[1,0]
    v_rcp_f32 v176, v176
    v_rcp_f32 v177, v177
    v_rcp_f32 v178, v178
    v_rcp_f32 v179, v179
    v_rcp_f32 v180, v180
    buffer_load_dwordx4 a[100:103], v8, s[28:31], s55 offen offset:1024
    v_rcp_f32 v181, v181
    v_rcp_f32 v182, v182
    v_rcp_f32 v183, v183
    v_rcp_f32 v184, v184
    v_rcp_f32 v185, v185
    v_rcp_f32 v186, v186
    v_rcp_f32 v187, v187
    v_rcp_f32 v188, v188
    v_rcp_f32 v189, v189
    v_rcp_f32 v190, v190
    buffer_load_dwordx4 a[104:107], v8, s[28:31], s55 offen offset:2048
    v_rcp_f32 v191, v191
    v_rcp_f32 v192, v192
    v_rcp_f32 v193, v193
    v_rcp_f32 v194, v194
    v_rcp_f32 v195, v195
    v_rcp_f32 v196, v196
    v_rcp_f32 v197, v197
    v_rcp_f32 v198, v198
    v_rcp_f32 v199, v199
    v_rcp_f32 v200, v200
    buffer_load_dwordx4 a[108:111], v8, s[28:31], s55 offen offset:3072
    v_rcp_f32 v201, v201
    v_rcp_f32 v202, v202
    v_rcp_f32 v203, v203
    v_pk_mul_f32 v[32:33], v[32:33], v[176:177]
    v_pk_mul_f32 v[34:35], v[34:35], v[178:179]
    v_pk_mul_f32 v[36:37], v[36:37], v[180:181]
    v_pk_mul_f32 v[38:39], v[38:39], v[182:183]
    v_pk_mul_f32 v[40:41], v[40:41], v[184:185]
    v_pk_mul_f32 v[42:43], v[42:43], v[186:187]
    v_pk_mul_f32 v[44:45], v[44:45], v[188:189]
    v_pk_mul_f32 v[46:47], v[46:47], v[190:191]
    v_pk_mul_f32 v[48:49], v[48:49], v[192:193]
    v_pk_mul_f32 v[50:51], v[50:51], v[194:195]
    v_pk_mul_f32 v[52:53], v[52:53], v[196:197]
    v_pk_mul_f32 v[54:55], v[54:55], v[198:199]
    v_pk_mul_f32 v[56:57], v[56:57], v[200:201]
    s_add_u32 s55, s55, 4096
    buffer_load_dwordx4 a[112:115], v8, s[28:31], s55 offen offset:0
    s_add_u32 s55, s55, 6144
    v_pk_mul_f32 v[58:59], v[58:59], v[202:203]
    v_cvt_pk_bf16_f32 v144, v32, v33
    v_cvt_pk_bf16_f32 v145, v34, v35
    v_cvt_pk_bf16_f32 v146, v36, v37
    v_cvt_pk_bf16_f32 v147, v38, v39
    v_cvt_pk_bf16_f32 v148, v40, v41
    v_cvt_pk_bf16_f32 v149, v42, v43
    v_cvt_pk_bf16_f32 v150, v44, v45
    v_cvt_pk_bf16_f32 v151, v46, v47
    v_cvt_pk_bf16_f32 v152, v48, v49
    v_cvt_pk_bf16_f32 v153, v50, v51
    v_cvt_pk_bf16_f32 v154, v52, v53
    v_cvt_pk_bf16_f32 v155, v54, v55
    v_cvt_pk_bf16_f32 v156, v56, v57
    v_cvt_pk_bf16_f32 v157, v58, v59
    s_nop 1
    v_permlane16_swap_b32 v144, v146
    v_permlane16_swap_b32 v145, v147
    v_permlane16_swap_b32 v148, v150
    v_permlane16_swap_b32 v149, v151
    v_permlane16_swap_b32 v152, v154
    v_permlane16_swap_b32 v153, v155
    s_add_u32 s26, s13, 0
    s_add_u32 s27, s12, 0
    buffer_store_dwordx4 v[144:147], v226, s[28:31], s26 offen sc1
    buffer_store_dwordx2 v[156:157], v227, s[28:31], s27 offen sc1
    s_cmp_eq_u32 s52, 15
    s_cbranch_scc1 chain_kernel_j157
    buffer_store_dwordx4 v[148:151], v226, s[28:31], s26 offen offset:1024 sc1
    buffer_store_dwordx4 v[152:155], v226, s[28:31], s26 offen offset:2048 sc1
chain_kernel_j157:
    v_pk_mul_f32 v[176:177], v[88:89], v[20:21] op_sel_hi:[1,0]
    buffer_load_dwordx4 a[116:119], v8, s[28:31], s55 offen offset:0
    v_pk_mul_f32 v[178:179], v[90:91], v[20:21] op_sel_hi:[1,0]
    v_pk_mul_f32 v[180:181], v[92:93], v[20:21] op_sel_hi:[1,0]
    v_pk_mul_f32 v[182:183], v[94:95], v[20:21] op_sel_hi:[1,0]
    v_pk_mul_f32 v[184:185], v[96:97], v[20:21] op_sel_hi:[1,0]
    v_pk_mul_f32 v[186:187], v[98:99], v[20:21] op_sel_hi:[1,0]
    v_pk_mul_f32 v[188:189], v[100:101], v[20:21] op_sel_hi:[1,0]
    v_pk_mul_f32 v[190:191], v[102:103], v[20:21] op_sel_hi:[1,0]
    v_pk_mul_f32 v[192:193], v[104:105], v[20:21] op_sel_hi:[1,0]
    v_pk_mul_f32 v[194:195], v[106:107], v[20:21] op_sel_hi:[1,0]
    v_pk_mul_f32 v[196:197], v[108:109], v[20:21] op_sel_hi:[1,0]
    v_pk_mul_f32 v[198:199], v[110:111], v[20:21] op_sel_hi:[1,0]
    v_pk_mul_f32 v[200:201], v[112:113], v[20:21] op_sel_hi:[1,0]
    v_pk_mul_f32 v[202:203], v[114:115], v[20:21] op_sel_hi:[1,0]
    v_pk_fma_f32 v[60:61], v[60:61], v[20:21], v[176:177] op_sel:[0,1,0] op_sel_hi:[1,1,1]
    v_pk_fma_f32 v[62:63], v[62:63], v[20:21], v[178:179] op_sel:[0,1,0] op_sel_hi:[1,1,1]
    v_pk_fma_f32 v[64:65], v[64:65], v[20:21], v[180:181] op_sel:[0,1,0] op_sel_hi:[1,1,1]
    v_pk_fma_f32 v[66:67], v[66:67], v[20:21], v[182:183] op_sel:[0,1,0] op_sel_hi:[1,1,1]
    v_pk_fma_f32 v[68:69], v[68:69], v[20:21], v[184:185] op_sel:[0,1,0] op_sel_hi:[1,1,1]
    v_pk_fma_f32 v[70:71], v[70:71], v[20:21], v[186:187] op_sel:[0,1,0] op_sel_hi:[1,1,1]
    buffer_load_dwordx4 a[120:123], v8, s[28:31], s55 offen offset:1024
    v_pk_fma_f32 v[72:73], v[72:73], v[20:21], v[188:189] op_sel:[0,1,0] op_sel_hi:[1,1,1]
    v_pk_fma_f32 v[74:75], v[74:75], v[20:21], v[190:191] op_sel:[0,1,0] op_sel_hi:[1,1,1]
    v_pk_fma_f32 v[76:77], v[76:77], v[20:21], v[192:193] op_sel:[0,1,0] op_sel_hi:[1,1,1]
    v_pk_fma_f32 v[78:79], v[78:79], v[20:21], v[194:195] op_sel:[0,1,0] op_sel_hi:[1,1,1]
    v_pk_fma_f32 v[80:81], v[80:81], v[20:21], v[196:197] op_sel:[0,1,0] op_sel_hi:[1,1,1]
    v_pk_fma_f32 v[82:83], v[82:83], v[20:21], v[198:199] op_sel:[0,1,0] op_sel_hi:[1,1,1]
    v_pk_fma_f32 v[84:85], v[84:85], v[20:21], v[200:201] op_sel:[0,1,0] op_sel_hi:[1,1,1]
    v_pk_fma_f32 v[86:87], v[86:87], v[20:21], v[202:203] op_sel:[0,1,0] op_sel_hi:[1,1,1]
    v_pk_mul_f32 v[176:177], v[60:61], v[60:61]
    v_pk_mul_f32 v[178:179], v[62:63], v[62:63]
    v_pk_mul_f32 v[180:181], v[64:65], v[64:65]
    v_pk_mul_f32 v[182:183], v[66:67], v[66:67]
    v_pk_mul_f32 v[184:185], v[68:69], v[68:69]
    v_pk_mul_f32 v[186:187], v[70:71], v[70:71]
    v_pk_mul_f32 v[188:189], v[72:73], v[72:73]
    v_pk_mul_f32 v[190:191], v[74:75], v[74:75]
    v_pk_mul_f32 v[192:193], v[76:77], v[76:77]
    v_pk_mul_f32 v[194:195], v[78:79], v[78:79]
    v_pk_mul_f32 v[196:197], v[80:81], v[80:81]
    buffer_load_dwordx4 a[124:127], v8, s[28:31], s55 offen offset:2048
    v_pk_mul_f32 v[198:199], v[82:83], v[82:83]
    v_pk_mul_f32 v[200:201], v[84:85], v[84:85]
    v_pk_mul_f32 v[202:203], v[86:87], v[86:87]
    v_pk_fma_f32 v[176:177], v[176:177], v[30:31], v[30:31] op_sel:[0,0,1] op_sel_hi:[1,0,1]
    v_pk_fma_f32 v[178:179], v[178:179], v[30:31], v[30:31] op_sel:[0,0,1] op_sel_hi:[1,0,1]
    v_pk_fma_f32 v[180:181], v[180:181], v[30:31], v[30:31] op_sel:[0,0,1] op_sel_hi:[1,0,1]
    v_pk_fma_f32 v[182:183], v[182:183], v[30:31], v[30:31] op_sel:[0,0,1] op_sel_hi:[1,0,1]
    v_pk_fma_f32 v[184:185], v[184:185], v[30:31], v[30:31] op_sel:[0,0,1] op_sel_hi:[1,0,1]
    v_pk_fma_f32 v[186:187], v[186:187], v[30:31], v[30:31] op_sel:[0,0,1] op_sel_hi:[1,0,1]
    v_pk_fma_f32 v[188:189], v[188:189], v[30:31], v[30:31] op_sel:[0,0,1] op_sel_hi:[1,0,1]
    v_pk_fma_f32 v[190:191], v[190:191], v[30:31], v[30:31] op_sel:[0,0,1] op_sel_hi:[1,0,1]
    v_pk_fma_f32 v[192:193], v[192:193], v[30:31], v[30:31] op_sel:[0,0,1] op_sel_hi:[1,0,1]
    v_pk_fma_f32 v[194:195], v[194:195], v[30:31], v[30:31] op_sel:[0,0,1] op_sel_hi:[1,0,1]
    v_pk_fma_f32 v[196:197], v[196:197], v[30:31], v[30:31] op_sel:[0,0,1] op_sel_hi:[1,0,1]
    v_pk_fma_f32 v[198:199], v[198:199], v[30:31], v[30:31] op_sel:[0,0,1] op_sel_hi:[1,0,1]
    v_pk_fma_f32 v[200:201], v[200:201], v[30:31], v[30:31] op_sel:[0,0,1] op_sel_hi:[1,0,1]
    v_pk_fma_f32 v[202:203], v[202:203], v[30:31], v[30:31] op_sel:[0,0,1] op_sel_hi:[1,0,1]
    v_pk_mul_f32 v[176:177], v[176:177], v[60:61]
    v_pk_mul_f32 v[178:179], v[178:179], v[62:63]
    buffer_load_dwordx4 a[128:131], v8, s[28:31], s55 offen offset:3072
    v_pk_mul_f32 v[180:181], v[180:181], v[64:65]
    v_pk_mul_f32 v[182:183], v[182:183], v[66:67]
    v_pk_mul_f32 v[184:185], v[184:185], v[68:69]
    v_pk_mul_f32 v[186:187], v[186:187], v[70:71]
    v_pk_mul_f32 v[188:189], v[188:189], v[72:73]
    v_pk_mul_f32 v[190:191], v[190:191], v[74:75]
    v_pk_mul_f32 v[192:193], v[192:193], v[76:77]
    v_pk_mul_f32 v[194:195], v[194:195], v[78:79]
    v_pk_mul_f32 v[196:197], v[196:197], v[80:81]
    v_pk_mul_f32 v[198:199], v[198:199], v[82:83]
    v_pk_mul_f32 v[200:201], v[200:201], v[84:85]
    v_pk_mul_f32 v[202:203], v[202:203], v[86:87]
    v_exp_f32 v176, v176
    v_exp_f32 v177, v177
    v_exp_f32 v178, v178
    v_exp_f32 v179, v179
    s_add_u32 s55, s55, 4096
    buffer_load_dwordx4 a[132:135], v8, s[28:31], s55 offen offset:0
    s_add_u32 s55, s55, 6144
    v_exp_f32 v180, v180
    v_exp_f32 v181, v181
    v_exp_f32 v182, v182
    v_exp_f32 v183, v183
    v_exp_f32 v184, v184
    v_exp_f32 v185, v185
    v_exp_f32 v186, v186
    v_exp_f32 v187, v187
    v_exp_f32 v188, v188
    v_exp_f32 v189, v189
    buffer_load_dwordx4 a[136:139], v8, s[28:31], s55 offen offset:0
    v_exp_f32 v190, v190
    v_exp_f32 v191, v191
    v_exp_f32 v192, v192
    v_exp_f32 v193, v193
    v_exp_f32 v194, v194
    v_exp_f32 v195, v195
    v_exp_f32 v196, v196
    v_exp_f32 v197, v197
    v_exp_f32 v198, v198
    v_exp_f32 v199, v199
    buffer_load_dwordx4 a[140:143], v8, s[28:31], s55 offen offset:1024
    v_exp_f32 v200, v200
    v_exp_f32 v201, v201
    v_exp_f32 v202, v202
    v_exp_f32 v203, v203
    v_pk_add_f32 v[176:177], v[176:177], 1.0 op_sel_hi:[1,0]
    v_pk_add_f32 v[178:179], v[178:179], 1.0 op_sel_hi:[1,0]
    v_pk_add_f32 v[180:181], v[180:181], 1.0 op_sel_hi:[1,0]
    v_pk_add_f32 v[182:183], v[182:183], 1.0 op_sel_hi:[1,0]
    v_pk_add_f32 v[184:185], v[184:185], 1.0 op_sel_hi:[1,0]
    v_pk_add_f32 v[186:187], v[186:187], 1.0 op_sel_hi:[1,0]
    v_pk_add_f32 v[188:189], v[188:189], 1.0 op_sel_hi:[1,0]
    v_pk_add_f32 v[190:191], v[190:191], 1.0 op_sel_hi:[1,0]
    v_pk_add_f32 v[192:193], v[192:193], 1.0 op_sel_hi:[1,0]
    v_pk_add_f32 v[194:195], v[194:195], 1.0 op_sel_hi:[1,0]
    v_pk_add_f32 v[196:197], v[196:197], 1.0 op_sel_hi:[1,0]
    buffer_load_dwordx4 a[144:147], v8, s[28:31], s55 offen offset:2048
    v_pk_add_f32 v[198:199], v[198:199], 1.0 op_sel_hi:[1,0]
    v_pk_add_f32 v[200:201], v[200:201], 1.0 op_sel_hi:[1,0]
    v_pk_add_f32 v[202:203], v[202:203], 1.0 op_sel_hi:[1,0]
    v_rcp_f32 v176, v176
    v_rcp_f32 v177, v177
    v_rcp_f32 v178, v178
    v_rcp_f32 v179, v179
    v_rcp_f32 v180, v180
    v_rcp_f32 v181, v181
    v_rcp_f32 v182, v182
    v_rcp_f32 v183, v183
    buffer_load_dwordx4 a[148:151], v8, s[28:31], s55 offen offset:3072
    v_rcp_f32 v184, v184
    v_rcp_f32 v185, v185
    v_rcp_f32 v186, v186
    v_rcp_f32 v187, v187
    v_rcp_f32 v188, v188
    v_rcp_f32 v189, v189
    v_rcp_f32 v190, v190
    v_rcp_f32 v191, v191
    v_rcp_f32 v192, v192
    v_rcp_f32 v193, v193
    s_add_u32 s55, s55, 4096
    buffer_load_dwordx4 a[152:155], v8, s[28:31], s55 offen offset:0
    s_add_u32 s55, s55, 6144
    v_rcp_f32 v194, v194
    v_rcp_f32 v195, v195
    v_rcp_f32 v196, v196
    v_rcp_f32 v197, v197
    v_rcp_f32 v198, v198
    v_rcp_f32 v199, v199
    v_rcp_f32 v200, v200
    v_rcp_f32 v201, v201
    v_rcp_f32 v202, v202
    v_rcp_f32 v203, v203
    buffer_load_dwordx4 a[156:159], v8, s[28:31], s55 offen offset:0
    v_pk_mul_f32 v[60:61], v[60:61], v[176:177]
    v_pk_mul_f32 v[62:63], v[62:63], v[178:179]
    v_pk_mul_f32 v[64:65], v[64:65], v[180:181]
    v_pk_mul_f32 v[66:67], v[66:67], v[182:183]
    v_pk_mul_f32 v[68:69], v[68:69], v[184:185]
    v_pk_mul_f32 v[70:71], v[70:71], v[186:187]
    v_pk_mul_f32 v[72:73], v[72:73], v[188:189]
    v_pk_mul_f32 v[74:75], v[74:75], v[190:191]
    v_pk_mul_f32 v[76:77], v[76:77], v[192:193]
    v_pk_mul_f32 v[78:79], v[78:79], v[194:195]
    v_pk_mul_f32 v[80:81], v[80:81], v[196:197]
    v_pk_mul_f32 v[82:83], v[82:83], v[198:199]
    v_pk_mul_f32 v[84:85], v[84:85], v[200:201]
    v_pk_mul_f32 v[86:87], v[86:87], v[202:203]
    v_cvt_pk_bf16_f32 v160, v60, v61
    v_cvt_pk_bf16_f32 v161, v62, v63
    v_cvt_pk_bf16_f32 v162, v64, v65
    v_cvt_pk_bf16_f32 v163, v66, v67
    v_cvt_pk_bf16_f32 v164, v68, v69
    v_cvt_pk_bf16_f32 v165, v70, v71
    v_cvt_pk_bf16_f32 v166, v72, v73
    v_cvt_pk_bf16_f32 v167, v74, v75
    v_cvt_pk_bf16_f32 v168, v76, v77
    v_cvt_pk_bf16_f32 v169, v78, v79
    v_cvt_pk_bf16_f32 v170, v80, v81
    v_cvt_pk_bf16_f32 v171, v82, v83
    v_cvt_pk_bf16_f32 v172, v84, v85
    v_cvt_pk_bf16_f32 v173, v86, v87
    s_nop 1
    v_permlane16_swap_b32 v160, v162
    v_permlane16_swap_b32 v161, v163
    v_permlane16_swap_b32 v164, v166
    v_permlane16_swap_b32 v165, v167
    v_permlane16_swap_b32 v168, v170
    v_permlane16_swap_b32 v169, v171
    s_add_u32 s26, s13, 55296
    s_add_u32 s27, s12, 55296
    buffer_store_dwordx4 v[160:163], v226, s[28:31], s26 offen sc1
    buffer_store_dwordx2 v[172:173], v227, s[28:31], s27 offen sc1
    s_cmp_eq_u32 s52, 15
    s_cbranch_scc1 chain_kernel_j158
    buffer_store_dwordx4 v[164:167], v226, s[28:31], s26 offen offset:1024 sc1
    buffer_store_dwordx4 v[168:171], v226, s[28:31], s26 offen offset:2048 sc1
chain_kernel_j158:
    s_waitcnt vmcnt(0)
    v_mov_b32 v2, 1
    v_mov_b32 v7, 0
    s_mov_b64 exec, 1
    buffer_store_dword v2, v7, s[28:31], s15 offen sc1
    s_mov_b64 exec, -1
    buffer_load_dwordx4 a[160:163], v8, s[28:31], s55 offen offset:1024
    buffer_load_dwordx4 a[164:167], v8, s[28:31], s55 offen offset:2048
    buffer_load_dwordx4 a[168:171], v8, s[28:31], s55 offen offset:3072
    s_add_u32 s55, s55, 4096
    buffer_load_dwordx4 a[172:175], v8, s[28:31], s55 offen offset:0
    s_add_u32 s55, s55, 6144
    buffer_load_dwordx4 a[176:179], v8, s[28:31], s55 offen offset:0
    buffer_load_dwordx4 a[180:183], v8, s[28:31], s55 offen offset:1024
    buffer_load_dwordx4 a[184:187], v8, s[28:31], s55 offen offset:2048
    buffer_load_dwordx4 a[188:191], v8, s[28:31], s55 offen offset:3072
    s_add_u32 s55, s55, 4096
    buffer_load_dwordx4 a[192:195], v8, s[28:31], s55 offen offset:0
    s_add_u32 s55, s55, 6144
    buffer_load_dwordx4 a[196:199], v8, s[28:31], s55 offen offset:0
    buffer_load_dwordx4 a[200:203], v8, s[28:31], s55 offen offset:1024
    buffer_load_dwordx4 a[204:207], v8, s[28:31], s55 offen offset:2048
    buffer_load_dwordx4 a[208:211], v8, s[28:31], s55 offen offset:3072
    s_add_u32 s55, s55, 4096
    buffer_load_dwordx4 a[212:215], v8, s[28:31], s55 offen offset:0
    s_add_u32 s55, s55, 6144
    buffer_load_dwordx4 a[216:219], v8, s[28:31], s55 offen offset:0
    buffer_load_dwordx4 a[220:223], v8, s[28:31], s55 offen offset:1024
    buffer_load_dwordx4 a[224:227], v8, s[28:31], s55 offen offset:2048
    buffer_load_dwordx4 a[228:231], v8, s[28:31], s55 offen offset:3072
    s_add_u32 s55, s55, 4096
    buffer_load_dwordx4 a[232:235], v8, s[28:31], s55 offen offset:0
    s_add_u32 s55, s55, 6144
    buffer_load_dwordx4 a[236:239], v8, s[28:31], s55 offen offset:0
    buffer_load_dwordx4 a[240:243], v8, s[28:31], s55 offen offset:1024
    buffer_load_dwordx4 a[244:247], v8, s[28:31], s55 offen offset:2048
    buffer_load_dwordx4 a[248:251], v8, s[28:31], s55 offen offset:3072
    s_add_u32 s55, s55, 4096
    buffer_load_dwordx4 a[252:255], v8, s[28:31], s55 offen offset:0
    s_add_u32 s55, s55, 6144
    s_mul_i32 s26, s22, 5120
    v_add_u32 v12, s26, v8
    v_add_u32 v13, 0x10000, v12
    v_add_u32 v14, 0x20000, v12
    s_mov_b32 s47, 0
    s_mov_b64 exec, 511
chain_kernel_poll9:
    buffer_load_dword v2, v234, s[28:31], s48 offen sc1
    s_add_u32 s47, s47, 1
    s_waitcnt vmcnt(0)
    v_cmp_ne_u32 vcc, 1, v2
    s_cmp_ge_u32 s47, 200000
    s_cbranch_scc1 chain_kernel_polld10
    s_cbranch_vccnz chain_kernel_poll9
chain_kernel_polld10:
    s_mov_b64 exec, -1
    buffer_load_dwordx4 a[0:3], v8, s[28:31], s50 offen offset:0 sc1
    buffer_load_dwordx4 a[4:7], v8, s[28:31], s51 offen offset:0 sc1
    buffer_load_dwordx4 a[8:11], v8, s[28:31], s50 offen offset:1024 sc1
    buffer_load_dwordx4 a[12:15], v8, s[28:31], s51 offen offset:1024 sc1
    buffer_load_dwordx4 a[16:19], v8, s[28:31], s50 offen offset:2048 sc1
    buffer_load_dwordx4 a[20:23], v8, s[28:31], s51 offen offset:2048 sc1
    buffer_load_dwordx4 a[24:27], v8, s[28:31], s50 offen offset:3072 sc1
    buffer_load_dwordx4 a[28:31], v8, s[28:31], s51 offen offset:3072 sc1
    s_add_u32 s50, s50, 4096
    s_add_u32 s51, s51, 4096
    buffer_load_dwordx4 a[32:35], v8, s[28:31], s50 offen offset:0 sc1
    buffer_load_dwordx4 a[36:39], v8, s[28:31], s51 offen offset:0 sc1
    s_barrier
    ds_read_b128 v[136:139], v14 offset:12288
    ds_read_b128 v[140:143], v14 offset:13312
    ds_read_b128 v[144:147], v14 offset:14336
    ds_read_b128 v[148:151], v14 offset:15360
    ds_read_b128 v[152:155], v14 offset:16384
    ds_read_b128 v[156:159], v12 offset:0
    ds_read_b128 v[160:163], v12 offset:1024
    ds_read_b128 v[164:167], v12 offset:2048
    ds_read_b128 v[168:171], v12 offset:3072
    ds_read_b128 v[172:175], v12 offset:4096
    ds_read_b128 v[176:179], v12 offset:10240
    s_waitcnt vmcnt(8) lgkmcnt(6)
    v_mfma_f32_16x16x32_bf16 v[32:35], v[136:139], a[0:3], 0
    v_mfma_f32_16x16x32_bf16 v[52:55], v[136:139], a[4:7], 0
    ds_read_b128 v[180:183], v12 offset:11264
    buffer_load_dwordx4 a[40:43], v8, s[28:31], s50 offen offset:1024 sc1
    v_mfma_f32_16x16x32_bf16 v[36:39], v[140:143], a[0:3], 0
    v_mfma_f32_16x16x32_bf16 v[56:59], v[140:143], a[4:7], 0
    ds_read_b128 v[136:139], v12 offset:12288
    v_mfma_f32_16x16x32_bf16 v[40:43], v[144:147], a[0:3], 0
    v_mfma_f32_16x16x32_bf16 v[60:63], v[144:147], a[4:7], 0
    ds_read_b128 v[140:143], v12 offset:13312
    buffer_load_dwordx4 a[44:47], v8, s[28:31], s51 offen offset:1024 sc1
    v_mfma_f32_16x16x32_bf16 v[44:47], v[148:151], a[0:3], 0
    v_mfma_f32_16x16x32_bf16 v[64:67], v[148:151], a[4:7], 0
    ds_read_b128 v[144:147], v12 offset:14336
    v_mfma_f32_16x16x32_bf16 v[48:51], v[152:155], a[0:3], 0
    v_mfma_f32_16x16x32_bf16 v[68:71], v[152:155], a[4:7], 0
    ds_read_b128 v[148:151], v12 offset:20480
    buffer_load_dwordx4 a[48:51], v8, s[28:31], s50 offen offset:2048 sc1
    s_waitcnt vmcnt(9) lgkmcnt(6)
    v_mfma_f32_16x16x32_bf16 v[32:35], v[156:159], a[8:11], v[32:35]
    v_mfma_f32_16x16x32_bf16 v[52:55], v[156:159], a[12:15], v[52:55]
    ds_read_b128 v[152:155], v12 offset:21504
    v_mfma_f32_16x16x32_bf16 v[36:39], v[160:163], a[8:11], v[36:39]
    v_mfma_f32_16x16x32_bf16 v[56:59], v[160:163], a[12:15], v[56:59]
    ds_read_b128 v[156:159], v12 offset:22528
    buffer_load_dwordx4 a[52:55], v8, s[28:31], s51 offen offset:2048 sc1
    v_mfma_f32_16x16x32_bf16 v[40:43], v[164:167], a[8:11], v[40:43]
    v_mfma_f32_16x16x32_bf16 v[60:63], v[164:167], a[12:15], v[60:63]
    ds_read_b128 v[160:163], v12 offset:23552
    v_mfma_f32_16x16x32_bf16 v[44:47], v[168:171], a[8:11], v[44:47]
    v_mfma_f32_16x16x32_bf16 v[64:67], v[168:171], a[12:15], v[64:67]
    ds_read_b128 v[164:167], v12 offset:24576
    buffer_load_dwordx4 a[56:59], v8, s[28:31], s50 offen offset:3072 sc1
    v_mfma_f32_16x16x32_bf16 v[48:51], v[172:175], a[8:11], v[48:51]
    v_mfma_f32_16x16x32_bf16 v[68:71], v[172:175], a[12:15], v[68:71]
    s_waitcnt lgkmcnt(5)
    s_barrier
    ds_read_b128 v[168:171], v12 offset:30720
    s_mul_i32 s25, s20, 3
    s_min_u32 s25, s25, 7
    s_lshl_b32 s25, s25, 10
    s_add_u32 s62, s25, 143360
    s_add_u32 s63, s25, s59
    s_mov_b32 m0, s62
    s_add_u32 s63, s63, 163840
    buffer_load_dwordx4 v8, s[28:31], s63 offen offset:0 lds
    s_waitcnt vmcnt(10) lgkmcnt(6)
    v_mfma_f32_16x16x32_bf16 v[32:35], v[176:179], a[16:19], v[32:35]
    v_mfma_f32_16x16x32_bf16 v[52:55], v[176:179], a[20:23], v[52:55]
    ds_read_b128 v[172:175], v12 offset:31744
    buffer_load_dwordx4 v8, s[28:31], s63 offen offset:1024 lds
    v_mfma_f32_16x16x32_bf16 v[36:39], v[180:183], a[16:19], v[36:39]
    v_mfma_f32_16x16x32_bf16 v[56:59], v[180:183], a[20:23], v[56:59]
    ds_read_b128 v[176:179], v12 offset:32768
    buffer_load_dwordx4 v8, s[28:31], s63 offen offset:2048 lds
    v_mfma_f32_16x16x32_bf16 v[40:43], v[136:139], a[16:19], v[40:43]
    v_mfma_f32_16x16x32_bf16 v[60:63], v[136:139], a[20:23], v[60:63]
    ds_read_b128 v[180:183], v12 offset:33792
    s_mul_i32 s25, s20, 5
    s_lshl_b32 s25, s25, 10
    s_add_u32 s62, s25, 0
    s_add_u32 s63, s25, s59
    s_mov_b32 m0, s62
    s_add_u32 s63, s63, 174080
    buffer_load_dwordx4 v8, s[28:31], s63 offen offset:0 lds
    v_mfma_f32_16x16x32_bf16 v[44:47], v[140:143], a[16:19], v[44:47]
    v_mfma_f32_16x16x32_bf16 v[64:67], v[140:143], a[20:23], v[64:67]
    ds_read_b128 v[136:139], v12 offset:34816
    buffer_load_dwordx4 v8, s[28:31], s63 offen offset:1024 lds
    v_mfma_f32_16x16x32_bf16 v[48:51], v[144:147], a[16:19], v[48:51]
    v_mfma_f32_16x16x32_bf16 v[68:71], v[144:147], a[20:23], v[68:71]
    ds_read_b128 v[140:143], v12 offset:40960
    buffer_load_dwordx4 v8, s[28:31], s63 offen offset:2048 lds
    s_waitcnt vmcnt(13) lgkmcnt(6)
    v_mfma_f32_16x16x32_bf16 v[32:35], v[148:151], a[24:27], v[32:35]
    v_mfma_f32_16x16x32_bf16 v[52:55], v[148:151], a[28:31], v[52:55]
    ds_read_b128 v[144:147], v12 offset:41984
    buffer_load_dwordx4 v8, s[28:31], s63 offen offset:3072 lds
    v_mfma_f32_16x16x32_bf16 v[36:39], v[152:155], a[24:27], v[36:39]
    v_mfma_f32_16x16x32_bf16 v[56:59], v[152:155], a[28:31], v[56:59]
    ds_read_b128 v[148:151], v12 offset:43008
    s_add_u32 s62, s62, 4096
    s_mov_b32 m0, s62
    s_add_u32 s63, s63, 4096
    buffer_load_dwordx4 v8, s[28:31], s63 offen offset:0 lds
    v_mfma_f32_16x16x32_bf16 v[40:43], v[156:159], a[24:27], v[40:43]
    v_mfma_f32_16x16x32_bf16 v[60:63], v[156:159], a[28:31], v[60:63]
    ds_read_b128 v[152:155], v12 offset:44032
    v_mfma_f32_16x16x32_bf16 v[44:47], v[160:163], a[24:27], v[44:47]
    v_mfma_f32_16x16x32_bf16 v[64:67], v[160:163], a[28:31], v[64:67]
    ds_read_b128 v[156:159], v12 offset:45056
    buffer_load_dwordx4 a[60:63], v8, s[28:31], s51 offen offset:3072 sc1
    v_mfma_f32_16x16x32_bf16 v[48:51], v[164:167], a[24:27], v[48:51]
    v_mfma_f32_16x16x32_bf16 v[68:71], v[164:167], a[28:31], v[68:71]
    ds_read_b128 v[160:163], v12 offset:51200
    s_waitcnt vmcnt(14) lgkmcnt(6)
    v_mfma_f32_16x16x32_bf16 v[32:35], v[168:171], a[32:35], v[32:35]
    v_mfma_f32_16x16x32_bf16 v[52:55], v[168:171], a[36:39], v[52:55]
    ds_read_b128 v[164:167], v12 offset:52224
    s_add_u32 s50, s50, 4096
    s_add_u32 s51, s51, 4096
    buffer_load_dwordx4 a[64:67], v8, s[28:31], s50 offen offset:0 sc1
    v_mfma_f32_16x16x32_bf16 v[36:39], v[172:175], a[32:35], v[36:39]
    v_mfma_f32_16x16x32_bf16 v[56:59], v[172:175], a[36:39], v[56:59]
    ds_read_b128 v[168:171], v12 offset:53248
    v_mfma_f32_16x16x32_bf16 v[40:43], v[176:179], a[32:35], v[40:43]
    v_mfma_f32_16x16x32_bf16 v[60:63], v[176:179], a[36:39], v[60:63]
    ds_read_b128 v[172:175], v12 offset:54272
    buffer_load_dwordx4 a[68:71], v8, s[28:31], s51 offen offset:0 sc1
    v_mfma_f32_16x16x32_bf16 v[44:47], v[180:183], a[32:35], v[44:47]
    v_mfma_f32_16x16x32_bf16 v[64:67], v[180:183], a[36:39], v[64:67]
    ds_read_b128 v[176:179], v12 offset:55296
    v_mfma_f32_16x16x32_bf16 v[48:51], v[136:139], a[32:35], v[48:51]
    v_mfma_f32_16x16x32_bf16 v[68:71], v[136:139], a[36:39], v[68:71]
    ds_read_b128 v[180:183], v12 offset:61440
    buffer_load_dwordx4 a[72:75], v8, s[28:31], s50 offen offset:1024 sc1
    s_waitcnt vmcnt(15) lgkmcnt(6)
    v_mfma_f32_16x16x32_bf16 v[32:35], v[140:143], a[40:43], v[32:35]
    v_mfma_f32_16x16x32_bf16 v[52:55], v[140:143], a[44:47], v[52:55]
    ds_read_b128 v[136:139], v12 offset:62464
    v_mfma_f32_16x16x32_bf16 v[36:39], v[144:147], a[40:43], v[36:39]
    v_mfma_f32_16x16x32_bf16 v[56:59], v[144:147], a[44:47], v[56:59]
    ds_read_b128 v[140:143], v12 offset:63488
    buffer_load_dwordx4 a[76:79], v8, s[28:31], s51 offen offset:1024 sc1
    v_mfma_f32_16x16x32_bf16 v[40:43], v[148:151], a[40:43], v[40:43]
    v_mfma_f32_16x16x32_bf16 v[60:63], v[148:151], a[44:47], v[60:63]
    ds_read_b128 v[144:147], v12 offset:64512
    v_mfma_f32_16x16x32_bf16 v[44:47], v[152:155], a[40:43], v[44:47]
    v_mfma_f32_16x16x32_bf16 v[64:67], v[152:155], a[44:47], v[64:67]
    ds_read_b128 v[148:151], v13 offset:0
    buffer_load_dwordx4 a[80:83], v8, s[28:31], s50 offen offset:2048 sc1
    v_mfma_f32_16x16x32_bf16 v[48:51], v[156:159], a[40:43], v[48:51]
    v_mfma_f32_16x16x32_bf16 v[68:71], v[156:159], a[44:47], v[68:71]
    ds_read_b128 v[152:155], v13 offset:6144
    s_waitcnt vmcnt(15) lgkmcnt(6)
    v_mfma_f32_16x16x32_bf16 v[32:35], v[160:163], a[48:51], v[32:35]
    v_mfma_f32_16x16x32_bf16 v[52:55], v[160:163], a[52:55], v[52:55]
    ds_read_b128 v[156:159], v13 offset:7168
    buffer_load_dwordx4 a[84:87], v8, s[28:31], s51 offen offset:2048 sc1
    v_mfma_f32_16x16x32_bf16 v[36:39], v[164:167], a[48:51], v[36:39]
    v_mfma_f32_16x16x32_bf16 v[56:59], v[164:167], a[52:55], v[56:59]
    ds_read_b128 v[160:163], v13 offset:8192
    v_mfma_f32_16x16x32_bf16 v[40:43], v[168:171], a[48:51], v[40:43]
    v_mfma_f32_16x16x32_bf16 v[60:63], v[168:171], a[52:55], v[60:63]
    ds_read_b128 v[164:167], v13 offset:9216
    buffer_load_dwordx4 a[88:91], v8, s[28:31], s50 offen offset:3072 sc1
    v_mfma_f32_16x16x32_bf16 v[44:47], v[172:175], a[48:51], v[44:47]
    v_mfma_f32_16x16x32_bf16 v[64:67], v[172:175], a[52:55], v[64:67]
    ds_read_b128 v[168:171], v13 offset:10240
    v_mfma_f32_16x16x32_bf16 v[48:51], v[176:179], a[48:51], v[48:51]
    v_mfma_f32_16x16x32_bf16 v[68:71], v[176:179], a[52:55], v[68:71]
    ds_read_b128 v[172:175], v14 offset:22528
    buffer_load_dwordx4 a[92:95], v8, s[28:31], s51 offen offset:3072 sc1
    s_waitcnt vmcnt(8) lgkmcnt(6)
    v_mfma_f32_16x16x32_bf16 v[32:35], v[180:183], a[56:59], v[32:35]
    v_mfma_f32_16x16x32_bf16 v[52:55], v[180:183], a[60:63], v[52:55]
    ds_read_b128 v[176:179], v14 offset:23552
    v_mfma_f32_16x16x32_bf16 v[36:39], v[136:139], a[56:59], v[36:39]
    v_mfma_f32_16x16x32_bf16 v[56:59], v[136:139], a[60:63], v[56:59]
    ds_read_b128 v[180:183], v14 offset:24576
    s_add_u32 s50, s50, 4096
    s_add_u32 s51, s51, 4096
    buffer_load_dwordx4 a[0:3], v8, s[28:31], s50 offen offset:0 sc1
    v_mfma_f32_16x16x32_bf16 v[40:43], v[140:143], a[56:59], v[40:43]
    v_mfma_f32_16x16x32_bf16 v[60:63], v[140:143], a[60:63], v[60:63]
    ds_read_b128 v[136:139], v14 offset:25600
    v_mfma_f32_16x16x32_bf16 v[44:47], v[144:147], a[56:59], v[44:47]
    v_mfma_f32_16x16x32_bf16 v[64:67], v[144:147], a[60:63], v[64:67]
    ds_read_b128 v[140:143], v14 offset:26624
    buffer_load_dwordx4 a[4:7], v8, s[28:31], s51 offen offset:0 sc1
    v_mfma_f32_16x16x32_bf16 v[48:51], v[148:151], a[56:59], v[48:51]
    v_mfma_f32_16x16x32_bf16 v[68:71], v[148:151], a[60:63], v[68:71]
    ds_read_b128 v[144:147], v13 offset:57344
    s_waitcnt vmcnt(8) lgkmcnt(6)
    v_mfma_f32_16x16x32_bf16 v[32:35], v[152:155], a[64:67], v[32:35]
    v_mfma_f32_16x16x32_bf16 v[52:55], v[152:155], a[68:71], v[52:55]
    ds_read_b128 v[148:151], v13 offset:58368
    buffer_load_dwordx4 a[8:11], v8, s[28:31], s50 offen offset:1024 sc1
    v_mfma_f32_16x16x32_bf16 v[36:39], v[156:159], a[64:67], v[36:39]
    v_mfma_f32_16x16x32_bf16 v[56:59], v[156:159], a[68:71], v[56:59]
    ds_read_b128 v[152:155], v13 offset:59392
    buffer_load_dwordx4 a[12:15], v8, s[28:31], s51 offen offset:1024 sc1
    v_mfma_f32_16x16x32_bf16 v[40:43], v[160:163], a[64:67], v[40:43]
    v_mfma_f32_16x16x32_bf16 v[60:63], v[160:163], a[68:71], v[60:63]
    ds_read_b128 v[156:159], v13 offset:60416
    buffer_load_dwordx4 a[16:19], v8, s[28:31], s50 offen offset:2048 sc1
    v_mfma_f32_16x16x32_bf16 v[44:47], v[164:167], a[64:67], v[44:47]
    v_mfma_f32_16x16x32_bf16 v[64:67], v[164:167], a[68:71], v[64:67]
    ds_read_b128 v[160:163], v13 offset:61440
    v_mfma_f32_16x16x32_bf16 v[48:51], v[168:171], a[64:67], v[48:51]
    v_mfma_f32_16x16x32_bf16 v[68:71], v[168:171], a[68:71], v[68:71]
    ds_read_b128 v[164:167], v14 offset:2048
    buffer_load_dwordx4 a[20:23], v8, s[28:31], s51 offen offset:2048 sc1
    s_waitcnt vmcnt(10) lgkmcnt(6)
    v_mfma_f32_16x16x32_bf16 v[32:35], v[172:175], a[72:75], v[32:35]
    v_mfma_f32_16x16x32_bf16 v[52:55], v[172:175], a[76:79], v[52:55]
    ds_read_b128 v[168:171], v14 offset:3072
    s_add_u32 s26, s44, 13406208
    buffer_load_dwordx2 v[96:97], v230, s[28:31], s26 offen sc1
    v_mfma_f32_16x16x32_bf16 v[36:39], v[176:179], a[72:75], v[36:39]
    v_mfma_f32_16x16x32_bf16 v[56:59], v[176:179], a[76:79], v[56:59]
    ds_read_b128 v[172:175], v14 offset:4096
    s_add_u32 s26, s44, 13406720
    buffer_load_dwordx2 v[98:99], v230, s[28:31], s26 offen sc1
    v_mfma_f32_16x16x32_bf16 v[40:43], v[180:183], a[72:75], v[40:43]
    v_mfma_f32_16x16x32_bf16 v[60:63], v[180:183], a[76:79], v[60:63]
    ds_read_b128 v[176:179], v14 offset:5120
    v_mfma_f32_16x16x32_bf16 v[44:47], v[136:139], a[72:75], v[44:47]
    v_mfma_f32_16x16x32_bf16 v[64:67], v[136:139], a[76:79], v[64:67]
    ds_read_b128 v[180:183], v14 offset:6144
    s_add_u32 s26, s44, 13407232
    buffer_load_dwordx2 v[100:101], v230, s[28:31], s26 offen sc1
    v_mfma_f32_16x16x32_bf16 v[48:51], v[140:143], a[72:75], v[48:51]
    v_mfma_f32_16x16x32_bf16 v[68:71], v[140:143], a[76:79], v[68:71]
    ds_read_b128 v[136:139], v13 offset:16384
    s_waitcnt vmcnt(11) lgkmcnt(6)
    v_mfma_f32_16x16x32_bf16 v[32:35], v[144:147], a[80:83], v[32:35]
    v_mfma_f32_16x16x32_bf16 v[52:55], v[144:147], a[84:87], v[52:55]
    ds_read_b128 v[140:143], v13 offset:17408
    s_add_u32 s26, s44, 13407744
    buffer_load_dwordx2 v[102:103], v230, s[28:31], s26 offen sc1
    v_mfma_f32_16x16x32_bf16 v[36:39], v[148:151], a[80:83], v[36:39]
    v_mfma_f32_16x16x32_bf16 v[56:59], v[148:151], a[84:87], v[56:59]
    ds_read_b128 v[144:147], v13 offset:18432
    v_mfma_f32_16x16x32_bf16 v[40:43], v[152:155], a[80:83], v[40:43]
    v_mfma_f32_16x16x32_bf16 v[60:63], v[152:155], a[84:87], v[60:63]
    ds_read_b128 v[148:151], v13 offset:19456
    s_add_u32 s26, s45, 13406208
    buffer_load_dwordx2 v[104:105], v230, s[28:31], s26 offen sc1
    v_mfma_f32_16x16x32_bf16 v[44:47], v[156:159], a[80:83], v[44:47]
    v_mfma_f32_16x16x32_bf16 v[64:67], v[156:159], a[84:87], v[64:67]
    ds_read_b128 v[152:155], v13 offset:20480
    v_mfma_f32_16x16x32_bf16 v[48:51], v[160:163], a[80:83], v[48:51]
    v_mfma_f32_16x16x32_bf16 v[68:71], v[160:163], a[84:87], v[68:71]
    ds_read_b128 v[156:159], v13 offset:26624
    buffer_load_dwordx4 a[24:27], v8, s[28:31], s50 offen offset:3072 sc1
    s_waitcnt vmcnt(12) lgkmcnt(6)
    v_mfma_f32_16x16x32_bf16 v[32:35], v[164:167], a[88:91], v[32:35]
    v_mfma_f32_16x16x32_bf16 v[52:55], v[164:167], a[92:95], v[52:55]
    ds_read_b128 v[160:163], v13 offset:27648
    v_mfma_f32_16x16x32_bf16 v[36:39], v[168:171], a[88:91], v[36:39]
    v_mfma_f32_16x16x32_bf16 v[56:59], v[168:171], a[92:95], v[56:59]
    ds_read_b128 v[164:167], v13 offset:28672
    buffer_load_dwordx4 a[28:31], v8, s[28:31], s51 offen offset:3072 sc1
    v_mfma_f32_16x16x32_bf16 v[40:43], v[172:175], a[88:91], v[40:43]
    v_mfma_f32_16x16x32_bf16 v[60:63], v[172:175], a[92:95], v[60:63]
    ds_read_b128 v[168:171], v13 offset:29696
    v_mfma_f32_16x16x32_bf16 v[44:47], v[176:179], a[88:91], v[44:47]
    v_mfma_f32_16x16x32_bf16 v[64:67], v[176:179], a[92:95], v[64:67]
    ds_read_b128 v[172:175], v13 offset:30720
    s_add_u32 s50, s50, 4096
    s_add_u32 s51, s51, 4096
    buffer_load_dwordx4 a[32:35], v8, s[28:31], s50 offen offset:0 sc1
    v_mfma_f32_16x16x32_bf16 v[48:51], v[180:183], a[88:91], v[48:51]
    v_mfma_f32_16x16x32_bf16 v[68:71], v[180:183], a[92:95], v[68:71]
    ds_read_b128 v[176:179], v13 offset:36864
    s_waitcnt vmcnt(12) lgkmcnt(6)
    v_mfma_f32_16x16x32_bf16 v[32:35], v[136:139], a[0:3], v[32:35]
    v_mfma_f32_16x16x32_bf16 v[52:55], v[136:139], a[4:7], v[52:55]
    ds_read_b128 v[180:183], v13 offset:37888
    buffer_load_dwordx4 a[36:39], v8, s[28:31], s51 offen offset:0 sc1
    v_mfma_f32_16x16x32_bf16 v[36:39], v[140:143], a[0:3], v[36:39]
    v_mfma_f32_16x16x32_bf16 v[56:59], v[140:143], a[4:7], v[56:59]
    ds_read_b128 v[136:139], v13 offset:38912
    v_mfma_f32_16x16x32_bf16 v[40:43], v[144:147], a[0:3], v[40:43]
    v_mfma_f32_16x16x32_bf16 v[60:63], v[144:147], a[4:7], v[60:63]
    ds_read_b128 v[140:143], v13 offset:39936
    buffer_load_dwordx4 a[40:43], v8, s[28:31], s50 offen offset:1024 sc1
    v_mfma_f32_16x16x32_bf16 v[44:47], v[148:151], a[0:3], v[44:47]
    v_mfma_f32_16x16x32_bf16 v[64:67], v[148:151], a[4:7], v[64:67]
    ds_read_b128 v[144:147], v13 offset:40960
    v_mfma_f32_16x16x32_bf16 v[48:51], v[152:155], a[0:3], v[48:51]
    v_mfma_f32_16x16x32_bf16 v[68:71], v[152:155], a[4:7], v[68:71]
    ds_read_b128 v[148:151], v13 offset:47104
    buffer_load_dwordx4 a[44:47], v8, s[28:31], s51 offen offset:1024 sc1
    s_waitcnt vmcnt(13) lgkmcnt(6)
    v_mfma_f32_16x16x32_bf16 v[32:35], v[156:159], a[8:11], v[32:35]
    v_mfma_f32_16x16x32_bf16 v[52:55], v[156:159], a[12:15], v[52:55]
    ds_read_b128 v[152:155], v13 offset:48128
    v_mfma_f32_16x16x32_bf16 v[36:39], v[160:163], a[8:11], v[36:39]
    v_mfma_f32_16x16x32_bf16 v[56:59], v[160:163], a[12:15], v[56:59]
    ds_read_b128 v[156:159], v13 offset:49152
    buffer_load_dwordx4 a[48:51], v8, s[28:31], s50 offen offset:2048 sc1
    v_mfma_f32_16x16x32_bf16 v[40:43], v[164:167], a[8:11], v[40:43]
    v_mfma_f32_16x16x32_bf16 v[60:63], v[164:167], a[12:15], v[60:63]
    ds_read_b128 v[160:163], v13 offset:50176
    v_mfma_f32_16x16x32_bf16 v[44:47], v[168:171], a[8:11], v[44:47]
    v_mfma_f32_16x16x32_bf16 v[64:67], v[168:171], a[12:15], v[64:67]
    ds_read_b128 v[164:167], v13 offset:51200
    buffer_load_dwordx4 a[52:55], v8, s[28:31], s51 offen offset:2048 sc1
    v_mfma_f32_16x16x32_bf16 v[48:51], v[172:175], a[8:11], v[48:51]
    v_mfma_f32_16x16x32_bf16 v[68:71], v[172:175], a[12:15], v[68:71]
    s_barrier
    ds_read_b128 v[168:171], v14 offset:12288
    s_waitcnt vmcnt(13) lgkmcnt(6)
    v_mfma_f32_16x16x32_bf16 v[32:35], v[176:179], a[16:19], v[32:35]
    v_mfma_f32_16x16x32_bf16 v[52:55], v[176:179], a[20:23], v[52:55]
    ds_read_b128 v[172:175], v14 offset:13312
    buffer_load_dwordx4 a[56:59], v8, s[28:31], s50 offen offset:3072 sc1
    v_mfma_f32_16x16x32_bf16 v[36:39], v[180:183], a[16:19], v[36:39]
    v_mfma_f32_16x16x32_bf16 v[56:59], v[180:183], a[20:23], v[56:59]
    ds_read_b128 v[176:179], v14 offset:14336
    v_mfma_f32_16x16x32_bf16 v[40:43], v[136:139], a[16:19], v[40:43]
    v_mfma_f32_16x16x32_bf16 v[60:63], v[136:139], a[20:23], v[60:63]
    ds_read_b128 v[180:183], v14 offset:15360
    buffer_load_dwordx4 a[60:63], v8, s[28:31], s51 offen offset:3072 sc1
    v_mfma_f32_16x16x32_bf16 v[44:47], v[140:143], a[16:19], v[44:47]
    v_mfma_f32_16x16x32_bf16 v[64:67], v[140:143], a[20:23], v[64:67]
    ds_read_b128 v[136:139], v14 offset:16384
    v_mfma_f32_16x16x32_bf16 v[48:51], v[144:147], a[16:19], v[48:51]
    v_mfma_f32_16x16x32_bf16 v[68:71], v[144:147], a[20:23], v[68:71]
    ds_read_b128 v[140:143], v12 offset:0
    s_add_u32 s50, s50, 4096
    s_add_u32 s51, s51, 4096
    buffer_load_dwordx4 a[64:67], v8, s[28:31], s50 offen offset:0 sc1
    s_waitcnt vmcnt(9) lgkmcnt(6)
    v_mfma_f32_16x16x32_bf16 v[32:35], v[148:151], a[24:27], v[32:35]
    v_mfma_f32_16x16x32_bf16 v[52:55], v[148:151], a[28:31], v[52:55]
    ds_read_b128 v[144:147], v12 offset:1024
    v_mfma_f32_16x16x32_bf16 v[36:39], v[152:155], a[24:27], v[36:39]
    v_mfma_f32_16x16x32_bf16 v[56:59], v[152:155], a[28:31], v[56:59]
    ds_read_b128 v[148:151], v12 offset:2048
    buffer_load_dwordx4 a[68:71], v8, s[28:31], s51 offen offset:0 sc1
    v_mfma_f32_16x16x32_bf16 v[40:43], v[156:159], a[24:27], v[40:43]
    v_mfma_f32_16x16x32_bf16 v[60:63], v[156:159], a[28:31], v[60:63]
    ds_read_b128 v[152:155], v12 offset:3072
    v_mfma_f32_16x16x32_bf16 v[44:47], v[160:163], a[24:27], v[44:47]
    v_mfma_f32_16x16x32_bf16 v[64:67], v[160:163], a[28:31], v[64:67]
    ds_read_b128 v[156:159], v12 offset:4096
    buffer_load_dwordx4 a[72:75], v8, s[28:31], s50 offen offset:1024 sc1
    v_mfma_f32_16x16x32_bf16 v[48:51], v[164:167], a[24:27], v[48:51]
    v_mfma_f32_16x16x32_bf16 v[68:71], v[164:167], a[28:31], v[68:71]
    ds_read_b128 v[160:163], v12 offset:10240
    s_waitcnt vmcnt(9) lgkmcnt(6)
    v_mfma_f32_16x16x32_bf16 v[32:35], v[168:171], a[32:35], v[32:35]
    v_mfma_f32_16x16x32_bf16 v[52:55], v[168:171], a[36:39], v[52:55]
    ds_read_b128 v[164:167], v12 offset:11264
    buffer_load_dwordx4 a[76:79], v8, s[28:31], s51 offen offset:1024 sc1
    v_mfma_f32_16x16x32_bf16 v[36:39], v[172:175], a[32:35], v[36:39]
    v_mfma_f32_16x16x32_bf16 v[56:59], v[172:175], a[36:39], v[56:59]
    ds_read_b128 v[168:171], v12 offset:12288
    v_mfma_f32_16x16x32_bf16 v[40:43], v[176:179], a[32:35], v[40:43]
    v_mfma_f32_16x16x32_bf16 v[60:63], v[176:179], a[36:39], v[60:63]
    ds_read_b128 v[172:175], v12 offset:13312
    buffer_load_dwordx4 a[80:83], v8, s[28:31], s50 offen offset:2048 sc1
    v_mfma_f32_16x16x32_bf16 v[44:47], v[180:183], a[32:35], v[44:47]
    v_mfma_f32_16x16x32_bf16 v[64:67], v[180:183], a[36:39], v[64:67]
    ds_read_b128 v[176:179], v12 offset:14336
    v_mfma_f32_16x16x32_bf16 v[48:51], v[136:139], a[32:35], v[48:51]
    v_mfma_f32_16x16x32_bf16 v[68:71], v[136:139], a[36:39], v[68:71]
    buffer_load_dwordx4 a[84:87], v8, s[28:31], s51 offen offset:2048 sc1
    s_waitcnt vmcnt(10) lgkmcnt(5)
    v_mfma_f32_16x16x32_bf16 v[32:35], v[140:143], a[40:43], v[32:35]
    v_mfma_f32_16x16x32_bf16 v[52:55], v[140:143], a[44:47], v[52:55]
    v_mfma_f32_16x16x32_bf16 v[36:39], v[144:147], a[40:43], v[36:39]
    v_mfma_f32_16x16x32_bf16 v[56:59], v[144:147], a[44:47], v[56:59]
    buffer_load_dwordx4 a[88:91], v8, s[28:31], s50 offen offset:3072 sc1
    v_mfma_f32_16x16x32_bf16 v[40:43], v[148:151], a[40:43], v[40:43]
    v_mfma_f32_16x16x32_bf16 v[60:63], v[148:151], a[44:47], v[60:63]
    v_mfma_f32_16x16x32_bf16 v[44:47], v[152:155], a[40:43], v[44:47]
    v_mfma_f32_16x16x32_bf16 v[64:67], v[152:155], a[44:47], v[64:67]
    buffer_load_dwordx4 a[92:95], v8, s[28:31], s51 offen offset:3072 sc1
    v_mfma_f32_16x16x32_bf16 v[48:51], v[156:159], a[40:43], v[48:51]
    v_mfma_f32_16x16x32_bf16 v[68:71], v[156:159], a[44:47], v[68:71]
    s_waitcnt vmcnt(10) lgkmcnt(0)
    v_mfma_f32_16x16x32_bf16 v[32:35], v[160:163], a[48:51], v[32:35]
    v_mfma_f32_16x16x32_bf16 v[52:55], v[160:163], a[52:55], v[52:55]
    s_add_u32 s50, s50, 4096
    s_add_u32 s51, s51, 4096
    buffer_load_dwordx4 a[0:3], v8, s[28:31], s50 offen offset:0 sc1
    v_mfma_f32_16x16x32_bf16 v[36:39], v[164:167], a[48:51], v[36:39]
    v_mfma_f32_16x16x32_bf16 v[56:59], v[164:167], a[52:55], v[56:59]
    v_mfma_f32_16x16x32_bf16 v[40:43], v[168:171], a[48:51], v[40:43]
    v_mfma_f32_16x16x32_bf16 v[60:63], v[168:171], a[52:55], v[60:63]
    buffer_load_dwordx4 a[4:7], v8, s[28:31], s51 offen offset:0 sc1
    v_mfma_f32_16x16x32_bf16 v[44:47], v[172:175], a[48:51], v[44:47]
    v_mfma_f32_16x16x32_bf16 v[64:67], v[172:175], a[52:55], v[64:67]
    v_mfma_f32_16x16x32_bf16 v[48:51], v[176:179], a[48:51], v[48:51]
    v_mfma_f32_16x16x32_bf16 v[68:71], v[176:179], a[52:55], v[68:71]
    s_waitcnt vmcnt(10)
    v_mfma_f32_16x16x32_bf16 v[32:35], a[96:99], a[56:59], v[32:35]
    v_mfma_f32_16x16x32_bf16 v[52:55], a[96:99], a[60:63], v[52:55]
    v_mfma_f32_16x16x32_bf16 v[36:39], a[100:103], a[56:59], v[36:39]
    v_mfma_f32_16x16x32_bf16 v[56:59], a[100:103], a[60:63], v[56:59]
    buffer_load_dwordx4 a[8:11], v8, s[28:31], s50 offen offset:1024 sc1
    v_mfma_f32_16x16x32_bf16 v[40:43], a[104:107], a[56:59], v[40:43]
    v_mfma_f32_16x16x32_bf16 v[60:63], a[104:107], a[60:63], v[60:63]
    v_mfma_f32_16x16x32_bf16 v[44:47], a[108:111], a[56:59], v[44:47]
    v_mfma_f32_16x16x32_bf16 v[64:67], a[108:111], a[60:63], v[64:67]
    buffer_load_dwordx4 a[12:15], v8, s[28:31], s51 offen offset:1024 sc1
    v_mfma_f32_16x16x32_bf16 v[48:51], a[112:115], a[56:59], v[48:51]
    v_mfma_f32_16x16x32_bf16 v[68:71], a[112:115], a[60:63], v[68:71]
    s_waitcnt vmcnt(10)
    v_mfma_f32_16x16x32_bf16 v[32:35], a[116:119], a[64:67], v[32:35]
    v_mfma_f32_16x16x32_bf16 v[52:55], a[116:119], a[68:71], v[52:55]
    buffer_load_dwordx4 a[16:19], v8, s[28:31], s50 offen offset:2048 sc1
    v_mfma_f32_16x16x32_bf16 v[36:39], a[120:123], a[64:67], v[36:39]
    v_mfma_f32_16x16x32_bf16 v[56:59], a[120:123], a[68:71], v[56:59]
    v_mfma_f32_16x16x32_bf16 v[40:43], a[124:127], a[64:67], v[40:43]
    v_mfma_f32_16x16x32_bf16 v[60:63], a[124:127], a[68:71], v[60:63]
    buffer_load_dwordx4 a[20:23], v8, s[28:31], s51 offen offset:2048 sc1
    v_mfma_f32_16x16x32_bf16 v[44:47], a[128:131], a[64:67], v[44:47]
    v_mfma_f32_16x16x32_bf16 v[64:67], a[128:131], a[68:71], v[64:67]
    v_mfma_f32_16x16x32_bf16 v[48:51], a[132:135], a[64:67], v[48:51]
    v_mfma_f32_16x16x32_bf16 v[68:71], a[132:135], a[68:71], v[68:71]
    s_waitcnt vmcnt(10)
    v_mfma_f32_16x16x32_bf16 v[32:35], a[136:139], a[72:75], v[32:35]
    v_mfma_f32_16x16x32_bf16 v[52:55], a[136:139], a[76:79], v[52:55]
    v_mfma_f32_16x16x32_bf16 v[36:39], a[140:143], a[72:75], v[36:39]
    v_mfma_f32_16x16x32_bf16 v[56:59], a[140:143], a[76:79], v[56:59]
    v_mfma_f32_16x16x32_bf16 v[40:43], a[144:147], a[72:75], v[40:43]
    v_mfma_f32_16x16x32_bf16 v[60:63], a[144:147], a[76:79], v[60:63]
    v_mfma_f32_16x16x32_bf16 v[44:47], a[148:151], a[72:75], v[44:47]
    v_mfma_f32_16x16x32_bf16 v[64:67], a[148:151], a[76:79], v[64:67]
    v_mfma_f32_16x16x32_bf16 v[48:51], a[152:155], a[72:75], v[48:51]
    v_mfma_f32_16x16x32_bf16 v[68:71], a[152:155], a[76:79], v[68:71]
    s_waitcnt vmcnt(8)
    v_mfma_f32_16x16x32_bf16 v[32:35], a[156:159], a[80:83], v[32:35]
    v_mfma_f32_16x16x32_bf16 v[52:55], a[156:159], a[84:87], v[52:55]
    v_mfma_f32_16x16x32_bf16 v[36:39], a[160:163], a[80:83], v[36:39]
    v_mfma_f32_16x16x32_bf16 v[56:59], a[160:163], a[84:87], v[56:59]
    v_mfma_f32_16x16x32_bf16 v[40:43], a[164:167], a[80:83], v[40:43]
    v_mfma_f32_16x16x32_bf16 v[60:63], a[164:167], a[84:87], v[60:63]
    v_mfma_f32_16x16x32_bf16 v[44:47], a[168:171], a[80:83], v[44:47]
    v_mfma_f32_16x16x32_bf16 v[64:67], a[168:171], a[84:87], v[64:67]
    v_mfma_f32_16x16x32_bf16 v[48:51], a[172:175], a[80:83], v[48:51]
    v_mfma_f32_16x16x32_bf16 v[68:71], a[172:175], a[84:87], v[68:71]
    s_waitcnt vmcnt(6)
    v_mfma_f32_16x16x32_bf16 v[32:35], a[176:179], a[88:91], v[32:35]
    v_mfma_f32_16x16x32_bf16 v[52:55], a[176:179], a[92:95], v[52:55]
    v_mfma_f32_16x16x32_bf16 v[36:39], a[180:183], a[88:91], v[36:39]
    v_mfma_f32_16x16x32_bf16 v[56:59], a[180:183], a[92:95], v[56:59]
    v_mfma_f32_16x16x32_bf16 v[40:43], a[184:187], a[88:91], v[40:43]
    v_mfma_f32_16x16x32_bf16 v[60:63], a[184:187], a[92:95], v[60:63]
    v_mfma_f32_16x16x32_bf16 v[44:47], a[188:191], a[88:91], v[44:47]
    v_mfma_f32_16x16x32_bf16 v[64:67], a[188:191], a[92:95], v[64:67]
    v_mfma_f32_16x16x32_bf16 v[48:51], a[192:195], a[88:91], v[48:51]
    v_mfma_f32_16x16x32_bf16 v[68:71], a[192:195], a[92:95], v[68:71]
    s_waitcnt vmcnt(4)
    v_mfma_f32_16x16x32_bf16 v[32:35], a[196:199], a[0:3], v[32:35]
    v_mfma_f32_16x16x32_bf16 v[52:55], a[196:199], a[4:7], v[52:55]
    v_mfma_f32_16x16x32_bf16 v[36:39], a[200:203], a[0:3], v[36:39]
    v_mfma_f32_16x16x32_bf16 v[56:59], a[200:203], a[4:7], v[56:59]
    v_mfma_f32_16x16x32_bf16 v[40:43], a[204:207], a[0:3], v[40:43]
    v_mfma_f32_16x16x32_bf16 v[60:63], a[204:207], a[4:7], v[60:63]
    v_mfma_f32_16x16x32_bf16 v[44:47], a[208:211], a[0:3], v[44:47]
    v_mfma_f32_16x16x32_bf16 v[64:67], a[208:211], a[4:7], v[64:67]
    v_mfma_f32_16x16x32_bf16 v[48:51], a[212:215], a[0:3], v[48:51]
    v_mfma_f32_16x16x32_bf16 v[68:71], a[212:215], a[4:7], v[68:71]
    s_waitcnt vmcnt(2)
    v_mfma_f32_16x16x32_bf16 v[32:35], a[216:219], a[8:11], v[32:35]
    v_mfma_f32_16x16x32_bf16 v[52:55], a[216:219], a[12:15], v[52:55]
    v_mfma_f32_16x16x32_bf16 v[36:39], a[220:223], a[8:11], v[36:39]
    v_mfma_f32_16x16x32_bf16 v[56:59], a[220:223], a[12:15], v[56:59]
    v_mfma_f32_16x16x32_bf16 v[40:43], a[224:227], a[8:11], v[40:43]
    v_mfma_f32_16x16x32_bf16 v[60:63], a[224:227], a[12:15], v[60:63]
    v_mfma_f32_16x16x32_bf16 v[44:47], a[228:231], a[8:11], v[44:47]
    v_mfma_f32_16x16x32_bf16 v[64:67], a[228:231], a[12:15], v[64:67]
    v_mfma_f32_16x16x32_bf16 v[48:51], a[232:235], a[8:11], v[48:51]
    v_mfma_f32_16x16x32_bf16 v[68:71], a[232:235], a[12:15], v[68:71]
    s_waitcnt vmcnt(0)
    v_mfma_f32_16x16x32_bf16 v[32:35], a[236:239], a[16:19], v[32:35]
    v_mfma_f32_16x16x32_bf16 v[52:55], a[236:239], a[20:23], v[52:55]
    v_mfma_f32_16x16x32_bf16 v[36:39], a[240:243], a[16:19], v[36:39]
    v_mfma_f32_16x16x32_bf16 v[56:59], a[240:243], a[20:23], v[56:59]
    v_mfma_f32_16x16x32_bf16 v[40:43], a[244:247], a[16:19], v[40:43]
    v_mfma_f32_16x16x32_bf16 v[60:63], a[244:247], a[20:23], v[60:63]
    v_mfma_f32_16x16x32_bf16 v[44:47], a[248:251], a[16:19], v[44:47]
    v_mfma_f32_16x16x32_bf16 v[64:67], a[248:251], a[20:23], v[64:67]
    v_mfma_f32_16x16x32_bf16 v[48:51], a[252:255], a[16:19], v[48:51]
    v_mfma_f32_16x16x32_bf16 v[68:71], a[252:255], a[20:23], v[68:71]
    s_barrier
    s_nop 4
    ds_write_b128 v246, v[52:55] offset:0
    ds_write_b128 v246, v[56:59] offset:1024
    ds_write_b128 v246, v[60:63] offset:2048
    ds_write_b128 v246, v[64:67] offset:3072
    ds_write_b128 v246, v[68:71] offset:4096
    v_lshlrev_b32 v136, 16, v96
    v_and_b32 v137, 0xffff0000, v96
    v_lshlrev_b32 v138, 16, v97
    v_and_b32 v139, 0xffff0000, v97
    v_lshlrev_b32 v156, 16, v116
    v_and_b32 v157, 0xffff0000, v116
    v_lshlrev_b32 v158, 16, v117
    v_and_b32 v159, 0xffff0000, v117
    v_lshlrev_b32 v140, 16, v98
    v_and_b32 v141, 0xffff0000, v98
    v_lshlrev_b32 v142, 16, v99
    v_and_b32 v143, 0xffff0000, v99
    v_lshlrev_b32 v160, 16, v118
    v_and_b32 v161, 0xffff0000, v118
    v_lshlrev_b32 v162, 16, v119
    v_and_b32 v163, 0xffff0000, v119
    v_lshlrev_b32 v144, 16, v100
    v_and_b32 v145, 0xffff0000, v100
    v_lshlrev_b32 v146, 16, v101
    v_and_b32 v147, 0xffff0000, v101
    v_lshlrev_b32 v164, 16, v120
    v_and_b32 v165, 0xffff0000, v120
    v_lshlrev_b32 v166, 16, v121
    v_and_b32 v167, 0xffff0000, v121
    v_lshlrev_b32 v148, 16, v102
    v_and_b32 v149, 0xffff0000, v102
    v_lshlrev_b32 v150, 16, v103
    v_and_b32 v151, 0xffff0000, v103
    v_lshlrev_b32 v168, 16, v122
    v_and_b32 v169, 0xffff0000, v122
    v_lshlrev_b32 v170, 16, v123
    v_and_b32 v171, 0xffff0000, v123
    v_lshlrev_b32 v152, 16, v104
    v_and_b32 v153, 0xffff0000, v104
    v_lshlrev_b32 v154, 16, v105
    v_and_b32 v155, 0xffff0000, v105
    v_lshlrev_b32 v172, 16, v124
    v_and_b32 v173, 0xffff0000, v124
    v_lshlrev_b32 v174, 16, v125
    v_and_b32 v175, 0xffff0000, v125
    v_pk_add_f32 v[32:33], v[32:33], v[136:137]
    v_pk_add_f32 v[34:35], v[34:35], v[138:139]
    v_pk_add_f32 v[36:37], v[36:37], v[140:141]
    v_pk_add_f32 v[38:39], v[38:39], v[142:143]
    v_pk_add_f32 v[40:41], v[40:41], v[144:145]
    v_pk_add_f32 v[42:43], v[42:43], v[146:147]
    v_pk_add_f32 v[44:45], v[44:45], v[148:149]
    v_pk_add_f32 v[46:47], v[46:47], v[150:151]
    v_pk_add_f32 v[48:49], v[48:49], v[152:153]
    v_pk_add_f32 v[50:51], v[50:51], v[154:155]
    s_waitcnt lgkmcnt(0)
    s_barrier
    ds_read_b128 v[72:75], v247 offset:0
    ds_read_b128 v[76:79], v247 offset:1024
    ds_read_b128 v[80:83], v247 offset:2048
    ds_read_b128 v[84:87], v247 offset:3072
    ds_read_b128 v[88:91], v247 offset:4096
    s_waitcnt lgkmcnt(4)
    v_pk_add_f32 v[32:33], v[32:33], v[72:73]
    v_pk_add_f32 v[34:35], v[34:35], v[74:75]
    v_pk_fma_f32 v[32:33], v[32:33], v[204:205], v[156:157]
    v_pk_fma_f32 v[34:35], v[34:35], v[206:207], v[158:159]
    v_cvt_pk_bf16_f32 v180, v32, v33
    v_cvt_pk_bf16_f32 v181, v34, v35
    s_waitcnt lgkmcnt(3)
    v_pk_add_f32 v[36:37], v[36:37], v[76:77]
    v_pk_add_f32 v[38:39], v[38:39], v[78:79]
    v_pk_fma_f32 v[36:37], v[36:37], v[208:209], v[160:161]
    v_pk_fma_f32 v[38:39], v[38:39], v[210:211], v[162:163]
    v_cvt_pk_bf16_f32 v182, v36, v37
    v_cvt_pk_bf16_f32 v183, v38, v39
    s_waitcnt lgkmcnt(2)
    v_pk_add_f32 v[40:41], v[40:41], v[80:81]
    v_pk_add_f32 v[42:43], v[42:43], v[82:83]
    v_pk_fma_f32 v[40:41], v[40:41], v[212:213], v[164:165]
    v_pk_fma_f32 v[42:43], v[42:43], v[214:215], v[166:167]
    v_cvt_pk_bf16_f32 v184, v40, v41
    v_cvt_pk_bf16_f32 v185, v42, v43
    s_waitcnt lgkmcnt(1)
    v_pk_add_f32 v[44:45], v[44:45], v[84:85]
    v_pk_add_f32 v[46:47], v[46:47], v[86:87]
    v_pk_fma_f32 v[44:45], v[44:45], v[216:217], v[168:169]
    v_pk_fma_f32 v[46:47], v[46:47], v[218:219], v[170:171]
    v_cvt_pk_bf16_f32 v186, v44, v45
    v_cvt_pk_bf16_f32 v187, v46, v47
    s_waitcnt lgkmcnt(0)
    v_pk_add_f32 v[48:49], v[48:49], v[88:89]
    v_pk_add_f32 v[50:51], v[50:51], v[90:91]
    v_pk_fma_f32 v[48:49], v[48:49], v[220:221], v[172:173]
    v_pk_fma_f32 v[50:51], v[50:51], v[222:223], v[174:175]
    v_cvt_pk_bf16_f32 v188, v48, v49
    v_cvt_pk_bf16_f32 v189, v50, v51
    s_nop 1
    v_permlane16_swap_b32 v180, v182
    v_permlane16_swap_b32 v181, v183
    v_permlane16_swap_b32 v184, v186
    v_permlane16_swap_b32 v185, v187
    buffer_store_dwordx4 v[180:183], v231, s[32:35], s46 offen sc1
    buffer_store_dwordx4 v[184:187], v231, s[32:35], s46 offen offset:64 sc1
    buffer_store_dwordx2 v[188:189], v232, s[32:35], s49 offen sc1
    s_endpgm
chain_end:
    s_endpgm
.section .rodata,"a"
.p2align 6
.amdhsa_kernel prep_kernel
  .amdhsa_next_free_vgpr 256
  .amdhsa_next_free_sgpr 100
  .amdhsa_accum_offset 256
  .amdhsa_group_segment_fixed_size 0
  .amdhsa_kernarg_size 128
  .amdhsa_user_sgpr_count 2
  .amdhsa_user_sgpr_kernarg_segment_ptr 1
  .amdhsa_system_sgpr_workgroup_id_x 1
  .amdhsa_float_denorm_mode_32 3
.end_amdhsa_kernel
.p2align 6
.amdhsa_kernel chain_kernel
  .amdhsa_next_free_vgpr 512
  .amdhsa_next_free_sgpr 100
  .amdhsa_accum_offset 256
  .amdhsa_group_segment_fixed_size 0
  .amdhsa_kernarg_size 128
  .amdhsa_user_sgpr_count 2
  .amdhsa_user_sgpr_kernarg_segment_ptr 1
  .amdhsa_system_sgpr_workgroup_id_x 1
  .amdhsa_float_denorm_mode_32 3
.end_amdhsa_kernel
```
